```python
import torch

def _softmax(x, axis=-1):
    return torch.softmax(x, dim=axis)

def _gelu(x):
    return torch.nn.functional.gelu(x, approximate='tanh')

def _silu(x):
    return torch.nn.functional.silu(x)

def _sigmoid(x):
    return torch.sigmoid(x)

def _layernorm(x, axis=-1, eps=1e-05):
    m = x.mean(dim=axis, keepdim=True)
    v = x.var(dim=axis, keepdim=True, unbiased=False)
    return (x - m) / torch.sqrt(v + eps)

def _scatter_add(tgt, idx, src, axis=0):
    return tgt.clone().index_add_(axis, idx, src)

def _segment_sum(src, seg, n):
    out = torch.zeros((n,) + src.shape[1:], dtype=src.dtype)
    return out.index_add_(0, seg, src)

def _pad(x, pw):
    flat = tuple((v for pair in reversed(pw) for v in pair))
    return torch.nn.functional.pad(x, flat)
kernel_name = 'adaLN_cond__sliding_block_cached__moe_arch_mod__prompt'

def setup_inputs():

    _w = lambda a: (lambda t: t.to(torch.bfloat16) if t.is_floating_point() else t)(torch.as_tensor(a))

    def _A_setup():
        B, Sq, D = (1, 2048, 1024)
        Hq, Hkv, Sk, Dh = (32, 4, 2048, 128)
        assert Hq % Hkv == 0, (Hq, Hkv)
        return {'x': _w((lambda *s: torch.randn(*s, dtype=torch.bfloat16) * 0.05)(B, Sq, D)), 'k_cache': _w((lambda *s: torch.randn(*s, dtype=torch.bfloat16) * 3.2)(B, Hkv, Sk, Dh)), 'v_cache': _w((lambda *s: torch.randn(*s, dtype=torch.bfloat16) * 0.4)(B, Hkv, Sk, Dh)), 'wq': _w((lambda *s: torch.randn(*s, dtype=torch.bfloat16) * 3.2)(D, Hq * Dh) * D ** (-0.5)), 'wo': _w((lambda *s: torch.randn(*s, dtype=torch.bfloat16) * 0.4)(Hq * Dh, D) * (Hq * Dh) ** (-0.5))}
    _A_in = _A_setup()

    def _B_setup():
        B, S, D, F, C = (1, 2048, 1024, 3584, 1)
        return {'x': _w((lambda *s: torch.randn(*s, dtype=torch.bfloat16) * 0.05)(B, S, D)), 'w_r': _w((lambda *s: torch.randn(*s, dtype=torch.bfloat16) * 0.05)(D)), 'w_gate': _w((lambda *s: torch.randn(*s, dtype=torch.bfloat16) * 0.05)(D, F)), 'w_up': _w((lambda *s: torch.randn(*s, dtype=torch.bfloat16) * 0.05)(D, F)), 'w_down': _w((lambda *s: torch.randn(*s, dtype=torch.bfloat16) * 0.05)(F, D))}
    _B_in = _B_setup()
    return {'A_x': _A_in['x'], 'A_k_cache': _A_in['k_cache'], 'A_v_cache': _A_in['v_cache'], 'A_wq': _A_in['wq'], 'A_wo': _A_in['wo'], 'B_x': _B_in['x'], 'B_w_r': _B_in['w_r'], 'B_w_gate': _B_in['w_gate'], 'B_w_up': _B_in['w_up'], 'B_w_down': _B_in['w_down'], 'c': _w((lambda *s: torch.randn(*s, dtype=torch.bfloat16) * 0.1)(1, 1024) * 8.0), 'w_mod': _w((lambda *s: torch.randn(*s, dtype=torch.bfloat16) * 0.1)(1024, 6 * 1024) * 1024 ** (-0.5) * 8.0)}

def reference(A_x, A_k_cache, A_v_cache, A_wq, A_wo, B_x, B_w_r, B_w_gate, B_w_up, B_w_down, c, w_mod):

    def _A_ref(x, k_cache, v_cache, wq, wo):
        B, Sq, D = x.shape
        Hq, Dh = (32, 128)
        Hkv, Sk = (k_cache.shape[1], k_cache.shape[2])
        W = min(4096, max(256, Sk // 4))
        rep = Hq // Hkv
        q = (lambda x, *d: x.permute(*d))((x @ wq).reshape(B, Sq, Hq, Dh), 0, 2, 1, 3)
        k = (lambda x, n, axis: torch.repeat_interleave(x, n, dim=axis))(k_cache[:, :, Sk - W:, :], rep, axis=1)
        v = (lambda x, n, axis: torch.repeat_interleave(x, n, dim=axis))(v_cache[:, :, Sk - W:, :], rep, axis=1)
        scores = torch.einsum('bhqd,bhkd->bhqk', q, k) * Dh ** (-0.5)
        p = _softmax(scores, axis=-1)
        o = torch.einsum('bhqk,bhkd->bhqd', p, v)
        return (lambda x, *d: x.permute(*d))(o, 0, 2, 1, 3).reshape(B, Sq, Hq * Dh) @ wo

    def _B_ref(x, w_r, w_gate, w_up, w_down):
        B, S, D = x.shape
        C = 1
        r = x @ w_r
        idx = torch.argsort(-r, axis=-1)[:, :C]
        idx_e = (lambda x, n, axis: torch.repeat_interleave(x, n, dim=axis))(idx.reshape(B, C, 1), D, axis=2)
        x_sel = (lambda x, i, axis: torch.take_along_dim(x, i, dim=axis))(x, idx_e, axis=1)
        g = _silu(x_sel @ w_gate)
        u = x_sel @ w_up
        y = g * u @ w_down
        r_sel = _sigmoid((lambda x, i, axis: torch.take_along_dim(x, i, dim=axis))(r, idx, axis=1))
        y = y * r_sel.reshape(B, C, 1)
        b_off = (torch.arange(B) * S).reshape(B, 1)
        flat_idx = (idx + b_off).reshape(B * C)
        zero = (x * 0.0).reshape(B * S, D)
        upd = _scatter_add(zero, flat_idx, y.reshape(B * C, D), axis=0)
        return x + upd.reshape(B, S, D)
    x = A_x
    mod = (_silu(c) @ w_mod).reshape(c.shape[0], 6, 1, -1)
    sa, ca, ga, sb, cb, gb = (mod[:, 0].clone(), mod[:, 1].clone(), mod[:, 2].clone(), mod[:, 3].clone(), mod[:, 4].clone(), mod[:, 5].clone())
    h = _layernorm(x, axis=-1) * (1 + ca) + sa
    x = x + ga * _A_ref(h, A_k_cache, A_v_cache, A_wq, A_wo)
    h = _layernorm(x, axis=-1) * (1 + cb) + sb
    x = x + gb * _B_ref(h, B_w_r, B_w_gate, B_w_up, B_w_down)
    return x
```

```asm
; @launch grid=(256,1,1) block=(512,1,1) lds=163840
.amdgcn_target "amdgcn-amd-amdhsa--gfx950"
.text
.globl adaLN_cond__sliding_block_cached__moe_arch_mod__prompt_kernel
.p2align 8
.type adaLN_cond__sliding_block_cached__moe_arch_mod__prompt_kernel,@function
adaLN_cond__sliding_block_cached__moe_arch_mod__prompt_kernel:
fz_start:
    s_cmp_ge_u32 s2, 256
    s_cbranch_scc1 fz_end
    s_load_dwordx16 s[32:47], s[0:1], 0
    s_load_dwordx8 s[48:55], s[0:1], 64
    s_load_dwordx4 s[56:59], s[0:1], 96
    s_load_dwordx2 s[60:61], s[0:1], 112
    s_and_b32 s12, s2, 3
    s_lshl_b32 s12, s12, 3
    s_bfe_u32 s13, s2, 0x30003
    s_add_u32 s12, s12, s13
    s_bfe_u32 s13, s2, 0x10002
    s_lshl_b32 s13, s13, 2
    s_lshr_b32 s19, s2, 6
    s_add_u32 s13, s13, s19
    s_mov_b32 s15, 0
    v_and_b32 v8, 255, v0
    v_lshrrev_b32 v9, 6, v0
    v_and_b32 v0, 63, v0
    v_readfirstlane_b32 s3, v9
    v_lshlrev_b32 v1, 4, v0
    s_mov_b32 s10, 0x3400000
    s_mov_b32 s11, 0x20000
    s_lshl_b32 s19, s13, 3
    s_add_u32 s19, s19, s3
    s_lshl_b32 s20, s19, 16
    v_add_u32 v4, s20, v1
    v_bfe_u32 v9, v0, 2, 2
    v_lshrrev_b32 v10, 4, v0
    v_and_b32 v11, 3, v0
    v_bfe_u32 v13, v0, 4, 1
    v_lshlrev_b32 v3, 11, v10
    v_lshl_add_u32 v3, v9, 6, v3
    v_lshl_add_u32 v3, v11, 3, v3
    v_lshlrev_b32 v16, 5, v13
    v_sub_u32 v15, v3, v16
    v_add_u32 v3, v3, v16
    v_lshlrev_b32 v2, 6, v10
    v_lshl_add_u32 v2, v11, 4, v2
    v_lshl_add_u32 v2, v9, 13, v2
    v_xor_b32 v16, 32, v2
    s_lshr_b32 s18, s12, 3
    s_lshl_b32 s18, s18, 18
    s_add_u32 s18, s18, 0x400000
    v_add_u32 v5, s18, v1
    v_mov_b32 v17, 0
    v_mov_b32 v18, 0
    v_mov_b32 v19, 0
    s_lshl_b32 s16, s3, 17
    s_lshl_b32 s17, s3, 12
    s_cmp_ge_u32 s3, 4
    s_cbranch_scc1 fz_roleB
    v_and_b32 v20, 7, v8
    v_bfe_u32 v26, v8, 3, 3
    v_lshlrev_b32 v22, 4, v26
    s_lshl_b32 s19, s3, 9
    v_add_u32 v22, s19, v22
    v_lshl_add_u32 v21, v20, 11, v22
    v_mov_b32 v25, 0
    s_lshl_b32 s25, s2, 14
    s_waitcnt lgkmcnt(0)
    s_mov_b64 s[8:9], s[60:61]
    s_mov_b64 s[28:29], s[32:33]
    s_mov_b32 s30, 0x400000
    s_mov_b32 s31, 0x20000
    s_barrier
    buffer_load_dwordx4 v[36:39], v21, s[28:31], s25 offen offset:0
    buffer_load_dwordx4 v[40:43], v21, s[28:31], s25 offen offset:128
    buffer_load_dwordx4 v[44:47], v21, s[28:31], s25 offen offset:256
    buffer_load_dwordx4 v[48:51], v21, s[28:31], s25 offen offset:384
    s_mov_b32 s27, 0x570000
    buffer_load_dword v24, v25, s[8:11], s27 offen sc1
    s_lshl_b32 s19, s12, 8
    s_add_u32 s4, s38, s19
    s_addc_u32 s5, s39, 0
    s_sub_u32 s6, 0x800000, s19
    s_mov_b32 s7, 0x20000
    s_waitcnt vmcnt(4)
    v_lshlrev_b32 v52, 16, v36
    v_and_b32 v53, 0xffff0000, v36
    v_lshlrev_b32 v54, 16, v37
    v_and_b32 v55, 0xffff0000, v37
    v_lshlrev_b32 v56, 16, v38
    v_and_b32 v57, 0xffff0000, v38
    v_lshlrev_b32 v58, 16, v39
    v_and_b32 v59, 0xffff0000, v39
    s_waitcnt vmcnt(3)
    v_lshlrev_b32 v60, 16, v40
    v_and_b32 v61, 0xffff0000, v40
    v_lshlrev_b32 v62, 16, v41
    v_and_b32 v63, 0xffff0000, v41
    v_lshlrev_b32 v64, 16, v42
    v_and_b32 v65, 0xffff0000, v42
    v_lshlrev_b32 v66, 16, v43
    v_and_b32 v67, 0xffff0000, v43
    s_waitcnt vmcnt(2)
    v_lshlrev_b32 v68, 16, v44
    v_and_b32 v69, 0xffff0000, v44
    v_lshlrev_b32 v70, 16, v45
    v_and_b32 v71, 0xffff0000, v45
    v_lshlrev_b32 v72, 16, v46
    v_and_b32 v73, 0xffff0000, v46
    v_lshlrev_b32 v74, 16, v47
    v_and_b32 v75, 0xffff0000, v47
    s_waitcnt vmcnt(1)
    v_lshlrev_b32 v76, 16, v48
    v_and_b32 v77, 0xffff0000, v48
    v_lshlrev_b32 v78, 16, v49
    v_and_b32 v79, 0xffff0000, v49
    v_lshlrev_b32 v80, 16, v50
    v_and_b32 v81, 0xffff0000, v50
    v_lshlrev_b32 v82, 16, v51
    v_and_b32 v83, 0xffff0000, v51
    s_waitcnt vmcnt(0)
    v_readfirstlane_b32 s14, v24
    s_add_u32 s14, s14, 1
    v_lshlrev_b32 v30, 5, v20
    s_lshl_b32 s19, s3, 3
    v_add_u32 v23, s19, v30
    v_add_f32 v31, v52, v53
    v_add_f32 v32, v54, v55
    v_add_f32 v31, v31, v56
    v_add_f32 v32, v32, v57
    v_add_f32 v31, v31, v58
    v_add_f32 v32, v32, v59
    v_add_f32 v31, v31, v60
    v_add_f32 v32, v32, v61
    v_add_f32 v31, v31, v62
    v_add_f32 v32, v32, v63
    v_add_f32 v31, v31, v64
    v_add_f32 v32, v32, v65
    v_add_f32 v31, v31, v66
    v_add_f32 v32, v32, v67
    v_add_f32 v31, v31, v68
    v_add_f32 v32, v32, v69
    v_add_f32 v31, v31, v70
    v_add_f32 v32, v32, v71
    v_add_f32 v31, v31, v72
    v_add_f32 v32, v32, v73
    v_add_f32 v31, v31, v74
    v_add_f32 v32, v32, v75
    v_add_f32 v31, v31, v76
    v_add_f32 v32, v32, v77
    v_add_f32 v31, v31, v78
    v_add_f32 v32, v32, v79
    v_add_f32 v31, v31, v80
    v_add_f32 v32, v32, v81
    v_add_f32 v31, v31, v82
    v_add_f32 v32, v32, v83
    v_add_f32 v26, v31, v32
    s_nop 1
    v_add_f32_dpp v26, v26, v26 row_ror:8 row_mask:0xf bank_mask:0xf
    v_mov_b32 v148, v26
    s_nop 1
    v_permlane16_swap_b32 v26, v148
    v_add_f32 v26, v26, v148
    v_mov_b32 v148, v26
    s_nop 1
    v_permlane32_swap_b32 v26, v148
    v_add_f32 v26, v26, v148
    v_mul_f32 v26, 0x3b800000, v26
    v_sub_f32 v28, v52, v26
    v_mul_f32 v31, v28, v28
    v_sub_f32 v29, v53, v26
    v_mul_f32 v32, v29, v29
    v_sub_f32 v28, v54, v26
    v_sub_f32 v29, v55, v26
    v_fmac_f32 v31, v28, v28
    v_fmac_f32 v32, v29, v29
    v_sub_f32 v28, v56, v26
    v_sub_f32 v29, v57, v26
    v_fmac_f32 v31, v28, v28
    v_fmac_f32 v32, v29, v29
    v_sub_f32 v28, v58, v26
    v_sub_f32 v29, v59, v26
    v_fmac_f32 v31, v28, v28
    v_fmac_f32 v32, v29, v29
    v_sub_f32 v28, v60, v26
    v_sub_f32 v29, v61, v26
    v_fmac_f32 v31, v28, v28
    v_fmac_f32 v32, v29, v29
    v_sub_f32 v28, v62, v26
    v_sub_f32 v29, v63, v26
    v_fmac_f32 v31, v28, v28
    v_fmac_f32 v32, v29, v29
    v_sub_f32 v28, v64, v26
    v_sub_f32 v29, v65, v26
    v_fmac_f32 v31, v28, v28
    v_fmac_f32 v32, v29, v29
    v_sub_f32 v28, v66, v26
    v_sub_f32 v29, v67, v26
    v_fmac_f32 v31, v28, v28
    v_fmac_f32 v32, v29, v29
    v_sub_f32 v28, v68, v26
    v_sub_f32 v29, v69, v26
    v_fmac_f32 v31, v28, v28
    v_fmac_f32 v32, v29, v29
    v_sub_f32 v28, v70, v26
    v_sub_f32 v29, v71, v26
    v_fmac_f32 v31, v28, v28
    v_fmac_f32 v32, v29, v29
    v_sub_f32 v28, v72, v26
    v_sub_f32 v29, v73, v26
    v_fmac_f32 v31, v28, v28
    v_fmac_f32 v32, v29, v29
    v_sub_f32 v28, v74, v26
    v_sub_f32 v29, v75, v26
    v_fmac_f32 v31, v28, v28
    v_fmac_f32 v32, v29, v29
    v_sub_f32 v28, v76, v26
    v_sub_f32 v29, v77, v26
    v_fmac_f32 v31, v28, v28
    v_fmac_f32 v32, v29, v29
    v_sub_f32 v28, v78, v26
    v_sub_f32 v29, v79, v26
    v_fmac_f32 v31, v28, v28
    v_fmac_f32 v32, v29, v29
    v_sub_f32 v28, v80, v26
    v_sub_f32 v29, v81, v26
    v_fmac_f32 v31, v28, v28
    v_fmac_f32 v32, v29, v29
    v_sub_f32 v28, v82, v26
    v_sub_f32 v29, v83, v26
    v_fmac_f32 v31, v28, v28
    v_fmac_f32 v32, v29, v29
    v_add_f32 v27, v31, v32
    s_nop 1
    v_add_f32_dpp v27, v27, v27 row_ror:8 row_mask:0xf bank_mask:0xf
    v_mov_b32 v148, v27
    s_nop 1
    v_permlane16_swap_b32 v27, v148
    v_add_f32 v27, v27, v148
    v_mov_b32 v148, v27
    s_nop 1
    v_permlane32_swap_b32 v27, v148
    v_add_f32 v27, v27, v148
    v_add_u32 v23, 0x20400, v23
    ds_write_b64 v23, v[26:27]
    v_add_u32 v30, 0x20400, v30
    s_waitcnt lgkmcnt(0)
    s_barrier
    ds_read_b128 v[148:151], v30
    ds_read_b128 v[152:155], v30 offset:16
    s_waitcnt lgkmcnt(1)
    v_add_f32 v31, v148, v150
    s_waitcnt lgkmcnt(0)
    v_add_f32 v32, v152, v154
    v_add_f32 v26, v31, v32
    v_mul_f32 v26, 0x3e800000, v26
    v_add_f32 v31, v149, v151
    v_add_f32 v32, v153, v155
    v_add_f32 v27, v31, v32
    v_sub_f32 v148, v148, v26
    v_sub_f32 v150, v150, v26
    v_sub_f32 v152, v152, v26
    v_sub_f32 v154, v154, v26
    v_mul_f32 v31, v148, v148
    v_fmac_f32 v31, v150, v150
    v_fmac_f32 v31, v152, v152
    v_fmac_f32 v31, v154, v154
    v_fmamk_f32 v27, v31, 0x43800000, v27
    v_mul_f32 v27, 0x3a800000, v27
    v_cvt_pk_bf16_f32 v26, v26, v26
    v_lshlrev_b32 v26, 16, v26
    v_cvt_pk_bf16_f32 v27, v27, v27
    v_lshlrev_b32 v27, 16, v27
    v_add_f32 v27, 0x3727c5ac, v27
    v_cvt_pk_bf16_f32 v27, v27, v27
    v_lshlrev_b32 v27, 16, v27
    v_sqrt_f32 v28, v27
    s_nop 0
    v_cvt_pk_bf16_f32 v28, v28, v28
    v_lshlrev_b32 v28, 16, v28
    v_rcp_f32 v29, v28
    s_nop 0
    v_mov_b32 v28, v29
    v_pk_add_f32 v[52:53], v[52:53], v[26:27] op_sel_hi:[1,0] neg_lo:[0,1] neg_hi:[0,1]
    v_pk_add_f32 v[54:55], v[54:55], v[26:27] op_sel_hi:[1,0] neg_lo:[0,1] neg_hi:[0,1]
    v_pk_add_f32 v[56:57], v[56:57], v[26:27] op_sel_hi:[1,0] neg_lo:[0,1] neg_hi:[0,1]
    v_pk_add_f32 v[58:59], v[58:59], v[26:27] op_sel_hi:[1,0] neg_lo:[0,1] neg_hi:[0,1]
    v_pk_add_f32 v[60:61], v[60:61], v[26:27] op_sel_hi:[1,0] neg_lo:[0,1] neg_hi:[0,1]
    v_pk_add_f32 v[62:63], v[62:63], v[26:27] op_sel_hi:[1,0] neg_lo:[0,1] neg_hi:[0,1]
    v_pk_add_f32 v[64:65], v[64:65], v[26:27] op_sel_hi:[1,0] neg_lo:[0,1] neg_hi:[0,1]
    v_pk_add_f32 v[66:67], v[66:67], v[26:27] op_sel_hi:[1,0] neg_lo:[0,1] neg_hi:[0,1]
    v_pk_add_f32 v[68:69], v[68:69], v[26:27] op_sel_hi:[1,0] neg_lo:[0,1] neg_hi:[0,1]
    v_pk_add_f32 v[70:71], v[70:71], v[26:27] op_sel_hi:[1,0] neg_lo:[0,1] neg_hi:[0,1]
    v_pk_add_f32 v[72:73], v[72:73], v[26:27] op_sel_hi:[1,0] neg_lo:[0,1] neg_hi:[0,1]
    v_pk_add_f32 v[74:75], v[74:75], v[26:27] op_sel_hi:[1,0] neg_lo:[0,1] neg_hi:[0,1]
    v_pk_add_f32 v[76:77], v[76:77], v[26:27] op_sel_hi:[1,0] neg_lo:[0,1] neg_hi:[0,1]
    v_pk_add_f32 v[78:79], v[78:79], v[26:27] op_sel_hi:[1,0] neg_lo:[0,1] neg_hi:[0,1]
    v_pk_add_f32 v[80:81], v[80:81], v[26:27] op_sel_hi:[1,0] neg_lo:[0,1] neg_hi:[0,1]
    v_pk_add_f32 v[82:83], v[82:83], v[26:27] op_sel_hi:[1,0] neg_lo:[0,1] neg_hi:[0,1]
    v_cvt_pk_bf16_f32 v31, v52, v53
    v_lshlrev_b32 v52, 16, v31
    v_and_b32 v53, 0xffff0000, v31
    v_cvt_pk_bf16_f32 v31, v54, v55
    v_lshlrev_b32 v54, 16, v31
    v_and_b32 v55, 0xffff0000, v31
    v_cvt_pk_bf16_f32 v31, v56, v57
    v_lshlrev_b32 v56, 16, v31
    v_and_b32 v57, 0xffff0000, v31
    v_cvt_pk_bf16_f32 v31, v58, v59
    v_lshlrev_b32 v58, 16, v31
    v_and_b32 v59, 0xffff0000, v31
    v_cvt_pk_bf16_f32 v31, v60, v61
    v_lshlrev_b32 v60, 16, v31
    v_and_b32 v61, 0xffff0000, v31
    v_cvt_pk_bf16_f32 v31, v62, v63
    v_lshlrev_b32 v62, 16, v31
    v_and_b32 v63, 0xffff0000, v31
    v_cvt_pk_bf16_f32 v31, v64, v65
    v_lshlrev_b32 v64, 16, v31
    v_and_b32 v65, 0xffff0000, v31
    v_cvt_pk_bf16_f32 v31, v66, v67
    v_lshlrev_b32 v66, 16, v31
    v_and_b32 v67, 0xffff0000, v31
    v_cvt_pk_bf16_f32 v31, v68, v69
    v_lshlrev_b32 v68, 16, v31
    v_and_b32 v69, 0xffff0000, v31
    v_cvt_pk_bf16_f32 v31, v70, v71
    v_lshlrev_b32 v70, 16, v31
    v_and_b32 v71, 0xffff0000, v31
    v_cvt_pk_bf16_f32 v31, v72, v73
    v_lshlrev_b32 v72, 16, v31
    v_and_b32 v73, 0xffff0000, v31
    v_cvt_pk_bf16_f32 v31, v74, v75
    v_lshlrev_b32 v74, 16, v31
    v_and_b32 v75, 0xffff0000, v31
    v_cvt_pk_bf16_f32 v31, v76, v77
    v_lshlrev_b32 v76, 16, v31
    v_and_b32 v77, 0xffff0000, v31
    v_cvt_pk_bf16_f32 v31, v78, v79
    v_lshlrev_b32 v78, 16, v31
    v_and_b32 v79, 0xffff0000, v31
    v_cvt_pk_bf16_f32 v31, v80, v81
    v_lshlrev_b32 v80, 16, v31
    v_and_b32 v81, 0xffff0000, v31
    v_cvt_pk_bf16_f32 v31, v82, v83
    v_lshlrev_b32 v82, 16, v31
    v_and_b32 v83, 0xffff0000, v31
    v_pk_mul_f32 v[52:53], v[52:53], v[28:29] op_sel_hi:[1,0]
    v_pk_mul_f32 v[54:55], v[54:55], v[28:29] op_sel_hi:[1,0]
    v_pk_mul_f32 v[56:57], v[56:57], v[28:29] op_sel_hi:[1,0]
    v_pk_mul_f32 v[58:59], v[58:59], v[28:29] op_sel_hi:[1,0]
    v_pk_mul_f32 v[60:61], v[60:61], v[28:29] op_sel_hi:[1,0]
    v_pk_mul_f32 v[62:63], v[62:63], v[28:29] op_sel_hi:[1,0]
    v_pk_mul_f32 v[64:65], v[64:65], v[28:29] op_sel_hi:[1,0]
    v_pk_mul_f32 v[66:67], v[66:67], v[28:29] op_sel_hi:[1,0]
    v_pk_mul_f32 v[68:69], v[68:69], v[28:29] op_sel_hi:[1,0]
    v_pk_mul_f32 v[70:71], v[70:71], v[28:29] op_sel_hi:[1,0]
    v_pk_mul_f32 v[72:73], v[72:73], v[28:29] op_sel_hi:[1,0]
    v_pk_mul_f32 v[74:75], v[74:75], v[28:29] op_sel_hi:[1,0]
    v_pk_mul_f32 v[76:77], v[76:77], v[28:29] op_sel_hi:[1,0]
    v_pk_mul_f32 v[78:79], v[78:79], v[28:29] op_sel_hi:[1,0]
    v_pk_mul_f32 v[80:81], v[80:81], v[28:29] op_sel_hi:[1,0]
    v_pk_mul_f32 v[82:83], v[82:83], v[28:29] op_sel_hi:[1,0]
    v_cvt_pk_bf16_f32 v31, v52, v53
    v_lshlrev_b32 v52, 16, v31
    v_and_b32 v53, 0xffff0000, v31
    v_cvt_pk_bf16_f32 v31, v54, v55
    v_lshlrev_b32 v54, 16, v31
    v_and_b32 v55, 0xffff0000, v31
    v_cvt_pk_bf16_f32 v31, v56, v57
    v_lshlrev_b32 v56, 16, v31
    v_and_b32 v57, 0xffff0000, v31
    v_cvt_pk_bf16_f32 v31, v58, v59
    v_lshlrev_b32 v58, 16, v31
    v_and_b32 v59, 0xffff0000, v31
    v_cvt_pk_bf16_f32 v31, v60, v61
    v_lshlrev_b32 v60, 16, v31
    v_and_b32 v61, 0xffff0000, v31
    v_cvt_pk_bf16_f32 v31, v62, v63
    v_lshlrev_b32 v62, 16, v31
    v_and_b32 v63, 0xffff0000, v31
    v_cvt_pk_bf16_f32 v31, v64, v65
    v_lshlrev_b32 v64, 16, v31
    v_and_b32 v65, 0xffff0000, v31
    v_cvt_pk_bf16_f32 v31, v66, v67
    v_lshlrev_b32 v66, 16, v31
    v_and_b32 v67, 0xffff0000, v31
    v_cvt_pk_bf16_f32 v31, v68, v69
    v_lshlrev_b32 v68, 16, v31
    v_and_b32 v69, 0xffff0000, v31
    v_cvt_pk_bf16_f32 v31, v70, v71
    v_lshlrev_b32 v70, 16, v31
    v_and_b32 v71, 0xffff0000, v31
    v_cvt_pk_bf16_f32 v31, v72, v73
    v_lshlrev_b32 v72, 16, v31
    v_and_b32 v73, 0xffff0000, v31
    v_cvt_pk_bf16_f32 v31, v74, v75
    v_lshlrev_b32 v74, 16, v31
    v_and_b32 v75, 0xffff0000, v31
    v_cvt_pk_bf16_f32 v31, v76, v77
    v_lshlrev_b32 v76, 16, v31
    v_and_b32 v77, 0xffff0000, v31
    v_cvt_pk_bf16_f32 v31, v78, v79
    v_lshlrev_b32 v78, 16, v31
    v_and_b32 v79, 0xffff0000, v31
    v_cvt_pk_bf16_f32 v31, v80, v81
    v_lshlrev_b32 v80, 16, v31
    v_and_b32 v81, 0xffff0000, v31
    v_cvt_pk_bf16_f32 v31, v82, v83
    v_lshlrev_b32 v82, 16, v31
    v_and_b32 v83, 0xffff0000, v31
    v_lshlrev_b32 v33, 1, v22
    v_add_u32 v33, 0x21000, v33
    v_lshlrev_b32 v23, 4, v22
    v_lshl_add_u32 v23, v20, 4, v23
    s_lshr_b32 s23, s2, 1
    s_lshl_b32 s23, s23, 15
    s_and_b32 s24, s2, 1
    s_lshl_b32 s24, s24, 7
    s_add_u32 s23, s23, s24
    s_barrier
    ds_read_b128 v[84:87], v33 offset:4096
    ds_read_b128 v[116:119], v33 offset:0
    ds_read_b128 v[88:91], v33 offset:4112
    ds_read_b128 v[120:123], v33 offset:16
    ds_read_b128 v[92:95], v33 offset:4352
    ds_read_b128 v[124:127], v33 offset:256
    ds_read_b128 v[96:99], v33 offset:4368
    ds_read_b128 v[128:131], v33 offset:272
    ds_read_b128 v[100:103], v33 offset:4608
    ds_read_b128 v[132:135], v33 offset:512
    ds_read_b128 v[104:107], v33 offset:4624
    ds_read_b128 v[136:139], v33 offset:528
    ds_read_b128 v[108:111], v33 offset:4864
    ds_read_b128 v[140:143], v33 offset:768
    ds_read_b128 v[112:115], v33 offset:4880
    ds_read_b128 v[144:147], v33 offset:784
    s_waitcnt lgkmcnt(15)
    v_pk_mul_f32 v[52:53], v[52:53], v[84:85]
    v_pk_mul_f32 v[54:55], v[54:55], v[86:87]
    s_waitcnt lgkmcnt(13)
    v_pk_mul_f32 v[56:57], v[56:57], v[88:89]
    v_pk_mul_f32 v[58:59], v[58:59], v[90:91]
    v_cvt_pk_bf16_f32 v31, v52, v53
    v_lshlrev_b32 v52, 16, v31
    v_and_b32 v53, 0xffff0000, v31
    v_cvt_pk_bf16_f32 v31, v54, v55
    v_lshlrev_b32 v54, 16, v31
    v_and_b32 v55, 0xffff0000, v31
    v_cvt_pk_bf16_f32 v31, v56, v57
    v_lshlrev_b32 v56, 16, v31
    v_and_b32 v57, 0xffff0000, v31
    v_cvt_pk_bf16_f32 v31, v58, v59
    v_lshlrev_b32 v58, 16, v31
    v_and_b32 v59, 0xffff0000, v31
    v_pk_add_f32 v[52:53], v[52:53], v[116:117]
    v_pk_add_f32 v[54:55], v[54:55], v[118:119]
    s_waitcnt lgkmcnt(12)
    v_pk_add_f32 v[56:57], v[56:57], v[120:121]
    v_pk_add_f32 v[58:59], v[58:59], v[122:123]
    v_cvt_pk_bf16_f32 v36, v52, v53
    v_cvt_pk_bf16_f32 v37, v54, v55
    v_cvt_pk_bf16_f32 v38, v56, v57
    v_cvt_pk_bf16_f32 v39, v58, v59
    s_add_u32 s24, s23, 0
    buffer_store_dwordx4 v[36:39], v23, s[8:11], s24 offen sc1
    s_waitcnt lgkmcnt(11)
    v_pk_mul_f32 v[60:61], v[60:61], v[92:93]
    v_pk_mul_f32 v[62:63], v[62:63], v[94:95]
    s_waitcnt lgkmcnt(9)
    v_pk_mul_f32 v[64:65], v[64:65], v[96:97]
    v_pk_mul_f32 v[66:67], v[66:67], v[98:99]
    v_cvt_pk_bf16_f32 v31, v60, v61
    v_lshlrev_b32 v60, 16, v31
    v_and_b32 v61, 0xffff0000, v31
    v_cvt_pk_bf16_f32 v31, v62, v63
    v_lshlrev_b32 v62, 16, v31
    v_and_b32 v63, 0xffff0000, v31
    v_cvt_pk_bf16_f32 v31, v64, v65
    v_lshlrev_b32 v64, 16, v31
    v_and_b32 v65, 0xffff0000, v31
    v_cvt_pk_bf16_f32 v31, v66, v67
    v_lshlrev_b32 v66, 16, v31
    v_and_b32 v67, 0xffff0000, v31
    v_pk_add_f32 v[60:61], v[60:61], v[124:125]
    v_pk_add_f32 v[62:63], v[62:63], v[126:127]
    s_waitcnt lgkmcnt(8)
    v_pk_add_f32 v[64:65], v[64:65], v[128:129]
    v_pk_add_f32 v[66:67], v[66:67], v[130:131]
    v_cvt_pk_bf16_f32 v40, v60, v61
    v_cvt_pk_bf16_f32 v41, v62, v63
    v_cvt_pk_bf16_f32 v42, v64, v65
    v_cvt_pk_bf16_f32 v43, v66, v67
    s_add_u32 s24, s23, 2048
    buffer_store_dwordx4 v[40:43], v23, s[8:11], s24 offen sc1
    s_waitcnt lgkmcnt(7)
    v_pk_mul_f32 v[68:69], v[68:69], v[100:101]
    v_pk_mul_f32 v[70:71], v[70:71], v[102:103]
    s_waitcnt lgkmcnt(5)
    v_pk_mul_f32 v[72:73], v[72:73], v[104:105]
    v_pk_mul_f32 v[74:75], v[74:75], v[106:107]
    v_cvt_pk_bf16_f32 v31, v68, v69
    v_lshlrev_b32 v68, 16, v31
    v_and_b32 v69, 0xffff0000, v31
    v_cvt_pk_bf16_f32 v31, v70, v71
    v_lshlrev_b32 v70, 16, v31
    v_and_b32 v71, 0xffff0000, v31
    v_cvt_pk_bf16_f32 v31, v72, v73
    v_lshlrev_b32 v72, 16, v31
    v_and_b32 v73, 0xffff0000, v31
    v_cvt_pk_bf16_f32 v31, v74, v75
    v_lshlrev_b32 v74, 16, v31
    v_and_b32 v75, 0xffff0000, v31
    v_pk_add_f32 v[68:69], v[68:69], v[132:133]
    v_pk_add_f32 v[70:71], v[70:71], v[134:135]
    s_waitcnt lgkmcnt(4)
    v_pk_add_f32 v[72:73], v[72:73], v[136:137]
    v_pk_add_f32 v[74:75], v[74:75], v[138:139]
    v_cvt_pk_bf16_f32 v44, v68, v69
    v_cvt_pk_bf16_f32 v45, v70, v71
    v_cvt_pk_bf16_f32 v46, v72, v73
    v_cvt_pk_bf16_f32 v47, v74, v75
    s_add_u32 s24, s23, 4096
    buffer_store_dwordx4 v[44:47], v23, s[8:11], s24 offen sc1
    s_waitcnt lgkmcnt(3)
    v_pk_mul_f32 v[76:77], v[76:77], v[108:109]
    v_pk_mul_f32 v[78:79], v[78:79], v[110:111]
    s_waitcnt lgkmcnt(1)
    v_pk_mul_f32 v[80:81], v[80:81], v[112:113]
    v_pk_mul_f32 v[82:83], v[82:83], v[114:115]
    v_cvt_pk_bf16_f32 v31, v76, v77
    v_lshlrev_b32 v76, 16, v31
    v_and_b32 v77, 0xffff0000, v31
    v_cvt_pk_bf16_f32 v31, v78, v79
    v_lshlrev_b32 v78, 16, v31
    v_and_b32 v79, 0xffff0000, v31
    v_cvt_pk_bf16_f32 v31, v80, v81
    v_lshlrev_b32 v80, 16, v31
    v_and_b32 v81, 0xffff0000, v31
    v_cvt_pk_bf16_f32 v31, v82, v83
    v_lshlrev_b32 v82, 16, v31
    v_and_b32 v83, 0xffff0000, v31
    v_pk_add_f32 v[76:77], v[76:77], v[140:141]
    v_pk_add_f32 v[78:79], v[78:79], v[142:143]
    s_waitcnt lgkmcnt(0)
    v_pk_add_f32 v[80:81], v[80:81], v[144:145]
    v_pk_add_f32 v[82:83], v[82:83], v[146:147]
    v_cvt_pk_bf16_f32 v48, v76, v77
    v_cvt_pk_bf16_f32 v49, v78, v79
    v_cvt_pk_bf16_f32 v50, v80, v81
    v_cvt_pk_bf16_f32 v51, v82, v83
    s_add_u32 s24, s23, 6144
    buffer_store_dwordx4 v[48:51], v23, s[8:11], s24 offen sc1
    s_lshl_b32 s26, s2, 7
    s_lshl_b32 s27, s3, 2
    s_add_u32 s26, s26, s27
    s_add_u32 s26, s26, 0x510000
    v_mov_b32 v24, s14
    s_waitcnt vmcnt(0)
    s_mov_b64 exec, 1
    buffer_store_dword v24, v25, s[8:11], s26 offen sc1
    s_mov_b64 exec, -1
    s_add_u32 s22, s16, 0x0
    s_add_u32 m0, s17, 0x0
    s_nop 0
    buffer_load_dwordx4 v2, s[4:7], s22 offen lds
    s_add_u32 s22, s16, 0x8000
    s_add_u32 m0, s17, 0x400
    s_nop 0
    buffer_load_dwordx4 v2, s[4:7], s22 offen lds
    s_add_u32 s22, s16, 0x10000
    s_add_u32 m0, s17, 0x800
    s_nop 0
    buffer_load_dwordx4 v16, s[4:7], s22 offen lds
    s_add_u32 s22, s16, 0x18000
    s_add_u32 m0, s17, 0xc00
    s_nop 0
    buffer_load_dwordx4 v16, s[4:7], s22 offen lds
    s_add_u32 s22, s16, 0x80000
    s_add_u32 m0, s17, 0x4000
    s_nop 0
    buffer_load_dwordx4 v2, s[4:7], s22 offen lds
    s_add_u32 s22, s16, 0x88000
    s_add_u32 m0, s17, 0x4400
    s_nop 0
    buffer_load_dwordx4 v2, s[4:7], s22 offen lds
    s_add_u32 s22, s16, 0x90000
    s_add_u32 m0, s17, 0x4800
    s_nop 0
    buffer_load_dwordx4 v16, s[4:7], s22 offen lds
    s_add_u32 s22, s16, 0x98000
    s_add_u32 m0, s17, 0x4c00
    s_nop 0
    buffer_load_dwordx4 v16, s[4:7], s22 offen lds
    s_add_u32 s22, s16, 0x100000
    s_add_u32 m0, s17, 0x8000
    s_nop 0
    buffer_load_dwordx4 v2, s[4:7], s22 offen lds
    s_add_u32 s22, s16, 0x108000
    s_add_u32 m0, s17, 0x8400
    s_nop 0
    buffer_load_dwordx4 v2, s[4:7], s22 offen lds
    s_add_u32 s22, s16, 0x110000
    s_add_u32 m0, s17, 0x8800
    s_nop 0
    buffer_load_dwordx4 v16, s[4:7], s22 offen lds
    s_add_u32 s22, s16, 0x118000
    s_add_u32 m0, s17, 0x8c00
    s_nop 0
    buffer_load_dwordx4 v16, s[4:7], s22 offen lds
    s_barrier
    s_lshl_b32 s26, s13, 5
    s_lshl_b32 s25, s3, 2
    s_add_u32 s26, s26, s25
    v_bfe_u32 v9, v0, 2, 2
    v_lshlrev_b32 v9, 7, v9
    v_and_b32 v10, 3, v0
    v_lshl_add_u32 v9, v10, 2, v9
    s_lshl_b32 s26, s26, 7
    s_add_u32 s26, s26, 0x510000
    s_mov_b32 s27, 0
fz_hAp:
    buffer_load_dword v10, v9, s[8:11], s26 offen sc1
    s_waitcnt vmcnt(0)
    v_cmp_ne_u32 vcc, s14, v10
    s_add_u32 s27, s27, 1
    s_cmp_ge_u32 s27, 65536
    s_cbranch_scc1 fz_hAg
    s_cbranch_vccz fz_hAg
    s_sleep 4
    s_branch fz_hAp
fz_hAg:
    s_mov_b32 s23, 0x0
    buffer_load_dwordx4 v[204:207], v4, s[8:11], s23 offen offset:0 sc1
    s_mov_b32 s23, 0x8000
    buffer_load_dwordx4 v[208:211], v4, s[8:11], s23 offen offset:0 sc1
    s_mov_b32 s23, 0x0
    buffer_load_dwordx4 v[212:215], v4, s[8:11], s23 offen offset:1024 sc1
    s_mov_b32 s23, 0x8000
    buffer_load_dwordx4 v[216:219], v4, s[8:11], s23 offen offset:1024 sc1
    s_barrier
    ds_read_b64_tr_b16 v[84:85], v3 offset:0
    ds_read_b64_tr_b16 v[86:87], v3 offset:1024
    ds_read_b64_tr_b16 v[88:89], v15 offset:32
    ds_read_b64_tr_b16 v[90:91], v15 offset:1056
    ds_read_b64_tr_b16 v[92:93], v3 offset:256
    ds_read_b64_tr_b16 v[94:95], v3 offset:1280
    ds_read_b64_tr_b16 v[96:97], v15 offset:288
    ds_read_b64_tr_b16 v[98:99], v15 offset:1312
    s_waitcnt vmcnt(3) lgkmcnt(6)
    v_mfma_f32_16x16x32_bf16 v[20:23], v[84:87], v[204:207], 0
    s_mov_b32 s23, 0x800
    buffer_load_dwordx4 v[220:223], v4, s[8:11], s23 offen offset:0 sc1
    ds_read_b64_tr_b16 v[100:101], v3 offset:512
    s_waitcnt vmcnt(3)
    v_mfma_f32_16x16x32_bf16 v[24:27], v[84:87], v[208:211], 0
    ds_read_b64_tr_b16 v[102:103], v3 offset:1536
    s_waitcnt lgkmcnt(6)
    v_mfma_f32_16x16x32_bf16 v[28:31], v[88:91], v[204:207], 0
    s_mov_b32 s23, 0x8800
    buffer_load_dwordx4 v[224:227], v4, s[8:11], s23 offen offset:0 sc1
    ds_read_b64_tr_b16 v[104:105], v15 offset:544
    v_mfma_f32_16x16x32_bf16 v[32:35], v[88:91], v[208:211], 0
    ds_read_b64_tr_b16 v[106:107], v15 offset:1568
    s_mov_b32 s23, 0x1000
    buffer_load_dwordx4 v[140:143], v4, s[8:11], s23 offen offset:0 sc1
    s_waitcnt lgkmcnt(6)
    v_mfma_f32_16x16x32_bf16 v[36:39], v[92:95], v[204:207], 0
    s_mov_b32 s23, 0x800
    buffer_load_dwordx4 v[228:231], v4, s[8:11], s23 offen offset:1024 sc1
    ds_read_b64_tr_b16 v[84:85], v3 offset:768
    v_mfma_f32_16x16x32_bf16 v[40:43], v[92:95], v[208:211], 0
    ds_read_b64_tr_b16 v[86:87], v3 offset:1792
    s_waitcnt lgkmcnt(6)
    v_mfma_f32_16x16x32_bf16 v[44:47], v[96:99], v[204:207], 0
    s_mov_b32 s23, 0x8800
    buffer_load_dwordx4 v[232:235], v4, s[8:11], s23 offen offset:1024 sc1
    ds_read_b64_tr_b16 v[88:89], v15 offset:800
    v_mfma_f32_16x16x32_bf16 v[48:51], v[96:99], v[208:211], 0
    ds_read_b64_tr_b16 v[90:91], v15 offset:1824
    s_waitcnt lgkmcnt(6)
    v_mfma_f32_16x16x32_bf16 v[52:55], v[100:103], v[204:207], 0
    ds_read_b64_tr_b16 v[92:93], v3 offset:8192
    v_mfma_f32_16x16x32_bf16 v[56:59], v[100:103], v[208:211], 0
    ds_read_b64_tr_b16 v[94:95], v3 offset:9216
    s_waitcnt lgkmcnt(6)
    v_mfma_f32_16x16x32_bf16 v[60:63], v[104:107], v[204:207], 0
    ds_read_b64_tr_b16 v[96:97], v15 offset:8224
    v_mfma_f32_16x16x32_bf16 v[64:67], v[104:107], v[208:211], 0
    ds_read_b64_tr_b16 v[98:99], v15 offset:9248
    s_mov_b32 s23, 0x9000
    buffer_load_dwordx4 v[144:147], v4, s[8:11], s23 offen offset:0 sc1
    s_waitcnt lgkmcnt(6)
    v_mfma_f32_16x16x32_bf16 v[68:71], v[84:87], v[204:207], 0
    ds_read_b64_tr_b16 v[100:101], v3 offset:8448
    v_mfma_f32_16x16x32_bf16 v[72:75], v[84:87], v[208:211], 0
    ds_read_b64_tr_b16 v[102:103], v3 offset:9472
    s_waitcnt lgkmcnt(6)
    v_mfma_f32_16x16x32_bf16 v[76:79], v[88:91], v[204:207], 0
    ds_read_b64_tr_b16 v[104:105], v15 offset:8480
    v_mfma_f32_16x16x32_bf16 v[80:83], v[88:91], v[208:211], 0
    ds_read_b64_tr_b16 v[106:107], v15 offset:9504
    s_waitcnt vmcnt(7) lgkmcnt(6)
    v_mfma_f32_16x16x32_bf16 v[20:23], v[92:95], v[212:215], v[20:23]
    ds_read_b64_tr_b16 v[84:85], v3 offset:8704
    s_waitcnt vmcnt(6)
    v_mfma_f32_16x16x32_bf16 v[24:27], v[92:95], v[216:219], v[24:27]
    ds_read_b64_tr_b16 v[86:87], v3 offset:9728
    s_waitcnt lgkmcnt(6)
    v_mfma_f32_16x16x32_bf16 v[28:31], v[96:99], v[212:215], v[28:31]
    ds_read_b64_tr_b16 v[88:89], v15 offset:8736
    v_mfma_f32_16x16x32_bf16 v[32:35], v[96:99], v[216:219], v[32:35]
    ds_read_b64_tr_b16 v[90:91], v15 offset:9760
    s_mov_b32 s23, 0x1000
    buffer_load_dwordx4 v[148:151], v4, s[8:11], s23 offen offset:1024 sc1
    s_waitcnt lgkmcnt(6)
    v_mfma_f32_16x16x32_bf16 v[36:39], v[100:103], v[212:215], v[36:39]
    ds_read_b64_tr_b16 v[92:93], v3 offset:8960
    v_mfma_f32_16x16x32_bf16 v[40:43], v[100:103], v[216:219], v[40:43]
    ds_read_b64_tr_b16 v[94:95], v3 offset:9984
    s_waitcnt lgkmcnt(6)
    v_mfma_f32_16x16x32_bf16 v[44:47], v[104:107], v[212:215], v[44:47]
    ds_read_b64_tr_b16 v[96:97], v15 offset:8992
    v_mfma_f32_16x16x32_bf16 v[48:51], v[104:107], v[216:219], v[48:51]
    ds_read_b64_tr_b16 v[98:99], v15 offset:10016
    s_waitcnt lgkmcnt(6)
    v_mfma_f32_16x16x32_bf16 v[52:55], v[84:87], v[212:215], v[52:55]
    v_mfma_f32_16x16x32_bf16 v[56:59], v[84:87], v[216:219], v[56:59]
    s_barrier
    ds_read_b64_tr_b16 v[100:101], v3 offset:16384
    ds_read_b64_tr_b16 v[102:103], v3 offset:17408
    s_waitcnt lgkmcnt(6)
    v_mfma_f32_16x16x32_bf16 v[60:63], v[88:91], v[212:215], v[60:63]
    ds_read_b64_tr_b16 v[104:105], v15 offset:16416
    v_mfma_f32_16x16x32_bf16 v[64:67], v[88:91], v[216:219], v[64:67]
    s_add_u32 s22, s16, 0x180000
    s_add_u32 m0, s17, 0xc000
    s_nop 0
    buffer_load_dwordx4 v2, s[4:7], s22 offen lds
    ds_read_b64_tr_b16 v[106:107], v15 offset:17440
    s_mov_b32 s23, 0x9000
    buffer_load_dwordx4 v[152:155], v4, s[8:11], s23 offen offset:1024 sc1
    s_waitcnt lgkmcnt(6)
    v_mfma_f32_16x16x32_bf16 v[68:71], v[92:95], v[212:215], v[68:71]
    ds_read_b64_tr_b16 v[84:85], v3 offset:16640
    v_mfma_f32_16x16x32_bf16 v[72:75], v[92:95], v[216:219], v[72:75]
    ds_read_b64_tr_b16 v[86:87], v3 offset:17664
    s_waitcnt lgkmcnt(6)
    v_mfma_f32_16x16x32_bf16 v[76:79], v[96:99], v[212:215], v[76:79]
    ds_read_b64_tr_b16 v[88:89], v15 offset:16672
    v_mfma_f32_16x16x32_bf16 v[80:83], v[96:99], v[216:219], v[80:83]
    s_add_u32 s22, s16, 0x188000
    s_add_u32 m0, s17, 0xc400
    s_nop 0
    buffer_load_dwordx4 v2, s[4:7], s22 offen lds
    ds_read_b64_tr_b16 v[90:91], v15 offset:17696
    s_waitcnt vmcnt(9) lgkmcnt(6)
    v_mfma_f32_16x16x32_bf16 v[20:23], v[100:103], v[220:223], v[20:23]
    ds_read_b64_tr_b16 v[92:93], v3 offset:16896
    s_waitcnt vmcnt(8)
    v_mfma_f32_16x16x32_bf16 v[24:27], v[100:103], v[224:227], v[24:27]
    ds_read_b64_tr_b16 v[94:95], v3 offset:17920
    s_waitcnt lgkmcnt(6)
    v_mfma_f32_16x16x32_bf16 v[28:31], v[104:107], v[220:223], v[28:31]
    ds_read_b64_tr_b16 v[96:97], v15 offset:16928
    v_mfma_f32_16x16x32_bf16 v[32:35], v[104:107], v[224:227], v[32:35]
    s_add_u32 s22, s16, 0x190000
    s_add_u32 m0, s17, 0xc800
    s_nop 0
    buffer_load_dwordx4 v16, s[4:7], s22 offen lds
    ds_read_b64_tr_b16 v[98:99], v15 offset:17952
    s_mov_b32 s23, 0x1800
    buffer_load_dwordx4 v[204:207], v4, s[8:11], s23 offen offset:0 sc1
    s_waitcnt lgkmcnt(6)
    v_mfma_f32_16x16x32_bf16 v[36:39], v[84:87], v[220:223], v[36:39]
    ds_read_b64_tr_b16 v[100:101], v3 offset:17152
    v_mfma_f32_16x16x32_bf16 v[40:43], v[84:87], v[224:227], v[40:43]
    ds_read_b64_tr_b16 v[102:103], v3 offset:18176
    s_waitcnt lgkmcnt(6)
    v_mfma_f32_16x16x32_bf16 v[44:47], v[88:91], v[220:223], v[44:47]
    ds_read_b64_tr_b16 v[104:105], v15 offset:17184
    v_mfma_f32_16x16x32_bf16 v[48:51], v[88:91], v[224:227], v[48:51]
    s_add_u32 s22, s16, 0x198000
    s_add_u32 m0, s17, 0xcc00
    s_nop 0
    buffer_load_dwordx4 v16, s[4:7], s22 offen lds
    ds_read_b64_tr_b16 v[106:107], v15 offset:18208
    s_waitcnt lgkmcnt(6)
    v_mfma_f32_16x16x32_bf16 v[52:55], v[92:95], v[220:223], v[52:55]
    ds_read_b64_tr_b16 v[84:85], v3 offset:24576
    v_mfma_f32_16x16x32_bf16 v[56:59], v[92:95], v[224:227], v[56:59]
    ds_read_b64_tr_b16 v[86:87], v3 offset:25600
    s_waitcnt lgkmcnt(6)
    v_mfma_f32_16x16x32_bf16 v[60:63], v[96:99], v[220:223], v[60:63]
    ds_read_b64_tr_b16 v[88:89], v15 offset:24608
    v_mfma_f32_16x16x32_bf16 v[64:67], v[96:99], v[224:227], v[64:67]
    ds_read_b64_tr_b16 v[90:91], v15 offset:25632
    s_mov_b32 s23, 0x9800
    buffer_load_dwordx4 v[208:211], v4, s[8:11], s23 offen offset:0 sc1
    s_waitcnt lgkmcnt(6)
    v_mfma_f32_16x16x32_bf16 v[68:71], v[100:103], v[220:223], v[68:71]
    ds_read_b64_tr_b16 v[92:93], v3 offset:24832
    v_mfma_f32_16x16x32_bf16 v[72:75], v[100:103], v[224:227], v[72:75]
    ds_read_b64_tr_b16 v[94:95], v3 offset:25856
    s_waitcnt lgkmcnt(6)
    v_mfma_f32_16x16x32_bf16 v[76:79], v[104:107], v[220:223], v[76:79]
    ds_read_b64_tr_b16 v[96:97], v15 offset:24864
    v_mfma_f32_16x16x32_bf16 v[80:83], v[104:107], v[224:227], v[80:83]
    ds_read_b64_tr_b16 v[98:99], v15 offset:25888
    s_waitcnt vmcnt(10) lgkmcnt(6)
    v_mfma_f32_16x16x32_bf16 v[20:23], v[84:87], v[228:231], v[20:23]
    ds_read_b64_tr_b16 v[100:101], v3 offset:25088
    s_waitcnt vmcnt(9)
    v_mfma_f32_16x16x32_bf16 v[24:27], v[84:87], v[232:235], v[24:27]
    ds_read_b64_tr_b16 v[102:103], v3 offset:26112
    s_waitcnt lgkmcnt(6)
    v_mfma_f32_16x16x32_bf16 v[28:31], v[88:91], v[228:231], v[28:31]
    ds_read_b64_tr_b16 v[104:105], v15 offset:25120
    v_mfma_f32_16x16x32_bf16 v[32:35], v[88:91], v[232:235], v[32:35]
    ds_read_b64_tr_b16 v[106:107], v15 offset:26144
    s_mov_b32 s23, 0x1800
    buffer_load_dwordx4 v[212:215], v4, s[8:11], s23 offen offset:1024 sc1
    s_waitcnt lgkmcnt(6)
    v_mfma_f32_16x16x32_bf16 v[36:39], v[92:95], v[228:231], v[36:39]
    ds_read_b64_tr_b16 v[84:85], v3 offset:25344
    v_mfma_f32_16x16x32_bf16 v[40:43], v[92:95], v[232:235], v[40:43]
    ds_read_b64_tr_b16 v[86:87], v3 offset:26368
    s_waitcnt lgkmcnt(6)
    v_mfma_f32_16x16x32_bf16 v[44:47], v[96:99], v[228:231], v[44:47]
    ds_read_b64_tr_b16 v[88:89], v15 offset:25376
    v_mfma_f32_16x16x32_bf16 v[48:51], v[96:99], v[232:235], v[48:51]
    ds_read_b64_tr_b16 v[90:91], v15 offset:26400
    s_waitcnt lgkmcnt(6)
    v_mfma_f32_16x16x32_bf16 v[52:55], v[100:103], v[228:231], v[52:55]
    v_mfma_f32_16x16x32_bf16 v[56:59], v[100:103], v[232:235], v[56:59]
    s_barrier
    ds_read_b64_tr_b16 v[92:93], v3 offset:32768
    ds_read_b64_tr_b16 v[94:95], v3 offset:33792
    s_waitcnt lgkmcnt(6)
    v_mfma_f32_16x16x32_bf16 v[60:63], v[104:107], v[228:231], v[60:63]
    ds_read_b64_tr_b16 v[96:97], v15 offset:32800
    v_mfma_f32_16x16x32_bf16 v[64:67], v[104:107], v[232:235], v[64:67]
    s_add_u32 s22, s16, 0x200000
    s_add_u32 m0, s17, 0x0
    s_nop 0
    buffer_load_dwordx4 v2, s[4:7], s22 offen lds
    ds_read_b64_tr_b16 v[98:99], v15 offset:33824
    s_mov_b32 s23, 0x9800
    buffer_load_dwordx4 v[216:219], v4, s[8:11], s23 offen offset:1024 sc1
    s_waitcnt lgkmcnt(6)
    v_mfma_f32_16x16x32_bf16 v[68:71], v[84:87], v[228:231], v[68:71]
    ds_read_b64_tr_b16 v[100:101], v3 offset:33024
    v_mfma_f32_16x16x32_bf16 v[72:75], v[84:87], v[232:235], v[72:75]
    ds_read_b64_tr_b16 v[102:103], v3 offset:34048
    s_waitcnt lgkmcnt(6)
    v_mfma_f32_16x16x32_bf16 v[76:79], v[88:91], v[228:231], v[76:79]
    ds_read_b64_tr_b16 v[104:105], v15 offset:33056
    v_mfma_f32_16x16x32_bf16 v[80:83], v[88:91], v[232:235], v[80:83]
    s_add_u32 s22, s16, 0x208000
    s_add_u32 m0, s17, 0x400
    s_nop 0
    buffer_load_dwordx4 v2, s[4:7], s22 offen lds
    ds_read_b64_tr_b16 v[106:107], v15 offset:34080
    s_waitcnt lgkmcnt(6)
    v_mfma_f32_16x16x32_bf16 v[20:23], v[92:95], v[140:143], v[20:23]
    ds_read_b64_tr_b16 v[84:85], v3 offset:33280
    s_waitcnt vmcnt(12)
    v_mfma_f32_16x16x32_bf16 v[24:27], v[92:95], v[144:147], v[24:27]
    ds_read_b64_tr_b16 v[86:87], v3 offset:34304
    s_waitcnt lgkmcnt(6)
    v_mfma_f32_16x16x32_bf16 v[28:31], v[96:99], v[140:143], v[28:31]
    ds_read_b64_tr_b16 v[88:89], v15 offset:33312
    v_mfma_f32_16x16x32_bf16 v[32:35], v[96:99], v[144:147], v[32:35]
    s_add_u32 s22, s16, 0x210000
    s_add_u32 m0, s17, 0x800
    s_nop 0
    buffer_load_dwordx4 v16, s[4:7], s22 offen lds
    ds_read_b64_tr_b16 v[90:91], v15 offset:34336
    s_mov_b32 s23, 0x2000
    buffer_load_dwordx4 v[220:223], v4, s[8:11], s23 offen offset:0 sc1
    s_waitcnt lgkmcnt(6)
    v_mfma_f32_16x16x32_bf16 v[36:39], v[100:103], v[140:143], v[36:39]
    ds_read_b64_tr_b16 v[92:93], v3 offset:33536
    v_mfma_f32_16x16x32_bf16 v[40:43], v[100:103], v[144:147], v[40:43]
    ds_read_b64_tr_b16 v[94:95], v3 offset:34560
    s_waitcnt lgkmcnt(6)
    v_mfma_f32_16x16x32_bf16 v[44:47], v[104:107], v[140:143], v[44:47]
    ds_read_b64_tr_b16 v[96:97], v15 offset:33568
    v_mfma_f32_16x16x32_bf16 v[48:51], v[104:107], v[144:147], v[48:51]
    s_add_u32 s22, s16, 0x218000
    s_add_u32 m0, s17, 0xc00
    s_nop 0
    buffer_load_dwordx4 v16, s[4:7], s22 offen lds
    ds_read_b64_tr_b16 v[98:99], v15 offset:34592
    s_waitcnt lgkmcnt(6)
    v_mfma_f32_16x16x32_bf16 v[52:55], v[84:87], v[140:143], v[52:55]
    ds_read_b64_tr_b16 v[100:101], v3 offset:40960
    v_mfma_f32_16x16x32_bf16 v[56:59], v[84:87], v[144:147], v[56:59]
    ds_read_b64_tr_b16 v[102:103], v3 offset:41984
    s_waitcnt lgkmcnt(6)
    v_mfma_f32_16x16x32_bf16 v[60:63], v[88:91], v[140:143], v[60:63]
    ds_read_b64_tr_b16 v[104:105], v15 offset:40992
    v_mfma_f32_16x16x32_bf16 v[64:67], v[88:91], v[144:147], v[64:67]
    ds_read_b64_tr_b16 v[106:107], v15 offset:42016
    s_mov_b32 s23, 0xa000
    buffer_load_dwordx4 v[224:227], v4, s[8:11], s23 offen offset:0 sc1
    s_waitcnt lgkmcnt(6)
    v_mfma_f32_16x16x32_bf16 v[68:71], v[92:95], v[140:143], v[68:71]
    ds_read_b64_tr_b16 v[84:85], v3 offset:41216
    v_mfma_f32_16x16x32_bf16 v[72:75], v[92:95], v[144:147], v[72:75]
    ds_read_b64_tr_b16 v[86:87], v3 offset:42240
    s_waitcnt lgkmcnt(6)
    v_mfma_f32_16x16x32_bf16 v[76:79], v[96:99], v[140:143], v[76:79]
    ds_read_b64_tr_b16 v[88:89], v15 offset:41248
    v_mfma_f32_16x16x32_bf16 v[80:83], v[96:99], v[144:147], v[80:83]
    ds_read_b64_tr_b16 v[90:91], v15 offset:42272
    s_waitcnt vmcnt(15) lgkmcnt(6)
    v_mfma_f32_16x16x32_bf16 v[20:23], v[100:103], v[148:151], v[20:23]
    ds_read_b64_tr_b16 v[92:93], v3 offset:41472
    s_waitcnt vmcnt(13)
    v_mfma_f32_16x16x32_bf16 v[24:27], v[100:103], v[152:155], v[24:27]
    ds_read_b64_tr_b16 v[94:95], v3 offset:42496
    s_waitcnt lgkmcnt(6)
    v_mfma_f32_16x16x32_bf16 v[28:31], v[104:107], v[148:151], v[28:31]
    ds_read_b64_tr_b16 v[96:97], v15 offset:41504
    v_mfma_f32_16x16x32_bf16 v[32:35], v[104:107], v[152:155], v[32:35]
    ds_read_b64_tr_b16 v[98:99], v15 offset:42528
    s_mov_b32 s23, 0x2000
    buffer_load_dwordx4 v[228:231], v4, s[8:11], s23 offen offset:1024 sc1
    s_waitcnt lgkmcnt(6)
    v_mfma_f32_16x16x32_bf16 v[36:39], v[84:87], v[148:151], v[36:39]
    ds_read_b64_tr_b16 v[100:101], v3 offset:41728
    v_mfma_f32_16x16x32_bf16 v[40:43], v[84:87], v[152:155], v[40:43]
    ds_read_b64_tr_b16 v[102:103], v3 offset:42752
    s_waitcnt lgkmcnt(6)
    v_mfma_f32_16x16x32_bf16 v[44:47], v[88:91], v[148:151], v[44:47]
    ds_read_b64_tr_b16 v[104:105], v15 offset:41760
    v_mfma_f32_16x16x32_bf16 v[48:51], v[88:91], v[152:155], v[48:51]
    ds_read_b64_tr_b16 v[106:107], v15 offset:42784
    s_waitcnt lgkmcnt(6)
    v_mfma_f32_16x16x32_bf16 v[52:55], v[92:95], v[148:151], v[52:55]
    v_mfma_f32_16x16x32_bf16 v[56:59], v[92:95], v[152:155], v[56:59]
    s_waitcnt vmcnt(10)
    s_barrier
    ds_read_b64_tr_b16 v[84:85], v3 offset:49152
    ds_read_b64_tr_b16 v[86:87], v3 offset:50176
    s_waitcnt lgkmcnt(6)
    v_mfma_f32_16x16x32_bf16 v[60:63], v[96:99], v[148:151], v[60:63]
    ds_read_b64_tr_b16 v[88:89], v15 offset:49184
    v_mfma_f32_16x16x32_bf16 v[64:67], v[96:99], v[152:155], v[64:67]
    s_add_u32 s22, s16, 0x280000
    s_add_u32 m0, s17, 0x4000
    s_nop 0
    buffer_load_dwordx4 v2, s[4:7], s22 offen lds
    ds_read_b64_tr_b16 v[90:91], v15 offset:50208
    s_mov_b32 s23, 0xa000
    buffer_load_dwordx4 v[232:235], v4, s[8:11], s23 offen offset:1024 sc1
    s_waitcnt lgkmcnt(6)
    v_mfma_f32_16x16x32_bf16 v[68:71], v[100:103], v[148:151], v[68:71]
    ds_read_b64_tr_b16 v[92:93], v3 offset:49408
    v_mfma_f32_16x16x32_bf16 v[72:75], v[100:103], v[152:155], v[72:75]
    ds_read_b64_tr_b16 v[94:95], v3 offset:50432
    s_waitcnt lgkmcnt(6)
    v_mfma_f32_16x16x32_bf16 v[76:79], v[104:107], v[148:151], v[76:79]
    ds_read_b64_tr_b16 v[96:97], v15 offset:49440
    v_mfma_f32_16x16x32_bf16 v[80:83], v[104:107], v[152:155], v[80:83]
    s_add_u32 s22, s16, 0x288000
    s_add_u32 m0, s17, 0x4400
    s_nop 0
    buffer_load_dwordx4 v2, s[4:7], s22 offen lds
    ds_read_b64_tr_b16 v[98:99], v15 offset:50464
    s_waitcnt lgkmcnt(6)
    v_mfma_f32_16x16x32_bf16 v[20:23], v[84:87], v[204:207], v[20:23]
    ds_read_b64_tr_b16 v[100:101], v3 offset:49664
    s_waitcnt vmcnt(12)
    v_mfma_f32_16x16x32_bf16 v[24:27], v[84:87], v[208:211], v[24:27]
    ds_read_b64_tr_b16 v[102:103], v3 offset:50688
    s_waitcnt lgkmcnt(6)
    v_mfma_f32_16x16x32_bf16 v[28:31], v[88:91], v[204:207], v[28:31]
    ds_read_b64_tr_b16 v[104:105], v15 offset:49696
    v_mfma_f32_16x16x32_bf16 v[32:35], v[88:91], v[208:211], v[32:35]
    s_add_u32 s22, s16, 0x290000
    s_add_u32 m0, s17, 0x4800
    s_nop 0
    buffer_load_dwordx4 v16, s[4:7], s22 offen lds
    ds_read_b64_tr_b16 v[106:107], v15 offset:50720
    s_mov_b32 s23, 0x2800
    buffer_load_dwordx4 v[140:143], v4, s[8:11], s23 offen offset:0 sc1
    s_waitcnt lgkmcnt(6)
    v_mfma_f32_16x16x32_bf16 v[36:39], v[92:95], v[204:207], v[36:39]
    ds_read_b64_tr_b16 v[84:85], v3 offset:49920
    v_mfma_f32_16x16x32_bf16 v[40:43], v[92:95], v[208:211], v[40:43]
    ds_read_b64_tr_b16 v[86:87], v3 offset:50944
    s_waitcnt lgkmcnt(6)
    v_mfma_f32_16x16x32_bf16 v[44:47], v[96:99], v[204:207], v[44:47]
    ds_read_b64_tr_b16 v[88:89], v15 offset:49952
    v_mfma_f32_16x16x32_bf16 v[48:51], v[96:99], v[208:211], v[48:51]
    s_add_u32 s22, s16, 0x298000
    s_add_u32 m0, s17, 0x4c00
    s_nop 0
    buffer_load_dwordx4 v16, s[4:7], s22 offen lds
    ds_read_b64_tr_b16 v[90:91], v15 offset:50976
    s_waitcnt lgkmcnt(6)
    v_mfma_f32_16x16x32_bf16 v[52:55], v[100:103], v[204:207], v[52:55]
    ds_read_b64_tr_b16 v[92:93], v3 offset:57344
    v_mfma_f32_16x16x32_bf16 v[56:59], v[100:103], v[208:211], v[56:59]
    ds_read_b64_tr_b16 v[94:95], v3 offset:58368
    s_waitcnt lgkmcnt(6)
    v_mfma_f32_16x16x32_bf16 v[60:63], v[104:107], v[204:207], v[60:63]
    ds_read_b64_tr_b16 v[96:97], v15 offset:57376
    v_mfma_f32_16x16x32_bf16 v[64:67], v[104:107], v[208:211], v[64:67]
    ds_read_b64_tr_b16 v[98:99], v15 offset:58400
    s_mov_b32 s23, 0xa800
    buffer_load_dwordx4 v[144:147], v4, s[8:11], s23 offen offset:0 sc1
    s_waitcnt lgkmcnt(6)
    v_mfma_f32_16x16x32_bf16 v[68:71], v[84:87], v[204:207], v[68:71]
    ds_read_b64_tr_b16 v[100:101], v3 offset:57600
    v_mfma_f32_16x16x32_bf16 v[72:75], v[84:87], v[208:211], v[72:75]
    ds_read_b64_tr_b16 v[102:103], v3 offset:58624
    s_waitcnt lgkmcnt(6)
    v_mfma_f32_16x16x32_bf16 v[76:79], v[88:91], v[204:207], v[76:79]
    ds_read_b64_tr_b16 v[104:105], v15 offset:57632
    v_mfma_f32_16x16x32_bf16 v[80:83], v[88:91], v[208:211], v[80:83]
    ds_read_b64_tr_b16 v[106:107], v15 offset:58656
    s_waitcnt vmcnt(15) lgkmcnt(6)
    v_mfma_f32_16x16x32_bf16 v[20:23], v[92:95], v[212:215], v[20:23]
    ds_read_b64_tr_b16 v[84:85], v3 offset:57856
    s_waitcnt vmcnt(13)
    v_mfma_f32_16x16x32_bf16 v[24:27], v[92:95], v[216:219], v[24:27]
    ds_read_b64_tr_b16 v[86:87], v3 offset:58880
    s_waitcnt lgkmcnt(6)
    v_mfma_f32_16x16x32_bf16 v[28:31], v[96:99], v[212:215], v[28:31]
    ds_read_b64_tr_b16 v[88:89], v15 offset:57888
    v_mfma_f32_16x16x32_bf16 v[32:35], v[96:99], v[216:219], v[32:35]
    ds_read_b64_tr_b16 v[90:91], v15 offset:58912
    s_mov_b32 s23, 0x2800
    buffer_load_dwordx4 v[148:151], v4, s[8:11], s23 offen offset:1024 sc1
    s_waitcnt lgkmcnt(6)
    v_mfma_f32_16x16x32_bf16 v[36:39], v[100:103], v[212:215], v[36:39]
    ds_read_b64_tr_b16 v[92:93], v3 offset:58112
    v_mfma_f32_16x16x32_bf16 v[40:43], v[100:103], v[216:219], v[40:43]
    ds_read_b64_tr_b16 v[94:95], v3 offset:59136
    s_waitcnt lgkmcnt(6)
    v_mfma_f32_16x16x32_bf16 v[44:47], v[104:107], v[212:215], v[44:47]
    ds_read_b64_tr_b16 v[96:97], v15 offset:58144
    v_mfma_f32_16x16x32_bf16 v[48:51], v[104:107], v[216:219], v[48:51]
    ds_read_b64_tr_b16 v[98:99], v15 offset:59168
    s_waitcnt lgkmcnt(6)
    v_mfma_f32_16x16x32_bf16 v[52:55], v[84:87], v[212:215], v[52:55]
    v_mfma_f32_16x16x32_bf16 v[56:59], v[84:87], v[216:219], v[56:59]
    s_waitcnt vmcnt(10)
    s_barrier
    ds_read_b64_tr_b16 v[100:101], v3 offset:0
    ds_read_b64_tr_b16 v[102:103], v3 offset:1024
    s_waitcnt lgkmcnt(6)
    v_mfma_f32_16x16x32_bf16 v[60:63], v[88:91], v[212:215], v[60:63]
    ds_read_b64_tr_b16 v[104:105], v15 offset:32
    v_mfma_f32_16x16x32_bf16 v[64:67], v[88:91], v[216:219], v[64:67]
    s_add_u32 s22, s16, 0x300000
    s_add_u32 m0, s17, 0x8000
    s_nop 0
    buffer_load_dwordx4 v2, s[4:7], s22 offen lds
    ds_read_b64_tr_b16 v[106:107], v15 offset:1056
    s_mov_b32 s23, 0xa800
    buffer_load_dwordx4 v[152:155], v4, s[8:11], s23 offen offset:1024 sc1
    s_waitcnt lgkmcnt(6)
    v_mfma_f32_16x16x32_bf16 v[68:71], v[92:95], v[212:215], v[68:71]
    ds_read_b64_tr_b16 v[84:85], v3 offset:256
    v_mfma_f32_16x16x32_bf16 v[72:75], v[92:95], v[216:219], v[72:75]
    ds_read_b64_tr_b16 v[86:87], v3 offset:1280
    s_waitcnt lgkmcnt(6)
    v_mfma_f32_16x16x32_bf16 v[76:79], v[96:99], v[212:215], v[76:79]
    ds_read_b64_tr_b16 v[88:89], v15 offset:288
    v_mfma_f32_16x16x32_bf16 v[80:83], v[96:99], v[216:219], v[80:83]
    s_add_u32 s22, s16, 0x308000
    s_add_u32 m0, s17, 0x8400
    s_nop 0
    buffer_load_dwordx4 v2, s[4:7], s22 offen lds
    ds_read_b64_tr_b16 v[90:91], v15 offset:1312
    s_waitcnt lgkmcnt(6)
    v_mfma_f32_16x16x32_bf16 v[20:23], v[100:103], v[220:223], v[20:23]
    ds_read_b64_tr_b16 v[92:93], v3 offset:512
    s_waitcnt vmcnt(12)
    v_mfma_f32_16x16x32_bf16 v[24:27], v[100:103], v[224:227], v[24:27]
    ds_read_b64_tr_b16 v[94:95], v3 offset:1536
    s_waitcnt lgkmcnt(6)
    v_mfma_f32_16x16x32_bf16 v[28:31], v[104:107], v[220:223], v[28:31]
    ds_read_b64_tr_b16 v[96:97], v15 offset:544
    v_mfma_f32_16x16x32_bf16 v[32:35], v[104:107], v[224:227], v[32:35]
    s_add_u32 s22, s16, 0x310000
    s_add_u32 m0, s17, 0x8800
    s_nop 0
    buffer_load_dwordx4 v16, s[4:7], s22 offen lds
    ds_read_b64_tr_b16 v[98:99], v15 offset:1568
    s_mov_b32 s23, 0x3000
    buffer_load_dwordx4 v[204:207], v4, s[8:11], s23 offen offset:0 sc1
    s_waitcnt lgkmcnt(6)
    v_mfma_f32_16x16x32_bf16 v[36:39], v[84:87], v[220:223], v[36:39]
    ds_read_b64_tr_b16 v[100:101], v3 offset:768
    v_mfma_f32_16x16x32_bf16 v[40:43], v[84:87], v[224:227], v[40:43]
    ds_read_b64_tr_b16 v[102:103], v3 offset:1792
    s_waitcnt lgkmcnt(6)
    v_mfma_f32_16x16x32_bf16 v[44:47], v[88:91], v[220:223], v[44:47]
    ds_read_b64_tr_b16 v[104:105], v15 offset:800
    v_mfma_f32_16x16x32_bf16 v[48:51], v[88:91], v[224:227], v[48:51]
    s_add_u32 s22, s16, 0x318000
    s_add_u32 m0, s17, 0x8c00
    s_nop 0
    buffer_load_dwordx4 v16, s[4:7], s22 offen lds
    ds_read_b64_tr_b16 v[106:107], v15 offset:1824
    s_waitcnt lgkmcnt(6)
    v_mfma_f32_16x16x32_bf16 v[52:55], v[92:95], v[220:223], v[52:55]
    ds_read_b64_tr_b16 v[84:85], v3 offset:8192
    v_mfma_f32_16x16x32_bf16 v[56:59], v[92:95], v[224:227], v[56:59]
    ds_read_b64_tr_b16 v[86:87], v3 offset:9216
    s_waitcnt lgkmcnt(6)
    v_mfma_f32_16x16x32_bf16 v[60:63], v[96:99], v[220:223], v[60:63]
    ds_read_b64_tr_b16 v[88:89], v15 offset:8224
    v_mfma_f32_16x16x32_bf16 v[64:67], v[96:99], v[224:227], v[64:67]
    ds_read_b64_tr_b16 v[90:91], v15 offset:9248
    s_mov_b32 s23, 0xb000
    buffer_load_dwordx4 v[208:211], v4, s[8:11], s23 offen offset:0 sc1
    s_waitcnt lgkmcnt(6)
    v_mfma_f32_16x16x32_bf16 v[68:71], v[100:103], v[220:223], v[68:71]
    ds_read_b64_tr_b16 v[92:93], v3 offset:8448
    v_mfma_f32_16x16x32_bf16 v[72:75], v[100:103], v[224:227], v[72:75]
    ds_read_b64_tr_b16 v[94:95], v3 offset:9472
    s_waitcnt lgkmcnt(6)
    v_mfma_f32_16x16x32_bf16 v[76:79], v[104:107], v[220:223], v[76:79]
    ds_read_b64_tr_b16 v[96:97], v15 offset:8480
    v_mfma_f32_16x16x32_bf16 v[80:83], v[104:107], v[224:227], v[80:83]
    ds_read_b64_tr_b16 v[98:99], v15 offset:9504
    s_waitcnt vmcnt(15) lgkmcnt(6)
    v_mfma_f32_16x16x32_bf16 v[20:23], v[84:87], v[228:231], v[20:23]
    ds_read_b64_tr_b16 v[100:101], v3 offset:8704
    s_waitcnt vmcnt(13)
    v_mfma_f32_16x16x32_bf16 v[24:27], v[84:87], v[232:235], v[24:27]
    ds_read_b64_tr_b16 v[102:103], v3 offset:9728
    s_waitcnt lgkmcnt(6)
    v_mfma_f32_16x16x32_bf16 v[28:31], v[88:91], v[228:231], v[28:31]
    ds_read_b64_tr_b16 v[104:105], v15 offset:8736
    v_mfma_f32_16x16x32_bf16 v[32:35], v[88:91], v[232:235], v[32:35]
    ds_read_b64_tr_b16 v[106:107], v15 offset:9760
    s_mov_b32 s23, 0x3000
    buffer_load_dwordx4 v[212:215], v4, s[8:11], s23 offen offset:1024 sc1
    s_waitcnt lgkmcnt(6)
    v_mfma_f32_16x16x32_bf16 v[36:39], v[92:95], v[228:231], v[36:39]
    ds_read_b64_tr_b16 v[84:85], v3 offset:8960
    v_mfma_f32_16x16x32_bf16 v[40:43], v[92:95], v[232:235], v[40:43]
    ds_read_b64_tr_b16 v[86:87], v3 offset:9984
    s_waitcnt lgkmcnt(6)
    v_mfma_f32_16x16x32_bf16 v[44:47], v[96:99], v[228:231], v[44:47]
    ds_read_b64_tr_b16 v[88:89], v15 offset:8992
    v_mfma_f32_16x16x32_bf16 v[48:51], v[96:99], v[232:235], v[48:51]
    ds_read_b64_tr_b16 v[90:91], v15 offset:10016
    s_waitcnt lgkmcnt(6)
    v_mfma_f32_16x16x32_bf16 v[52:55], v[100:103], v[228:231], v[52:55]
    v_mfma_f32_16x16x32_bf16 v[56:59], v[100:103], v[232:235], v[56:59]
    s_waitcnt vmcnt(10)
    s_barrier
    ds_read_b64_tr_b16 v[92:93], v3 offset:16384
    ds_read_b64_tr_b16 v[94:95], v3 offset:17408
    s_waitcnt lgkmcnt(6)
    v_mfma_f32_16x16x32_bf16 v[60:63], v[104:107], v[228:231], v[60:63]
    ds_read_b64_tr_b16 v[96:97], v15 offset:16416
    v_mfma_f32_16x16x32_bf16 v[64:67], v[104:107], v[232:235], v[64:67]
    s_add_u32 s22, s16, 0x380000
    s_add_u32 m0, s17, 0xc000
    s_nop 0
    buffer_load_dwordx4 v2, s[4:7], s22 offen lds
    ds_read_b64_tr_b16 v[98:99], v15 offset:17440
    s_mov_b32 s23, 0xb000
    buffer_load_dwordx4 v[216:219], v4, s[8:11], s23 offen offset:1024 sc1
    s_waitcnt lgkmcnt(6)
    v_mfma_f32_16x16x32_bf16 v[68:71], v[84:87], v[228:231], v[68:71]
    ds_read_b64_tr_b16 v[100:101], v3 offset:16640
    v_mfma_f32_16x16x32_bf16 v[72:75], v[84:87], v[232:235], v[72:75]
    ds_read_b64_tr_b16 v[102:103], v3 offset:17664
    s_waitcnt lgkmcnt(6)
    v_mfma_f32_16x16x32_bf16 v[76:79], v[88:91], v[228:231], v[76:79]
    ds_read_b64_tr_b16 v[104:105], v15 offset:16672
    v_mfma_f32_16x16x32_bf16 v[80:83], v[88:91], v[232:235], v[80:83]
    s_add_u32 s22, s16, 0x388000
    s_add_u32 m0, s17, 0xc400
    s_nop 0
    buffer_load_dwordx4 v2, s[4:7], s22 offen lds
    ds_read_b64_tr_b16 v[106:107], v15 offset:17696
    s_waitcnt lgkmcnt(6)
    v_mfma_f32_16x16x32_bf16 v[20:23], v[92:95], v[140:143], v[20:23]
    ds_read_b64_tr_b16 v[84:85], v3 offset:16896
    s_waitcnt vmcnt(12)
    v_mfma_f32_16x16x32_bf16 v[24:27], v[92:95], v[144:147], v[24:27]
    ds_read_b64_tr_b16 v[86:87], v3 offset:17920
    s_waitcnt lgkmcnt(6)
    v_mfma_f32_16x16x32_bf16 v[28:31], v[96:99], v[140:143], v[28:31]
    ds_read_b64_tr_b16 v[88:89], v15 offset:16928
    v_mfma_f32_16x16x32_bf16 v[32:35], v[96:99], v[144:147], v[32:35]
    s_add_u32 s22, s16, 0x390000
    s_add_u32 m0, s17, 0xc800
    s_nop 0
    buffer_load_dwordx4 v16, s[4:7], s22 offen lds
    ds_read_b64_tr_b16 v[90:91], v15 offset:17952
    s_mov_b32 s23, 0x3800
    buffer_load_dwordx4 v[220:223], v4, s[8:11], s23 offen offset:0 sc1
    s_waitcnt lgkmcnt(6)
    v_mfma_f32_16x16x32_bf16 v[36:39], v[100:103], v[140:143], v[36:39]
    ds_read_b64_tr_b16 v[92:93], v3 offset:17152
    v_mfma_f32_16x16x32_bf16 v[40:43], v[100:103], v[144:147], v[40:43]
    ds_read_b64_tr_b16 v[94:95], v3 offset:18176
    s_waitcnt lgkmcnt(6)
    v_mfma_f32_16x16x32_bf16 v[44:47], v[104:107], v[140:143], v[44:47]
    ds_read_b64_tr_b16 v[96:97], v15 offset:17184
    v_mfma_f32_16x16x32_bf16 v[48:51], v[104:107], v[144:147], v[48:51]
    s_add_u32 s22, s16, 0x398000
    s_add_u32 m0, s17, 0xcc00
    s_nop 0
    buffer_load_dwordx4 v16, s[4:7], s22 offen lds
    ds_read_b64_tr_b16 v[98:99], v15 offset:18208
    s_waitcnt lgkmcnt(6)
    v_mfma_f32_16x16x32_bf16 v[52:55], v[84:87], v[140:143], v[52:55]
    ds_read_b64_tr_b16 v[100:101], v3 offset:24576
    v_mfma_f32_16x16x32_bf16 v[56:59], v[84:87], v[144:147], v[56:59]
    ds_read_b64_tr_b16 v[102:103], v3 offset:25600
    s_waitcnt lgkmcnt(6)
    v_mfma_f32_16x16x32_bf16 v[60:63], v[88:91], v[140:143], v[60:63]
    ds_read_b64_tr_b16 v[104:105], v15 offset:24608
    v_mfma_f32_16x16x32_bf16 v[64:67], v[88:91], v[144:147], v[64:67]
    ds_read_b64_tr_b16 v[106:107], v15 offset:25632
    s_mov_b32 s23, 0xb800
    buffer_load_dwordx4 v[224:227], v4, s[8:11], s23 offen offset:0 sc1
    s_waitcnt lgkmcnt(6)
    v_mfma_f32_16x16x32_bf16 v[68:71], v[92:95], v[140:143], v[68:71]
    ds_read_b64_tr_b16 v[84:85], v3 offset:24832
    v_mfma_f32_16x16x32_bf16 v[72:75], v[92:95], v[144:147], v[72:75]
    ds_read_b64_tr_b16 v[86:87], v3 offset:25856
    s_waitcnt lgkmcnt(6)
    v_mfma_f32_16x16x32_bf16 v[76:79], v[96:99], v[140:143], v[76:79]
    ds_read_b64_tr_b16 v[88:89], v15 offset:24864
    v_mfma_f32_16x16x32_bf16 v[80:83], v[96:99], v[144:147], v[80:83]
    ds_read_b64_tr_b16 v[90:91], v15 offset:25888
    s_waitcnt vmcnt(15) lgkmcnt(6)
    v_mfma_f32_16x16x32_bf16 v[20:23], v[100:103], v[148:151], v[20:23]
    ds_read_b64_tr_b16 v[92:93], v3 offset:25088
    s_waitcnt vmcnt(13)
    v_mfma_f32_16x16x32_bf16 v[24:27], v[100:103], v[152:155], v[24:27]
    ds_read_b64_tr_b16 v[94:95], v3 offset:26112
    s_waitcnt lgkmcnt(6)
    v_mfma_f32_16x16x32_bf16 v[28:31], v[104:107], v[148:151], v[28:31]
    ds_read_b64_tr_b16 v[96:97], v15 offset:25120
    v_mfma_f32_16x16x32_bf16 v[32:35], v[104:107], v[152:155], v[32:35]
    ds_read_b64_tr_b16 v[98:99], v15 offset:26144
    s_mov_b32 s23, 0x3800
    buffer_load_dwordx4 v[228:231], v4, s[8:11], s23 offen offset:1024 sc1
    s_waitcnt lgkmcnt(6)
    v_mfma_f32_16x16x32_bf16 v[36:39], v[84:87], v[148:151], v[36:39]
    ds_read_b64_tr_b16 v[100:101], v3 offset:25344
    v_mfma_f32_16x16x32_bf16 v[40:43], v[84:87], v[152:155], v[40:43]
    ds_read_b64_tr_b16 v[102:103], v3 offset:26368
    s_waitcnt lgkmcnt(6)
    v_mfma_f32_16x16x32_bf16 v[44:47], v[88:91], v[148:151], v[44:47]
    ds_read_b64_tr_b16 v[104:105], v15 offset:25376
    v_mfma_f32_16x16x32_bf16 v[48:51], v[88:91], v[152:155], v[48:51]
    ds_read_b64_tr_b16 v[106:107], v15 offset:26400
    s_waitcnt lgkmcnt(6)
    v_mfma_f32_16x16x32_bf16 v[52:55], v[92:95], v[148:151], v[52:55]
    v_mfma_f32_16x16x32_bf16 v[56:59], v[92:95], v[152:155], v[56:59]
    s_waitcnt vmcnt(10)
    s_barrier
    ds_read_b64_tr_b16 v[84:85], v3 offset:32768
    ds_read_b64_tr_b16 v[86:87], v3 offset:33792
    s_waitcnt lgkmcnt(6)
    v_mfma_f32_16x16x32_bf16 v[60:63], v[96:99], v[148:151], v[60:63]
    ds_read_b64_tr_b16 v[88:89], v15 offset:32800
    v_mfma_f32_16x16x32_bf16 v[64:67], v[96:99], v[152:155], v[64:67]
    s_add_u32 s22, s16, 0x400000
    s_add_u32 m0, s17, 0x0
    s_nop 0
    buffer_load_dwordx4 v2, s[4:7], s22 offen lds
    ds_read_b64_tr_b16 v[90:91], v15 offset:33824
    s_mov_b32 s23, 0xb800
    buffer_load_dwordx4 v[232:235], v4, s[8:11], s23 offen offset:1024 sc1
    s_waitcnt lgkmcnt(6)
    v_mfma_f32_16x16x32_bf16 v[68:71], v[100:103], v[148:151], v[68:71]
    ds_read_b64_tr_b16 v[92:93], v3 offset:33024
    v_mfma_f32_16x16x32_bf16 v[72:75], v[100:103], v[152:155], v[72:75]
    ds_read_b64_tr_b16 v[94:95], v3 offset:34048
    s_waitcnt lgkmcnt(6)
    v_mfma_f32_16x16x32_bf16 v[76:79], v[104:107], v[148:151], v[76:79]
    ds_read_b64_tr_b16 v[96:97], v15 offset:33056
    v_mfma_f32_16x16x32_bf16 v[80:83], v[104:107], v[152:155], v[80:83]
    s_add_u32 s22, s16, 0x408000
    s_add_u32 m0, s17, 0x400
    s_nop 0
    buffer_load_dwordx4 v2, s[4:7], s22 offen lds
    ds_read_b64_tr_b16 v[98:99], v15 offset:34080
    s_waitcnt lgkmcnt(6)
    v_mfma_f32_16x16x32_bf16 v[20:23], v[84:87], v[204:207], v[20:23]
    ds_read_b64_tr_b16 v[100:101], v3 offset:33280
    s_waitcnt vmcnt(12)
    v_mfma_f32_16x16x32_bf16 v[24:27], v[84:87], v[208:211], v[24:27]
    ds_read_b64_tr_b16 v[102:103], v3 offset:34304
    s_waitcnt lgkmcnt(6)
    v_mfma_f32_16x16x32_bf16 v[28:31], v[88:91], v[204:207], v[28:31]
    ds_read_b64_tr_b16 v[104:105], v15 offset:33312
    v_mfma_f32_16x16x32_bf16 v[32:35], v[88:91], v[208:211], v[32:35]
    s_add_u32 s22, s16, 0x410000
    s_add_u32 m0, s17, 0x800
    s_nop 0
    buffer_load_dwordx4 v16, s[4:7], s22 offen lds
    ds_read_b64_tr_b16 v[106:107], v15 offset:34336
    s_mov_b32 s23, 0x4000
    buffer_load_dwordx4 v[140:143], v4, s[8:11], s23 offen offset:0 sc1
    s_waitcnt lgkmcnt(6)
    v_mfma_f32_16x16x32_bf16 v[36:39], v[92:95], v[204:207], v[36:39]
    ds_read_b64_tr_b16 v[84:85], v3 offset:33536
    v_mfma_f32_16x16x32_bf16 v[40:43], v[92:95], v[208:211], v[40:43]
    ds_read_b64_tr_b16 v[86:87], v3 offset:34560
    s_waitcnt lgkmcnt(6)
    v_mfma_f32_16x16x32_bf16 v[44:47], v[96:99], v[204:207], v[44:47]
    ds_read_b64_tr_b16 v[88:89], v15 offset:33568
    v_mfma_f32_16x16x32_bf16 v[48:51], v[96:99], v[208:211], v[48:51]
    s_add_u32 s22, s16, 0x418000
    s_add_u32 m0, s17, 0xc00
    s_nop 0
    buffer_load_dwordx4 v16, s[4:7], s22 offen lds
    ds_read_b64_tr_b16 v[90:91], v15 offset:34592
    s_waitcnt lgkmcnt(6)
    v_mfma_f32_16x16x32_bf16 v[52:55], v[100:103], v[204:207], v[52:55]
    ds_read_b64_tr_b16 v[92:93], v3 offset:40960
    v_mfma_f32_16x16x32_bf16 v[56:59], v[100:103], v[208:211], v[56:59]
    ds_read_b64_tr_b16 v[94:95], v3 offset:41984
    s_waitcnt lgkmcnt(6)
    v_mfma_f32_16x16x32_bf16 v[60:63], v[104:107], v[204:207], v[60:63]
    ds_read_b64_tr_b16 v[96:97], v15 offset:40992
    v_mfma_f32_16x16x32_bf16 v[64:67], v[104:107], v[208:211], v[64:67]
    ds_read_b64_tr_b16 v[98:99], v15 offset:42016
    s_mov_b32 s23, 0xc000
    buffer_load_dwordx4 v[144:147], v4, s[8:11], s23 offen offset:0 sc1
    s_waitcnt lgkmcnt(6)
    v_mfma_f32_16x16x32_bf16 v[68:71], v[84:87], v[204:207], v[68:71]
    ds_read_b64_tr_b16 v[100:101], v3 offset:41216
    v_mfma_f32_16x16x32_bf16 v[72:75], v[84:87], v[208:211], v[72:75]
    ds_read_b64_tr_b16 v[102:103], v3 offset:42240
    s_waitcnt lgkmcnt(6)
    v_mfma_f32_16x16x32_bf16 v[76:79], v[88:91], v[204:207], v[76:79]
    ds_read_b64_tr_b16 v[104:105], v15 offset:41248
    v_mfma_f32_16x16x32_bf16 v[80:83], v[88:91], v[208:211], v[80:83]
    ds_read_b64_tr_b16 v[106:107], v15 offset:42272
    s_waitcnt vmcnt(15) lgkmcnt(6)
    v_mfma_f32_16x16x32_bf16 v[20:23], v[92:95], v[212:215], v[20:23]
    ds_read_b64_tr_b16 v[84:85], v3 offset:41472
    s_waitcnt vmcnt(13)
    v_mfma_f32_16x16x32_bf16 v[24:27], v[92:95], v[216:219], v[24:27]
    ds_read_b64_tr_b16 v[86:87], v3 offset:42496
    s_waitcnt lgkmcnt(6)
    v_mfma_f32_16x16x32_bf16 v[28:31], v[96:99], v[212:215], v[28:31]
    ds_read_b64_tr_b16 v[88:89], v15 offset:41504
    v_mfma_f32_16x16x32_bf16 v[32:35], v[96:99], v[216:219], v[32:35]
    ds_read_b64_tr_b16 v[90:91], v15 offset:42528
    s_mov_b32 s23, 0x4000
    buffer_load_dwordx4 v[148:151], v4, s[8:11], s23 offen offset:1024 sc1
    s_waitcnt lgkmcnt(6)
    v_mfma_f32_16x16x32_bf16 v[36:39], v[100:103], v[212:215], v[36:39]
    ds_read_b64_tr_b16 v[92:93], v3 offset:41728
    v_mfma_f32_16x16x32_bf16 v[40:43], v[100:103], v[216:219], v[40:43]
    ds_read_b64_tr_b16 v[94:95], v3 offset:42752
    s_waitcnt lgkmcnt(6)
    v_mfma_f32_16x16x32_bf16 v[44:47], v[104:107], v[212:215], v[44:47]
    ds_read_b64_tr_b16 v[96:97], v15 offset:41760
    v_mfma_f32_16x16x32_bf16 v[48:51], v[104:107], v[216:219], v[48:51]
    ds_read_b64_tr_b16 v[98:99], v15 offset:42784
    s_waitcnt lgkmcnt(6)
    v_mfma_f32_16x16x32_bf16 v[52:55], v[84:87], v[212:215], v[52:55]
    v_mfma_f32_16x16x32_bf16 v[56:59], v[84:87], v[216:219], v[56:59]
    s_waitcnt vmcnt(10)
    s_barrier
    ds_read_b64_tr_b16 v[100:101], v3 offset:49152
    ds_read_b64_tr_b16 v[102:103], v3 offset:50176
    s_waitcnt lgkmcnt(6)
    v_mfma_f32_16x16x32_bf16 v[60:63], v[88:91], v[212:215], v[60:63]
    ds_read_b64_tr_b16 v[104:105], v15 offset:49184
    v_mfma_f32_16x16x32_bf16 v[64:67], v[88:91], v[216:219], v[64:67]
    s_add_u32 s22, s16, 0x480000
    s_add_u32 m0, s17, 0x4000
    s_nop 0
    buffer_load_dwordx4 v2, s[4:7], s22 offen lds
    ds_read_b64_tr_b16 v[106:107], v15 offset:50208
    s_mov_b32 s23, 0xc000
    buffer_load_dwordx4 v[152:155], v4, s[8:11], s23 offen offset:1024 sc1
    s_waitcnt lgkmcnt(6)
    v_mfma_f32_16x16x32_bf16 v[68:71], v[92:95], v[212:215], v[68:71]
    ds_read_b64_tr_b16 v[84:85], v3 offset:49408
    v_mfma_f32_16x16x32_bf16 v[72:75], v[92:95], v[216:219], v[72:75]
    ds_read_b64_tr_b16 v[86:87], v3 offset:50432
    s_waitcnt lgkmcnt(6)
    v_mfma_f32_16x16x32_bf16 v[76:79], v[96:99], v[212:215], v[76:79]
    ds_read_b64_tr_b16 v[88:89], v15 offset:49440
    v_mfma_f32_16x16x32_bf16 v[80:83], v[96:99], v[216:219], v[80:83]
    s_add_u32 s22, s16, 0x488000
    s_add_u32 m0, s17, 0x4400
    s_nop 0
    buffer_load_dwordx4 v2, s[4:7], s22 offen lds
    ds_read_b64_tr_b16 v[90:91], v15 offset:50464
    s_waitcnt lgkmcnt(6)
    v_mfma_f32_16x16x32_bf16 v[20:23], v[100:103], v[220:223], v[20:23]
    ds_read_b64_tr_b16 v[92:93], v3 offset:49664
    s_waitcnt vmcnt(12)
    v_mfma_f32_16x16x32_bf16 v[24:27], v[100:103], v[224:227], v[24:27]
    ds_read_b64_tr_b16 v[94:95], v3 offset:50688
    s_waitcnt lgkmcnt(6)
    v_mfma_f32_16x16x32_bf16 v[28:31], v[104:107], v[220:223], v[28:31]
    ds_read_b64_tr_b16 v[96:97], v15 offset:49696
    v_mfma_f32_16x16x32_bf16 v[32:35], v[104:107], v[224:227], v[32:35]
    s_add_u32 s22, s16, 0x490000
    s_add_u32 m0, s17, 0x4800
    s_nop 0
    buffer_load_dwordx4 v16, s[4:7], s22 offen lds
    ds_read_b64_tr_b16 v[98:99], v15 offset:50720
    s_mov_b32 s23, 0x4800
    buffer_load_dwordx4 v[204:207], v4, s[8:11], s23 offen offset:0 sc1
    s_waitcnt lgkmcnt(6)
    v_mfma_f32_16x16x32_bf16 v[36:39], v[84:87], v[220:223], v[36:39]
    ds_read_b64_tr_b16 v[100:101], v3 offset:49920
    v_mfma_f32_16x16x32_bf16 v[40:43], v[84:87], v[224:227], v[40:43]
    ds_read_b64_tr_b16 v[102:103], v3 offset:50944
    s_waitcnt lgkmcnt(6)
    v_mfma_f32_16x16x32_bf16 v[44:47], v[88:91], v[220:223], v[44:47]
    ds_read_b64_tr_b16 v[104:105], v15 offset:49952
    v_mfma_f32_16x16x32_bf16 v[48:51], v[88:91], v[224:227], v[48:51]
    s_add_u32 s22, s16, 0x498000
    s_add_u32 m0, s17, 0x4c00
    s_nop 0
    buffer_load_dwordx4 v16, s[4:7], s22 offen lds
    ds_read_b64_tr_b16 v[106:107], v15 offset:50976
    s_waitcnt lgkmcnt(6)
    v_mfma_f32_16x16x32_bf16 v[52:55], v[92:95], v[220:223], v[52:55]
    ds_read_b64_tr_b16 v[84:85], v3 offset:57344
    v_mfma_f32_16x16x32_bf16 v[56:59], v[92:95], v[224:227], v[56:59]
    ds_read_b64_tr_b16 v[86:87], v3 offset:58368
    s_waitcnt lgkmcnt(6)
    v_mfma_f32_16x16x32_bf16 v[60:63], v[96:99], v[220:223], v[60:63]
    ds_read_b64_tr_b16 v[88:89], v15 offset:57376
    v_mfma_f32_16x16x32_bf16 v[64:67], v[96:99], v[224:227], v[64:67]
    ds_read_b64_tr_b16 v[90:91], v15 offset:58400
    s_mov_b32 s23, 0xc800
    buffer_load_dwordx4 v[208:211], v4, s[8:11], s23 offen offset:0 sc1
    s_waitcnt lgkmcnt(6)
    v_mfma_f32_16x16x32_bf16 v[68:71], v[100:103], v[220:223], v[68:71]
    ds_read_b64_tr_b16 v[92:93], v3 offset:57600
    v_mfma_f32_16x16x32_bf16 v[72:75], v[100:103], v[224:227], v[72:75]
    ds_read_b64_tr_b16 v[94:95], v3 offset:58624
    s_waitcnt lgkmcnt(6)
    v_mfma_f32_16x16x32_bf16 v[76:79], v[104:107], v[220:223], v[76:79]
    ds_read_b64_tr_b16 v[96:97], v15 offset:57632
    v_mfma_f32_16x16x32_bf16 v[80:83], v[104:107], v[224:227], v[80:83]
    ds_read_b64_tr_b16 v[98:99], v15 offset:58656
    s_waitcnt vmcnt(15) lgkmcnt(6)
    v_mfma_f32_16x16x32_bf16 v[20:23], v[84:87], v[228:231], v[20:23]
    ds_read_b64_tr_b16 v[100:101], v3 offset:57856
    s_waitcnt vmcnt(13)
    v_mfma_f32_16x16x32_bf16 v[24:27], v[84:87], v[232:235], v[24:27]
    ds_read_b64_tr_b16 v[102:103], v3 offset:58880
    s_waitcnt lgkmcnt(6)
    v_mfma_f32_16x16x32_bf16 v[28:31], v[88:91], v[228:231], v[28:31]
    ds_read_b64_tr_b16 v[104:105], v15 offset:57888
    v_mfma_f32_16x16x32_bf16 v[32:35], v[88:91], v[232:235], v[32:35]
    ds_read_b64_tr_b16 v[106:107], v15 offset:58912
    s_mov_b32 s23, 0x4800
    buffer_load_dwordx4 v[212:215], v4, s[8:11], s23 offen offset:1024 sc1
    s_waitcnt lgkmcnt(6)
    v_mfma_f32_16x16x32_bf16 v[36:39], v[92:95], v[228:231], v[36:39]
    ds_read_b64_tr_b16 v[84:85], v3 offset:58112
    v_mfma_f32_16x16x32_bf16 v[40:43], v[92:95], v[232:235], v[40:43]
    ds_read_b64_tr_b16 v[86:87], v3 offset:59136
    s_waitcnt lgkmcnt(6)
    v_mfma_f32_16x16x32_bf16 v[44:47], v[96:99], v[228:231], v[44:47]
    ds_read_b64_tr_b16 v[88:89], v15 offset:58144
    v_mfma_f32_16x16x32_bf16 v[48:51], v[96:99], v[232:235], v[48:51]
    ds_read_b64_tr_b16 v[90:91], v15 offset:59168
    s_waitcnt lgkmcnt(6)
    v_mfma_f32_16x16x32_bf16 v[52:55], v[100:103], v[228:231], v[52:55]
    v_mfma_f32_16x16x32_bf16 v[56:59], v[100:103], v[232:235], v[56:59]
    s_waitcnt vmcnt(10)
    s_barrier
    ds_read_b64_tr_b16 v[92:93], v3 offset:0
    ds_read_b64_tr_b16 v[94:95], v3 offset:1024
    s_waitcnt lgkmcnt(6)
    v_mfma_f32_16x16x32_bf16 v[60:63], v[104:107], v[228:231], v[60:63]
    ds_read_b64_tr_b16 v[96:97], v15 offset:32
    v_mfma_f32_16x16x32_bf16 v[64:67], v[104:107], v[232:235], v[64:67]
    s_add_u32 s22, s16, 0x500000
    s_add_u32 m0, s17, 0x8000
    s_nop 0
    buffer_load_dwordx4 v2, s[4:7], s22 offen lds
    ds_read_b64_tr_b16 v[98:99], v15 offset:1056
    s_mov_b32 s23, 0xc800
    buffer_load_dwordx4 v[216:219], v4, s[8:11], s23 offen offset:1024 sc1
    s_waitcnt lgkmcnt(6)
    v_mfma_f32_16x16x32_bf16 v[68:71], v[84:87], v[228:231], v[68:71]
    ds_read_b64_tr_b16 v[100:101], v3 offset:256
    v_mfma_f32_16x16x32_bf16 v[72:75], v[84:87], v[232:235], v[72:75]
    ds_read_b64_tr_b16 v[102:103], v3 offset:1280
    s_waitcnt lgkmcnt(6)
    v_mfma_f32_16x16x32_bf16 v[76:79], v[88:91], v[228:231], v[76:79]
    ds_read_b64_tr_b16 v[104:105], v15 offset:288
    v_mfma_f32_16x16x32_bf16 v[80:83], v[88:91], v[232:235], v[80:83]
    s_add_u32 s22, s16, 0x508000
    s_add_u32 m0, s17, 0x8400
    s_nop 0
    buffer_load_dwordx4 v2, s[4:7], s22 offen lds
    ds_read_b64_tr_b16 v[106:107], v15 offset:1312
    s_waitcnt lgkmcnt(6)
    v_mfma_f32_16x16x32_bf16 v[20:23], v[92:95], v[140:143], v[20:23]
    ds_read_b64_tr_b16 v[84:85], v3 offset:512
    s_waitcnt vmcnt(12)
    v_mfma_f32_16x16x32_bf16 v[24:27], v[92:95], v[144:147], v[24:27]
    ds_read_b64_tr_b16 v[86:87], v3 offset:1536
    s_waitcnt lgkmcnt(6)
    v_mfma_f32_16x16x32_bf16 v[28:31], v[96:99], v[140:143], v[28:31]
    ds_read_b64_tr_b16 v[88:89], v15 offset:544
    v_mfma_f32_16x16x32_bf16 v[32:35], v[96:99], v[144:147], v[32:35]
    s_add_u32 s22, s16, 0x510000
    s_add_u32 m0, s17, 0x8800
    s_nop 0
    buffer_load_dwordx4 v16, s[4:7], s22 offen lds
    ds_read_b64_tr_b16 v[90:91], v15 offset:1568
    s_mov_b32 s23, 0x5000
    buffer_load_dwordx4 v[220:223], v4, s[8:11], s23 offen offset:0 sc1
    s_waitcnt lgkmcnt(6)
    v_mfma_f32_16x16x32_bf16 v[36:39], v[100:103], v[140:143], v[36:39]
    ds_read_b64_tr_b16 v[92:93], v3 offset:768
    v_mfma_f32_16x16x32_bf16 v[40:43], v[100:103], v[144:147], v[40:43]
    ds_read_b64_tr_b16 v[94:95], v3 offset:1792
    s_waitcnt lgkmcnt(6)
    v_mfma_f32_16x16x32_bf16 v[44:47], v[104:107], v[140:143], v[44:47]
    ds_read_b64_tr_b16 v[96:97], v15 offset:800
    v_mfma_f32_16x16x32_bf16 v[48:51], v[104:107], v[144:147], v[48:51]
    s_add_u32 s22, s16, 0x518000
    s_add_u32 m0, s17, 0x8c00
    s_nop 0
    buffer_load_dwordx4 v16, s[4:7], s22 offen lds
    ds_read_b64_tr_b16 v[98:99], v15 offset:1824
    s_waitcnt lgkmcnt(6)
    v_mfma_f32_16x16x32_bf16 v[52:55], v[84:87], v[140:143], v[52:55]
    ds_read_b64_tr_b16 v[100:101], v3 offset:8192
    v_mfma_f32_16x16x32_bf16 v[56:59], v[84:87], v[144:147], v[56:59]
    ds_read_b64_tr_b16 v[102:103], v3 offset:9216
    s_waitcnt lgkmcnt(6)
    v_mfma_f32_16x16x32_bf16 v[60:63], v[88:91], v[140:143], v[60:63]
    ds_read_b64_tr_b16 v[104:105], v15 offset:8224
    v_mfma_f32_16x16x32_bf16 v[64:67], v[88:91], v[144:147], v[64:67]
    ds_read_b64_tr_b16 v[106:107], v15 offset:9248
    s_mov_b32 s23, 0xd000
    buffer_load_dwordx4 v[224:227], v4, s[8:11], s23 offen offset:0 sc1
    s_waitcnt lgkmcnt(6)
    v_mfma_f32_16x16x32_bf16 v[68:71], v[92:95], v[140:143], v[68:71]
    ds_read_b64_tr_b16 v[84:85], v3 offset:8448
    v_mfma_f32_16x16x32_bf16 v[72:75], v[92:95], v[144:147], v[72:75]
    ds_read_b64_tr_b16 v[86:87], v3 offset:9472
    s_waitcnt lgkmcnt(6)
    v_mfma_f32_16x16x32_bf16 v[76:79], v[96:99], v[140:143], v[76:79]
    ds_read_b64_tr_b16 v[88:89], v15 offset:8480
    v_mfma_f32_16x16x32_bf16 v[80:83], v[96:99], v[144:147], v[80:83]
    ds_read_b64_tr_b16 v[90:91], v15 offset:9504
    s_waitcnt vmcnt(15) lgkmcnt(6)
    v_mfma_f32_16x16x32_bf16 v[20:23], v[100:103], v[148:151], v[20:23]
    ds_read_b64_tr_b16 v[92:93], v3 offset:8704
    s_waitcnt vmcnt(13)
    v_mfma_f32_16x16x32_bf16 v[24:27], v[100:103], v[152:155], v[24:27]
    ds_read_b64_tr_b16 v[94:95], v3 offset:9728
    s_waitcnt lgkmcnt(6)
    v_mfma_f32_16x16x32_bf16 v[28:31], v[104:107], v[148:151], v[28:31]
    ds_read_b64_tr_b16 v[96:97], v15 offset:8736
    v_mfma_f32_16x16x32_bf16 v[32:35], v[104:107], v[152:155], v[32:35]
    ds_read_b64_tr_b16 v[98:99], v15 offset:9760
    s_mov_b32 s23, 0x5000
    buffer_load_dwordx4 v[228:231], v4, s[8:11], s23 offen offset:1024 sc1
    s_waitcnt lgkmcnt(6)
    v_mfma_f32_16x16x32_bf16 v[36:39], v[84:87], v[148:151], v[36:39]
    ds_read_b64_tr_b16 v[100:101], v3 offset:8960
    v_mfma_f32_16x16x32_bf16 v[40:43], v[84:87], v[152:155], v[40:43]
    ds_read_b64_tr_b16 v[102:103], v3 offset:9984
    s_waitcnt lgkmcnt(6)
    v_mfma_f32_16x16x32_bf16 v[44:47], v[88:91], v[148:151], v[44:47]
    ds_read_b64_tr_b16 v[104:105], v15 offset:8992
    v_mfma_f32_16x16x32_bf16 v[48:51], v[88:91], v[152:155], v[48:51]
    ds_read_b64_tr_b16 v[106:107], v15 offset:10016
    s_waitcnt lgkmcnt(6)
    v_mfma_f32_16x16x32_bf16 v[52:55], v[92:95], v[148:151], v[52:55]
    v_mfma_f32_16x16x32_bf16 v[56:59], v[92:95], v[152:155], v[56:59]
    s_waitcnt vmcnt(10)
    s_barrier
    ds_read_b64_tr_b16 v[84:85], v3 offset:16384
    ds_read_b64_tr_b16 v[86:87], v3 offset:17408
    s_waitcnt lgkmcnt(6)
    v_mfma_f32_16x16x32_bf16 v[60:63], v[96:99], v[148:151], v[60:63]
    ds_read_b64_tr_b16 v[88:89], v15 offset:16416
    v_mfma_f32_16x16x32_bf16 v[64:67], v[96:99], v[152:155], v[64:67]
    s_add_u32 s22, s16, 0x580000
    s_add_u32 m0, s17, 0xc000
    s_nop 0
    buffer_load_dwordx4 v2, s[4:7], s22 offen lds
    ds_read_b64_tr_b16 v[90:91], v15 offset:17440
    s_mov_b32 s23, 0xd000
    buffer_load_dwordx4 v[232:235], v4, s[8:11], s23 offen offset:1024 sc1
    s_waitcnt lgkmcnt(6)
    v_mfma_f32_16x16x32_bf16 v[68:71], v[100:103], v[148:151], v[68:71]
    ds_read_b64_tr_b16 v[92:93], v3 offset:16640
    v_mfma_f32_16x16x32_bf16 v[72:75], v[100:103], v[152:155], v[72:75]
    ds_read_b64_tr_b16 v[94:95], v3 offset:17664
    s_waitcnt lgkmcnt(6)
    v_mfma_f32_16x16x32_bf16 v[76:79], v[104:107], v[148:151], v[76:79]
    ds_read_b64_tr_b16 v[96:97], v15 offset:16672
    v_mfma_f32_16x16x32_bf16 v[80:83], v[104:107], v[152:155], v[80:83]
    s_add_u32 s22, s16, 0x588000
    s_add_u32 m0, s17, 0xc400
    s_nop 0
    buffer_load_dwordx4 v2, s[4:7], s22 offen lds
    ds_read_b64_tr_b16 v[98:99], v15 offset:17696
    s_waitcnt lgkmcnt(6)
    v_mfma_f32_16x16x32_bf16 v[20:23], v[84:87], v[204:207], v[20:23]
    ds_read_b64_tr_b16 v[100:101], v3 offset:16896
    s_waitcnt vmcnt(12)
    v_mfma_f32_16x16x32_bf16 v[24:27], v[84:87], v[208:211], v[24:27]
    ds_read_b64_tr_b16 v[102:103], v3 offset:17920
    s_waitcnt lgkmcnt(6)
    v_mfma_f32_16x16x32_bf16 v[28:31], v[88:91], v[204:207], v[28:31]
    ds_read_b64_tr_b16 v[104:105], v15 offset:16928
    v_mfma_f32_16x16x32_bf16 v[32:35], v[88:91], v[208:211], v[32:35]
    s_add_u32 s22, s16, 0x590000
    s_add_u32 m0, s17, 0xc800
    s_nop 0
    buffer_load_dwordx4 v16, s[4:7], s22 offen lds
    ds_read_b64_tr_b16 v[106:107], v15 offset:17952
    s_mov_b32 s23, 0x5800
    buffer_load_dwordx4 v[140:143], v4, s[8:11], s23 offen offset:0 sc1
    s_waitcnt lgkmcnt(6)
    v_mfma_f32_16x16x32_bf16 v[36:39], v[92:95], v[204:207], v[36:39]
    ds_read_b64_tr_b16 v[84:85], v3 offset:17152
    v_mfma_f32_16x16x32_bf16 v[40:43], v[92:95], v[208:211], v[40:43]
    ds_read_b64_tr_b16 v[86:87], v3 offset:18176
    s_waitcnt lgkmcnt(6)
    v_mfma_f32_16x16x32_bf16 v[44:47], v[96:99], v[204:207], v[44:47]
    ds_read_b64_tr_b16 v[88:89], v15 offset:17184
    v_mfma_f32_16x16x32_bf16 v[48:51], v[96:99], v[208:211], v[48:51]
    s_add_u32 s22, s16, 0x598000
    s_add_u32 m0, s17, 0xcc00
    s_nop 0
    buffer_load_dwordx4 v16, s[4:7], s22 offen lds
    ds_read_b64_tr_b16 v[90:91], v15 offset:18208
    s_waitcnt lgkmcnt(6)
    v_mfma_f32_16x16x32_bf16 v[52:55], v[100:103], v[204:207], v[52:55]
    ds_read_b64_tr_b16 v[92:93], v3 offset:24576
    v_mfma_f32_16x16x32_bf16 v[56:59], v[100:103], v[208:211], v[56:59]
    ds_read_b64_tr_b16 v[94:95], v3 offset:25600
    s_waitcnt lgkmcnt(6)
    v_mfma_f32_16x16x32_bf16 v[60:63], v[104:107], v[204:207], v[60:63]
    ds_read_b64_tr_b16 v[96:97], v15 offset:24608
    v_mfma_f32_16x16x32_bf16 v[64:67], v[104:107], v[208:211], v[64:67]
    ds_read_b64_tr_b16 v[98:99], v15 offset:25632
    s_mov_b32 s23, 0xd800
    buffer_load_dwordx4 v[144:147], v4, s[8:11], s23 offen offset:0 sc1
    s_waitcnt lgkmcnt(6)
    v_mfma_f32_16x16x32_bf16 v[68:71], v[84:87], v[204:207], v[68:71]
    ds_read_b64_tr_b16 v[100:101], v3 offset:24832
    v_mfma_f32_16x16x32_bf16 v[72:75], v[84:87], v[208:211], v[72:75]
    ds_read_b64_tr_b16 v[102:103], v3 offset:25856
    s_waitcnt lgkmcnt(6)
    v_mfma_f32_16x16x32_bf16 v[76:79], v[88:91], v[204:207], v[76:79]
    ds_read_b64_tr_b16 v[104:105], v15 offset:24864
    v_mfma_f32_16x16x32_bf16 v[80:83], v[88:91], v[208:211], v[80:83]
    ds_read_b64_tr_b16 v[106:107], v15 offset:25888
    s_waitcnt vmcnt(15) lgkmcnt(6)
    v_mfma_f32_16x16x32_bf16 v[20:23], v[92:95], v[212:215], v[20:23]
    ds_read_b64_tr_b16 v[84:85], v3 offset:25088
    s_waitcnt vmcnt(13)
    v_mfma_f32_16x16x32_bf16 v[24:27], v[92:95], v[216:219], v[24:27]
    ds_read_b64_tr_b16 v[86:87], v3 offset:26112
    s_waitcnt lgkmcnt(6)
    v_mfma_f32_16x16x32_bf16 v[28:31], v[96:99], v[212:215], v[28:31]
    ds_read_b64_tr_b16 v[88:89], v15 offset:25120
    v_mfma_f32_16x16x32_bf16 v[32:35], v[96:99], v[216:219], v[32:35]
    ds_read_b64_tr_b16 v[90:91], v15 offset:26144
    s_mov_b32 s23, 0x5800
    buffer_load_dwordx4 v[148:151], v4, s[8:11], s23 offen offset:1024 sc1
    s_waitcnt lgkmcnt(6)
    v_mfma_f32_16x16x32_bf16 v[36:39], v[100:103], v[212:215], v[36:39]
    ds_read_b64_tr_b16 v[92:93], v3 offset:25344
    v_mfma_f32_16x16x32_bf16 v[40:43], v[100:103], v[216:219], v[40:43]
    ds_read_b64_tr_b16 v[94:95], v3 offset:26368
    s_waitcnt lgkmcnt(6)
    v_mfma_f32_16x16x32_bf16 v[44:47], v[104:107], v[212:215], v[44:47]
    ds_read_b64_tr_b16 v[96:97], v15 offset:25376
    v_mfma_f32_16x16x32_bf16 v[48:51], v[104:107], v[216:219], v[48:51]
    ds_read_b64_tr_b16 v[98:99], v15 offset:26400
    s_waitcnt lgkmcnt(6)
    v_mfma_f32_16x16x32_bf16 v[52:55], v[84:87], v[212:215], v[52:55]
    v_mfma_f32_16x16x32_bf16 v[56:59], v[84:87], v[216:219], v[56:59]
    s_waitcnt vmcnt(10)
    s_barrier
    ds_read_b64_tr_b16 v[100:101], v3 offset:32768
    ds_read_b64_tr_b16 v[102:103], v3 offset:33792
    s_waitcnt lgkmcnt(6)
    v_mfma_f32_16x16x32_bf16 v[60:63], v[88:91], v[212:215], v[60:63]
    ds_read_b64_tr_b16 v[104:105], v15 offset:32800
    v_mfma_f32_16x16x32_bf16 v[64:67], v[88:91], v[216:219], v[64:67]
    s_add_u32 s22, s16, 0x600000
    s_add_u32 m0, s17, 0x0
    s_nop 0
    buffer_load_dwordx4 v2, s[4:7], s22 offen lds
    ds_read_b64_tr_b16 v[106:107], v15 offset:33824
    s_mov_b32 s23, 0xd800
    buffer_load_dwordx4 v[152:155], v4, s[8:11], s23 offen offset:1024 sc1
    s_waitcnt lgkmcnt(6)
    v_mfma_f32_16x16x32_bf16 v[68:71], v[92:95], v[212:215], v[68:71]
    ds_read_b64_tr_b16 v[84:85], v3 offset:33024
    v_mfma_f32_16x16x32_bf16 v[72:75], v[92:95], v[216:219], v[72:75]
    ds_read_b64_tr_b16 v[86:87], v3 offset:34048
    s_waitcnt lgkmcnt(6)
    v_mfma_f32_16x16x32_bf16 v[76:79], v[96:99], v[212:215], v[76:79]
    ds_read_b64_tr_b16 v[88:89], v15 offset:33056
    v_mfma_f32_16x16x32_bf16 v[80:83], v[96:99], v[216:219], v[80:83]
    s_add_u32 s22, s16, 0x608000
    s_add_u32 m0, s17, 0x400
    s_nop 0
    buffer_load_dwordx4 v2, s[4:7], s22 offen lds
    ds_read_b64_tr_b16 v[90:91], v15 offset:34080
    s_waitcnt lgkmcnt(6)
    v_mfma_f32_16x16x32_bf16 v[20:23], v[100:103], v[220:223], v[20:23]
    ds_read_b64_tr_b16 v[92:93], v3 offset:33280
    s_waitcnt vmcnt(12)
    v_mfma_f32_16x16x32_bf16 v[24:27], v[100:103], v[224:227], v[24:27]
    ds_read_b64_tr_b16 v[94:95], v3 offset:34304
    s_waitcnt lgkmcnt(6)
    v_mfma_f32_16x16x32_bf16 v[28:31], v[104:107], v[220:223], v[28:31]
    ds_read_b64_tr_b16 v[96:97], v15 offset:33312
    v_mfma_f32_16x16x32_bf16 v[32:35], v[104:107], v[224:227], v[32:35]
    s_add_u32 s22, s16, 0x610000
    s_add_u32 m0, s17, 0x800
    s_nop 0
    buffer_load_dwordx4 v16, s[4:7], s22 offen lds
    ds_read_b64_tr_b16 v[98:99], v15 offset:34336
    s_mov_b32 s23, 0x6000
    buffer_load_dwordx4 v[204:207], v4, s[8:11], s23 offen offset:0 sc1
    s_waitcnt lgkmcnt(6)
    v_mfma_f32_16x16x32_bf16 v[36:39], v[84:87], v[220:223], v[36:39]
    ds_read_b64_tr_b16 v[100:101], v3 offset:33536
    v_mfma_f32_16x16x32_bf16 v[40:43], v[84:87], v[224:227], v[40:43]
    ds_read_b64_tr_b16 v[102:103], v3 offset:34560
    s_waitcnt lgkmcnt(6)
    v_mfma_f32_16x16x32_bf16 v[44:47], v[88:91], v[220:223], v[44:47]
    ds_read_b64_tr_b16 v[104:105], v15 offset:33568
    v_mfma_f32_16x16x32_bf16 v[48:51], v[88:91], v[224:227], v[48:51]
    s_add_u32 s22, s16, 0x618000
    s_add_u32 m0, s17, 0xc00
    s_nop 0
    buffer_load_dwordx4 v16, s[4:7], s22 offen lds
    ds_read_b64_tr_b16 v[106:107], v15 offset:34592
    s_waitcnt lgkmcnt(6)
    v_mfma_f32_16x16x32_bf16 v[52:55], v[92:95], v[220:223], v[52:55]
    ds_read_b64_tr_b16 v[84:85], v3 offset:40960
    v_mfma_f32_16x16x32_bf16 v[56:59], v[92:95], v[224:227], v[56:59]
    ds_read_b64_tr_b16 v[86:87], v3 offset:41984
    s_waitcnt lgkmcnt(6)
    v_mfma_f32_16x16x32_bf16 v[60:63], v[96:99], v[220:223], v[60:63]
    ds_read_b64_tr_b16 v[88:89], v15 offset:40992
    v_mfma_f32_16x16x32_bf16 v[64:67], v[96:99], v[224:227], v[64:67]
    ds_read_b64_tr_b16 v[90:91], v15 offset:42016
    s_mov_b32 s23, 0xe000
    buffer_load_dwordx4 v[208:211], v4, s[8:11], s23 offen offset:0 sc1
    s_waitcnt lgkmcnt(6)
    v_mfma_f32_16x16x32_bf16 v[68:71], v[100:103], v[220:223], v[68:71]
    ds_read_b64_tr_b16 v[92:93], v3 offset:41216
    v_mfma_f32_16x16x32_bf16 v[72:75], v[100:103], v[224:227], v[72:75]
    ds_read_b64_tr_b16 v[94:95], v3 offset:42240
    s_waitcnt lgkmcnt(6)
    v_mfma_f32_16x16x32_bf16 v[76:79], v[104:107], v[220:223], v[76:79]
    ds_read_b64_tr_b16 v[96:97], v15 offset:41248
    v_mfma_f32_16x16x32_bf16 v[80:83], v[104:107], v[224:227], v[80:83]
    ds_read_b64_tr_b16 v[98:99], v15 offset:42272
    s_waitcnt vmcnt(15) lgkmcnt(6)
    v_mfma_f32_16x16x32_bf16 v[20:23], v[84:87], v[228:231], v[20:23]
    ds_read_b64_tr_b16 v[100:101], v3 offset:41472
    s_waitcnt vmcnt(13)
    v_mfma_f32_16x16x32_bf16 v[24:27], v[84:87], v[232:235], v[24:27]
    ds_read_b64_tr_b16 v[102:103], v3 offset:42496
    s_waitcnt lgkmcnt(6)
    v_mfma_f32_16x16x32_bf16 v[28:31], v[88:91], v[228:231], v[28:31]
    ds_read_b64_tr_b16 v[104:105], v15 offset:41504
    v_mfma_f32_16x16x32_bf16 v[32:35], v[88:91], v[232:235], v[32:35]
    ds_read_b64_tr_b16 v[106:107], v15 offset:42528
    s_mov_b32 s23, 0x6000
    buffer_load_dwordx4 v[212:215], v4, s[8:11], s23 offen offset:1024 sc1
    s_waitcnt lgkmcnt(6)
    v_mfma_f32_16x16x32_bf16 v[36:39], v[92:95], v[228:231], v[36:39]
    ds_read_b64_tr_b16 v[84:85], v3 offset:41728
    v_mfma_f32_16x16x32_bf16 v[40:43], v[92:95], v[232:235], v[40:43]
    ds_read_b64_tr_b16 v[86:87], v3 offset:42752
    s_waitcnt lgkmcnt(6)
    v_mfma_f32_16x16x32_bf16 v[44:47], v[96:99], v[228:231], v[44:47]
    ds_read_b64_tr_b16 v[88:89], v15 offset:41760
    v_mfma_f32_16x16x32_bf16 v[48:51], v[96:99], v[232:235], v[48:51]
    ds_read_b64_tr_b16 v[90:91], v15 offset:42784
    s_waitcnt lgkmcnt(6)
    v_mfma_f32_16x16x32_bf16 v[52:55], v[100:103], v[228:231], v[52:55]
    v_mfma_f32_16x16x32_bf16 v[56:59], v[100:103], v[232:235], v[56:59]
    s_waitcnt vmcnt(10)
    s_barrier
    ds_read_b64_tr_b16 v[92:93], v3 offset:49152
    ds_read_b64_tr_b16 v[94:95], v3 offset:50176
    s_waitcnt lgkmcnt(6)
    v_mfma_f32_16x16x32_bf16 v[60:63], v[104:107], v[228:231], v[60:63]
    s_lshr_b32 s26, s12, 3
    s_lshl_b32 s26, s26, 10
    s_add_u32 s62, s26, 0x530000
    buffer_load_dword v17, v1, s[8:11], s62 offen offset:0 sc1
    buffer_load_dword v18, v1, s[8:11], s62 offen offset:4 sc1
    buffer_load_dword v19, v1, s[8:11], s62 offen offset:8 sc1
    buffer_load_dword v6, v1, s[8:11], s62 offen offset:12 sc1
    ds_read_b64_tr_b16 v[96:97], v15 offset:49184
    v_mfma_f32_16x16x32_bf16 v[64:67], v[104:107], v[232:235], v[64:67]
    s_add_u32 s22, s16, 0x680000
    s_add_u32 m0, s17, 0x4000
    s_nop 0
    buffer_load_dwordx4 v2, s[4:7], s22 offen lds
    ds_read_b64_tr_b16 v[98:99], v15 offset:50208
    s_mov_b32 s23, 0xe000
    buffer_load_dwordx4 v[216:219], v4, s[8:11], s23 offen offset:1024 sc1
    s_waitcnt lgkmcnt(6)
    v_mfma_f32_16x16x32_bf16 v[68:71], v[84:87], v[228:231], v[68:71]
    ds_read_b64_tr_b16 v[100:101], v3 offset:49408
    v_mfma_f32_16x16x32_bf16 v[72:75], v[84:87], v[232:235], v[72:75]
    ds_read_b64_tr_b16 v[102:103], v3 offset:50432
    s_waitcnt lgkmcnt(6)
    v_mfma_f32_16x16x32_bf16 v[76:79], v[88:91], v[228:231], v[76:79]
    ds_read_b64_tr_b16 v[104:105], v15 offset:49440
    v_mfma_f32_16x16x32_bf16 v[80:83], v[88:91], v[232:235], v[80:83]
    s_add_u32 s22, s16, 0x688000
    s_add_u32 m0, s17, 0x4400
    s_nop 0
    buffer_load_dwordx4 v2, s[4:7], s22 offen lds
    ds_read_b64_tr_b16 v[106:107], v15 offset:50464
    s_waitcnt lgkmcnt(6)
    v_mfma_f32_16x16x32_bf16 v[20:23], v[92:95], v[140:143], v[20:23]
    ds_read_b64_tr_b16 v[84:85], v3 offset:49664
    s_waitcnt vmcnt(16)
    v_mfma_f32_16x16x32_bf16 v[24:27], v[92:95], v[144:147], v[24:27]
    ds_read_b64_tr_b16 v[86:87], v3 offset:50688
    s_waitcnt lgkmcnt(6)
    v_mfma_f32_16x16x32_bf16 v[28:31], v[96:99], v[140:143], v[28:31]
    ds_read_b64_tr_b16 v[88:89], v15 offset:49696
    v_mfma_f32_16x16x32_bf16 v[32:35], v[96:99], v[144:147], v[32:35]
    s_add_u32 s22, s16, 0x690000
    s_add_u32 m0, s17, 0x4800
    s_nop 0
    buffer_load_dwordx4 v16, s[4:7], s22 offen lds
    ds_read_b64_tr_b16 v[90:91], v15 offset:50720
    s_mov_b32 s23, 0x6800
    buffer_load_dwordx4 v[220:223], v4, s[8:11], s23 offen offset:0 sc1
    s_waitcnt lgkmcnt(6)
    v_mfma_f32_16x16x32_bf16 v[36:39], v[100:103], v[140:143], v[36:39]
    ds_read_b64_tr_b16 v[92:93], v3 offset:49920
    v_mfma_f32_16x16x32_bf16 v[40:43], v[100:103], v[144:147], v[40:43]
    ds_read_b64_tr_b16 v[94:95], v3 offset:50944
    s_waitcnt lgkmcnt(6)
    v_mfma_f32_16x16x32_bf16 v[44:47], v[104:107], v[140:143], v[44:47]
    ds_read_b64_tr_b16 v[96:97], v15 offset:49952
    v_mfma_f32_16x16x32_bf16 v[48:51], v[104:107], v[144:147], v[48:51]
    s_add_u32 s22, s16, 0x698000
    s_add_u32 m0, s17, 0x4c00
    s_nop 0
    buffer_load_dwordx4 v16, s[4:7], s22 offen lds
    ds_read_b64_tr_b16 v[98:99], v15 offset:50976
    s_waitcnt lgkmcnt(6)
    v_mfma_f32_16x16x32_bf16 v[52:55], v[84:87], v[140:143], v[52:55]
    ds_read_b64_tr_b16 v[100:101], v3 offset:57344
    v_mfma_f32_16x16x32_bf16 v[56:59], v[84:87], v[144:147], v[56:59]
    ds_read_b64_tr_b16 v[102:103], v3 offset:58368
    s_waitcnt lgkmcnt(6)
    v_mfma_f32_16x16x32_bf16 v[60:63], v[88:91], v[140:143], v[60:63]
    ds_read_b64_tr_b16 v[104:105], v15 offset:57376
    v_mfma_f32_16x16x32_bf16 v[64:67], v[88:91], v[144:147], v[64:67]
    ds_read_b64_tr_b16 v[106:107], v15 offset:58400
    s_mov_b32 s23, 0xe800
    buffer_load_dwordx4 v[224:227], v4, s[8:11], s23 offen offset:0 sc1
    s_waitcnt lgkmcnt(6)
    v_mfma_f32_16x16x32_bf16 v[68:71], v[92:95], v[140:143], v[68:71]
    ds_read_b64_tr_b16 v[84:85], v3 offset:57600
    v_mfma_f32_16x16x32_bf16 v[72:75], v[92:95], v[144:147], v[72:75]
    ds_read_b64_tr_b16 v[86:87], v3 offset:58624
    s_waitcnt lgkmcnt(6)
    v_mfma_f32_16x16x32_bf16 v[76:79], v[96:99], v[140:143], v[76:79]
    ds_read_b64_tr_b16 v[88:89], v15 offset:57632
    v_mfma_f32_16x16x32_bf16 v[80:83], v[96:99], v[144:147], v[80:83]
    ds_read_b64_tr_b16 v[90:91], v15 offset:58656
    s_waitcnt vmcnt(19) lgkmcnt(6)
    v_mfma_f32_16x16x32_bf16 v[20:23], v[100:103], v[148:151], v[20:23]
    ds_read_b64_tr_b16 v[92:93], v3 offset:57856
    s_waitcnt vmcnt(17)
    v_mfma_f32_16x16x32_bf16 v[24:27], v[100:103], v[152:155], v[24:27]
    ds_read_b64_tr_b16 v[94:95], v3 offset:58880
    s_waitcnt lgkmcnt(6)
    v_mfma_f32_16x16x32_bf16 v[28:31], v[104:107], v[148:151], v[28:31]
    ds_read_b64_tr_b16 v[96:97], v15 offset:57888
    v_mfma_f32_16x16x32_bf16 v[32:35], v[104:107], v[152:155], v[32:35]
    ds_read_b64_tr_b16 v[98:99], v15 offset:58912
    s_mov_b32 s23, 0x6800
    buffer_load_dwordx4 v[228:231], v4, s[8:11], s23 offen offset:1024 sc1
    s_waitcnt lgkmcnt(6)
    v_mfma_f32_16x16x32_bf16 v[36:39], v[84:87], v[148:151], v[36:39]
    ds_read_b64_tr_b16 v[100:101], v3 offset:58112
    v_mfma_f32_16x16x32_bf16 v[40:43], v[84:87], v[152:155], v[40:43]
    ds_read_b64_tr_b16 v[102:103], v3 offset:59136
    s_waitcnt lgkmcnt(6)
    v_mfma_f32_16x16x32_bf16 v[44:47], v[88:91], v[148:151], v[44:47]
    ds_read_b64_tr_b16 v[104:105], v15 offset:58144
    v_mfma_f32_16x16x32_bf16 v[48:51], v[88:91], v[152:155], v[48:51]
    ds_read_b64_tr_b16 v[106:107], v15 offset:59168
    s_waitcnt lgkmcnt(6)
    v_mfma_f32_16x16x32_bf16 v[52:55], v[92:95], v[148:151], v[52:55]
    v_mfma_f32_16x16x32_bf16 v[56:59], v[92:95], v[152:155], v[56:59]
    s_waitcnt vmcnt(14)
    s_barrier
    ds_read_b64_tr_b16 v[84:85], v3 offset:0
    ds_read_b64_tr_b16 v[86:87], v3 offset:1024
    s_waitcnt lgkmcnt(6)
    v_mfma_f32_16x16x32_bf16 v[60:63], v[96:99], v[148:151], v[60:63]
    ds_read_b64_tr_b16 v[88:89], v15 offset:32
    v_mfma_f32_16x16x32_bf16 v[64:67], v[96:99], v[152:155], v[64:67]
    s_add_u32 s22, s16, 0x700000
    s_add_u32 m0, s17, 0x8000
    s_nop 0
    buffer_load_dwordx4 v2, s[4:7], s22 offen lds
    ds_read_b64_tr_b16 v[90:91], v15 offset:1056
    s_mov_b32 s23, 0xe800
    buffer_load_dwordx4 v[232:235], v4, s[8:11], s23 offen offset:1024 sc1
    s_waitcnt lgkmcnt(6)
    v_mfma_f32_16x16x32_bf16 v[68:71], v[100:103], v[148:151], v[68:71]
    ds_read_b64_tr_b16 v[92:93], v3 offset:256
    v_mfma_f32_16x16x32_bf16 v[72:75], v[100:103], v[152:155], v[72:75]
    ds_read_b64_tr_b16 v[94:95], v3 offset:1280
    s_waitcnt lgkmcnt(6)
    v_mfma_f32_16x16x32_bf16 v[76:79], v[104:107], v[148:151], v[76:79]
    ds_read_b64_tr_b16 v[96:97], v15 offset:288
    v_mfma_f32_16x16x32_bf16 v[80:83], v[104:107], v[152:155], v[80:83]
    s_add_u32 s22, s16, 0x708000
    s_add_u32 m0, s17, 0x8400
    s_nop 0
    buffer_load_dwordx4 v2, s[4:7], s22 offen lds
    ds_read_b64_tr_b16 v[98:99], v15 offset:1312
    s_waitcnt lgkmcnt(6)
    v_mfma_f32_16x16x32_bf16 v[20:23], v[84:87], v[204:207], v[20:23]
    ds_read_b64_tr_b16 v[100:101], v3 offset:512
    s_waitcnt vmcnt(16)
    v_mfma_f32_16x16x32_bf16 v[24:27], v[84:87], v[208:211], v[24:27]
    ds_read_b64_tr_b16 v[102:103], v3 offset:1536
    s_waitcnt lgkmcnt(6)
    v_mfma_f32_16x16x32_bf16 v[28:31], v[88:91], v[204:207], v[28:31]
    ds_read_b64_tr_b16 v[104:105], v15 offset:544
    v_mfma_f32_16x16x32_bf16 v[32:35], v[88:91], v[208:211], v[32:35]
    s_add_u32 s22, s16, 0x710000
    s_add_u32 m0, s17, 0x8800
    s_nop 0
    buffer_load_dwordx4 v16, s[4:7], s22 offen lds
    ds_read_b64_tr_b16 v[106:107], v15 offset:1568
    s_mov_b32 s23, 0x7000
    buffer_load_dwordx4 v[140:143], v4, s[8:11], s23 offen offset:0 sc1
    s_waitcnt lgkmcnt(6)
    v_mfma_f32_16x16x32_bf16 v[36:39], v[92:95], v[204:207], v[36:39]
    ds_read_b64_tr_b16 v[84:85], v3 offset:768
    v_mfma_f32_16x16x32_bf16 v[40:43], v[92:95], v[208:211], v[40:43]
    ds_read_b64_tr_b16 v[86:87], v3 offset:1792
    s_waitcnt lgkmcnt(6)
    v_mfma_f32_16x16x32_bf16 v[44:47], v[96:99], v[204:207], v[44:47]
    ds_read_b64_tr_b16 v[88:89], v15 offset:800
    v_mfma_f32_16x16x32_bf16 v[48:51], v[96:99], v[208:211], v[48:51]
    s_add_u32 s22, s16, 0x718000
    s_add_u32 m0, s17, 0x8c00
    s_nop 0
    buffer_load_dwordx4 v16, s[4:7], s22 offen lds
    ds_read_b64_tr_b16 v[90:91], v15 offset:1824
    s_waitcnt lgkmcnt(6)
    v_mfma_f32_16x16x32_bf16 v[52:55], v[100:103], v[204:207], v[52:55]
    ds_read_b64_tr_b16 v[92:93], v3 offset:8192
    v_mfma_f32_16x16x32_bf16 v[56:59], v[100:103], v[208:211], v[56:59]
    ds_read_b64_tr_b16 v[94:95], v3 offset:9216
    s_waitcnt lgkmcnt(6)
    v_mfma_f32_16x16x32_bf16 v[60:63], v[104:107], v[204:207], v[60:63]
    ds_read_b64_tr_b16 v[96:97], v15 offset:8224
    v_mfma_f32_16x16x32_bf16 v[64:67], v[104:107], v[208:211], v[64:67]
    ds_read_b64_tr_b16 v[98:99], v15 offset:9248
    s_mov_b32 s23, 0xf000
    buffer_load_dwordx4 v[144:147], v4, s[8:11], s23 offen offset:0 sc1
    s_waitcnt lgkmcnt(6)
    v_mfma_f32_16x16x32_bf16 v[68:71], v[84:87], v[204:207], v[68:71]
    ds_read_b64_tr_b16 v[100:101], v3 offset:8448
    v_mfma_f32_16x16x32_bf16 v[72:75], v[84:87], v[208:211], v[72:75]
    ds_read_b64_tr_b16 v[102:103], v3 offset:9472
    s_waitcnt lgkmcnt(6)
    v_mfma_f32_16x16x32_bf16 v[76:79], v[88:91], v[204:207], v[76:79]
    ds_read_b64_tr_b16 v[104:105], v15 offset:8480
    v_mfma_f32_16x16x32_bf16 v[80:83], v[88:91], v[208:211], v[80:83]
    ds_read_b64_tr_b16 v[106:107], v15 offset:9504
    s_waitcnt vmcnt(19) lgkmcnt(6)
    v_mfma_f32_16x16x32_bf16 v[20:23], v[92:95], v[212:215], v[20:23]
    ds_read_b64_tr_b16 v[84:85], v3 offset:8704
    s_waitcnt vmcnt(13)
    v_mfma_f32_16x16x32_bf16 v[24:27], v[92:95], v[216:219], v[24:27]
    ds_read_b64_tr_b16 v[86:87], v3 offset:9728
    s_waitcnt lgkmcnt(6)
    v_mfma_f32_16x16x32_bf16 v[28:31], v[96:99], v[212:215], v[28:31]
    ds_read_b64_tr_b16 v[88:89], v15 offset:8736
    v_mfma_f32_16x16x32_bf16 v[32:35], v[96:99], v[216:219], v[32:35]
    ds_read_b64_tr_b16 v[90:91], v15 offset:9760
    s_mov_b32 s23, 0x7000
    buffer_load_dwordx4 v[148:151], v4, s[8:11], s23 offen offset:1024 sc1
    s_waitcnt lgkmcnt(6)
    v_mfma_f32_16x16x32_bf16 v[36:39], v[100:103], v[212:215], v[36:39]
    ds_read_b64_tr_b16 v[92:93], v3 offset:8960
    v_mfma_f32_16x16x32_bf16 v[40:43], v[100:103], v[216:219], v[40:43]
    ds_read_b64_tr_b16 v[94:95], v3 offset:9984
    s_waitcnt lgkmcnt(6)
    v_mfma_f32_16x16x32_bf16 v[44:47], v[104:107], v[212:215], v[44:47]
    ds_read_b64_tr_b16 v[96:97], v15 offset:8992
    v_mfma_f32_16x16x32_bf16 v[48:51], v[104:107], v[216:219], v[48:51]
    ds_read_b64_tr_b16 v[98:99], v15 offset:10016
    s_waitcnt lgkmcnt(6)
    v_mfma_f32_16x16x32_bf16 v[52:55], v[84:87], v[212:215], v[52:55]
    v_mfma_f32_16x16x32_bf16 v[56:59], v[84:87], v[216:219], v[56:59]
    s_waitcnt vmcnt(10)
    s_barrier
    ds_read_b64_tr_b16 v[100:101], v3 offset:16384
    ds_read_b64_tr_b16 v[102:103], v3 offset:17408
    s_waitcnt lgkmcnt(6)
    v_mfma_f32_16x16x32_bf16 v[60:63], v[88:91], v[212:215], v[60:63]
    ds_read_b64_tr_b16 v[104:105], v15 offset:16416
    v_mfma_f32_16x16x32_bf16 v[64:67], v[88:91], v[216:219], v[64:67]
    s_add_u32 s22, s16, 0x780000
    s_add_u32 m0, s17, 0xc000
    s_nop 0
    buffer_load_dwordx4 v2, s[4:7], s22 offen lds
    ds_read_b64_tr_b16 v[106:107], v15 offset:17440
    s_mov_b32 s23, 0xf000
    buffer_load_dwordx4 v[152:155], v4, s[8:11], s23 offen offset:1024 sc1
    s_waitcnt lgkmcnt(6)
    v_mfma_f32_16x16x32_bf16 v[68:71], v[92:95], v[212:215], v[68:71]
    ds_read_b64_tr_b16 v[84:85], v3 offset:16640
    v_mfma_f32_16x16x32_bf16 v[72:75], v[92:95], v[216:219], v[72:75]
    ds_read_b64_tr_b16 v[86:87], v3 offset:17664
    s_waitcnt lgkmcnt(6)
    v_mfma_f32_16x16x32_bf16 v[76:79], v[96:99], v[212:215], v[76:79]
    ds_read_b64_tr_b16 v[88:89], v15 offset:16672
    v_mfma_f32_16x16x32_bf16 v[80:83], v[96:99], v[216:219], v[80:83]
    s_add_u32 s22, s16, 0x788000
    s_add_u32 m0, s17, 0xc400
    s_nop 0
    buffer_load_dwordx4 v2, s[4:7], s22 offen lds
    ds_read_b64_tr_b16 v[90:91], v15 offset:17696
    s_waitcnt lgkmcnt(6)
    v_mfma_f32_16x16x32_bf16 v[20:23], v[100:103], v[220:223], v[20:23]
    ds_read_b64_tr_b16 v[92:93], v3 offset:16896
    s_waitcnt vmcnt(12)
    v_mfma_f32_16x16x32_bf16 v[24:27], v[100:103], v[224:227], v[24:27]
    ds_read_b64_tr_b16 v[94:95], v3 offset:17920
    s_waitcnt lgkmcnt(6)
    v_mfma_f32_16x16x32_bf16 v[28:31], v[104:107], v[220:223], v[28:31]
    ds_read_b64_tr_b16 v[96:97], v15 offset:16928
    v_mfma_f32_16x16x32_bf16 v[32:35], v[104:107], v[224:227], v[32:35]
    s_add_u32 s22, s16, 0x790000
    s_add_u32 m0, s17, 0xc800
    s_nop 0
    buffer_load_dwordx4 v16, s[4:7], s22 offen lds
    ds_read_b64_tr_b16 v[98:99], v15 offset:17952
    s_mov_b32 s23, 0x7800
    buffer_load_dwordx4 v[204:207], v4, s[8:11], s23 offen offset:0 sc1
    s_waitcnt lgkmcnt(6)
    v_mfma_f32_16x16x32_bf16 v[36:39], v[84:87], v[220:223], v[36:39]
    ds_read_b64_tr_b16 v[100:101], v3 offset:17152
    v_mfma_f32_16x16x32_bf16 v[40:43], v[84:87], v[224:227], v[40:43]
    ds_read_b64_tr_b16 v[102:103], v3 offset:18176
    s_waitcnt lgkmcnt(6)
    v_mfma_f32_16x16x32_bf16 v[44:47], v[88:91], v[220:223], v[44:47]
    ds_read_b64_tr_b16 v[104:105], v15 offset:17184
    v_mfma_f32_16x16x32_bf16 v[48:51], v[88:91], v[224:227], v[48:51]
    s_add_u32 s22, s16, 0x798000
    s_add_u32 m0, s17, 0xcc00
    s_nop 0
    buffer_load_dwordx4 v16, s[4:7], s22 offen lds
    ds_read_b64_tr_b16 v[106:107], v15 offset:18208
    s_waitcnt lgkmcnt(6)
    v_mfma_f32_16x16x32_bf16 v[52:55], v[92:95], v[220:223], v[52:55]
    ds_read_b64_tr_b16 v[84:85], v3 offset:24576
    v_mfma_f32_16x16x32_bf16 v[56:59], v[92:95], v[224:227], v[56:59]
    ds_read_b64_tr_b16 v[86:87], v3 offset:25600
    s_waitcnt lgkmcnt(6)
    v_mfma_f32_16x16x32_bf16 v[60:63], v[96:99], v[220:223], v[60:63]
    ds_read_b64_tr_b16 v[88:89], v15 offset:24608
    v_mfma_f32_16x16x32_bf16 v[64:67], v[96:99], v[224:227], v[64:67]
    ds_read_b64_tr_b16 v[90:91], v15 offset:25632
    s_mov_b32 s23, 0xf800
    buffer_load_dwordx4 v[208:211], v4, s[8:11], s23 offen offset:0 sc1
    s_waitcnt lgkmcnt(6)
    v_mfma_f32_16x16x32_bf16 v[68:71], v[100:103], v[220:223], v[68:71]
    ds_read_b64_tr_b16 v[92:93], v3 offset:24832
    v_mfma_f32_16x16x32_bf16 v[72:75], v[100:103], v[224:227], v[72:75]
    ds_read_b64_tr_b16 v[94:95], v3 offset:25856
    s_waitcnt lgkmcnt(6)
    v_mfma_f32_16x16x32_bf16 v[76:79], v[104:107], v[220:223], v[76:79]
    ds_read_b64_tr_b16 v[96:97], v15 offset:24864
    v_mfma_f32_16x16x32_bf16 v[80:83], v[104:107], v[224:227], v[80:83]
    ds_read_b64_tr_b16 v[98:99], v15 offset:25888
    s_waitcnt vmcnt(15) lgkmcnt(6)
    v_mfma_f32_16x16x32_bf16 v[20:23], v[84:87], v[228:231], v[20:23]
    ds_read_b64_tr_b16 v[100:101], v3 offset:25088
    s_waitcnt vmcnt(13)
    v_mfma_f32_16x16x32_bf16 v[24:27], v[84:87], v[232:235], v[24:27]
    ds_read_b64_tr_b16 v[102:103], v3 offset:26112
    s_waitcnt lgkmcnt(6)
    v_mfma_f32_16x16x32_bf16 v[28:31], v[88:91], v[228:231], v[28:31]
    ds_read_b64_tr_b16 v[104:105], v15 offset:25120
    v_mfma_f32_16x16x32_bf16 v[32:35], v[88:91], v[232:235], v[32:35]
    ds_read_b64_tr_b16 v[106:107], v15 offset:26144
    s_mov_b32 s23, 0x7800
    buffer_load_dwordx4 v[212:215], v4, s[8:11], s23 offen offset:1024 sc1
    s_waitcnt lgkmcnt(6)
    v_mfma_f32_16x16x32_bf16 v[36:39], v[92:95], v[228:231], v[36:39]
    ds_read_b64_tr_b16 v[84:85], v3 offset:25344
    v_mfma_f32_16x16x32_bf16 v[40:43], v[92:95], v[232:235], v[40:43]
    ds_read_b64_tr_b16 v[86:87], v3 offset:26368
    s_waitcnt lgkmcnt(6)
    v_mfma_f32_16x16x32_bf16 v[44:47], v[96:99], v[228:231], v[44:47]
    ds_read_b64_tr_b16 v[88:89], v15 offset:25376
    v_mfma_f32_16x16x32_bf16 v[48:51], v[96:99], v[232:235], v[48:51]
    ds_read_b64_tr_b16 v[90:91], v15 offset:26400
    s_waitcnt lgkmcnt(6)
    v_mfma_f32_16x16x32_bf16 v[52:55], v[100:103], v[228:231], v[52:55]
    v_mfma_f32_16x16x32_bf16 v[56:59], v[100:103], v[232:235], v[56:59]
    s_waitcnt vmcnt(10)
    s_barrier
    v_xor_b32 v17, s14, v17
    v_xor_b32 v18, s14, v18
    v_xor_b32 v19, s14, v19
    v_xor_b32 v6, s14, v6
    v_or3_b32 v17, v17, v18, v19
    v_or_b32 v17, v17, v6
    v_cmp_ne_u32 vcc, 0, v17
    s_cbranch_vccz fz_kvg
    s_mov_b32 s27, 0
fz_kvp:
    buffer_load_dword v17, v1, s[8:11], s62 offen offset:0 sc1
    buffer_load_dword v18, v1, s[8:11], s62 offen offset:4 sc1
    buffer_load_dword v19, v1, s[8:11], s62 offen offset:8 sc1
    buffer_load_dword v6, v1, s[8:11], s62 offen offset:12 sc1
    s_waitcnt vmcnt(0)
    v_xor_b32 v17, s14, v17
    v_xor_b32 v18, s14, v18
    v_xor_b32 v19, s14, v19
    v_xor_b32 v6, s14, v6
    v_or3_b32 v17, v17, v18, v19
    v_or_b32 v17, v17, v6
    v_cmp_ne_u32 vcc, 0, v17
    s_add_u32 s27, s27, 1
    s_cmp_ge_u32 s27, 65536
    s_nop 4
    s_cbranch_scc1 fz_kvg
    s_cbranch_vccnz fz_kvp
fz_kvg:
    ds_read_b64_tr_b16 v[92:93], v3 offset:32768
    ds_read_b64_tr_b16 v[94:95], v3 offset:33792
    s_waitcnt lgkmcnt(6)
    v_mfma_f32_16x16x32_bf16 v[60:63], v[104:107], v[228:231], v[60:63]
    ds_read_b64_tr_b16 v[96:97], v15 offset:32800
    v_mfma_f32_16x16x32_bf16 v[64:67], v[104:107], v[232:235], v[64:67]
    s_add_u32 s22, s17, 0x0
    s_add_u32 m0, s17, 0x10000
    s_nop 0
    buffer_load_dwordx4 v5, s[8:11], s22 offen sc1 lds
    ds_read_b64_tr_b16 v[98:99], v15 offset:33824
    s_mov_b32 s23, 0xf800
    buffer_load_dwordx4 v[216:219], v4, s[8:11], s23 offen offset:1024 sc1
    s_waitcnt lgkmcnt(6)
    v_mfma_f32_16x16x32_bf16 v[68:71], v[84:87], v[228:231], v[68:71]
    ds_read_b64_tr_b16 v[100:101], v3 offset:33024
    v_mfma_f32_16x16x32_bf16 v[72:75], v[84:87], v[232:235], v[72:75]
    ds_read_b64_tr_b16 v[102:103], v3 offset:34048
    s_waitcnt lgkmcnt(6)
    v_mfma_f32_16x16x32_bf16 v[76:79], v[88:91], v[228:231], v[76:79]
    ds_read_b64_tr_b16 v[104:105], v15 offset:33056
    v_mfma_f32_16x16x32_bf16 v[80:83], v[88:91], v[232:235], v[80:83]
    s_add_u32 s22, s17, 0x400
    s_add_u32 m0, s17, 0x10400
    s_nop 0
    buffer_load_dwordx4 v5, s[8:11], s22 offen sc1 lds
    ds_read_b64_tr_b16 v[106:107], v15 offset:34080
    s_waitcnt lgkmcnt(6)
    v_mfma_f32_16x16x32_bf16 v[20:23], v[92:95], v[140:143], v[20:23]
    ds_read_b64_tr_b16 v[84:85], v3 offset:33280
    s_waitcnt vmcnt(12)
    v_mfma_f32_16x16x32_bf16 v[24:27], v[92:95], v[144:147], v[24:27]
    ds_read_b64_tr_b16 v[86:87], v3 offset:34304
    s_waitcnt lgkmcnt(6)
    v_mfma_f32_16x16x32_bf16 v[28:31], v[96:99], v[140:143], v[28:31]
    ds_read_b64_tr_b16 v[88:89], v15 offset:33312
    v_mfma_f32_16x16x32_bf16 v[32:35], v[96:99], v[144:147], v[32:35]
    s_add_u32 s22, s17, 0x800
    s_add_u32 m0, s17, 0x10800
    s_nop 0
    buffer_load_dwordx4 v5, s[8:11], s22 offen sc1 lds
    ds_read_b64_tr_b16 v[90:91], v15 offset:34336
    s_waitcnt lgkmcnt(6)
    v_mfma_f32_16x16x32_bf16 v[36:39], v[100:103], v[140:143], v[36:39]
    ds_read_b64_tr_b16 v[92:93], v3 offset:33536
    v_mfma_f32_16x16x32_bf16 v[40:43], v[100:103], v[144:147], v[40:43]
    ds_read_b64_tr_b16 v[94:95], v3 offset:34560
    s_waitcnt lgkmcnt(6)
    v_mfma_f32_16x16x32_bf16 v[44:47], v[104:107], v[140:143], v[44:47]
    ds_read_b64_tr_b16 v[96:97], v15 offset:33568
    v_mfma_f32_16x16x32_bf16 v[48:51], v[104:107], v[144:147], v[48:51]
    s_add_u32 s22, s17, 0xc00
    s_add_u32 m0, s17, 0x10c00
    s_nop 0
    buffer_load_dwordx4 v5, s[8:11], s22 offen sc1 lds
    ds_read_b64_tr_b16 v[98:99], v15 offset:34592
    s_waitcnt lgkmcnt(6)
    v_mfma_f32_16x16x32_bf16 v[52:55], v[84:87], v[140:143], v[52:55]
    ds_read_b64_tr_b16 v[100:101], v3 offset:40960
    v_mfma_f32_16x16x32_bf16 v[56:59], v[84:87], v[144:147], v[56:59]
    ds_read_b64_tr_b16 v[102:103], v3 offset:41984
    s_waitcnt lgkmcnt(6)
    v_mfma_f32_16x16x32_bf16 v[60:63], v[88:91], v[140:143], v[60:63]
    ds_read_b64_tr_b16 v[104:105], v15 offset:40992
    v_mfma_f32_16x16x32_bf16 v[64:67], v[88:91], v[144:147], v[64:67]
    ds_read_b64_tr_b16 v[106:107], v15 offset:42016
    s_waitcnt lgkmcnt(6)
    v_mfma_f32_16x16x32_bf16 v[68:71], v[92:95], v[140:143], v[68:71]
    ds_read_b64_tr_b16 v[84:85], v3 offset:41216
    v_mfma_f32_16x16x32_bf16 v[72:75], v[92:95], v[144:147], v[72:75]
    ds_read_b64_tr_b16 v[86:87], v3 offset:42240
    s_waitcnt lgkmcnt(6)
    v_mfma_f32_16x16x32_bf16 v[76:79], v[96:99], v[140:143], v[76:79]
    ds_read_b64_tr_b16 v[88:89], v15 offset:41248
    v_mfma_f32_16x16x32_bf16 v[80:83], v[96:99], v[144:147], v[80:83]
    ds_read_b64_tr_b16 v[90:91], v15 offset:42272
    s_waitcnt vmcnt(13) lgkmcnt(6)
    v_mfma_f32_16x16x32_bf16 v[20:23], v[100:103], v[148:151], v[20:23]
    ds_read_b64_tr_b16 v[92:93], v3 offset:41472
    s_waitcnt vmcnt(11)
    v_mfma_f32_16x16x32_bf16 v[24:27], v[100:103], v[152:155], v[24:27]
    ds_read_b64_tr_b16 v[94:95], v3 offset:42496
    s_add_u32 s22, s17, 0x8000
    s_add_u32 m0, s17, 0x18000
    s_nop 0
    buffer_load_dwordx4 v5, s[8:11], s22 offen sc1 lds
    s_waitcnt lgkmcnt(6)
    v_mfma_f32_16x16x32_bf16 v[28:31], v[104:107], v[148:151], v[28:31]
    ds_read_b64_tr_b16 v[96:97], v15 offset:41504
    v_mfma_f32_16x16x32_bf16 v[32:35], v[104:107], v[152:155], v[32:35]
    ds_read_b64_tr_b16 v[98:99], v15 offset:42528
    s_add_u32 s22, s17, 0x8400
    s_add_u32 m0, s17, 0x18400
    s_nop 0
    buffer_load_dwordx4 v5, s[8:11], s22 offen sc1 lds
    s_waitcnt lgkmcnt(6)
    v_mfma_f32_16x16x32_bf16 v[36:39], v[84:87], v[148:151], v[36:39]
    ds_read_b64_tr_b16 v[100:101], v3 offset:41728
    v_mfma_f32_16x16x32_bf16 v[40:43], v[84:87], v[152:155], v[40:43]
    ds_read_b64_tr_b16 v[102:103], v3 offset:42752
    s_add_u32 s22, s17, 0x8800
    s_add_u32 m0, s17, 0x18800
    s_nop 0
    buffer_load_dwordx4 v5, s[8:11], s22 offen sc1 lds
    s_waitcnt lgkmcnt(6)
    v_mfma_f32_16x16x32_bf16 v[44:47], v[88:91], v[148:151], v[44:47]
    ds_read_b64_tr_b16 v[104:105], v15 offset:41760
    v_mfma_f32_16x16x32_bf16 v[48:51], v[88:91], v[152:155], v[48:51]
    ds_read_b64_tr_b16 v[106:107], v15 offset:42784
    s_add_u32 s22, s17, 0x8c00
    s_add_u32 m0, s17, 0x18c00
    s_nop 0
    buffer_load_dwordx4 v5, s[8:11], s22 offen sc1 lds
    s_waitcnt lgkmcnt(6)
    v_mfma_f32_16x16x32_bf16 v[52:55], v[92:95], v[148:151], v[52:55]
    v_mfma_f32_16x16x32_bf16 v[56:59], v[92:95], v[152:155], v[56:59]
    s_waitcnt vmcnt(11)
    s_barrier
    ds_read_b64_tr_b16 v[84:85], v3 offset:49152
    ds_read_b64_tr_b16 v[86:87], v3 offset:50176
    s_add_u32 s22, s17, 0xc000
    s_add_u32 m0, s17, 0x1c000
    s_nop 0
    buffer_load_dwordx4 v5, s[8:11], s22 offen sc1 lds
    s_waitcnt lgkmcnt(6)
    v_mfma_f32_16x16x32_bf16 v[60:63], v[96:99], v[148:151], v[60:63]
    ds_read_b64_tr_b16 v[88:89], v15 offset:49184
    v_mfma_f32_16x16x32_bf16 v[64:67], v[96:99], v[152:155], v[64:67]
    s_add_u32 s22, s17, 0x4000
    s_add_u32 m0, s17, 0x14000
    s_nop 0
    buffer_load_dwordx4 v5, s[8:11], s22 offen sc1 lds
    ds_read_b64_tr_b16 v[90:91], v15 offset:50208
    s_add_u32 s22, s17, 0xc400
    s_add_u32 m0, s17, 0x1c400
    s_nop 0
    buffer_load_dwordx4 v5, s[8:11], s22 offen sc1 lds
    s_waitcnt lgkmcnt(6)
    v_mfma_f32_16x16x32_bf16 v[68:71], v[100:103], v[148:151], v[68:71]
    ds_read_b64_tr_b16 v[92:93], v3 offset:49408
    v_mfma_f32_16x16x32_bf16 v[72:75], v[100:103], v[152:155], v[72:75]
    ds_read_b64_tr_b16 v[94:95], v3 offset:50432
    s_add_u32 s22, s17, 0xc800
    s_add_u32 m0, s17, 0x1c800
    s_nop 0
    buffer_load_dwordx4 v5, s[8:11], s22 offen sc1 lds
    s_waitcnt lgkmcnt(6)
    v_mfma_f32_16x16x32_bf16 v[76:79], v[104:107], v[148:151], v[76:79]
    ds_read_b64_tr_b16 v[96:97], v15 offset:49440
    v_mfma_f32_16x16x32_bf16 v[80:83], v[104:107], v[152:155], v[80:83]
    s_add_u32 s22, s17, 0x4400
    s_add_u32 m0, s17, 0x14400
    s_nop 0
    buffer_load_dwordx4 v5, s[8:11], s22 offen sc1 lds
    ds_read_b64_tr_b16 v[98:99], v15 offset:50464
    s_add_u32 s22, s17, 0xcc00
    s_add_u32 m0, s17, 0x1cc00
    s_nop 0
    buffer_load_dwordx4 v5, s[8:11], s22 offen sc1 lds
    s_waitcnt lgkmcnt(6)
    v_mfma_f32_16x16x32_bf16 v[20:23], v[84:87], v[204:207], v[20:23]
    ds_read_b64_tr_b16 v[100:101], v3 offset:49664
    s_waitcnt vmcnt(16)
    v_mfma_f32_16x16x32_bf16 v[24:27], v[84:87], v[208:211], v[24:27]
    ds_read_b64_tr_b16 v[102:103], v3 offset:50688
    s_waitcnt lgkmcnt(6)
    v_mfma_f32_16x16x32_bf16 v[28:31], v[88:91], v[204:207], v[28:31]
    ds_read_b64_tr_b16 v[104:105], v15 offset:49696
    v_mfma_f32_16x16x32_bf16 v[32:35], v[88:91], v[208:211], v[32:35]
    s_add_u32 s22, s17, 0x4800
    s_add_u32 m0, s17, 0x14800
    s_nop 0
    buffer_load_dwordx4 v5, s[8:11], s22 offen sc1 lds
    ds_read_b64_tr_b16 v[106:107], v15 offset:50720
    s_waitcnt lgkmcnt(6)
    v_mfma_f32_16x16x32_bf16 v[36:39], v[92:95], v[204:207], v[36:39]
    ds_read_b64_tr_b16 v[84:85], v3 offset:49920
    v_mfma_f32_16x16x32_bf16 v[40:43], v[92:95], v[208:211], v[40:43]
    ds_read_b64_tr_b16 v[86:87], v3 offset:50944
    s_waitcnt lgkmcnt(6)
    v_mfma_f32_16x16x32_bf16 v[44:47], v[96:99], v[204:207], v[44:47]
    ds_read_b64_tr_b16 v[88:89], v15 offset:49952
    v_mfma_f32_16x16x32_bf16 v[48:51], v[96:99], v[208:211], v[48:51]
    s_add_u32 s22, s17, 0x4c00
    s_add_u32 m0, s17, 0x14c00
    s_nop 0
    buffer_load_dwordx4 v5, s[8:11], s22 offen sc1 lds
    ds_read_b64_tr_b16 v[90:91], v15 offset:50976
    s_waitcnt lgkmcnt(6)
    v_mfma_f32_16x16x32_bf16 v[52:55], v[100:103], v[204:207], v[52:55]
    ds_read_b64_tr_b16 v[92:93], v3 offset:57344
    v_mfma_f32_16x16x32_bf16 v[56:59], v[100:103], v[208:211], v[56:59]
    ds_read_b64_tr_b16 v[94:95], v3 offset:58368
    s_waitcnt lgkmcnt(6)
    v_mfma_f32_16x16x32_bf16 v[60:63], v[104:107], v[204:207], v[60:63]
    ds_read_b64_tr_b16 v[96:97], v15 offset:57376
    v_mfma_f32_16x16x32_bf16 v[64:67], v[104:107], v[208:211], v[64:67]
    ds_read_b64_tr_b16 v[98:99], v15 offset:58400
    s_waitcnt lgkmcnt(6)
    v_mfma_f32_16x16x32_bf16 v[68:71], v[84:87], v[204:207], v[68:71]
    ds_read_b64_tr_b16 v[100:101], v3 offset:57600
    v_mfma_f32_16x16x32_bf16 v[72:75], v[84:87], v[208:211], v[72:75]
    ds_read_b64_tr_b16 v[102:103], v3 offset:58624
    s_waitcnt lgkmcnt(6)
    v_mfma_f32_16x16x32_bf16 v[76:79], v[88:91], v[204:207], v[76:79]
    ds_read_b64_tr_b16 v[104:105], v15 offset:57632
    v_mfma_f32_16x16x32_bf16 v[80:83], v[88:91], v[208:211], v[80:83]
    ds_read_b64_tr_b16 v[106:107], v15 offset:58656
    s_waitcnt vmcnt(17) lgkmcnt(6)
    v_mfma_f32_16x16x32_bf16 v[20:23], v[92:95], v[212:215], v[20:23]
    ds_read_b64_tr_b16 v[84:85], v3 offset:57856
    s_waitcnt vmcnt(15)
    v_mfma_f32_16x16x32_bf16 v[24:27], v[92:95], v[216:219], v[24:27]
    ds_read_b64_tr_b16 v[86:87], v3 offset:58880
    s_add_u32 s22, s17, 0x10000
    s_add_u32 m0, s17, 0x20000
    s_nop 0
    buffer_load_dwordx4 v5, s[8:11], s22 offen sc1 lds
    s_waitcnt lgkmcnt(6)
    v_mfma_f32_16x16x32_bf16 v[28:31], v[96:99], v[212:215], v[28:31]
    ds_read_b64_tr_b16 v[88:89], v15 offset:57888
    v_mfma_f32_16x16x32_bf16 v[32:35], v[96:99], v[216:219], v[32:35]
    ds_read_b64_tr_b16 v[90:91], v15 offset:58912
    s_add_u32 s22, s17, 0x10400
    s_add_u32 m0, s17, 0x20400
    s_nop 0
    buffer_load_dwordx4 v5, s[8:11], s22 offen sc1 lds
    s_waitcnt lgkmcnt(6)
    v_mfma_f32_16x16x32_bf16 v[36:39], v[100:103], v[212:215], v[36:39]
    ds_read_b64_tr_b16 v[92:93], v3 offset:58112
    v_mfma_f32_16x16x32_bf16 v[40:43], v[100:103], v[216:219], v[40:43]
    ds_read_b64_tr_b16 v[94:95], v3 offset:59136
    s_add_u32 s22, s17, 0x10800
    s_add_u32 m0, s17, 0x20800
    s_nop 0
    buffer_load_dwordx4 v5, s[8:11], s22 offen sc1 lds
    s_waitcnt lgkmcnt(6)
    v_mfma_f32_16x16x32_bf16 v[44:47], v[104:107], v[212:215], v[44:47]
    ds_read_b64_tr_b16 v[96:97], v15 offset:58144
    v_mfma_f32_16x16x32_bf16 v[48:51], v[104:107], v[216:219], v[48:51]
    ds_read_b64_tr_b16 v[98:99], v15 offset:59168
    s_add_u32 s22, s17, 0x10c00
    s_add_u32 m0, s17, 0x20c00
    s_nop 0
    buffer_load_dwordx4 v5, s[8:11], s22 offen sc1 lds
    s_waitcnt lgkmcnt(6)
    v_mfma_f32_16x16x32_bf16 v[52:55], v[84:87], v[212:215], v[52:55]
    v_mfma_f32_16x16x32_bf16 v[56:59], v[84:87], v[216:219], v[56:59]
    s_add_u32 s22, s17, 0x14000
    s_add_u32 m0, s17, 0x24000
    s_nop 0
    buffer_load_dwordx4 v5, s[8:11], s22 offen sc1 lds
    s_waitcnt lgkmcnt(4)
    v_mfma_f32_16x16x32_bf16 v[60:63], v[88:91], v[212:215], v[60:63]
    v_mfma_f32_16x16x32_bf16 v[64:67], v[88:91], v[216:219], v[64:67]
    s_add_u32 s22, s17, 0x14400
    s_add_u32 m0, s17, 0x24400
    s_nop 0
    buffer_load_dwordx4 v5, s[8:11], s22 offen sc1 lds
    s_waitcnt lgkmcnt(2)
    v_mfma_f32_16x16x32_bf16 v[68:71], v[92:95], v[212:215], v[68:71]
    v_mfma_f32_16x16x32_bf16 v[72:75], v[92:95], v[216:219], v[72:75]
    s_add_u32 s22, s17, 0x14800
    s_add_u32 m0, s17, 0x24800
    s_nop 0
    buffer_load_dwordx4 v5, s[8:11], s22 offen sc1 lds
    s_waitcnt lgkmcnt(0)
    v_mfma_f32_16x16x32_bf16 v[76:79], v[96:99], v[212:215], v[76:79]
    v_mfma_f32_16x16x32_bf16 v[80:83], v[96:99], v[216:219], v[80:83]
    s_add_u32 s22, s17, 0x14c00
    s_add_u32 m0, s17, 0x24c00
    s_nop 0
    buffer_load_dwordx4 v5, s[8:11], s22 offen sc1 lds
    s_mov_b32 s24, 0x3e0293ee
    v_mul_f32 v9, s24, v20
    v_mul_f32 v10, s24, v21
    v_cvt_pk_bf16_f32 v108, v9, v10
    v_mul_f32 v11, s24, v22
    v_mul_f32 v12, s24, v23
    v_cvt_pk_bf16_f32 v109, v11, v12
    v_mul_f32 v9, s24, v24
    v_mul_f32 v10, s24, v25
    v_cvt_pk_bf16_f32 v124, v9, v10
    v_mul_f32 v11, s24, v26
    v_mul_f32 v12, s24, v27
    v_cvt_pk_bf16_f32 v125, v11, v12
    v_mul_f32 v9, s24, v28
    v_mul_f32 v10, s24, v29
    v_cvt_pk_bf16_f32 v110, v9, v10
    v_mul_f32 v11, s24, v30
    v_mul_f32 v12, s24, v31
    v_cvt_pk_bf16_f32 v111, v11, v12
    v_mul_f32 v9, s24, v32
    v_mul_f32 v10, s24, v33
    v_cvt_pk_bf16_f32 v126, v9, v10
    v_mul_f32 v11, s24, v34
    v_mul_f32 v12, s24, v35
    v_cvt_pk_bf16_f32 v127, v11, v12
    v_mul_f32 v9, s24, v36
    v_mul_f32 v10, s24, v37
    v_cvt_pk_bf16_f32 v112, v9, v10
    v_mul_f32 v11, s24, v38
    v_mul_f32 v12, s24, v39
    v_cvt_pk_bf16_f32 v113, v11, v12
    v_mul_f32 v9, s24, v40
    v_mul_f32 v10, s24, v41
    v_cvt_pk_bf16_f32 v128, v9, v10
    v_mul_f32 v11, s24, v42
    v_mul_f32 v12, s24, v43
    v_cvt_pk_bf16_f32 v129, v11, v12
    v_mul_f32 v9, s24, v44
    v_mul_f32 v10, s24, v45
    v_cvt_pk_bf16_f32 v114, v9, v10
    v_mul_f32 v11, s24, v46
    v_mul_f32 v12, s24, v47
    v_cvt_pk_bf16_f32 v115, v11, v12
    v_mul_f32 v9, s24, v48
    v_mul_f32 v10, s24, v49
    v_cvt_pk_bf16_f32 v130, v9, v10
    v_mul_f32 v11, s24, v50
    v_mul_f32 v12, s24, v51
    v_cvt_pk_bf16_f32 v131, v11, v12
    v_mul_f32 v9, s24, v52
    v_mul_f32 v10, s24, v53
    v_cvt_pk_bf16_f32 v116, v9, v10
    v_mul_f32 v11, s24, v54
    v_mul_f32 v12, s24, v55
    v_cvt_pk_bf16_f32 v117, v11, v12
    v_mul_f32 v9, s24, v56
    v_mul_f32 v10, s24, v57
    v_cvt_pk_bf16_f32 v132, v9, v10
    v_mul_f32 v11, s24, v58
    v_mul_f32 v12, s24, v59
    v_cvt_pk_bf16_f32 v133, v11, v12
    v_mul_f32 v9, s24, v60
    v_mul_f32 v10, s24, v61
    v_cvt_pk_bf16_f32 v118, v9, v10
    v_mul_f32 v11, s24, v62
    v_mul_f32 v12, s24, v63
    v_cvt_pk_bf16_f32 v119, v11, v12
    v_mul_f32 v9, s24, v64
    v_mul_f32 v10, s24, v65
    v_cvt_pk_bf16_f32 v134, v9, v10
    v_mul_f32 v11, s24, v66
    v_mul_f32 v12, s24, v67
    v_cvt_pk_bf16_f32 v135, v11, v12
    v_mul_f32 v9, s24, v68
    v_mul_f32 v10, s24, v69
    v_cvt_pk_bf16_f32 v120, v9, v10
    v_mul_f32 v11, s24, v70
    v_mul_f32 v12, s24, v71
    v_cvt_pk_bf16_f32 v121, v11, v12
    v_mul_f32 v9, s24, v72
    v_mul_f32 v10, s24, v73
    v_cvt_pk_bf16_f32 v136, v9, v10
    v_mul_f32 v11, s24, v74
    v_mul_f32 v12, s24, v75
    v_cvt_pk_bf16_f32 v137, v11, v12
    v_mul_f32 v9, s24, v76
    v_mul_f32 v10, s24, v77
    v_cvt_pk_bf16_f32 v122, v9, v10
    v_mul_f32 v11, s24, v78
    v_mul_f32 v12, s24, v79
    v_cvt_pk_bf16_f32 v123, v11, v12
    v_mul_f32 v9, s24, v80
    v_mul_f32 v10, s24, v81
    v_cvt_pk_bf16_f32 v138, v9, v10
    v_mul_f32 v11, s24, v82
    v_mul_f32 v12, s24, v83
    v_cvt_pk_bf16_f32 v139, v11, v12
    v_add_u32 v2, 0x10000, v1
    v_add_u32 v3, 0x20000, v1
    s_and_b32 s62, s12, 24
    s_and_b32 s19, s12, 7
    s_lshl_b32 s20, s19, 2
    s_lshr_b32 s20, 0x54732160, s20
    s_and_b32 s20, s20, 7
    s_lshl_b32 s20, s20, 2
    s_bfm_b32 s21, s20, 0
    s_and_b32 s22, s21, 0x51764320
    s_lshl_b32 s22, s22, 4
    s_lshl_b32 s21, s21, 4
    s_or_b32 s21, s21, 15
    s_andn2_b32 s21, 0x51764320, s21
    s_or_b32 s42, s21, s22
    s_or_b32 s42, s42, s19
    s_add_u32 s19, s12, 1
    s_and_b32 s19, s19, 7
    s_lshl_b32 s19, s19, 8
    s_add_u32 s4, s40, s19
    s_addc_u32 s5, s41, 0
    s_sub_u32 s6, 0x800000, s19
    s_mov_b32 s7, 0x20000
    s_lshl_b32 s16, s3, 15
    v_bfe_u32 v9, v0, 2, 2
    v_lshrrev_b32 v10, 4, v0
    v_and_b32 v11, 3, v0
    v_lshlrev_b32 v17, 6, v10
    v_lshl_add_u32 v17, v11, 4, v17
    v_lshl_add_u32 v17, v9, 11, v17
    v_xor_b32 v18, 32, v17
    s_waitcnt vmcnt(20)
    s_barrier
    ds_read_b128 v[84:87], v2 offset:0
    ds_read_b128 v[88:91], v2 offset:1024
    ds_read_b128 v[92:95], v2 offset:2048
    ds_read_b128 v[96:99], v2 offset:3072
    s_waitcnt lgkmcnt(3)
    v_mfma_f32_16x16x32_bf16 v[140:143], v[84:87], v[108:111], 0
    v_mfma_f32_16x16x32_bf16 v[144:147], v[84:87], v[124:127], 0
    ds_read_b128 v[100:103], v2 offset:4096
    s_waitcnt lgkmcnt(3)
    v_mfma_f32_16x16x32_bf16 v[148:151], v[88:91], v[108:111], 0
    v_mfma_f32_16x16x32_bf16 v[152:155], v[88:91], v[124:127], 0
    ds_read_b128 v[104:107], v2 offset:5120
    s_waitcnt lgkmcnt(3)
    v_mfma_f32_16x16x32_bf16 v[140:143], v[92:95], v[112:115], v[140:143]
    v_mfma_f32_16x16x32_bf16 v[144:147], v[92:95], v[128:131], v[144:147]
    ds_read_b128 v[84:87], v2 offset:6144
    s_waitcnt lgkmcnt(3)
    v_mfma_f32_16x16x32_bf16 v[148:151], v[96:99], v[112:115], v[148:151]
    v_mfma_f32_16x16x32_bf16 v[152:155], v[96:99], v[128:131], v[152:155]
    ds_read_b128 v[88:91], v2 offset:7168
    s_waitcnt lgkmcnt(3)
    v_mfma_f32_16x16x32_bf16 v[140:143], v[100:103], v[116:119], v[140:143]
    v_mfma_f32_16x16x32_bf16 v[144:147], v[100:103], v[132:135], v[144:147]
    s_waitcnt vmcnt(8)
    s_barrier
    ds_read_b128 v[92:95], v2 offset:16384
    s_waitcnt lgkmcnt(3)
    v_mfma_f32_16x16x32_bf16 v[148:151], v[104:107], v[116:119], v[148:151]
    v_mfma_f32_16x16x32_bf16 v[152:155], v[104:107], v[132:135], v[152:155]
    ds_read_b128 v[96:99], v2 offset:17408
    s_waitcnt lgkmcnt(3)
    v_mfma_f32_16x16x32_bf16 v[140:143], v[84:87], v[120:123], v[140:143]
    v_mfma_f32_16x16x32_bf16 v[144:147], v[84:87], v[136:139], v[144:147]
    ds_read_b128 v[100:103], v2 offset:18432
    s_waitcnt lgkmcnt(3)
    v_mfma_f32_16x16x32_bf16 v[148:151], v[88:91], v[120:123], v[148:151]
    v_mfma_f32_16x16x32_bf16 v[152:155], v[88:91], v[136:139], v[152:155]
    ds_read_b128 v[104:107], v2 offset:19456
    s_waitcnt lgkmcnt(3)
    v_mfma_f32_16x16x32_bf16 v[156:159], v[92:95], v[108:111], 0
    v_mfma_f32_16x16x32_bf16 v[160:163], v[92:95], v[124:127], 0
    ds_read_b128 v[84:87], v2 offset:20480
    s_waitcnt lgkmcnt(3)
    v_mfma_f32_16x16x32_bf16 v[164:167], v[96:99], v[108:111], 0
    v_mfma_f32_16x16x32_bf16 v[168:171], v[96:99], v[124:127], 0
    ds_read_b128 v[88:91], v2 offset:21504
    s_waitcnt lgkmcnt(3)
    v_mfma_f32_16x16x32_bf16 v[156:159], v[100:103], v[112:115], v[156:159]
    v_mfma_f32_16x16x32_bf16 v[160:163], v[100:103], v[128:131], v[160:163]
    ds_read_b128 v[92:95], v2 offset:22528
    s_waitcnt lgkmcnt(3)
    v_mfma_f32_16x16x32_bf16 v[164:167], v[104:107], v[112:115], v[164:167]
    v_max3_f32 v9, v140, v141, v142
    v_mfma_f32_16x16x32_bf16 v[168:171], v[104:107], v[128:131], v[168:171]
    ds_read_b128 v[96:99], v2 offset:23552
    v_max3_f32 v9, v9, v143, v148
    s_waitcnt lgkmcnt(3)
    v_mfma_f32_16x16x32_bf16 v[156:159], v[84:87], v[116:119], v[156:159]
    v_max3_f32 v9, v9, v149, v150
    v_mfma_f32_16x16x32_bf16 v[160:163], v[84:87], v[132:135], v[160:163]
    s_barrier
    s_setprio 3
    ds_read_b128 v[100:103], v2 offset:32768
    v_max_f32 v9, v9, v151
    s_waitcnt lgkmcnt(3)
    v_mfma_f32_16x16x32_bf16 v[164:167], v[88:91], v[116:119], v[164:167]
    v_max3_f32 v10, v144, v145, v146
    v_mfma_f32_16x16x32_bf16 v[168:171], v[88:91], v[132:135], v[168:171]
    ds_read_b128 v[104:107], v2 offset:33792
    v_max3_f32 v10, v10, v147, v152
    s_waitcnt lgkmcnt(3)
    v_mfma_f32_16x16x32_bf16 v[156:159], v[92:95], v[120:123], v[156:159]
    v_max3_f32 v10, v10, v153, v154
    v_mfma_f32_16x16x32_bf16 v[160:163], v[92:95], v[136:139], v[160:163]
    ds_read_b128 v[84:87], v2 offset:34816
    v_max_f32 v10, v10, v155
    s_waitcnt lgkmcnt(3)
    v_mfma_f32_16x16x32_bf16 v[164:167], v[96:99], v[120:123], v[164:167]
    v_mfma_f32_16x16x32_bf16 v[168:171], v[96:99], v[136:139], v[168:171]
    ds_read_b128 v[88:91], v2 offset:35840
    v_max3_f32 v9, v9, v156, v157
    v_max3_f32 v9, v9, v158, v159
    s_nop 3
    v_max3_f32 v9, v9, v164, v165
    v_max3_f32 v9, v9, v166, v167
    v_max3_f32 v10, v10, v160, v161
    v_max3_f32 v10, v10, v162, v163
    v_max3_f32 v10, v10, v168, v169
    v_max3_f32 v10, v10, v170, v171
    v_mov_b32 v11, v9
    v_mov_b32 v12, v10
    s_nop 0
    v_permlane16_swap_b32 v9, v11
    v_permlane16_swap_b32 v10, v12
    v_max_f32 v9, v9, v11
    v_max_f32 v10, v10, v12
    v_mov_b32 v11, v9
    v_mov_b32 v12, v10
    s_nop 0
    v_permlane32_swap_b32 v9, v11
    v_permlane32_swap_b32 v10, v12
    v_max_f32 v9, v9, v11
    v_max_f32 v10, v10, v12
    v_sub_f32 v172, 0, v9
    v_sub_f32 v173, 0, v9
    v_sub_f32 v174, 0, v9
    v_sub_f32 v175, 0, v9
    v_sub_f32 v176, 0, v10
    v_sub_f32 v177, 0, v10
    v_sub_f32 v178, 0, v10
    v_sub_f32 v179, 0, v10
    v_add_f32 v140, v140, v172
    v_add_f32 v141, v141, v172
    v_exp_f32 v140, v140
    v_exp_f32 v141, v141
    s_nop 0
    v_add_f32 v15, v140, v141
    v_cvt_pk_bf16_f32 v188, v140, v141
    v_add_f32 v142, v142, v172
    v_add_f32 v143, v143, v172
    v_exp_f32 v142, v142
    v_exp_f32 v143, v143
    v_add_f32 v15, v15, v142
    v_add_f32 v15, v15, v143
    v_cvt_pk_bf16_f32 v189, v142, v143
    v_add_f32 v144, v144, v176
    v_add_f32 v145, v145, v176
    v_exp_f32 v144, v144
    v_exp_f32 v145, v145
    s_nop 0
    v_add_f32 v16, v144, v145
    v_cvt_pk_bf16_f32 v192, v144, v145
    v_add_f32 v146, v146, v176
    v_add_f32 v147, v147, v176
    v_exp_f32 v146, v146
    v_exp_f32 v147, v147
    v_add_f32 v16, v16, v146
    v_add_f32 v16, v16, v147
    v_cvt_pk_bf16_f32 v193, v146, v147
    v_add_f32 v148, v148, v172
    v_add_f32 v149, v149, v172
    v_exp_f32 v148, v148
    v_exp_f32 v149, v149
    v_add_f32 v15, v15, v148
    v_add_f32 v15, v15, v149
    v_cvt_pk_bf16_f32 v190, v148, v149
    v_add_f32 v150, v150, v172
    v_add_f32 v151, v151, v172
    v_exp_f32 v150, v150
    v_exp_f32 v151, v151
    v_add_f32 v15, v15, v150
    v_add_f32 v15, v15, v151
    v_cvt_pk_bf16_f32 v191, v150, v151
    v_add_f32 v152, v152, v176
    v_add_f32 v153, v153, v176
    v_exp_f32 v152, v152
    v_exp_f32 v153, v153
    v_add_f32 v16, v16, v152
    v_add_f32 v16, v16, v153
    v_cvt_pk_bf16_f32 v194, v152, v153
    v_add_f32 v154, v154, v176
    v_add_f32 v155, v155, v176
    v_exp_f32 v154, v154
    v_exp_f32 v155, v155
    v_add_f32 v16, v16, v154
    v_add_f32 v16, v16, v155
    v_cvt_pk_bf16_f32 v195, v154, v155
    s_waitcnt lgkmcnt(3)
    v_mfma_f32_16x16x32_bf16 v[140:143], v[100:103], v[108:111], v[172:175]
    v_add_f32 v156, v156, v172
    v_add_f32 v157, v157, v172
    v_mfma_f32_16x16x32_bf16 v[144:147], v[100:103], v[124:127], v[176:179]
    ds_read_b128 v[92:95], v2 offset:36864
    v_exp_f32 v156, v156
    v_exp_f32 v157, v157
    s_waitcnt lgkmcnt(3)
    v_mfma_f32_16x16x32_bf16 v[148:151], v[104:107], v[108:111], v[172:175]
    v_add_f32 v15, v15, v156
    v_add_f32 v15, v15, v157
    v_mfma_f32_16x16x32_bf16 v[152:155], v[104:107], v[124:127], v[176:179]
    ds_read_b128 v[96:99], v2 offset:37888
    v_cvt_pk_bf16_f32 v196, v156, v157
    s_waitcnt lgkmcnt(3)
    v_mfma_f32_16x16x32_bf16 v[140:143], v[84:87], v[112:115], v[140:143]
    v_add_f32 v158, v158, v172
    v_add_f32 v159, v159, v172
    v_mfma_f32_16x16x32_bf16 v[144:147], v[84:87], v[128:131], v[144:147]
    ds_read_b128 v[100:103], v2 offset:38912
    v_exp_f32 v158, v158
    v_exp_f32 v159, v159
    s_waitcnt lgkmcnt(3)
    v_mfma_f32_16x16x32_bf16 v[148:151], v[88:91], v[112:115], v[148:151]
    v_add_f32 v15, v15, v158
    v_add_f32 v15, v15, v159
    v_mfma_f32_16x16x32_bf16 v[152:155], v[88:91], v[128:131], v[152:155]
    ds_read_b128 v[104:107], v2 offset:39936
    v_cvt_pk_bf16_f32 v197, v158, v159
    v_lshrrev_b32 v6, 3, v8
    v_and_b32 v7, 7, v8
    s_mov_b64 s[64:65], s[50:51]
    s_mov_b32 s66, 0x700000
    s_mov_b32 s67, 0x20000
    v_mul_u32_u24 v19, 14336, v6
    v_lshl_add_u32 v19, v7, 4, v19
    s_and_b32 s24, s2, 7
    s_lshl_b32 s24, s24, 1
    s_lshr_b32 s26, s2, 7
    s_add_u32 s24, s24, s26
    s_mul_i32 s24, s24, 458752
    s_bfe_u32 s25, s2, 0x40003
    s_lshl_b32 s25, s25, 7
    s_add_u32 s24, s24, s25
    s_waitcnt lgkmcnt(3)
    v_mfma_f32_16x16x32_bf16 v[140:143], v[92:95], v[116:119], v[140:143]
    v_add_f32 v160, v160, v176
    v_add_f32 v161, v161, v176
    v_mfma_f32_16x16x32_bf16 v[144:147], v[92:95], v[132:135], v[144:147]
    ds_read_b128 v[84:87], v2 offset:8192
    v_exp_f32 v160, v160
    v_exp_f32 v161, v161
    s_add_u32 s25, s24, 0
    buffer_load_dwordx4 v[204:207], v19, s[64:67], s25 offen
    s_waitcnt lgkmcnt(3)
    v_mfma_f32_16x16x32_bf16 v[148:151], v[96:99], v[116:119], v[148:151]
    v_add_f32 v16, v16, v160
    v_add_f32 v16, v16, v161
    v_mfma_f32_16x16x32_bf16 v[152:155], v[96:99], v[132:135], v[152:155]
    ds_read_b128 v[88:91], v2 offset:9216
    v_cvt_pk_bf16_f32 v200, v160, v161
    s_waitcnt lgkmcnt(3)
    v_mfma_f32_16x16x32_bf16 v[140:143], v[100:103], v[120:123], v[140:143]
    v_add_f32 v162, v162, v176
    v_add_f32 v163, v163, v176
    v_mfma_f32_16x16x32_bf16 v[144:147], v[100:103], v[136:139], v[144:147]
    ds_read_b128 v[92:95], v2 offset:10240
    v_exp_f32 v162, v162
    v_exp_f32 v163, v163
    s_waitcnt lgkmcnt(3)
    v_mfma_f32_16x16x32_bf16 v[148:151], v[104:107], v[120:123], v[148:151]
    v_add_f32 v16, v16, v162
    v_add_f32 v16, v16, v163
    v_mfma_f32_16x16x32_bf16 v[152:155], v[104:107], v[136:139], v[152:155]
    ds_read_b128 v[96:99], v2 offset:11264
    v_cvt_pk_bf16_f32 v201, v162, v163
    s_waitcnt lgkmcnt(3)
    v_mfma_f32_16x16x32_bf16 v[20:23], v[84:87], v[188:191], 0
    v_add_f32 v164, v164, v172
    v_add_f32 v165, v165, v172
    v_mfma_f32_16x16x32_bf16 v[24:27], v[84:87], v[192:195], 0
    ds_read_b128 v[100:103], v2 offset:12288
    v_exp_f32 v164, v164
    v_exp_f32 v165, v165
    s_waitcnt lgkmcnt(3)
    v_mfma_f32_16x16x32_bf16 v[28:31], v[88:91], v[188:191], 0
    v_add_f32 v15, v15, v164
    v_add_f32 v15, v15, v165
    v_mfma_f32_16x16x32_bf16 v[32:35], v[88:91], v[192:195], 0
    ds_read_b128 v[104:107], v2 offset:13312
    v_cvt_pk_bf16_f32 v198, v164, v165
    s_add_u32 s25, s24, 2048
    buffer_load_dwordx4 v[208:211], v19, s[64:67], s25 offen
    s_waitcnt lgkmcnt(3)
    v_mfma_f32_16x16x32_bf16 v[36:39], v[92:95], v[188:191], 0
    v_add_f32 v166, v166, v172
    v_add_f32 v167, v167, v172
    v_mfma_f32_16x16x32_bf16 v[40:43], v[92:95], v[192:195], 0
    ds_read_b128 v[84:87], v2 offset:14336
    v_exp_f32 v166, v166
    v_exp_f32 v167, v167
    s_waitcnt lgkmcnt(3)
    v_mfma_f32_16x16x32_bf16 v[44:47], v[96:99], v[188:191], 0
    v_add_f32 v15, v15, v166
    v_add_f32 v15, v15, v167
    v_mfma_f32_16x16x32_bf16 v[48:51], v[96:99], v[192:195], 0
    ds_read_b128 v[88:91], v2 offset:15360
    v_cvt_pk_bf16_f32 v199, v166, v167
    s_waitcnt lgkmcnt(3)
    v_mfma_f32_16x16x32_bf16 v[52:55], v[100:103], v[188:191], 0
    v_add_f32 v168, v168, v176
    v_add_f32 v169, v169, v176
    v_mfma_f32_16x16x32_bf16 v[56:59], v[100:103], v[192:195], 0
    s_barrier
    ds_read_b128 v[92:95], v2 offset:49152
    v_exp_f32 v168, v168
    v_exp_f32 v169, v169
    s_waitcnt lgkmcnt(3)
    v_mfma_f32_16x16x32_bf16 v[60:63], v[104:107], v[188:191], 0
    v_add_f32 v16, v16, v168
    v_add_f32 v16, v16, v169
    v_mfma_f32_16x16x32_bf16 v[64:67], v[104:107], v[192:195], 0
    ds_read_b128 v[96:99], v2 offset:50176
    v_cvt_pk_bf16_f32 v202, v168, v169
    s_waitcnt lgkmcnt(3)
    v_mfma_f32_16x16x32_bf16 v[68:71], v[84:87], v[188:191], 0
    v_add_f32 v170, v170, v176
    v_add_f32 v171, v171, v176
    v_mfma_f32_16x16x32_bf16 v[72:75], v[84:87], v[192:195], 0
    ds_read_b128 v[100:103], v2 offset:51200
    v_exp_f32 v170, v170
    v_exp_f32 v171, v171
    s_waitcnt lgkmcnt(3)
    v_mfma_f32_16x16x32_bf16 v[76:79], v[88:91], v[188:191], 0
    v_add_f32 v16, v16, v170
    v_add_f32 v16, v16, v171
    v_mfma_f32_16x16x32_bf16 v[80:83], v[88:91], v[192:195], 0
    ds_read_b128 v[104:107], v2 offset:52224
    v_cvt_pk_bf16_f32 v203, v170, v171
    s_add_u32 s25, s24, 4096
    buffer_load_dwordx4 v[212:215], v19, s[64:67], s25 offen
    s_waitcnt lgkmcnt(3)
    v_mfma_f32_16x16x32_bf16 v[156:159], v[92:95], v[108:111], v[172:175]
    v_exp_f32 v140, v140
    v_exp_f32 v141, v141
    v_mfma_f32_16x16x32_bf16 v[160:163], v[92:95], v[124:127], v[176:179]
    ds_read_b128 v[84:87], v2 offset:53248
    v_add_f32 v15, v15, v140
    s_waitcnt lgkmcnt(3)
    v_mfma_f32_16x16x32_bf16 v[164:167], v[96:99], v[108:111], v[172:175]
    v_add_f32 v15, v15, v141
    v_mfma_f32_16x16x32_bf16 v[168:171], v[96:99], v[124:127], v[176:179]
    ds_read_b128 v[88:91], v2 offset:54272
    v_cvt_pk_bf16_f32 v188, v140, v141
    s_waitcnt lgkmcnt(3)
    v_mfma_f32_16x16x32_bf16 v[156:159], v[100:103], v[112:115], v[156:159]
    v_exp_f32 v142, v142
    v_exp_f32 v143, v143
    v_mfma_f32_16x16x32_bf16 v[160:163], v[100:103], v[128:131], v[160:163]
    ds_read_b128 v[92:95], v2 offset:55296
    v_add_f32 v15, v15, v142
    s_waitcnt lgkmcnt(3)
    v_mfma_f32_16x16x32_bf16 v[164:167], v[104:107], v[112:115], v[164:167]
    v_add_f32 v15, v15, v143
    v_mfma_f32_16x16x32_bf16 v[168:171], v[104:107], v[128:131], v[168:171]
    ds_read_b128 v[96:99], v2 offset:56320
    v_cvt_pk_bf16_f32 v189, v142, v143
    s_waitcnt lgkmcnt(3)
    v_mfma_f32_16x16x32_bf16 v[156:159], v[84:87], v[116:119], v[156:159]
    v_exp_f32 v144, v144
    v_exp_f32 v145, v145
    v_mfma_f32_16x16x32_bf16 v[160:163], v[84:87], v[132:135], v[160:163]
    ds_read_b128 v[100:103], v2 offset:24576
    v_add_f32 v16, v16, v144
    s_waitcnt lgkmcnt(3)
    v_mfma_f32_16x16x32_bf16 v[164:167], v[88:91], v[116:119], v[164:167]
    v_add_f32 v16, v16, v145
    v_mfma_f32_16x16x32_bf16 v[168:171], v[88:91], v[132:135], v[168:171]
    ds_read_b128 v[104:107], v2 offset:25600
    v_cvt_pk_bf16_f32 v192, v144, v145
    s_add_u32 s25, s24, 6144
    buffer_load_dwordx4 v[216:219], v19, s[64:67], s25 offen
    s_waitcnt lgkmcnt(3)
    v_mfma_f32_16x16x32_bf16 v[156:159], v[92:95], v[120:123], v[156:159]
    v_exp_f32 v146, v146
    v_exp_f32 v147, v147
    v_mfma_f32_16x16x32_bf16 v[160:163], v[92:95], v[136:139], v[160:163]
    ds_read_b128 v[84:87], v2 offset:26624
    v_add_f32 v16, v16, v146
    s_waitcnt lgkmcnt(3)
    v_mfma_f32_16x16x32_bf16 v[164:167], v[96:99], v[120:123], v[164:167]
    v_add_f32 v16, v16, v147
    v_mfma_f32_16x16x32_bf16 v[168:171], v[96:99], v[136:139], v[168:171]
    ds_read_b128 v[88:91], v2 offset:27648
    v_cvt_pk_bf16_f32 v193, v146, v147
    s_waitcnt lgkmcnt(3)
    v_mfma_f32_16x16x32_bf16 v[20:23], v[100:103], v[196:199], v[20:23]
    v_exp_f32 v148, v148
    v_exp_f32 v149, v149
    v_mfma_f32_16x16x32_bf16 v[24:27], v[100:103], v[200:203], v[24:27]
    ds_read_b128 v[92:95], v2 offset:28672
    v_add_f32 v15, v15, v148
    s_waitcnt lgkmcnt(3)
    v_mfma_f32_16x16x32_bf16 v[28:31], v[104:107], v[196:199], v[28:31]
    v_add_f32 v15, v15, v149
    v_mfma_f32_16x16x32_bf16 v[32:35], v[104:107], v[200:203], v[32:35]
    ds_read_b128 v[96:99], v2 offset:29696
    v_cvt_pk_bf16_f32 v190, v148, v149
    s_waitcnt lgkmcnt(3)
    v_mfma_f32_16x16x32_bf16 v[36:39], v[84:87], v[196:199], v[36:39]
    v_exp_f32 v150, v150
    v_exp_f32 v151, v151
    v_mfma_f32_16x16x32_bf16 v[40:43], v[84:87], v[200:203], v[40:43]
    ds_read_b128 v[100:103], v2 offset:30720
    v_add_f32 v15, v15, v150
    s_add_u32 s25, s24, 8192
    buffer_load_dwordx4 v[220:223], v19, s[64:67], s25 offen
    s_waitcnt lgkmcnt(3)
    v_mfma_f32_16x16x32_bf16 v[44:47], v[88:91], v[196:199], v[44:47]
    v_add_f32 v15, v15, v151
    v_mfma_f32_16x16x32_bf16 v[48:51], v[88:91], v[200:203], v[48:51]
    ds_read_b128 v[104:107], v2 offset:31744
    v_cvt_pk_bf16_f32 v191, v150, v151
    s_waitcnt lgkmcnt(3)
    v_mfma_f32_16x16x32_bf16 v[52:55], v[92:95], v[196:199], v[52:55]
    v_exp_f32 v152, v152
    v_exp_f32 v153, v153
    v_mfma_f32_16x16x32_bf16 v[56:59], v[92:95], v[200:203], v[56:59]
    s_waitcnt vmcnt(9)
    s_barrier
    ds_read_b128 v[84:87], v3 offset:0
    v_add_f32 v16, v16, v152
    s_waitcnt lgkmcnt(3)
    v_mfma_f32_16x16x32_bf16 v[60:63], v[96:99], v[196:199], v[60:63]
    v_add_f32 v16, v16, v153
    v_mfma_f32_16x16x32_bf16 v[64:67], v[96:99], v[200:203], v[64:67]
    s_add_u32 s22, s17, 0x18000
    s_add_u32 m0, s17, 0x10000
    s_nop 0
    buffer_load_dwordx4 v5, s[8:11], s22 offen sc1 lds
    ds_read_b128 v[88:91], v3 offset:1024
    v_cvt_pk_bf16_f32 v194, v152, v153
    s_waitcnt lgkmcnt(3)
    v_mfma_f32_16x16x32_bf16 v[68:71], v[100:103], v[196:199], v[68:71]
    v_exp_f32 v154, v154
    v_exp_f32 v155, v155
    v_mfma_f32_16x16x32_bf16 v[72:75], v[100:103], v[200:203], v[72:75]
    ds_read_b128 v[92:95], v3 offset:2048
    v_add_f32 v16, v16, v154
    s_waitcnt lgkmcnt(3)
    v_mfma_f32_16x16x32_bf16 v[76:79], v[104:107], v[196:199], v[76:79]
    v_add_f32 v16, v16, v155
    v_mfma_f32_16x16x32_bf16 v[80:83], v[104:107], v[200:203], v[80:83]
    s_add_u32 s22, s17, 0x18400
    s_add_u32 m0, s17, 0x10400
    s_nop 0
    buffer_load_dwordx4 v5, s[8:11], s22 offen sc1 lds
    ds_read_b128 v[96:99], v3 offset:3072
    v_cvt_pk_bf16_f32 v195, v154, v155
    s_waitcnt lgkmcnt(3)
    v_mfma_f32_16x16x32_bf16 v[140:143], v[84:87], v[108:111], v[172:175]
    v_exp_f32 v156, v156
    v_exp_f32 v157, v157
    v_mfma_f32_16x16x32_bf16 v[144:147], v[84:87], v[124:127], v[176:179]
    ds_read_b128 v[100:103], v3 offset:4096
    v_add_f32 v15, v15, v156
    s_add_u32 s25, s24, 10240
    buffer_load_dwordx4 v[224:227], v19, s[64:67], s25 offen
    s_waitcnt lgkmcnt(3)
    v_mfma_f32_16x16x32_bf16 v[148:151], v[88:91], v[108:111], v[172:175]
    v_add_f32 v15, v15, v157
    v_mfma_f32_16x16x32_bf16 v[152:155], v[88:91], v[124:127], v[176:179]
    s_add_u32 s22, s17, 0x18800
    s_add_u32 m0, s17, 0x10800
    s_nop 0
    buffer_load_dwordx4 v5, s[8:11], s22 offen sc1 lds
    ds_read_b128 v[104:107], v3 offset:5120
    v_cvt_pk_bf16_f32 v196, v156, v157
    s_waitcnt lgkmcnt(3)
    v_mfma_f32_16x16x32_bf16 v[140:143], v[92:95], v[112:115], v[140:143]
    v_exp_f32 v158, v158
    v_exp_f32 v159, v159
    v_mfma_f32_16x16x32_bf16 v[144:147], v[92:95], v[128:131], v[144:147]
    ds_read_b128 v[84:87], v3 offset:6144
    v_add_f32 v15, v15, v158
    s_waitcnt lgkmcnt(3)
    v_mfma_f32_16x16x32_bf16 v[148:151], v[96:99], v[112:115], v[148:151]
    v_add_f32 v15, v15, v159
    v_mfma_f32_16x16x32_bf16 v[152:155], v[96:99], v[128:131], v[152:155]
    s_add_u32 s22, s17, 0x18c00
    s_add_u32 m0, s17, 0x10c00
    s_nop 0
    buffer_load_dwordx4 v5, s[8:11], s22 offen sc1 lds
    ds_read_b128 v[88:91], v3 offset:7168
    v_cvt_pk_bf16_f32 v197, v158, v159
    s_waitcnt lgkmcnt(3)
    v_mfma_f32_16x16x32_bf16 v[140:143], v[100:103], v[116:119], v[140:143]
    v_exp_f32 v160, v160
    v_exp_f32 v161, v161
    v_mfma_f32_16x16x32_bf16 v[144:147], v[100:103], v[132:135], v[144:147]
    ds_read_b128 v[92:95], v2 offset:40960
    v_add_f32 v16, v16, v160
    s_waitcnt lgkmcnt(3)
    v_mfma_f32_16x16x32_bf16 v[148:151], v[104:107], v[116:119], v[148:151]
    v_add_f32 v16, v16, v161
    v_mfma_f32_16x16x32_bf16 v[152:155], v[104:107], v[132:135], v[152:155]
    ds_read_b128 v[96:99], v2 offset:41984
    v_cvt_pk_bf16_f32 v200, v160, v161
    s_waitcnt lgkmcnt(3)
    v_mfma_f32_16x16x32_bf16 v[140:143], v[84:87], v[120:123], v[140:143]
    v_exp_f32 v162, v162
    v_exp_f32 v163, v163
    v_mfma_f32_16x16x32_bf16 v[144:147], v[84:87], v[136:139], v[144:147]
    ds_read_b128 v[100:103], v2 offset:43008
    v_add_f32 v16, v16, v162
    s_add_u32 s25, s24, 12288
    buffer_load_dwordx4 v[228:231], v19, s[64:67], s25 offen
    s_waitcnt lgkmcnt(3)
    v_mfma_f32_16x16x32_bf16 v[148:151], v[88:91], v[120:123], v[148:151]
    v_add_f32 v16, v16, v163
    v_mfma_f32_16x16x32_bf16 v[152:155], v[88:91], v[136:139], v[152:155]
    ds_read_b128 v[104:107], v2 offset:44032
    v_cvt_pk_bf16_f32 v201, v162, v163
    s_waitcnt lgkmcnt(3)
    v_mfma_f32_16x16x32_bf16 v[20:23], v[92:95], v[188:191], v[20:23]
    v_exp_f32 v164, v164
    v_exp_f32 v165, v165
    v_mfma_f32_16x16x32_bf16 v[24:27], v[92:95], v[192:195], v[24:27]
    ds_read_b128 v[84:87], v2 offset:45056
    v_add_f32 v15, v15, v164
    s_waitcnt lgkmcnt(3)
    v_mfma_f32_16x16x32_bf16 v[28:31], v[96:99], v[188:191], v[28:31]
    v_add_f32 v15, v15, v165
    v_mfma_f32_16x16x32_bf16 v[32:35], v[96:99], v[192:195], v[32:35]
    ds_read_b128 v[88:91], v2 offset:46080
    v_cvt_pk_bf16_f32 v198, v164, v165
    s_waitcnt lgkmcnt(3)
    v_mfma_f32_16x16x32_bf16 v[36:39], v[100:103], v[188:191], v[36:39]
    v_exp_f32 v166, v166
    v_exp_f32 v167, v167
    v_mfma_f32_16x16x32_bf16 v[40:43], v[100:103], v[192:195], v[40:43]
    ds_read_b128 v[92:95], v2 offset:47104
    v_add_f32 v15, v15, v166
    s_waitcnt lgkmcnt(3)
    v_mfma_f32_16x16x32_bf16 v[44:47], v[104:107], v[188:191], v[44:47]
    v_add_f32 v15, v15, v167
    v_mfma_f32_16x16x32_bf16 v[48:51], v[104:107], v[192:195], v[48:51]
    ds_read_b128 v[96:99], v2 offset:48128
    v_cvt_pk_bf16_f32 v199, v166, v167
    s_waitcnt lgkmcnt(3)
    v_mfma_f32_16x16x32_bf16 v[52:55], v[84:87], v[188:191], v[52:55]
    v_exp_f32 v168, v168
    v_exp_f32 v169, v169
    v_mfma_f32_16x16x32_bf16 v[56:59], v[84:87], v[192:195], v[56:59]
    s_waitcnt vmcnt(11)
    s_barrier
    ds_read_b128 v[100:103], v3 offset:16384
    v_add_f32 v16, v16, v168
    s_waitcnt lgkmcnt(3)
    v_mfma_f32_16x16x32_bf16 v[60:63], v[88:91], v[188:191], v[60:63]
    v_add_f32 v16, v16, v169
    v_mfma_f32_16x16x32_bf16 v[64:67], v[88:91], v[192:195], v[64:67]
    s_add_u32 s22, s17, 0x1c000
    s_add_u32 m0, s17, 0x14000
    s_nop 0
    buffer_load_dwordx4 v5, s[8:11], s22 offen sc1 lds
    ds_read_b128 v[104:107], v3 offset:17408
    v_cvt_pk_bf16_f32 v202, v168, v169
    s_waitcnt lgkmcnt(3)
    v_mfma_f32_16x16x32_bf16 v[68:71], v[92:95], v[188:191], v[68:71]
    v_exp_f32 v170, v170
    v_exp_f32 v171, v171
    v_mfma_f32_16x16x32_bf16 v[72:75], v[92:95], v[192:195], v[72:75]
    ds_read_b128 v[84:87], v3 offset:18432
    v_add_f32 v16, v16, v170
    s_waitcnt lgkmcnt(3)
    v_mfma_f32_16x16x32_bf16 v[76:79], v[96:99], v[188:191], v[76:79]
    v_add_f32 v16, v16, v171
    v_mfma_f32_16x16x32_bf16 v[80:83], v[96:99], v[192:195], v[80:83]
    s_add_u32 s22, s17, 0x1c400
    s_add_u32 m0, s17, 0x14400
    s_nop 0
    buffer_load_dwordx4 v5, s[8:11], s22 offen sc1 lds
    ds_read_b128 v[88:91], v3 offset:19456
    v_cvt_pk_bf16_f32 v203, v170, v171
    s_waitcnt lgkmcnt(3)
    v_mfma_f32_16x16x32_bf16 v[156:159], v[100:103], v[108:111], v[172:175]
    v_exp_f32 v140, v140
    v_exp_f32 v141, v141
    v_mfma_f32_16x16x32_bf16 v[160:163], v[100:103], v[124:127], v[176:179]
    ds_read_b128 v[92:95], v3 offset:20480
    v_add_f32 v15, v15, v140
    s_waitcnt lgkmcnt(3)
    v_mfma_f32_16x16x32_bf16 v[164:167], v[104:107], v[108:111], v[172:175]
    v_add_f32 v15, v15, v141
    v_mfma_f32_16x16x32_bf16 v[168:171], v[104:107], v[124:127], v[176:179]
    s_add_u32 s22, s17, 0x1c800
    s_add_u32 m0, s17, 0x14800
    s_nop 0
    buffer_load_dwordx4 v5, s[8:11], s22 offen sc1 lds
    ds_read_b128 v[96:99], v3 offset:21504
    v_cvt_pk_bf16_f32 v188, v140, v141
    s_waitcnt lgkmcnt(3)
    v_mfma_f32_16x16x32_bf16 v[156:159], v[84:87], v[112:115], v[156:159]
    v_exp_f32 v142, v142
    v_exp_f32 v143, v143
    v_mfma_f32_16x16x32_bf16 v[160:163], v[84:87], v[128:131], v[160:163]
    ds_read_b128 v[100:103], v3 offset:22528
    v_add_f32 v15, v15, v142
    s_waitcnt lgkmcnt(3)
    v_mfma_f32_16x16x32_bf16 v[164:167], v[88:91], v[112:115], v[164:167]
    v_add_f32 v15, v15, v143
    v_mfma_f32_16x16x32_bf16 v[168:171], v[88:91], v[128:131], v[168:171]
    s_add_u32 s22, s17, 0x1cc00
    s_add_u32 m0, s17, 0x14c00
    s_nop 0
    buffer_load_dwordx4 v5, s[8:11], s22 offen sc1 lds
    ds_read_b128 v[104:107], v3 offset:23552
    v_cvt_pk_bf16_f32 v189, v142, v143
    s_waitcnt lgkmcnt(3)
    v_mfma_f32_16x16x32_bf16 v[156:159], v[92:95], v[116:119], v[156:159]
    v_exp_f32 v144, v144
    v_exp_f32 v145, v145
    v_mfma_f32_16x16x32_bf16 v[160:163], v[92:95], v[132:135], v[160:163]
    ds_read_b128 v[84:87], v2 offset:57344
    v_add_f32 v16, v16, v144
    s_waitcnt lgkmcnt(3)
    v_mfma_f32_16x16x32_bf16 v[164:167], v[96:99], v[116:119], v[164:167]
    v_add_f32 v16, v16, v145
    v_mfma_f32_16x16x32_bf16 v[168:171], v[96:99], v[132:135], v[168:171]
    ds_read_b128 v[88:91], v2 offset:58368
    v_cvt_pk_bf16_f32 v192, v144, v145
    s_waitcnt lgkmcnt(3)
    v_mfma_f32_16x16x32_bf16 v[156:159], v[100:103], v[120:123], v[156:159]
    v_exp_f32 v146, v146
    v_exp_f32 v147, v147
    v_mfma_f32_16x16x32_bf16 v[160:163], v[100:103], v[136:139], v[160:163]
    ds_read_b128 v[92:95], v2 offset:59392
    v_add_f32 v16, v16, v146
    s_waitcnt lgkmcnt(3)
    v_mfma_f32_16x16x32_bf16 v[164:167], v[104:107], v[120:123], v[164:167]
    v_add_f32 v16, v16, v147
    v_mfma_f32_16x16x32_bf16 v[168:171], v[104:107], v[136:139], v[168:171]
    ds_read_b128 v[96:99], v2 offset:60416
    v_cvt_pk_bf16_f32 v193, v146, v147
    s_waitcnt lgkmcnt(3)
    v_mfma_f32_16x16x32_bf16 v[20:23], v[84:87], v[196:199], v[20:23]
    v_exp_f32 v148, v148
    v_exp_f32 v149, v149
    v_mfma_f32_16x16x32_bf16 v[24:27], v[84:87], v[200:203], v[24:27]
    ds_read_b128 v[100:103], v2 offset:61440
    v_add_f32 v15, v15, v148
    s_waitcnt lgkmcnt(3)
    v_mfma_f32_16x16x32_bf16 v[28:31], v[88:91], v[196:199], v[28:31]
    v_add_f32 v15, v15, v149
    v_mfma_f32_16x16x32_bf16 v[32:35], v[88:91], v[200:203], v[32:35]
    ds_read_b128 v[104:107], v2 offset:62464
    v_cvt_pk_bf16_f32 v190, v148, v149
    s_waitcnt lgkmcnt(3)
    v_mfma_f32_16x16x32_bf16 v[36:39], v[92:95], v[196:199], v[36:39]
    v_exp_f32 v150, v150
    v_exp_f32 v151, v151
    v_mfma_f32_16x16x32_bf16 v[40:43], v[92:95], v[200:203], v[40:43]
    ds_read_b128 v[84:87], v2 offset:63488
    v_add_f32 v15, v15, v150
    s_waitcnt lgkmcnt(3)
    v_mfma_f32_16x16x32_bf16 v[44:47], v[96:99], v[196:199], v[44:47]
    v_add_f32 v15, v15, v151
    v_mfma_f32_16x16x32_bf16 v[48:51], v[96:99], v[200:203], v[48:51]
    ds_read_b128 v[88:91], v2 offset:64512
    v_cvt_pk_bf16_f32 v191, v150, v151
    s_waitcnt lgkmcnt(3)
    v_mfma_f32_16x16x32_bf16 v[52:55], v[100:103], v[196:199], v[52:55]
    v_exp_f32 v152, v152
    v_exp_f32 v153, v153
    v_mfma_f32_16x16x32_bf16 v[56:59], v[100:103], v[200:203], v[56:59]
    s_waitcnt vmcnt(5)
    s_barrier
    ds_read_b128 v[92:95], v2 offset:0
    v_add_f32 v16, v16, v152
    s_waitcnt lgkmcnt(3)
    v_mfma_f32_16x16x32_bf16 v[60:63], v[104:107], v[196:199], v[60:63]
    v_add_f32 v16, v16, v153
    v_mfma_f32_16x16x32_bf16 v[64:67], v[104:107], v[200:203], v[64:67]
    s_add_u32 s22, s17, 0x20000
    s_add_u32 m0, s17, 0x18000
    s_nop 0
    buffer_load_dwordx4 v5, s[8:11], s22 offen sc1 lds
    ds_read_b128 v[96:99], v2 offset:1024
    v_cvt_pk_bf16_f32 v194, v152, v153
    s_waitcnt lgkmcnt(3)
    v_mfma_f32_16x16x32_bf16 v[68:71], v[84:87], v[196:199], v[68:71]
    v_exp_f32 v154, v154
    v_exp_f32 v155, v155
    v_mfma_f32_16x16x32_bf16 v[72:75], v[84:87], v[200:203], v[72:75]
    ds_read_b128 v[100:103], v2 offset:2048
    v_add_f32 v16, v16, v154
    s_waitcnt lgkmcnt(3)
    v_mfma_f32_16x16x32_bf16 v[76:79], v[88:91], v[196:199], v[76:79]
    v_add_f32 v16, v16, v155
    v_mfma_f32_16x16x32_bf16 v[80:83], v[88:91], v[200:203], v[80:83]
    s_add_u32 s22, s17, 0x20400
    s_add_u32 m0, s17, 0x18400
    s_nop 0
    buffer_load_dwordx4 v5, s[8:11], s22 offen sc1 lds
    ds_read_b128 v[104:107], v2 offset:3072
    v_cvt_pk_bf16_f32 v195, v154, v155
    s_waitcnt lgkmcnt(3)
    v_mfma_f32_16x16x32_bf16 v[140:143], v[92:95], v[108:111], v[172:175]
    v_exp_f32 v156, v156
    v_exp_f32 v157, v157
    v_mfma_f32_16x16x32_bf16 v[144:147], v[92:95], v[124:127], v[176:179]
    ds_read_b128 v[84:87], v2 offset:4096
    v_add_f32 v15, v15, v156
    s_waitcnt lgkmcnt(3)
    v_mfma_f32_16x16x32_bf16 v[148:151], v[96:99], v[108:111], v[172:175]
    v_add_f32 v15, v15, v157
    v_mfma_f32_16x16x32_bf16 v[152:155], v[96:99], v[124:127], v[176:179]
    s_add_u32 s22, s17, 0x20800
    s_add_u32 m0, s17, 0x18800
    s_nop 0
    buffer_load_dwordx4 v5, s[8:11], s22 offen sc1 lds
    ds_read_b128 v[88:91], v2 offset:5120
    v_cvt_pk_bf16_f32 v196, v156, v157
    s_waitcnt lgkmcnt(3)
    v_mfma_f32_16x16x32_bf16 v[140:143], v[100:103], v[112:115], v[140:143]
    v_exp_f32 v158, v158
    v_exp_f32 v159, v159
    v_mfma_f32_16x16x32_bf16 v[144:147], v[100:103], v[128:131], v[144:147]
    ds_read_b128 v[92:95], v2 offset:6144
    v_add_f32 v15, v15, v158
    s_waitcnt lgkmcnt(3)
    v_mfma_f32_16x16x32_bf16 v[148:151], v[104:107], v[112:115], v[148:151]
    v_add_f32 v15, v15, v159
    v_mfma_f32_16x16x32_bf16 v[152:155], v[104:107], v[128:131], v[152:155]
    s_add_u32 s22, s17, 0x20c00
    s_add_u32 m0, s17, 0x18c00
    s_nop 0
    buffer_load_dwordx4 v5, s[8:11], s22 offen sc1 lds
    ds_read_b128 v[96:99], v2 offset:7168
    v_cvt_pk_bf16_f32 v197, v158, v159
    s_waitcnt lgkmcnt(3)
    v_mfma_f32_16x16x32_bf16 v[140:143], v[84:87], v[116:119], v[140:143]
    v_exp_f32 v160, v160
    v_exp_f32 v161, v161
    v_mfma_f32_16x16x32_bf16 v[144:147], v[84:87], v[132:135], v[144:147]
    ds_read_b128 v[100:103], v3 offset:8192
    v_add_f32 v16, v16, v160
    s_waitcnt lgkmcnt(3)
    v_mfma_f32_16x16x32_bf16 v[148:151], v[88:91], v[116:119], v[148:151]
    v_add_f32 v16, v16, v161
    v_mfma_f32_16x16x32_bf16 v[152:155], v[88:91], v[132:135], v[152:155]
    ds_read_b128 v[104:107], v3 offset:9216
    v_cvt_pk_bf16_f32 v200, v160, v161
    s_waitcnt lgkmcnt(3)
    v_mfma_f32_16x16x32_bf16 v[140:143], v[92:95], v[120:123], v[140:143]
    v_exp_f32 v162, v162
    v_exp_f32 v163, v163
    v_mfma_f32_16x16x32_bf16 v[144:147], v[92:95], v[136:139], v[144:147]
    ds_read_b128 v[84:87], v3 offset:10240
    v_add_f32 v16, v16, v162
    s_waitcnt lgkmcnt(3)
    v_mfma_f32_16x16x32_bf16 v[148:151], v[96:99], v[120:123], v[148:151]
    v_add_f32 v16, v16, v163
    v_mfma_f32_16x16x32_bf16 v[152:155], v[96:99], v[136:139], v[152:155]
    ds_read_b128 v[88:91], v3 offset:11264
    v_cvt_pk_bf16_f32 v201, v162, v163
    s_waitcnt lgkmcnt(3)
    v_mfma_f32_16x16x32_bf16 v[20:23], v[100:103], v[188:191], v[20:23]
    v_exp_f32 v164, v164
    v_exp_f32 v165, v165
    v_mfma_f32_16x16x32_bf16 v[24:27], v[100:103], v[192:195], v[24:27]
    ds_read_b128 v[92:95], v3 offset:12288
    v_add_f32 v15, v15, v164
    s_waitcnt lgkmcnt(3)
    v_mfma_f32_16x16x32_bf16 v[28:31], v[104:107], v[188:191], v[28:31]
    v_add_f32 v15, v15, v165
    v_mfma_f32_16x16x32_bf16 v[32:35], v[104:107], v[192:195], v[32:35]
    ds_read_b128 v[96:99], v3 offset:13312
    v_cvt_pk_bf16_f32 v198, v164, v165
    s_waitcnt lgkmcnt(3)
    v_mfma_f32_16x16x32_bf16 v[36:39], v[84:87], v[188:191], v[36:39]
    v_exp_f32 v166, v166
    v_exp_f32 v167, v167
    v_mfma_f32_16x16x32_bf16 v[40:43], v[84:87], v[192:195], v[40:43]
    ds_read_b128 v[100:103], v3 offset:14336
    v_add_f32 v15, v15, v166
    s_waitcnt lgkmcnt(3)
    v_mfma_f32_16x16x32_bf16 v[44:47], v[88:91], v[188:191], v[44:47]
    v_add_f32 v15, v15, v167
    v_mfma_f32_16x16x32_bf16 v[48:51], v[88:91], v[192:195], v[48:51]
    ds_read_b128 v[104:107], v3 offset:15360
    v_cvt_pk_bf16_f32 v199, v166, v167
    s_waitcnt lgkmcnt(3)
    v_mfma_f32_16x16x32_bf16 v[52:55], v[92:95], v[188:191], v[52:55]
    v_exp_f32 v168, v168
    v_exp_f32 v169, v169
    v_mfma_f32_16x16x32_bf16 v[56:59], v[92:95], v[192:195], v[56:59]
    s_waitcnt vmcnt(4)
    s_barrier
    ds_read_b128 v[84:87], v2 offset:16384
    v_add_f32 v16, v16, v168
    s_waitcnt lgkmcnt(3)
    v_mfma_f32_16x16x32_bf16 v[60:63], v[96:99], v[188:191], v[60:63]
    v_add_f32 v16, v16, v169
    v_mfma_f32_16x16x32_bf16 v[64:67], v[96:99], v[192:195], v[64:67]
    s_add_u32 s22, s17, 0x24000
    s_add_u32 m0, s17, 0x1c000
    s_nop 0
    buffer_load_dwordx4 v5, s[8:11], s22 offen sc1 lds
    ds_read_b128 v[88:91], v2 offset:17408
    v_cvt_pk_bf16_f32 v202, v168, v169
    s_waitcnt lgkmcnt(3)
    v_mfma_f32_16x16x32_bf16 v[68:71], v[100:103], v[188:191], v[68:71]
    v_exp_f32 v170, v170
    v_exp_f32 v171, v171
    v_mfma_f32_16x16x32_bf16 v[72:75], v[100:103], v[192:195], v[72:75]
    ds_read_b128 v[92:95], v2 offset:18432
    v_add_f32 v16, v16, v170
    s_waitcnt lgkmcnt(3)
    v_mfma_f32_16x16x32_bf16 v[76:79], v[104:107], v[188:191], v[76:79]
    v_add_f32 v16, v16, v171
    v_mfma_f32_16x16x32_bf16 v[80:83], v[104:107], v[192:195], v[80:83]
    s_add_u32 s22, s17, 0x24400
    s_add_u32 m0, s17, 0x1c400
    s_nop 0
    buffer_load_dwordx4 v5, s[8:11], s22 offen sc1 lds
    ds_read_b128 v[96:99], v2 offset:19456
    v_cvt_pk_bf16_f32 v203, v170, v171
    s_waitcnt lgkmcnt(3)
    v_mfma_f32_16x16x32_bf16 v[156:159], v[84:87], v[108:111], v[172:175]
    v_exp_f32 v140, v140
    v_exp_f32 v141, v141
    v_mfma_f32_16x16x32_bf16 v[160:163], v[84:87], v[124:127], v[176:179]
    ds_read_b128 v[100:103], v2 offset:20480
    v_add_f32 v15, v15, v140
    s_waitcnt lgkmcnt(3)
    v_mfma_f32_16x16x32_bf16 v[164:167], v[88:91], v[108:111], v[172:175]
    v_add_f32 v15, v15, v141
    v_mfma_f32_16x16x32_bf16 v[168:171], v[88:91], v[124:127], v[176:179]
    s_add_u32 s22, s17, 0x24800
    s_add_u32 m0, s17, 0x1c800
    s_nop 0
    buffer_load_dwordx4 v5, s[8:11], s22 offen sc1 lds
    ds_read_b128 v[104:107], v2 offset:21504
    v_cvt_pk_bf16_f32 v188, v140, v141
    s_waitcnt lgkmcnt(3)
    v_mfma_f32_16x16x32_bf16 v[156:159], v[92:95], v[112:115], v[156:159]
    v_exp_f32 v142, v142
    v_exp_f32 v143, v143
    v_mfma_f32_16x16x32_bf16 v[160:163], v[92:95], v[128:131], v[160:163]
    ds_read_b128 v[84:87], v2 offset:22528
    v_add_f32 v15, v15, v142
    s_waitcnt lgkmcnt(3)
    v_mfma_f32_16x16x32_bf16 v[164:167], v[96:99], v[112:115], v[164:167]
    v_add_f32 v15, v15, v143
    v_mfma_f32_16x16x32_bf16 v[168:171], v[96:99], v[128:131], v[168:171]
    s_add_u32 s22, s17, 0x24c00
    s_add_u32 m0, s17, 0x1cc00
    s_nop 0
    buffer_load_dwordx4 v5, s[8:11], s22 offen sc1 lds
    ds_read_b128 v[88:91], v2 offset:23552
    v_cvt_pk_bf16_f32 v189, v142, v143
    s_waitcnt lgkmcnt(3)
    v_mfma_f32_16x16x32_bf16 v[156:159], v[100:103], v[116:119], v[156:159]
    v_exp_f32 v144, v144
    v_exp_f32 v145, v145
    v_mfma_f32_16x16x32_bf16 v[160:163], v[100:103], v[132:135], v[160:163]
    ds_read_b128 v[92:95], v3 offset:24576
    v_add_f32 v16, v16, v144
    s_waitcnt lgkmcnt(3)
    v_mfma_f32_16x16x32_bf16 v[164:167], v[104:107], v[116:119], v[164:167]
    v_add_f32 v16, v16, v145
    v_mfma_f32_16x16x32_bf16 v[168:171], v[104:107], v[132:135], v[168:171]
    ds_read_b128 v[96:99], v3 offset:25600
    v_cvt_pk_bf16_f32 v192, v144, v145
    s_waitcnt lgkmcnt(3)
    v_mfma_f32_16x16x32_bf16 v[156:159], v[84:87], v[120:123], v[156:159]
    v_exp_f32 v146, v146
    v_exp_f32 v147, v147
    v_mfma_f32_16x16x32_bf16 v[160:163], v[84:87], v[136:139], v[160:163]
    ds_read_b128 v[100:103], v3 offset:26624
    v_add_f32 v16, v16, v146
    s_waitcnt lgkmcnt(3)
    v_mfma_f32_16x16x32_bf16 v[164:167], v[88:91], v[120:123], v[164:167]
    v_add_f32 v16, v16, v147
    v_mfma_f32_16x16x32_bf16 v[168:171], v[88:91], v[136:139], v[168:171]
    ds_read_b128 v[104:107], v3 offset:27648
    v_cvt_pk_bf16_f32 v193, v146, v147
    s_waitcnt lgkmcnt(3)
    v_mfma_f32_16x16x32_bf16 v[20:23], v[92:95], v[196:199], v[20:23]
    v_exp_f32 v148, v148
    v_exp_f32 v149, v149
    v_mfma_f32_16x16x32_bf16 v[24:27], v[92:95], v[200:203], v[24:27]
    ds_read_b128 v[84:87], v3 offset:28672
    v_add_f32 v15, v15, v148
    s_waitcnt lgkmcnt(3)
    v_mfma_f32_16x16x32_bf16 v[28:31], v[96:99], v[196:199], v[28:31]
    v_add_f32 v15, v15, v149
    v_mfma_f32_16x16x32_bf16 v[32:35], v[96:99], v[200:203], v[32:35]
    ds_read_b128 v[88:91], v3 offset:29696
    v_cvt_pk_bf16_f32 v190, v148, v149
    s_waitcnt lgkmcnt(3)
    v_mfma_f32_16x16x32_bf16 v[36:39], v[100:103], v[196:199], v[36:39]
    v_exp_f32 v150, v150
    v_exp_f32 v151, v151
    v_mfma_f32_16x16x32_bf16 v[40:43], v[100:103], v[200:203], v[40:43]
    ds_read_b128 v[92:95], v3 offset:30720
    v_add_f32 v15, v15, v150
    s_waitcnt lgkmcnt(3)
    v_mfma_f32_16x16x32_bf16 v[44:47], v[104:107], v[196:199], v[44:47]
    v_add_f32 v15, v15, v151
    v_mfma_f32_16x16x32_bf16 v[48:51], v[104:107], v[200:203], v[48:51]
    ds_read_b128 v[96:99], v3 offset:31744
    v_cvt_pk_bf16_f32 v191, v150, v151
    s_waitcnt lgkmcnt(3)
    v_mfma_f32_16x16x32_bf16 v[52:55], v[84:87], v[196:199], v[52:55]
    v_exp_f32 v152, v152
    v_exp_f32 v153, v153
    v_mfma_f32_16x16x32_bf16 v[56:59], v[84:87], v[200:203], v[56:59]
    s_waitcnt vmcnt(4)
    s_barrier
    ds_read_b128 v[100:103], v2 offset:32768
    v_add_f32 v16, v16, v152
    s_waitcnt lgkmcnt(3)
    v_mfma_f32_16x16x32_bf16 v[60:63], v[88:91], v[196:199], v[60:63]
    v_add_f32 v16, v16, v153
    v_mfma_f32_16x16x32_bf16 v[64:67], v[88:91], v[200:203], v[64:67]
    s_add_u32 s22, s17, 0x28000
    s_add_u32 m0, s17, 0x20000
    s_nop 0
    buffer_load_dwordx4 v5, s[8:11], s22 offen sc1 lds
    ds_read_b128 v[104:107], v2 offset:33792
    v_cvt_pk_bf16_f32 v194, v152, v153
    s_waitcnt lgkmcnt(3)
    v_mfma_f32_16x16x32_bf16 v[68:71], v[92:95], v[196:199], v[68:71]
    v_exp_f32 v154, v154
    v_exp_f32 v155, v155
    v_mfma_f32_16x16x32_bf16 v[72:75], v[92:95], v[200:203], v[72:75]
    ds_read_b128 v[84:87], v2 offset:34816
    v_add_f32 v16, v16, v154
    s_waitcnt lgkmcnt(3)
    v_mfma_f32_16x16x32_bf16 v[76:79], v[96:99], v[196:199], v[76:79]
    v_add_f32 v16, v16, v155
    v_mfma_f32_16x16x32_bf16 v[80:83], v[96:99], v[200:203], v[80:83]
    s_add_u32 s22, s17, 0x28400
    s_add_u32 m0, s17, 0x20400
    s_nop 0
    buffer_load_dwordx4 v5, s[8:11], s22 offen sc1 lds
    ds_read_b128 v[88:91], v2 offset:35840
    v_cvt_pk_bf16_f32 v195, v154, v155
    s_waitcnt lgkmcnt(3)
    v_mfma_f32_16x16x32_bf16 v[140:143], v[100:103], v[108:111], v[172:175]
    v_exp_f32 v156, v156
    v_exp_f32 v157, v157
    v_mfma_f32_16x16x32_bf16 v[144:147], v[100:103], v[124:127], v[176:179]
    ds_read_b128 v[92:95], v2 offset:36864
    v_add_f32 v15, v15, v156
    s_waitcnt lgkmcnt(3)
    v_mfma_f32_16x16x32_bf16 v[148:151], v[104:107], v[108:111], v[172:175]
    v_add_f32 v15, v15, v157
    v_mfma_f32_16x16x32_bf16 v[152:155], v[104:107], v[124:127], v[176:179]
    s_add_u32 s22, s17, 0x28800
    s_add_u32 m0, s17, 0x20800
    s_nop 0
    buffer_load_dwordx4 v5, s[8:11], s22 offen sc1 lds
    ds_read_b128 v[96:99], v2 offset:37888
    v_cvt_pk_bf16_f32 v196, v156, v157
    s_waitcnt lgkmcnt(3)
    v_mfma_f32_16x16x32_bf16 v[140:143], v[84:87], v[112:115], v[140:143]
    v_exp_f32 v158, v158
    v_exp_f32 v159, v159
    v_mfma_f32_16x16x32_bf16 v[144:147], v[84:87], v[128:131], v[144:147]
    ds_read_b128 v[100:103], v2 offset:38912
    v_add_f32 v15, v15, v158
    s_waitcnt lgkmcnt(3)
    v_mfma_f32_16x16x32_bf16 v[148:151], v[88:91], v[112:115], v[148:151]
    v_add_f32 v15, v15, v159
    v_mfma_f32_16x16x32_bf16 v[152:155], v[88:91], v[128:131], v[152:155]
    s_add_u32 s22, s17, 0x28c00
    s_add_u32 m0, s17, 0x20c00
    s_nop 0
    buffer_load_dwordx4 v5, s[8:11], s22 offen sc1 lds
    ds_read_b128 v[104:107], v2 offset:39936
    v_cvt_pk_bf16_f32 v197, v158, v159
    s_waitcnt lgkmcnt(3)
    v_mfma_f32_16x16x32_bf16 v[140:143], v[92:95], v[116:119], v[140:143]
    v_exp_f32 v160, v160
    v_exp_f32 v161, v161
    v_mfma_f32_16x16x32_bf16 v[144:147], v[92:95], v[132:135], v[144:147]
    ds_read_b128 v[84:87], v2 offset:8192
    v_add_f32 v16, v16, v160
    s_waitcnt lgkmcnt(3)
    v_mfma_f32_16x16x32_bf16 v[148:151], v[96:99], v[116:119], v[148:151]
    v_add_f32 v16, v16, v161
    v_mfma_f32_16x16x32_bf16 v[152:155], v[96:99], v[132:135], v[152:155]
    ds_read_b128 v[88:91], v2 offset:9216
    v_cvt_pk_bf16_f32 v200, v160, v161
    s_waitcnt lgkmcnt(3)
    v_mfma_f32_16x16x32_bf16 v[140:143], v[100:103], v[120:123], v[140:143]
    v_exp_f32 v162, v162
    v_exp_f32 v163, v163
    v_mfma_f32_16x16x32_bf16 v[144:147], v[100:103], v[136:139], v[144:147]
    ds_read_b128 v[92:95], v2 offset:10240
    v_add_f32 v16, v16, v162
    s_waitcnt lgkmcnt(3)
    v_mfma_f32_16x16x32_bf16 v[148:151], v[104:107], v[120:123], v[148:151]
    v_add_f32 v16, v16, v163
    v_mfma_f32_16x16x32_bf16 v[152:155], v[104:107], v[136:139], v[152:155]
    ds_read_b128 v[96:99], v2 offset:11264
    v_cvt_pk_bf16_f32 v201, v162, v163
    s_waitcnt lgkmcnt(3)
    v_mfma_f32_16x16x32_bf16 v[20:23], v[84:87], v[188:191], v[20:23]
    v_exp_f32 v164, v164
    v_exp_f32 v165, v165
    v_mfma_f32_16x16x32_bf16 v[24:27], v[84:87], v[192:195], v[24:27]
    ds_read_b128 v[100:103], v2 offset:12288
    v_add_f32 v15, v15, v164
    s_waitcnt lgkmcnt(3)
    v_mfma_f32_16x16x32_bf16 v[28:31], v[88:91], v[188:191], v[28:31]
    v_add_f32 v15, v15, v165
    v_mfma_f32_16x16x32_bf16 v[32:35], v[88:91], v[192:195], v[32:35]
    ds_read_b128 v[104:107], v2 offset:13312
    v_cvt_pk_bf16_f32 v198, v164, v165
    s_waitcnt lgkmcnt(3)
    v_mfma_f32_16x16x32_bf16 v[36:39], v[92:95], v[188:191], v[36:39]
    v_exp_f32 v166, v166
    v_exp_f32 v167, v167
    v_mfma_f32_16x16x32_bf16 v[40:43], v[92:95], v[192:195], v[40:43]
    ds_read_b128 v[84:87], v2 offset:14336
    v_add_f32 v15, v15, v166
    s_waitcnt lgkmcnt(3)
    v_mfma_f32_16x16x32_bf16 v[44:47], v[96:99], v[188:191], v[44:47]
    v_add_f32 v15, v15, v167
    v_mfma_f32_16x16x32_bf16 v[48:51], v[96:99], v[192:195], v[48:51]
    ds_read_b128 v[88:91], v2 offset:15360
    v_cvt_pk_bf16_f32 v199, v166, v167
    s_waitcnt lgkmcnt(3)
    v_mfma_f32_16x16x32_bf16 v[52:55], v[100:103], v[188:191], v[52:55]
    v_exp_f32 v168, v168
    v_exp_f32 v169, v169
    v_mfma_f32_16x16x32_bf16 v[56:59], v[100:103], v[192:195], v[56:59]
    s_waitcnt vmcnt(4)
    s_barrier
    ds_read_b128 v[92:95], v2 offset:49152
    v_add_f32 v16, v16, v168
    s_waitcnt lgkmcnt(3)
    v_mfma_f32_16x16x32_bf16 v[60:63], v[104:107], v[188:191], v[60:63]
    v_add_f32 v16, v16, v169
    v_mfma_f32_16x16x32_bf16 v[64:67], v[104:107], v[192:195], v[64:67]
    s_add_u32 s22, s17, 0x2c000
    s_add_u32 m0, s17, 0x24000
    s_nop 0
    buffer_load_dwordx4 v5, s[8:11], s22 offen sc1 lds
    ds_read_b128 v[96:99], v2 offset:50176
    v_cvt_pk_bf16_f32 v202, v168, v169
    s_waitcnt lgkmcnt(3)
    v_mfma_f32_16x16x32_bf16 v[68:71], v[84:87], v[188:191], v[68:71]
    v_exp_f32 v170, v170
    v_exp_f32 v171, v171
    v_mfma_f32_16x16x32_bf16 v[72:75], v[84:87], v[192:195], v[72:75]
    ds_read_b128 v[100:103], v2 offset:51200
    v_add_f32 v16, v16, v170
    s_waitcnt lgkmcnt(3)
    v_mfma_f32_16x16x32_bf16 v[76:79], v[88:91], v[188:191], v[76:79]
    v_add_f32 v16, v16, v171
    v_mfma_f32_16x16x32_bf16 v[80:83], v[88:91], v[192:195], v[80:83]
    s_add_u32 s22, s17, 0x2c400
    s_add_u32 m0, s17, 0x24400
    s_nop 0
    buffer_load_dwordx4 v5, s[8:11], s22 offen sc1 lds
    ds_read_b128 v[104:107], v2 offset:52224
    v_cvt_pk_bf16_f32 v203, v170, v171
    s_waitcnt lgkmcnt(3)
    v_mfma_f32_16x16x32_bf16 v[156:159], v[92:95], v[108:111], v[172:175]
    v_exp_f32 v140, v140
    v_exp_f32 v141, v141
    v_mfma_f32_16x16x32_bf16 v[160:163], v[92:95], v[124:127], v[176:179]
    ds_read_b128 v[84:87], v2 offset:53248
    v_add_f32 v15, v15, v140
    s_waitcnt lgkmcnt(3)
    v_mfma_f32_16x16x32_bf16 v[164:167], v[96:99], v[108:111], v[172:175]
    v_add_f32 v15, v15, v141
    v_mfma_f32_16x16x32_bf16 v[168:171], v[96:99], v[124:127], v[176:179]
    s_add_u32 s22, s17, 0x2c800
    s_add_u32 m0, s17, 0x24800
    s_nop 0
    buffer_load_dwordx4 v5, s[8:11], s22 offen sc1 lds
    ds_read_b128 v[88:91], v2 offset:54272
    v_cvt_pk_bf16_f32 v188, v140, v141
    s_waitcnt lgkmcnt(3)
    v_mfma_f32_16x16x32_bf16 v[156:159], v[100:103], v[112:115], v[156:159]
    v_exp_f32 v142, v142
    v_exp_f32 v143, v143
    v_mfma_f32_16x16x32_bf16 v[160:163], v[100:103], v[128:131], v[160:163]
    ds_read_b128 v[92:95], v2 offset:55296
    v_add_f32 v15, v15, v142
    s_waitcnt lgkmcnt(3)
    v_mfma_f32_16x16x32_bf16 v[164:167], v[104:107], v[112:115], v[164:167]
    v_add_f32 v15, v15, v143
    v_mfma_f32_16x16x32_bf16 v[168:171], v[104:107], v[128:131], v[168:171]
    s_add_u32 s22, s17, 0x2cc00
    s_add_u32 m0, s17, 0x24c00
    s_nop 0
    buffer_load_dwordx4 v5, s[8:11], s22 offen sc1 lds
    ds_read_b128 v[96:99], v2 offset:56320
    v_cvt_pk_bf16_f32 v189, v142, v143
    s_waitcnt lgkmcnt(3)
    v_mfma_f32_16x16x32_bf16 v[156:159], v[84:87], v[116:119], v[156:159]
    v_exp_f32 v144, v144
    v_exp_f32 v145, v145
    v_mfma_f32_16x16x32_bf16 v[160:163], v[84:87], v[132:135], v[160:163]
    ds_read_b128 v[100:103], v2 offset:24576
    v_add_f32 v16, v16, v144
    s_waitcnt lgkmcnt(3)
    v_mfma_f32_16x16x32_bf16 v[164:167], v[88:91], v[116:119], v[164:167]
    v_add_f32 v16, v16, v145
    v_mfma_f32_16x16x32_bf16 v[168:171], v[88:91], v[132:135], v[168:171]
    ds_read_b128 v[104:107], v2 offset:25600
    v_cvt_pk_bf16_f32 v192, v144, v145
    s_waitcnt lgkmcnt(3)
    v_mfma_f32_16x16x32_bf16 v[156:159], v[92:95], v[120:123], v[156:159]
    v_exp_f32 v146, v146
    v_exp_f32 v147, v147
    v_mfma_f32_16x16x32_bf16 v[160:163], v[92:95], v[136:139], v[160:163]
    ds_read_b128 v[84:87], v2 offset:26624
    v_add_f32 v16, v16, v146
    s_waitcnt lgkmcnt(3)
    v_mfma_f32_16x16x32_bf16 v[164:167], v[96:99], v[120:123], v[164:167]
    v_add_f32 v16, v16, v147
    v_mfma_f32_16x16x32_bf16 v[168:171], v[96:99], v[136:139], v[168:171]
    ds_read_b128 v[88:91], v2 offset:27648
    v_cvt_pk_bf16_f32 v193, v146, v147
    s_waitcnt lgkmcnt(3)
    v_mfma_f32_16x16x32_bf16 v[20:23], v[100:103], v[196:199], v[20:23]
    v_exp_f32 v148, v148
    v_exp_f32 v149, v149
    v_mfma_f32_16x16x32_bf16 v[24:27], v[100:103], v[200:203], v[24:27]
    ds_read_b128 v[92:95], v2 offset:28672
    v_add_f32 v15, v15, v148
    s_waitcnt lgkmcnt(3)
    v_mfma_f32_16x16x32_bf16 v[28:31], v[104:107], v[196:199], v[28:31]
    v_add_f32 v15, v15, v149
    v_mfma_f32_16x16x32_bf16 v[32:35], v[104:107], v[200:203], v[32:35]
    ds_read_b128 v[96:99], v2 offset:29696
    v_cvt_pk_bf16_f32 v190, v148, v149
    s_waitcnt lgkmcnt(3)
    v_mfma_f32_16x16x32_bf16 v[36:39], v[84:87], v[196:199], v[36:39]
    v_exp_f32 v150, v150
    v_exp_f32 v151, v151
    v_mfma_f32_16x16x32_bf16 v[40:43], v[84:87], v[200:203], v[40:43]
    ds_read_b128 v[100:103], v2 offset:30720
    v_add_f32 v15, v15, v150
    s_waitcnt lgkmcnt(3)
    v_mfma_f32_16x16x32_bf16 v[44:47], v[88:91], v[196:199], v[44:47]
    v_add_f32 v15, v15, v151
    v_mfma_f32_16x16x32_bf16 v[48:51], v[88:91], v[200:203], v[48:51]
    ds_read_b128 v[104:107], v2 offset:31744
    v_cvt_pk_bf16_f32 v191, v150, v151
    s_waitcnt lgkmcnt(3)
    v_mfma_f32_16x16x32_bf16 v[52:55], v[92:95], v[196:199], v[52:55]
    v_exp_f32 v152, v152
    v_exp_f32 v153, v153
    v_mfma_f32_16x16x32_bf16 v[56:59], v[92:95], v[200:203], v[56:59]
    s_waitcnt vmcnt(4)
    s_barrier
    ds_read_b128 v[84:87], v3 offset:0
    v_add_f32 v16, v16, v152
    s_waitcnt lgkmcnt(3)
    v_mfma_f32_16x16x32_bf16 v[60:63], v[96:99], v[196:199], v[60:63]
    v_add_f32 v16, v16, v153
    v_mfma_f32_16x16x32_bf16 v[64:67], v[96:99], v[200:203], v[64:67]
    s_add_u32 s22, s17, 0x30000
    s_add_u32 m0, s17, 0x10000
    s_nop 0
    buffer_load_dwordx4 v5, s[8:11], s22 offen sc1 lds
    ds_read_b128 v[88:91], v3 offset:1024
    v_cvt_pk_bf16_f32 v194, v152, v153
    s_waitcnt lgkmcnt(3)
    v_mfma_f32_16x16x32_bf16 v[68:71], v[100:103], v[196:199], v[68:71]
    v_exp_f32 v154, v154
    v_exp_f32 v155, v155
    v_mfma_f32_16x16x32_bf16 v[72:75], v[100:103], v[200:203], v[72:75]
    ds_read_b128 v[92:95], v3 offset:2048
    v_add_f32 v16, v16, v154
    s_waitcnt lgkmcnt(3)
    v_mfma_f32_16x16x32_bf16 v[76:79], v[104:107], v[196:199], v[76:79]
    v_add_f32 v16, v16, v155
    v_mfma_f32_16x16x32_bf16 v[80:83], v[104:107], v[200:203], v[80:83]
    s_add_u32 s22, s17, 0x30400
    s_add_u32 m0, s17, 0x10400
    s_nop 0
    buffer_load_dwordx4 v5, s[8:11], s22 offen sc1 lds
    ds_read_b128 v[96:99], v3 offset:3072
    v_cvt_pk_bf16_f32 v195, v154, v155
    s_waitcnt lgkmcnt(3)
    v_mfma_f32_16x16x32_bf16 v[140:143], v[84:87], v[108:111], v[172:175]
    v_exp_f32 v156, v156
    v_exp_f32 v157, v157
    v_mfma_f32_16x16x32_bf16 v[144:147], v[84:87], v[124:127], v[176:179]
    ds_read_b128 v[100:103], v3 offset:4096
    v_add_f32 v15, v15, v156
    s_waitcnt lgkmcnt(3)
    v_mfma_f32_16x16x32_bf16 v[148:151], v[88:91], v[108:111], v[172:175]
    v_add_f32 v15, v15, v157
    v_mfma_f32_16x16x32_bf16 v[152:155], v[88:91], v[124:127], v[176:179]
    s_add_u32 s22, s17, 0x30800
    s_add_u32 m0, s17, 0x10800
    s_nop 0
    buffer_load_dwordx4 v5, s[8:11], s22 offen sc1 lds
    ds_read_b128 v[104:107], v3 offset:5120
    v_cvt_pk_bf16_f32 v196, v156, v157
    s_waitcnt lgkmcnt(3)
    v_mfma_f32_16x16x32_bf16 v[140:143], v[92:95], v[112:115], v[140:143]
    v_exp_f32 v158, v158
    v_exp_f32 v159, v159
    v_mfma_f32_16x16x32_bf16 v[144:147], v[92:95], v[128:131], v[144:147]
    ds_read_b128 v[84:87], v3 offset:6144
    v_add_f32 v15, v15, v158
    s_waitcnt lgkmcnt(3)
    v_mfma_f32_16x16x32_bf16 v[148:151], v[96:99], v[112:115], v[148:151]
    v_add_f32 v15, v15, v159
    v_mfma_f32_16x16x32_bf16 v[152:155], v[96:99], v[128:131], v[152:155]
    s_add_u32 s22, s17, 0x30c00
    s_add_u32 m0, s17, 0x10c00
    s_nop 0
    buffer_load_dwordx4 v5, s[8:11], s22 offen sc1 lds
    ds_read_b128 v[88:91], v3 offset:7168
    v_cvt_pk_bf16_f32 v197, v158, v159
    s_waitcnt lgkmcnt(3)
    v_mfma_f32_16x16x32_bf16 v[140:143], v[100:103], v[116:119], v[140:143]
    v_exp_f32 v160, v160
    v_exp_f32 v161, v161
    v_mfma_f32_16x16x32_bf16 v[144:147], v[100:103], v[132:135], v[144:147]
    ds_read_b128 v[92:95], v2 offset:40960
    v_add_f32 v16, v16, v160
    s_waitcnt lgkmcnt(3)
    v_mfma_f32_16x16x32_bf16 v[148:151], v[104:107], v[116:119], v[148:151]
    v_add_f32 v16, v16, v161
    v_mfma_f32_16x16x32_bf16 v[152:155], v[104:107], v[132:135], v[152:155]
    ds_read_b128 v[96:99], v2 offset:41984
    v_cvt_pk_bf16_f32 v200, v160, v161
    s_waitcnt lgkmcnt(3)
    v_mfma_f32_16x16x32_bf16 v[140:143], v[84:87], v[120:123], v[140:143]
    v_exp_f32 v162, v162
    v_exp_f32 v163, v163
    v_mfma_f32_16x16x32_bf16 v[144:147], v[84:87], v[136:139], v[144:147]
    ds_read_b128 v[100:103], v2 offset:43008
    v_add_f32 v16, v16, v162
    s_waitcnt lgkmcnt(3)
    v_mfma_f32_16x16x32_bf16 v[148:151], v[88:91], v[120:123], v[148:151]
    v_add_f32 v16, v16, v163
    v_mfma_f32_16x16x32_bf16 v[152:155], v[88:91], v[136:139], v[152:155]
    ds_read_b128 v[104:107], v2 offset:44032
    v_cvt_pk_bf16_f32 v201, v162, v163
    s_waitcnt lgkmcnt(3)
    v_mfma_f32_16x16x32_bf16 v[20:23], v[92:95], v[188:191], v[20:23]
    v_exp_f32 v164, v164
    v_exp_f32 v165, v165
    v_mfma_f32_16x16x32_bf16 v[24:27], v[92:95], v[192:195], v[24:27]
    ds_read_b128 v[84:87], v2 offset:45056
    v_add_f32 v15, v15, v164
    s_waitcnt lgkmcnt(3)
    v_mfma_f32_16x16x32_bf16 v[28:31], v[96:99], v[188:191], v[28:31]
    v_add_f32 v15, v15, v165
    v_mfma_f32_16x16x32_bf16 v[32:35], v[96:99], v[192:195], v[32:35]
    ds_read_b128 v[88:91], v2 offset:46080
    v_cvt_pk_bf16_f32 v198, v164, v165
    s_waitcnt lgkmcnt(3)
    v_mfma_f32_16x16x32_bf16 v[36:39], v[100:103], v[188:191], v[36:39]
    v_exp_f32 v166, v166
    v_exp_f32 v167, v167
    v_mfma_f32_16x16x32_bf16 v[40:43], v[100:103], v[192:195], v[40:43]
    ds_read_b128 v[92:95], v2 offset:47104
    v_add_f32 v15, v15, v166
    s_waitcnt lgkmcnt(3)
    v_mfma_f32_16x16x32_bf16 v[44:47], v[104:107], v[188:191], v[44:47]
    v_add_f32 v15, v15, v167
    v_mfma_f32_16x16x32_bf16 v[48:51], v[104:107], v[192:195], v[48:51]
    ds_read_b128 v[96:99], v2 offset:48128
    v_cvt_pk_bf16_f32 v199, v166, v167
    s_waitcnt lgkmcnt(3)
    v_mfma_f32_16x16x32_bf16 v[52:55], v[84:87], v[188:191], v[52:55]
    v_exp_f32 v168, v168
    v_exp_f32 v169, v169
    v_mfma_f32_16x16x32_bf16 v[56:59], v[84:87], v[192:195], v[56:59]
    s_waitcnt vmcnt(4)
    s_barrier
    ds_read_b128 v[100:103], v3 offset:16384
    v_add_f32 v16, v16, v168
    s_waitcnt lgkmcnt(3)
    v_mfma_f32_16x16x32_bf16 v[60:63], v[88:91], v[188:191], v[60:63]
    v_add_f32 v16, v16, v169
    v_mfma_f32_16x16x32_bf16 v[64:67], v[88:91], v[192:195], v[64:67]
    s_add_u32 s22, s17, 0x34000
    s_add_u32 m0, s17, 0x14000
    s_nop 0
    buffer_load_dwordx4 v5, s[8:11], s22 offen sc1 lds
    ds_read_b128 v[104:107], v3 offset:17408
    v_cvt_pk_bf16_f32 v202, v168, v169
    s_waitcnt lgkmcnt(3)
    v_mfma_f32_16x16x32_bf16 v[68:71], v[92:95], v[188:191], v[68:71]
    v_exp_f32 v170, v170
    v_exp_f32 v171, v171
    v_mfma_f32_16x16x32_bf16 v[72:75], v[92:95], v[192:195], v[72:75]
    ds_read_b128 v[84:87], v3 offset:18432
    v_add_f32 v16, v16, v170
    s_waitcnt lgkmcnt(3)
    v_mfma_f32_16x16x32_bf16 v[76:79], v[96:99], v[188:191], v[76:79]
    v_add_f32 v16, v16, v171
    v_mfma_f32_16x16x32_bf16 v[80:83], v[96:99], v[192:195], v[80:83]
    s_add_u32 s22, s17, 0x34400
    s_add_u32 m0, s17, 0x14400
    s_nop 0
    buffer_load_dwordx4 v5, s[8:11], s22 offen sc1 lds
    ds_read_b128 v[88:91], v3 offset:19456
    v_cvt_pk_bf16_f32 v203, v170, v171
    s_waitcnt lgkmcnt(3)
    v_mfma_f32_16x16x32_bf16 v[156:159], v[100:103], v[108:111], v[172:175]
    v_exp_f32 v140, v140
    v_exp_f32 v141, v141
    v_mfma_f32_16x16x32_bf16 v[160:163], v[100:103], v[124:127], v[176:179]
    ds_read_b128 v[92:95], v3 offset:20480
    v_add_f32 v15, v15, v140
    s_waitcnt lgkmcnt(3)
    v_mfma_f32_16x16x32_bf16 v[164:167], v[104:107], v[108:111], v[172:175]
    v_add_f32 v15, v15, v141
    v_mfma_f32_16x16x32_bf16 v[168:171], v[104:107], v[124:127], v[176:179]
    s_add_u32 s22, s17, 0x34800
    s_add_u32 m0, s17, 0x14800
    s_nop 0
    buffer_load_dwordx4 v5, s[8:11], s22 offen sc1 lds
    ds_read_b128 v[96:99], v3 offset:21504
    v_cvt_pk_bf16_f32 v188, v140, v141
    s_waitcnt lgkmcnt(3)
    v_mfma_f32_16x16x32_bf16 v[156:159], v[84:87], v[112:115], v[156:159]
    v_exp_f32 v142, v142
    v_exp_f32 v143, v143
    v_mfma_f32_16x16x32_bf16 v[160:163], v[84:87], v[128:131], v[160:163]
    ds_read_b128 v[100:103], v3 offset:22528
    v_add_f32 v15, v15, v142
    s_waitcnt lgkmcnt(3)
    v_mfma_f32_16x16x32_bf16 v[164:167], v[88:91], v[112:115], v[164:167]
    v_add_f32 v15, v15, v143
    v_mfma_f32_16x16x32_bf16 v[168:171], v[88:91], v[128:131], v[168:171]
    s_add_u32 s22, s17, 0x34c00
    s_add_u32 m0, s17, 0x14c00
    s_nop 0
    buffer_load_dwordx4 v5, s[8:11], s22 offen sc1 lds
    ds_read_b128 v[104:107], v3 offset:23552
    v_cvt_pk_bf16_f32 v189, v142, v143
    s_waitcnt lgkmcnt(3)
    v_mfma_f32_16x16x32_bf16 v[156:159], v[92:95], v[116:119], v[156:159]
    v_exp_f32 v144, v144
    v_exp_f32 v145, v145
    v_mfma_f32_16x16x32_bf16 v[160:163], v[92:95], v[132:135], v[160:163]
    ds_read_b128 v[84:87], v2 offset:57344
    v_add_f32 v16, v16, v144
    s_waitcnt lgkmcnt(3)
    v_mfma_f32_16x16x32_bf16 v[164:167], v[96:99], v[116:119], v[164:167]
    v_add_f32 v16, v16, v145
    v_mfma_f32_16x16x32_bf16 v[168:171], v[96:99], v[132:135], v[168:171]
    ds_read_b128 v[88:91], v2 offset:58368
    v_cvt_pk_bf16_f32 v192, v144, v145
    s_waitcnt lgkmcnt(3)
    v_mfma_f32_16x16x32_bf16 v[156:159], v[100:103], v[120:123], v[156:159]
    v_exp_f32 v146, v146
    v_exp_f32 v147, v147
    v_mfma_f32_16x16x32_bf16 v[160:163], v[100:103], v[136:139], v[160:163]
    ds_read_b128 v[92:95], v2 offset:59392
    v_add_f32 v16, v16, v146
    s_waitcnt lgkmcnt(3)
    v_mfma_f32_16x16x32_bf16 v[164:167], v[104:107], v[120:123], v[164:167]
    v_add_f32 v16, v16, v147
    v_mfma_f32_16x16x32_bf16 v[168:171], v[104:107], v[136:139], v[168:171]
    ds_read_b128 v[96:99], v2 offset:60416
    v_cvt_pk_bf16_f32 v193, v146, v147
    s_waitcnt lgkmcnt(3)
    v_mfma_f32_16x16x32_bf16 v[20:23], v[84:87], v[196:199], v[20:23]
    v_exp_f32 v148, v148
    v_exp_f32 v149, v149
    v_mfma_f32_16x16x32_bf16 v[24:27], v[84:87], v[200:203], v[24:27]
    ds_read_b128 v[100:103], v2 offset:61440
    v_add_f32 v15, v15, v148
    s_waitcnt lgkmcnt(3)
    v_mfma_f32_16x16x32_bf16 v[28:31], v[88:91], v[196:199], v[28:31]
    v_add_f32 v15, v15, v149
    v_mfma_f32_16x16x32_bf16 v[32:35], v[88:91], v[200:203], v[32:35]
    ds_read_b128 v[104:107], v2 offset:62464
    v_cvt_pk_bf16_f32 v190, v148, v149
    s_waitcnt lgkmcnt(3)
    v_mfma_f32_16x16x32_bf16 v[36:39], v[92:95], v[196:199], v[36:39]
    v_exp_f32 v150, v150
    v_exp_f32 v151, v151
    v_mfma_f32_16x16x32_bf16 v[40:43], v[92:95], v[200:203], v[40:43]
    ds_read_b128 v[84:87], v2 offset:63488
    v_add_f32 v15, v15, v150
    s_waitcnt lgkmcnt(3)
    v_mfma_f32_16x16x32_bf16 v[44:47], v[96:99], v[196:199], v[44:47]
    v_add_f32 v15, v15, v151
    v_mfma_f32_16x16x32_bf16 v[48:51], v[96:99], v[200:203], v[48:51]
    ds_read_b128 v[88:91], v2 offset:64512
    v_cvt_pk_bf16_f32 v191, v150, v151
    s_waitcnt lgkmcnt(3)
    v_mfma_f32_16x16x32_bf16 v[52:55], v[100:103], v[196:199], v[52:55]
    v_exp_f32 v152, v152
    v_exp_f32 v153, v153
    v_mfma_f32_16x16x32_bf16 v[56:59], v[100:103], v[200:203], v[56:59]
    s_waitcnt vmcnt(4)
    s_barrier
    ds_read_b128 v[92:95], v2 offset:0
    v_add_f32 v16, v16, v152
    s_waitcnt lgkmcnt(3)
    v_mfma_f32_16x16x32_bf16 v[60:63], v[104:107], v[196:199], v[60:63]
    v_add_f32 v16, v16, v153
    v_mfma_f32_16x16x32_bf16 v[64:67], v[104:107], v[200:203], v[64:67]
    s_add_u32 s22, s17, 0x38000
    s_add_u32 m0, s17, 0x18000
    s_nop 0
    buffer_load_dwordx4 v5, s[8:11], s22 offen sc1 lds
    ds_read_b128 v[96:99], v2 offset:1024
    v_cvt_pk_bf16_f32 v194, v152, v153
    s_waitcnt lgkmcnt(3)
    v_mfma_f32_16x16x32_bf16 v[68:71], v[84:87], v[196:199], v[68:71]
    v_exp_f32 v154, v154
    v_exp_f32 v155, v155
    v_mfma_f32_16x16x32_bf16 v[72:75], v[84:87], v[200:203], v[72:75]
    ds_read_b128 v[100:103], v2 offset:2048
    v_add_f32 v16, v16, v154
    s_waitcnt lgkmcnt(3)
    v_mfma_f32_16x16x32_bf16 v[76:79], v[88:91], v[196:199], v[76:79]
    v_add_f32 v16, v16, v155
    v_mfma_f32_16x16x32_bf16 v[80:83], v[88:91], v[200:203], v[80:83]
    s_add_u32 s22, s17, 0x38400
    s_add_u32 m0, s17, 0x18400
    s_nop 0
    buffer_load_dwordx4 v5, s[8:11], s22 offen sc1 lds
    ds_read_b128 v[104:107], v2 offset:3072
    v_cvt_pk_bf16_f32 v195, v154, v155
    s_waitcnt lgkmcnt(3)
    v_mfma_f32_16x16x32_bf16 v[140:143], v[92:95], v[108:111], v[172:175]
    v_exp_f32 v156, v156
    v_exp_f32 v157, v157
    v_mfma_f32_16x16x32_bf16 v[144:147], v[92:95], v[124:127], v[176:179]
    ds_read_b128 v[84:87], v2 offset:4096
    v_add_f32 v15, v15, v156
    s_waitcnt lgkmcnt(3)
    v_mfma_f32_16x16x32_bf16 v[148:151], v[96:99], v[108:111], v[172:175]
    v_add_f32 v15, v15, v157
    v_mfma_f32_16x16x32_bf16 v[152:155], v[96:99], v[124:127], v[176:179]
    s_add_u32 s22, s17, 0x38800
    s_add_u32 m0, s17, 0x18800
    s_nop 0
    buffer_load_dwordx4 v5, s[8:11], s22 offen sc1 lds
    ds_read_b128 v[88:91], v2 offset:5120
    v_cvt_pk_bf16_f32 v196, v156, v157
    s_waitcnt lgkmcnt(3)
    v_mfma_f32_16x16x32_bf16 v[140:143], v[100:103], v[112:115], v[140:143]
    v_exp_f32 v158, v158
    v_exp_f32 v159, v159
    v_mfma_f32_16x16x32_bf16 v[144:147], v[100:103], v[128:131], v[144:147]
    ds_read_b128 v[92:95], v2 offset:6144
    v_add_f32 v15, v15, v158
    s_waitcnt lgkmcnt(3)
    v_mfma_f32_16x16x32_bf16 v[148:151], v[104:107], v[112:115], v[148:151]
    v_add_f32 v15, v15, v159
    v_mfma_f32_16x16x32_bf16 v[152:155], v[104:107], v[128:131], v[152:155]
    s_add_u32 s22, s17, 0x38c00
    s_add_u32 m0, s17, 0x18c00
    s_nop 0
    buffer_load_dwordx4 v5, s[8:11], s22 offen sc1 lds
    ds_read_b128 v[96:99], v2 offset:7168
    v_cvt_pk_bf16_f32 v197, v158, v159
    s_waitcnt lgkmcnt(3)
    v_mfma_f32_16x16x32_bf16 v[140:143], v[84:87], v[116:119], v[140:143]
    v_exp_f32 v160, v160
    v_exp_f32 v161, v161
    v_mfma_f32_16x16x32_bf16 v[144:147], v[84:87], v[132:135], v[144:147]
    ds_read_b128 v[100:103], v3 offset:8192
    v_add_f32 v16, v16, v160
    s_waitcnt lgkmcnt(3)
    v_mfma_f32_16x16x32_bf16 v[148:151], v[88:91], v[116:119], v[148:151]
    v_add_f32 v16, v16, v161
    v_mfma_f32_16x16x32_bf16 v[152:155], v[88:91], v[132:135], v[152:155]
    ds_read_b128 v[104:107], v3 offset:9216
    v_cvt_pk_bf16_f32 v200, v160, v161
    s_waitcnt lgkmcnt(3)
    v_mfma_f32_16x16x32_bf16 v[140:143], v[92:95], v[120:123], v[140:143]
    v_exp_f32 v162, v162
    v_exp_f32 v163, v163
    v_mfma_f32_16x16x32_bf16 v[144:147], v[92:95], v[136:139], v[144:147]
    ds_read_b128 v[84:87], v3 offset:10240
    v_add_f32 v16, v16, v162
    s_waitcnt lgkmcnt(3)
    v_mfma_f32_16x16x32_bf16 v[148:151], v[96:99], v[120:123], v[148:151]
    v_add_f32 v16, v16, v163
    v_mfma_f32_16x16x32_bf16 v[152:155], v[96:99], v[136:139], v[152:155]
    ds_read_b128 v[88:91], v3 offset:11264
    v_cvt_pk_bf16_f32 v201, v162, v163
    s_waitcnt lgkmcnt(3)
    v_mfma_f32_16x16x32_bf16 v[20:23], v[100:103], v[188:191], v[20:23]
    v_exp_f32 v164, v164
    v_exp_f32 v165, v165
    v_mfma_f32_16x16x32_bf16 v[24:27], v[100:103], v[192:195], v[24:27]
    ds_read_b128 v[92:95], v3 offset:12288
    v_add_f32 v15, v15, v164
    s_waitcnt lgkmcnt(3)
    v_mfma_f32_16x16x32_bf16 v[28:31], v[104:107], v[188:191], v[28:31]
    v_add_f32 v15, v15, v165
    v_mfma_f32_16x16x32_bf16 v[32:35], v[104:107], v[192:195], v[32:35]
    ds_read_b128 v[96:99], v3 offset:13312
    v_cvt_pk_bf16_f32 v198, v164, v165
    s_waitcnt lgkmcnt(3)
    v_mfma_f32_16x16x32_bf16 v[36:39], v[84:87], v[188:191], v[36:39]
    v_exp_f32 v166, v166
    v_exp_f32 v167, v167
    v_mfma_f32_16x16x32_bf16 v[40:43], v[84:87], v[192:195], v[40:43]
    ds_read_b128 v[100:103], v3 offset:14336
    v_add_f32 v15, v15, v166
    s_waitcnt lgkmcnt(3)
    v_mfma_f32_16x16x32_bf16 v[44:47], v[88:91], v[188:191], v[44:47]
    v_add_f32 v15, v15, v167
    v_mfma_f32_16x16x32_bf16 v[48:51], v[88:91], v[192:195], v[48:51]
    ds_read_b128 v[104:107], v3 offset:15360
    v_cvt_pk_bf16_f32 v199, v166, v167
    s_waitcnt lgkmcnt(3)
    v_mfma_f32_16x16x32_bf16 v[52:55], v[92:95], v[188:191], v[52:55]
    v_exp_f32 v168, v168
    v_exp_f32 v169, v169
    v_mfma_f32_16x16x32_bf16 v[56:59], v[92:95], v[192:195], v[56:59]
    s_waitcnt vmcnt(4)
    s_barrier
    ds_read_b128 v[84:87], v2 offset:16384
    v_add_f32 v16, v16, v168
    s_waitcnt lgkmcnt(3)
    v_mfma_f32_16x16x32_bf16 v[60:63], v[96:99], v[188:191], v[60:63]
    v_add_f32 v16, v16, v169
    v_mfma_f32_16x16x32_bf16 v[64:67], v[96:99], v[192:195], v[64:67]
    s_add_u32 s22, s17, 0x3c000
    s_add_u32 m0, s17, 0x1c000
    s_nop 0
    buffer_load_dwordx4 v5, s[8:11], s22 offen sc1 lds
    ds_read_b128 v[88:91], v2 offset:17408
    v_cvt_pk_bf16_f32 v202, v168, v169
    s_waitcnt lgkmcnt(3)
    v_mfma_f32_16x16x32_bf16 v[68:71], v[100:103], v[188:191], v[68:71]
    v_exp_f32 v170, v170
    v_exp_f32 v171, v171
    v_mfma_f32_16x16x32_bf16 v[72:75], v[100:103], v[192:195], v[72:75]
    ds_read_b128 v[92:95], v2 offset:18432
    v_add_f32 v16, v16, v170
    s_waitcnt lgkmcnt(3)
    v_mfma_f32_16x16x32_bf16 v[76:79], v[104:107], v[188:191], v[76:79]
    v_add_f32 v16, v16, v171
    v_mfma_f32_16x16x32_bf16 v[80:83], v[104:107], v[192:195], v[80:83]
    s_add_u32 s22, s17, 0x3c400
    s_add_u32 m0, s17, 0x1c400
    s_nop 0
    buffer_load_dwordx4 v5, s[8:11], s22 offen sc1 lds
    ds_read_b128 v[96:99], v2 offset:19456
    v_cvt_pk_bf16_f32 v203, v170, v171
    s_waitcnt lgkmcnt(3)
    v_mfma_f32_16x16x32_bf16 v[156:159], v[84:87], v[108:111], v[172:175]
    v_exp_f32 v140, v140
    v_exp_f32 v141, v141
    v_mfma_f32_16x16x32_bf16 v[160:163], v[84:87], v[124:127], v[176:179]
    ds_read_b128 v[100:103], v2 offset:20480
    v_add_f32 v15, v15, v140
    s_waitcnt lgkmcnt(3)
    v_mfma_f32_16x16x32_bf16 v[164:167], v[88:91], v[108:111], v[172:175]
    v_add_f32 v15, v15, v141
    v_mfma_f32_16x16x32_bf16 v[168:171], v[88:91], v[124:127], v[176:179]
    s_add_u32 s22, s17, 0x3c800
    s_add_u32 m0, s17, 0x1c800
    s_nop 0
    buffer_load_dwordx4 v5, s[8:11], s22 offen sc1 lds
    ds_read_b128 v[104:107], v2 offset:21504
    v_cvt_pk_bf16_f32 v188, v140, v141
    s_waitcnt lgkmcnt(3)
    v_mfma_f32_16x16x32_bf16 v[156:159], v[92:95], v[112:115], v[156:159]
    v_exp_f32 v142, v142
    v_exp_f32 v143, v143
    v_mfma_f32_16x16x32_bf16 v[160:163], v[92:95], v[128:131], v[160:163]
    ds_read_b128 v[84:87], v2 offset:22528
    v_add_f32 v15, v15, v142
    s_waitcnt lgkmcnt(3)
    v_mfma_f32_16x16x32_bf16 v[164:167], v[96:99], v[112:115], v[164:167]
    v_add_f32 v15, v15, v143
    v_mfma_f32_16x16x32_bf16 v[168:171], v[96:99], v[128:131], v[168:171]
    s_add_u32 s22, s17, 0x3cc00
    s_add_u32 m0, s17, 0x1cc00
    s_nop 0
    buffer_load_dwordx4 v5, s[8:11], s22 offen sc1 lds
    ds_read_b128 v[88:91], v2 offset:23552
    v_cvt_pk_bf16_f32 v189, v142, v143
    s_waitcnt lgkmcnt(3)
    v_mfma_f32_16x16x32_bf16 v[156:159], v[100:103], v[116:119], v[156:159]
    v_exp_f32 v144, v144
    v_exp_f32 v145, v145
    v_mfma_f32_16x16x32_bf16 v[160:163], v[100:103], v[132:135], v[160:163]
    ds_read_b128 v[92:95], v3 offset:24576
    v_add_f32 v16, v16, v144
    s_waitcnt lgkmcnt(3)
    v_mfma_f32_16x16x32_bf16 v[164:167], v[104:107], v[116:119], v[164:167]
    v_add_f32 v16, v16, v145
    v_mfma_f32_16x16x32_bf16 v[168:171], v[104:107], v[132:135], v[168:171]
    ds_read_b128 v[96:99], v3 offset:25600
    v_cvt_pk_bf16_f32 v192, v144, v145
    s_waitcnt lgkmcnt(3)
    v_mfma_f32_16x16x32_bf16 v[156:159], v[84:87], v[120:123], v[156:159]
    v_exp_f32 v146, v146
    v_exp_f32 v147, v147
    v_mfma_f32_16x16x32_bf16 v[160:163], v[84:87], v[136:139], v[160:163]
    ds_read_b128 v[100:103], v3 offset:26624
    v_add_f32 v16, v16, v146
    s_waitcnt lgkmcnt(3)
    v_mfma_f32_16x16x32_bf16 v[164:167], v[88:91], v[120:123], v[164:167]
    v_add_f32 v16, v16, v147
    v_mfma_f32_16x16x32_bf16 v[168:171], v[88:91], v[136:139], v[168:171]
    ds_read_b128 v[104:107], v3 offset:27648
    v_cvt_pk_bf16_f32 v193, v146, v147
    s_waitcnt lgkmcnt(3)
    v_mfma_f32_16x16x32_bf16 v[20:23], v[92:95], v[196:199], v[20:23]
    v_exp_f32 v148, v148
    v_exp_f32 v149, v149
    v_mfma_f32_16x16x32_bf16 v[24:27], v[92:95], v[200:203], v[24:27]
    ds_read_b128 v[84:87], v3 offset:28672
    v_add_f32 v15, v15, v148
    s_waitcnt lgkmcnt(3)
    v_mfma_f32_16x16x32_bf16 v[28:31], v[96:99], v[196:199], v[28:31]
    v_add_f32 v15, v15, v149
    v_mfma_f32_16x16x32_bf16 v[32:35], v[96:99], v[200:203], v[32:35]
    ds_read_b128 v[88:91], v3 offset:29696
    v_cvt_pk_bf16_f32 v190, v148, v149
    s_waitcnt lgkmcnt(3)
    v_mfma_f32_16x16x32_bf16 v[36:39], v[100:103], v[196:199], v[36:39]
    v_exp_f32 v150, v150
    v_exp_f32 v151, v151
    v_mfma_f32_16x16x32_bf16 v[40:43], v[100:103], v[200:203], v[40:43]
    ds_read_b128 v[92:95], v3 offset:30720
    v_add_f32 v15, v15, v150
    s_waitcnt lgkmcnt(3)
    v_mfma_f32_16x16x32_bf16 v[44:47], v[104:107], v[196:199], v[44:47]
    v_add_f32 v15, v15, v151
    v_mfma_f32_16x16x32_bf16 v[48:51], v[104:107], v[200:203], v[48:51]
    ds_read_b128 v[96:99], v3 offset:31744
    v_cvt_pk_bf16_f32 v191, v150, v151
    s_waitcnt lgkmcnt(3)
    v_mfma_f32_16x16x32_bf16 v[52:55], v[84:87], v[196:199], v[52:55]
    v_exp_f32 v152, v152
    v_exp_f32 v153, v153
    v_mfma_f32_16x16x32_bf16 v[56:59], v[84:87], v[200:203], v[56:59]
    s_waitcnt vmcnt(4)
    s_barrier
    ds_read_b128 v[100:103], v2 offset:32768
    v_add_f32 v16, v16, v152
    s_waitcnt lgkmcnt(3)
    v_mfma_f32_16x16x32_bf16 v[60:63], v[88:91], v[196:199], v[60:63]
    v_add_f32 v16, v16, v153
    v_mfma_f32_16x16x32_bf16 v[64:67], v[88:91], v[200:203], v[64:67]
    ds_read_b128 v[104:107], v2 offset:33792
    v_cvt_pk_bf16_f32 v194, v152, v153
    s_waitcnt lgkmcnt(3)
    v_mfma_f32_16x16x32_bf16 v[68:71], v[92:95], v[196:199], v[68:71]
    v_exp_f32 v154, v154
    v_exp_f32 v155, v155
    v_mfma_f32_16x16x32_bf16 v[72:75], v[92:95], v[200:203], v[72:75]
    ds_read_b128 v[84:87], v2 offset:34816
    v_add_f32 v16, v16, v154
    s_waitcnt lgkmcnt(3)
    v_mfma_f32_16x16x32_bf16 v[76:79], v[96:99], v[196:199], v[76:79]
    v_add_f32 v16, v16, v155
    v_mfma_f32_16x16x32_bf16 v[80:83], v[96:99], v[200:203], v[80:83]
    ds_read_b128 v[88:91], v2 offset:35840
    v_cvt_pk_bf16_f32 v195, v154, v155
    s_waitcnt lgkmcnt(3)
    v_mfma_f32_16x16x32_bf16 v[140:143], v[100:103], v[108:111], v[172:175]
    v_exp_f32 v156, v156
    v_exp_f32 v157, v157
    v_mfma_f32_16x16x32_bf16 v[144:147], v[100:103], v[124:127], v[176:179]
    ds_read_b128 v[92:95], v2 offset:36864
    v_add_f32 v15, v15, v156
    s_waitcnt lgkmcnt(3)
    v_mfma_f32_16x16x32_bf16 v[148:151], v[104:107], v[108:111], v[172:175]
    v_add_f32 v15, v15, v157
    v_mfma_f32_16x16x32_bf16 v[152:155], v[104:107], v[124:127], v[176:179]
    ds_read_b128 v[96:99], v2 offset:37888
    v_cvt_pk_bf16_f32 v196, v156, v157
    s_waitcnt lgkmcnt(3)
    v_mfma_f32_16x16x32_bf16 v[140:143], v[84:87], v[112:115], v[140:143]
    v_exp_f32 v158, v158
    v_exp_f32 v159, v159
    v_mfma_f32_16x16x32_bf16 v[144:147], v[84:87], v[128:131], v[144:147]
    ds_read_b128 v[100:103], v2 offset:38912
    v_add_f32 v15, v15, v158
    s_waitcnt lgkmcnt(3)
    v_mfma_f32_16x16x32_bf16 v[148:151], v[88:91], v[112:115], v[148:151]
    v_add_f32 v15, v15, v159
    v_mfma_f32_16x16x32_bf16 v[152:155], v[88:91], v[128:131], v[152:155]
    ds_read_b128 v[104:107], v2 offset:39936
    v_cvt_pk_bf16_f32 v197, v158, v159
    s_waitcnt lgkmcnt(3)
    v_mfma_f32_16x16x32_bf16 v[140:143], v[92:95], v[116:119], v[140:143]
    v_exp_f32 v160, v160
    v_exp_f32 v161, v161
    v_mfma_f32_16x16x32_bf16 v[144:147], v[92:95], v[132:135], v[144:147]
    ds_read_b128 v[84:87], v2 offset:8192
    v_add_f32 v16, v16, v160
    s_waitcnt lgkmcnt(3)
    v_mfma_f32_16x16x32_bf16 v[148:151], v[96:99], v[116:119], v[148:151]
    v_add_f32 v16, v16, v161
    v_mfma_f32_16x16x32_bf16 v[152:155], v[96:99], v[132:135], v[152:155]
    ds_read_b128 v[88:91], v2 offset:9216
    v_cvt_pk_bf16_f32 v200, v160, v161
    s_bfe_u32 s22, s42, 0x30000
    s_or_b32 s22, s22, s62
    s_lshl_b32 s22, s22, 18
    s_add_u32 s22, s22, s16
    s_add_u32 s22, s22, 0x0
    s_add_u32 m0, s17, 0x0
    s_nop 0
    buffer_load_dwordx4 v17, s[4:7], s22 offen lds
    s_waitcnt lgkmcnt(3)
    v_mfma_f32_16x16x32_bf16 v[140:143], v[100:103], v[120:123], v[140:143]
    v_exp_f32 v162, v162
    v_exp_f32 v163, v163
    v_mfma_f32_16x16x32_bf16 v[144:147], v[100:103], v[136:139], v[144:147]
    ds_read_b128 v[92:95], v2 offset:10240
    v_add_f32 v16, v16, v162
    s_waitcnt lgkmcnt(3)
    v_mfma_f32_16x16x32_bf16 v[148:151], v[104:107], v[120:123], v[148:151]
    v_add_f32 v16, v16, v163
    v_mfma_f32_16x16x32_bf16 v[152:155], v[104:107], v[136:139], v[152:155]
    ds_read_b128 v[96:99], v2 offset:11264
    v_cvt_pk_bf16_f32 v201, v162, v163
    s_bfe_u32 s22, s42, 0x30000
    s_or_b32 s22, s22, s62
    s_lshl_b32 s22, s22, 18
    s_add_u32 s22, s22, s16
    s_add_u32 s22, s22, 0x2000
    s_add_u32 m0, s17, 0x400
    s_nop 0
    buffer_load_dwordx4 v18, s[4:7], s22 offen lds
    s_waitcnt lgkmcnt(3)
    v_mfma_f32_16x16x32_bf16 v[20:23], v[84:87], v[188:191], v[20:23]
    v_exp_f32 v164, v164
    v_exp_f32 v165, v165
    v_mfma_f32_16x16x32_bf16 v[24:27], v[84:87], v[192:195], v[24:27]
    ds_read_b128 v[100:103], v2 offset:12288
    v_add_f32 v15, v15, v164
    s_waitcnt lgkmcnt(3)
    v_mfma_f32_16x16x32_bf16 v[28:31], v[88:91], v[188:191], v[28:31]
    v_add_f32 v15, v15, v165
    v_mfma_f32_16x16x32_bf16 v[32:35], v[88:91], v[192:195], v[32:35]
    ds_read_b128 v[104:107], v2 offset:13312
    v_cvt_pk_bf16_f32 v198, v164, v165
    s_bfe_u32 s22, s42, 0x30000
    s_or_b32 s22, s22, s62
    s_lshl_b32 s22, s22, 18
    s_add_u32 s22, s22, s16
    s_add_u32 s22, s22, 0x4000
    s_add_u32 m0, s17, 0x800
    s_nop 0
    buffer_load_dwordx4 v17, s[4:7], s22 offen lds
    s_waitcnt lgkmcnt(3)
    v_mfma_f32_16x16x32_bf16 v[36:39], v[92:95], v[188:191], v[36:39]
    v_exp_f32 v166, v166
    v_exp_f32 v167, v167
    v_mfma_f32_16x16x32_bf16 v[40:43], v[92:95], v[192:195], v[40:43]
    ds_read_b128 v[84:87], v2 offset:14336
    v_add_f32 v15, v15, v166
    s_waitcnt lgkmcnt(3)
    v_mfma_f32_16x16x32_bf16 v[44:47], v[96:99], v[188:191], v[44:47]
    v_add_f32 v15, v15, v167
    v_mfma_f32_16x16x32_bf16 v[48:51], v[96:99], v[192:195], v[48:51]
    ds_read_b128 v[88:91], v2 offset:15360
    v_cvt_pk_bf16_f32 v199, v166, v167
    s_bfe_u32 s22, s42, 0x30000
    s_or_b32 s22, s22, s62
    s_lshl_b32 s22, s22, 18
    s_add_u32 s22, s22, s16
    s_add_u32 s22, s22, 0x6000
    s_add_u32 m0, s17, 0xc00
    s_nop 0
    buffer_load_dwordx4 v18, s[4:7], s22 offen lds
    s_waitcnt lgkmcnt(3)
    v_mfma_f32_16x16x32_bf16 v[52:55], v[100:103], v[188:191], v[52:55]
    v_exp_f32 v168, v168
    v_exp_f32 v169, v169
    v_mfma_f32_16x16x32_bf16 v[56:59], v[100:103], v[192:195], v[56:59]
    s_waitcnt vmcnt(4)
    s_barrier
    ds_read_b128 v[92:95], v2 offset:49152
    v_add_f32 v16, v16, v168
    s_waitcnt lgkmcnt(3)
    v_mfma_f32_16x16x32_bf16 v[60:63], v[104:107], v[188:191], v[60:63]
    v_add_f32 v16, v16, v169
    v_mfma_f32_16x16x32_bf16 v[64:67], v[104:107], v[192:195], v[64:67]
    ds_read_b128 v[96:99], v2 offset:50176
    v_cvt_pk_bf16_f32 v202, v168, v169
    s_waitcnt lgkmcnt(3)
    v_mfma_f32_16x16x32_bf16 v[68:71], v[84:87], v[188:191], v[68:71]
    v_exp_f32 v170, v170
    v_exp_f32 v171, v171
    v_mfma_f32_16x16x32_bf16 v[72:75], v[84:87], v[192:195], v[72:75]
    ds_read_b128 v[100:103], v2 offset:51200
    v_add_f32 v16, v16, v170
    s_waitcnt lgkmcnt(3)
    v_mfma_f32_16x16x32_bf16 v[76:79], v[88:91], v[188:191], v[76:79]
    v_add_f32 v16, v16, v171
    v_mfma_f32_16x16x32_bf16 v[80:83], v[88:91], v[192:195], v[80:83]
    ds_read_b128 v[104:107], v2 offset:52224
    v_cvt_pk_bf16_f32 v203, v170, v171
    s_waitcnt lgkmcnt(3)
    v_mfma_f32_16x16x32_bf16 v[156:159], v[92:95], v[108:111], v[172:175]
    v_exp_f32 v140, v140
    v_exp_f32 v141, v141
    v_mfma_f32_16x16x32_bf16 v[160:163], v[92:95], v[124:127], v[176:179]
    ds_read_b128 v[84:87], v2 offset:53248
    v_add_f32 v15, v15, v140
    v_lshlrev_b32 v6, 4, v8
    s_mov_b64 s[68:69], s[44:45]
    s_mov_b32 s70, 0x800
    s_mov_b32 s71, 0x20000
    v_lshlrev_b32 v7, 3, v8
    buffer_load_dwordx2 v[186:187], v7, s[68:71], 0 offen
    s_mov_b32 s26, 0xa20000
    buffer_load_dwordx4 v[236:239], v6, s[8:11], s26 offen sc1
    s_mov_b32 s26, 0xa21000
    buffer_load_dwordx4 v[240:243], v6, s[8:11], s26 offen sc1
    s_mov_b32 s26, 0xa22000
    buffer_load_dwordx4 v[244:247], v6, s[8:11], s26 offen sc1
    s_mov_b32 s26, 0xa23000
    buffer_load_dwordx4 v[248:251], v6, s[8:11], s26 offen sc1
    s_waitcnt lgkmcnt(3)
    v_mfma_f32_16x16x32_bf16 v[164:167], v[96:99], v[108:111], v[172:175]
    v_add_f32 v15, v15, v141
    v_mfma_f32_16x16x32_bf16 v[168:171], v[96:99], v[124:127], v[176:179]
    ds_read_b128 v[88:91], v2 offset:54272
    v_cvt_pk_bf16_f32 v188, v140, v141
    s_waitcnt lgkmcnt(3)
    v_mfma_f32_16x16x32_bf16 v[156:159], v[100:103], v[112:115], v[156:159]
    v_exp_f32 v142, v142
    v_exp_f32 v143, v143
    v_mfma_f32_16x16x32_bf16 v[160:163], v[100:103], v[128:131], v[160:163]
    ds_read_b128 v[92:95], v2 offset:55296
    v_add_f32 v15, v15, v142
    s_waitcnt lgkmcnt(3)
    v_mfma_f32_16x16x32_bf16 v[164:167], v[104:107], v[112:115], v[164:167]
    v_add_f32 v15, v15, v143
    v_mfma_f32_16x16x32_bf16 v[168:171], v[104:107], v[128:131], v[168:171]
    ds_read_b128 v[96:99], v2 offset:56320
    v_cvt_pk_bf16_f32 v189, v142, v143
    s_waitcnt lgkmcnt(3)
    v_mfma_f32_16x16x32_bf16 v[156:159], v[84:87], v[116:119], v[156:159]
    v_exp_f32 v144, v144
    v_exp_f32 v145, v145
    v_mfma_f32_16x16x32_bf16 v[160:163], v[84:87], v[132:135], v[160:163]
    ds_read_b128 v[100:103], v2 offset:24576
    v_add_f32 v16, v16, v144
    s_waitcnt lgkmcnt(3)
    v_mfma_f32_16x16x32_bf16 v[164:167], v[88:91], v[116:119], v[164:167]
    v_add_f32 v16, v16, v145
    v_mfma_f32_16x16x32_bf16 v[168:171], v[88:91], v[132:135], v[168:171]
    ds_read_b128 v[104:107], v2 offset:25600
    v_cvt_pk_bf16_f32 v192, v144, v145
    s_bfe_u32 s22, s42, 0x30000
    s_or_b32 s22, s22, s62
    s_lshl_b32 s22, s22, 18
    s_add_u32 s22, s22, s16
    s_add_u32 s22, s22, 0x20000
    s_add_u32 m0, s17, 0x4000
    s_nop 0
    buffer_load_dwordx4 v17, s[4:7], s22 offen lds
    s_waitcnt lgkmcnt(3)
    v_mfma_f32_16x16x32_bf16 v[156:159], v[92:95], v[120:123], v[156:159]
    v_exp_f32 v146, v146
    v_exp_f32 v147, v147
    v_mfma_f32_16x16x32_bf16 v[160:163], v[92:95], v[136:139], v[160:163]
    ds_read_b128 v[84:87], v2 offset:26624
    v_add_f32 v16, v16, v146
    s_waitcnt lgkmcnt(3)
    v_mfma_f32_16x16x32_bf16 v[164:167], v[96:99], v[120:123], v[164:167]
    v_add_f32 v16, v16, v147
    v_mfma_f32_16x16x32_bf16 v[168:171], v[96:99], v[136:139], v[168:171]
    ds_read_b128 v[88:91], v2 offset:27648
    v_cvt_pk_bf16_f32 v193, v146, v147
    s_bfe_u32 s22, s42, 0x30000
    s_or_b32 s22, s22, s62
    s_lshl_b32 s22, s22, 18
    s_add_u32 s22, s22, s16
    s_add_u32 s22, s22, 0x22000
    s_add_u32 m0, s17, 0x4400
    s_nop 0
    buffer_load_dwordx4 v18, s[4:7], s22 offen lds
    s_waitcnt lgkmcnt(3)
    v_mfma_f32_16x16x32_bf16 v[20:23], v[100:103], v[196:199], v[20:23]
    v_exp_f32 v148, v148
    v_exp_f32 v149, v149
    v_mfma_f32_16x16x32_bf16 v[24:27], v[100:103], v[200:203], v[24:27]
    ds_read_b128 v[92:95], v2 offset:28672
    v_add_f32 v15, v15, v148
    s_waitcnt lgkmcnt(3)
    v_mfma_f32_16x16x32_bf16 v[28:31], v[104:107], v[196:199], v[28:31]
    v_add_f32 v15, v15, v149
    v_mfma_f32_16x16x32_bf16 v[32:35], v[104:107], v[200:203], v[32:35]
    ds_read_b128 v[96:99], v2 offset:29696
    v_cvt_pk_bf16_f32 v190, v148, v149
    s_bfe_u32 s22, s42, 0x30000
    s_or_b32 s22, s22, s62
    s_lshl_b32 s22, s22, 18
    s_add_u32 s22, s22, s16
    s_add_u32 s22, s22, 0x24000
    s_add_u32 m0, s17, 0x4800
    s_nop 0
    buffer_load_dwordx4 v17, s[4:7], s22 offen lds
    s_waitcnt lgkmcnt(3)
    v_mfma_f32_16x16x32_bf16 v[36:39], v[84:87], v[196:199], v[36:39]
    v_exp_f32 v150, v150
    v_exp_f32 v151, v151
    v_mfma_f32_16x16x32_bf16 v[40:43], v[84:87], v[200:203], v[40:43]
    ds_read_b128 v[100:103], v2 offset:30720
    v_add_f32 v15, v15, v150
    s_waitcnt lgkmcnt(3)
    v_mfma_f32_16x16x32_bf16 v[44:47], v[88:91], v[196:199], v[44:47]
    v_add_f32 v15, v15, v151
    v_mfma_f32_16x16x32_bf16 v[48:51], v[88:91], v[200:203], v[48:51]
    ds_read_b128 v[104:107], v2 offset:31744
    v_cvt_pk_bf16_f32 v191, v150, v151
    s_bfe_u32 s22, s42, 0x30000
    s_or_b32 s22, s22, s62
    s_lshl_b32 s22, s22, 18
    s_add_u32 s22, s22, s16
    s_add_u32 s22, s22, 0x26000
    s_add_u32 m0, s17, 0x4c00
    s_nop 0
    buffer_load_dwordx4 v18, s[4:7], s22 offen lds
    s_waitcnt lgkmcnt(3)
    v_mfma_f32_16x16x32_bf16 v[52:55], v[92:95], v[196:199], v[52:55]
    v_exp_f32 v152, v152
    v_exp_f32 v153, v153
    v_mfma_f32_16x16x32_bf16 v[56:59], v[92:95], v[200:203], v[56:59]
    ds_read_b128 v[84:87], v2 offset:40960
    v_add_f32 v16, v16, v152
    s_waitcnt lgkmcnt(3)
    v_mfma_f32_16x16x32_bf16 v[60:63], v[96:99], v[196:199], v[60:63]
    v_add_f32 v16, v16, v153
    v_mfma_f32_16x16x32_bf16 v[64:67], v[96:99], v[200:203], v[64:67]
    ds_read_b128 v[88:91], v2 offset:41984
    v_cvt_pk_bf16_f32 v194, v152, v153
    s_waitcnt lgkmcnt(3)
    v_mfma_f32_16x16x32_bf16 v[68:71], v[100:103], v[196:199], v[68:71]
    v_exp_f32 v154, v154
    v_exp_f32 v155, v155
    v_mfma_f32_16x16x32_bf16 v[72:75], v[100:103], v[200:203], v[72:75]
    ds_read_b128 v[92:95], v2 offset:43008
    v_add_f32 v16, v16, v154
    s_waitcnt lgkmcnt(3)
    v_mfma_f32_16x16x32_bf16 v[76:79], v[104:107], v[196:199], v[76:79]
    v_add_f32 v16, v16, v155
    v_mfma_f32_16x16x32_bf16 v[80:83], v[104:107], v[200:203], v[80:83]
    ds_read_b128 v[96:99], v2 offset:44032
    v_cvt_pk_bf16_f32 v195, v154, v155
    s_waitcnt lgkmcnt(3)
    v_mfma_f32_16x16x32_bf16 v[20:23], v[84:87], v[188:191], v[20:23]
    v_exp_f32 v156, v156
    v_exp_f32 v157, v157
    v_add_f32 v15, v15, v156
    v_mfma_f32_16x16x32_bf16 v[24:27], v[84:87], v[192:195], v[24:27]
    ds_read_b128 v[100:103], v2 offset:45056
    v_add_f32 v15, v15, v157
    v_cvt_pk_bf16_f32 v196, v156, v157
    s_waitcnt vmcnt(7)
    v_min3_u32 v13, v236, v237, v238
    s_waitcnt vmcnt(6)
    v_min3_u32 v13, v13, v239, v240
    v_min3_u32 v13, v13, v241, v242
    s_waitcnt vmcnt(5)
    v_min3_u32 v13, v13, v243, v244
    v_min3_u32 v13, v13, v245, v246
    s_waitcnt vmcnt(4)
    v_min3_u32 v13, v13, v247, v248
    v_min3_u32 v13, v13, v249, v250
    v_min_u32 v13, v13, v251
    v_cmp_eq_u32 vcc, 0, v13
    s_cbranch_vccz fz_mfg
    s_mov_b32 s27, 0
fz_mfp:
    s_mov_b32 s26, 0xa20000
    buffer_load_dwordx4 v[236:239], v6, s[8:11], s26 offen sc1
    s_mov_b32 s26, 0xa21000
    buffer_load_dwordx4 v[240:243], v6, s[8:11], s26 offen sc1
    s_mov_b32 s26, 0xa22000
    buffer_load_dwordx4 v[244:247], v6, s[8:11], s26 offen sc1
    s_mov_b32 s26, 0xa23000
    buffer_load_dwordx4 v[248:251], v6, s[8:11], s26 offen sc1
    s_waitcnt vmcnt(0)
    v_min3_u32 v13, v236, v237, v238
    v_min3_u32 v13, v13, v239, v240
    v_min3_u32 v13, v13, v241, v242
    v_min3_u32 v13, v13, v243, v244
    v_min3_u32 v13, v13, v245, v246
    v_min3_u32 v13, v13, v247, v248
    v_min3_u32 v13, v13, v249, v250
    v_min_u32 v13, v13, v251
    v_cmp_eq_u32 vcc, 0, v13
    s_add_u32 s27, s27, 1
    s_cmp_ge_u32 s27, 65536
    s_nop 4
    s_cbranch_scc1 fz_mfg
    s_cbranch_vccnz fz_mfp
fz_mfg:
    s_mov_b32 s26, 0x07060302
    v_perm_b32 v180, v241, v240, s26
    v_perm_b32 v181, v243, v242, s26
    v_perm_b32 v182, v245, v244, s26
    v_perm_b32 v183, v247, v246, s26
    v_perm_b32 v184, v249, v248, s26
    v_perm_b32 v185, v251, v250, s26
    v_add_u32 v7, 0x20000, v7
    ds_write_b64 v7, v[180:181] offset:0
    ds_write_b64 v7, v[182:183] offset:2048
    ds_write_b64 v7, v[184:185] offset:4096
    ds_write_b64 v7, v[186:187] offset:6144
    v_and_b32 v236, 0xffff0000, v236
    v_and_b32 v237, 0xffff0000, v237
    v_and_b32 v238, 0xffff0000, v238
    v_and_b32 v239, 0xffff0000, v239
    v_add_u32 v6, 0x22000, v6
    ds_write_b128 v6, v[236:239]
    s_waitcnt lgkmcnt(0)
    v_mfma_f32_16x16x32_bf16 v[28:31], v[88:91], v[188:191], v[28:31]
    v_exp_f32 v158, v158
    v_exp_f32 v159, v159
    v_add_f32 v15, v15, v158
    v_mfma_f32_16x16x32_bf16 v[32:35], v[88:91], v[192:195], v[32:35]
    ds_read_b128 v[104:107], v2 offset:46080
    v_add_f32 v15, v15, v159
    v_cvt_pk_bf16_f32 v197, v158, v159
    v_mfma_f32_16x16x32_bf16 v[36:39], v[92:95], v[188:191], v[36:39]
    v_exp_f32 v160, v160
    v_exp_f32 v161, v161
    v_add_f32 v16, v16, v160
    v_mfma_f32_16x16x32_bf16 v[40:43], v[92:95], v[192:195], v[40:43]
    ds_read_b128 v[84:87], v2 offset:47104
    v_add_f32 v16, v16, v161
    v_cvt_pk_bf16_f32 v200, v160, v161
    v_mfma_f32_16x16x32_bf16 v[44:47], v[96:99], v[188:191], v[44:47]
    v_exp_f32 v162, v162
    v_exp_f32 v163, v163
    v_add_f32 v16, v16, v162
    v_mfma_f32_16x16x32_bf16 v[48:51], v[96:99], v[192:195], v[48:51]
    ds_read_b128 v[88:91], v2 offset:48128
    v_add_f32 v16, v16, v163
    v_cvt_pk_bf16_f32 v201, v162, v163
    v_mfma_f32_16x16x32_bf16 v[52:55], v[100:103], v[188:191], v[52:55]
    v_exp_f32 v164, v164
    v_exp_f32 v165, v165
    v_add_f32 v15, v15, v164
    v_mfma_f32_16x16x32_bf16 v[56:59], v[100:103], v[192:195], v[56:59]
    ds_read_b128 v[92:95], v2 offset:57344
    v_add_f32 v15, v15, v165
    v_cvt_pk_bf16_f32 v198, v164, v165
    s_waitcnt lgkmcnt(3)
    v_mfma_f32_16x16x32_bf16 v[60:63], v[104:107], v[188:191], v[60:63]
    v_exp_f32 v166, v166
    v_exp_f32 v167, v167
    v_add_f32 v15, v15, v166
    v_mfma_f32_16x16x32_bf16 v[64:67], v[104:107], v[192:195], v[64:67]
    ds_read_b128 v[96:99], v2 offset:58368
    v_add_f32 v15, v15, v167
    v_cvt_pk_bf16_f32 v199, v166, v167
    s_bfe_u32 s22, s42, 0x30004
    s_or_b32 s22, s22, s62
    s_lshl_b32 s22, s22, 18
    s_add_u32 s22, s22, s16
    s_add_u32 s22, s22, 0x0
    s_add_u32 m0, s17, 0x8000
    s_nop 0
    buffer_load_dwordx4 v17, s[4:7], s22 offen lds
    s_waitcnt lgkmcnt(3)
    v_mfma_f32_16x16x32_bf16 v[68:71], v[84:87], v[188:191], v[68:71]
    v_exp_f32 v168, v168
    v_exp_f32 v169, v169
    v_add_f32 v16, v16, v168
    v_mfma_f32_16x16x32_bf16 v[72:75], v[84:87], v[192:195], v[72:75]
    ds_read_b128 v[100:103], v2 offset:59392
    v_add_f32 v16, v16, v169
    v_cvt_pk_bf16_f32 v202, v168, v169
    s_waitcnt lgkmcnt(3)
    v_mfma_f32_16x16x32_bf16 v[76:79], v[88:91], v[188:191], v[76:79]
    v_exp_f32 v170, v170
    v_exp_f32 v171, v171
    v_add_f32 v16, v16, v170
    v_mfma_f32_16x16x32_bf16 v[80:83], v[88:91], v[192:195], v[80:83]
    ds_read_b128 v[104:107], v2 offset:60416
    v_add_f32 v16, v16, v171
    v_cvt_pk_bf16_f32 v203, v170, v171
    s_bfe_u32 s22, s42, 0x30004
    s_or_b32 s22, s22, s62
    s_lshl_b32 s22, s22, 18
    s_add_u32 s22, s22, s16
    s_add_u32 s22, s22, 0x2000
    s_add_u32 m0, s17, 0x8400
    s_nop 0
    buffer_load_dwordx4 v18, s[4:7], s22 offen lds
    s_waitcnt lgkmcnt(3)
    v_mfma_f32_16x16x32_bf16 v[20:23], v[92:95], v[196:199], v[20:23]
    v_mfma_f32_16x16x32_bf16 v[24:27], v[92:95], v[200:203], v[24:27]
    ds_read_b128 v[84:87], v2 offset:61440
    s_waitcnt lgkmcnt(3)
    v_mfma_f32_16x16x32_bf16 v[28:31], v[96:99], v[196:199], v[28:31]
    v_mfma_f32_16x16x32_bf16 v[32:35], v[96:99], v[200:203], v[32:35]
    ds_read_b128 v[88:91], v2 offset:62464
    s_bfe_u32 s22, s42, 0x30004
    s_or_b32 s22, s22, s62
    s_lshl_b32 s22, s22, 18
    s_add_u32 s22, s22, s16
    s_add_u32 s22, s22, 0x4000
    s_add_u32 m0, s17, 0x8800
    s_nop 0
    buffer_load_dwordx4 v17, s[4:7], s22 offen lds
    s_waitcnt lgkmcnt(3)
    v_mfma_f32_16x16x32_bf16 v[36:39], v[100:103], v[196:199], v[36:39]
    v_mfma_f32_16x16x32_bf16 v[40:43], v[100:103], v[200:203], v[40:43]
    ds_read_b128 v[92:95], v2 offset:63488
    s_waitcnt lgkmcnt(3)
    v_mfma_f32_16x16x32_bf16 v[44:47], v[104:107], v[196:199], v[44:47]
    v_mfma_f32_16x16x32_bf16 v[48:51], v[104:107], v[200:203], v[48:51]
    ds_read_b128 v[96:99], v2 offset:64512
    s_bfe_u32 s22, s42, 0x30004
    s_or_b32 s22, s22, s62
    s_lshl_b32 s22, s22, 18
    s_add_u32 s22, s22, s16
    s_add_u32 s22, s22, 0x6000
    s_add_u32 m0, s17, 0x8c00
    s_nop 0
    buffer_load_dwordx4 v18, s[4:7], s22 offen lds
    s_waitcnt lgkmcnt(3)
    v_mfma_f32_16x16x32_bf16 v[52:55], v[84:87], v[196:199], v[52:55]
    v_mfma_f32_16x16x32_bf16 v[56:59], v[84:87], v[200:203], v[56:59]
    s_waitcnt lgkmcnt(2)
    v_mfma_f32_16x16x32_bf16 v[60:63], v[88:91], v[196:199], v[60:63]
    v_mfma_f32_16x16x32_bf16 v[64:67], v[88:91], v[200:203], v[64:67]
    s_waitcnt lgkmcnt(1)
    v_mfma_f32_16x16x32_bf16 v[68:71], v[92:95], v[196:199], v[68:71]
    v_mfma_f32_16x16x32_bf16 v[72:75], v[92:95], v[200:203], v[72:75]
    s_waitcnt lgkmcnt(0)
    v_mfma_f32_16x16x32_bf16 v[76:79], v[96:99], v[196:199], v[76:79]
    v_mfma_f32_16x16x32_bf16 v[80:83], v[96:99], v[200:203], v[80:83]
    s_branch fz_chk
fz_roleB:
    s_and_b32 s20, s2, 7
    s_lshl_b32 s20, s20, 3
    s_bfe_u32 s21, s2, 0x30003
    s_add_u32 s20, s20, s21
    s_lshr_b32 s21, s2, 6
    v_lshrrev_b32 v31, 2, v8
    v_mul_u32_u24 v28, 49152, v31
    v_and_b32 v32, 3, v8
    v_lshl_add_u32 v28, v32, 4, v28
    v_lshlrev_b32 v29, 3, v31
    s_mul_i32 s22, s21, 3145728
    s_lshl_b32 s23, s20, 6
    s_add_u32 s22, s22, s23
    s_lshl_b32 s24, s21, 9
    v_mov_b32 v24, 0
    v_mov_b32 v25, 0
    v_mov_b32 v26, 0
    v_mov_b32 v27, 0
    v_lshlrev_b32 v33, 3, v8
    s_lshl_b32 s26, s2, 11
    s_add_u32 s26, s26, 0xa00000
    s_sub_u32 s19, s3, 4
    v_mov_b32 v39, 0x20200
    ds_write_b32 v39, v24
    s_waitcnt lgkmcnt(0)
    s_mov_b64 s[8:9], s[60:61]
    s_mov_b64 s[64:65], s[52:53]
    s_mov_b32 s66, 0x800
    s_mov_b32 s67, 0x20000
    s_mov_b64 s[68:69], s[54:55]
    s_mov_b32 s70, 0xc00000
    s_mov_b32 s71, 0x20000
    s_mov_b64 s[4:5], s[38:39]
    s_mov_b32 s6, 0x800000
    s_mov_b32 s7, 0x20000
    buffer_store_dwordx2 v[24:25], v33, s[8:11], s26 offen sc1
    buffer_load_dwordx2 v[60:61], v29, s[64:67], s24 offen
    s_add_u32 s25, s22, 0
    buffer_load_dwordx4 v[44:47], v28, s[68:71], s25 offen
    s_add_u32 s25, s22, 12288
    buffer_load_dwordx4 v[48:51], v28, s[68:71], s25 offen
    s_add_u32 s25, s22, 24576
    buffer_load_dwordx4 v[52:55], v28, s[68:71], s25 offen
    s_add_u32 s25, s22, 36864
    buffer_load_dwordx4 v[56:59], v28, s[68:71], s25 offen
    s_mov_b32 s27, 0x570000
    buffer_load_dword v20, v24, s[8:11], s27 offen sc1
    s_cmp_lg_u32 s3, 4
    s_cbranch_scc1 fz_ncp
    s_getpc_b64 s[22:23]
fz_pc:
    s_add_u32 s22, s22, fz_start-fz_pc
    s_addc_u32 s23, s23, -1
    s_lshr_b32 s24, s2, 3
    s_lshl_b32 s24, s24, 12
    v_lshl_add_u32 v35, v0, 7, s24
    v_min_u32 v35, fz_end-fz_start, v35
    s_mov_b64 exec, 0xffffffff
    global_load_dword v7, v35, s[22:23]
    s_mov_b64 exec, -1
fz_ncp:
    s_barrier
    v_lshrrev_b32 v34, 4, v0
    s_waitcnt vmcnt(5)
    v_lshlrev_b32 v62, 16, v61
    v_and_b32 v63, 0xffff0000, v61
    v_and_b32 v61, 0xffff0000, v60
    v_lshlrev_b32 v60, 16, v60
    v_mul_f32 v72, 0xbfb8aa3b, v60
    v_exp_f32 v72, v72
    s_nop 0
    v_add_f32 v72, 1.0, v72
    v_rcp_f32 v72, v72
    s_nop 0
    v_mul_f32 v60, v60, v72
    v_mul_f32 v73, 0xbfb8aa3b, v61
    v_exp_f32 v73, v73
    s_nop 0
    v_add_f32 v73, 1.0, v73
    v_rcp_f32 v73, v73
    s_nop 0
    v_mul_f32 v61, v61, v73
    v_mul_f32 v74, 0xbfb8aa3b, v62
    v_exp_f32 v74, v74
    s_nop 0
    v_add_f32 v74, 1.0, v74
    v_rcp_f32 v74, v74
    s_nop 0
    v_mul_f32 v62, v62, v74
    v_mul_f32 v75, 0xbfb8aa3b, v63
    v_exp_f32 v75, v75
    s_nop 0
    v_add_f32 v75, 1.0, v75
    v_rcp_f32 v75, v75
    s_nop 0
    v_mul_f32 v63, v63, v75
    v_cvt_pk_bf16_f32 v72, v60, v61
    v_lshlrev_b32 v60, 16, v72
    v_and_b32 v61, 0xffff0000, v72
    v_cvt_pk_bf16_f32 v73, v62, v63
    v_lshlrev_b32 v62, 16, v73
    v_and_b32 v63, 0xffff0000, v73
    s_waitcnt vmcnt(4)
    v_lshlrev_b32 v72, 16, v44
    v_and_b32 v73, 0xffff0000, v44
    v_lshlrev_b32 v74, 16, v45
    v_and_b32 v75, 0xffff0000, v45
    v_lshlrev_b32 v76, 16, v46
    v_and_b32 v77, 0xffff0000, v46
    v_lshlrev_b32 v78, 16, v47
    v_and_b32 v79, 0xffff0000, v47
    v_mul_f32 v64, v60, v72
    v_mul_f32 v65, v60, v73
    v_mul_f32 v66, v60, v74
    v_mul_f32 v67, v60, v75
    v_mul_f32 v68, v60, v76
    v_mul_f32 v69, v60, v77
    v_mul_f32 v70, v60, v78
    v_mul_f32 v71, v60, v79
    s_waitcnt vmcnt(3)
    v_lshlrev_b32 v72, 16, v48
    v_and_b32 v73, 0xffff0000, v48
    v_lshlrev_b32 v74, 16, v49
    v_and_b32 v75, 0xffff0000, v49
    v_lshlrev_b32 v76, 16, v50
    v_and_b32 v77, 0xffff0000, v50
    v_lshlrev_b32 v78, 16, v51
    v_and_b32 v79, 0xffff0000, v51
    v_fmac_f32 v64, v61, v72
    v_fmac_f32 v65, v61, v73
    v_fmac_f32 v66, v61, v74
    v_fmac_f32 v67, v61, v75
    v_fmac_f32 v68, v61, v76
    v_fmac_f32 v69, v61, v77
    v_fmac_f32 v70, v61, v78
    v_fmac_f32 v71, v61, v79
    s_waitcnt vmcnt(2)
    v_lshlrev_b32 v72, 16, v52
    v_and_b32 v73, 0xffff0000, v52
    v_lshlrev_b32 v74, 16, v53
    v_and_b32 v75, 0xffff0000, v53
    v_lshlrev_b32 v76, 16, v54
    v_and_b32 v77, 0xffff0000, v54
    v_lshlrev_b32 v78, 16, v55
    v_and_b32 v79, 0xffff0000, v55
    v_fmac_f32 v64, v62, v72
    v_fmac_f32 v65, v62, v73
    v_fmac_f32 v66, v62, v74
    v_fmac_f32 v67, v62, v75
    v_fmac_f32 v68, v62, v76
    v_fmac_f32 v69, v62, v77
    v_fmac_f32 v70, v62, v78
    v_fmac_f32 v71, v62, v79
    s_waitcnt vmcnt(1)
    v_lshlrev_b32 v72, 16, v56
    v_and_b32 v73, 0xffff0000, v56
    v_lshlrev_b32 v74, 16, v57
    v_and_b32 v75, 0xffff0000, v57
    v_lshlrev_b32 v76, 16, v58
    v_and_b32 v77, 0xffff0000, v58
    v_lshlrev_b32 v78, 16, v59
    v_and_b32 v79, 0xffff0000, v59
    v_fmac_f32 v64, v63, v72
    v_fmac_f32 v65, v63, v73
    v_fmac_f32 v66, v63, v74
    v_fmac_f32 v67, v63, v75
    v_fmac_f32 v68, v63, v76
    v_fmac_f32 v69, v63, v77
    v_fmac_f32 v70, v63, v78
    v_fmac_f32 v71, v63, v79
    v_permlane32_swap_b32 v64, v68
    v_permlane32_swap_b32 v65, v69
    v_permlane32_swap_b32 v66, v70
    v_permlane32_swap_b32 v67, v71
    v_add_f32 v64, v64, v68
    v_add_f32 v65, v65, v69
    v_add_f32 v66, v66, v70
    v_add_f32 v67, v67, v71
    s_nop 0
    v_permlane16_swap_b32 v64, v66
    v_permlane16_swap_b32 v65, v67
    v_add_f32 v64, v64, v66
    v_add_f32 v65, v65, v67
    s_nop 0
    v_add_f32_dpp v64, v64, v64 row_ror:8 row_mask:0xf bank_mask:0xf
    v_add_f32_dpp v65, v65, v65 row_ror:8 row_mask:0xf bank_mask:0xf
    s_nop 0
    v_add_f32_dpp v64, v64, v64 row_ror:4 row_mask:0xf bank_mask:0xf
    v_add_f32_dpp v65, v65, v65 row_ror:4 row_mask:0xf bank_mask:0xf
    v_lshlrev_b32 v36, 5, v32
    v_lshl_add_u32 v36, v34, 3, v36
    s_lshl_b32 s26, s19, 7
    s_add_u32 s26, s26, 0x20000
    v_add_u32 v36, s26, v36
    ds_write_b64 v36, v[64:65]
    v_mov_b32 v40, 1
    s_mov_b64 exec, 1
    ds_add_rtn_u32 v40, v39, v40
    s_mov_b64 exec, -1
    s_waitcnt vmcnt(0)
    v_readfirstlane_b32 s14, v20
    s_add_u32 s14, s14, 1
    v_add_u32 v37, 0x20000, v1
    s_waitcnt lgkmcnt(0)
    v_readfirstlane_b32 s26, v40
    s_cmp_lg_u32 s26, 3
    s_cbranch_scc1 fz_np
    ds_read_b128 v[80:83], v37 offset:0
    ds_read_b128 v[84:87], v37 offset:128
    ds_read_b128 v[88:91], v37 offset:256
    ds_read_b128 v[92:95], v37 offset:384
    v_mov_b32 v30, 0xff
    s_lshl_b32 s26, s21, 13
    s_lshl_b32 s27, s20, 7
    s_add_u32 s26, s26, s27
    s_add_u32 s26, s26, 0x500000
    s_waitcnt lgkmcnt(2)
    v_pk_add_f32 v[80:81], v[80:81], v[84:85]
    v_pk_add_f32 v[82:83], v[82:83], v[86:87]
    s_waitcnt lgkmcnt(0)
    v_pk_add_f32 v[88:89], v[88:89], v[92:93]
    v_pk_add_f32 v[90:91], v[90:91], v[94:95]
    v_pk_add_f32 v[80:81], v[80:81], v[88:89]
    v_pk_add_f32 v[82:83], v[82:83], v[90:91]
    v_bfi_b32 v80, v30, s14, v80
    s_lshr_b32 s27, s14, 8
    v_bfi_b32 v81, v30, s27, v81
    s_lshr_b32 s27, s14, 16
    v_bfi_b32 v82, v30, s27, v82
    s_lshr_b32 s27, s14, 24
    v_bfi_b32 v83, v30, s27, v83
    s_mov_b64 exec, 0xff
    buffer_store_dwordx4 v[80:83], v1, s[8:11], s26 offen sc1
    s_mov_b64 exec, -1
    s_waitcnt vmcnt(0)
fz_np:
    s_waitcnt vmcnt(0)
    s_barrier
    v_lshlrev_b32 v38, 4, v8
    s_mov_b32 s24, 0x0c0c0400
    s_mov_b32 s25, 0x04000c0c
    s_mov_b32 s27, 0
fz_gp:
    s_mov_b32 s21, 0x500000
    buffer_load_dwordx4 v[96:99], v38, s[8:11], s21 offen sc1
    s_mov_b32 s21, 0x501000
    buffer_load_dwordx4 v[100:103], v38, s[8:11], s21 offen sc1
    s_mov_b32 s21, 0x502000
    buffer_load_dwordx4 v[104:107], v38, s[8:11], s21 offen sc1
    s_mov_b32 s21, 0x503000
    buffer_load_dwordx4 v[108:111], v38, s[8:11], s21 offen sc1
    s_mov_b32 s21, 0x504000
    buffer_load_dwordx4 v[112:115], v38, s[8:11], s21 offen sc1
    s_mov_b32 s21, 0x505000
    buffer_load_dwordx4 v[116:119], v38, s[8:11], s21 offen sc1
    s_mov_b32 s21, 0x506000
    buffer_load_dwordx4 v[120:123], v38, s[8:11], s21 offen sc1
    s_mov_b32 s21, 0x507000
    buffer_load_dwordx4 v[124:127], v38, s[8:11], s21 offen sc1
    s_waitcnt vmcnt(7)
    v_perm_b32 v36, v97, v96, s24
    v_perm_b32 v37, v99, v98, s25
    v_or_b32 v36, v36, v37
    v_xor_b32 v35, s14, v36
    s_waitcnt vmcnt(6)
    v_perm_b32 v36, v101, v100, s24
    v_perm_b32 v37, v103, v102, s25
    v_or_b32 v36, v36, v37
    v_xor_b32 v36, s14, v36
    v_or_b32 v35, v35, v36
    s_waitcnt vmcnt(5)
    v_perm_b32 v36, v105, v104, s24
    v_perm_b32 v37, v107, v106, s25
    v_or_b32 v36, v36, v37
    v_xor_b32 v36, s14, v36
    v_or_b32 v35, v35, v36
    s_waitcnt vmcnt(4)
    v_perm_b32 v36, v109, v108, s24
    v_perm_b32 v37, v111, v110, s25
    v_or_b32 v36, v36, v37
    v_xor_b32 v36, s14, v36
    v_or_b32 v35, v35, v36
    s_waitcnt vmcnt(3)
    v_perm_b32 v36, v113, v112, s24
    v_perm_b32 v37, v115, v114, s25
    v_or_b32 v36, v36, v37
    v_xor_b32 v36, s14, v36
    v_or_b32 v35, v35, v36
    s_waitcnt vmcnt(2)
    v_perm_b32 v36, v117, v116, s24
    v_perm_b32 v37, v119, v118, s25
    v_or_b32 v36, v36, v37
    v_xor_b32 v36, s14, v36
    v_or_b32 v35, v35, v36
    s_waitcnt vmcnt(1)
    v_perm_b32 v36, v121, v120, s24
    v_perm_b32 v37, v123, v122, s25
    v_or_b32 v36, v36, v37
    v_xor_b32 v36, s14, v36
    v_or_b32 v35, v35, v36
    s_waitcnt vmcnt(0)
    v_perm_b32 v36, v125, v124, s24
    v_perm_b32 v37, v127, v126, s25
    v_or_b32 v36, v36, v37
    v_xor_b32 v36, s14, v36
    v_or_b32 v35, v35, v36
    v_cmp_ne_u32 vcc, 0, v35
    s_add_u32 s27, s27, 1
    s_cmp_ge_u32 s27, 65536
    s_cbranch_scc1 fz_gg
    s_cbranch_vccz fz_gg
    s_sleep 1
    s_branch fz_gp
fz_gg:
    v_and_b32 v96, 0xffffff00, v96
    v_and_b32 v97, 0xffffff00, v97
    v_and_b32 v98, 0xffffff00, v98
    v_and_b32 v99, 0xffffff00, v99
    v_and_b32 v100, 0xffffff00, v100
    v_and_b32 v101, 0xffffff00, v101
    v_and_b32 v102, 0xffffff00, v102
    v_and_b32 v103, 0xffffff00, v103
    v_and_b32 v104, 0xffffff00, v104
    v_and_b32 v105, 0xffffff00, v105
    v_and_b32 v106, 0xffffff00, v106
    v_and_b32 v107, 0xffffff00, v107
    v_and_b32 v108, 0xffffff00, v108
    v_and_b32 v109, 0xffffff00, v109
    v_and_b32 v110, 0xffffff00, v110
    v_and_b32 v111, 0xffffff00, v111
    v_and_b32 v112, 0xffffff00, v112
    v_and_b32 v113, 0xffffff00, v113
    v_and_b32 v114, 0xffffff00, v114
    v_and_b32 v115, 0xffffff00, v115
    v_and_b32 v116, 0xffffff00, v116
    v_and_b32 v117, 0xffffff00, v117
    v_and_b32 v118, 0xffffff00, v118
    v_and_b32 v119, 0xffffff00, v119
    v_and_b32 v120, 0xffffff00, v120
    v_and_b32 v121, 0xffffff00, v121
    v_and_b32 v122, 0xffffff00, v122
    v_and_b32 v123, 0xffffff00, v123
    v_and_b32 v124, 0xffffff00, v124
    v_and_b32 v125, 0xffffff00, v125
    v_and_b32 v126, 0xffffff00, v126
    v_and_b32 v127, 0xffffff00, v127
    v_pk_add_f32 v[96:97], v[96:97], v[112:113]
    v_pk_add_f32 v[98:99], v[98:99], v[114:115]
    v_pk_add_f32 v[100:101], v[100:101], v[116:117]
    v_pk_add_f32 v[102:103], v[102:103], v[118:119]
    v_pk_add_f32 v[104:105], v[104:105], v[120:121]
    v_pk_add_f32 v[106:107], v[106:107], v[122:123]
    v_pk_add_f32 v[108:109], v[108:109], v[124:125]
    v_pk_add_f32 v[110:111], v[110:111], v[126:127]
    v_pk_add_f32 v[96:97], v[96:97], v[104:105]
    v_pk_add_f32 v[98:99], v[98:99], v[106:107]
    v_pk_add_f32 v[100:101], v[100:101], v[108:109]
    v_pk_add_f32 v[102:103], v[102:103], v[110:111]
    v_cvt_pk_bf16_f32 v31, v96, v97
    v_lshlrev_b32 v96, 16, v31
    v_and_b32 v97, 0xffff0000, v31
    v_cvt_pk_bf16_f32 v31, v98, v99
    v_lshlrev_b32 v98, 16, v31
    v_and_b32 v99, 0xffff0000, v31
    v_cvt_pk_bf16_f32 v31, v100, v101
    v_lshlrev_b32 v100, 16, v31
    v_and_b32 v101, 0xffff0000, v31
    v_cvt_pk_bf16_f32 v31, v102, v103
    v_lshlrev_b32 v102, 16, v31
    v_and_b32 v103, 0xffff0000, v31
    v_add_f32 v100, 1.0, v100
    v_add_f32 v101, 1.0, v101
    v_add_f32 v102, 1.0, v102
    v_add_f32 v103, 1.0, v103
    v_cvt_pk_bf16_f32 v31, v100, v101
    v_lshlrev_b32 v100, 16, v31
    v_and_b32 v101, 0xffff0000, v31
    v_cvt_pk_bf16_f32 v31, v102, v103
    v_lshlrev_b32 v102, 16, v31
    v_and_b32 v103, 0xffff0000, v31
    v_add_u32 v38, 0x21000, v38
    ds_write_b128 v38, v[96:99]
    ds_write_b128 v38, v[100:103] offset:4096
    s_waitcnt lgkmcnt(0)
    s_barrier
    s_barrier
    s_lshl_b32 s26, s13, 5
    s_lshl_b32 s25, s3, 2
    s_add_u32 s26, s26, s25
    v_bfe_u32 v9, v0, 2, 2
    v_lshlrev_b32 v9, 7, v9
    v_and_b32 v10, 3, v0
    v_lshl_add_u32 v9, v10, 2, v9
    s_lshl_b32 s26, s26, 7
    s_add_u32 s26, s26, 0x510000
    s_mov_b32 s27, 0
fz_hBp:
    buffer_load_dword v10, v9, s[8:11], s26 offen sc1
    s_waitcnt vmcnt(0)
    v_cmp_ne_u32 vcc, s14, v10
    s_add_u32 s27, s27, 1
    s_cmp_ge_u32 s27, 65536
    s_cbranch_scc1 fz_hBg
    s_cbranch_vccz fz_hBg
    s_sleep 4
    s_branch fz_hBp
fz_hBg:
    s_mov_b32 s23, 0x0
    buffer_load_dwordx4 v[204:207], v4, s[8:11], s23 offen offset:0 sc1
    s_mov_b32 s23, 0x8000
    buffer_load_dwordx4 v[208:211], v4, s[8:11], s23 offen offset:0 sc1
    s_mov_b32 s23, 0x0
    buffer_load_dwordx4 v[212:215], v4, s[8:11], s23 offen offset:1024 sc1
    s_mov_b32 s23, 0x8000
    buffer_load_dwordx4 v[216:219], v4, s[8:11], s23 offen offset:1024 sc1
    s_barrier
    ds_read_b64_tr_b16 v[84:85], v3 offset:0
    ds_read_b64_tr_b16 v[86:87], v3 offset:1024
    ds_read_b64_tr_b16 v[88:89], v15 offset:32
    ds_read_b64_tr_b16 v[90:91], v15 offset:1056
    ds_read_b64_tr_b16 v[92:93], v3 offset:256
    ds_read_b64_tr_b16 v[94:95], v3 offset:1280
    ds_read_b64_tr_b16 v[96:97], v15 offset:288
    ds_read_b64_tr_b16 v[98:99], v15 offset:1312
    s_waitcnt vmcnt(3) lgkmcnt(6)
    v_mfma_f32_16x16x32_bf16 v[20:23], v[84:87], v[204:207], 0
    s_mov_b32 s23, 0x800
    buffer_load_dwordx4 v[220:223], v4, s[8:11], s23 offen offset:0 sc1
    ds_read_b64_tr_b16 v[100:101], v3 offset:512
    s_sub_u32 s26, s3, 4
    s_lshl_b32 s26, s26, 3
    v_add_u32 v17, s26, v0
    v_lshrrev_b32 v18, 4, v17
    v_lshlrev_b32 v18, 13, v18
    v_and_b32 v17, 15, v17
    v_lshl_add_u32 v17, v17, 7, v18
    s_lshr_b32 s26, s2, 3
    s_lshl_b32 s26, s26, 14
    s_and_b32 s27, s2, 3
    s_lshl_b32 s27, s27, 11
    s_add_u32 s26, s26, s27
    v_add_u32 v17, s26, v17
    v_cmp_gt_u32 vcc, 8, v0
    v_bfrev_b32 v18, -2
    s_nop 0
    v_cndmask_b32 v17, v18, v17, vcc
    s_mov_b64 s[68:69], s[38:39]
    s_mov_b32 s70, 0x800000
    s_mov_b32 s71, 0x20000
    s_waitcnt vmcnt(3)
    v_mfma_f32_16x16x32_bf16 v[24:27], v[84:87], v[208:211], 0
    ds_read_b64_tr_b16 v[102:103], v3 offset:1536
    s_mov_b32 s26, 0x180000
    buffer_load_dword v18, v17, s[68:71], s26 offen
    s_waitcnt lgkmcnt(6)
    v_mfma_f32_16x16x32_bf16 v[28:31], v[88:91], v[204:207], 0
    s_mov_b32 s23, 0x8800
    buffer_load_dwordx4 v[224:227], v4, s[8:11], s23 offen offset:0 sc1
    ds_read_b64_tr_b16 v[104:105], v15 offset:544
    v_mfma_f32_16x16x32_bf16 v[32:35], v[88:91], v[208:211], 0
    ds_read_b64_tr_b16 v[106:107], v15 offset:1568
    s_mov_b32 s23, 0x1000
    buffer_load_dwordx4 v[140:143], v4, s[8:11], s23 offen offset:0 sc1
    s_waitcnt lgkmcnt(6)
    v_mfma_f32_16x16x32_bf16 v[36:39], v[92:95], v[204:207], 0
    s_mov_b32 s23, 0x800
    buffer_load_dwordx4 v[228:231], v4, s[8:11], s23 offen offset:1024 sc1
    ds_read_b64_tr_b16 v[84:85], v3 offset:768
    v_mfma_f32_16x16x32_bf16 v[40:43], v[92:95], v[208:211], 0
    ds_read_b64_tr_b16 v[86:87], v3 offset:1792
    s_waitcnt lgkmcnt(6)
    v_mfma_f32_16x16x32_bf16 v[44:47], v[96:99], v[204:207], 0
    s_mov_b32 s23, 0x8800
    buffer_load_dwordx4 v[232:235], v4, s[8:11], s23 offen offset:1024 sc1
    ds_read_b64_tr_b16 v[88:89], v15 offset:800
    v_mfma_f32_16x16x32_bf16 v[48:51], v[96:99], v[208:211], 0
    ds_read_b64_tr_b16 v[90:91], v15 offset:1824
    s_mov_b32 s26, 0x200000
    buffer_load_dword v18, v17, s[68:71], s26 offen
    s_waitcnt lgkmcnt(6)
    v_mfma_f32_16x16x32_bf16 v[52:55], v[100:103], v[204:207], 0
    ds_read_b64_tr_b16 v[92:93], v3 offset:8192
    v_mfma_f32_16x16x32_bf16 v[56:59], v[100:103], v[208:211], 0
    ds_read_b64_tr_b16 v[94:95], v3 offset:9216
    s_waitcnt lgkmcnt(6)
    v_mfma_f32_16x16x32_bf16 v[60:63], v[104:107], v[204:207], 0
    ds_read_b64_tr_b16 v[96:97], v15 offset:8224
    v_mfma_f32_16x16x32_bf16 v[64:67], v[104:107], v[208:211], 0
    ds_read_b64_tr_b16 v[98:99], v15 offset:9248
    s_mov_b32 s23, 0x9000
    buffer_load_dwordx4 v[144:147], v4, s[8:11], s23 offen offset:0 sc1
    s_waitcnt lgkmcnt(6)
    v_mfma_f32_16x16x32_bf16 v[68:71], v[84:87], v[204:207], 0
    ds_read_b64_tr_b16 v[100:101], v3 offset:8448
    v_mfma_f32_16x16x32_bf16 v[72:75], v[84:87], v[208:211], 0
    ds_read_b64_tr_b16 v[102:103], v3 offset:9472
    s_waitcnt lgkmcnt(6)
    v_mfma_f32_16x16x32_bf16 v[76:79], v[88:91], v[204:207], 0
    ds_read_b64_tr_b16 v[104:105], v15 offset:8480
    v_mfma_f32_16x16x32_bf16 v[80:83], v[88:91], v[208:211], 0
    ds_read_b64_tr_b16 v[106:107], v15 offset:9504
    s_waitcnt vmcnt(9) lgkmcnt(6)
    v_mfma_f32_16x16x32_bf16 v[20:23], v[92:95], v[212:215], v[20:23]
    ds_read_b64_tr_b16 v[84:85], v3 offset:8704
    s_waitcnt vmcnt(8)
    v_mfma_f32_16x16x32_bf16 v[24:27], v[92:95], v[216:219], v[24:27]
    ds_read_b64_tr_b16 v[86:87], v3 offset:9728
    s_waitcnt lgkmcnt(6)
    v_mfma_f32_16x16x32_bf16 v[28:31], v[96:99], v[212:215], v[28:31]
    ds_read_b64_tr_b16 v[88:89], v15 offset:8736
    v_mfma_f32_16x16x32_bf16 v[32:35], v[96:99], v[216:219], v[32:35]
    ds_read_b64_tr_b16 v[90:91], v15 offset:9760
    s_mov_b32 s23, 0x1000
    buffer_load_dwordx4 v[148:151], v4, s[8:11], s23 offen offset:1024 sc1
    s_waitcnt lgkmcnt(6)
    v_mfma_f32_16x16x32_bf16 v[36:39], v[100:103], v[212:215], v[36:39]
    ds_read_b64_tr_b16 v[92:93], v3 offset:8960
    v_mfma_f32_16x16x32_bf16 v[40:43], v[100:103], v[216:219], v[40:43]
    ds_read_b64_tr_b16 v[94:95], v3 offset:9984
    s_waitcnt lgkmcnt(6)
    v_mfma_f32_16x16x32_bf16 v[44:47], v[104:107], v[212:215], v[44:47]
    ds_read_b64_tr_b16 v[96:97], v15 offset:8992
    v_mfma_f32_16x16x32_bf16 v[48:51], v[104:107], v[216:219], v[48:51]
    ds_read_b64_tr_b16 v[98:99], v15 offset:10016
    s_waitcnt lgkmcnt(6)
    v_mfma_f32_16x16x32_bf16 v[52:55], v[84:87], v[212:215], v[52:55]
    v_mfma_f32_16x16x32_bf16 v[56:59], v[84:87], v[216:219], v[56:59]
    s_barrier
    ds_read_b64_tr_b16 v[100:101], v3 offset:16384
    ds_read_b64_tr_b16 v[102:103], v3 offset:17408
    s_waitcnt lgkmcnt(6)
    v_mfma_f32_16x16x32_bf16 v[60:63], v[88:91], v[212:215], v[60:63]
    ds_read_b64_tr_b16 v[104:105], v15 offset:16416
    v_mfma_f32_16x16x32_bf16 v[64:67], v[88:91], v[216:219], v[64:67]
    ds_read_b64_tr_b16 v[106:107], v15 offset:17440
    s_mov_b32 s23, 0x9000
    buffer_load_dwordx4 v[152:155], v4, s[8:11], s23 offen offset:1024 sc1
    s_waitcnt lgkmcnt(6)
    v_mfma_f32_16x16x32_bf16 v[68:71], v[92:95], v[212:215], v[68:71]
    ds_read_b64_tr_b16 v[84:85], v3 offset:16640
    v_mfma_f32_16x16x32_bf16 v[72:75], v[92:95], v[216:219], v[72:75]
    ds_read_b64_tr_b16 v[86:87], v3 offset:17664
    s_waitcnt lgkmcnt(6)
    v_mfma_f32_16x16x32_bf16 v[76:79], v[96:99], v[212:215], v[76:79]
    ds_read_b64_tr_b16 v[88:89], v15 offset:16672
    v_mfma_f32_16x16x32_bf16 v[80:83], v[96:99], v[216:219], v[80:83]
    ds_read_b64_tr_b16 v[90:91], v15 offset:17696
    s_waitcnt vmcnt(9) lgkmcnt(6)
    v_mfma_f32_16x16x32_bf16 v[20:23], v[100:103], v[220:223], v[20:23]
    ds_read_b64_tr_b16 v[92:93], v3 offset:16896
    s_waitcnt vmcnt(7)
    v_mfma_f32_16x16x32_bf16 v[24:27], v[100:103], v[224:227], v[24:27]
    ds_read_b64_tr_b16 v[94:95], v3 offset:17920
    s_sub_u32 s19, s3, 4
    s_lshl_b32 s25, s2, 2
    s_add_u32 s63, s25, s19
    s_lshr_b32 s20, s63, 8
    s_bfe_u32 s21, s63, 0x40004
    s_and_b32 s24, s63, 15
    s_lshl_b32 s20, s20, 19
    s_lshl_b32 s21, s21, 13
    s_add_u32 s20, s20, s21
    s_add_u32 s20, s20, 393216
    v_and_b32 v168, 15, v0
    v_lshrrev_b32 v169, 4, v0
    s_mov_b64 s[28:29], s[34:35]
    s_mov_b32 s30, 0x200000
    s_mov_b32 s31, 0x20000
    s_cmp_lt_u32 s24, 8
    s_cselect_b32 s30, s30, 0
    v_lshlrev_b32 v170, 8, v168
    v_lshl_add_u32 v170, v169, 3, v170
    s_and_b32 s26, s24, 1
    s_lshl_b32 s26, s26, 12
    s_add_u32 s21, s20, s26
    s_bfe_u32 s26, s24, 0x20001
    s_lshl_b32 s26, s26, 6
    s_add_u32 s21, s21, s26
    buffer_load_dwordx2 v[156:157], v170, s[28:31], s21 offen
    buffer_load_dwordx2 v[158:159], v170, s[28:31], s21 offen offset:32
    s_mov_b64 s[64:65], s[36:37]
    s_mov_b32 s66, 0x200000
    s_mov_b32 s67, 0x20000
    s_cmp_ge_u32 s24, 8
    s_cselect_b32 s66, s66, 0
    s_and_b32 s26, s24, 7
    s_lshl_b32 s26, s26, 5
    s_add_u32 s20, s20, s26
    s_add_u32 s26, s20, 4096
    v_lshlrev_b32 v171, 10, v169
    v_lshl_add_u32 v171, v168, 1, v171
    buffer_load_ushort v160, v171, s[64:67], s20 offen offset:0
    buffer_load_ushort v161, v171, s[64:67], s20 offen offset:256
    buffer_load_ushort v162, v171, s[64:67], s20 offen offset:512
    buffer_load_ushort v163, v171, s[64:67], s20 offen offset:768
    buffer_load_ushort v164, v171, s[64:67], s26 offen offset:0
    buffer_load_ushort v165, v171, s[64:67], s26 offen offset:256
    buffer_load_ushort v166, v171, s[64:67], s26 offen offset:512
    buffer_load_ushort v167, v171, s[64:67], s26 offen offset:768
    s_waitcnt lgkmcnt(6)
    v_mfma_f32_16x16x32_bf16 v[28:31], v[104:107], v[220:223], v[28:31]
    ds_read_b64_tr_b16 v[96:97], v15 offset:16928
    v_mfma_f32_16x16x32_bf16 v[32:35], v[104:107], v[224:227], v[32:35]
    ds_read_b64_tr_b16 v[98:99], v15 offset:17952
    s_mov_b32 s23, 0x1800
    buffer_load_dwordx4 v[204:207], v4, s[8:11], s23 offen offset:0 sc1
    s_waitcnt lgkmcnt(6)
    v_mfma_f32_16x16x32_bf16 v[36:39], v[84:87], v[220:223], v[36:39]
    ds_read_b64_tr_b16 v[100:101], v3 offset:17152
    v_mfma_f32_16x16x32_bf16 v[40:43], v[84:87], v[224:227], v[40:43]
    ds_read_b64_tr_b16 v[102:103], v3 offset:18176
    s_waitcnt lgkmcnt(6)
    v_mfma_f32_16x16x32_bf16 v[44:47], v[88:91], v[220:223], v[44:47]
    ds_read_b64_tr_b16 v[104:105], v15 offset:17184
    v_mfma_f32_16x16x32_bf16 v[48:51], v[88:91], v[224:227], v[48:51]
    ds_read_b64_tr_b16 v[106:107], v15 offset:18208
    s_mov_b32 s26, 0x280000
    buffer_load_dword v18, v17, s[68:71], s26 offen
    s_waitcnt lgkmcnt(6)
    v_mfma_f32_16x16x32_bf16 v[52:55], v[92:95], v[220:223], v[52:55]
    ds_read_b64_tr_b16 v[84:85], v3 offset:24576
    v_mfma_f32_16x16x32_bf16 v[56:59], v[92:95], v[224:227], v[56:59]
    ds_read_b64_tr_b16 v[86:87], v3 offset:25600
    s_waitcnt lgkmcnt(6)
    v_mfma_f32_16x16x32_bf16 v[60:63], v[96:99], v[220:223], v[60:63]
    ds_read_b64_tr_b16 v[88:89], v15 offset:24608
    v_mfma_f32_16x16x32_bf16 v[64:67], v[96:99], v[224:227], v[64:67]
    ds_read_b64_tr_b16 v[90:91], v15 offset:25632
    s_mov_b32 s23, 0x9800
    buffer_load_dwordx4 v[208:211], v4, s[8:11], s23 offen offset:0 sc1
    s_waitcnt lgkmcnt(6)
    v_mfma_f32_16x16x32_bf16 v[68:71], v[100:103], v[220:223], v[68:71]
    ds_read_b64_tr_b16 v[92:93], v3 offset:24832
    v_mfma_f32_16x16x32_bf16 v[72:75], v[100:103], v[224:227], v[72:75]
    ds_read_b64_tr_b16 v[94:95], v3 offset:25856
    s_waitcnt lgkmcnt(6)
    v_mfma_f32_16x16x32_bf16 v[76:79], v[104:107], v[220:223], v[76:79]
    ds_read_b64_tr_b16 v[96:97], v15 offset:24864
    v_mfma_f32_16x16x32_bf16 v[80:83], v[104:107], v[224:227], v[80:83]
    ds_read_b64_tr_b16 v[98:99], v15 offset:25888
    s_waitcnt vmcnt(18) lgkmcnt(6)
    v_mfma_f32_16x16x32_bf16 v[20:23], v[84:87], v[228:231], v[20:23]
    ds_read_b64_tr_b16 v[100:101], v3 offset:25088
    s_waitcnt vmcnt(17)
    v_mfma_f32_16x16x32_bf16 v[24:27], v[84:87], v[232:235], v[24:27]
    ds_read_b64_tr_b16 v[102:103], v3 offset:26112
    s_waitcnt lgkmcnt(6)
    v_mfma_f32_16x16x32_bf16 v[28:31], v[88:91], v[228:231], v[28:31]
    ds_read_b64_tr_b16 v[104:105], v15 offset:25120
    v_mfma_f32_16x16x32_bf16 v[32:35], v[88:91], v[232:235], v[32:35]
    ds_read_b64_tr_b16 v[106:107], v15 offset:26144
    s_mov_b32 s23, 0x1800
    buffer_load_dwordx4 v[212:215], v4, s[8:11], s23 offen offset:1024 sc1
    s_waitcnt lgkmcnt(6)
    v_mfma_f32_16x16x32_bf16 v[36:39], v[92:95], v[228:231], v[36:39]
    ds_read_b64_tr_b16 v[84:85], v3 offset:25344
    v_mfma_f32_16x16x32_bf16 v[40:43], v[92:95], v[232:235], v[40:43]
    ds_read_b64_tr_b16 v[86:87], v3 offset:26368
    s_waitcnt lgkmcnt(6)
    v_mfma_f32_16x16x32_bf16 v[44:47], v[96:99], v[228:231], v[44:47]
    ds_read_b64_tr_b16 v[88:89], v15 offset:25376
    v_mfma_f32_16x16x32_bf16 v[48:51], v[96:99], v[232:235], v[48:51]
    ds_read_b64_tr_b16 v[90:91], v15 offset:26400
    s_waitcnt lgkmcnt(6)
    v_mfma_f32_16x16x32_bf16 v[52:55], v[100:103], v[228:231], v[52:55]
    v_mfma_f32_16x16x32_bf16 v[56:59], v[100:103], v[232:235], v[56:59]
    s_barrier
    ds_read_b64_tr_b16 v[92:93], v3 offset:32768
    ds_read_b64_tr_b16 v[94:95], v3 offset:33792
    s_waitcnt lgkmcnt(6)
    v_mfma_f32_16x16x32_bf16 v[60:63], v[104:107], v[228:231], v[60:63]
    ds_read_b64_tr_b16 v[96:97], v15 offset:32800
    v_mfma_f32_16x16x32_bf16 v[64:67], v[104:107], v[232:235], v[64:67]
    ds_read_b64_tr_b16 v[98:99], v15 offset:33824
    s_mov_b32 s23, 0x9800
    buffer_load_dwordx4 v[216:219], v4, s[8:11], s23 offen offset:1024 sc1
    s_waitcnt lgkmcnt(6)
    v_mfma_f32_16x16x32_bf16 v[68:71], v[84:87], v[228:231], v[68:71]
    ds_read_b64_tr_b16 v[100:101], v3 offset:33024
    v_mfma_f32_16x16x32_bf16 v[72:75], v[84:87], v[232:235], v[72:75]
    ds_read_b64_tr_b16 v[102:103], v3 offset:34048
    s_waitcnt lgkmcnt(6)
    v_mfma_f32_16x16x32_bf16 v[76:79], v[88:91], v[228:231], v[76:79]
    ds_read_b64_tr_b16 v[104:105], v15 offset:33056
    v_mfma_f32_16x16x32_bf16 v[80:83], v[88:91], v[232:235], v[80:83]
    ds_read_b64_tr_b16 v[106:107], v15 offset:34080
    s_waitcnt lgkmcnt(6)
    v_mfma_f32_16x16x32_bf16 v[20:23], v[92:95], v[140:143], v[20:23]
    ds_read_b64_tr_b16 v[84:85], v3 offset:33280
    s_waitcnt vmcnt(17)
    v_mfma_f32_16x16x32_bf16 v[24:27], v[92:95], v[144:147], v[24:27]
    ds_read_b64_tr_b16 v[86:87], v3 offset:34304
    s_waitcnt lgkmcnt(6)
    v_mfma_f32_16x16x32_bf16 v[28:31], v[96:99], v[140:143], v[28:31]
    ds_read_b64_tr_b16 v[88:89], v15 offset:33312
    v_mfma_f32_16x16x32_bf16 v[32:35], v[96:99], v[144:147], v[32:35]
    ds_read_b64_tr_b16 v[90:91], v15 offset:34336
    s_mov_b32 s23, 0x2000
    buffer_load_dwordx4 v[220:223], v4, s[8:11], s23 offen offset:0 sc1
    s_waitcnt lgkmcnt(6)
    v_mfma_f32_16x16x32_bf16 v[36:39], v[100:103], v[140:143], v[36:39]
    ds_read_b64_tr_b16 v[92:93], v3 offset:33536
    v_mfma_f32_16x16x32_bf16 v[40:43], v[100:103], v[144:147], v[40:43]
    ds_read_b64_tr_b16 v[94:95], v3 offset:34560
    s_waitcnt lgkmcnt(6)
    v_mfma_f32_16x16x32_bf16 v[44:47], v[104:107], v[140:143], v[44:47]
    ds_read_b64_tr_b16 v[96:97], v15 offset:33568
    v_mfma_f32_16x16x32_bf16 v[48:51], v[104:107], v[144:147], v[48:51]
    ds_read_b64_tr_b16 v[98:99], v15 offset:34592
    s_mov_b32 s26, 0x300000
    buffer_load_dword v18, v17, s[68:71], s26 offen
    s_waitcnt lgkmcnt(6)
    v_mfma_f32_16x16x32_bf16 v[52:55], v[84:87], v[140:143], v[52:55]
    ds_read_b64_tr_b16 v[100:101], v3 offset:40960
    v_mfma_f32_16x16x32_bf16 v[56:59], v[84:87], v[144:147], v[56:59]
    ds_read_b64_tr_b16 v[102:103], v3 offset:41984
    s_waitcnt lgkmcnt(6)
    v_mfma_f32_16x16x32_bf16 v[60:63], v[88:91], v[140:143], v[60:63]
    ds_read_b64_tr_b16 v[104:105], v15 offset:40992
    v_mfma_f32_16x16x32_bf16 v[64:67], v[88:91], v[144:147], v[64:67]
    ds_read_b64_tr_b16 v[106:107], v15 offset:42016
    s_mov_b32 s23, 0xa000
    buffer_load_dwordx4 v[224:227], v4, s[8:11], s23 offen offset:0 sc1
    s_waitcnt lgkmcnt(6)
    v_mfma_f32_16x16x32_bf16 v[68:71], v[92:95], v[140:143], v[68:71]
    ds_read_b64_tr_b16 v[84:85], v3 offset:41216
    v_mfma_f32_16x16x32_bf16 v[72:75], v[92:95], v[144:147], v[72:75]
    ds_read_b64_tr_b16 v[86:87], v3 offset:42240
    s_waitcnt lgkmcnt(6)
    v_mfma_f32_16x16x32_bf16 v[76:79], v[96:99], v[140:143], v[76:79]
    ds_read_b64_tr_b16 v[88:89], v15 offset:41248
    v_mfma_f32_16x16x32_bf16 v[80:83], v[96:99], v[144:147], v[80:83]
    ds_read_b64_tr_b16 v[90:91], v15 offset:42272
    s_waitcnt vmcnt(19) lgkmcnt(6)
    v_mfma_f32_16x16x32_bf16 v[20:23], v[100:103], v[148:151], v[20:23]
    ds_read_b64_tr_b16 v[92:93], v3 offset:41472
    s_waitcnt vmcnt(18)
    v_mfma_f32_16x16x32_bf16 v[24:27], v[100:103], v[152:155], v[24:27]
    ds_read_b64_tr_b16 v[94:95], v3 offset:42496
    s_waitcnt lgkmcnt(6)
    v_mfma_f32_16x16x32_bf16 v[28:31], v[104:107], v[148:151], v[28:31]
    ds_read_b64_tr_b16 v[96:97], v15 offset:41504
    v_mfma_f32_16x16x32_bf16 v[32:35], v[104:107], v[152:155], v[32:35]
    ds_read_b64_tr_b16 v[98:99], v15 offset:42528
    s_mov_b32 s23, 0x2000
    buffer_load_dwordx4 v[228:231], v4, s[8:11], s23 offen offset:1024 sc1
    s_waitcnt lgkmcnt(6)
    v_mfma_f32_16x16x32_bf16 v[36:39], v[84:87], v[148:151], v[36:39]
    ds_read_b64_tr_b16 v[100:101], v3 offset:41728
    v_mfma_f32_16x16x32_bf16 v[40:43], v[84:87], v[152:155], v[40:43]
    ds_read_b64_tr_b16 v[102:103], v3 offset:42752
    s_waitcnt lgkmcnt(6)
    v_mfma_f32_16x16x32_bf16 v[44:47], v[88:91], v[148:151], v[44:47]
    ds_read_b64_tr_b16 v[104:105], v15 offset:41760
    v_mfma_f32_16x16x32_bf16 v[48:51], v[88:91], v[152:155], v[48:51]
    ds_read_b64_tr_b16 v[106:107], v15 offset:42784
    s_waitcnt lgkmcnt(6)
    v_mfma_f32_16x16x32_bf16 v[52:55], v[92:95], v[148:151], v[52:55]
    v_mfma_f32_16x16x32_bf16 v[56:59], v[92:95], v[152:155], v[56:59]
    s_barrier
    ds_read_b64_tr_b16 v[84:85], v3 offset:49152
    ds_read_b64_tr_b16 v[86:87], v3 offset:50176
    s_waitcnt lgkmcnt(6)
    v_mfma_f32_16x16x32_bf16 v[60:63], v[96:99], v[148:151], v[60:63]
    ds_read_b64_tr_b16 v[88:89], v15 offset:49184
    v_mfma_f32_16x16x32_bf16 v[64:67], v[96:99], v[152:155], v[64:67]
    ds_read_b64_tr_b16 v[90:91], v15 offset:50208
    s_mov_b32 s23, 0xa000
    buffer_load_dwordx4 v[232:235], v4, s[8:11], s23 offen offset:1024 sc1
    s_waitcnt lgkmcnt(6)
    v_mfma_f32_16x16x32_bf16 v[68:71], v[100:103], v[148:151], v[68:71]
    ds_read_b64_tr_b16 v[92:93], v3 offset:49408
    v_mfma_f32_16x16x32_bf16 v[72:75], v[100:103], v[152:155], v[72:75]
    ds_read_b64_tr_b16 v[94:95], v3 offset:50432
    s_waitcnt lgkmcnt(6)
    v_mfma_f32_16x16x32_bf16 v[76:79], v[104:107], v[148:151], v[76:79]
    ds_read_b64_tr_b16 v[96:97], v15 offset:49440
    v_mfma_f32_16x16x32_bf16 v[80:83], v[104:107], v[152:155], v[80:83]
    ds_read_b64_tr_b16 v[98:99], v15 offset:50464
    s_waitcnt vmcnt(9) lgkmcnt(6)
    v_mfma_f32_16x16x32_bf16 v[20:23], v[84:87], v[204:207], v[20:23]
    ds_read_b64_tr_b16 v[100:101], v3 offset:49664
    s_waitcnt vmcnt(7)
    v_mfma_f32_16x16x32_bf16 v[24:27], v[84:87], v[208:211], v[24:27]
    ds_read_b64_tr_b16 v[102:103], v3 offset:50688
    v_lshl_or_b32 v160, v161, 16, v160
    v_or_b32 v156, v156, v160
    v_lshl_or_b32 v162, v163, 16, v162
    v_or_b32 v157, v157, v162
    v_lshl_or_b32 v164, v165, 16, v164
    v_or_b32 v158, v158, v164
    v_lshl_or_b32 v166, v167, 16, v166
    v_or_b32 v159, v159, v166
    s_lshl_b32 s27, s63, 10
    s_add_u32 s27, s27, 0x400000
    buffer_store_dwordx4 v[156:159], v1, s[8:11], s27 offen sc1
    s_waitcnt lgkmcnt(6)
    v_mfma_f32_16x16x32_bf16 v[28:31], v[88:91], v[204:207], v[28:31]
    ds_read_b64_tr_b16 v[104:105], v15 offset:49696
    v_mfma_f32_16x16x32_bf16 v[32:35], v[88:91], v[208:211], v[32:35]
    ds_read_b64_tr_b16 v[106:107], v15 offset:50720
    s_mov_b32 s23, 0x2800
    buffer_load_dwordx4 v[140:143], v4, s[8:11], s23 offen offset:0 sc1
    s_waitcnt lgkmcnt(6)
    v_mfma_f32_16x16x32_bf16 v[36:39], v[92:95], v[204:207], v[36:39]
    ds_read_b64_tr_b16 v[84:85], v3 offset:49920
    v_mfma_f32_16x16x32_bf16 v[40:43], v[92:95], v[208:211], v[40:43]
    ds_read_b64_tr_b16 v[86:87], v3 offset:50944
    s_waitcnt lgkmcnt(6)
    v_mfma_f32_16x16x32_bf16 v[44:47], v[96:99], v[204:207], v[44:47]
    ds_read_b64_tr_b16 v[88:89], v15 offset:49952
    v_mfma_f32_16x16x32_bf16 v[48:51], v[96:99], v[208:211], v[48:51]
    ds_read_b64_tr_b16 v[90:91], v15 offset:50976
    s_mov_b32 s26, 0x380000
    buffer_load_dword v18, v17, s[68:71], s26 offen
    s_waitcnt lgkmcnt(6)
    v_mfma_f32_16x16x32_bf16 v[52:55], v[100:103], v[204:207], v[52:55]
    ds_read_b64_tr_b16 v[92:93], v3 offset:57344
    v_mfma_f32_16x16x32_bf16 v[56:59], v[100:103], v[208:211], v[56:59]
    ds_read_b64_tr_b16 v[94:95], v3 offset:58368
    s_waitcnt lgkmcnt(6)
    v_mfma_f32_16x16x32_bf16 v[60:63], v[104:107], v[204:207], v[60:63]
    ds_read_b64_tr_b16 v[96:97], v15 offset:57376
    v_mfma_f32_16x16x32_bf16 v[64:67], v[104:107], v[208:211], v[64:67]
    ds_read_b64_tr_b16 v[98:99], v15 offset:58400
    s_mov_b32 s23, 0xa800
    buffer_load_dwordx4 v[144:147], v4, s[8:11], s23 offen offset:0 sc1
    s_waitcnt lgkmcnt(6)
    v_mfma_f32_16x16x32_bf16 v[68:71], v[84:87], v[204:207], v[68:71]
    ds_read_b64_tr_b16 v[100:101], v3 offset:57600
    v_mfma_f32_16x16x32_bf16 v[72:75], v[84:87], v[208:211], v[72:75]
    ds_read_b64_tr_b16 v[102:103], v3 offset:58624
    s_waitcnt lgkmcnt(6)
    v_mfma_f32_16x16x32_bf16 v[76:79], v[88:91], v[204:207], v[76:79]
    ds_read_b64_tr_b16 v[104:105], v15 offset:57632
    v_mfma_f32_16x16x32_bf16 v[80:83], v[88:91], v[208:211], v[80:83]
    ds_read_b64_tr_b16 v[106:107], v15 offset:58656
    s_waitcnt vmcnt(10) lgkmcnt(6)
    v_mfma_f32_16x16x32_bf16 v[20:23], v[92:95], v[212:215], v[20:23]
    ds_read_b64_tr_b16 v[84:85], v3 offset:57856
    s_waitcnt vmcnt(9)
    v_mfma_f32_16x16x32_bf16 v[24:27], v[92:95], v[216:219], v[24:27]
    ds_read_b64_tr_b16 v[86:87], v3 offset:58880
    s_waitcnt lgkmcnt(6)
    v_mfma_f32_16x16x32_bf16 v[28:31], v[96:99], v[212:215], v[28:31]
    ds_read_b64_tr_b16 v[88:89], v15 offset:57888
    v_mfma_f32_16x16x32_bf16 v[32:35], v[96:99], v[216:219], v[32:35]
    ds_read_b64_tr_b16 v[90:91], v15 offset:58912
    s_mov_b32 s23, 0x2800
    buffer_load_dwordx4 v[148:151], v4, s[8:11], s23 offen offset:1024 sc1
    s_waitcnt lgkmcnt(6)
    v_mfma_f32_16x16x32_bf16 v[36:39], v[100:103], v[212:215], v[36:39]
    ds_read_b64_tr_b16 v[92:93], v3 offset:58112
    v_mfma_f32_16x16x32_bf16 v[40:43], v[100:103], v[216:219], v[40:43]
    ds_read_b64_tr_b16 v[94:95], v3 offset:59136
    s_waitcnt lgkmcnt(6)
    v_mfma_f32_16x16x32_bf16 v[44:47], v[104:107], v[212:215], v[44:47]
    ds_read_b64_tr_b16 v[96:97], v15 offset:58144
    v_mfma_f32_16x16x32_bf16 v[48:51], v[104:107], v[216:219], v[48:51]
    ds_read_b64_tr_b16 v[98:99], v15 offset:59168
    s_waitcnt lgkmcnt(6)
    v_mfma_f32_16x16x32_bf16 v[52:55], v[84:87], v[212:215], v[52:55]
    v_mfma_f32_16x16x32_bf16 v[56:59], v[84:87], v[216:219], v[56:59]
    s_barrier
    ds_read_b64_tr_b16 v[100:101], v3 offset:0
    ds_read_b64_tr_b16 v[102:103], v3 offset:1024
    s_waitcnt lgkmcnt(6)
    v_mfma_f32_16x16x32_bf16 v[60:63], v[88:91], v[212:215], v[60:63]
    ds_read_b64_tr_b16 v[104:105], v15 offset:32
    v_mfma_f32_16x16x32_bf16 v[64:67], v[88:91], v[216:219], v[64:67]
    ds_read_b64_tr_b16 v[106:107], v15 offset:1056
    s_mov_b32 s23, 0xa800
    buffer_load_dwordx4 v[152:155], v4, s[8:11], s23 offen offset:1024 sc1
    s_waitcnt lgkmcnt(6)
    v_mfma_f32_16x16x32_bf16 v[68:71], v[92:95], v[212:215], v[68:71]
    ds_read_b64_tr_b16 v[84:85], v3 offset:256
    v_mfma_f32_16x16x32_bf16 v[72:75], v[92:95], v[216:219], v[72:75]
    ds_read_b64_tr_b16 v[86:87], v3 offset:1280
    s_waitcnt lgkmcnt(6)
    v_mfma_f32_16x16x32_bf16 v[76:79], v[96:99], v[212:215], v[76:79]
    ds_read_b64_tr_b16 v[88:89], v15 offset:288
    v_mfma_f32_16x16x32_bf16 v[80:83], v[96:99], v[216:219], v[80:83]
    ds_read_b64_tr_b16 v[90:91], v15 offset:1312
    s_waitcnt vmcnt(10) lgkmcnt(6)
    v_mfma_f32_16x16x32_bf16 v[20:23], v[100:103], v[220:223], v[20:23]
    ds_read_b64_tr_b16 v[92:93], v3 offset:512
    s_waitcnt vmcnt(8)
    v_mfma_f32_16x16x32_bf16 v[24:27], v[100:103], v[224:227], v[24:27]
    ds_read_b64_tr_b16 v[94:95], v3 offset:1536
    s_waitcnt lgkmcnt(6)
    v_mfma_f32_16x16x32_bf16 v[28:31], v[104:107], v[220:223], v[28:31]
    ds_read_b64_tr_b16 v[96:97], v15 offset:544
    v_mfma_f32_16x16x32_bf16 v[32:35], v[104:107], v[224:227], v[32:35]
    ds_read_b64_tr_b16 v[98:99], v15 offset:1568
    s_mov_b32 s23, 0x3000
    buffer_load_dwordx4 v[204:207], v4, s[8:11], s23 offen offset:0 sc1
    s_waitcnt lgkmcnt(6)
    v_mfma_f32_16x16x32_bf16 v[36:39], v[84:87], v[220:223], v[36:39]
    ds_read_b64_tr_b16 v[100:101], v3 offset:768
    v_mfma_f32_16x16x32_bf16 v[40:43], v[84:87], v[224:227], v[40:43]
    ds_read_b64_tr_b16 v[102:103], v3 offset:1792
    s_waitcnt lgkmcnt(6)
    v_mfma_f32_16x16x32_bf16 v[44:47], v[88:91], v[220:223], v[44:47]
    ds_read_b64_tr_b16 v[104:105], v15 offset:800
    v_mfma_f32_16x16x32_bf16 v[48:51], v[88:91], v[224:227], v[48:51]
    ds_read_b64_tr_b16 v[106:107], v15 offset:1824
    s_mov_b32 s26, 0x400000
    buffer_load_dword v18, v17, s[68:71], s26 offen
    s_waitcnt lgkmcnt(6)
    v_mfma_f32_16x16x32_bf16 v[52:55], v[92:95], v[220:223], v[52:55]
    ds_read_b64_tr_b16 v[84:85], v3 offset:8192
    v_mfma_f32_16x16x32_bf16 v[56:59], v[92:95], v[224:227], v[56:59]
    ds_read_b64_tr_b16 v[86:87], v3 offset:9216
    s_waitcnt lgkmcnt(6)
    v_mfma_f32_16x16x32_bf16 v[60:63], v[96:99], v[220:223], v[60:63]
    ds_read_b64_tr_b16 v[88:89], v15 offset:8224
    v_mfma_f32_16x16x32_bf16 v[64:67], v[96:99], v[224:227], v[64:67]
    ds_read_b64_tr_b16 v[90:91], v15 offset:9248
    s_mov_b32 s23, 0xb000
    buffer_load_dwordx4 v[208:211], v4, s[8:11], s23 offen offset:0 sc1
    s_waitcnt lgkmcnt(6)
    v_mfma_f32_16x16x32_bf16 v[68:71], v[100:103], v[220:223], v[68:71]
    ds_read_b64_tr_b16 v[92:93], v3 offset:8448
    v_mfma_f32_16x16x32_bf16 v[72:75], v[100:103], v[224:227], v[72:75]
    ds_read_b64_tr_b16 v[94:95], v3 offset:9472
    s_waitcnt lgkmcnt(6)
    v_mfma_f32_16x16x32_bf16 v[76:79], v[104:107], v[220:223], v[76:79]
    ds_read_b64_tr_b16 v[96:97], v15 offset:8480
    v_mfma_f32_16x16x32_bf16 v[80:83], v[104:107], v[224:227], v[80:83]
    ds_read_b64_tr_b16 v[98:99], v15 offset:9504
    s_waitcnt vmcnt(10) lgkmcnt(6)
    v_mfma_f32_16x16x32_bf16 v[20:23], v[84:87], v[228:231], v[20:23]
    ds_read_b64_tr_b16 v[100:101], v3 offset:8704
    s_waitcnt vmcnt(9)
    v_mfma_f32_16x16x32_bf16 v[24:27], v[84:87], v[232:235], v[24:27]
    ds_read_b64_tr_b16 v[102:103], v3 offset:9728
    s_waitcnt lgkmcnt(6)
    v_mfma_f32_16x16x32_bf16 v[28:31], v[88:91], v[228:231], v[28:31]
    ds_read_b64_tr_b16 v[104:105], v15 offset:8736
    v_mfma_f32_16x16x32_bf16 v[32:35], v[88:91], v[232:235], v[32:35]
    ds_read_b64_tr_b16 v[106:107], v15 offset:9760
    s_mov_b32 s23, 0x3000
    buffer_load_dwordx4 v[212:215], v4, s[8:11], s23 offen offset:1024 sc1
    s_waitcnt lgkmcnt(6)
    v_mfma_f32_16x16x32_bf16 v[36:39], v[92:95], v[228:231], v[36:39]
    ds_read_b64_tr_b16 v[84:85], v3 offset:8960
    v_mfma_f32_16x16x32_bf16 v[40:43], v[92:95], v[232:235], v[40:43]
    ds_read_b64_tr_b16 v[86:87], v3 offset:9984
    s_waitcnt lgkmcnt(6)
    v_mfma_f32_16x16x32_bf16 v[44:47], v[96:99], v[228:231], v[44:47]
    ds_read_b64_tr_b16 v[88:89], v15 offset:8992
    v_mfma_f32_16x16x32_bf16 v[48:51], v[96:99], v[232:235], v[48:51]
    ds_read_b64_tr_b16 v[90:91], v15 offset:10016
    s_waitcnt lgkmcnt(6)
    v_mfma_f32_16x16x32_bf16 v[52:55], v[100:103], v[228:231], v[52:55]
    v_mfma_f32_16x16x32_bf16 v[56:59], v[100:103], v[232:235], v[56:59]
    s_barrier
    ds_read_b64_tr_b16 v[92:93], v3 offset:16384
    ds_read_b64_tr_b16 v[94:95], v3 offset:17408
    s_waitcnt lgkmcnt(6)
    v_mfma_f32_16x16x32_bf16 v[60:63], v[104:107], v[228:231], v[60:63]
    ds_read_b64_tr_b16 v[96:97], v15 offset:16416
    v_mfma_f32_16x16x32_bf16 v[64:67], v[104:107], v[232:235], v[64:67]
    ds_read_b64_tr_b16 v[98:99], v15 offset:17440
    s_mov_b32 s23, 0xb000
    buffer_load_dwordx4 v[216:219], v4, s[8:11], s23 offen offset:1024 sc1
    s_waitcnt lgkmcnt(6)
    v_mfma_f32_16x16x32_bf16 v[68:71], v[84:87], v[228:231], v[68:71]
    ds_read_b64_tr_b16 v[100:101], v3 offset:16640
    v_mfma_f32_16x16x32_bf16 v[72:75], v[84:87], v[232:235], v[72:75]
    ds_read_b64_tr_b16 v[102:103], v3 offset:17664
    s_waitcnt lgkmcnt(6)
    v_mfma_f32_16x16x32_bf16 v[76:79], v[88:91], v[228:231], v[76:79]
    ds_read_b64_tr_b16 v[104:105], v15 offset:16672
    v_mfma_f32_16x16x32_bf16 v[80:83], v[88:91], v[232:235], v[80:83]
    ds_read_b64_tr_b16 v[106:107], v15 offset:17696
    s_waitcnt vmcnt(9) lgkmcnt(6)
    v_mfma_f32_16x16x32_bf16 v[20:23], v[92:95], v[140:143], v[20:23]
    ds_read_b64_tr_b16 v[84:85], v3 offset:16896
    s_waitcnt vmcnt(7)
    v_mfma_f32_16x16x32_bf16 v[24:27], v[92:95], v[144:147], v[24:27]
    ds_read_b64_tr_b16 v[86:87], v3 offset:17920
    s_lshl_b32 s26, s63, 2
    s_add_u32 s26, s26, 0x530000
    v_mov_b32 v168, s14
    v_mov_b32 v169, 0
    s_mov_b64 exec, 1
    buffer_store_dword v168, v169, s[8:11], s26 offen sc1
    s_mov_b64 exec, -1
    s_nop 3
    s_waitcnt lgkmcnt(6)
    v_mfma_f32_16x16x32_bf16 v[28:31], v[96:99], v[140:143], v[28:31]
    ds_read_b64_tr_b16 v[88:89], v15 offset:16928
    v_mfma_f32_16x16x32_bf16 v[32:35], v[96:99], v[144:147], v[32:35]
    ds_read_b64_tr_b16 v[90:91], v15 offset:17952
    s_mov_b32 s23, 0x3800
    buffer_load_dwordx4 v[220:223], v4, s[8:11], s23 offen offset:0 sc1
    s_waitcnt lgkmcnt(6)
    v_mfma_f32_16x16x32_bf16 v[36:39], v[100:103], v[140:143], v[36:39]
    ds_read_b64_tr_b16 v[92:93], v3 offset:17152
    v_mfma_f32_16x16x32_bf16 v[40:43], v[100:103], v[144:147], v[40:43]
    ds_read_b64_tr_b16 v[94:95], v3 offset:18176
    s_waitcnt lgkmcnt(6)
    v_mfma_f32_16x16x32_bf16 v[44:47], v[104:107], v[140:143], v[44:47]
    ds_read_b64_tr_b16 v[96:97], v15 offset:17184
    v_mfma_f32_16x16x32_bf16 v[48:51], v[104:107], v[144:147], v[48:51]
    ds_read_b64_tr_b16 v[98:99], v15 offset:18208
    s_mov_b32 s26, 0x480000
    buffer_load_dword v18, v17, s[68:71], s26 offen
    s_waitcnt lgkmcnt(6)
    v_mfma_f32_16x16x32_bf16 v[52:55], v[84:87], v[140:143], v[52:55]
    ds_read_b64_tr_b16 v[100:101], v3 offset:24576
    v_mfma_f32_16x16x32_bf16 v[56:59], v[84:87], v[144:147], v[56:59]
    ds_read_b64_tr_b16 v[102:103], v3 offset:25600
    s_waitcnt lgkmcnt(6)
    v_mfma_f32_16x16x32_bf16 v[60:63], v[88:91], v[140:143], v[60:63]
    ds_read_b64_tr_b16 v[104:105], v15 offset:24608
    v_mfma_f32_16x16x32_bf16 v[64:67], v[88:91], v[144:147], v[64:67]
    ds_read_b64_tr_b16 v[106:107], v15 offset:25632
    s_mov_b32 s23, 0xb800
    buffer_load_dwordx4 v[224:227], v4, s[8:11], s23 offen offset:0 sc1
    s_waitcnt lgkmcnt(6)
    v_mfma_f32_16x16x32_bf16 v[68:71], v[92:95], v[140:143], v[68:71]
    ds_read_b64_tr_b16 v[84:85], v3 offset:24832
    v_mfma_f32_16x16x32_bf16 v[72:75], v[92:95], v[144:147], v[72:75]
    ds_read_b64_tr_b16 v[86:87], v3 offset:25856
    s_waitcnt lgkmcnt(6)
    v_mfma_f32_16x16x32_bf16 v[76:79], v[96:99], v[140:143], v[76:79]
    ds_read_b64_tr_b16 v[88:89], v15 offset:24864
    v_mfma_f32_16x16x32_bf16 v[80:83], v[96:99], v[144:147], v[80:83]
    ds_read_b64_tr_b16 v[90:91], v15 offset:25888
    s_waitcnt vmcnt(10) lgkmcnt(6)
    v_mfma_f32_16x16x32_bf16 v[20:23], v[100:103], v[148:151], v[20:23]
    ds_read_b64_tr_b16 v[92:93], v3 offset:25088
    s_waitcnt vmcnt(9)
    v_mfma_f32_16x16x32_bf16 v[24:27], v[100:103], v[152:155], v[24:27]
    ds_read_b64_tr_b16 v[94:95], v3 offset:26112
    s_waitcnt lgkmcnt(6)
    v_mfma_f32_16x16x32_bf16 v[28:31], v[104:107], v[148:151], v[28:31]
    ds_read_b64_tr_b16 v[96:97], v15 offset:25120
    v_mfma_f32_16x16x32_bf16 v[32:35], v[104:107], v[152:155], v[32:35]
    ds_read_b64_tr_b16 v[98:99], v15 offset:26144
    s_mov_b32 s23, 0x3800
    buffer_load_dwordx4 v[228:231], v4, s[8:11], s23 offen offset:1024 sc1
    s_waitcnt lgkmcnt(6)
    v_mfma_f32_16x16x32_bf16 v[36:39], v[84:87], v[148:151], v[36:39]
    ds_read_b64_tr_b16 v[100:101], v3 offset:25344
    v_mfma_f32_16x16x32_bf16 v[40:43], v[84:87], v[152:155], v[40:43]
    ds_read_b64_tr_b16 v[102:103], v3 offset:26368
    s_waitcnt lgkmcnt(6)
    v_mfma_f32_16x16x32_bf16 v[44:47], v[88:91], v[148:151], v[44:47]
    ds_read_b64_tr_b16 v[104:105], v15 offset:25376
    v_mfma_f32_16x16x32_bf16 v[48:51], v[88:91], v[152:155], v[48:51]
    ds_read_b64_tr_b16 v[106:107], v15 offset:26400
    s_waitcnt lgkmcnt(6)
    v_mfma_f32_16x16x32_bf16 v[52:55], v[92:95], v[148:151], v[52:55]
    v_mfma_f32_16x16x32_bf16 v[56:59], v[92:95], v[152:155], v[56:59]
    s_barrier
    ds_read_b64_tr_b16 v[84:85], v3 offset:32768
    ds_read_b64_tr_b16 v[86:87], v3 offset:33792
    s_waitcnt lgkmcnt(6)
    v_mfma_f32_16x16x32_bf16 v[60:63], v[96:99], v[148:151], v[60:63]
    ds_read_b64_tr_b16 v[88:89], v15 offset:32800
    v_mfma_f32_16x16x32_bf16 v[64:67], v[96:99], v[152:155], v[64:67]
    ds_read_b64_tr_b16 v[90:91], v15 offset:33824
    s_mov_b32 s23, 0xb800
    buffer_load_dwordx4 v[232:235], v4, s[8:11], s23 offen offset:1024 sc1
    s_waitcnt lgkmcnt(6)
    v_mfma_f32_16x16x32_bf16 v[68:71], v[100:103], v[148:151], v[68:71]
    ds_read_b64_tr_b16 v[92:93], v3 offset:33024
    v_mfma_f32_16x16x32_bf16 v[72:75], v[100:103], v[152:155], v[72:75]
    ds_read_b64_tr_b16 v[94:95], v3 offset:34048
    s_waitcnt lgkmcnt(6)
    v_mfma_f32_16x16x32_bf16 v[76:79], v[104:107], v[148:151], v[76:79]
    ds_read_b64_tr_b16 v[96:97], v15 offset:33056
    v_mfma_f32_16x16x32_bf16 v[80:83], v[104:107], v[152:155], v[80:83]
    ds_read_b64_tr_b16 v[98:99], v15 offset:34080
    s_waitcnt vmcnt(10) lgkmcnt(6)
    v_mfma_f32_16x16x32_bf16 v[20:23], v[84:87], v[204:207], v[20:23]
    ds_read_b64_tr_b16 v[100:101], v3 offset:33280
    s_waitcnt vmcnt(8)
    v_mfma_f32_16x16x32_bf16 v[24:27], v[84:87], v[208:211], v[24:27]
    ds_read_b64_tr_b16 v[102:103], v3 offset:34304
    s_waitcnt lgkmcnt(6)
    v_mfma_f32_16x16x32_bf16 v[28:31], v[88:91], v[204:207], v[28:31]
    ds_read_b64_tr_b16 v[104:105], v15 offset:33312
    v_mfma_f32_16x16x32_bf16 v[32:35], v[88:91], v[208:211], v[32:35]
    ds_read_b64_tr_b16 v[106:107], v15 offset:34336
    s_mov_b32 s23, 0x4000
    buffer_load_dwordx4 v[140:143], v4, s[8:11], s23 offen offset:0 sc1
    s_waitcnt lgkmcnt(6)
    v_mfma_f32_16x16x32_bf16 v[36:39], v[92:95], v[204:207], v[36:39]
    ds_read_b64_tr_b16 v[84:85], v3 offset:33536
    v_mfma_f32_16x16x32_bf16 v[40:43], v[92:95], v[208:211], v[40:43]
    ds_read_b64_tr_b16 v[86:87], v3 offset:34560
    s_waitcnt lgkmcnt(6)
    v_mfma_f32_16x16x32_bf16 v[44:47], v[96:99], v[204:207], v[44:47]
    ds_read_b64_tr_b16 v[88:89], v15 offset:33568
    v_mfma_f32_16x16x32_bf16 v[48:51], v[96:99], v[208:211], v[48:51]
    ds_read_b64_tr_b16 v[90:91], v15 offset:34592
    s_mov_b32 s26, 0x500000
    buffer_load_dword v18, v17, s[68:71], s26 offen
    s_waitcnt lgkmcnt(6)
    v_mfma_f32_16x16x32_bf16 v[52:55], v[100:103], v[204:207], v[52:55]
    ds_read_b64_tr_b16 v[92:93], v3 offset:40960
    v_mfma_f32_16x16x32_bf16 v[56:59], v[100:103], v[208:211], v[56:59]
    ds_read_b64_tr_b16 v[94:95], v3 offset:41984
    s_waitcnt lgkmcnt(6)
    v_mfma_f32_16x16x32_bf16 v[60:63], v[104:107], v[204:207], v[60:63]
    ds_read_b64_tr_b16 v[96:97], v15 offset:40992
    v_mfma_f32_16x16x32_bf16 v[64:67], v[104:107], v[208:211], v[64:67]
    ds_read_b64_tr_b16 v[98:99], v15 offset:42016
    s_mov_b32 s23, 0xc000
    buffer_load_dwordx4 v[144:147], v4, s[8:11], s23 offen offset:0 sc1
    s_waitcnt lgkmcnt(6)
    v_mfma_f32_16x16x32_bf16 v[68:71], v[84:87], v[204:207], v[68:71]
    ds_read_b64_tr_b16 v[100:101], v3 offset:41216
    v_mfma_f32_16x16x32_bf16 v[72:75], v[84:87], v[208:211], v[72:75]
    ds_read_b64_tr_b16 v[102:103], v3 offset:42240
    s_waitcnt lgkmcnt(6)
    v_mfma_f32_16x16x32_bf16 v[76:79], v[88:91], v[204:207], v[76:79]
    ds_read_b64_tr_b16 v[104:105], v15 offset:41248
    v_mfma_f32_16x16x32_bf16 v[80:83], v[88:91], v[208:211], v[80:83]
    ds_read_b64_tr_b16 v[106:107], v15 offset:42272
    s_waitcnt vmcnt(10) lgkmcnt(6)
    v_mfma_f32_16x16x32_bf16 v[20:23], v[92:95], v[212:215], v[20:23]
    ds_read_b64_tr_b16 v[84:85], v3 offset:41472
    s_waitcnt vmcnt(9)
    v_mfma_f32_16x16x32_bf16 v[24:27], v[92:95], v[216:219], v[24:27]
    ds_read_b64_tr_b16 v[86:87], v3 offset:42496
    s_waitcnt lgkmcnt(6)
    v_mfma_f32_16x16x32_bf16 v[28:31], v[96:99], v[212:215], v[28:31]
    ds_read_b64_tr_b16 v[88:89], v15 offset:41504
    v_mfma_f32_16x16x32_bf16 v[32:35], v[96:99], v[216:219], v[32:35]
    ds_read_b64_tr_b16 v[90:91], v15 offset:42528
    s_mov_b32 s23, 0x4000
    buffer_load_dwordx4 v[148:151], v4, s[8:11], s23 offen offset:1024 sc1
    s_waitcnt lgkmcnt(6)
    v_mfma_f32_16x16x32_bf16 v[36:39], v[100:103], v[212:215], v[36:39]
    ds_read_b64_tr_b16 v[92:93], v3 offset:41728
    v_mfma_f32_16x16x32_bf16 v[40:43], v[100:103], v[216:219], v[40:43]
    ds_read_b64_tr_b16 v[94:95], v3 offset:42752
    s_waitcnt lgkmcnt(6)
    v_mfma_f32_16x16x32_bf16 v[44:47], v[104:107], v[212:215], v[44:47]
    ds_read_b64_tr_b16 v[96:97], v15 offset:41760
    v_mfma_f32_16x16x32_bf16 v[48:51], v[104:107], v[216:219], v[48:51]
    ds_read_b64_tr_b16 v[98:99], v15 offset:42784
    s_waitcnt lgkmcnt(6)
    v_mfma_f32_16x16x32_bf16 v[52:55], v[84:87], v[212:215], v[52:55]
    v_mfma_f32_16x16x32_bf16 v[56:59], v[84:87], v[216:219], v[56:59]
    s_barrier
    ds_read_b64_tr_b16 v[100:101], v3 offset:49152
    ds_read_b64_tr_b16 v[102:103], v3 offset:50176
    s_waitcnt lgkmcnt(6)
    v_mfma_f32_16x16x32_bf16 v[60:63], v[88:91], v[212:215], v[60:63]
    ds_read_b64_tr_b16 v[104:105], v15 offset:49184
    v_mfma_f32_16x16x32_bf16 v[64:67], v[88:91], v[216:219], v[64:67]
    ds_read_b64_tr_b16 v[106:107], v15 offset:50208
    s_mov_b32 s23, 0xc000
    buffer_load_dwordx4 v[152:155], v4, s[8:11], s23 offen offset:1024 sc1
    s_waitcnt lgkmcnt(6)
    v_mfma_f32_16x16x32_bf16 v[68:71], v[92:95], v[212:215], v[68:71]
    ds_read_b64_tr_b16 v[84:85], v3 offset:49408
    v_mfma_f32_16x16x32_bf16 v[72:75], v[92:95], v[216:219], v[72:75]
    ds_read_b64_tr_b16 v[86:87], v3 offset:50432
    s_waitcnt lgkmcnt(6)
    v_mfma_f32_16x16x32_bf16 v[76:79], v[96:99], v[212:215], v[76:79]
    ds_read_b64_tr_b16 v[88:89], v15 offset:49440
    v_mfma_f32_16x16x32_bf16 v[80:83], v[96:99], v[216:219], v[80:83]
    ds_read_b64_tr_b16 v[90:91], v15 offset:50464
    s_waitcnt vmcnt(9) lgkmcnt(6)
    v_mfma_f32_16x16x32_bf16 v[20:23], v[100:103], v[220:223], v[20:23]
    ds_read_b64_tr_b16 v[92:93], v3 offset:49664
    s_waitcnt vmcnt(7)
    v_mfma_f32_16x16x32_bf16 v[24:27], v[100:103], v[224:227], v[24:27]
    ds_read_b64_tr_b16 v[94:95], v3 offset:50688
    s_waitcnt lgkmcnt(6)
    v_mfma_f32_16x16x32_bf16 v[28:31], v[104:107], v[220:223], v[28:31]
    ds_read_b64_tr_b16 v[96:97], v15 offset:49696
    v_mfma_f32_16x16x32_bf16 v[32:35], v[104:107], v[224:227], v[32:35]
    ds_read_b64_tr_b16 v[98:99], v15 offset:50720
    s_mov_b32 s23, 0x4800
    buffer_load_dwordx4 v[204:207], v4, s[8:11], s23 offen offset:0 sc1
    s_waitcnt lgkmcnt(6)
    v_mfma_f32_16x16x32_bf16 v[36:39], v[84:87], v[220:223], v[36:39]
    ds_read_b64_tr_b16 v[100:101], v3 offset:49920
    v_mfma_f32_16x16x32_bf16 v[40:43], v[84:87], v[224:227], v[40:43]
    ds_read_b64_tr_b16 v[102:103], v3 offset:50944
    s_waitcnt lgkmcnt(6)
    v_mfma_f32_16x16x32_bf16 v[44:47], v[88:91], v[220:223], v[44:47]
    ds_read_b64_tr_b16 v[104:105], v15 offset:49952
    v_mfma_f32_16x16x32_bf16 v[48:51], v[88:91], v[224:227], v[48:51]
    ds_read_b64_tr_b16 v[106:107], v15 offset:50976
    s_mov_b32 s26, 0x580000
    buffer_load_dword v18, v17, s[68:71], s26 offen
    s_waitcnt lgkmcnt(6)
    v_mfma_f32_16x16x32_bf16 v[52:55], v[92:95], v[220:223], v[52:55]
    ds_read_b64_tr_b16 v[84:85], v3 offset:57344
    v_mfma_f32_16x16x32_bf16 v[56:59], v[92:95], v[224:227], v[56:59]
    ds_read_b64_tr_b16 v[86:87], v3 offset:58368
    s_waitcnt lgkmcnt(6)
    v_mfma_f32_16x16x32_bf16 v[60:63], v[96:99], v[220:223], v[60:63]
    ds_read_b64_tr_b16 v[88:89], v15 offset:57376
    v_mfma_f32_16x16x32_bf16 v[64:67], v[96:99], v[224:227], v[64:67]
    ds_read_b64_tr_b16 v[90:91], v15 offset:58400
    s_mov_b32 s23, 0xc800
    buffer_load_dwordx4 v[208:211], v4, s[8:11], s23 offen offset:0 sc1
    s_waitcnt lgkmcnt(6)
    v_mfma_f32_16x16x32_bf16 v[68:71], v[100:103], v[220:223], v[68:71]
    ds_read_b64_tr_b16 v[92:93], v3 offset:57600
    v_mfma_f32_16x16x32_bf16 v[72:75], v[100:103], v[224:227], v[72:75]
    ds_read_b64_tr_b16 v[94:95], v3 offset:58624
    s_waitcnt lgkmcnt(6)
    v_mfma_f32_16x16x32_bf16 v[76:79], v[104:107], v[220:223], v[76:79]
    ds_read_b64_tr_b16 v[96:97], v15 offset:57632
    v_mfma_f32_16x16x32_bf16 v[80:83], v[104:107], v[224:227], v[80:83]
    ds_read_b64_tr_b16 v[98:99], v15 offset:58656
    s_waitcnt vmcnt(9) lgkmcnt(6)
    v_mfma_f32_16x16x32_bf16 v[20:23], v[84:87], v[228:231], v[20:23]
    ds_read_b64_tr_b16 v[100:101], v3 offset:57856
    s_waitcnt vmcnt(8)
    v_mfma_f32_16x16x32_bf16 v[24:27], v[84:87], v[232:235], v[24:27]
    ds_read_b64_tr_b16 v[102:103], v3 offset:58880
    s_waitcnt lgkmcnt(6)
    v_mfma_f32_16x16x32_bf16 v[28:31], v[88:91], v[228:231], v[28:31]
    ds_read_b64_tr_b16 v[104:105], v15 offset:57888
    v_mfma_f32_16x16x32_bf16 v[32:35], v[88:91], v[232:235], v[32:35]
    ds_read_b64_tr_b16 v[106:107], v15 offset:58912
    s_mov_b32 s23, 0x4800
    buffer_load_dwordx4 v[212:215], v4, s[8:11], s23 offen offset:1024 sc1
    s_waitcnt lgkmcnt(6)
    v_mfma_f32_16x16x32_bf16 v[36:39], v[92:95], v[228:231], v[36:39]
    ds_read_b64_tr_b16 v[84:85], v3 offset:58112
    v_mfma_f32_16x16x32_bf16 v[40:43], v[92:95], v[232:235], v[40:43]
    ds_read_b64_tr_b16 v[86:87], v3 offset:59136
    s_waitcnt lgkmcnt(6)
    v_mfma_f32_16x16x32_bf16 v[44:47], v[96:99], v[228:231], v[44:47]
    ds_read_b64_tr_b16 v[88:89], v15 offset:58144
    v_mfma_f32_16x16x32_bf16 v[48:51], v[96:99], v[232:235], v[48:51]
    ds_read_b64_tr_b16 v[90:91], v15 offset:59168
    s_waitcnt lgkmcnt(6)
    v_mfma_f32_16x16x32_bf16 v[52:55], v[100:103], v[228:231], v[52:55]
    v_mfma_f32_16x16x32_bf16 v[56:59], v[100:103], v[232:235], v[56:59]
    s_barrier
    ds_read_b64_tr_b16 v[92:93], v3 offset:0
    ds_read_b64_tr_b16 v[94:95], v3 offset:1024
    s_waitcnt lgkmcnt(6)
    v_mfma_f32_16x16x32_bf16 v[60:63], v[104:107], v[228:231], v[60:63]
    ds_read_b64_tr_b16 v[96:97], v15 offset:32
    v_mfma_f32_16x16x32_bf16 v[64:67], v[104:107], v[232:235], v[64:67]
    ds_read_b64_tr_b16 v[98:99], v15 offset:1056
    s_mov_b32 s23, 0xc800
    buffer_load_dwordx4 v[216:219], v4, s[8:11], s23 offen offset:1024 sc1
    s_waitcnt lgkmcnt(6)
    v_mfma_f32_16x16x32_bf16 v[68:71], v[84:87], v[228:231], v[68:71]
    ds_read_b64_tr_b16 v[100:101], v3 offset:256
    v_mfma_f32_16x16x32_bf16 v[72:75], v[84:87], v[232:235], v[72:75]
    ds_read_b64_tr_b16 v[102:103], v3 offset:1280
    s_waitcnt lgkmcnt(6)
    v_mfma_f32_16x16x32_bf16 v[76:79], v[88:91], v[228:231], v[76:79]
    ds_read_b64_tr_b16 v[104:105], v15 offset:288
    v_mfma_f32_16x16x32_bf16 v[80:83], v[88:91], v[232:235], v[80:83]
    ds_read_b64_tr_b16 v[106:107], v15 offset:1312
    s_waitcnt vmcnt(9) lgkmcnt(6)
    v_mfma_f32_16x16x32_bf16 v[20:23], v[92:95], v[140:143], v[20:23]
    ds_read_b64_tr_b16 v[84:85], v3 offset:512
    s_waitcnt vmcnt(7)
    v_mfma_f32_16x16x32_bf16 v[24:27], v[92:95], v[144:147], v[24:27]
    ds_read_b64_tr_b16 v[86:87], v3 offset:1536
    s_waitcnt lgkmcnt(6)
    v_mfma_f32_16x16x32_bf16 v[28:31], v[96:99], v[140:143], v[28:31]
    ds_read_b64_tr_b16 v[88:89], v15 offset:544
    v_mfma_f32_16x16x32_bf16 v[32:35], v[96:99], v[144:147], v[32:35]
    ds_read_b64_tr_b16 v[90:91], v15 offset:1568
    s_mov_b32 s23, 0x5000
    buffer_load_dwordx4 v[220:223], v4, s[8:11], s23 offen offset:0 sc1
    s_waitcnt lgkmcnt(6)
    v_mfma_f32_16x16x32_bf16 v[36:39], v[100:103], v[140:143], v[36:39]
    ds_read_b64_tr_b16 v[92:93], v3 offset:768
    v_mfma_f32_16x16x32_bf16 v[40:43], v[100:103], v[144:147], v[40:43]
    ds_read_b64_tr_b16 v[94:95], v3 offset:1792
    s_waitcnt lgkmcnt(6)
    v_mfma_f32_16x16x32_bf16 v[44:47], v[104:107], v[140:143], v[44:47]
    ds_read_b64_tr_b16 v[96:97], v15 offset:800
    v_mfma_f32_16x16x32_bf16 v[48:51], v[104:107], v[144:147], v[48:51]
    ds_read_b64_tr_b16 v[98:99], v15 offset:1824
    s_mov_b32 s26, 0x600000
    buffer_load_dword v18, v17, s[68:71], s26 offen
    s_waitcnt lgkmcnt(6)
    v_mfma_f32_16x16x32_bf16 v[52:55], v[84:87], v[140:143], v[52:55]
    ds_read_b64_tr_b16 v[100:101], v3 offset:8192
    v_mfma_f32_16x16x32_bf16 v[56:59], v[84:87], v[144:147], v[56:59]
    ds_read_b64_tr_b16 v[102:103], v3 offset:9216
    s_waitcnt lgkmcnt(6)
    v_mfma_f32_16x16x32_bf16 v[60:63], v[88:91], v[140:143], v[60:63]
    ds_read_b64_tr_b16 v[104:105], v15 offset:8224
    v_mfma_f32_16x16x32_bf16 v[64:67], v[88:91], v[144:147], v[64:67]
    ds_read_b64_tr_b16 v[106:107], v15 offset:9248
    s_mov_b32 s23, 0xd000
    buffer_load_dwordx4 v[224:227], v4, s[8:11], s23 offen offset:0 sc1
    s_waitcnt lgkmcnt(6)
    v_mfma_f32_16x16x32_bf16 v[68:71], v[92:95], v[140:143], v[68:71]
    ds_read_b64_tr_b16 v[84:85], v3 offset:8448
    v_mfma_f32_16x16x32_bf16 v[72:75], v[92:95], v[144:147], v[72:75]
    ds_read_b64_tr_b16 v[86:87], v3 offset:9472
    s_waitcnt lgkmcnt(6)
    v_mfma_f32_16x16x32_bf16 v[76:79], v[96:99], v[140:143], v[76:79]
    ds_read_b64_tr_b16 v[88:89], v15 offset:8480
    v_mfma_f32_16x16x32_bf16 v[80:83], v[96:99], v[144:147], v[80:83]
    ds_read_b64_tr_b16 v[90:91], v15 offset:9504
    s_waitcnt vmcnt(9) lgkmcnt(6)
    v_mfma_f32_16x16x32_bf16 v[20:23], v[100:103], v[148:151], v[20:23]
    ds_read_b64_tr_b16 v[92:93], v3 offset:8704
    s_waitcnt vmcnt(8)
    v_mfma_f32_16x16x32_bf16 v[24:27], v[100:103], v[152:155], v[24:27]
    ds_read_b64_tr_b16 v[94:95], v3 offset:9728
    s_waitcnt lgkmcnt(6)
    v_mfma_f32_16x16x32_bf16 v[28:31], v[104:107], v[148:151], v[28:31]
    ds_read_b64_tr_b16 v[96:97], v15 offset:8736
    v_mfma_f32_16x16x32_bf16 v[32:35], v[104:107], v[152:155], v[32:35]
    ds_read_b64_tr_b16 v[98:99], v15 offset:9760
    s_mov_b32 s23, 0x5000
    buffer_load_dwordx4 v[228:231], v4, s[8:11], s23 offen offset:1024 sc1
    s_waitcnt lgkmcnt(6)
    v_mfma_f32_16x16x32_bf16 v[36:39], v[84:87], v[148:151], v[36:39]
    ds_read_b64_tr_b16 v[100:101], v3 offset:8960
    v_mfma_f32_16x16x32_bf16 v[40:43], v[84:87], v[152:155], v[40:43]
    ds_read_b64_tr_b16 v[102:103], v3 offset:9984
    s_waitcnt lgkmcnt(6)
    v_mfma_f32_16x16x32_bf16 v[44:47], v[88:91], v[148:151], v[44:47]
    ds_read_b64_tr_b16 v[104:105], v15 offset:8992
    v_mfma_f32_16x16x32_bf16 v[48:51], v[88:91], v[152:155], v[48:51]
    ds_read_b64_tr_b16 v[106:107], v15 offset:10016
    s_waitcnt lgkmcnt(6)
    v_mfma_f32_16x16x32_bf16 v[52:55], v[92:95], v[148:151], v[52:55]
    v_mfma_f32_16x16x32_bf16 v[56:59], v[92:95], v[152:155], v[56:59]
    s_barrier
    ds_read_b64_tr_b16 v[84:85], v3 offset:16384
    ds_read_b64_tr_b16 v[86:87], v3 offset:17408
    s_waitcnt lgkmcnt(6)
    v_mfma_f32_16x16x32_bf16 v[60:63], v[96:99], v[148:151], v[60:63]
    ds_read_b64_tr_b16 v[88:89], v15 offset:16416
    v_mfma_f32_16x16x32_bf16 v[64:67], v[96:99], v[152:155], v[64:67]
    ds_read_b64_tr_b16 v[90:91], v15 offset:17440
    s_mov_b32 s23, 0xd000
    buffer_load_dwordx4 v[232:235], v4, s[8:11], s23 offen offset:1024 sc1
    s_waitcnt lgkmcnt(6)
    v_mfma_f32_16x16x32_bf16 v[68:71], v[100:103], v[148:151], v[68:71]
    ds_read_b64_tr_b16 v[92:93], v3 offset:16640
    v_mfma_f32_16x16x32_bf16 v[72:75], v[100:103], v[152:155], v[72:75]
    ds_read_b64_tr_b16 v[94:95], v3 offset:17664
    s_waitcnt lgkmcnt(6)
    v_mfma_f32_16x16x32_bf16 v[76:79], v[104:107], v[148:151], v[76:79]
    ds_read_b64_tr_b16 v[96:97], v15 offset:16672
    v_mfma_f32_16x16x32_bf16 v[80:83], v[104:107], v[152:155], v[80:83]
    ds_read_b64_tr_b16 v[98:99], v15 offset:17696
    s_waitcnt vmcnt(9) lgkmcnt(6)
    v_mfma_f32_16x16x32_bf16 v[20:23], v[84:87], v[204:207], v[20:23]
    ds_read_b64_tr_b16 v[100:101], v3 offset:16896
    s_waitcnt vmcnt(7)
    v_mfma_f32_16x16x32_bf16 v[24:27], v[84:87], v[208:211], v[24:27]
    ds_read_b64_tr_b16 v[102:103], v3 offset:17920
    s_waitcnt lgkmcnt(6)
    v_mfma_f32_16x16x32_bf16 v[28:31], v[88:91], v[204:207], v[28:31]
    ds_read_b64_tr_b16 v[104:105], v15 offset:16928
    v_mfma_f32_16x16x32_bf16 v[32:35], v[88:91], v[208:211], v[32:35]
    ds_read_b64_tr_b16 v[106:107], v15 offset:17952
    s_mov_b32 s23, 0x5800
    buffer_load_dwordx4 v[140:143], v4, s[8:11], s23 offen offset:0 sc1
    s_waitcnt lgkmcnt(6)
    v_mfma_f32_16x16x32_bf16 v[36:39], v[92:95], v[204:207], v[36:39]
    ds_read_b64_tr_b16 v[84:85], v3 offset:17152
    v_mfma_f32_16x16x32_bf16 v[40:43], v[92:95], v[208:211], v[40:43]
    ds_read_b64_tr_b16 v[86:87], v3 offset:18176
    s_waitcnt lgkmcnt(6)
    v_mfma_f32_16x16x32_bf16 v[44:47], v[96:99], v[204:207], v[44:47]
    ds_read_b64_tr_b16 v[88:89], v15 offset:17184
    v_mfma_f32_16x16x32_bf16 v[48:51], v[96:99], v[208:211], v[48:51]
    ds_read_b64_tr_b16 v[90:91], v15 offset:18208
    s_mov_b32 s26, 0x680000
    buffer_load_dword v18, v17, s[68:71], s26 offen
    s_waitcnt lgkmcnt(6)
    v_mfma_f32_16x16x32_bf16 v[52:55], v[100:103], v[204:207], v[52:55]
    ds_read_b64_tr_b16 v[92:93], v3 offset:24576
    v_mfma_f32_16x16x32_bf16 v[56:59], v[100:103], v[208:211], v[56:59]
    ds_read_b64_tr_b16 v[94:95], v3 offset:25600
    s_waitcnt lgkmcnt(6)
    v_mfma_f32_16x16x32_bf16 v[60:63], v[104:107], v[204:207], v[60:63]
    ds_read_b64_tr_b16 v[96:97], v15 offset:24608
    v_mfma_f32_16x16x32_bf16 v[64:67], v[104:107], v[208:211], v[64:67]
    ds_read_b64_tr_b16 v[98:99], v15 offset:25632
    s_mov_b32 s23, 0xd800
    buffer_load_dwordx4 v[144:147], v4, s[8:11], s23 offen offset:0 sc1
    s_waitcnt lgkmcnt(6)
    v_mfma_f32_16x16x32_bf16 v[68:71], v[84:87], v[204:207], v[68:71]
    ds_read_b64_tr_b16 v[100:101], v3 offset:24832
    v_mfma_f32_16x16x32_bf16 v[72:75], v[84:87], v[208:211], v[72:75]
    ds_read_b64_tr_b16 v[102:103], v3 offset:25856
    s_waitcnt lgkmcnt(6)
    v_mfma_f32_16x16x32_bf16 v[76:79], v[88:91], v[204:207], v[76:79]
    ds_read_b64_tr_b16 v[104:105], v15 offset:24864
    v_mfma_f32_16x16x32_bf16 v[80:83], v[88:91], v[208:211], v[80:83]
    ds_read_b64_tr_b16 v[106:107], v15 offset:25888
    s_waitcnt vmcnt(9) lgkmcnt(6)
    v_mfma_f32_16x16x32_bf16 v[20:23], v[92:95], v[212:215], v[20:23]
    ds_read_b64_tr_b16 v[84:85], v3 offset:25088
    s_waitcnt vmcnt(8)
    v_mfma_f32_16x16x32_bf16 v[24:27], v[92:95], v[216:219], v[24:27]
    ds_read_b64_tr_b16 v[86:87], v3 offset:26112
    s_waitcnt lgkmcnt(6)
    v_mfma_f32_16x16x32_bf16 v[28:31], v[96:99], v[212:215], v[28:31]
    ds_read_b64_tr_b16 v[88:89], v15 offset:25120
    v_mfma_f32_16x16x32_bf16 v[32:35], v[96:99], v[216:219], v[32:35]
    ds_read_b64_tr_b16 v[90:91], v15 offset:26144
    s_mov_b32 s23, 0x5800
    buffer_load_dwordx4 v[148:151], v4, s[8:11], s23 offen offset:1024 sc1
    s_waitcnt lgkmcnt(6)
    v_mfma_f32_16x16x32_bf16 v[36:39], v[100:103], v[212:215], v[36:39]
    ds_read_b64_tr_b16 v[92:93], v3 offset:25344
    v_mfma_f32_16x16x32_bf16 v[40:43], v[100:103], v[216:219], v[40:43]
    ds_read_b64_tr_b16 v[94:95], v3 offset:26368
    s_waitcnt lgkmcnt(6)
    v_mfma_f32_16x16x32_bf16 v[44:47], v[104:107], v[212:215], v[44:47]
    ds_read_b64_tr_b16 v[96:97], v15 offset:25376
    v_mfma_f32_16x16x32_bf16 v[48:51], v[104:107], v[216:219], v[48:51]
    ds_read_b64_tr_b16 v[98:99], v15 offset:26400
    s_waitcnt lgkmcnt(6)
    v_mfma_f32_16x16x32_bf16 v[52:55], v[84:87], v[212:215], v[52:55]
    v_mfma_f32_16x16x32_bf16 v[56:59], v[84:87], v[216:219], v[56:59]
    s_barrier
    ds_read_b64_tr_b16 v[100:101], v3 offset:32768
    ds_read_b64_tr_b16 v[102:103], v3 offset:33792
    s_waitcnt lgkmcnt(6)
    v_mfma_f32_16x16x32_bf16 v[60:63], v[88:91], v[212:215], v[60:63]
    ds_read_b64_tr_b16 v[104:105], v15 offset:32800
    v_mfma_f32_16x16x32_bf16 v[64:67], v[88:91], v[216:219], v[64:67]
    ds_read_b64_tr_b16 v[106:107], v15 offset:33824
    s_mov_b32 s23, 0xd800
    buffer_load_dwordx4 v[152:155], v4, s[8:11], s23 offen offset:1024 sc1
    s_waitcnt lgkmcnt(6)
    v_mfma_f32_16x16x32_bf16 v[68:71], v[92:95], v[212:215], v[68:71]
    ds_read_b64_tr_b16 v[84:85], v3 offset:33024
    v_mfma_f32_16x16x32_bf16 v[72:75], v[92:95], v[216:219], v[72:75]
    ds_read_b64_tr_b16 v[86:87], v3 offset:34048
    s_waitcnt lgkmcnt(6)
    v_mfma_f32_16x16x32_bf16 v[76:79], v[96:99], v[212:215], v[76:79]
    ds_read_b64_tr_b16 v[88:89], v15 offset:33056
    v_mfma_f32_16x16x32_bf16 v[80:83], v[96:99], v[216:219], v[80:83]
    ds_read_b64_tr_b16 v[90:91], v15 offset:34080
    s_waitcnt vmcnt(9) lgkmcnt(6)
    v_mfma_f32_16x16x32_bf16 v[20:23], v[100:103], v[220:223], v[20:23]
    ds_read_b64_tr_b16 v[92:93], v3 offset:33280
    s_waitcnt vmcnt(7)
    v_mfma_f32_16x16x32_bf16 v[24:27], v[100:103], v[224:227], v[24:27]
    ds_read_b64_tr_b16 v[94:95], v3 offset:34304
    s_waitcnt lgkmcnt(6)
    v_mfma_f32_16x16x32_bf16 v[28:31], v[104:107], v[220:223], v[28:31]
    ds_read_b64_tr_b16 v[96:97], v15 offset:33312
    v_mfma_f32_16x16x32_bf16 v[32:35], v[104:107], v[224:227], v[32:35]
    ds_read_b64_tr_b16 v[98:99], v15 offset:34336
    s_mov_b32 s23, 0x6000
    buffer_load_dwordx4 v[204:207], v4, s[8:11], s23 offen offset:0 sc1
    s_waitcnt lgkmcnt(6)
    v_mfma_f32_16x16x32_bf16 v[36:39], v[84:87], v[220:223], v[36:39]
    ds_read_b64_tr_b16 v[100:101], v3 offset:33536
    v_mfma_f32_16x16x32_bf16 v[40:43], v[84:87], v[224:227], v[40:43]
    ds_read_b64_tr_b16 v[102:103], v3 offset:34560
    s_waitcnt lgkmcnt(6)
    v_mfma_f32_16x16x32_bf16 v[44:47], v[88:91], v[220:223], v[44:47]
    ds_read_b64_tr_b16 v[104:105], v15 offset:33568
    v_mfma_f32_16x16x32_bf16 v[48:51], v[88:91], v[224:227], v[48:51]
    ds_read_b64_tr_b16 v[106:107], v15 offset:34592
    s_mov_b32 s26, 0x700000
    buffer_load_dword v18, v17, s[68:71], s26 offen
    s_waitcnt lgkmcnt(6)
    v_mfma_f32_16x16x32_bf16 v[52:55], v[92:95], v[220:223], v[52:55]
    ds_read_b64_tr_b16 v[84:85], v3 offset:40960
    v_mfma_f32_16x16x32_bf16 v[56:59], v[92:95], v[224:227], v[56:59]
    ds_read_b64_tr_b16 v[86:87], v3 offset:41984
    s_waitcnt lgkmcnt(6)
    v_mfma_f32_16x16x32_bf16 v[60:63], v[96:99], v[220:223], v[60:63]
    ds_read_b64_tr_b16 v[88:89], v15 offset:40992
    v_mfma_f32_16x16x32_bf16 v[64:67], v[96:99], v[224:227], v[64:67]
    ds_read_b64_tr_b16 v[90:91], v15 offset:42016
    s_mov_b32 s23, 0xe000
    buffer_load_dwordx4 v[208:211], v4, s[8:11], s23 offen offset:0 sc1
    s_waitcnt lgkmcnt(6)
    v_mfma_f32_16x16x32_bf16 v[68:71], v[100:103], v[220:223], v[68:71]
    ds_read_b64_tr_b16 v[92:93], v3 offset:41216
    v_mfma_f32_16x16x32_bf16 v[72:75], v[100:103], v[224:227], v[72:75]
    ds_read_b64_tr_b16 v[94:95], v3 offset:42240
    s_waitcnt lgkmcnt(6)
    v_mfma_f32_16x16x32_bf16 v[76:79], v[104:107], v[220:223], v[76:79]
    ds_read_b64_tr_b16 v[96:97], v15 offset:41248
    v_mfma_f32_16x16x32_bf16 v[80:83], v[104:107], v[224:227], v[80:83]
    ds_read_b64_tr_b16 v[98:99], v15 offset:42272
    s_waitcnt vmcnt(9) lgkmcnt(6)
    v_mfma_f32_16x16x32_bf16 v[20:23], v[84:87], v[228:231], v[20:23]
    ds_read_b64_tr_b16 v[100:101], v3 offset:41472
    s_waitcnt vmcnt(8)
    v_mfma_f32_16x16x32_bf16 v[24:27], v[84:87], v[232:235], v[24:27]
    ds_read_b64_tr_b16 v[102:103], v3 offset:42496
    s_waitcnt lgkmcnt(6)
    v_mfma_f32_16x16x32_bf16 v[28:31], v[88:91], v[228:231], v[28:31]
    ds_read_b64_tr_b16 v[104:105], v15 offset:41504
    v_mfma_f32_16x16x32_bf16 v[32:35], v[88:91], v[232:235], v[32:35]
    ds_read_b64_tr_b16 v[106:107], v15 offset:42528
    s_mov_b32 s23, 0x6000
    buffer_load_dwordx4 v[212:215], v4, s[8:11], s23 offen offset:1024 sc1
    s_waitcnt lgkmcnt(6)
    v_mfma_f32_16x16x32_bf16 v[36:39], v[92:95], v[228:231], v[36:39]
    ds_read_b64_tr_b16 v[84:85], v3 offset:41728
    v_mfma_f32_16x16x32_bf16 v[40:43], v[92:95], v[232:235], v[40:43]
    ds_read_b64_tr_b16 v[86:87], v3 offset:42752
    s_waitcnt lgkmcnt(6)
    v_mfma_f32_16x16x32_bf16 v[44:47], v[96:99], v[228:231], v[44:47]
    ds_read_b64_tr_b16 v[88:89], v15 offset:41760
    v_mfma_f32_16x16x32_bf16 v[48:51], v[96:99], v[232:235], v[48:51]
    ds_read_b64_tr_b16 v[90:91], v15 offset:42784
    s_waitcnt lgkmcnt(6)
    v_mfma_f32_16x16x32_bf16 v[52:55], v[100:103], v[228:231], v[52:55]
    v_mfma_f32_16x16x32_bf16 v[56:59], v[100:103], v[232:235], v[56:59]
    s_barrier
    ds_read_b64_tr_b16 v[92:93], v3 offset:49152
    ds_read_b64_tr_b16 v[94:95], v3 offset:50176
    s_waitcnt lgkmcnt(6)
    v_mfma_f32_16x16x32_bf16 v[60:63], v[104:107], v[228:231], v[60:63]
    ds_read_b64_tr_b16 v[96:97], v15 offset:49184
    v_mfma_f32_16x16x32_bf16 v[64:67], v[104:107], v[232:235], v[64:67]
    ds_read_b64_tr_b16 v[98:99], v15 offset:50208
    s_mov_b32 s23, 0xe000
    buffer_load_dwordx4 v[216:219], v4, s[8:11], s23 offen offset:1024 sc1
    s_waitcnt lgkmcnt(6)
    v_mfma_f32_16x16x32_bf16 v[68:71], v[84:87], v[228:231], v[68:71]
    ds_read_b64_tr_b16 v[100:101], v3 offset:49408
    v_mfma_f32_16x16x32_bf16 v[72:75], v[84:87], v[232:235], v[72:75]
    ds_read_b64_tr_b16 v[102:103], v3 offset:50432
    s_waitcnt lgkmcnt(6)
    v_mfma_f32_16x16x32_bf16 v[76:79], v[88:91], v[228:231], v[76:79]
    ds_read_b64_tr_b16 v[104:105], v15 offset:49440
    v_mfma_f32_16x16x32_bf16 v[80:83], v[88:91], v[232:235], v[80:83]
    ds_read_b64_tr_b16 v[106:107], v15 offset:50464
    s_waitcnt vmcnt(9) lgkmcnt(6)
    v_mfma_f32_16x16x32_bf16 v[20:23], v[92:95], v[140:143], v[20:23]
    ds_read_b64_tr_b16 v[84:85], v3 offset:49664
    s_waitcnt vmcnt(7)
    v_mfma_f32_16x16x32_bf16 v[24:27], v[92:95], v[144:147], v[24:27]
    ds_read_b64_tr_b16 v[86:87], v3 offset:50688
    s_waitcnt lgkmcnt(6)
    v_mfma_f32_16x16x32_bf16 v[28:31], v[96:99], v[140:143], v[28:31]
    ds_read_b64_tr_b16 v[88:89], v15 offset:49696
    v_mfma_f32_16x16x32_bf16 v[32:35], v[96:99], v[144:147], v[32:35]
    ds_read_b64_tr_b16 v[90:91], v15 offset:50720
    s_mov_b32 s23, 0x6800
    buffer_load_dwordx4 v[220:223], v4, s[8:11], s23 offen offset:0 sc1
    s_waitcnt lgkmcnt(6)
    v_mfma_f32_16x16x32_bf16 v[36:39], v[100:103], v[140:143], v[36:39]
    ds_read_b64_tr_b16 v[92:93], v3 offset:49920
    v_mfma_f32_16x16x32_bf16 v[40:43], v[100:103], v[144:147], v[40:43]
    ds_read_b64_tr_b16 v[94:95], v3 offset:50944
    s_waitcnt lgkmcnt(6)
    v_mfma_f32_16x16x32_bf16 v[44:47], v[104:107], v[140:143], v[44:47]
    ds_read_b64_tr_b16 v[96:97], v15 offset:49952
    v_mfma_f32_16x16x32_bf16 v[48:51], v[104:107], v[144:147], v[48:51]
    ds_read_b64_tr_b16 v[98:99], v15 offset:50976
    s_mov_b32 s26, 0x780000
    buffer_load_dword v18, v17, s[68:71], s26 offen
    s_waitcnt lgkmcnt(6)
    v_mfma_f32_16x16x32_bf16 v[52:55], v[84:87], v[140:143], v[52:55]
    ds_read_b64_tr_b16 v[100:101], v3 offset:57344
    v_mfma_f32_16x16x32_bf16 v[56:59], v[84:87], v[144:147], v[56:59]
    ds_read_b64_tr_b16 v[102:103], v3 offset:58368
    s_waitcnt lgkmcnt(6)
    v_mfma_f32_16x16x32_bf16 v[60:63], v[88:91], v[140:143], v[60:63]
    ds_read_b64_tr_b16 v[104:105], v15 offset:57376
    v_mfma_f32_16x16x32_bf16 v[64:67], v[88:91], v[144:147], v[64:67]
    ds_read_b64_tr_b16 v[106:107], v15 offset:58400
    s_mov_b32 s23, 0xe800
    buffer_load_dwordx4 v[224:227], v4, s[8:11], s23 offen offset:0 sc1
    s_waitcnt lgkmcnt(6)
    v_mfma_f32_16x16x32_bf16 v[68:71], v[92:95], v[140:143], v[68:71]
    ds_read_b64_tr_b16 v[84:85], v3 offset:57600
    v_mfma_f32_16x16x32_bf16 v[72:75], v[92:95], v[144:147], v[72:75]
    ds_read_b64_tr_b16 v[86:87], v3 offset:58624
    s_waitcnt lgkmcnt(6)
    v_mfma_f32_16x16x32_bf16 v[76:79], v[96:99], v[140:143], v[76:79]
    ds_read_b64_tr_b16 v[88:89], v15 offset:57632
    v_mfma_f32_16x16x32_bf16 v[80:83], v[96:99], v[144:147], v[80:83]
    ds_read_b64_tr_b16 v[90:91], v15 offset:58656
    s_waitcnt vmcnt(9) lgkmcnt(6)
    v_mfma_f32_16x16x32_bf16 v[20:23], v[100:103], v[148:151], v[20:23]
    ds_read_b64_tr_b16 v[92:93], v3 offset:57856
    s_waitcnt vmcnt(8)
    v_mfma_f32_16x16x32_bf16 v[24:27], v[100:103], v[152:155], v[24:27]
    ds_read_b64_tr_b16 v[94:95], v3 offset:58880
    s_waitcnt lgkmcnt(6)
    v_mfma_f32_16x16x32_bf16 v[28:31], v[104:107], v[148:151], v[28:31]
    ds_read_b64_tr_b16 v[96:97], v15 offset:57888
    v_mfma_f32_16x16x32_bf16 v[32:35], v[104:107], v[152:155], v[32:35]
    ds_read_b64_tr_b16 v[98:99], v15 offset:58912
    s_mov_b32 s23, 0x6800
    buffer_load_dwordx4 v[228:231], v4, s[8:11], s23 offen offset:1024 sc1
    s_waitcnt lgkmcnt(6)
    v_mfma_f32_16x16x32_bf16 v[36:39], v[84:87], v[148:151], v[36:39]
    ds_read_b64_tr_b16 v[100:101], v3 offset:58112
    v_mfma_f32_16x16x32_bf16 v[40:43], v[84:87], v[152:155], v[40:43]
    ds_read_b64_tr_b16 v[102:103], v3 offset:59136
    s_waitcnt lgkmcnt(6)
    v_mfma_f32_16x16x32_bf16 v[44:47], v[88:91], v[148:151], v[44:47]
    ds_read_b64_tr_b16 v[104:105], v15 offset:58144
    v_mfma_f32_16x16x32_bf16 v[48:51], v[88:91], v[152:155], v[48:51]
    ds_read_b64_tr_b16 v[106:107], v15 offset:59168
    s_waitcnt lgkmcnt(6)
    v_mfma_f32_16x16x32_bf16 v[52:55], v[92:95], v[148:151], v[52:55]
    v_mfma_f32_16x16x32_bf16 v[56:59], v[92:95], v[152:155], v[56:59]
    s_barrier
    ds_read_b64_tr_b16 v[84:85], v3 offset:0
    ds_read_b64_tr_b16 v[86:87], v3 offset:1024
    s_waitcnt lgkmcnt(6)
    v_mfma_f32_16x16x32_bf16 v[60:63], v[96:99], v[148:151], v[60:63]
    ds_read_b64_tr_b16 v[88:89], v15 offset:32
    v_mfma_f32_16x16x32_bf16 v[64:67], v[96:99], v[152:155], v[64:67]
    ds_read_b64_tr_b16 v[90:91], v15 offset:1056
    s_mov_b32 s23, 0xe800
    buffer_load_dwordx4 v[232:235], v4, s[8:11], s23 offen offset:1024 sc1
    s_waitcnt lgkmcnt(6)
    v_mfma_f32_16x16x32_bf16 v[68:71], v[100:103], v[148:151], v[68:71]
    ds_read_b64_tr_b16 v[92:93], v3 offset:256
    v_mfma_f32_16x16x32_bf16 v[72:75], v[100:103], v[152:155], v[72:75]
    ds_read_b64_tr_b16 v[94:95], v3 offset:1280
    s_waitcnt lgkmcnt(6)
    v_mfma_f32_16x16x32_bf16 v[76:79], v[104:107], v[148:151], v[76:79]
    ds_read_b64_tr_b16 v[96:97], v15 offset:288
    v_mfma_f32_16x16x32_bf16 v[80:83], v[104:107], v[152:155], v[80:83]
    ds_read_b64_tr_b16 v[98:99], v15 offset:1312
    s_waitcnt vmcnt(9) lgkmcnt(6)
    v_mfma_f32_16x16x32_bf16 v[20:23], v[84:87], v[204:207], v[20:23]
    ds_read_b64_tr_b16 v[100:101], v3 offset:512
    s_waitcnt vmcnt(7)
    v_mfma_f32_16x16x32_bf16 v[24:27], v[84:87], v[208:211], v[24:27]
    ds_read_b64_tr_b16 v[102:103], v3 offset:1536
    s_waitcnt lgkmcnt(6)
    v_mfma_f32_16x16x32_bf16 v[28:31], v[88:91], v[204:207], v[28:31]
    ds_read_b64_tr_b16 v[104:105], v15 offset:544
    v_mfma_f32_16x16x32_bf16 v[32:35], v[88:91], v[208:211], v[32:35]
    ds_read_b64_tr_b16 v[106:107], v15 offset:1568
    s_mov_b32 s23, 0x7000
    buffer_load_dwordx4 v[140:143], v4, s[8:11], s23 offen offset:0 sc1
    s_waitcnt lgkmcnt(6)
    v_mfma_f32_16x16x32_bf16 v[36:39], v[92:95], v[204:207], v[36:39]
    ds_read_b64_tr_b16 v[84:85], v3 offset:768
    v_mfma_f32_16x16x32_bf16 v[40:43], v[92:95], v[208:211], v[40:43]
    ds_read_b64_tr_b16 v[86:87], v3 offset:1792
    s_waitcnt lgkmcnt(6)
    v_mfma_f32_16x16x32_bf16 v[44:47], v[96:99], v[204:207], v[44:47]
    ds_read_b64_tr_b16 v[88:89], v15 offset:800
    v_mfma_f32_16x16x32_bf16 v[48:51], v[96:99], v[208:211], v[48:51]
    ds_read_b64_tr_b16 v[90:91], v15 offset:1824
    s_waitcnt lgkmcnt(6)
    v_mfma_f32_16x16x32_bf16 v[52:55], v[100:103], v[204:207], v[52:55]
    ds_read_b64_tr_b16 v[92:93], v3 offset:8192
    v_mfma_f32_16x16x32_bf16 v[56:59], v[100:103], v[208:211], v[56:59]
    ds_read_b64_tr_b16 v[94:95], v3 offset:9216
    s_waitcnt lgkmcnt(6)
    v_mfma_f32_16x16x32_bf16 v[60:63], v[104:107], v[204:207], v[60:63]
    ds_read_b64_tr_b16 v[96:97], v15 offset:8224
    v_mfma_f32_16x16x32_bf16 v[64:67], v[104:107], v[208:211], v[64:67]
    ds_read_b64_tr_b16 v[98:99], v15 offset:9248
    s_mov_b32 s23, 0xf000
    buffer_load_dwordx4 v[144:147], v4, s[8:11], s23 offen offset:0 sc1
    s_waitcnt lgkmcnt(6)
    v_mfma_f32_16x16x32_bf16 v[68:71], v[84:87], v[204:207], v[68:71]
    ds_read_b64_tr_b16 v[100:101], v3 offset:8448
    v_mfma_f32_16x16x32_bf16 v[72:75], v[84:87], v[208:211], v[72:75]
    ds_read_b64_tr_b16 v[102:103], v3 offset:9472
    s_waitcnt lgkmcnt(6)
    v_mfma_f32_16x16x32_bf16 v[76:79], v[88:91], v[204:207], v[76:79]
    ds_read_b64_tr_b16 v[104:105], v15 offset:8480
    v_mfma_f32_16x16x32_bf16 v[80:83], v[88:91], v[208:211], v[80:83]
    ds_read_b64_tr_b16 v[106:107], v15 offset:9504
    s_waitcnt vmcnt(8) lgkmcnt(6)
    v_mfma_f32_16x16x32_bf16 v[20:23], v[92:95], v[212:215], v[20:23]
    ds_read_b64_tr_b16 v[84:85], v3 offset:8704
    s_waitcnt vmcnt(7)
    v_mfma_f32_16x16x32_bf16 v[24:27], v[92:95], v[216:219], v[24:27]
    ds_read_b64_tr_b16 v[86:87], v3 offset:9728
    s_waitcnt lgkmcnt(6)
    v_mfma_f32_16x16x32_bf16 v[28:31], v[96:99], v[212:215], v[28:31]
    ds_read_b64_tr_b16 v[88:89], v15 offset:8736
    v_mfma_f32_16x16x32_bf16 v[32:35], v[96:99], v[216:219], v[32:35]
    ds_read_b64_tr_b16 v[90:91], v15 offset:9760
    s_mov_b32 s23, 0x7000
    buffer_load_dwordx4 v[148:151], v4, s[8:11], s23 offen offset:1024 sc1
    s_waitcnt lgkmcnt(6)
    v_mfma_f32_16x16x32_bf16 v[36:39], v[100:103], v[212:215], v[36:39]
    ds_read_b64_tr_b16 v[92:93], v3 offset:8960
    v_mfma_f32_16x16x32_bf16 v[40:43], v[100:103], v[216:219], v[40:43]
    ds_read_b64_tr_b16 v[94:95], v3 offset:9984
    s_waitcnt lgkmcnt(6)
    v_mfma_f32_16x16x32_bf16 v[44:47], v[104:107], v[212:215], v[44:47]
    ds_read_b64_tr_b16 v[96:97], v15 offset:8992
    v_mfma_f32_16x16x32_bf16 v[48:51], v[104:107], v[216:219], v[48:51]
    ds_read_b64_tr_b16 v[98:99], v15 offset:10016
    s_waitcnt lgkmcnt(6)
    v_mfma_f32_16x16x32_bf16 v[52:55], v[84:87], v[212:215], v[52:55]
    v_mfma_f32_16x16x32_bf16 v[56:59], v[84:87], v[216:219], v[56:59]
    s_barrier
    ds_read_b64_tr_b16 v[100:101], v3 offset:16384
    ds_read_b64_tr_b16 v[102:103], v3 offset:17408
    s_waitcnt lgkmcnt(6)
    v_mfma_f32_16x16x32_bf16 v[60:63], v[88:91], v[212:215], v[60:63]
    ds_read_b64_tr_b16 v[104:105], v15 offset:16416
    v_mfma_f32_16x16x32_bf16 v[64:67], v[88:91], v[216:219], v[64:67]
    ds_read_b64_tr_b16 v[106:107], v15 offset:17440
    s_mov_b32 s23, 0xf000
    buffer_load_dwordx4 v[152:155], v4, s[8:11], s23 offen offset:1024 sc1
    s_waitcnt lgkmcnt(6)
    v_mfma_f32_16x16x32_bf16 v[68:71], v[92:95], v[212:215], v[68:71]
    ds_read_b64_tr_b16 v[84:85], v3 offset:16640
    v_mfma_f32_16x16x32_bf16 v[72:75], v[92:95], v[216:219], v[72:75]
    ds_read_b64_tr_b16 v[86:87], v3 offset:17664
    s_waitcnt lgkmcnt(6)
    v_mfma_f32_16x16x32_bf16 v[76:79], v[96:99], v[212:215], v[76:79]
    ds_read_b64_tr_b16 v[88:89], v15 offset:16672
    v_mfma_f32_16x16x32_bf16 v[80:83], v[96:99], v[216:219], v[80:83]
    ds_read_b64_tr_b16 v[90:91], v15 offset:17696
    s_waitcnt vmcnt(8) lgkmcnt(6)
    v_mfma_f32_16x16x32_bf16 v[20:23], v[100:103], v[220:223], v[20:23]
    ds_read_b64_tr_b16 v[92:93], v3 offset:16896
    s_waitcnt vmcnt(6)
    v_mfma_f32_16x16x32_bf16 v[24:27], v[100:103], v[224:227], v[24:27]
    ds_read_b64_tr_b16 v[94:95], v3 offset:17920
    s_waitcnt lgkmcnt(6)
    v_mfma_f32_16x16x32_bf16 v[28:31], v[104:107], v[220:223], v[28:31]
    ds_read_b64_tr_b16 v[96:97], v15 offset:16928
    v_mfma_f32_16x16x32_bf16 v[32:35], v[104:107], v[224:227], v[32:35]
    ds_read_b64_tr_b16 v[98:99], v15 offset:17952
    s_mov_b32 s23, 0x7800
    buffer_load_dwordx4 v[204:207], v4, s[8:11], s23 offen offset:0 sc1
    s_waitcnt lgkmcnt(6)
    v_mfma_f32_16x16x32_bf16 v[36:39], v[84:87], v[220:223], v[36:39]
    ds_read_b64_tr_b16 v[100:101], v3 offset:17152
    v_mfma_f32_16x16x32_bf16 v[40:43], v[84:87], v[224:227], v[40:43]
    ds_read_b64_tr_b16 v[102:103], v3 offset:18176
    s_waitcnt lgkmcnt(6)
    v_mfma_f32_16x16x32_bf16 v[44:47], v[88:91], v[220:223], v[44:47]
    ds_read_b64_tr_b16 v[104:105], v15 offset:17184
    v_mfma_f32_16x16x32_bf16 v[48:51], v[88:91], v[224:227], v[48:51]
    ds_read_b64_tr_b16 v[106:107], v15 offset:18208
    s_waitcnt lgkmcnt(6)
    v_mfma_f32_16x16x32_bf16 v[52:55], v[92:95], v[220:223], v[52:55]
    ds_read_b64_tr_b16 v[84:85], v3 offset:24576
    v_mfma_f32_16x16x32_bf16 v[56:59], v[92:95], v[224:227], v[56:59]
    ds_read_b64_tr_b16 v[86:87], v3 offset:25600
    s_waitcnt lgkmcnt(6)
    v_mfma_f32_16x16x32_bf16 v[60:63], v[96:99], v[220:223], v[60:63]
    ds_read_b64_tr_b16 v[88:89], v15 offset:24608
    v_mfma_f32_16x16x32_bf16 v[64:67], v[96:99], v[224:227], v[64:67]
    ds_read_b64_tr_b16 v[90:91], v15 offset:25632
    s_mov_b32 s23, 0xf800
    buffer_load_dwordx4 v[208:211], v4, s[8:11], s23 offen offset:0 sc1
    s_waitcnt lgkmcnt(6)
    v_mfma_f32_16x16x32_bf16 v[68:71], v[100:103], v[220:223], v[68:71]
    ds_read_b64_tr_b16 v[92:93], v3 offset:24832
    v_mfma_f32_16x16x32_bf16 v[72:75], v[100:103], v[224:227], v[72:75]
    ds_read_b64_tr_b16 v[94:95], v3 offset:25856
    s_waitcnt lgkmcnt(6)
    v_mfma_f32_16x16x32_bf16 v[76:79], v[104:107], v[220:223], v[76:79]
    ds_read_b64_tr_b16 v[96:97], v15 offset:24864
    v_mfma_f32_16x16x32_bf16 v[80:83], v[104:107], v[224:227], v[80:83]
    ds_read_b64_tr_b16 v[98:99], v15 offset:25888
    s_waitcnt vmcnt(7) lgkmcnt(6)
    v_mfma_f32_16x16x32_bf16 v[20:23], v[84:87], v[228:231], v[20:23]
    ds_read_b64_tr_b16 v[100:101], v3 offset:25088
    s_waitcnt vmcnt(6)
    v_mfma_f32_16x16x32_bf16 v[24:27], v[84:87], v[232:235], v[24:27]
    ds_read_b64_tr_b16 v[102:103], v3 offset:26112
    s_waitcnt lgkmcnt(6)
    v_mfma_f32_16x16x32_bf16 v[28:31], v[88:91], v[228:231], v[28:31]
    ds_read_b64_tr_b16 v[104:105], v15 offset:25120
    v_mfma_f32_16x16x32_bf16 v[32:35], v[88:91], v[232:235], v[32:35]
    ds_read_b64_tr_b16 v[106:107], v15 offset:26144
    s_mov_b32 s23, 0x7800
    buffer_load_dwordx4 v[212:215], v4, s[8:11], s23 offen offset:1024 sc1
    s_waitcnt lgkmcnt(6)
    v_mfma_f32_16x16x32_bf16 v[36:39], v[92:95], v[228:231], v[36:39]
    ds_read_b64_tr_b16 v[84:85], v3 offset:25344
    v_mfma_f32_16x16x32_bf16 v[40:43], v[92:95], v[232:235], v[40:43]
    ds_read_b64_tr_b16 v[86:87], v3 offset:26368
    s_waitcnt lgkmcnt(6)
    v_mfma_f32_16x16x32_bf16 v[44:47], v[96:99], v[228:231], v[44:47]
    ds_read_b64_tr_b16 v[88:89], v15 offset:25376
    v_mfma_f32_16x16x32_bf16 v[48:51], v[96:99], v[232:235], v[48:51]
    ds_read_b64_tr_b16 v[90:91], v15 offset:26400
    s_waitcnt lgkmcnt(6)
    v_mfma_f32_16x16x32_bf16 v[52:55], v[100:103], v[228:231], v[52:55]
    v_mfma_f32_16x16x32_bf16 v[56:59], v[100:103], v[232:235], v[56:59]
    s_barrier
    ds_read_b64_tr_b16 v[92:93], v3 offset:32768
    ds_read_b64_tr_b16 v[94:95], v3 offset:33792
    s_waitcnt lgkmcnt(6)
    v_mfma_f32_16x16x32_bf16 v[60:63], v[104:107], v[228:231], v[60:63]
    ds_read_b64_tr_b16 v[96:97], v15 offset:32800
    v_mfma_f32_16x16x32_bf16 v[64:67], v[104:107], v[232:235], v[64:67]
    ds_read_b64_tr_b16 v[98:99], v15 offset:33824
    s_mov_b32 s23, 0xf800
    buffer_load_dwordx4 v[216:219], v4, s[8:11], s23 offen offset:1024 sc1
    s_waitcnt lgkmcnt(6)
    v_mfma_f32_16x16x32_bf16 v[68:71], v[84:87], v[228:231], v[68:71]
    ds_read_b64_tr_b16 v[100:101], v3 offset:33024
    v_mfma_f32_16x16x32_bf16 v[72:75], v[84:87], v[232:235], v[72:75]
    ds_read_b64_tr_b16 v[102:103], v3 offset:34048
    s_waitcnt lgkmcnt(6)
    v_mfma_f32_16x16x32_bf16 v[76:79], v[88:91], v[228:231], v[76:79]
    ds_read_b64_tr_b16 v[104:105], v15 offset:33056
    v_mfma_f32_16x16x32_bf16 v[80:83], v[88:91], v[232:235], v[80:83]
    ds_read_b64_tr_b16 v[106:107], v15 offset:34080
    s_waitcnt vmcnt(7) lgkmcnt(6)
    v_mfma_f32_16x16x32_bf16 v[20:23], v[92:95], v[140:143], v[20:23]
    ds_read_b64_tr_b16 v[84:85], v3 offset:33280
    s_waitcnt vmcnt(6)
    v_mfma_f32_16x16x32_bf16 v[24:27], v[92:95], v[144:147], v[24:27]
    ds_read_b64_tr_b16 v[86:87], v3 offset:34304
    s_waitcnt lgkmcnt(6)
    v_mfma_f32_16x16x32_bf16 v[28:31], v[96:99], v[140:143], v[28:31]
    ds_read_b64_tr_b16 v[88:89], v15 offset:33312
    v_mfma_f32_16x16x32_bf16 v[32:35], v[96:99], v[144:147], v[32:35]
    ds_read_b64_tr_b16 v[90:91], v15 offset:34336
    s_waitcnt lgkmcnt(6)
    v_mfma_f32_16x16x32_bf16 v[36:39], v[100:103], v[140:143], v[36:39]
    ds_read_b64_tr_b16 v[92:93], v3 offset:33536
    v_mfma_f32_16x16x32_bf16 v[40:43], v[100:103], v[144:147], v[40:43]
    ds_read_b64_tr_b16 v[94:95], v3 offset:34560
    s_waitcnt lgkmcnt(6)
    v_mfma_f32_16x16x32_bf16 v[44:47], v[104:107], v[140:143], v[44:47]
    ds_read_b64_tr_b16 v[96:97], v15 offset:33568
    v_mfma_f32_16x16x32_bf16 v[48:51], v[104:107], v[144:147], v[48:51]
    ds_read_b64_tr_b16 v[98:99], v15 offset:34592
    s_waitcnt lgkmcnt(6)
    v_mfma_f32_16x16x32_bf16 v[52:55], v[84:87], v[140:143], v[52:55]
    ds_read_b64_tr_b16 v[100:101], v3 offset:40960
    v_mfma_f32_16x16x32_bf16 v[56:59], v[84:87], v[144:147], v[56:59]
    ds_read_b64_tr_b16 v[102:103], v3 offset:41984
    s_waitcnt lgkmcnt(6)
    v_mfma_f32_16x16x32_bf16 v[60:63], v[88:91], v[140:143], v[60:63]
    ds_read_b64_tr_b16 v[104:105], v15 offset:40992
    v_mfma_f32_16x16x32_bf16 v[64:67], v[88:91], v[144:147], v[64:67]
    ds_read_b64_tr_b16 v[106:107], v15 offset:42016
    s_waitcnt lgkmcnt(6)
    v_mfma_f32_16x16x32_bf16 v[68:71], v[92:95], v[140:143], v[68:71]
    ds_read_b64_tr_b16 v[84:85], v3 offset:41216
    v_mfma_f32_16x16x32_bf16 v[72:75], v[92:95], v[144:147], v[72:75]
    ds_read_b64_tr_b16 v[86:87], v3 offset:42240
    s_waitcnt lgkmcnt(6)
    v_mfma_f32_16x16x32_bf16 v[76:79], v[96:99], v[140:143], v[76:79]
    ds_read_b64_tr_b16 v[88:89], v15 offset:41248
    v_mfma_f32_16x16x32_bf16 v[80:83], v[96:99], v[144:147], v[80:83]
    ds_read_b64_tr_b16 v[90:91], v15 offset:42272
    s_waitcnt vmcnt(5) lgkmcnt(6)
    v_mfma_f32_16x16x32_bf16 v[20:23], v[100:103], v[148:151], v[20:23]
    ds_read_b64_tr_b16 v[92:93], v3 offset:41472
    s_waitcnt vmcnt(4)
    v_mfma_f32_16x16x32_bf16 v[24:27], v[100:103], v[152:155], v[24:27]
    ds_read_b64_tr_b16 v[94:95], v3 offset:42496
    s_waitcnt lgkmcnt(6)
    v_mfma_f32_16x16x32_bf16 v[28:31], v[104:107], v[148:151], v[28:31]
    ds_read_b64_tr_b16 v[96:97], v15 offset:41504
    v_mfma_f32_16x16x32_bf16 v[32:35], v[104:107], v[152:155], v[32:35]
    ds_read_b64_tr_b16 v[98:99], v15 offset:42528
    s_waitcnt lgkmcnt(6)
    v_mfma_f32_16x16x32_bf16 v[36:39], v[84:87], v[148:151], v[36:39]
    ds_read_b64_tr_b16 v[100:101], v3 offset:41728
    v_mfma_f32_16x16x32_bf16 v[40:43], v[84:87], v[152:155], v[40:43]
    ds_read_b64_tr_b16 v[102:103], v3 offset:42752
    s_waitcnt lgkmcnt(6)
    v_mfma_f32_16x16x32_bf16 v[44:47], v[88:91], v[148:151], v[44:47]
    ds_read_b64_tr_b16 v[104:105], v15 offset:41760
    v_mfma_f32_16x16x32_bf16 v[48:51], v[88:91], v[152:155], v[48:51]
    ds_read_b64_tr_b16 v[106:107], v15 offset:42784
    s_waitcnt lgkmcnt(6)
    v_mfma_f32_16x16x32_bf16 v[52:55], v[92:95], v[148:151], v[52:55]
    v_mfma_f32_16x16x32_bf16 v[56:59], v[92:95], v[152:155], v[56:59]
    s_barrier
    ds_read_b64_tr_b16 v[84:85], v3 offset:49152
    ds_read_b64_tr_b16 v[86:87], v3 offset:50176
    s_waitcnt lgkmcnt(6)
    v_mfma_f32_16x16x32_bf16 v[60:63], v[96:99], v[148:151], v[60:63]
    ds_read_b64_tr_b16 v[88:89], v15 offset:49184
    v_mfma_f32_16x16x32_bf16 v[64:67], v[96:99], v[152:155], v[64:67]
    ds_read_b64_tr_b16 v[90:91], v15 offset:50208
    s_waitcnt lgkmcnt(6)
    v_mfma_f32_16x16x32_bf16 v[68:71], v[100:103], v[148:151], v[68:71]
    ds_read_b64_tr_b16 v[92:93], v3 offset:49408
    v_mfma_f32_16x16x32_bf16 v[72:75], v[100:103], v[152:155], v[72:75]
    ds_read_b64_tr_b16 v[94:95], v3 offset:50432
    s_waitcnt lgkmcnt(6)
    v_mfma_f32_16x16x32_bf16 v[76:79], v[104:107], v[148:151], v[76:79]
    ds_read_b64_tr_b16 v[96:97], v15 offset:49440
    v_mfma_f32_16x16x32_bf16 v[80:83], v[104:107], v[152:155], v[80:83]
    ds_read_b64_tr_b16 v[98:99], v15 offset:50464
    s_waitcnt vmcnt(3) lgkmcnt(6)
    v_mfma_f32_16x16x32_bf16 v[20:23], v[84:87], v[204:207], v[20:23]
    ds_read_b64_tr_b16 v[100:101], v3 offset:49664
    s_waitcnt vmcnt(2)
    v_mfma_f32_16x16x32_bf16 v[24:27], v[84:87], v[208:211], v[24:27]
    ds_read_b64_tr_b16 v[102:103], v3 offset:50688
    s_waitcnt lgkmcnt(6)
    v_mfma_f32_16x16x32_bf16 v[28:31], v[88:91], v[204:207], v[28:31]
    ds_read_b64_tr_b16 v[104:105], v15 offset:49696
    v_mfma_f32_16x16x32_bf16 v[32:35], v[88:91], v[208:211], v[32:35]
    ds_read_b64_tr_b16 v[106:107], v15 offset:50720
    s_waitcnt lgkmcnt(6)
    v_mfma_f32_16x16x32_bf16 v[36:39], v[92:95], v[204:207], v[36:39]
    ds_read_b64_tr_b16 v[84:85], v3 offset:49920
    v_mfma_f32_16x16x32_bf16 v[40:43], v[92:95], v[208:211], v[40:43]
    ds_read_b64_tr_b16 v[86:87], v3 offset:50944
    s_waitcnt lgkmcnt(6)
    v_mfma_f32_16x16x32_bf16 v[44:47], v[96:99], v[204:207], v[44:47]
    ds_read_b64_tr_b16 v[88:89], v15 offset:49952
    v_mfma_f32_16x16x32_bf16 v[48:51], v[96:99], v[208:211], v[48:51]
    ds_read_b64_tr_b16 v[90:91], v15 offset:50976
    s_waitcnt lgkmcnt(6)
    v_mfma_f32_16x16x32_bf16 v[52:55], v[100:103], v[204:207], v[52:55]
    ds_read_b64_tr_b16 v[92:93], v3 offset:57344
    v_mfma_f32_16x16x32_bf16 v[56:59], v[100:103], v[208:211], v[56:59]
    ds_read_b64_tr_b16 v[94:95], v3 offset:58368
    s_waitcnt lgkmcnt(6)
    v_mfma_f32_16x16x32_bf16 v[60:63], v[104:107], v[204:207], v[60:63]
    ds_read_b64_tr_b16 v[96:97], v15 offset:57376
    v_mfma_f32_16x16x32_bf16 v[64:67], v[104:107], v[208:211], v[64:67]
    ds_read_b64_tr_b16 v[98:99], v15 offset:58400
    s_waitcnt lgkmcnt(6)
    v_mfma_f32_16x16x32_bf16 v[68:71], v[84:87], v[204:207], v[68:71]
    ds_read_b64_tr_b16 v[100:101], v3 offset:57600
    v_mfma_f32_16x16x32_bf16 v[72:75], v[84:87], v[208:211], v[72:75]
    ds_read_b64_tr_b16 v[102:103], v3 offset:58624
    s_waitcnt lgkmcnt(6)
    v_mfma_f32_16x16x32_bf16 v[76:79], v[88:91], v[204:207], v[76:79]
    ds_read_b64_tr_b16 v[104:105], v15 offset:57632
    v_mfma_f32_16x16x32_bf16 v[80:83], v[88:91], v[208:211], v[80:83]
    ds_read_b64_tr_b16 v[106:107], v15 offset:58656
    s_waitcnt vmcnt(1) lgkmcnt(6)
    v_mfma_f32_16x16x32_bf16 v[20:23], v[92:95], v[212:215], v[20:23]
    ds_read_b64_tr_b16 v[84:85], v3 offset:57856
    s_waitcnt vmcnt(0)
    v_mfma_f32_16x16x32_bf16 v[24:27], v[92:95], v[216:219], v[24:27]
    ds_read_b64_tr_b16 v[86:87], v3 offset:58880
    s_waitcnt lgkmcnt(6)
    v_mfma_f32_16x16x32_bf16 v[28:31], v[96:99], v[212:215], v[28:31]
    ds_read_b64_tr_b16 v[88:89], v15 offset:57888
    v_mfma_f32_16x16x32_bf16 v[32:35], v[96:99], v[216:219], v[32:35]
    ds_read_b64_tr_b16 v[90:91], v15 offset:58912
    s_waitcnt lgkmcnt(6)
    v_mfma_f32_16x16x32_bf16 v[36:39], v[100:103], v[212:215], v[36:39]
    ds_read_b64_tr_b16 v[92:93], v3 offset:58112
    v_mfma_f32_16x16x32_bf16 v[40:43], v[100:103], v[216:219], v[40:43]
    ds_read_b64_tr_b16 v[94:95], v3 offset:59136
    s_waitcnt lgkmcnt(6)
    v_mfma_f32_16x16x32_bf16 v[44:47], v[104:107], v[212:215], v[44:47]
    ds_read_b64_tr_b16 v[96:97], v15 offset:58144
    v_mfma_f32_16x16x32_bf16 v[48:51], v[104:107], v[216:219], v[48:51]
    ds_read_b64_tr_b16 v[98:99], v15 offset:59168
    s_waitcnt lgkmcnt(6)
    v_mfma_f32_16x16x32_bf16 v[52:55], v[84:87], v[212:215], v[52:55]
    v_mfma_f32_16x16x32_bf16 v[56:59], v[84:87], v[216:219], v[56:59]
    s_waitcnt lgkmcnt(4)
    v_mfma_f32_16x16x32_bf16 v[60:63], v[88:91], v[212:215], v[60:63]
    v_mfma_f32_16x16x32_bf16 v[64:67], v[88:91], v[216:219], v[64:67]
    s_waitcnt lgkmcnt(2)
    v_mfma_f32_16x16x32_bf16 v[68:71], v[92:95], v[212:215], v[68:71]
    v_mfma_f32_16x16x32_bf16 v[72:75], v[92:95], v[216:219], v[72:75]
    s_waitcnt lgkmcnt(0)
    v_mfma_f32_16x16x32_bf16 v[76:79], v[96:99], v[212:215], v[76:79]
    v_mfma_f32_16x16x32_bf16 v[80:83], v[96:99], v[216:219], v[80:83]
    s_mov_b32 s24, 0x3e0293ee
    v_mul_f32 v9, s24, v20
    v_mul_f32 v10, s24, v21
    v_cvt_pk_bf16_f32 v108, v9, v10
    v_mul_f32 v11, s24, v22
    v_mul_f32 v12, s24, v23
    v_cvt_pk_bf16_f32 v109, v11, v12
    v_mul_f32 v9, s24, v24
    v_mul_f32 v10, s24, v25
    v_cvt_pk_bf16_f32 v124, v9, v10
    v_mul_f32 v11, s24, v26
    v_mul_f32 v12, s24, v27
    v_cvt_pk_bf16_f32 v125, v11, v12
    v_mul_f32 v9, s24, v28
    v_mul_f32 v10, s24, v29
    v_cvt_pk_bf16_f32 v110, v9, v10
    v_mul_f32 v11, s24, v30
    v_mul_f32 v12, s24, v31
    v_cvt_pk_bf16_f32 v111, v11, v12
    v_mul_f32 v9, s24, v32
    v_mul_f32 v10, s24, v33
    v_cvt_pk_bf16_f32 v126, v9, v10
    v_mul_f32 v11, s24, v34
    v_mul_f32 v12, s24, v35
    v_cvt_pk_bf16_f32 v127, v11, v12
    v_mul_f32 v9, s24, v36
    v_mul_f32 v10, s24, v37
    v_cvt_pk_bf16_f32 v112, v9, v10
    v_mul_f32 v11, s24, v38
    v_mul_f32 v12, s24, v39
    v_cvt_pk_bf16_f32 v113, v11, v12
    v_mul_f32 v9, s24, v40
    v_mul_f32 v10, s24, v41
    v_cvt_pk_bf16_f32 v128, v9, v10
    v_mul_f32 v11, s24, v42
    v_mul_f32 v12, s24, v43
    v_cvt_pk_bf16_f32 v129, v11, v12
    v_mul_f32 v9, s24, v44
    v_mul_f32 v10, s24, v45
    v_cvt_pk_bf16_f32 v114, v9, v10
    v_mul_f32 v11, s24, v46
    v_mul_f32 v12, s24, v47
    v_cvt_pk_bf16_f32 v115, v11, v12
    v_mul_f32 v9, s24, v48
    v_mul_f32 v10, s24, v49
    v_cvt_pk_bf16_f32 v130, v9, v10
    v_mul_f32 v11, s24, v50
    v_mul_f32 v12, s24, v51
    v_cvt_pk_bf16_f32 v131, v11, v12
    v_mul_f32 v9, s24, v52
    v_mul_f32 v10, s24, v53
    v_cvt_pk_bf16_f32 v116, v9, v10
    v_mul_f32 v11, s24, v54
    v_mul_f32 v12, s24, v55
    v_cvt_pk_bf16_f32 v117, v11, v12
    v_mul_f32 v9, s24, v56
    v_mul_f32 v10, s24, v57
    v_cvt_pk_bf16_f32 v132, v9, v10
    v_mul_f32 v11, s24, v58
    v_mul_f32 v12, s24, v59
    v_cvt_pk_bf16_f32 v133, v11, v12
    v_mul_f32 v9, s24, v60
    v_mul_f32 v10, s24, v61
    v_cvt_pk_bf16_f32 v118, v9, v10
    v_mul_f32 v11, s24, v62
    v_mul_f32 v12, s24, v63
    v_cvt_pk_bf16_f32 v119, v11, v12
    v_mul_f32 v9, s24, v64
    v_mul_f32 v10, s24, v65
    v_cvt_pk_bf16_f32 v134, v9, v10
    v_mul_f32 v11, s24, v66
    v_mul_f32 v12, s24, v67
    v_cvt_pk_bf16_f32 v135, v11, v12
    v_mul_f32 v9, s24, v68
    v_mul_f32 v10, s24, v69
    v_cvt_pk_bf16_f32 v120, v9, v10
    v_mul_f32 v11, s24, v70
    v_mul_f32 v12, s24, v71
    v_cvt_pk_bf16_f32 v121, v11, v12
    v_mul_f32 v9, s24, v72
    v_mul_f32 v10, s24, v73
    v_cvt_pk_bf16_f32 v136, v9, v10
    v_mul_f32 v11, s24, v74
    v_mul_f32 v12, s24, v75
    v_cvt_pk_bf16_f32 v137, v11, v12
    v_mul_f32 v9, s24, v76
    v_mul_f32 v10, s24, v77
    v_cvt_pk_bf16_f32 v122, v9, v10
    v_mul_f32 v11, s24, v78
    v_mul_f32 v12, s24, v79
    v_cvt_pk_bf16_f32 v123, v11, v12
    v_mul_f32 v9, s24, v80
    v_mul_f32 v10, s24, v81
    v_cvt_pk_bf16_f32 v138, v9, v10
    v_mul_f32 v11, s24, v82
    v_mul_f32 v12, s24, v83
    v_cvt_pk_bf16_f32 v139, v11, v12
    v_add_u32 v2, 0x10000, v1
    v_add_u32 v3, 0x20000, v1
    s_barrier
    ds_read_b128 v[84:87], v2 offset:0
    ds_read_b128 v[88:91], v2 offset:1024
    ds_read_b128 v[92:95], v2 offset:2048
    ds_read_b128 v[96:99], v2 offset:3072
    s_waitcnt lgkmcnt(3)
    v_mfma_f32_16x16x32_bf16 v[140:143], v[84:87], v[108:111], 0
    v_mfma_f32_16x16x32_bf16 v[144:147], v[84:87], v[124:127], 0
    ds_read_b128 v[100:103], v2 offset:4096
    s_waitcnt lgkmcnt(3)
    v_mfma_f32_16x16x32_bf16 v[148:151], v[88:91], v[108:111], 0
    v_mfma_f32_16x16x32_bf16 v[152:155], v[88:91], v[124:127], 0
    ds_read_b128 v[104:107], v2 offset:5120
    s_mov_b64 s[64:65], s[52:53]
    s_mov_b32 s66, 0x800
    s_mov_b32 s67, 0x20000
    s_mov_b64 s[68:69], s[54:55]
    s_mov_b32 s70, 0xc00000
    s_mov_b32 s71, 0x20000
    s_and_b32 s100, s2, 7
    s_lshl_b32 s100, s100, 5
    s_lshr_b32 s26, s2, 3
    s_add_u32 s100, s100, s26
    v_lshrrev_b32 v13, 1, v8
    v_lshlrev_b32 v14, 4, v13
    buffer_load_dwordx4 v[244:247], v14, s[64:67], 0 offen
    s_mov_b32 s26, 98304
    v_mul_lo_u32 v13, s26, v13
    v_and_b32 v14, 1, v8
    v_lshl_add_u32 v13, v14, 4, v13
    s_lshl_b32 s25, s100, 5
    s_add_u32 s25, s25, 4096
    s_waitcnt lgkmcnt(3)
    v_mfma_f32_16x16x32_bf16 v[140:143], v[92:95], v[112:115], v[140:143]
    v_mfma_f32_16x16x32_bf16 v[144:147], v[92:95], v[128:131], v[144:147]
    ds_read_b128 v[84:87], v2 offset:6144
    s_waitcnt lgkmcnt(3)
    v_mfma_f32_16x16x32_bf16 v[148:151], v[96:99], v[112:115], v[148:151]
    v_mfma_f32_16x16x32_bf16 v[152:155], v[96:99], v[128:131], v[152:155]
    ds_read_b128 v[88:91], v2 offset:7168
    s_add_u32 s26, s25, 0
    buffer_load_dwordx4 v[204:207], v13, s[68:71], s26 offen
    s_waitcnt lgkmcnt(3)
    v_mfma_f32_16x16x32_bf16 v[140:143], v[100:103], v[116:119], v[140:143]
    v_mfma_f32_16x16x32_bf16 v[144:147], v[100:103], v[132:135], v[144:147]
    s_barrier
    ds_read_b128 v[92:95], v2 offset:16384
    s_waitcnt lgkmcnt(3)
    v_mfma_f32_16x16x32_bf16 v[148:151], v[104:107], v[116:119], v[148:151]
    v_mfma_f32_16x16x32_bf16 v[152:155], v[104:107], v[132:135], v[152:155]
    ds_read_b128 v[96:99], v2 offset:17408
    s_waitcnt lgkmcnt(3)
    v_mfma_f32_16x16x32_bf16 v[140:143], v[84:87], v[120:123], v[140:143]
    v_mfma_f32_16x16x32_bf16 v[144:147], v[84:87], v[136:139], v[144:147]
    ds_read_b128 v[100:103], v2 offset:18432
    s_waitcnt lgkmcnt(3)
    v_mfma_f32_16x16x32_bf16 v[148:151], v[88:91], v[120:123], v[148:151]
    v_mfma_f32_16x16x32_bf16 v[152:155], v[88:91], v[136:139], v[152:155]
    ds_read_b128 v[104:107], v2 offset:19456
    s_waitcnt lgkmcnt(3)
    v_mfma_f32_16x16x32_bf16 v[156:159], v[92:95], v[108:111], 0
    v_mfma_f32_16x16x32_bf16 v[160:163], v[92:95], v[124:127], 0
    ds_read_b128 v[84:87], v2 offset:20480
    s_waitcnt lgkmcnt(3)
    v_mfma_f32_16x16x32_bf16 v[164:167], v[96:99], v[108:111], 0
    v_mfma_f32_16x16x32_bf16 v[168:171], v[96:99], v[124:127], 0
    ds_read_b128 v[88:91], v2 offset:21504
    s_waitcnt lgkmcnt(3)
    v_mfma_f32_16x16x32_bf16 v[156:159], v[100:103], v[112:115], v[156:159]
    v_mfma_f32_16x16x32_bf16 v[160:163], v[100:103], v[128:131], v[160:163]
    ds_read_b128 v[92:95], v2 offset:22528
    s_add_u32 s26, s25, 12288
    buffer_load_dwordx4 v[208:211], v13, s[68:71], s26 offen
    s_waitcnt lgkmcnt(3)
    v_mfma_f32_16x16x32_bf16 v[164:167], v[104:107], v[112:115], v[164:167]
    v_max3_f32 v9, v140, v141, v142
    v_mfma_f32_16x16x32_bf16 v[168:171], v[104:107], v[128:131], v[168:171]
    ds_read_b128 v[96:99], v2 offset:23552
    v_max3_f32 v9, v9, v143, v148
    s_waitcnt lgkmcnt(3)
    v_mfma_f32_16x16x32_bf16 v[156:159], v[84:87], v[116:119], v[156:159]
    v_max3_f32 v9, v9, v149, v150
    v_mfma_f32_16x16x32_bf16 v[160:163], v[84:87], v[132:135], v[160:163]
    s_barrier
    ds_read_b128 v[100:103], v2 offset:32768
    v_max_f32 v9, v9, v151
    s_waitcnt lgkmcnt(3)
    v_mfma_f32_16x16x32_bf16 v[164:167], v[88:91], v[116:119], v[164:167]
    v_max3_f32 v10, v144, v145, v146
    v_mfma_f32_16x16x32_bf16 v[168:171], v[88:91], v[132:135], v[168:171]
    ds_read_b128 v[104:107], v2 offset:33792
    v_max3_f32 v10, v10, v147, v152
    s_waitcnt lgkmcnt(3)
    v_mfma_f32_16x16x32_bf16 v[156:159], v[92:95], v[120:123], v[156:159]
    v_max3_f32 v10, v10, v153, v154
    v_mfma_f32_16x16x32_bf16 v[160:163], v[92:95], v[136:139], v[160:163]
    ds_read_b128 v[84:87], v2 offset:34816
    v_max_f32 v10, v10, v155
    s_waitcnt lgkmcnt(3)
    v_mfma_f32_16x16x32_bf16 v[164:167], v[96:99], v[120:123], v[164:167]
    v_mfma_f32_16x16x32_bf16 v[168:171], v[96:99], v[136:139], v[168:171]
    ds_read_b128 v[88:91], v2 offset:35840
    v_max3_f32 v9, v9, v156, v157
    v_max3_f32 v9, v9, v158, v159
    s_nop 3
    v_max3_f32 v9, v9, v164, v165
    v_max3_f32 v9, v9, v166, v167
    v_max3_f32 v10, v10, v160, v161
    v_max3_f32 v10, v10, v162, v163
    v_max3_f32 v10, v10, v168, v169
    v_max3_f32 v10, v10, v170, v171
    v_mov_b32 v11, v9
    v_mov_b32 v12, v10
    s_nop 0
    v_permlane16_swap_b32 v9, v11
    v_permlane16_swap_b32 v10, v12
    v_max_f32 v9, v9, v11
    v_max_f32 v10, v10, v12
    v_mov_b32 v11, v9
    v_mov_b32 v12, v10
    s_nop 0
    v_permlane32_swap_b32 v9, v11
    v_permlane32_swap_b32 v10, v12
    v_max_f32 v9, v9, v11
    v_max_f32 v10, v10, v12
    v_sub_f32 v172, 0, v9
    v_sub_f32 v173, 0, v9
    v_sub_f32 v174, 0, v9
    v_sub_f32 v175, 0, v9
    v_sub_f32 v176, 0, v10
    v_sub_f32 v177, 0, v10
    v_sub_f32 v178, 0, v10
    v_sub_f32 v179, 0, v10
    v_add_f32 v140, v140, v172
    v_add_f32 v141, v141, v172
    v_exp_f32 v140, v140
    v_exp_f32 v141, v141
    s_nop 0
    v_add_f32 v15, v140, v141
    v_cvt_pk_bf16_f32 v188, v140, v141
    v_add_f32 v142, v142, v172
    v_add_f32 v143, v143, v172
    v_exp_f32 v142, v142
    v_exp_f32 v143, v143
    v_add_f32 v15, v15, v142
    v_add_f32 v15, v15, v143
    v_cvt_pk_bf16_f32 v189, v142, v143
    v_add_f32 v144, v144, v176
    v_add_f32 v145, v145, v176
    v_exp_f32 v144, v144
    v_exp_f32 v145, v145
    s_nop 0
    v_add_f32 v16, v144, v145
    v_cvt_pk_bf16_f32 v192, v144, v145
    v_add_f32 v146, v146, v176
    v_add_f32 v147, v147, v176
    v_exp_f32 v146, v146
    v_exp_f32 v147, v147
    v_add_f32 v16, v16, v146
    v_add_f32 v16, v16, v147
    v_cvt_pk_bf16_f32 v193, v146, v147
    v_add_f32 v148, v148, v172
    v_add_f32 v149, v149, v172
    v_exp_f32 v148, v148
    v_exp_f32 v149, v149
    v_add_f32 v15, v15, v148
    v_add_f32 v15, v15, v149
    v_cvt_pk_bf16_f32 v190, v148, v149
    v_add_f32 v150, v150, v172
    v_add_f32 v151, v151, v172
    v_exp_f32 v150, v150
    v_exp_f32 v151, v151
    v_add_f32 v15, v15, v150
    v_add_f32 v15, v15, v151
    v_cvt_pk_bf16_f32 v191, v150, v151
    v_add_f32 v152, v152, v176
    v_add_f32 v153, v153, v176
    v_exp_f32 v152, v152
    v_exp_f32 v153, v153
    v_add_f32 v16, v16, v152
    v_add_f32 v16, v16, v153
    v_cvt_pk_bf16_f32 v194, v152, v153
    v_add_f32 v154, v154, v176
    v_add_f32 v155, v155, v176
    v_exp_f32 v154, v154
    v_exp_f32 v155, v155
    v_add_f32 v16, v16, v154
    v_add_f32 v16, v16, v155
    v_cvt_pk_bf16_f32 v195, v154, v155
    s_waitcnt lgkmcnt(3)
    v_mfma_f32_16x16x32_bf16 v[140:143], v[100:103], v[108:111], v[172:175]
    v_add_f32 v156, v156, v172
    v_add_f32 v157, v157, v172
    v_mfma_f32_16x16x32_bf16 v[144:147], v[100:103], v[124:127], v[176:179]
    ds_read_b128 v[92:95], v2 offset:36864
    v_exp_f32 v156, v156
    v_exp_f32 v157, v157
    s_waitcnt lgkmcnt(3)
    v_mfma_f32_16x16x32_bf16 v[148:151], v[104:107], v[108:111], v[172:175]
    v_add_f32 v15, v15, v156
    v_add_f32 v15, v15, v157
    v_mfma_f32_16x16x32_bf16 v[152:155], v[104:107], v[124:127], v[176:179]
    ds_read_b128 v[96:99], v2 offset:37888
    v_cvt_pk_bf16_f32 v196, v156, v157
    s_add_u32 s26, s25, 24576
    buffer_load_dwordx4 v[212:215], v13, s[68:71], s26 offen
    s_waitcnt lgkmcnt(3)
    v_mfma_f32_16x16x32_bf16 v[140:143], v[84:87], v[112:115], v[140:143]
    v_add_f32 v158, v158, v172
    v_add_f32 v159, v159, v172
    v_mfma_f32_16x16x32_bf16 v[144:147], v[84:87], v[128:131], v[144:147]
    ds_read_b128 v[100:103], v2 offset:38912
    v_exp_f32 v158, v158
    v_exp_f32 v159, v159
    s_waitcnt lgkmcnt(3)
    v_mfma_f32_16x16x32_bf16 v[148:151], v[88:91], v[112:115], v[148:151]
    v_add_f32 v15, v15, v158
    v_add_f32 v15, v15, v159
    v_mfma_f32_16x16x32_bf16 v[152:155], v[88:91], v[128:131], v[152:155]
    ds_read_b128 v[104:107], v2 offset:39936
    v_cvt_pk_bf16_f32 v197, v158, v159
    s_waitcnt lgkmcnt(3)
    v_mfma_f32_16x16x32_bf16 v[140:143], v[92:95], v[116:119], v[140:143]
    v_add_f32 v160, v160, v176
    v_add_f32 v161, v161, v176
    v_mfma_f32_16x16x32_bf16 v[144:147], v[92:95], v[132:135], v[144:147]
    ds_read_b128 v[84:87], v2 offset:8192
    v_exp_f32 v160, v160
    v_exp_f32 v161, v161
    s_waitcnt lgkmcnt(3)
    v_mfma_f32_16x16x32_bf16 v[148:151], v[96:99], v[116:119], v[148:151]
    v_add_f32 v16, v16, v160
    v_add_f32 v16, v16, v161
    v_mfma_f32_16x16x32_bf16 v[152:155], v[96:99], v[132:135], v[152:155]
    ds_read_b128 v[88:91], v2 offset:9216
    v_cvt_pk_bf16_f32 v200, v160, v161
    s_waitcnt lgkmcnt(3)
    v_mfma_f32_16x16x32_bf16 v[140:143], v[100:103], v[120:123], v[140:143]
    v_add_f32 v162, v162, v176
    v_add_f32 v163, v163, v176
    v_mfma_f32_16x16x32_bf16 v[144:147], v[100:103], v[136:139], v[144:147]
    ds_read_b128 v[92:95], v2 offset:10240
    v_exp_f32 v162, v162
    v_exp_f32 v163, v163
    s_waitcnt lgkmcnt(3)
    v_mfma_f32_16x16x32_bf16 v[148:151], v[104:107], v[120:123], v[148:151]
    v_add_f32 v16, v16, v162
    v_add_f32 v16, v16, v163
    v_mfma_f32_16x16x32_bf16 v[152:155], v[104:107], v[136:139], v[152:155]
    ds_read_b128 v[96:99], v2 offset:11264
    v_cvt_pk_bf16_f32 v201, v162, v163
    s_waitcnt lgkmcnt(3)
    v_mfma_f32_16x16x32_bf16 v[20:23], v[84:87], v[188:191], 0
    v_add_f32 v164, v164, v172
    v_add_f32 v165, v165, v172
    v_mfma_f32_16x16x32_bf16 v[24:27], v[84:87], v[192:195], 0
    ds_read_b128 v[100:103], v2 offset:12288
    v_exp_f32 v164, v164
    v_exp_f32 v165, v165
    s_add_u32 s26, s25, 36864
    buffer_load_dwordx4 v[216:219], v13, s[68:71], s26 offen
    s_waitcnt lgkmcnt(3)
    v_mfma_f32_16x16x32_bf16 v[28:31], v[88:91], v[188:191], 0
    v_add_f32 v15, v15, v164
    v_add_f32 v15, v15, v165
    v_mfma_f32_16x16x32_bf16 v[32:35], v[88:91], v[192:195], 0
    ds_read_b128 v[104:107], v2 offset:13312
    v_cvt_pk_bf16_f32 v198, v164, v165
    s_waitcnt lgkmcnt(3)
    v_mfma_f32_16x16x32_bf16 v[36:39], v[92:95], v[188:191], 0
    v_add_f32 v166, v166, v172
    v_add_f32 v167, v167, v172
    v_mfma_f32_16x16x32_bf16 v[40:43], v[92:95], v[192:195], 0
    ds_read_b128 v[84:87], v2 offset:14336
    v_exp_f32 v166, v166
    v_exp_f32 v167, v167
    s_waitcnt lgkmcnt(3)
    v_mfma_f32_16x16x32_bf16 v[44:47], v[96:99], v[188:191], 0
    v_add_f32 v15, v15, v166
    v_add_f32 v15, v15, v167
    v_mfma_f32_16x16x32_bf16 v[48:51], v[96:99], v[192:195], 0
    ds_read_b128 v[88:91], v2 offset:15360
    v_cvt_pk_bf16_f32 v199, v166, v167
    s_waitcnt lgkmcnt(3)
    v_mfma_f32_16x16x32_bf16 v[52:55], v[100:103], v[188:191], 0
    v_add_f32 v168, v168, v176
    v_add_f32 v169, v169, v176
    v_mfma_f32_16x16x32_bf16 v[56:59], v[100:103], v[192:195], 0
    s_barrier
    ds_read_b128 v[92:95], v2 offset:49152
    v_exp_f32 v168, v168
    v_exp_f32 v169, v169
    s_waitcnt lgkmcnt(3)
    v_mfma_f32_16x16x32_bf16 v[60:63], v[104:107], v[188:191], 0
    v_add_f32 v16, v16, v168
    v_add_f32 v16, v16, v169
    v_mfma_f32_16x16x32_bf16 v[64:67], v[104:107], v[192:195], 0
    ds_read_b128 v[96:99], v2 offset:50176
    v_cvt_pk_bf16_f32 v202, v168, v169
    s_waitcnt lgkmcnt(3)
    v_mfma_f32_16x16x32_bf16 v[68:71], v[84:87], v[188:191], 0
    v_add_f32 v170, v170, v176
    v_add_f32 v171, v171, v176
    v_mfma_f32_16x16x32_bf16 v[72:75], v[84:87], v[192:195], 0
    ds_read_b128 v[100:103], v2 offset:51200
    v_exp_f32 v170, v170
    v_exp_f32 v171, v171
    s_waitcnt lgkmcnt(3)
    v_mfma_f32_16x16x32_bf16 v[76:79], v[88:91], v[188:191], 0
    v_add_f32 v16, v16, v170
    v_add_f32 v16, v16, v171
    v_mfma_f32_16x16x32_bf16 v[80:83], v[88:91], v[192:195], 0
    ds_read_b128 v[104:107], v2 offset:52224
    v_cvt_pk_bf16_f32 v203, v170, v171
    s_add_u32 s26, s25, 49152
    buffer_load_dwordx4 v[220:223], v13, s[68:71], s26 offen
    s_waitcnt lgkmcnt(3)
    v_mfma_f32_16x16x32_bf16 v[156:159], v[92:95], v[108:111], v[172:175]
    v_exp_f32 v140, v140
    v_exp_f32 v141, v141
    v_mfma_f32_16x16x32_bf16 v[160:163], v[92:95], v[124:127], v[176:179]
    ds_read_b128 v[84:87], v2 offset:53248
    v_add_f32 v15, v15, v140
    s_waitcnt lgkmcnt(3)
    v_mfma_f32_16x16x32_bf16 v[164:167], v[96:99], v[108:111], v[172:175]
    v_add_f32 v15, v15, v141
    v_mfma_f32_16x16x32_bf16 v[168:171], v[96:99], v[124:127], v[176:179]
    ds_read_b128 v[88:91], v2 offset:54272
    v_cvt_pk_bf16_f32 v188, v140, v141
    s_waitcnt lgkmcnt(3)
    v_mfma_f32_16x16x32_bf16 v[156:159], v[100:103], v[112:115], v[156:159]
    v_exp_f32 v142, v142
    v_exp_f32 v143, v143
    v_mfma_f32_16x16x32_bf16 v[160:163], v[100:103], v[128:131], v[160:163]
    ds_read_b128 v[92:95], v2 offset:55296
    v_add_f32 v15, v15, v142
    s_waitcnt lgkmcnt(3)
    v_mfma_f32_16x16x32_bf16 v[164:167], v[104:107], v[112:115], v[164:167]
    v_add_f32 v15, v15, v143
    v_mfma_f32_16x16x32_bf16 v[168:171], v[104:107], v[128:131], v[168:171]
    ds_read_b128 v[96:99], v2 offset:56320
    v_cvt_pk_bf16_f32 v189, v142, v143
    s_waitcnt lgkmcnt(3)
    v_mfma_f32_16x16x32_bf16 v[156:159], v[84:87], v[116:119], v[156:159]
    v_exp_f32 v144, v144
    v_exp_f32 v145, v145
    v_mfma_f32_16x16x32_bf16 v[160:163], v[84:87], v[132:135], v[160:163]
    ds_read_b128 v[100:103], v2 offset:24576
    v_add_f32 v16, v16, v144
    s_waitcnt lgkmcnt(3)
    v_mfma_f32_16x16x32_bf16 v[164:167], v[88:91], v[116:119], v[164:167]
    v_add_f32 v16, v16, v145
    v_mfma_f32_16x16x32_bf16 v[168:171], v[88:91], v[132:135], v[168:171]
    ds_read_b128 v[104:107], v2 offset:25600
    v_cvt_pk_bf16_f32 v192, v144, v145
    s_waitcnt lgkmcnt(3)
    v_mfma_f32_16x16x32_bf16 v[156:159], v[92:95], v[120:123], v[156:159]
    v_exp_f32 v146, v146
    v_exp_f32 v147, v147
    v_mfma_f32_16x16x32_bf16 v[160:163], v[92:95], v[136:139], v[160:163]
    ds_read_b128 v[84:87], v2 offset:26624
    v_add_f32 v16, v16, v146
    s_add_u32 s26, s25, 61440
    buffer_load_dwordx4 v[224:227], v13, s[68:71], s26 offen
    s_waitcnt lgkmcnt(3)
    v_mfma_f32_16x16x32_bf16 v[164:167], v[96:99], v[120:123], v[164:167]
    v_add_f32 v16, v16, v147
    v_mfma_f32_16x16x32_bf16 v[168:171], v[96:99], v[136:139], v[168:171]
    ds_read_b128 v[88:91], v2 offset:27648
    v_cvt_pk_bf16_f32 v193, v146, v147
    s_waitcnt lgkmcnt(3)
    v_mfma_f32_16x16x32_bf16 v[20:23], v[100:103], v[196:199], v[20:23]
    v_exp_f32 v148, v148
    v_exp_f32 v149, v149
    v_mfma_f32_16x16x32_bf16 v[24:27], v[100:103], v[200:203], v[24:27]
    ds_read_b128 v[92:95], v2 offset:28672
    v_add_f32 v15, v15, v148
    s_waitcnt lgkmcnt(3)
    v_mfma_f32_16x16x32_bf16 v[28:31], v[104:107], v[196:199], v[28:31]
    v_add_f32 v15, v15, v149
    v_mfma_f32_16x16x32_bf16 v[32:35], v[104:107], v[200:203], v[32:35]
    ds_read_b128 v[96:99], v2 offset:29696
    v_cvt_pk_bf16_f32 v190, v148, v149
    s_waitcnt lgkmcnt(3)
    v_mfma_f32_16x16x32_bf16 v[36:39], v[84:87], v[196:199], v[36:39]
    v_exp_f32 v150, v150
    v_exp_f32 v151, v151
    v_mfma_f32_16x16x32_bf16 v[40:43], v[84:87], v[200:203], v[40:43]
    ds_read_b128 v[100:103], v2 offset:30720
    v_add_f32 v15, v15, v150
    s_waitcnt lgkmcnt(3)
    v_mfma_f32_16x16x32_bf16 v[44:47], v[88:91], v[196:199], v[44:47]
    v_add_f32 v15, v15, v151
    v_mfma_f32_16x16x32_bf16 v[48:51], v[88:91], v[200:203], v[48:51]
    ds_read_b128 v[104:107], v2 offset:31744
    v_cvt_pk_bf16_f32 v191, v150, v151
    s_waitcnt lgkmcnt(3)
    v_mfma_f32_16x16x32_bf16 v[52:55], v[92:95], v[196:199], v[52:55]
    v_exp_f32 v152, v152
    v_exp_f32 v153, v153
    v_mfma_f32_16x16x32_bf16 v[56:59], v[92:95], v[200:203], v[56:59]
    s_barrier
    ds_read_b128 v[84:87], v3 offset:0
    v_add_f32 v16, v16, v152
    s_waitcnt lgkmcnt(3)
    v_mfma_f32_16x16x32_bf16 v[60:63], v[96:99], v[196:199], v[60:63]
    v_add_f32 v16, v16, v153
    v_mfma_f32_16x16x32_bf16 v[64:67], v[96:99], v[200:203], v[64:67]
    ds_read_b128 v[88:91], v3 offset:1024
    v_cvt_pk_bf16_f32 v194, v152, v153
    s_add_u32 s26, s25, 73728
    buffer_load_dwordx4 v[228:231], v13, s[68:71], s26 offen
    s_waitcnt lgkmcnt(3)
    v_mfma_f32_16x16x32_bf16 v[68:71], v[100:103], v[196:199], v[68:71]
    v_exp_f32 v154, v154
    v_exp_f32 v155, v155
    v_mfma_f32_16x16x32_bf16 v[72:75], v[100:103], v[200:203], v[72:75]
    ds_read_b128 v[92:95], v3 offset:2048
    v_add_f32 v16, v16, v154
    s_waitcnt lgkmcnt(3)
    v_mfma_f32_16x16x32_bf16 v[76:79], v[104:107], v[196:199], v[76:79]
    v_add_f32 v16, v16, v155
    v_mfma_f32_16x16x32_bf16 v[80:83], v[104:107], v[200:203], v[80:83]
    ds_read_b128 v[96:99], v3 offset:3072
    v_cvt_pk_bf16_f32 v195, v154, v155
    s_waitcnt lgkmcnt(3)
    v_mfma_f32_16x16x32_bf16 v[140:143], v[84:87], v[108:111], v[172:175]
    v_exp_f32 v156, v156
    v_exp_f32 v157, v157
    v_mfma_f32_16x16x32_bf16 v[144:147], v[84:87], v[124:127], v[176:179]
    ds_read_b128 v[100:103], v3 offset:4096
    v_add_f32 v15, v15, v156
    s_waitcnt lgkmcnt(3)
    v_mfma_f32_16x16x32_bf16 v[148:151], v[88:91], v[108:111], v[172:175]
    v_add_f32 v15, v15, v157
    v_mfma_f32_16x16x32_bf16 v[152:155], v[88:91], v[124:127], v[176:179]
    ds_read_b128 v[104:107], v3 offset:5120
    v_cvt_pk_bf16_f32 v196, v156, v157
    s_waitcnt lgkmcnt(3)
    v_mfma_f32_16x16x32_bf16 v[140:143], v[92:95], v[112:115], v[140:143]
    v_exp_f32 v158, v158
    v_exp_f32 v159, v159
    v_mfma_f32_16x16x32_bf16 v[144:147], v[92:95], v[128:131], v[144:147]
    ds_read_b128 v[84:87], v3 offset:6144
    v_add_f32 v15, v15, v158
    s_waitcnt lgkmcnt(3)
    v_mfma_f32_16x16x32_bf16 v[148:151], v[96:99], v[112:115], v[148:151]
    v_add_f32 v15, v15, v159
    v_mfma_f32_16x16x32_bf16 v[152:155], v[96:99], v[128:131], v[152:155]
    ds_read_b128 v[88:91], v3 offset:7168
    v_cvt_pk_bf16_f32 v197, v158, v159
    s_waitcnt lgkmcnt(3)
    v_mfma_f32_16x16x32_bf16 v[140:143], v[100:103], v[116:119], v[140:143]
    v_exp_f32 v160, v160
    v_exp_f32 v161, v161
    v_mfma_f32_16x16x32_bf16 v[144:147], v[100:103], v[132:135], v[144:147]
    ds_read_b128 v[92:95], v2 offset:40960
    v_add_f32 v16, v16, v160
    s_add_u32 s26, s25, 86016
    buffer_load_dwordx4 v[232:235], v13, s[68:71], s26 offen
    s_waitcnt lgkmcnt(3)
    v_mfma_f32_16x16x32_bf16 v[148:151], v[104:107], v[116:119], v[148:151]
    v_add_f32 v16, v16, v161
    v_mfma_f32_16x16x32_bf16 v[152:155], v[104:107], v[132:135], v[152:155]
    ds_read_b128 v[96:99], v2 offset:41984
    v_cvt_pk_bf16_f32 v200, v160, v161
    s_waitcnt lgkmcnt(3)
    v_mfma_f32_16x16x32_bf16 v[140:143], v[84:87], v[120:123], v[140:143]
    v_exp_f32 v162, v162
    v_exp_f32 v163, v163
    v_mfma_f32_16x16x32_bf16 v[144:147], v[84:87], v[136:139], v[144:147]
    ds_read_b128 v[100:103], v2 offset:43008
    v_add_f32 v16, v16, v162
    s_waitcnt lgkmcnt(3)
    v_mfma_f32_16x16x32_bf16 v[148:151], v[88:91], v[120:123], v[148:151]
    v_add_f32 v16, v16, v163
    v_mfma_f32_16x16x32_bf16 v[152:155], v[88:91], v[136:139], v[152:155]
    ds_read_b128 v[104:107], v2 offset:44032
    v_cvt_pk_bf16_f32 v201, v162, v163
    s_waitcnt lgkmcnt(3)
    v_mfma_f32_16x16x32_bf16 v[20:23], v[92:95], v[188:191], v[20:23]
    v_exp_f32 v164, v164
    v_exp_f32 v165, v165
    v_mfma_f32_16x16x32_bf16 v[24:27], v[92:95], v[192:195], v[24:27]
    ds_read_b128 v[84:87], v2 offset:45056
    v_add_f32 v15, v15, v164
    s_waitcnt lgkmcnt(3)
    v_mfma_f32_16x16x32_bf16 v[28:31], v[96:99], v[188:191], v[28:31]
    v_add_f32 v15, v15, v165
    v_mfma_f32_16x16x32_bf16 v[32:35], v[96:99], v[192:195], v[32:35]
    ds_read_b128 v[88:91], v2 offset:46080
    v_cvt_pk_bf16_f32 v198, v164, v165
    s_waitcnt lgkmcnt(3)
    v_mfma_f32_16x16x32_bf16 v[36:39], v[100:103], v[188:191], v[36:39]
    v_exp_f32 v166, v166
    v_exp_f32 v167, v167
    v_mfma_f32_16x16x32_bf16 v[40:43], v[100:103], v[192:195], v[40:43]
    ds_read_b128 v[92:95], v2 offset:47104
    v_add_f32 v15, v15, v166
    s_waitcnt lgkmcnt(3)
    v_mfma_f32_16x16x32_bf16 v[44:47], v[104:107], v[188:191], v[44:47]
    v_add_f32 v15, v15, v167
    v_mfma_f32_16x16x32_bf16 v[48:51], v[104:107], v[192:195], v[48:51]
    ds_read_b128 v[96:99], v2 offset:48128
    v_cvt_pk_bf16_f32 v199, v166, v167
    s_and_b32 s26, s12, 24
    s_lshl_b32 s26, s26, 18
    s_lshr_b32 s27, s2, 3
    s_lshl_b32 s27, s27, 16
    s_add_u32 s26, s26, s27
    v_lshrrev_b32 v17, 6, v8
    v_lshlrev_b32 v17, 10, v17
    v_lshl_add_u32 v17, v0, 7, v17
    v_add_u32 v17, s26, v17
    v_cmp_gt_u32 vcc, 8, v0
    v_bfrev_b32 v18, -2
    s_nop 0
    v_cndmask_b32 v17, v18, v17, vcc
    s_waitcnt lgkmcnt(3)
    v_mfma_f32_16x16x32_bf16 v[52:55], v[84:87], v[188:191], v[52:55]
    v_exp_f32 v168, v168
    v_exp_f32 v169, v169
    v_mfma_f32_16x16x32_bf16 v[56:59], v[84:87], v[192:195], v[56:59]
    s_barrier
    ds_read_b128 v[100:103], v3 offset:16384
    v_add_f32 v16, v16, v168
    s_mov_b64 s[20:21], s[40:41]
    s_mov_b32 s22, 0x800000
    s_mov_b32 s23, 0x20000
    s_mov_b32 s26, 0x0
    buffer_load_dword v18, v17, s[20:23], s26 offen
    s_waitcnt lgkmcnt(3)
    v_mfma_f32_16x16x32_bf16 v[60:63], v[88:91], v[188:191], v[60:63]
    v_add_f32 v16, v16, v169
    v_mfma_f32_16x16x32_bf16 v[64:67], v[88:91], v[192:195], v[64:67]
    ds_read_b128 v[104:107], v3 offset:17408
    v_cvt_pk_bf16_f32 v202, v168, v169
    s_waitcnt lgkmcnt(3)
    v_mfma_f32_16x16x32_bf16 v[68:71], v[92:95], v[188:191], v[68:71]
    v_exp_f32 v170, v170
    v_exp_f32 v171, v171
    v_mfma_f32_16x16x32_bf16 v[72:75], v[92:95], v[192:195], v[72:75]
    ds_read_b128 v[84:87], v3 offset:18432
    v_add_f32 v16, v16, v170
    s_waitcnt lgkmcnt(3)
    v_mfma_f32_16x16x32_bf16 v[76:79], v[96:99], v[188:191], v[76:79]
    v_add_f32 v16, v16, v171
    v_mfma_f32_16x16x32_bf16 v[80:83], v[96:99], v[192:195], v[80:83]
    ds_read_b128 v[88:91], v3 offset:19456
    v_cvt_pk_bf16_f32 v203, v170, v171
    s_mov_b64 s[20:21], s[40:41]
    s_mov_b32 s22, 0x800000
    s_mov_b32 s23, 0x20000
    s_mov_b32 s26, 0x1000
    buffer_load_dword v18, v17, s[20:23], s26 offen
    s_waitcnt lgkmcnt(3)
    v_mfma_f32_16x16x32_bf16 v[156:159], v[100:103], v[108:111], v[172:175]
    v_exp_f32 v140, v140
    v_exp_f32 v141, v141
    v_mfma_f32_16x16x32_bf16 v[160:163], v[100:103], v[124:127], v[176:179]
    ds_read_b128 v[92:95], v3 offset:20480
    v_add_f32 v15, v15, v140
    s_waitcnt vmcnt(10)
    v_lshlrev_b32 v236, 16, v244
    v_and_b32 v237, 0xffff0000, v244
    v_lshlrev_b32 v238, 16, v245
    v_and_b32 v239, 0xffff0000, v245
    v_lshlrev_b32 v240, 16, v246
    v_and_b32 v241, 0xffff0000, v246
    v_lshlrev_b32 v242, 16, v247
    s_waitcnt lgkmcnt(3)
    v_mfma_f32_16x16x32_bf16 v[164:167], v[104:107], v[108:111], v[172:175]
    v_add_f32 v15, v15, v141
    v_mfma_f32_16x16x32_bf16 v[168:171], v[104:107], v[124:127], v[176:179]
    ds_read_b128 v[96:99], v3 offset:21504
    v_cvt_pk_bf16_f32 v188, v140, v141
    v_and_b32 v243, 0xffff0000, v247
    v_mul_f32 v4, 0xbfb8aa3b, v236
    v_exp_f32 v4, v4
    s_nop 0
    v_add_f32 v4, 1.0, v4
    v_rcp_f32 v4, v4
    s_nop 0
    v_mul_f32 v236, v236, v4
    v_mul_f32 v10, 0xbfb8aa3b, v237
    s_waitcnt lgkmcnt(3)
    v_mfma_f32_16x16x32_bf16 v[156:159], v[84:87], v[112:115], v[156:159]
    v_exp_f32 v142, v142
    v_exp_f32 v143, v143
    v_mfma_f32_16x16x32_bf16 v[160:163], v[84:87], v[128:131], v[160:163]
    ds_read_b128 v[100:103], v3 offset:22528
    v_add_f32 v15, v15, v142
    v_exp_f32 v10, v10
    s_nop 0
    v_add_f32 v10, 1.0, v10
    v_rcp_f32 v10, v10
    s_nop 0
    v_mul_f32 v237, v237, v10
    v_mul_f32 v5, 0xbfb8aa3b, v238
    v_exp_f32 v5, v5
    s_nop 0
    v_add_f32 v5, 1.0, v5
    s_waitcnt lgkmcnt(3)
    v_mfma_f32_16x16x32_bf16 v[164:167], v[88:91], v[112:115], v[164:167]
    v_add_f32 v15, v15, v143
    v_mfma_f32_16x16x32_bf16 v[168:171], v[88:91], v[128:131], v[168:171]
    ds_read_b128 v[104:107], v3 offset:23552
    v_cvt_pk_bf16_f32 v189, v142, v143
    v_rcp_f32 v5, v5
    s_nop 0
    v_mul_f32 v238, v238, v5
    v_mul_f32 v12, 0xbfb8aa3b, v239
    v_exp_f32 v12, v12
    s_nop 0
    v_add_f32 v12, 1.0, v12
    v_rcp_f32 v12, v12
    s_nop 0
    v_mul_f32 v239, v239, v12
    s_mov_b64 s[20:21], s[40:41]
    s_mov_b32 s22, 0x800000
    s_mov_b32 s23, 0x20000
    s_mov_b32 s26, 0x2000
    buffer_load_dword v18, v17, s[20:23], s26 offen
    s_waitcnt lgkmcnt(3)
    v_mfma_f32_16x16x32_bf16 v[156:159], v[92:95], v[116:119], v[156:159]
    v_exp_f32 v144, v144
    v_exp_f32 v145, v145
    v_mfma_f32_16x16x32_bf16 v[160:163], v[92:95], v[132:135], v[160:163]
    ds_read_b128 v[84:87], v2 offset:57344
    v_add_f32 v16, v16, v144
    v_mul_f32 v4, 0xbfb8aa3b, v240
    v_exp_f32 v4, v4
    s_nop 0
    v_add_f32 v4, 1.0, v4
    v_rcp_f32 v4, v4
    s_nop 0
    v_mul_f32 v240, v240, v4
    v_mul_f32 v10, 0xbfb8aa3b, v241
    v_exp_f32 v10, v10
    s_waitcnt lgkmcnt(3)
    v_mfma_f32_16x16x32_bf16 v[164:167], v[96:99], v[116:119], v[164:167]
    v_add_f32 v16, v16, v145
    v_mfma_f32_16x16x32_bf16 v[168:171], v[96:99], v[132:135], v[168:171]
    ds_read_b128 v[88:91], v2 offset:58368
    v_cvt_pk_bf16_f32 v192, v144, v145
    v_add_f32 v10, 1.0, v10
    v_rcp_f32 v10, v10
    s_nop 0
    v_mul_f32 v241, v241, v10
    v_mul_f32 v5, 0xbfb8aa3b, v242
    v_exp_f32 v5, v5
    s_nop 0
    v_add_f32 v5, 1.0, v5
    v_rcp_f32 v5, v5
    s_waitcnt lgkmcnt(3)
    v_mfma_f32_16x16x32_bf16 v[156:159], v[100:103], v[120:123], v[156:159]
    v_exp_f32 v146, v146
    v_exp_f32 v147, v147
    v_mfma_f32_16x16x32_bf16 v[160:163], v[100:103], v[136:139], v[160:163]
    ds_read_b128 v[92:95], v2 offset:59392
    v_add_f32 v16, v16, v146
    v_mul_f32 v242, v242, v5
    v_mul_f32 v12, 0xbfb8aa3b, v243
    v_exp_f32 v12, v12
    s_nop 0
    v_add_f32 v12, 1.0, v12
    v_rcp_f32 v12, v12
    s_nop 0
    v_mul_f32 v243, v243, v12
    s_waitcnt lgkmcnt(3)
    v_mfma_f32_16x16x32_bf16 v[164:167], v[104:107], v[120:123], v[164:167]
    v_add_f32 v16, v16, v147
    v_mfma_f32_16x16x32_bf16 v[168:171], v[104:107], v[136:139], v[168:171]
    ds_read_b128 v[96:99], v2 offset:60416
    v_cvt_pk_bf16_f32 v193, v146, v147
    v_cvt_pk_bf16_f32 v4, v236, v237
    v_lshlrev_b32 v236, 16, v4
    v_and_b32 v237, 0xffff0000, v4
    v_cvt_pk_bf16_f32 v4, v238, v239
    v_lshlrev_b32 v238, 16, v4
    v_and_b32 v239, 0xffff0000, v4
    v_cvt_pk_bf16_f32 v4, v240, v241
    s_mov_b64 s[20:21], s[40:41]
    s_mov_b32 s22, 0x800000
    s_mov_b32 s23, 0x20000
    s_mov_b32 s26, 0x3000
    buffer_load_dword v18, v17, s[20:23], s26 offen
    s_waitcnt lgkmcnt(3)
    v_mfma_f32_16x16x32_bf16 v[20:23], v[84:87], v[196:199], v[20:23]
    v_exp_f32 v148, v148
    v_exp_f32 v149, v149
    v_mfma_f32_16x16x32_bf16 v[24:27], v[84:87], v[200:203], v[24:27]
    ds_read_b128 v[100:103], v2 offset:61440
    v_add_f32 v15, v15, v148
    v_lshlrev_b32 v240, 16, v4
    v_and_b32 v241, 0xffff0000, v4
    v_cvt_pk_bf16_f32 v4, v242, v243
    v_lshlrev_b32 v242, 16, v4
    v_and_b32 v243, 0xffff0000, v4
    s_waitcnt vmcnt(11)
    v_lshlrev_b32 v4, 16, v204
    v_and_b32 v10, 0xffff0000, v204
    s_waitcnt lgkmcnt(3)
    v_mfma_f32_16x16x32_bf16 v[28:31], v[88:91], v[196:199], v[28:31]
    v_add_f32 v15, v15, v149
    v_mfma_f32_16x16x32_bf16 v[32:35], v[88:91], v[200:203], v[32:35]
    ds_read_b128 v[104:107], v2 offset:62464
    v_cvt_pk_bf16_f32 v190, v148, v149
    v_lshlrev_b32 v5, 16, v205
    v_and_b32 v12, 0xffff0000, v205
    v_mul_f32 v244, v236, v4
    v_mul_f32 v245, v236, v10
    v_mul_f32 v246, v236, v5
    v_mul_f32 v247, v236, v12
    v_lshlrev_b32 v4, 16, v206
    s_waitcnt lgkmcnt(3)
    v_mfma_f32_16x16x32_bf16 v[36:39], v[92:95], v[196:199], v[36:39]
    v_exp_f32 v150, v150
    v_exp_f32 v151, v151
    v_mfma_f32_16x16x32_bf16 v[40:43], v[92:95], v[200:203], v[40:43]
    ds_read_b128 v[84:87], v2 offset:63488
    v_add_f32 v15, v15, v150
    v_and_b32 v10, 0xffff0000, v206
    v_lshlrev_b32 v5, 16, v207
    v_and_b32 v12, 0xffff0000, v207
    v_mul_f32 v248, v236, v4
    v_mul_f32 v249, v236, v10
    v_mul_f32 v250, v236, v5
    v_mul_f32 v251, v236, v12
    s_waitcnt lgkmcnt(3)
    v_mfma_f32_16x16x32_bf16 v[44:47], v[96:99], v[196:199], v[44:47]
    v_add_f32 v15, v15, v151
    v_mfma_f32_16x16x32_bf16 v[48:51], v[96:99], v[200:203], v[48:51]
    ds_read_b128 v[88:91], v2 offset:64512
    v_cvt_pk_bf16_f32 v191, v150, v151
    s_waitcnt vmcnt(10)
    v_lshlrev_b32 v4, 16, v208
    v_and_b32 v10, 0xffff0000, v208
    v_lshlrev_b32 v5, 16, v209
    v_and_b32 v12, 0xffff0000, v209
    v_fmac_f32 v244, v237, v4
    v_fmac_f32 v245, v237, v10
    v_fmac_f32 v246, v237, v5
    s_mov_b64 s[20:21], s[40:41]
    s_mov_b32 s22, 0x800000
    s_mov_b32 s23, 0x20000
    s_mov_b32 s26, 0x4000
    buffer_load_dword v18, v17, s[20:23], s26 offen
    s_waitcnt lgkmcnt(3)
    v_mfma_f32_16x16x32_bf16 v[52:55], v[100:103], v[196:199], v[52:55]
    v_exp_f32 v152, v152
    v_exp_f32 v153, v153
    v_mfma_f32_16x16x32_bf16 v[56:59], v[100:103], v[200:203], v[56:59]
    s_barrier
    ds_read_b128 v[92:95], v2 offset:0
    v_add_f32 v16, v16, v152
    v_fmac_f32 v247, v237, v12
    v_lshlrev_b32 v4, 16, v210
    v_and_b32 v10, 0xffff0000, v210
    v_lshlrev_b32 v5, 16, v211
    v_and_b32 v12, 0xffff0000, v211
    v_fmac_f32 v248, v237, v4
    s_waitcnt lgkmcnt(3)
    v_mfma_f32_16x16x32_bf16 v[60:63], v[104:107], v[196:199], v[60:63]
    v_add_f32 v16, v16, v153
    v_mfma_f32_16x16x32_bf16 v[64:67], v[104:107], v[200:203], v[64:67]
    ds_read_b128 v[96:99], v2 offset:1024
    v_cvt_pk_bf16_f32 v194, v152, v153
    v_fmac_f32 v249, v237, v10
    v_fmac_f32 v250, v237, v5
    v_fmac_f32 v251, v237, v12
    s_waitcnt vmcnt(10)
    v_lshlrev_b32 v4, 16, v212
    v_and_b32 v10, 0xffff0000, v212
    v_lshlrev_b32 v5, 16, v213
    v_and_b32 v12, 0xffff0000, v213
    s_waitcnt lgkmcnt(3)
    v_mfma_f32_16x16x32_bf16 v[68:71], v[84:87], v[196:199], v[68:71]
    v_exp_f32 v154, v154
    v_exp_f32 v155, v155
    v_mfma_f32_16x16x32_bf16 v[72:75], v[84:87], v[200:203], v[72:75]
    ds_read_b128 v[100:103], v2 offset:2048
    v_add_f32 v16, v16, v154
    v_fmac_f32 v244, v238, v4
    v_fmac_f32 v245, v238, v10
    v_fmac_f32 v246, v238, v5
    v_fmac_f32 v247, v238, v12
    v_lshlrev_b32 v4, 16, v214
    v_and_b32 v10, 0xffff0000, v214
    v_lshlrev_b32 v5, 16, v215
    s_mov_b64 s[20:21], s[40:41]
    s_mov_b32 s22, 0x800000
    s_mov_b32 s23, 0x20000
    s_mov_b32 s26, 0x5000
    buffer_load_dword v18, v17, s[20:23], s26 offen
    s_waitcnt lgkmcnt(3)
    v_mfma_f32_16x16x32_bf16 v[76:79], v[88:91], v[196:199], v[76:79]
    v_add_f32 v16, v16, v155
    v_mfma_f32_16x16x32_bf16 v[80:83], v[88:91], v[200:203], v[80:83]
    ds_read_b128 v[104:107], v2 offset:3072
    v_cvt_pk_bf16_f32 v195, v154, v155
    v_and_b32 v12, 0xffff0000, v215
    v_fmac_f32 v248, v238, v4
    v_fmac_f32 v249, v238, v10
    v_fmac_f32 v250, v238, v5
    v_fmac_f32 v251, v238, v12
    s_waitcnt vmcnt(10)
    v_lshlrev_b32 v4, 16, v216
    v_and_b32 v10, 0xffff0000, v216
    s_waitcnt lgkmcnt(3)
    v_mfma_f32_16x16x32_bf16 v[140:143], v[92:95], v[108:111], v[172:175]
    v_exp_f32 v156, v156
    v_exp_f32 v157, v157
    v_mfma_f32_16x16x32_bf16 v[144:147], v[92:95], v[124:127], v[176:179]
    ds_read_b128 v[84:87], v2 offset:4096
    v_add_f32 v15, v15, v156
    v_lshlrev_b32 v5, 16, v217
    v_and_b32 v12, 0xffff0000, v217
    v_fmac_f32 v244, v239, v4
    v_fmac_f32 v245, v239, v10
    v_fmac_f32 v246, v239, v5
    v_fmac_f32 v247, v239, v12
    v_lshlrev_b32 v4, 16, v218
    s_waitcnt lgkmcnt(3)
    v_mfma_f32_16x16x32_bf16 v[148:151], v[96:99], v[108:111], v[172:175]
    v_add_f32 v15, v15, v157
    v_mfma_f32_16x16x32_bf16 v[152:155], v[96:99], v[124:127], v[176:179]
    ds_read_b128 v[88:91], v2 offset:5120
    v_cvt_pk_bf16_f32 v196, v156, v157
    v_and_b32 v10, 0xffff0000, v218
    v_lshlrev_b32 v5, 16, v219
    v_and_b32 v12, 0xffff0000, v219
    v_fmac_f32 v248, v239, v4
    v_fmac_f32 v249, v239, v10
    v_fmac_f32 v250, v239, v5
    v_fmac_f32 v251, v239, v12
    s_waitcnt lgkmcnt(3)
    v_mfma_f32_16x16x32_bf16 v[140:143], v[100:103], v[112:115], v[140:143]
    v_exp_f32 v158, v158
    v_exp_f32 v159, v159
    v_mfma_f32_16x16x32_bf16 v[144:147], v[100:103], v[128:131], v[144:147]
    ds_read_b128 v[92:95], v2 offset:6144
    v_add_f32 v15, v15, v158
    s_waitcnt vmcnt(9)
    v_lshlrev_b32 v4, 16, v220
    v_and_b32 v10, 0xffff0000, v220
    v_lshlrev_b32 v5, 16, v221
    v_and_b32 v12, 0xffff0000, v221
    v_fmac_f32 v244, v240, v4
    v_fmac_f32 v245, v240, v10
    s_mov_b64 s[20:21], s[40:41]
    s_mov_b32 s22, 0x800000
    s_mov_b32 s23, 0x20000
    s_mov_b32 s26, 0x6000
    buffer_load_dword v18, v17, s[20:23], s26 offen
    s_waitcnt lgkmcnt(3)
    v_mfma_f32_16x16x32_bf16 v[148:151], v[104:107], v[112:115], v[148:151]
    v_add_f32 v15, v15, v159
    v_mfma_f32_16x16x32_bf16 v[152:155], v[104:107], v[128:131], v[152:155]
    ds_read_b128 v[96:99], v2 offset:7168
    v_cvt_pk_bf16_f32 v197, v158, v159
    v_fmac_f32 v246, v240, v5
    v_fmac_f32 v247, v240, v12
    v_lshlrev_b32 v4, 16, v222
    v_and_b32 v10, 0xffff0000, v222
    v_lshlrev_b32 v5, 16, v223
    v_and_b32 v12, 0xffff0000, v223
    v_fmac_f32 v248, v240, v4
    s_waitcnt lgkmcnt(3)
    v_mfma_f32_16x16x32_bf16 v[140:143], v[84:87], v[116:119], v[140:143]
    v_exp_f32 v160, v160
    v_exp_f32 v161, v161
    v_mfma_f32_16x16x32_bf16 v[144:147], v[84:87], v[132:135], v[144:147]
    ds_read_b128 v[100:103], v3 offset:8192
    v_add_f32 v16, v16, v160
    v_fmac_f32 v249, v240, v10
    v_fmac_f32 v250, v240, v5
    v_fmac_f32 v251, v240, v12
    s_waitcnt vmcnt(9)
    v_lshlrev_b32 v4, 16, v224
    v_and_b32 v10, 0xffff0000, v224
    v_lshlrev_b32 v5, 16, v225
    v_and_b32 v12, 0xffff0000, v225
    s_waitcnt lgkmcnt(3)
    v_mfma_f32_16x16x32_bf16 v[148:151], v[88:91], v[116:119], v[148:151]
    v_add_f32 v16, v16, v161
    v_mfma_f32_16x16x32_bf16 v[152:155], v[88:91], v[132:135], v[152:155]
    ds_read_b128 v[104:107], v3 offset:9216
    v_cvt_pk_bf16_f32 v200, v160, v161
    v_fmac_f32 v244, v241, v4
    v_fmac_f32 v245, v241, v10
    v_fmac_f32 v246, v241, v5
    v_fmac_f32 v247, v241, v12
    v_lshlrev_b32 v4, 16, v226
    v_and_b32 v10, 0xffff0000, v226
    v_lshlrev_b32 v5, 16, v227
    s_waitcnt lgkmcnt(3)
    v_mfma_f32_16x16x32_bf16 v[140:143], v[92:95], v[120:123], v[140:143]
    v_exp_f32 v162, v162
    v_exp_f32 v163, v163
    v_mfma_f32_16x16x32_bf16 v[144:147], v[92:95], v[136:139], v[144:147]
    ds_read_b128 v[84:87], v3 offset:10240
    v_add_f32 v16, v16, v162
    v_and_b32 v12, 0xffff0000, v227
    v_fmac_f32 v248, v241, v4
    v_fmac_f32 v249, v241, v10
    v_fmac_f32 v250, v241, v5
    v_fmac_f32 v251, v241, v12
    s_waitcnt vmcnt(8)
    v_lshlrev_b32 v4, 16, v228
    v_and_b32 v10, 0xffff0000, v228
    s_mov_b64 s[20:21], s[40:41]
    s_mov_b32 s22, 0x800000
    s_mov_b32 s23, 0x20000
    s_mov_b32 s26, 0x7000
    buffer_load_dword v18, v17, s[20:23], s26 offen
    s_waitcnt lgkmcnt(3)
    v_mfma_f32_16x16x32_bf16 v[148:151], v[96:99], v[120:123], v[148:151]
    v_add_f32 v16, v16, v163
    v_mfma_f32_16x16x32_bf16 v[152:155], v[96:99], v[136:139], v[152:155]
    ds_read_b128 v[88:91], v3 offset:11264
    v_cvt_pk_bf16_f32 v201, v162, v163
    v_lshlrev_b32 v5, 16, v229
    v_and_b32 v12, 0xffff0000, v229
    v_fmac_f32 v244, v242, v4
    v_fmac_f32 v245, v242, v10
    v_fmac_f32 v246, v242, v5
    v_fmac_f32 v247, v242, v12
    v_lshlrev_b32 v4, 16, v230
    s_waitcnt lgkmcnt(3)
    v_mfma_f32_16x16x32_bf16 v[20:23], v[100:103], v[188:191], v[20:23]
    v_exp_f32 v164, v164
    v_exp_f32 v165, v165
    v_mfma_f32_16x16x32_bf16 v[24:27], v[100:103], v[192:195], v[24:27]
    ds_read_b128 v[92:95], v3 offset:12288
    v_add_f32 v15, v15, v164
    v_and_b32 v10, 0xffff0000, v230
    v_lshlrev_b32 v5, 16, v231
    v_and_b32 v12, 0xffff0000, v231
    v_fmac_f32 v248, v242, v4
    v_fmac_f32 v249, v242, v10
    v_fmac_f32 v250, v242, v5
    s_waitcnt lgkmcnt(3)
    v_mfma_f32_16x16x32_bf16 v[28:31], v[104:107], v[188:191], v[28:31]
    v_add_f32 v15, v15, v165
    v_mfma_f32_16x16x32_bf16 v[32:35], v[104:107], v[192:195], v[32:35]
    ds_read_b128 v[96:99], v3 offset:13312
    v_cvt_pk_bf16_f32 v198, v164, v165
    v_fmac_f32 v251, v242, v12
    s_waitcnt vmcnt(8)
    v_lshlrev_b32 v4, 16, v232
    v_and_b32 v10, 0xffff0000, v232
    v_lshlrev_b32 v5, 16, v233
    v_and_b32 v12, 0xffff0000, v233
    v_fmac_f32 v244, v243, v4
    v_fmac_f32 v245, v243, v10
    s_waitcnt lgkmcnt(3)
    v_mfma_f32_16x16x32_bf16 v[36:39], v[84:87], v[188:191], v[36:39]
    v_exp_f32 v166, v166
    v_exp_f32 v167, v167
    v_mfma_f32_16x16x32_bf16 v[40:43], v[84:87], v[192:195], v[40:43]
    ds_read_b128 v[100:103], v3 offset:14336
    v_add_f32 v15, v15, v166
    v_fmac_f32 v246, v243, v5
    v_fmac_f32 v247, v243, v12
    v_lshlrev_b32 v4, 16, v234
    v_and_b32 v10, 0xffff0000, v234
    v_lshlrev_b32 v5, 16, v235
    v_and_b32 v12, 0xffff0000, v235
    v_fmac_f32 v248, v243, v4
    s_mov_b64 s[20:21], s[40:41]
    s_mov_b32 s22, 0x800000
    s_mov_b32 s23, 0x20000
    s_mov_b32 s26, 0x8000
    buffer_load_dword v18, v17, s[20:23], s26 offen
    s_waitcnt lgkmcnt(3)
    v_mfma_f32_16x16x32_bf16 v[44:47], v[88:91], v[188:191], v[44:47]
    v_add_f32 v15, v15, v167
    v_mfma_f32_16x16x32_bf16 v[48:51], v[88:91], v[192:195], v[48:51]
    ds_read_b128 v[104:107], v3 offset:15360
    v_cvt_pk_bf16_f32 v199, v166, v167
    v_fmac_f32 v249, v243, v10
    v_fmac_f32 v250, v243, v5
    v_fmac_f32 v251, v243, v12
    v_permlane32_swap_b32 v244, v248
    v_permlane32_swap_b32 v245, v249
    v_permlane32_swap_b32 v246, v250
    v_permlane32_swap_b32 v247, v251
    s_waitcnt lgkmcnt(3)
    v_mfma_f32_16x16x32_bf16 v[52:55], v[92:95], v[188:191], v[52:55]
    v_exp_f32 v168, v168
    v_exp_f32 v169, v169
    v_mfma_f32_16x16x32_bf16 v[56:59], v[92:95], v[192:195], v[56:59]
    s_barrier
    ds_read_b128 v[84:87], v2 offset:16384
    v_add_f32 v16, v16, v168
    v_add_f32 v244, v244, v248
    v_add_f32 v245, v245, v249
    v_add_f32 v246, v246, v250
    v_add_f32 v247, v247, v251
    s_nop 0
    v_permlane16_swap_b32 v244, v246
    v_permlane16_swap_b32 v245, v247
    v_add_f32 v244, v244, v246
    s_waitcnt lgkmcnt(3)
    v_mfma_f32_16x16x32_bf16 v[60:63], v[96:99], v[188:191], v[60:63]
    v_add_f32 v16, v16, v169
    v_mfma_f32_16x16x32_bf16 v[64:67], v[96:99], v[192:195], v[64:67]
    ds_read_b128 v[88:91], v2 offset:17408
    v_cvt_pk_bf16_f32 v202, v168, v169
    v_add_f32 v245, v245, v247
    v_add_f32_dpp v244, v244, v244 row_ror:8 row_mask:0xf bank_mask:0xf
    s_nop 0
    v_add_f32_dpp v245, v245, v245 row_ror:8 row_mask:0xf bank_mask:0xf
    v_add_f32_dpp v244, v244, v244 row_ror:4 row_mask:0xf bank_mask:0xf
    s_nop 0
    v_add_f32_dpp v245, v245, v245 row_ror:4 row_mask:0xf bank_mask:0xf
    v_add_f32_dpp v244, v244, v244 row_ror:2 row_mask:0xf bank_mask:0xf
    s_nop 0
    v_add_f32_dpp v245, v245, v245 row_ror:2 row_mask:0xf bank_mask:0xf
    s_mov_b64 s[20:21], s[40:41]
    s_mov_b32 s22, 0x800000
    s_mov_b32 s23, 0x20000
    s_mov_b32 s26, 0x9000
    buffer_load_dword v18, v17, s[20:23], s26 offen
    s_waitcnt lgkmcnt(3)
    v_mfma_f32_16x16x32_bf16 v[68:71], v[100:103], v[188:191], v[68:71]
    v_exp_f32 v170, v170
    v_exp_f32 v171, v171
    v_mfma_f32_16x16x32_bf16 v[72:75], v[100:103], v[192:195], v[72:75]
    ds_read_b128 v[92:95], v2 offset:18432
    v_add_f32 v16, v16, v170
    v_lshrrev_b32 v13, 6, v8
    v_lshlrev_b32 v13, 6, v13
    v_lshl_add_u32 v13, v14, 5, v13
    v_bfe_u32 v14, v8, 4, 2
    v_lshl_add_u32 v13, v14, 3, v13
    ds_write_b64 v13, v[244:245] offset:49152
    s_waitcnt lgkmcnt(4)
    v_mfma_f32_16x16x32_bf16 v[76:79], v[104:107], v[188:191], v[76:79]
    v_add_f32 v16, v16, v171
    v_mfma_f32_16x16x32_bf16 v[80:83], v[104:107], v[192:195], v[80:83]
    ds_read_b128 v[96:99], v2 offset:19456
    v_cvt_pk_bf16_f32 v203, v170, v171
    s_waitcnt lgkmcnt(4)
    v_mfma_f32_16x16x32_bf16 v[156:159], v[84:87], v[108:111], v[172:175]
    v_exp_f32 v140, v140
    v_exp_f32 v141, v141
    v_mfma_f32_16x16x32_bf16 v[160:163], v[84:87], v[124:127], v[176:179]
    ds_read_b128 v[100:103], v2 offset:20480
    v_add_f32 v15, v15, v140
    s_waitcnt lgkmcnt(4)
    v_mfma_f32_16x16x32_bf16 v[164:167], v[88:91], v[108:111], v[172:175]
    v_add_f32 v15, v15, v141
    v_mfma_f32_16x16x32_bf16 v[168:171], v[88:91], v[124:127], v[176:179]
    ds_read_b128 v[104:107], v2 offset:21504
    v_cvt_pk_bf16_f32 v188, v140, v141
    s_mov_b64 s[20:21], s[40:41]
    s_mov_b32 s22, 0x800000
    s_mov_b32 s23, 0x20000
    s_mov_b32 s26, 0xa000
    buffer_load_dword v18, v17, s[20:23], s26 offen
    s_waitcnt lgkmcnt(4)
    v_mfma_f32_16x16x32_bf16 v[156:159], v[92:95], v[112:115], v[156:159]
    v_exp_f32 v142, v142
    v_exp_f32 v143, v143
    v_mfma_f32_16x16x32_bf16 v[160:163], v[92:95], v[128:131], v[160:163]
    ds_read_b128 v[84:87], v2 offset:22528
    v_add_f32 v15, v15, v142
    s_waitcnt lgkmcnt(3)
    v_mfma_f32_16x16x32_bf16 v[164:167], v[96:99], v[112:115], v[164:167]
    v_add_f32 v15, v15, v143
    v_mfma_f32_16x16x32_bf16 v[168:171], v[96:99], v[128:131], v[168:171]
    ds_read_b128 v[88:91], v2 offset:23552
    v_cvt_pk_bf16_f32 v189, v142, v143
    s_waitcnt lgkmcnt(0)
    v_mfma_f32_16x16x32_bf16 v[156:159], v[100:103], v[116:119], v[156:159]
    v_exp_f32 v144, v144
    v_exp_f32 v145, v145
    v_mfma_f32_16x16x32_bf16 v[160:163], v[100:103], v[132:135], v[160:163]
    ds_read_b128 v[92:95], v3 offset:24576
    v_add_f32 v16, v16, v144
    v_mfma_f32_16x16x32_bf16 v[164:167], v[104:107], v[116:119], v[164:167]
    v_add_f32 v16, v16, v145
    v_mfma_f32_16x16x32_bf16 v[168:171], v[104:107], v[132:135], v[168:171]
    ds_read_b128 v[96:99], v3 offset:25600
    v_cvt_pk_bf16_f32 v192, v144, v145
    s_mov_b64 s[20:21], s[40:41]
    s_mov_b32 s22, 0x800000
    s_mov_b32 s23, 0x20000
    s_mov_b32 s26, 0xb000
    buffer_load_dword v18, v17, s[20:23], s26 offen
    v_mfma_f32_16x16x32_bf16 v[156:159], v[84:87], v[120:123], v[156:159]
    v_exp_f32 v146, v146
    v_exp_f32 v147, v147
    v_mfma_f32_16x16x32_bf16 v[160:163], v[84:87], v[136:139], v[160:163]
    ds_read_b128 v[100:103], v3 offset:26624
    v_add_f32 v16, v16, v146
    v_mfma_f32_16x16x32_bf16 v[164:167], v[88:91], v[120:123], v[164:167]
    v_add_f32 v16, v16, v147
    v_mfma_f32_16x16x32_bf16 v[168:171], v[88:91], v[136:139], v[168:171]
    ds_read_b128 v[104:107], v3 offset:27648
    v_cvt_pk_bf16_f32 v193, v146, v147
    s_waitcnt lgkmcnt(3)
    v_mfma_f32_16x16x32_bf16 v[20:23], v[92:95], v[196:199], v[20:23]
    v_exp_f32 v148, v148
    v_exp_f32 v149, v149
    v_mfma_f32_16x16x32_bf16 v[24:27], v[92:95], v[200:203], v[24:27]
    ds_read_b128 v[84:87], v3 offset:28672
    v_add_f32 v15, v15, v148
    s_waitcnt lgkmcnt(3)
    v_mfma_f32_16x16x32_bf16 v[28:31], v[96:99], v[196:199], v[28:31]
    v_add_f32 v15, v15, v149
    v_mfma_f32_16x16x32_bf16 v[32:35], v[96:99], v[200:203], v[32:35]
    ds_read_b128 v[88:91], v3 offset:29696
    v_cvt_pk_bf16_f32 v190, v148, v149
    s_mov_b64 s[20:21], s[40:41]
    s_mov_b32 s22, 0x800000
    s_mov_b32 s23, 0x20000
    s_mov_b32 s26, 0xc000
    buffer_load_dword v18, v17, s[20:23], s26 offen
    s_waitcnt lgkmcnt(3)
    v_mfma_f32_16x16x32_bf16 v[36:39], v[100:103], v[196:199], v[36:39]
    v_exp_f32 v150, v150
    v_exp_f32 v151, v151
    v_mfma_f32_16x16x32_bf16 v[40:43], v[100:103], v[200:203], v[40:43]
    ds_read_b128 v[92:95], v3 offset:30720
    v_add_f32 v15, v15, v150
    s_waitcnt lgkmcnt(3)
    v_mfma_f32_16x16x32_bf16 v[44:47], v[104:107], v[196:199], v[44:47]
    v_add_f32 v15, v15, v151
    v_mfma_f32_16x16x32_bf16 v[48:51], v[104:107], v[200:203], v[48:51]
    ds_read_b128 v[96:99], v3 offset:31744
    v_cvt_pk_bf16_f32 v191, v150, v151
    s_waitcnt lgkmcnt(3)
    v_mfma_f32_16x16x32_bf16 v[52:55], v[84:87], v[196:199], v[52:55]
    v_exp_f32 v152, v152
    v_exp_f32 v153, v153
    v_mfma_f32_16x16x32_bf16 v[56:59], v[84:87], v[200:203], v[56:59]
    s_barrier
    ds_read_b128 v[100:103], v2 offset:32768
    v_add_f32 v16, v16, v152
    s_mov_b64 s[20:21], s[40:41]
    s_mov_b32 s22, 0x800000
    s_mov_b32 s23, 0x20000
    s_mov_b32 s26, 0xd000
    buffer_load_dword v18, v17, s[20:23], s26 offen
    s_waitcnt lgkmcnt(3)
    v_mfma_f32_16x16x32_bf16 v[60:63], v[88:91], v[196:199], v[60:63]
    v_add_f32 v16, v16, v153
    v_mfma_f32_16x16x32_bf16 v[64:67], v[88:91], v[200:203], v[64:67]
    ds_read_b128 v[104:107], v2 offset:33792
    v_cvt_pk_bf16_f32 v194, v152, v153
    s_waitcnt lgkmcnt(3)
    v_mfma_f32_16x16x32_bf16 v[68:71], v[92:95], v[196:199], v[68:71]
    v_exp_f32 v154, v154
    v_exp_f32 v155, v155
    v_mfma_f32_16x16x32_bf16 v[72:75], v[92:95], v[200:203], v[72:75]
    ds_read_b128 v[84:87], v2 offset:34816
    v_add_f32 v16, v16, v154
    s_waitcnt lgkmcnt(3)
    v_mfma_f32_16x16x32_bf16 v[76:79], v[96:99], v[196:199], v[76:79]
    v_add_f32 v16, v16, v155
    v_mfma_f32_16x16x32_bf16 v[80:83], v[96:99], v[200:203], v[80:83]
    ds_read_b128 v[88:91], v2 offset:35840
    v_cvt_pk_bf16_f32 v195, v154, v155
    s_waitcnt lgkmcnt(3)
    v_mfma_f32_16x16x32_bf16 v[140:143], v[100:103], v[108:111], v[172:175]
    v_exp_f32 v156, v156
    v_exp_f32 v157, v157
    v_mfma_f32_16x16x32_bf16 v[144:147], v[100:103], v[124:127], v[176:179]
    ds_read_b128 v[92:95], v2 offset:36864
    v_add_f32 v15, v15, v156
    s_mov_b64 s[20:21], s[40:41]
    s_mov_b32 s22, 0x800000
    s_mov_b32 s23, 0x20000
    s_mov_b32 s26, 0xe000
    buffer_load_dword v18, v17, s[20:23], s26 offen
    s_waitcnt lgkmcnt(3)
    v_mfma_f32_16x16x32_bf16 v[148:151], v[104:107], v[108:111], v[172:175]
    v_add_f32 v15, v15, v157
    v_mfma_f32_16x16x32_bf16 v[152:155], v[104:107], v[124:127], v[176:179]
    ds_read_b128 v[96:99], v2 offset:37888
    v_cvt_pk_bf16_f32 v196, v156, v157
    s_waitcnt lgkmcnt(3)
    v_mfma_f32_16x16x32_bf16 v[140:143], v[84:87], v[112:115], v[140:143]
    v_exp_f32 v158, v158
    v_exp_f32 v159, v159
    v_mfma_f32_16x16x32_bf16 v[144:147], v[84:87], v[128:131], v[144:147]
    ds_read_b128 v[100:103], v2 offset:38912
    v_add_f32 v15, v15, v158
    v_and_b32 v13, 15, v0
    v_lshlrev_b32 v13, 2, v13
    ds_read_b32 v244, v13 offset:49152
    ds_read_b32 v245, v13 offset:49216
    ds_read_b32 v246, v13 offset:49280
    ds_read_b32 v247, v13 offset:49344
    s_waitcnt lgkmcnt(7)
    v_mfma_f32_16x16x32_bf16 v[148:151], v[88:91], v[112:115], v[148:151]
    v_add_f32 v15, v15, v159
    v_mfma_f32_16x16x32_bf16 v[152:155], v[88:91], v[128:131], v[152:155]
    ds_read_b128 v[104:107], v2 offset:39936
    v_cvt_pk_bf16_f32 v197, v158, v159
    s_waitcnt lgkmcnt(7)
    v_mfma_f32_16x16x32_bf16 v[140:143], v[92:95], v[116:119], v[140:143]
    v_exp_f32 v160, v160
    v_exp_f32 v161, v161
    v_mfma_f32_16x16x32_bf16 v[144:147], v[92:95], v[132:135], v[144:147]
    ds_read_b128 v[84:87], v2 offset:8192
    v_add_f32 v16, v16, v160
    s_mov_b64 s[20:21], s[40:41]
    s_mov_b32 s22, 0x800000
    s_mov_b32 s23, 0x20000
    s_mov_b32 s26, 0xf000
    buffer_load_dword v18, v17, s[20:23], s26 offen
    s_waitcnt lgkmcnt(7)
    v_mfma_f32_16x16x32_bf16 v[148:151], v[96:99], v[116:119], v[148:151]
    v_add_f32 v16, v16, v161
    v_mfma_f32_16x16x32_bf16 v[152:155], v[96:99], v[132:135], v[152:155]
    ds_read_b128 v[88:91], v2 offset:9216
    v_cvt_pk_bf16_f32 v200, v160, v161
    s_waitcnt lgkmcnt(7)
    v_mfma_f32_16x16x32_bf16 v[140:143], v[100:103], v[120:123], v[140:143]
    v_exp_f32 v162, v162
    v_exp_f32 v163, v163
    v_mfma_f32_16x16x32_bf16 v[144:147], v[100:103], v[136:139], v[144:147]
    ds_read_b128 v[92:95], v2 offset:10240
    v_add_f32 v16, v16, v162
    s_waitcnt lgkmcnt(3)
    v_mfma_f32_16x16x32_bf16 v[148:151], v[104:107], v[120:123], v[148:151]
    v_add_f32 v16, v16, v163
    v_mfma_f32_16x16x32_bf16 v[152:155], v[104:107], v[136:139], v[152:155]
    ds_read_b128 v[96:99], v2 offset:11264
    v_cvt_pk_bf16_f32 v201, v162, v163
    s_waitcnt lgkmcnt(3)
    v_mfma_f32_16x16x32_bf16 v[20:23], v[84:87], v[188:191], v[20:23]
    v_exp_f32 v164, v164
    v_exp_f32 v165, v165
    v_mfma_f32_16x16x32_bf16 v[24:27], v[84:87], v[192:195], v[24:27]
    ds_read_b128 v[100:103], v2 offset:12288
    v_add_f32 v15, v15, v164
    v_add_f32 v244, v244, v246
    v_add_f32 v245, v245, v247
    v_add_f32 v244, v244, v245
    v_cvt_pk_bf16_f32 v244, v244, v244
    v_lshlrev_b32 v244, 16, v244
    s_lshr_b32 s26, s100, 6
    s_cmp_eq_u32 s26, 2
    s_cselect_b32 s26, 1.0, 0
    v_add_f32 v244, s26, v244
    v_cvt_pk_bf16_f32 v244, v244, v244
    v_lshlrev_b32 v244, 16, v244
    v_or_b32 v244, 1, v244
    s_lshl_b32 s26, s100, 6
    s_add_u32 s26, s26, 0xa20000
    s_cmp_eq_u32 s3, 4
    s_cselect_b32 s26, s26, 0x7ffffff0
    s_mov_b64 exec, 0xffff
    buffer_store_dword v244, v13, s[8:11], s26 offen sc1
    s_mov_b64 exec, -1
    s_nop 3
    s_waitcnt lgkmcnt(3)
    v_mfma_f32_16x16x32_bf16 v[28:31], v[88:91], v[188:191], v[28:31]
    v_add_f32 v15, v15, v165
    v_mfma_f32_16x16x32_bf16 v[32:35], v[88:91], v[192:195], v[32:35]
    ds_read_b128 v[104:107], v2 offset:13312
    v_cvt_pk_bf16_f32 v198, v164, v165
    s_waitcnt lgkmcnt(3)
    v_mfma_f32_16x16x32_bf16 v[36:39], v[92:95], v[188:191], v[36:39]
    v_exp_f32 v166, v166
    v_exp_f32 v167, v167
    v_mfma_f32_16x16x32_bf16 v[40:43], v[92:95], v[192:195], v[40:43]
    ds_read_b128 v[84:87], v2 offset:14336
    v_add_f32 v15, v15, v166
    s_waitcnt lgkmcnt(3)
    v_mfma_f32_16x16x32_bf16 v[44:47], v[96:99], v[188:191], v[44:47]
    v_add_f32 v15, v15, v167
    v_mfma_f32_16x16x32_bf16 v[48:51], v[96:99], v[192:195], v[48:51]
    ds_read_b128 v[88:91], v2 offset:15360
    v_cvt_pk_bf16_f32 v199, v166, v167
    v_lshrrev_b32 v6, 3, v8
    v_and_b32 v7, 7, v8
    s_bfe_u32 s25, s2, 0x10002
    s_mul_i32 s25, s25, 28
    s_lshr_b32 s26, s2, 3
    s_add_u32 s25, s25, s26
    s_lshl_b32 s25, s25, 7
    s_bfe_u32 s24, s2, 0x10001
    s_mul_i32 s24, s24, 3670016
    s_add_u32 s24, s24, s25
    s_mov_b32 s26, 114688
    v_mul_lo_u32 v19, s26, v6
    v_lshl_add_u32 v19, v7, 4, v19
    s_bitcmp0_b32 s2, 0
    s_cselect_b32 s64, s46, s48
    s_cselect_b32 s65, s47, s49
    s_cmp_lt_u32 s2, 224
    s_cselect_b32 s66, 0x700000, 0
    s_mov_b32 s67, 0x20000
    s_waitcnt lgkmcnt(3)
    v_mfma_f32_16x16x32_bf16 v[52:55], v[100:103], v[188:191], v[52:55]
    v_exp_f32 v168, v168
    v_exp_f32 v169, v169
    v_mfma_f32_16x16x32_bf16 v[56:59], v[100:103], v[192:195], v[56:59]
    s_barrier
    ds_read_b128 v[92:95], v2 offset:49152
    v_add_f32 v16, v16, v168
    s_add_u32 s25, s24, 0
    buffer_load_dwordx4 v[204:207], v19, s[64:67], s25 offen
    s_waitcnt lgkmcnt(3)
    v_mfma_f32_16x16x32_bf16 v[60:63], v[104:107], v[188:191], v[60:63]
    v_add_f32 v16, v16, v169
    v_mfma_f32_16x16x32_bf16 v[64:67], v[104:107], v[192:195], v[64:67]
    ds_read_b128 v[96:99], v2 offset:50176
    v_cvt_pk_bf16_f32 v202, v168, v169
    s_waitcnt lgkmcnt(3)
    v_mfma_f32_16x16x32_bf16 v[68:71], v[84:87], v[188:191], v[68:71]
    v_exp_f32 v170, v170
    v_exp_f32 v171, v171
    v_mfma_f32_16x16x32_bf16 v[72:75], v[84:87], v[192:195], v[72:75]
    ds_read_b128 v[100:103], v2 offset:51200
    v_add_f32 v16, v16, v170
    s_waitcnt lgkmcnt(3)
    v_mfma_f32_16x16x32_bf16 v[76:79], v[88:91], v[188:191], v[76:79]
    v_add_f32 v16, v16, v171
    v_mfma_f32_16x16x32_bf16 v[80:83], v[88:91], v[192:195], v[80:83]
    ds_read_b128 v[104:107], v2 offset:52224
    v_cvt_pk_bf16_f32 v203, v170, v171
    s_waitcnt lgkmcnt(3)
    v_mfma_f32_16x16x32_bf16 v[156:159], v[92:95], v[108:111], v[172:175]
    v_exp_f32 v140, v140
    v_exp_f32 v141, v141
    v_mfma_f32_16x16x32_bf16 v[160:163], v[92:95], v[124:127], v[176:179]
    ds_read_b128 v[84:87], v2 offset:53248
    v_add_f32 v15, v15, v140
    s_add_u32 s25, s24, 7168
    buffer_load_dwordx4 v[208:211], v19, s[64:67], s25 offen
    s_waitcnt lgkmcnt(3)
    v_mfma_f32_16x16x32_bf16 v[164:167], v[96:99], v[108:111], v[172:175]
    v_add_f32 v15, v15, v141
    v_mfma_f32_16x16x32_bf16 v[168:171], v[96:99], v[124:127], v[176:179]
    ds_read_b128 v[88:91], v2 offset:54272
    v_cvt_pk_bf16_f32 v188, v140, v141
    s_waitcnt lgkmcnt(3)
    v_mfma_f32_16x16x32_bf16 v[156:159], v[100:103], v[112:115], v[156:159]
    v_exp_f32 v142, v142
    v_exp_f32 v143, v143
    v_mfma_f32_16x16x32_bf16 v[160:163], v[100:103], v[128:131], v[160:163]
    ds_read_b128 v[92:95], v2 offset:55296
    v_add_f32 v15, v15, v142
    s_waitcnt lgkmcnt(3)
    v_mfma_f32_16x16x32_bf16 v[164:167], v[104:107], v[112:115], v[164:167]
    v_add_f32 v15, v15, v143
    v_mfma_f32_16x16x32_bf16 v[168:171], v[104:107], v[128:131], v[168:171]
    ds_read_b128 v[96:99], v2 offset:56320
    v_cvt_pk_bf16_f32 v189, v142, v143
    s_waitcnt lgkmcnt(3)
    v_mfma_f32_16x16x32_bf16 v[156:159], v[84:87], v[116:119], v[156:159]
    v_exp_f32 v144, v144
    v_exp_f32 v145, v145
    v_mfma_f32_16x16x32_bf16 v[160:163], v[84:87], v[132:135], v[160:163]
    ds_read_b128 v[100:103], v2 offset:24576
    v_add_f32 v16, v16, v144
    s_add_u32 s25, s24, 14336
    buffer_load_dwordx4 v[212:215], v19, s[64:67], s25 offen
    s_waitcnt lgkmcnt(3)
    v_mfma_f32_16x16x32_bf16 v[164:167], v[88:91], v[116:119], v[164:167]
    v_add_f32 v16, v16, v145
    v_mfma_f32_16x16x32_bf16 v[168:171], v[88:91], v[132:135], v[168:171]
    ds_read_b128 v[104:107], v2 offset:25600
    v_cvt_pk_bf16_f32 v192, v144, v145
    s_waitcnt lgkmcnt(3)
    v_mfma_f32_16x16x32_bf16 v[156:159], v[92:95], v[120:123], v[156:159]
    v_exp_f32 v146, v146
    v_exp_f32 v147, v147
    v_mfma_f32_16x16x32_bf16 v[160:163], v[92:95], v[136:139], v[160:163]
    ds_read_b128 v[84:87], v2 offset:26624
    v_add_f32 v16, v16, v146
    s_waitcnt lgkmcnt(3)
    v_mfma_f32_16x16x32_bf16 v[164:167], v[96:99], v[120:123], v[164:167]
    v_add_f32 v16, v16, v147
    v_mfma_f32_16x16x32_bf16 v[168:171], v[96:99], v[136:139], v[168:171]
    ds_read_b128 v[88:91], v2 offset:27648
    v_cvt_pk_bf16_f32 v193, v146, v147
    s_waitcnt lgkmcnt(3)
    v_mfma_f32_16x16x32_bf16 v[20:23], v[100:103], v[196:199], v[20:23]
    v_exp_f32 v148, v148
    v_exp_f32 v149, v149
    v_mfma_f32_16x16x32_bf16 v[24:27], v[100:103], v[200:203], v[24:27]
    ds_read_b128 v[92:95], v2 offset:28672
    v_add_f32 v15, v15, v148
    s_waitcnt lgkmcnt(3)
    v_mfma_f32_16x16x32_bf16 v[28:31], v[104:107], v[196:199], v[28:31]
    v_add_f32 v15, v15, v149
    v_mfma_f32_16x16x32_bf16 v[32:35], v[104:107], v[200:203], v[32:35]
    ds_read_b128 v[96:99], v2 offset:29696
    v_cvt_pk_bf16_f32 v190, v148, v149
    s_add_u32 s25, s24, 21504
    buffer_load_dwordx4 v[216:219], v19, s[64:67], s25 offen
    s_waitcnt lgkmcnt(3)
    v_mfma_f32_16x16x32_bf16 v[36:39], v[84:87], v[196:199], v[36:39]
    v_exp_f32 v150, v150
    v_exp_f32 v151, v151
    v_mfma_f32_16x16x32_bf16 v[40:43], v[84:87], v[200:203], v[40:43]
    ds_read_b128 v[100:103], v2 offset:30720
    v_add_f32 v15, v15, v150
    s_waitcnt lgkmcnt(3)
    v_mfma_f32_16x16x32_bf16 v[44:47], v[88:91], v[196:199], v[44:47]
    v_add_f32 v15, v15, v151
    v_mfma_f32_16x16x32_bf16 v[48:51], v[88:91], v[200:203], v[48:51]
    ds_read_b128 v[104:107], v2 offset:31744
    v_cvt_pk_bf16_f32 v191, v150, v151
    s_waitcnt lgkmcnt(3)
    v_mfma_f32_16x16x32_bf16 v[52:55], v[92:95], v[196:199], v[52:55]
    v_exp_f32 v152, v152
    v_exp_f32 v153, v153
    v_mfma_f32_16x16x32_bf16 v[56:59], v[92:95], v[200:203], v[56:59]
    s_barrier
    ds_read_b128 v[84:87], v3 offset:0
    v_add_f32 v16, v16, v152
    s_waitcnt lgkmcnt(3)
    v_mfma_f32_16x16x32_bf16 v[60:63], v[96:99], v[196:199], v[60:63]
    v_add_f32 v16, v16, v153
    v_mfma_f32_16x16x32_bf16 v[64:67], v[96:99], v[200:203], v[64:67]
    ds_read_b128 v[88:91], v3 offset:1024
    v_cvt_pk_bf16_f32 v194, v152, v153
    s_add_u32 s25, s24, 28672
    buffer_load_dwordx4 v[220:223], v19, s[64:67], s25 offen
    s_waitcnt lgkmcnt(3)
    v_mfma_f32_16x16x32_bf16 v[68:71], v[100:103], v[196:199], v[68:71]
    v_exp_f32 v154, v154
    v_exp_f32 v155, v155
    v_mfma_f32_16x16x32_bf16 v[72:75], v[100:103], v[200:203], v[72:75]
    ds_read_b128 v[92:95], v3 offset:2048
    v_add_f32 v16, v16, v154
    s_waitcnt lgkmcnt(3)
    v_mfma_f32_16x16x32_bf16 v[76:79], v[104:107], v[196:199], v[76:79]
    v_add_f32 v16, v16, v155
    v_mfma_f32_16x16x32_bf16 v[80:83], v[104:107], v[200:203], v[80:83]
    ds_read_b128 v[96:99], v3 offset:3072
    v_cvt_pk_bf16_f32 v195, v154, v155
    s_waitcnt lgkmcnt(3)
    v_mfma_f32_16x16x32_bf16 v[140:143], v[84:87], v[108:111], v[172:175]
    v_exp_f32 v156, v156
    v_exp_f32 v157, v157
    v_mfma_f32_16x16x32_bf16 v[144:147], v[84:87], v[124:127], v[176:179]
    ds_read_b128 v[100:103], v3 offset:4096
    v_add_f32 v15, v15, v156
    s_waitcnt lgkmcnt(3)
    v_mfma_f32_16x16x32_bf16 v[148:151], v[88:91], v[108:111], v[172:175]
    v_add_f32 v15, v15, v157
    v_mfma_f32_16x16x32_bf16 v[152:155], v[88:91], v[124:127], v[176:179]
    ds_read_b128 v[104:107], v3 offset:5120
    v_cvt_pk_bf16_f32 v196, v156, v157
    s_waitcnt lgkmcnt(3)
    v_mfma_f32_16x16x32_bf16 v[140:143], v[92:95], v[112:115], v[140:143]
    v_exp_f32 v158, v158
    v_exp_f32 v159, v159
    v_mfma_f32_16x16x32_bf16 v[144:147], v[92:95], v[128:131], v[144:147]
    ds_read_b128 v[84:87], v3 offset:6144
    v_add_f32 v15, v15, v158
    s_add_u32 s25, s24, 35840
    buffer_load_dwordx4 v[224:227], v19, s[64:67], s25 offen
    s_waitcnt lgkmcnt(3)
    v_mfma_f32_16x16x32_bf16 v[148:151], v[96:99], v[112:115], v[148:151]
    v_add_f32 v15, v15, v159
    v_mfma_f32_16x16x32_bf16 v[152:155], v[96:99], v[128:131], v[152:155]
    ds_read_b128 v[88:91], v3 offset:7168
    v_cvt_pk_bf16_f32 v197, v158, v159
    s_waitcnt lgkmcnt(3)
    v_mfma_f32_16x16x32_bf16 v[140:143], v[100:103], v[116:119], v[140:143]
    v_exp_f32 v160, v160
    v_exp_f32 v161, v161
    v_mfma_f32_16x16x32_bf16 v[144:147], v[100:103], v[132:135], v[144:147]
    ds_read_b128 v[92:95], v2 offset:40960
    v_add_f32 v16, v16, v160
    s_waitcnt lgkmcnt(3)
    v_mfma_f32_16x16x32_bf16 v[148:151], v[104:107], v[116:119], v[148:151]
    v_add_f32 v16, v16, v161
    v_mfma_f32_16x16x32_bf16 v[152:155], v[104:107], v[132:135], v[152:155]
    ds_read_b128 v[96:99], v2 offset:41984
    v_cvt_pk_bf16_f32 v200, v160, v161
    s_waitcnt lgkmcnt(3)
    v_mfma_f32_16x16x32_bf16 v[140:143], v[84:87], v[120:123], v[140:143]
    v_exp_f32 v162, v162
    v_exp_f32 v163, v163
    v_mfma_f32_16x16x32_bf16 v[144:147], v[84:87], v[136:139], v[144:147]
    ds_read_b128 v[100:103], v2 offset:43008
    v_add_f32 v16, v16, v162
    s_add_u32 s25, s24, 43008
    buffer_load_dwordx4 v[228:231], v19, s[64:67], s25 offen
    s_waitcnt lgkmcnt(3)
    v_mfma_f32_16x16x32_bf16 v[148:151], v[88:91], v[120:123], v[148:151]
    v_add_f32 v16, v16, v163
    v_mfma_f32_16x16x32_bf16 v[152:155], v[88:91], v[136:139], v[152:155]
    ds_read_b128 v[104:107], v2 offset:44032
    v_cvt_pk_bf16_f32 v201, v162, v163
    s_waitcnt lgkmcnt(3)
    v_mfma_f32_16x16x32_bf16 v[20:23], v[92:95], v[188:191], v[20:23]
    v_exp_f32 v164, v164
    v_exp_f32 v165, v165
    v_mfma_f32_16x16x32_bf16 v[24:27], v[92:95], v[192:195], v[24:27]
    ds_read_b128 v[84:87], v2 offset:45056
    v_add_f32 v15, v15, v164
    s_waitcnt lgkmcnt(3)
    v_mfma_f32_16x16x32_bf16 v[28:31], v[96:99], v[188:191], v[28:31]
    v_add_f32 v15, v15, v165
    v_mfma_f32_16x16x32_bf16 v[32:35], v[96:99], v[192:195], v[32:35]
    ds_read_b128 v[88:91], v2 offset:46080
    v_cvt_pk_bf16_f32 v198, v164, v165
    s_waitcnt lgkmcnt(3)
    v_mfma_f32_16x16x32_bf16 v[36:39], v[100:103], v[188:191], v[36:39]
    v_exp_f32 v166, v166
    v_exp_f32 v167, v167
    v_mfma_f32_16x16x32_bf16 v[40:43], v[100:103], v[192:195], v[40:43]
    ds_read_b128 v[92:95], v2 offset:47104
    v_add_f32 v15, v15, v166
    s_add_u32 s25, s24, 50176
    buffer_load_dwordx4 v[232:235], v19, s[64:67], s25 offen
    s_waitcnt lgkmcnt(3)
    v_mfma_f32_16x16x32_bf16 v[44:47], v[104:107], v[188:191], v[44:47]
    v_add_f32 v15, v15, v167
    v_mfma_f32_16x16x32_bf16 v[48:51], v[104:107], v[192:195], v[48:51]
    ds_read_b128 v[96:99], v2 offset:48128
    v_cvt_pk_bf16_f32 v199, v166, v167
    s_waitcnt lgkmcnt(3)
    v_mfma_f32_16x16x32_bf16 v[52:55], v[84:87], v[188:191], v[52:55]
    v_exp_f32 v168, v168
    v_exp_f32 v169, v169
    v_mfma_f32_16x16x32_bf16 v[56:59], v[84:87], v[192:195], v[56:59]
    s_barrier
    ds_read_b128 v[100:103], v3 offset:16384
    v_add_f32 v16, v16, v168
    s_waitcnt lgkmcnt(3)
    v_mfma_f32_16x16x32_bf16 v[60:63], v[88:91], v[188:191], v[60:63]
    v_add_f32 v16, v16, v169
    v_mfma_f32_16x16x32_bf16 v[64:67], v[88:91], v[192:195], v[64:67]
    ds_read_b128 v[104:107], v3 offset:17408
    v_cvt_pk_bf16_f32 v202, v168, v169
    s_waitcnt lgkmcnt(3)
    v_mfma_f32_16x16x32_bf16 v[68:71], v[92:95], v[188:191], v[68:71]
    v_exp_f32 v170, v170
    v_exp_f32 v171, v171
    v_mfma_f32_16x16x32_bf16 v[72:75], v[92:95], v[192:195], v[72:75]
    ds_read_b128 v[84:87], v3 offset:18432
    v_add_f32 v16, v16, v170
    s_waitcnt lgkmcnt(3)
    v_mfma_f32_16x16x32_bf16 v[76:79], v[96:99], v[188:191], v[76:79]
    v_add_f32 v16, v16, v171
    v_mfma_f32_16x16x32_bf16 v[80:83], v[96:99], v[192:195], v[80:83]
    ds_read_b128 v[88:91], v3 offset:19456
    v_cvt_pk_bf16_f32 v203, v170, v171
    s_add_u32 s25, s24, 57344
    buffer_load_dwordx4 v[236:239], v19, s[64:67], s25 offen
    s_waitcnt lgkmcnt(3)
    v_mfma_f32_16x16x32_bf16 v[156:159], v[100:103], v[108:111], v[172:175]
    v_exp_f32 v140, v140
    v_exp_f32 v141, v141
    v_mfma_f32_16x16x32_bf16 v[160:163], v[100:103], v[124:127], v[176:179]
    ds_read_b128 v[92:95], v3 offset:20480
    v_add_f32 v15, v15, v140
    s_waitcnt lgkmcnt(3)
    v_mfma_f32_16x16x32_bf16 v[164:167], v[104:107], v[108:111], v[172:175]
    v_add_f32 v15, v15, v141
    v_mfma_f32_16x16x32_bf16 v[168:171], v[104:107], v[124:127], v[176:179]
    ds_read_b128 v[96:99], v3 offset:21504
    v_cvt_pk_bf16_f32 v188, v140, v141
    s_waitcnt lgkmcnt(3)
    v_mfma_f32_16x16x32_bf16 v[156:159], v[84:87], v[112:115], v[156:159]
    v_exp_f32 v142, v142
    v_exp_f32 v143, v143
    v_mfma_f32_16x16x32_bf16 v[160:163], v[84:87], v[128:131], v[160:163]
    ds_read_b128 v[100:103], v3 offset:22528
    v_add_f32 v15, v15, v142
    s_waitcnt lgkmcnt(3)
    v_mfma_f32_16x16x32_bf16 v[164:167], v[88:91], v[112:115], v[164:167]
    v_add_f32 v15, v15, v143
    v_mfma_f32_16x16x32_bf16 v[168:171], v[88:91], v[128:131], v[168:171]
    ds_read_b128 v[104:107], v3 offset:23552
    v_cvt_pk_bf16_f32 v189, v142, v143
    s_add_u32 s25, s24, 64512
    buffer_load_dwordx4 v[240:243], v19, s[64:67], s25 offen
    s_waitcnt lgkmcnt(3)
    v_mfma_f32_16x16x32_bf16 v[156:159], v[92:95], v[116:119], v[156:159]
    v_exp_f32 v144, v144
    v_exp_f32 v145, v145
    v_mfma_f32_16x16x32_bf16 v[160:163], v[92:95], v[132:135], v[160:163]
    ds_read_b128 v[84:87], v2 offset:57344
    v_add_f32 v16, v16, v144
    s_waitcnt lgkmcnt(3)
    v_mfma_f32_16x16x32_bf16 v[164:167], v[96:99], v[116:119], v[164:167]
    v_add_f32 v16, v16, v145
    v_mfma_f32_16x16x32_bf16 v[168:171], v[96:99], v[132:135], v[168:171]
    ds_read_b128 v[88:91], v2 offset:58368
    v_cvt_pk_bf16_f32 v192, v144, v145
    s_waitcnt lgkmcnt(3)
    v_mfma_f32_16x16x32_bf16 v[156:159], v[100:103], v[120:123], v[156:159]
    v_exp_f32 v146, v146
    v_exp_f32 v147, v147
    v_mfma_f32_16x16x32_bf16 v[160:163], v[100:103], v[136:139], v[160:163]
    ds_read_b128 v[92:95], v2 offset:59392
    v_add_f32 v16, v16, v146
    s_waitcnt lgkmcnt(3)
    v_mfma_f32_16x16x32_bf16 v[164:167], v[104:107], v[120:123], v[164:167]
    v_add_f32 v16, v16, v147
    v_mfma_f32_16x16x32_bf16 v[168:171], v[104:107], v[136:139], v[168:171]
    ds_read_b128 v[96:99], v2 offset:60416
    v_cvt_pk_bf16_f32 v193, v146, v147
    s_waitcnt lgkmcnt(3)
    v_mfma_f32_16x16x32_bf16 v[20:23], v[84:87], v[196:199], v[20:23]
    v_exp_f32 v148, v148
    v_exp_f32 v149, v149
    v_mfma_f32_16x16x32_bf16 v[24:27], v[84:87], v[200:203], v[24:27]
    ds_read_b128 v[100:103], v2 offset:61440
    v_add_f32 v15, v15, v148
    s_add_u32 s25, s24, 71680
    buffer_load_dwordx4 v[244:247], v19, s[64:67], s25 offen
    s_waitcnt lgkmcnt(3)
    v_mfma_f32_16x16x32_bf16 v[28:31], v[88:91], v[196:199], v[28:31]
    v_add_f32 v15, v15, v149
    v_mfma_f32_16x16x32_bf16 v[32:35], v[88:91], v[200:203], v[32:35]
    ds_read_b128 v[104:107], v2 offset:62464
    v_cvt_pk_bf16_f32 v190, v148, v149
    s_waitcnt lgkmcnt(3)
    v_mfma_f32_16x16x32_bf16 v[36:39], v[92:95], v[196:199], v[36:39]
    v_exp_f32 v150, v150
    v_exp_f32 v151, v151
    v_mfma_f32_16x16x32_bf16 v[40:43], v[92:95], v[200:203], v[40:43]
    ds_read_b128 v[84:87], v2 offset:63488
    v_add_f32 v15, v15, v150
    s_waitcnt lgkmcnt(3)
    v_mfma_f32_16x16x32_bf16 v[44:47], v[96:99], v[196:199], v[44:47]
    v_add_f32 v15, v15, v151
    v_mfma_f32_16x16x32_bf16 v[48:51], v[96:99], v[200:203], v[48:51]
    ds_read_b128 v[88:91], v2 offset:64512
    v_cvt_pk_bf16_f32 v191, v150, v151
    s_waitcnt lgkmcnt(3)
    v_mfma_f32_16x16x32_bf16 v[52:55], v[100:103], v[196:199], v[52:55]
    v_exp_f32 v152, v152
    v_exp_f32 v153, v153
    v_mfma_f32_16x16x32_bf16 v[56:59], v[100:103], v[200:203], v[56:59]
    s_barrier
    ds_read_b128 v[92:95], v2 offset:0
    v_add_f32 v16, v16, v152
    s_add_u32 s25, s24, 78848
    buffer_load_dwordx4 v[248:251], v19, s[64:67], s25 offen
    s_waitcnt lgkmcnt(3)
    v_mfma_f32_16x16x32_bf16 v[60:63], v[104:107], v[196:199], v[60:63]
    v_add_f32 v16, v16, v153
    v_mfma_f32_16x16x32_bf16 v[64:67], v[104:107], v[200:203], v[64:67]
    ds_read_b128 v[96:99], v2 offset:1024
    v_cvt_pk_bf16_f32 v194, v152, v153
    s_waitcnt lgkmcnt(3)
    v_mfma_f32_16x16x32_bf16 v[68:71], v[84:87], v[196:199], v[68:71]
    v_exp_f32 v154, v154
    v_exp_f32 v155, v155
    v_mfma_f32_16x16x32_bf16 v[72:75], v[84:87], v[200:203], v[72:75]
    ds_read_b128 v[100:103], v2 offset:2048
    v_add_f32 v16, v16, v154
    s_waitcnt lgkmcnt(3)
    v_mfma_f32_16x16x32_bf16 v[76:79], v[88:91], v[196:199], v[76:79]
    v_add_f32 v16, v16, v155
    v_mfma_f32_16x16x32_bf16 v[80:83], v[88:91], v[200:203], v[80:83]
    ds_read_b128 v[104:107], v2 offset:3072
    v_cvt_pk_bf16_f32 v195, v154, v155
    s_waitcnt lgkmcnt(3)
    v_mfma_f32_16x16x32_bf16 v[140:143], v[92:95], v[108:111], v[172:175]
    v_exp_f32 v156, v156
    v_exp_f32 v157, v157
    v_mfma_f32_16x16x32_bf16 v[144:147], v[92:95], v[124:127], v[176:179]
    ds_read_b128 v[84:87], v2 offset:4096
    v_add_f32 v15, v15, v156
    s_add_u32 s25, s24, 86016
    buffer_load_dwordx4 v[252:255], v19, s[64:67], s25 offen
    s_waitcnt lgkmcnt(3)
    v_mfma_f32_16x16x32_bf16 v[148:151], v[96:99], v[108:111], v[172:175]
    v_add_f32 v15, v15, v157
    v_mfma_f32_16x16x32_bf16 v[152:155], v[96:99], v[124:127], v[176:179]
    ds_read_b128 v[88:91], v2 offset:5120
    v_cvt_pk_bf16_f32 v196, v156, v157
    s_waitcnt lgkmcnt(3)
    v_mfma_f32_16x16x32_bf16 v[140:143], v[100:103], v[112:115], v[140:143]
    v_exp_f32 v158, v158
    v_exp_f32 v159, v159
    v_mfma_f32_16x16x32_bf16 v[144:147], v[100:103], v[128:131], v[144:147]
    ds_read_b128 v[92:95], v2 offset:6144
    v_add_f32 v15, v15, v158
    s_waitcnt lgkmcnt(3)
    v_mfma_f32_16x16x32_bf16 v[148:151], v[104:107], v[112:115], v[148:151]
    v_add_f32 v15, v15, v159
    v_mfma_f32_16x16x32_bf16 v[152:155], v[104:107], v[128:131], v[152:155]
    ds_read_b128 v[96:99], v2 offset:7168
    v_cvt_pk_bf16_f32 v197, v158, v159
    s_waitcnt lgkmcnt(3)
    v_mfma_f32_16x16x32_bf16 v[140:143], v[84:87], v[116:119], v[140:143]
    v_exp_f32 v160, v160
    v_exp_f32 v161, v161
    v_mfma_f32_16x16x32_bf16 v[144:147], v[84:87], v[132:135], v[144:147]
    ds_read_b128 v[100:103], v3 offset:8192
    v_add_f32 v16, v16, v160
    s_waitcnt lgkmcnt(3)
    v_mfma_f32_16x16x32_bf16 v[148:151], v[88:91], v[116:119], v[148:151]
    v_add_f32 v16, v16, v161
    v_mfma_f32_16x16x32_bf16 v[152:155], v[88:91], v[132:135], v[152:155]
    ds_read_b128 v[104:107], v3 offset:9216
    v_cvt_pk_bf16_f32 v200, v160, v161
    s_add_u32 s25, s24, 93184
    buffer_load_dwordx4 v[180:183], v19, s[64:67], s25 offen
    s_waitcnt lgkmcnt(3)
    v_mfma_f32_16x16x32_bf16 v[140:143], v[92:95], v[120:123], v[140:143]
    v_exp_f32 v162, v162
    v_exp_f32 v163, v163
    v_mfma_f32_16x16x32_bf16 v[144:147], v[92:95], v[136:139], v[144:147]
    ds_read_b128 v[84:87], v3 offset:10240
    v_add_f32 v16, v16, v162
    s_waitcnt lgkmcnt(3)
    v_mfma_f32_16x16x32_bf16 v[148:151], v[96:99], v[120:123], v[148:151]
    v_add_f32 v16, v16, v163
    v_mfma_f32_16x16x32_bf16 v[152:155], v[96:99], v[136:139], v[152:155]
    ds_read_b128 v[88:91], v3 offset:11264
    v_cvt_pk_bf16_f32 v201, v162, v163
    s_waitcnt lgkmcnt(3)
    v_mfma_f32_16x16x32_bf16 v[20:23], v[100:103], v[188:191], v[20:23]
    v_exp_f32 v164, v164
    v_exp_f32 v165, v165
    v_mfma_f32_16x16x32_bf16 v[24:27], v[100:103], v[192:195], v[24:27]
    ds_read_b128 v[92:95], v3 offset:12288
    v_add_f32 v15, v15, v164
    s_waitcnt lgkmcnt(3)
    v_mfma_f32_16x16x32_bf16 v[28:31], v[104:107], v[188:191], v[28:31]
    v_add_f32 v15, v15, v165
    v_mfma_f32_16x16x32_bf16 v[32:35], v[104:107], v[192:195], v[32:35]
    ds_read_b128 v[96:99], v3 offset:13312
    v_cvt_pk_bf16_f32 v198, v164, v165
    s_add_u32 s25, s24, 100352
    buffer_load_dwordx4 v[184:187], v19, s[64:67], s25 offen
    s_waitcnt lgkmcnt(3)
    v_mfma_f32_16x16x32_bf16 v[36:39], v[84:87], v[188:191], v[36:39]
    v_exp_f32 v166, v166
    v_exp_f32 v167, v167
    v_mfma_f32_16x16x32_bf16 v[40:43], v[84:87], v[192:195], v[40:43]
    ds_read_b128 v[100:103], v3 offset:14336
    v_add_f32 v15, v15, v166
    s_waitcnt lgkmcnt(3)
    v_mfma_f32_16x16x32_bf16 v[44:47], v[88:91], v[188:191], v[44:47]
    v_add_f32 v15, v15, v167
    v_mfma_f32_16x16x32_bf16 v[48:51], v[88:91], v[192:195], v[48:51]
    ds_read_b128 v[104:107], v3 offset:15360
    v_cvt_pk_bf16_f32 v199, v166, v167
    s_waitcnt lgkmcnt(3)
    v_mfma_f32_16x16x32_bf16 v[52:55], v[92:95], v[188:191], v[52:55]
    v_exp_f32 v168, v168
    v_exp_f32 v169, v169
    v_mfma_f32_16x16x32_bf16 v[56:59], v[92:95], v[192:195], v[56:59]
    s_barrier
    ds_read_b128 v[84:87], v2 offset:16384
    v_add_f32 v16, v16, v168
    s_waitcnt lgkmcnt(3)
    v_mfma_f32_16x16x32_bf16 v[60:63], v[96:99], v[188:191], v[60:63]
    v_add_f32 v16, v16, v169
    v_mfma_f32_16x16x32_bf16 v[64:67], v[96:99], v[192:195], v[64:67]
    ds_read_b128 v[88:91], v2 offset:17408
    v_cvt_pk_bf16_f32 v202, v168, v169
    s_waitcnt lgkmcnt(3)
    v_mfma_f32_16x16x32_bf16 v[68:71], v[100:103], v[188:191], v[68:71]
    v_exp_f32 v170, v170
    v_exp_f32 v171, v171
    v_mfma_f32_16x16x32_bf16 v[72:75], v[100:103], v[192:195], v[72:75]
    ds_read_b128 v[92:95], v2 offset:18432
    v_add_f32 v16, v16, v170
    s_waitcnt lgkmcnt(3)
    v_mfma_f32_16x16x32_bf16 v[76:79], v[104:107], v[188:191], v[76:79]
    v_add_f32 v16, v16, v171
    v_mfma_f32_16x16x32_bf16 v[80:83], v[104:107], v[192:195], v[80:83]
    ds_read_b128 v[96:99], v2 offset:19456
    v_cvt_pk_bf16_f32 v203, v170, v171
    s_waitcnt lgkmcnt(3)
    v_mfma_f32_16x16x32_bf16 v[156:159], v[84:87], v[108:111], v[172:175]
    v_exp_f32 v140, v140
    v_exp_f32 v141, v141
    v_mfma_f32_16x16x32_bf16 v[160:163], v[84:87], v[124:127], v[176:179]
    ds_read_b128 v[100:103], v2 offset:20480
    v_add_f32 v15, v15, v140
    s_waitcnt lgkmcnt(3)
    v_mfma_f32_16x16x32_bf16 v[164:167], v[88:91], v[108:111], v[172:175]
    v_add_f32 v15, v15, v141
    v_mfma_f32_16x16x32_bf16 v[168:171], v[88:91], v[124:127], v[176:179]
    ds_read_b128 v[104:107], v2 offset:21504
    v_cvt_pk_bf16_f32 v188, v140, v141
    s_waitcnt lgkmcnt(3)
    v_mfma_f32_16x16x32_bf16 v[156:159], v[92:95], v[112:115], v[156:159]
    v_exp_f32 v142, v142
    v_exp_f32 v143, v143
    v_mfma_f32_16x16x32_bf16 v[160:163], v[92:95], v[128:131], v[160:163]
    ds_read_b128 v[84:87], v2 offset:22528
    v_add_f32 v15, v15, v142
    s_waitcnt lgkmcnt(3)
    v_mfma_f32_16x16x32_bf16 v[164:167], v[96:99], v[112:115], v[164:167]
    v_add_f32 v15, v15, v143
    v_mfma_f32_16x16x32_bf16 v[168:171], v[96:99], v[128:131], v[168:171]
    ds_read_b128 v[88:91], v2 offset:23552
    v_cvt_pk_bf16_f32 v189, v142, v143
    s_waitcnt lgkmcnt(3)
    v_mfma_f32_16x16x32_bf16 v[156:159], v[100:103], v[116:119], v[156:159]
    v_exp_f32 v144, v144
    v_exp_f32 v145, v145
    v_mfma_f32_16x16x32_bf16 v[160:163], v[100:103], v[132:135], v[160:163]
    ds_read_b128 v[92:95], v3 offset:24576
    v_add_f32 v16, v16, v144
    s_waitcnt lgkmcnt(3)
    v_mfma_f32_16x16x32_bf16 v[164:167], v[104:107], v[116:119], v[164:167]
    v_add_f32 v16, v16, v145
    v_mfma_f32_16x16x32_bf16 v[168:171], v[104:107], v[132:135], v[168:171]
    ds_read_b128 v[96:99], v3 offset:25600
    v_cvt_pk_bf16_f32 v192, v144, v145
    s_waitcnt lgkmcnt(3)
    v_mfma_f32_16x16x32_bf16 v[156:159], v[84:87], v[120:123], v[156:159]
    v_exp_f32 v146, v146
    v_exp_f32 v147, v147
    v_mfma_f32_16x16x32_bf16 v[160:163], v[84:87], v[136:139], v[160:163]
    ds_read_b128 v[100:103], v3 offset:26624
    v_add_f32 v16, v16, v146
    s_waitcnt lgkmcnt(3)
    v_mfma_f32_16x16x32_bf16 v[164:167], v[88:91], v[120:123], v[164:167]
    v_add_f32 v16, v16, v147
    v_mfma_f32_16x16x32_bf16 v[168:171], v[88:91], v[136:139], v[168:171]
    ds_read_b128 v[104:107], v3 offset:27648
    v_cvt_pk_bf16_f32 v193, v146, v147
    s_waitcnt lgkmcnt(3)
    v_mfma_f32_16x16x32_bf16 v[20:23], v[92:95], v[196:199], v[20:23]
    v_exp_f32 v148, v148
    v_exp_f32 v149, v149
    v_mfma_f32_16x16x32_bf16 v[24:27], v[92:95], v[200:203], v[24:27]
    ds_read_b128 v[84:87], v3 offset:28672
    v_add_f32 v15, v15, v148
    s_waitcnt lgkmcnt(3)
    v_mfma_f32_16x16x32_bf16 v[28:31], v[96:99], v[196:199], v[28:31]
    v_add_f32 v15, v15, v149
    v_mfma_f32_16x16x32_bf16 v[32:35], v[96:99], v[200:203], v[32:35]
    ds_read_b128 v[88:91], v3 offset:29696
    v_cvt_pk_bf16_f32 v190, v148, v149
    s_waitcnt lgkmcnt(3)
    v_mfma_f32_16x16x32_bf16 v[36:39], v[100:103], v[196:199], v[36:39]
    v_exp_f32 v150, v150
    v_exp_f32 v151, v151
    v_mfma_f32_16x16x32_bf16 v[40:43], v[100:103], v[200:203], v[40:43]
    ds_read_b128 v[92:95], v3 offset:30720
    v_add_f32 v15, v15, v150
    s_waitcnt lgkmcnt(3)
    v_mfma_f32_16x16x32_bf16 v[44:47], v[104:107], v[196:199], v[44:47]
    v_add_f32 v15, v15, v151
    v_mfma_f32_16x16x32_bf16 v[48:51], v[104:107], v[200:203], v[48:51]
    ds_read_b128 v[96:99], v3 offset:31744
    v_cvt_pk_bf16_f32 v191, v150, v151
    s_waitcnt lgkmcnt(3)
    v_mfma_f32_16x16x32_bf16 v[52:55], v[84:87], v[196:199], v[52:55]
    v_exp_f32 v152, v152
    v_exp_f32 v153, v153
    v_mfma_f32_16x16x32_bf16 v[56:59], v[84:87], v[200:203], v[56:59]
    s_barrier
    ds_read_b128 v[100:103], v2 offset:32768
    v_add_f32 v16, v16, v152
    s_waitcnt lgkmcnt(3)
    v_mfma_f32_16x16x32_bf16 v[60:63], v[88:91], v[196:199], v[60:63]
    v_add_f32 v16, v16, v153
    v_mfma_f32_16x16x32_bf16 v[64:67], v[88:91], v[200:203], v[64:67]
    ds_read_b128 v[104:107], v2 offset:33792
    v_cvt_pk_bf16_f32 v194, v152, v153
    s_waitcnt lgkmcnt(3)
    v_mfma_f32_16x16x32_bf16 v[68:71], v[92:95], v[196:199], v[68:71]
    v_exp_f32 v154, v154
    v_exp_f32 v155, v155
    v_mfma_f32_16x16x32_bf16 v[72:75], v[92:95], v[200:203], v[72:75]
    ds_read_b128 v[84:87], v2 offset:34816
    v_add_f32 v16, v16, v154
    s_waitcnt lgkmcnt(3)
    v_mfma_f32_16x16x32_bf16 v[76:79], v[96:99], v[196:199], v[76:79]
    v_add_f32 v16, v16, v155
    v_mfma_f32_16x16x32_bf16 v[80:83], v[96:99], v[200:203], v[80:83]
    ds_read_b128 v[88:91], v2 offset:35840
    v_cvt_pk_bf16_f32 v195, v154, v155
    s_waitcnt lgkmcnt(3)
    v_mfma_f32_16x16x32_bf16 v[140:143], v[100:103], v[108:111], v[172:175]
    v_exp_f32 v156, v156
    v_exp_f32 v157, v157
    v_mfma_f32_16x16x32_bf16 v[144:147], v[100:103], v[124:127], v[176:179]
    ds_read_b128 v[92:95], v2 offset:36864
    v_add_f32 v15, v15, v156
    s_waitcnt lgkmcnt(3)
    v_mfma_f32_16x16x32_bf16 v[148:151], v[104:107], v[108:111], v[172:175]
    v_add_f32 v15, v15, v157
    v_mfma_f32_16x16x32_bf16 v[152:155], v[104:107], v[124:127], v[176:179]
    ds_read_b128 v[96:99], v2 offset:37888
    v_cvt_pk_bf16_f32 v196, v156, v157
    s_waitcnt lgkmcnt(3)
    v_mfma_f32_16x16x32_bf16 v[140:143], v[84:87], v[112:115], v[140:143]
    v_exp_f32 v158, v158
    v_exp_f32 v159, v159
    v_mfma_f32_16x16x32_bf16 v[144:147], v[84:87], v[128:131], v[144:147]
    ds_read_b128 v[100:103], v2 offset:38912
    v_add_f32 v15, v15, v158
    s_waitcnt lgkmcnt(3)
    v_mfma_f32_16x16x32_bf16 v[148:151], v[88:91], v[112:115], v[148:151]
    v_add_f32 v15, v15, v159
    v_mfma_f32_16x16x32_bf16 v[152:155], v[88:91], v[128:131], v[152:155]
    ds_read_b128 v[104:107], v2 offset:39936
    v_cvt_pk_bf16_f32 v197, v158, v159
    s_waitcnt lgkmcnt(3)
    v_mfma_f32_16x16x32_bf16 v[140:143], v[92:95], v[116:119], v[140:143]
    v_exp_f32 v160, v160
    v_exp_f32 v161, v161
    v_mfma_f32_16x16x32_bf16 v[144:147], v[92:95], v[132:135], v[144:147]
    ds_read_b128 v[84:87], v2 offset:8192
    v_add_f32 v16, v16, v160
    s_waitcnt lgkmcnt(3)
    v_mfma_f32_16x16x32_bf16 v[148:151], v[96:99], v[116:119], v[148:151]
    v_add_f32 v16, v16, v161
    v_mfma_f32_16x16x32_bf16 v[152:155], v[96:99], v[132:135], v[152:155]
    ds_read_b128 v[88:91], v2 offset:9216
    v_cvt_pk_bf16_f32 v200, v160, v161
    s_waitcnt lgkmcnt(3)
    v_mfma_f32_16x16x32_bf16 v[140:143], v[100:103], v[120:123], v[140:143]
    v_exp_f32 v162, v162
    v_exp_f32 v163, v163
    v_mfma_f32_16x16x32_bf16 v[144:147], v[100:103], v[136:139], v[144:147]
    ds_read_b128 v[92:95], v2 offset:10240
    v_add_f32 v16, v16, v162
    s_waitcnt lgkmcnt(3)
    v_mfma_f32_16x16x32_bf16 v[148:151], v[104:107], v[120:123], v[148:151]
    v_add_f32 v16, v16, v163
    v_mfma_f32_16x16x32_bf16 v[152:155], v[104:107], v[136:139], v[152:155]
    ds_read_b128 v[96:99], v2 offset:11264
    v_cvt_pk_bf16_f32 v201, v162, v163
    s_waitcnt lgkmcnt(3)
    v_mfma_f32_16x16x32_bf16 v[20:23], v[84:87], v[188:191], v[20:23]
    v_exp_f32 v164, v164
    v_exp_f32 v165, v165
    v_mfma_f32_16x16x32_bf16 v[24:27], v[84:87], v[192:195], v[24:27]
    ds_read_b128 v[100:103], v2 offset:12288
    v_add_f32 v15, v15, v164
    s_waitcnt lgkmcnt(3)
    v_mfma_f32_16x16x32_bf16 v[28:31], v[88:91], v[188:191], v[28:31]
    v_add_f32 v15, v15, v165
    v_mfma_f32_16x16x32_bf16 v[32:35], v[88:91], v[192:195], v[32:35]
    ds_read_b128 v[104:107], v2 offset:13312
    v_cvt_pk_bf16_f32 v198, v164, v165
    s_waitcnt lgkmcnt(3)
    v_mfma_f32_16x16x32_bf16 v[36:39], v[92:95], v[188:191], v[36:39]
    v_exp_f32 v166, v166
    v_exp_f32 v167, v167
    v_mfma_f32_16x16x32_bf16 v[40:43], v[92:95], v[192:195], v[40:43]
    ds_read_b128 v[84:87], v2 offset:14336
    v_add_f32 v15, v15, v166
    s_waitcnt lgkmcnt(3)
    v_mfma_f32_16x16x32_bf16 v[44:47], v[96:99], v[188:191], v[44:47]
    v_add_f32 v15, v15, v167
    v_mfma_f32_16x16x32_bf16 v[48:51], v[96:99], v[192:195], v[48:51]
    ds_read_b128 v[88:91], v2 offset:15360
    v_cvt_pk_bf16_f32 v199, v166, v167
    s_waitcnt lgkmcnt(3)
    v_mfma_f32_16x16x32_bf16 v[52:55], v[100:103], v[188:191], v[52:55]
    v_exp_f32 v168, v168
    v_exp_f32 v169, v169
    v_mfma_f32_16x16x32_bf16 v[56:59], v[100:103], v[192:195], v[56:59]
    s_barrier
    ds_read_b128 v[92:95], v2 offset:49152
    v_add_f32 v16, v16, v168
    s_waitcnt lgkmcnt(3)
    v_mfma_f32_16x16x32_bf16 v[60:63], v[104:107], v[188:191], v[60:63]
    v_add_f32 v16, v16, v169
    v_mfma_f32_16x16x32_bf16 v[64:67], v[104:107], v[192:195], v[64:67]
    ds_read_b128 v[96:99], v2 offset:50176
    v_cvt_pk_bf16_f32 v202, v168, v169
    s_waitcnt lgkmcnt(3)
    v_mfma_f32_16x16x32_bf16 v[68:71], v[84:87], v[188:191], v[68:71]
    v_exp_f32 v170, v170
    v_exp_f32 v171, v171
    v_mfma_f32_16x16x32_bf16 v[72:75], v[84:87], v[192:195], v[72:75]
    ds_read_b128 v[100:103], v2 offset:51200
    v_add_f32 v16, v16, v170
    s_waitcnt lgkmcnt(3)
    v_mfma_f32_16x16x32_bf16 v[76:79], v[88:91], v[188:191], v[76:79]
    v_add_f32 v16, v16, v171
    v_mfma_f32_16x16x32_bf16 v[80:83], v[88:91], v[192:195], v[80:83]
    ds_read_b128 v[104:107], v2 offset:52224
    v_cvt_pk_bf16_f32 v203, v170, v171
    s_waitcnt lgkmcnt(3)
    v_mfma_f32_16x16x32_bf16 v[156:159], v[92:95], v[108:111], v[172:175]
    v_exp_f32 v140, v140
    v_exp_f32 v141, v141
    v_mfma_f32_16x16x32_bf16 v[160:163], v[92:95], v[124:127], v[176:179]
    ds_read_b128 v[84:87], v2 offset:53248
    v_add_f32 v15, v15, v140
    s_waitcnt lgkmcnt(3)
    v_mfma_f32_16x16x32_bf16 v[164:167], v[96:99], v[108:111], v[172:175]
    v_add_f32 v15, v15, v141
    v_mfma_f32_16x16x32_bf16 v[168:171], v[96:99], v[124:127], v[176:179]
    ds_read_b128 v[88:91], v2 offset:54272
    v_cvt_pk_bf16_f32 v188, v140, v141
    s_waitcnt lgkmcnt(3)
    v_mfma_f32_16x16x32_bf16 v[156:159], v[100:103], v[112:115], v[156:159]
    v_exp_f32 v142, v142
    v_exp_f32 v143, v143
    v_mfma_f32_16x16x32_bf16 v[160:163], v[100:103], v[128:131], v[160:163]
    ds_read_b128 v[92:95], v2 offset:55296
    v_add_f32 v15, v15, v142
    s_waitcnt lgkmcnt(3)
    v_mfma_f32_16x16x32_bf16 v[164:167], v[104:107], v[112:115], v[164:167]
    v_add_f32 v15, v15, v143
    v_mfma_f32_16x16x32_bf16 v[168:171], v[104:107], v[128:131], v[168:171]
    ds_read_b128 v[96:99], v2 offset:56320
    v_cvt_pk_bf16_f32 v189, v142, v143
    s_waitcnt lgkmcnt(3)
    v_mfma_f32_16x16x32_bf16 v[156:159], v[84:87], v[116:119], v[156:159]
    v_exp_f32 v144, v144
    v_exp_f32 v145, v145
    v_mfma_f32_16x16x32_bf16 v[160:163], v[84:87], v[132:135], v[160:163]
    ds_read_b128 v[100:103], v2 offset:24576
    v_add_f32 v16, v16, v144
    s_waitcnt lgkmcnt(3)
    v_mfma_f32_16x16x32_bf16 v[164:167], v[88:91], v[116:119], v[164:167]
    v_add_f32 v16, v16, v145
    v_mfma_f32_16x16x32_bf16 v[168:171], v[88:91], v[132:135], v[168:171]
    ds_read_b128 v[104:107], v2 offset:25600
    v_cvt_pk_bf16_f32 v192, v144, v145
    s_waitcnt lgkmcnt(3)
    v_mfma_f32_16x16x32_bf16 v[156:159], v[92:95], v[120:123], v[156:159]
    v_exp_f32 v146, v146
    v_exp_f32 v147, v147
    v_mfma_f32_16x16x32_bf16 v[160:163], v[92:95], v[136:139], v[160:163]
    ds_read_b128 v[84:87], v2 offset:26624
    v_add_f32 v16, v16, v146
    s_waitcnt lgkmcnt(3)
    v_mfma_f32_16x16x32_bf16 v[164:167], v[96:99], v[120:123], v[164:167]
    v_add_f32 v16, v16, v147
    v_mfma_f32_16x16x32_bf16 v[168:171], v[96:99], v[136:139], v[168:171]
    ds_read_b128 v[88:91], v2 offset:27648
    v_cvt_pk_bf16_f32 v193, v146, v147
    s_waitcnt lgkmcnt(3)
    v_mfma_f32_16x16x32_bf16 v[20:23], v[100:103], v[196:199], v[20:23]
    v_exp_f32 v148, v148
    v_exp_f32 v149, v149
    v_mfma_f32_16x16x32_bf16 v[24:27], v[100:103], v[200:203], v[24:27]
    ds_read_b128 v[92:95], v2 offset:28672
    v_add_f32 v15, v15, v148
    s_waitcnt lgkmcnt(3)
    v_mfma_f32_16x16x32_bf16 v[28:31], v[104:107], v[196:199], v[28:31]
    v_add_f32 v15, v15, v149
    v_mfma_f32_16x16x32_bf16 v[32:35], v[104:107], v[200:203], v[32:35]
    ds_read_b128 v[96:99], v2 offset:29696
    v_cvt_pk_bf16_f32 v190, v148, v149
    s_waitcnt lgkmcnt(3)
    v_mfma_f32_16x16x32_bf16 v[36:39], v[84:87], v[196:199], v[36:39]
    v_exp_f32 v150, v150
    v_exp_f32 v151, v151
    v_mfma_f32_16x16x32_bf16 v[40:43], v[84:87], v[200:203], v[40:43]
    ds_read_b128 v[100:103], v2 offset:30720
    v_add_f32 v15, v15, v150
    s_waitcnt lgkmcnt(3)
    v_mfma_f32_16x16x32_bf16 v[44:47], v[88:91], v[196:199], v[44:47]
    v_add_f32 v15, v15, v151
    v_mfma_f32_16x16x32_bf16 v[48:51], v[88:91], v[200:203], v[48:51]
    ds_read_b128 v[104:107], v2 offset:31744
    v_cvt_pk_bf16_f32 v191, v150, v151
    s_waitcnt lgkmcnt(3)
    v_mfma_f32_16x16x32_bf16 v[52:55], v[92:95], v[196:199], v[52:55]
    v_exp_f32 v152, v152
    v_exp_f32 v153, v153
    v_mfma_f32_16x16x32_bf16 v[56:59], v[92:95], v[200:203], v[56:59]
    ds_read_b128 v[84:87], v2 offset:40960
    v_add_f32 v16, v16, v152
    s_waitcnt lgkmcnt(3)
    v_mfma_f32_16x16x32_bf16 v[60:63], v[96:99], v[196:199], v[60:63]
    v_add_f32 v16, v16, v153
    v_mfma_f32_16x16x32_bf16 v[64:67], v[96:99], v[200:203], v[64:67]
    ds_read_b128 v[88:91], v2 offset:41984
    v_cvt_pk_bf16_f32 v194, v152, v153
    s_waitcnt lgkmcnt(3)
    v_mfma_f32_16x16x32_bf16 v[68:71], v[100:103], v[196:199], v[68:71]
    v_exp_f32 v154, v154
    v_exp_f32 v155, v155
    v_mfma_f32_16x16x32_bf16 v[72:75], v[100:103], v[200:203], v[72:75]
    ds_read_b128 v[92:95], v2 offset:43008
    v_add_f32 v16, v16, v154
    s_waitcnt lgkmcnt(3)
    v_mfma_f32_16x16x32_bf16 v[76:79], v[104:107], v[196:199], v[76:79]
    v_add_f32 v16, v16, v155
    v_mfma_f32_16x16x32_bf16 v[80:83], v[104:107], v[200:203], v[80:83]
    ds_read_b128 v[96:99], v2 offset:44032
    v_cvt_pk_bf16_f32 v195, v154, v155
    s_waitcnt lgkmcnt(3)
    v_mfma_f32_16x16x32_bf16 v[20:23], v[84:87], v[188:191], v[20:23]
    v_exp_f32 v156, v156
    v_exp_f32 v157, v157
    v_add_f32 v15, v15, v156
    v_mfma_f32_16x16x32_bf16 v[24:27], v[84:87], v[192:195], v[24:27]
    ds_read_b128 v[100:103], v2 offset:45056
    v_add_f32 v15, v15, v157
    v_cvt_pk_bf16_f32 v196, v156, v157
    s_waitcnt lgkmcnt(3)
    v_mfma_f32_16x16x32_bf16 v[28:31], v[88:91], v[188:191], v[28:31]
    v_exp_f32 v158, v158
    v_exp_f32 v159, v159
    v_add_f32 v15, v15, v158
    v_mfma_f32_16x16x32_bf16 v[32:35], v[88:91], v[192:195], v[32:35]
    ds_read_b128 v[104:107], v2 offset:46080
    v_add_f32 v15, v15, v159
    v_cvt_pk_bf16_f32 v197, v158, v159
    s_waitcnt lgkmcnt(3)
    v_mfma_f32_16x16x32_bf16 v[36:39], v[92:95], v[188:191], v[36:39]
    v_exp_f32 v160, v160
    v_exp_f32 v161, v161
    v_add_f32 v16, v16, v160
    v_mfma_f32_16x16x32_bf16 v[40:43], v[92:95], v[192:195], v[40:43]
    ds_read_b128 v[84:87], v2 offset:47104
    v_add_f32 v16, v16, v161
    v_cvt_pk_bf16_f32 v200, v160, v161
    s_waitcnt lgkmcnt(3)
    v_mfma_f32_16x16x32_bf16 v[44:47], v[96:99], v[188:191], v[44:47]
    v_exp_f32 v162, v162
    v_exp_f32 v163, v163
    v_add_f32 v16, v16, v162
    v_mfma_f32_16x16x32_bf16 v[48:51], v[96:99], v[192:195], v[48:51]
    ds_read_b128 v[88:91], v2 offset:48128
    v_add_f32 v16, v16, v163
    v_cvt_pk_bf16_f32 v201, v162, v163
    s_waitcnt lgkmcnt(3)
    v_mfma_f32_16x16x32_bf16 v[52:55], v[100:103], v[188:191], v[52:55]
    v_exp_f32 v164, v164
    v_exp_f32 v165, v165
    v_add_f32 v15, v15, v164
    v_mfma_f32_16x16x32_bf16 v[56:59], v[100:103], v[192:195], v[56:59]
    ds_read_b128 v[92:95], v2 offset:57344
    v_add_f32 v15, v15, v165
    v_cvt_pk_bf16_f32 v198, v164, v165
    s_waitcnt lgkmcnt(3)
    v_mfma_f32_16x16x32_bf16 v[60:63], v[104:107], v[188:191], v[60:63]
    v_exp_f32 v166, v166
    v_exp_f32 v167, v167
    v_add_f32 v15, v15, v166
    v_mfma_f32_16x16x32_bf16 v[64:67], v[104:107], v[192:195], v[64:67]
    ds_read_b128 v[96:99], v2 offset:58368
    v_add_f32 v15, v15, v167
    v_cvt_pk_bf16_f32 v199, v166, v167
    s_waitcnt lgkmcnt(3)
    v_mfma_f32_16x16x32_bf16 v[68:71], v[84:87], v[188:191], v[68:71]
    v_exp_f32 v168, v168
    v_exp_f32 v169, v169
    v_add_f32 v16, v16, v168
    v_mfma_f32_16x16x32_bf16 v[72:75], v[84:87], v[192:195], v[72:75]
    ds_read_b128 v[100:103], v2 offset:59392
    v_add_f32 v16, v16, v169
    v_cvt_pk_bf16_f32 v202, v168, v169
    s_waitcnt lgkmcnt(3)
    v_mfma_f32_16x16x32_bf16 v[76:79], v[88:91], v[188:191], v[76:79]
    v_exp_f32 v170, v170
    v_exp_f32 v171, v171
    v_add_f32 v16, v16, v170
    v_mfma_f32_16x16x32_bf16 v[80:83], v[88:91], v[192:195], v[80:83]
    ds_read_b128 v[104:107], v2 offset:60416
    v_add_f32 v16, v16, v171
    v_cvt_pk_bf16_f32 v203, v170, v171
    s_waitcnt lgkmcnt(3)
    v_mfma_f32_16x16x32_bf16 v[20:23], v[92:95], v[196:199], v[20:23]
    v_mfma_f32_16x16x32_bf16 v[24:27], v[92:95], v[200:203], v[24:27]
    ds_read_b128 v[84:87], v2 offset:61440
    s_waitcnt lgkmcnt(3)
    v_mfma_f32_16x16x32_bf16 v[28:31], v[96:99], v[196:199], v[28:31]
    v_mfma_f32_16x16x32_bf16 v[32:35], v[96:99], v[200:203], v[32:35]
    ds_read_b128 v[88:91], v2 offset:62464
    s_waitcnt lgkmcnt(3)
    v_mfma_f32_16x16x32_bf16 v[36:39], v[100:103], v[196:199], v[36:39]
    v_mfma_f32_16x16x32_bf16 v[40:43], v[100:103], v[200:203], v[40:43]
    ds_read_b128 v[92:95], v2 offset:63488
    s_waitcnt lgkmcnt(3)
    v_mfma_f32_16x16x32_bf16 v[44:47], v[104:107], v[196:199], v[44:47]
    v_mfma_f32_16x16x32_bf16 v[48:51], v[104:107], v[200:203], v[48:51]
    ds_read_b128 v[96:99], v2 offset:64512
    s_waitcnt lgkmcnt(3)
    v_mfma_f32_16x16x32_bf16 v[52:55], v[84:87], v[196:199], v[52:55]
    v_mfma_f32_16x16x32_bf16 v[56:59], v[84:87], v[200:203], v[56:59]
    s_waitcnt lgkmcnt(2)
    v_mfma_f32_16x16x32_bf16 v[60:63], v[88:91], v[196:199], v[60:63]
    v_mfma_f32_16x16x32_bf16 v[64:67], v[88:91], v[200:203], v[64:67]
    s_waitcnt lgkmcnt(1)
    v_mfma_f32_16x16x32_bf16 v[68:71], v[92:95], v[196:199], v[68:71]
    v_mfma_f32_16x16x32_bf16 v[72:75], v[92:95], v[200:203], v[72:75]
    s_waitcnt lgkmcnt(0)
    v_mfma_f32_16x16x32_bf16 v[76:79], v[96:99], v[196:199], v[76:79]
    v_mfma_f32_16x16x32_bf16 v[80:83], v[96:99], v[200:203], v[80:83]
fz_chk:
    s_setprio 0
    v_mov_b32 v9, v15
    v_mov_b32 v11, v16
    s_nop 0
    v_permlane16_swap_b32 v15, v9
    v_permlane16_swap_b32 v16, v11
    v_add_f32 v15, v15, v9
    v_add_f32 v16, v16, v11
    v_mov_b32 v9, v15
    v_mov_b32 v11, v16
    s_nop 0
    v_permlane32_swap_b32 v15, v9
    v_permlane32_swap_b32 v16, v11
    v_add_f32 v15, v15, v9
    v_add_f32 v16, v16, v11
    v_max3_f32 v10, |v20|, |v21|, v15
    v_max3_f32 v12, |v22|, |v23|, v16
    v_max3_f32 v10, |v24|, |v25|, v10
    v_max3_f32 v12, |v26|, |v27|, v12
    v_max3_f32 v10, |v28|, |v29|, v10
    v_max3_f32 v12, |v30|, |v31|, v12
    v_max3_f32 v10, |v32|, |v33|, v10
    v_max3_f32 v12, |v34|, |v35|, v12
    v_max3_f32 v10, |v36|, |v37|, v10
    v_max3_f32 v12, |v38|, |v39|, v12
    v_max3_f32 v10, |v40|, |v41|, v10
    v_max3_f32 v12, |v42|, |v43|, v12
    v_max3_f32 v10, |v44|, |v45|, v10
    v_max3_f32 v12, |v46|, |v47|, v12
    v_max3_f32 v10, |v48|, |v49|, v10
    v_max3_f32 v12, |v50|, |v51|, v12
    v_max3_f32 v10, |v52|, |v53|, v10
    v_max3_f32 v12, |v54|, |v55|, v12
    v_max3_f32 v10, |v56|, |v57|, v10
    v_max3_f32 v12, |v58|, |v59|, v12
    v_max3_f32 v10, |v60|, |v61|, v10
    v_max3_f32 v12, |v62|, |v63|, v12
    v_max3_f32 v10, |v64|, |v65|, v10
    v_max3_f32 v12, |v66|, |v67|, v12
    v_max3_f32 v10, |v68|, |v69|, v10
    v_max3_f32 v12, |v70|, |v71|, v12
    v_max3_f32 v10, |v72|, |v73|, v10
    v_max3_f32 v12, |v74|, |v75|, v12
    v_max3_f32 v10, |v76|, |v77|, v10
    v_max3_f32 v12, |v78|, |v79|, v12
    v_max3_f32 v10, |v80|, |v81|, v10
    v_max3_f32 v12, |v82|, |v83|, v12
    v_max_f32 v10, v10, v12
    s_mov_b32 s26, 0x7b800000
    v_cmp_ngt_f32 vcc, s26, v10
    v_cmp_u_f32 s[26:27], v15, v16
    s_or_b64 vcc, vcc, s[26:27]
    s_cbranch_vccnz fz_slow
fz_epi:
    s_cmp_lt_u32 s3, 4
    s_cbranch_scc1 fz_nw15
    s_add_u32 s25, s24, 107520
    buffer_load_dwordx4 v[172:175], v19, s[64:67], s25 offen
fz_nw15:
    v_rcp_f32 v9, v15
    v_rcp_f32 v11, v16
    s_lshl_b32 s19, s13, 3
    s_add_u32 s19, s19, s3
    s_mul_i32 s20, s19, 262144
    s_lshl_b32 s25, s12, 12
    s_add_u32 s20, s20, s25
    s_add_u32 s20, s20, 0x1000000
    s_add_u32 s25, s20, 131072
    v_mul_f32 v148, v20, v9
    v_mul_f32 v149, v21, v9
    v_mul_f32 v150, v22, v9
    v_mul_f32 v151, v23, v9
    v_mul_f32 v152, v28, v9
    v_mul_f32 v153, v29, v9
    v_mul_f32 v154, v30, v9
    v_mul_f32 v155, v31, v9
    v_cvt_pk_bf16_f32 v108, v148, v149
    v_cvt_pk_bf16_f32 v109, v150, v151
    v_cvt_pk_bf16_f32 v110, v152, v153
    v_cvt_pk_bf16_f32 v111, v154, v155
    buffer_store_dwordx4 v[108:111], v1, s[8:11], s20 offen offset:0 sc1
    v_mul_f32 v164, v24, v11
    v_mul_f32 v165, v25, v11
    v_mul_f32 v166, v26, v11
    v_mul_f32 v167, v27, v11
    v_mul_f32 v168, v32, v11
    v_mul_f32 v169, v33, v11
    v_mul_f32 v170, v34, v11
    v_mul_f32 v171, v35, v11
    v_cvt_pk_bf16_f32 v124, v164, v165
    v_cvt_pk_bf16_f32 v125, v166, v167
    v_cvt_pk_bf16_f32 v126, v168, v169
    v_cvt_pk_bf16_f32 v127, v170, v171
    buffer_store_dwordx4 v[124:127], v1, s[8:11], s25 offen offset:0 sc1
    v_mul_f32 v148, v36, v9
    v_mul_f32 v149, v37, v9
    v_mul_f32 v150, v38, v9
    v_mul_f32 v151, v39, v9
    v_mul_f32 v152, v44, v9
    v_mul_f32 v153, v45, v9
    v_mul_f32 v154, v46, v9
    v_mul_f32 v155, v47, v9
    v_cvt_pk_bf16_f32 v112, v148, v149
    v_cvt_pk_bf16_f32 v113, v150, v151
    v_cvt_pk_bf16_f32 v114, v152, v153
    v_cvt_pk_bf16_f32 v115, v154, v155
    buffer_store_dwordx4 v[112:115], v1, s[8:11], s20 offen offset:1024 sc1
    v_mul_f32 v164, v40, v11
    v_mul_f32 v165, v41, v11
    v_mul_f32 v166, v42, v11
    v_mul_f32 v167, v43, v11
    v_mul_f32 v168, v48, v11
    v_mul_f32 v169, v49, v11
    v_mul_f32 v170, v50, v11
    v_mul_f32 v171, v51, v11
    v_cvt_pk_bf16_f32 v128, v164, v165
    v_cvt_pk_bf16_f32 v129, v166, v167
    v_cvt_pk_bf16_f32 v130, v168, v169
    v_cvt_pk_bf16_f32 v131, v170, v171
    buffer_store_dwordx4 v[128:131], v1, s[8:11], s25 offen offset:1024 sc1
    v_mul_f32 v148, v52, v9
    v_mul_f32 v149, v53, v9
    v_mul_f32 v150, v54, v9
    v_mul_f32 v151, v55, v9
    v_mul_f32 v152, v60, v9
    v_mul_f32 v153, v61, v9
    v_mul_f32 v154, v62, v9
    v_mul_f32 v155, v63, v9
    v_cvt_pk_bf16_f32 v116, v148, v149
    v_cvt_pk_bf16_f32 v117, v150, v151
    v_cvt_pk_bf16_f32 v118, v152, v153
    v_cvt_pk_bf16_f32 v119, v154, v155
    buffer_store_dwordx4 v[116:119], v1, s[8:11], s20 offen offset:2048 sc1
    v_mul_f32 v164, v56, v11
    v_mul_f32 v165, v57, v11
    v_mul_f32 v166, v58, v11
    v_mul_f32 v167, v59, v11
    v_mul_f32 v168, v64, v11
    v_mul_f32 v169, v65, v11
    v_mul_f32 v170, v66, v11
    v_mul_f32 v171, v67, v11
    v_cvt_pk_bf16_f32 v132, v164, v165
    v_cvt_pk_bf16_f32 v133, v166, v167
    v_cvt_pk_bf16_f32 v134, v168, v169
    v_cvt_pk_bf16_f32 v135, v170, v171
    buffer_store_dwordx4 v[132:135], v1, s[8:11], s25 offen offset:2048 sc1
    v_mul_f32 v148, v68, v9
    v_mul_f32 v149, v69, v9
    v_mul_f32 v150, v70, v9
    v_mul_f32 v151, v71, v9
    v_mul_f32 v152, v76, v9
    v_mul_f32 v153, v77, v9
    v_mul_f32 v154, v78, v9
    v_mul_f32 v155, v79, v9
    v_cvt_pk_bf16_f32 v120, v148, v149
    v_cvt_pk_bf16_f32 v121, v150, v151
    v_cvt_pk_bf16_f32 v122, v152, v153
    v_cvt_pk_bf16_f32 v123, v154, v155
    buffer_store_dwordx4 v[120:123], v1, s[8:11], s20 offen offset:3072 sc1
    v_mul_f32 v164, v72, v11
    v_mul_f32 v165, v73, v11
    v_mul_f32 v166, v74, v11
    v_mul_f32 v167, v75, v11
    v_mul_f32 v168, v80, v11
    v_mul_f32 v169, v81, v11
    v_mul_f32 v170, v82, v11
    v_mul_f32 v171, v83, v11
    v_cvt_pk_bf16_f32 v136, v164, v165
    v_cvt_pk_bf16_f32 v137, v166, v167
    v_cvt_pk_bf16_f32 v138, v168, v169
    v_cvt_pk_bf16_f32 v139, v170, v171
    buffer_store_dwordx4 v[136:139], v1, s[8:11], s25 offen offset:3072 sc1
    s_cmp_ge_u32 s3, 4
    s_cbranch_scc1 fz_p3B
    v_bfe_u32 v9, v0, 2, 2
    v_lshrrev_b32 v10, 4, v0
    v_and_b32 v11, 3, v0
    v_lshlrev_b32 v3, 10, v10
    v_lshl_add_u32 v3, v9, 6, v3
    v_lshl_add_u32 v3, v11, 3, v3
    v_bfe_u32 v12, v0, 4, 1
    v_lshlrev_b32 v12, 5, v12
    v_sub_u32 v2, v3, v12
    v_add_u32 v3, v3, v12
    s_lshl_b32 s19, s13, 3
    s_add_u32 s19, s19, s3
    s_mul_i32 s19, s19, 262144
    v_add_u32 v4, s19, v1
    s_and_b32 s62, s12, 24
    s_and_b32 s19, s12, 7
    s_lshl_b32 s20, s19, 2
    s_lshr_b32 s20, 0x54732160, s20
    s_and_b32 s20, s20, 7
    s_lshl_b32 s20, s20, 2
    s_bfm_b32 s21, s20, 0
    s_and_b32 s22, s21, 0x51764320
    s_lshl_b32 s22, s22, 4
    s_lshl_b32 s21, s21, 4
    s_or_b32 s21, s21, 15
    s_andn2_b32 s21, 0x51764320, s21
    s_or_b32 s42, s21, s22
    s_or_b32 s42, s42, s19
    s_bfe_u32 s96, s2, 0x10002
    s_mul_i32 s96, s96, 28
    s_lshr_b32 s26, s2, 3
    s_add_u32 s96, s96, s26
    s_and_b32 s97, s2, 1
    s_bfe_u32 s98, s2, 0x10001
    s_bfe_u32 s99, s2, 0x40003
    s_and_b32 s100, s2, 7
    s_lshl_b32 s100, s100, 1
    s_lshr_b32 s26, s2, 7
    s_add_u32 s100, s100, s26
    v_lshrrev_b32 v9, 4, v0
    v_lshlrev_b32 v13, 4, v9
    s_add_u32 s19, s12, 1
    s_and_b32 s19, s19, 7
    s_lshl_b32 s26, s19, 9
    s_add_u32 s26, s26, 0x22000
    v_add_u32 v13, s26, v13
    v_and_b32 v14, 15, v0
    v_lshlrev_b32 v14, 6, v14
    v_lshl_add_u32 v14, v9, 4, v14
    s_lshr_b32 s18, s12, 3
    s_lshl_b32 s18, s18, 22
    s_lshl_b32 s26, s13, 3
    s_add_u32 s26, s26, s3
    s_lshl_b32 s26, s26, 16
    s_add_u32 s18, s18, s26
    s_lshl_b32 s19, s19, 12
    s_add_u32 s18, s18, s19
    s_add_u32 s18, s18, 0x2000000
    s_add_u32 s19, s18, 0x8000
    v_add_u32 v15, 0x10000, v3
    v_add_u32 v16, 0x10000, v2
    s_lshl_b32 s26, s13, 3
    s_add_u32 s26, s26, s3
    s_lshl_b32 s26, s26, 2
    s_lshr_b32 s27, s12, 3
    s_add_u32 s26, s26, s27
    s_lshl_b32 s26, s26, 7
    s_add_u32 s20, s26, 0x540000
    s_and_b32 s27, s12, 7
    s_lshl_b32 s27, s27, 2
    s_add_u32 s26, s20, s27
    v_mov_b32 v9, s14
    v_mov_b32 v10, 0
    s_waitcnt vmcnt(0)
    s_mov_b64 exec, 1
    buffer_store_dword v9, v10, s[8:11], s26 offen sc1
    s_mov_b64 exec, -1
    s_waitcnt lgkmcnt(0)
    s_barrier
    ds_read_b64_tr_b16 v[84:85], v3 offset:0
    ds_read_b64_tr_b16 v[86:87], v3 offset:4096
    ds_read_b64_tr_b16 v[88:89], v2 offset:32
    ds_read_b64_tr_b16 v[90:91], v2 offset:4128
    ds_read_b64_tr_b16 v[92:93], v3 offset:256
    ds_read_b64_tr_b16 v[94:95], v3 offset:4352
    ds_read_b64_tr_b16 v[96:97], v2 offset:288
    ds_read_b64_tr_b16 v[98:99], v2 offset:4384
    s_waitcnt lgkmcnt(6)
    v_mfma_f32_16x16x32_bf16 v[20:23], v[84:87], v[108:111], 0
    ds_read_b64_tr_b16 v[100:101], v3 offset:512
    v_mfma_f32_16x16x32_bf16 v[24:27], v[84:87], v[124:127], 0
    s_bfe_u32 s22, s42, 0x30004
    s_or_b32 s22, s22, s62
    s_lshl_b32 s22, s22, 18
    s_add_u32 s22, s22, s16
    s_add_u32 s22, s22, 0x20000
    s_add_u32 m0, s17, 0xc000
    s_nop 0
    buffer_load_dwordx4 v17, s[4:7], s22 offen lds
    ds_read_b64_tr_b16 v[102:103], v3 offset:4608
    s_waitcnt lgkmcnt(6)
    v_mfma_f32_16x16x32_bf16 v[28:31], v[88:91], v[108:111], 0
    ds_read_b64_tr_b16 v[104:105], v2 offset:544
    v_mfma_f32_16x16x32_bf16 v[32:35], v[88:91], v[124:127], 0
    ds_read_b64_tr_b16 v[106:107], v2 offset:4640
    s_waitcnt lgkmcnt(6)
    v_mfma_f32_16x16x32_bf16 v[36:39], v[92:95], v[108:111], 0
    s_bfe_u32 s22, s42, 0x30004
    s_or_b32 s22, s22, s62
    s_lshl_b32 s22, s22, 18
    s_add_u32 s22, s22, s16
    s_add_u32 s22, s22, 0x22000
    s_add_u32 m0, s17, 0xc400
    s_nop 0
    buffer_load_dwordx4 v18, s[4:7], s22 offen lds
    ds_read_b64_tr_b16 v[84:85], v3 offset:768
    v_mfma_f32_16x16x32_bf16 v[40:43], v[92:95], v[124:127], 0
    ds_read_b64_tr_b16 v[86:87], v3 offset:4864
    s_waitcnt lgkmcnt(6)
    v_mfma_f32_16x16x32_bf16 v[44:47], v[96:99], v[108:111], 0
    ds_read_b64_tr_b16 v[88:89], v2 offset:800
    v_mfma_f32_16x16x32_bf16 v[48:51], v[96:99], v[124:127], 0
    s_bfe_u32 s22, s42, 0x30004
    s_or_b32 s22, s22, s62
    s_lshl_b32 s22, s22, 18
    s_add_u32 s22, s22, s16
    s_add_u32 s22, s22, 0x24000
    s_add_u32 m0, s17, 0xc800
    s_nop 0
    buffer_load_dwordx4 v17, s[4:7], s22 offen lds
    ds_read_b64_tr_b16 v[90:91], v2 offset:4896
    s_waitcnt lgkmcnt(6)
    v_mfma_f32_16x16x32_bf16 v[52:55], v[100:103], v[108:111], 0
    ds_read_b64_tr_b16 v[92:93], v3 offset:8192
    v_mfma_f32_16x16x32_bf16 v[56:59], v[100:103], v[124:127], 0
    ds_read_b64_tr_b16 v[94:95], v3 offset:12288
    s_waitcnt lgkmcnt(6)
    v_mfma_f32_16x16x32_bf16 v[60:63], v[104:107], v[108:111], 0
    s_bfe_u32 s22, s42, 0x30004
    s_or_b32 s22, s22, s62
    s_lshl_b32 s22, s22, 18
    s_add_u32 s22, s22, s16
    s_add_u32 s22, s22, 0x26000
    s_add_u32 m0, s17, 0xcc00
    s_nop 0
    buffer_load_dwordx4 v18, s[4:7], s22 offen lds
    ds_read_b64_tr_b16 v[96:97], v2 offset:8224
    v_mfma_f32_16x16x32_bf16 v[64:67], v[104:107], v[124:127], 0
    ds_read_b64_tr_b16 v[98:99], v2 offset:12320
    s_waitcnt lgkmcnt(6)
    v_mfma_f32_16x16x32_bf16 v[68:71], v[84:87], v[108:111], 0
    ds_read_b64_tr_b16 v[100:101], v3 offset:8448
    v_mfma_f32_16x16x32_bf16 v[72:75], v[84:87], v[124:127], 0
    s_bfe_u32 s22, s42, 0x30008
    s_or_b32 s22, s22, s62
    s_lshl_b32 s22, s22, 18
    s_add_u32 s22, s22, s16
    s_add_u32 s22, s22, 0x0
    s_add_u32 m0, s17, 0x10000
    s_nop 0
    buffer_load_dwordx4 v17, s[4:7], s22 offen lds
    ds_read_b64_tr_b16 v[102:103], v3 offset:12544
    s_waitcnt lgkmcnt(6)
    v_mfma_f32_16x16x32_bf16 v[76:79], v[88:91], v[108:111], 0
    ds_read_b64_tr_b16 v[104:105], v2 offset:8480
    v_mfma_f32_16x16x32_bf16 v[80:83], v[88:91], v[124:127], 0
    ds_read_b64_tr_b16 v[106:107], v2 offset:12576
    s_waitcnt lgkmcnt(6)
    v_mfma_f32_16x16x32_bf16 v[20:23], v[92:95], v[112:115], v[20:23]
    s_bfe_u32 s22, s42, 0x30008
    s_or_b32 s22, s22, s62
    s_lshl_b32 s22, s22, 18
    s_add_u32 s22, s22, s16
    s_add_u32 s22, s22, 0x2000
    s_add_u32 m0, s17, 0x10400
    s_nop 0
    buffer_load_dwordx4 v18, s[4:7], s22 offen lds
    ds_read_b64_tr_b16 v[84:85], v3 offset:8704
    v_mfma_f32_16x16x32_bf16 v[24:27], v[92:95], v[128:131], v[24:27]
    ds_read_b64_tr_b16 v[86:87], v3 offset:12800
    s_waitcnt lgkmcnt(6)
    v_mfma_f32_16x16x32_bf16 v[28:31], v[96:99], v[112:115], v[28:31]
    ds_read_b64_tr_b16 v[88:89], v2 offset:8736
    v_mfma_f32_16x16x32_bf16 v[32:35], v[96:99], v[128:131], v[32:35]
    s_bfe_u32 s22, s42, 0x30008
    s_or_b32 s22, s22, s62
    s_lshl_b32 s22, s22, 18
    s_add_u32 s22, s22, s16
    s_add_u32 s22, s22, 0x4000
    s_add_u32 m0, s17, 0x10800
    s_nop 0
    buffer_load_dwordx4 v17, s[4:7], s22 offen lds
    ds_read_b64_tr_b16 v[90:91], v2 offset:12832
    s_waitcnt lgkmcnt(6)
    v_mfma_f32_16x16x32_bf16 v[36:39], v[100:103], v[112:115], v[36:39]
    ds_read_b64_tr_b16 v[92:93], v3 offset:8960
    v_mfma_f32_16x16x32_bf16 v[40:43], v[100:103], v[128:131], v[40:43]
    ds_read_b64_tr_b16 v[94:95], v3 offset:13056
    s_waitcnt lgkmcnt(6)
    v_mfma_f32_16x16x32_bf16 v[44:47], v[104:107], v[112:115], v[44:47]
    s_bfe_u32 s22, s42, 0x30008
    s_or_b32 s22, s22, s62
    s_lshl_b32 s22, s22, 18
    s_add_u32 s22, s22, s16
    s_add_u32 s22, s22, 0x6000
    s_add_u32 m0, s17, 0x10c00
    s_nop 0
    buffer_load_dwordx4 v18, s[4:7], s22 offen lds
    ds_read_b64_tr_b16 v[96:97], v2 offset:8992
    v_mfma_f32_16x16x32_bf16 v[48:51], v[104:107], v[128:131], v[48:51]
    ds_read_b64_tr_b16 v[98:99], v2 offset:13088
    s_waitcnt lgkmcnt(6)
    v_mfma_f32_16x16x32_bf16 v[52:55], v[84:87], v[112:115], v[52:55]
    v_mfma_f32_16x16x32_bf16 v[56:59], v[84:87], v[128:131], v[56:59]
    s_bfe_u32 s22, s42, 0x30008
    s_or_b32 s22, s22, s62
    s_lshl_b32 s22, s22, 18
    s_add_u32 s22, s22, s16
    s_add_u32 s22, s22, 0x20000
    s_add_u32 m0, s17, 0x14000
    s_nop 0
    buffer_load_dwordx4 v17, s[4:7], s22 offen lds
    s_barrier
    ds_read_b64_tr_b16 v[100:101], v3 offset:16384
    ds_read_b64_tr_b16 v[102:103], v3 offset:20480
    s_waitcnt lgkmcnt(6)
    v_mfma_f32_16x16x32_bf16 v[60:63], v[88:91], v[112:115], v[60:63]
    ds_read_b64_tr_b16 v[104:105], v2 offset:16416
    v_mfma_f32_16x16x32_bf16 v[64:67], v[88:91], v[128:131], v[64:67]
    s_bfe_u32 s22, s42, 0x3000c
    s_or_b32 s22, s22, s62
    s_lshl_b32 s22, s22, 18
    s_add_u32 s22, s22, s16
    s_add_u32 s22, s22, 0x0
    s_add_u32 m0, s17, 0x18000
    s_nop 0
    buffer_load_dwordx4 v17, s[4:7], s22 offen lds
    ds_read_b64_tr_b16 v[106:107], v2 offset:20512
    s_waitcnt lgkmcnt(6)
    v_mfma_f32_16x16x32_bf16 v[68:71], v[92:95], v[112:115], v[68:71]
    s_bfe_u32 s22, s42, 0x30008
    s_or_b32 s22, s22, s62
    s_lshl_b32 s22, s22, 18
    s_add_u32 s22, s22, s16
    s_add_u32 s22, s22, 0x22000
    s_add_u32 m0, s17, 0x14400
    s_nop 0
    buffer_load_dwordx4 v18, s[4:7], s22 offen lds
    ds_read_b64_tr_b16 v[84:85], v3 offset:16640
    v_mfma_f32_16x16x32_bf16 v[72:75], v[92:95], v[128:131], v[72:75]
    ds_read_b64_tr_b16 v[86:87], v3 offset:20736
    s_waitcnt lgkmcnt(6)
    v_mfma_f32_16x16x32_bf16 v[76:79], v[96:99], v[112:115], v[76:79]
    ds_read_b64_tr_b16 v[88:89], v2 offset:16672
    v_mfma_f32_16x16x32_bf16 v[80:83], v[96:99], v[128:131], v[80:83]
    s_bfe_u32 s22, s42, 0x30008
    s_or_b32 s22, s22, s62
    s_lshl_b32 s22, s22, 18
    s_add_u32 s22, s22, s16
    s_add_u32 s22, s22, 0x24000
    s_add_u32 m0, s17, 0x14800
    s_nop 0
    buffer_load_dwordx4 v17, s[4:7], s22 offen lds
    s_bfe_u32 s22, s42, 0x3000c
    s_or_b32 s22, s22, s62
    s_lshl_b32 s22, s22, 18
    s_add_u32 s22, s22, s16
    s_add_u32 s22, s22, 0x2000
    s_add_u32 m0, s17, 0x18400
    s_nop 0
    buffer_load_dwordx4 v18, s[4:7], s22 offen lds
    ds_read_b64_tr_b16 v[90:91], v2 offset:20768
    s_waitcnt lgkmcnt(6)
    v_mfma_f32_16x16x32_bf16 v[20:23], v[100:103], v[116:119], v[20:23]
    ds_read_b64_tr_b16 v[92:93], v3 offset:16896
    v_mfma_f32_16x16x32_bf16 v[24:27], v[100:103], v[132:135], v[24:27]
    ds_read_b64_tr_b16 v[94:95], v3 offset:20992
    s_waitcnt lgkmcnt(6)
    v_mfma_f32_16x16x32_bf16 v[28:31], v[104:107], v[116:119], v[28:31]
    s_bfe_u32 s22, s42, 0x30008
    s_or_b32 s22, s22, s62
    s_lshl_b32 s22, s22, 18
    s_add_u32 s22, s22, s16
    s_add_u32 s22, s22, 0x26000
    s_add_u32 m0, s17, 0x14c00
    s_nop 0
    buffer_load_dwordx4 v18, s[4:7], s22 offen lds
    ds_read_b64_tr_b16 v[96:97], v2 offset:16928
    v_mfma_f32_16x16x32_bf16 v[32:35], v[104:107], v[132:135], v[32:35]
    s_bfe_u32 s22, s42, 0x3000c
    s_or_b32 s22, s22, s62
    s_lshl_b32 s22, s22, 18
    s_add_u32 s22, s22, s16
    s_add_u32 s22, s22, 0x4000
    s_add_u32 m0, s17, 0x18800
    s_nop 0
    buffer_load_dwordx4 v17, s[4:7], s22 offen lds
    ds_read_b64_tr_b16 v[98:99], v2 offset:21024
    s_waitcnt lgkmcnt(6)
    v_mfma_f32_16x16x32_bf16 v[36:39], v[84:87], v[116:119], v[36:39]
    ds_read_b64_tr_b16 v[100:101], v3 offset:17152
    v_mfma_f32_16x16x32_bf16 v[40:43], v[84:87], v[132:135], v[40:43]
    ds_read_b64_tr_b16 v[102:103], v3 offset:21248
    s_waitcnt lgkmcnt(6)
    v_mfma_f32_16x16x32_bf16 v[44:47], v[88:91], v[116:119], v[44:47]
    ds_read_b64_tr_b16 v[104:105], v2 offset:17184
    v_mfma_f32_16x16x32_bf16 v[48:51], v[88:91], v[132:135], v[48:51]
    s_bfe_u32 s22, s42, 0x3000c
    s_or_b32 s22, s22, s62
    s_lshl_b32 s22, s22, 18
    s_add_u32 s22, s22, s16
    s_add_u32 s22, s22, 0x6000
    s_add_u32 m0, s17, 0x18c00
    s_nop 0
    buffer_load_dwordx4 v18, s[4:7], s22 offen lds
    ds_read_b64_tr_b16 v[106:107], v2 offset:21280
    s_waitcnt lgkmcnt(6)
    v_mfma_f32_16x16x32_bf16 v[52:55], v[92:95], v[116:119], v[52:55]
    ds_read_b64_tr_b16 v[84:85], v3 offset:24576
    v_mfma_f32_16x16x32_bf16 v[56:59], v[92:95], v[132:135], v[56:59]
    ds_read_b64_tr_b16 v[86:87], v3 offset:28672
    s_waitcnt lgkmcnt(6)
    v_mfma_f32_16x16x32_bf16 v[60:63], v[96:99], v[116:119], v[60:63]
    ds_read_b64_tr_b16 v[88:89], v2 offset:24608
    v_mfma_f32_16x16x32_bf16 v[64:67], v[96:99], v[132:135], v[64:67]
    ds_read_b64_tr_b16 v[90:91], v2 offset:28704
    s_waitcnt lgkmcnt(6)
    v_mfma_f32_16x16x32_bf16 v[68:71], v[100:103], v[116:119], v[68:71]
    ds_read_b64_tr_b16 v[92:93], v3 offset:24832
    v_mfma_f32_16x16x32_bf16 v[72:75], v[100:103], v[132:135], v[72:75]
    ds_read_b64_tr_b16 v[94:95], v3 offset:28928
    s_waitcnt lgkmcnt(6)
    v_mfma_f32_16x16x32_bf16 v[76:79], v[104:107], v[116:119], v[76:79]
    ds_read_b64_tr_b16 v[96:97], v2 offset:24864
    v_mfma_f32_16x16x32_bf16 v[80:83], v[104:107], v[132:135], v[80:83]
    ds_read_b64_tr_b16 v[98:99], v2 offset:28960
    s_waitcnt lgkmcnt(6)
    v_mfma_f32_16x16x32_bf16 v[20:23], v[84:87], v[120:123], v[20:23]
    ds_read_b64_tr_b16 v[100:101], v3 offset:25088
    v_mfma_f32_16x16x32_bf16 v[24:27], v[84:87], v[136:139], v[24:27]
    ds_read_b64_tr_b16 v[102:103], v3 offset:29184
    s_waitcnt lgkmcnt(6)
    v_mfma_f32_16x16x32_bf16 v[28:31], v[88:91], v[120:123], v[28:31]
    ds_read_b64_tr_b16 v[104:105], v2 offset:25120
    v_mfma_f32_16x16x32_bf16 v[32:35], v[88:91], v[136:139], v[32:35]
    ds_read_b64_tr_b16 v[106:107], v2 offset:29216
    s_waitcnt lgkmcnt(6)
    v_mfma_f32_16x16x32_bf16 v[36:39], v[92:95], v[120:123], v[36:39]
    ds_read_b64_tr_b16 v[84:85], v3 offset:25344
    v_mfma_f32_16x16x32_bf16 v[40:43], v[92:95], v[136:139], v[40:43]
    ds_read_b64_tr_b16 v[86:87], v3 offset:29440
    s_waitcnt lgkmcnt(6)
    v_mfma_f32_16x16x32_bf16 v[44:47], v[96:99], v[120:123], v[44:47]
    ds_read_b64_tr_b16 v[88:89], v2 offset:25376
    v_mfma_f32_16x16x32_bf16 v[48:51], v[96:99], v[136:139], v[48:51]
    ds_read_b64_tr_b16 v[90:91], v2 offset:29472
    s_waitcnt lgkmcnt(6)
    v_mfma_f32_16x16x32_bf16 v[52:55], v[100:103], v[120:123], v[52:55]
    v_mfma_f32_16x16x32_bf16 v[56:59], v[100:103], v[136:139], v[56:59]
    s_barrier
    ds_read_b64_tr_b16 v[92:93], v3 offset:32768
    ds_read_b64_tr_b16 v[94:95], v3 offset:36864
    s_waitcnt lgkmcnt(6)
    v_mfma_f32_16x16x32_bf16 v[60:63], v[104:107], v[120:123], v[60:63]
    ds_read_b64_tr_b16 v[96:97], v2 offset:32800
    v_mfma_f32_16x16x32_bf16 v[64:67], v[104:107], v[136:139], v[64:67]
    s_bfe_u32 s22, s42, 0x3000c
    s_or_b32 s22, s22, s62
    s_lshl_b32 s22, s22, 18
    s_add_u32 s22, s22, s16
    s_add_u32 s22, s22, 0x20000
    s_add_u32 m0, s17, 0x1c000
    s_nop 0
    buffer_load_dwordx4 v17, s[4:7], s22 offen lds
    ds_read_b64_tr_b16 v[98:99], v2 offset:36896
    s_waitcnt lgkmcnt(6)
    v_mfma_f32_16x16x32_bf16 v[68:71], v[84:87], v[120:123], v[68:71]
    ds_read_b64_tr_b16 v[100:101], v3 offset:33024
    v_mfma_f32_16x16x32_bf16 v[72:75], v[84:87], v[136:139], v[72:75]
    ds_read_b64_tr_b16 v[102:103], v3 offset:37120
    s_waitcnt lgkmcnt(6)
    v_mfma_f32_16x16x32_bf16 v[76:79], v[88:91], v[120:123], v[76:79]
    ds_read_b64_tr_b16 v[104:105], v2 offset:33056
    v_mfma_f32_16x16x32_bf16 v[80:83], v[88:91], v[136:139], v[80:83]
    s_bfe_u32 s22, s42, 0x3000c
    s_or_b32 s22, s22, s62
    s_lshl_b32 s22, s22, 18
    s_add_u32 s22, s22, s16
    s_add_u32 s22, s22, 0x22000
    s_add_u32 m0, s17, 0x1c400
    s_nop 0
    buffer_load_dwordx4 v18, s[4:7], s22 offen lds
    ds_read_b64_tr_b16 v[106:107], v2 offset:37152
    v_and_b32 v9, 7, v0
    v_lshlrev_b32 v9, 2, v9
    s_mov_b32 s27, 0
fz_oAp:
    buffer_load_dword v10, v9, s[8:11], s20 offen sc1
    s_waitcnt vmcnt(0)
    v_cmp_ne_u32 vcc, s14, v10
    s_and_b32 vcc_lo, vcc_lo, 0xdd
    s_mov_b32 vcc_hi, 0
    s_add_u32 s27, s27, 1
    s_cmp_ge_u32 s27, 65536
    s_cbranch_scc1 fz_oAg
    s_cbranch_vccz fz_oAg
    s_sleep 1
    s_branch fz_oAp
fz_oAg:
    s_bfe_u32 s21, s42, 0x30004
    s_or_b32 s21, s21, s62
    s_lshl_b32 s21, s21, 12
    s_add_u32 s23, s21, 0x1000000
    buffer_load_dwordx4 v[140:143], v4, s[8:11], s23 offen offset:0 sc1
    s_add_u32 s23, s21, 0x1020000
    buffer_load_dwordx4 v[144:147], v4, s[8:11], s23 offen offset:0 sc1
    s_add_u32 s23, s21, 0x1000000
    buffer_load_dwordx4 v[148:151], v4, s[8:11], s23 offen offset:1024 sc1
    s_add_u32 s23, s21, 0x1020000
    buffer_load_dwordx4 v[152:155], v4, s[8:11], s23 offen offset:1024 sc1
    s_add_u32 s23, s21, 0x1000800
    buffer_load_dwordx4 v[156:159], v4, s[8:11], s23 offen offset:0 sc1
    s_add_u32 s23, s21, 0x1020800
    buffer_load_dwordx4 v[160:163], v4, s[8:11], s23 offen offset:0 sc1
    s_add_u32 s23, s21, 0x1000800
    buffer_load_dwordx4 v[164:167], v4, s[8:11], s23 offen offset:1024 sc1
    s_add_u32 s23, s21, 0x1020800
    buffer_load_dwordx4 v[168:171], v4, s[8:11], s23 offen offset:1024 sc1
    s_bfe_u32 s21, s42, 0x30008
    s_or_b32 s21, s21, s62
    s_lshl_b32 s21, s21, 12
    s_add_u32 s23, s21, 0x1000000
    buffer_load_dwordx4 v[188:191], v4, s[8:11], s23 offen offset:0 sc1
    s_add_u32 s23, s21, 0x1020000
    buffer_load_dwordx4 v[192:195], v4, s[8:11], s23 offen offset:0 sc1
    s_add_u32 s23, s21, 0x1000000
    buffer_load_dwordx4 v[196:199], v4, s[8:11], s23 offen offset:1024 sc1
    s_add_u32 s23, s21, 0x1020000
    buffer_load_dwordx4 v[200:203], v4, s[8:11], s23 offen offset:1024 sc1
    s_waitcnt vmcnt(11) lgkmcnt(6)
    v_mfma_f32_16x16x32_bf16 v[20:23], v[92:95], v[140:143], v[20:23]
    ds_read_b64_tr_b16 v[84:85], v3 offset:33280
    s_waitcnt vmcnt(10)
    v_mfma_f32_16x16x32_bf16 v[24:27], v[92:95], v[144:147], v[24:27]
    ds_read_b64_tr_b16 v[86:87], v3 offset:37376
    s_waitcnt lgkmcnt(6)
    v_mfma_f32_16x16x32_bf16 v[28:31], v[96:99], v[140:143], v[28:31]
    ds_read_b64_tr_b16 v[88:89], v2 offset:33312
    v_mfma_f32_16x16x32_bf16 v[32:35], v[96:99], v[144:147], v[32:35]
    s_bfe_u32 s22, s42, 0x3000c
    s_or_b32 s22, s22, s62
    s_lshl_b32 s22, s22, 18
    s_add_u32 s22, s22, s16
    s_add_u32 s22, s22, 0x24000
    s_add_u32 m0, s17, 0x1c800
    s_nop 0
    buffer_load_dwordx4 v17, s[4:7], s22 offen lds
    ds_read_b64_tr_b16 v[90:91], v2 offset:37408
    s_add_u32 s23, s21, 0x1000800
    buffer_load_dwordx4 v[108:111], v4, s[8:11], s23 offen offset:0 sc1
    s_waitcnt lgkmcnt(6)
    v_mfma_f32_16x16x32_bf16 v[36:39], v[100:103], v[140:143], v[36:39]
    ds_read_b64_tr_b16 v[92:93], v3 offset:33536
    v_mfma_f32_16x16x32_bf16 v[40:43], v[100:103], v[144:147], v[40:43]
    ds_read_b64_tr_b16 v[94:95], v3 offset:37632
    s_waitcnt lgkmcnt(6)
    v_mfma_f32_16x16x32_bf16 v[44:47], v[104:107], v[140:143], v[44:47]
    ds_read_b64_tr_b16 v[96:97], v2 offset:33568
    v_mfma_f32_16x16x32_bf16 v[48:51], v[104:107], v[144:147], v[48:51]
    s_bfe_u32 s22, s42, 0x3000c
    s_or_b32 s22, s22, s62
    s_lshl_b32 s22, s22, 18
    s_add_u32 s22, s22, s16
    s_add_u32 s22, s22, 0x26000
    s_add_u32 m0, s17, 0x1cc00
    s_nop 0
    buffer_load_dwordx4 v18, s[4:7], s22 offen lds
    ds_read_b64_tr_b16 v[98:99], v2 offset:37664
    s_waitcnt lgkmcnt(6)
    v_mfma_f32_16x16x32_bf16 v[52:55], v[84:87], v[140:143], v[52:55]
    ds_read_b64_tr_b16 v[100:101], v3 offset:40960
    v_mfma_f32_16x16x32_bf16 v[56:59], v[84:87], v[144:147], v[56:59]
    ds_read_b64_tr_b16 v[102:103], v3 offset:45056
    s_waitcnt lgkmcnt(6)
    v_mfma_f32_16x16x32_bf16 v[60:63], v[88:91], v[140:143], v[60:63]
    ds_read_b64_tr_b16 v[104:105], v2 offset:40992
    v_mfma_f32_16x16x32_bf16 v[64:67], v[88:91], v[144:147], v[64:67]
    ds_read_b64_tr_b16 v[106:107], v2 offset:45088
    s_add_u32 s23, s21, 0x1020800
    buffer_load_dwordx4 v[112:115], v4, s[8:11], s23 offen offset:0 sc1
    s_waitcnt lgkmcnt(6)
    v_mfma_f32_16x16x32_bf16 v[68:71], v[92:95], v[140:143], v[68:71]
    ds_read_b64_tr_b16 v[84:85], v3 offset:41216
    v_mfma_f32_16x16x32_bf16 v[72:75], v[92:95], v[144:147], v[72:75]
    ds_read_b64_tr_b16 v[86:87], v3 offset:45312
    s_waitcnt lgkmcnt(6)
    v_mfma_f32_16x16x32_bf16 v[76:79], v[96:99], v[140:143], v[76:79]
    ds_read_b64_tr_b16 v[88:89], v2 offset:41248
    v_mfma_f32_16x16x32_bf16 v[80:83], v[96:99], v[144:147], v[80:83]
    ds_read_b64_tr_b16 v[90:91], v2 offset:45344
    s_waitcnt vmcnt(13) lgkmcnt(6)
    v_mfma_f32_16x16x32_bf16 v[20:23], v[100:103], v[148:151], v[20:23]
    ds_read_b64_tr_b16 v[92:93], v3 offset:41472
    s_waitcnt vmcnt(12)
    v_mfma_f32_16x16x32_bf16 v[24:27], v[100:103], v[152:155], v[24:27]
    ds_read_b64_tr_b16 v[94:95], v3 offset:45568
    s_waitcnt lgkmcnt(6)
    v_mfma_f32_16x16x32_bf16 v[28:31], v[104:107], v[148:151], v[28:31]
    ds_read_b64_tr_b16 v[96:97], v2 offset:41504
    v_mfma_f32_16x16x32_bf16 v[32:35], v[104:107], v[152:155], v[32:35]
    ds_read_b64_tr_b16 v[98:99], v2 offset:45600
    s_add_u32 s23, s21, 0x1000800
    buffer_load_dwordx4 v[116:119], v4, s[8:11], s23 offen offset:1024 sc1
    s_waitcnt lgkmcnt(6)
    v_mfma_f32_16x16x32_bf16 v[36:39], v[84:87], v[148:151], v[36:39]
    ds_read_b64_tr_b16 v[100:101], v3 offset:41728
    v_mfma_f32_16x16x32_bf16 v[40:43], v[84:87], v[152:155], v[40:43]
    ds_read_b64_tr_b16 v[102:103], v3 offset:45824
    s_waitcnt lgkmcnt(6)
    v_mfma_f32_16x16x32_bf16 v[44:47], v[88:91], v[148:151], v[44:47]
    ds_read_b64_tr_b16 v[104:105], v2 offset:41760
    v_mfma_f32_16x16x32_bf16 v[48:51], v[88:91], v[152:155], v[48:51]
    ds_read_b64_tr_b16 v[106:107], v2 offset:45856
    s_waitcnt lgkmcnt(6)
    v_mfma_f32_16x16x32_bf16 v[52:55], v[92:95], v[148:151], v[52:55]
    v_mfma_f32_16x16x32_bf16 v[56:59], v[92:95], v[152:155], v[56:59]
    s_barrier
    ds_read_b64_tr_b16 v[84:85], v3 offset:49152
    ds_read_b64_tr_b16 v[86:87], v3 offset:53248
    s_waitcnt lgkmcnt(6)
    v_mfma_f32_16x16x32_bf16 v[60:63], v[96:99], v[148:151], v[60:63]
    ds_read_b64_tr_b16 v[88:89], v2 offset:49184
    v_mfma_f32_16x16x32_bf16 v[64:67], v[96:99], v[152:155], v[64:67]
    s_bfe_u32 s22, s42, 0x30010
    s_or_b32 s22, s22, s62
    s_lshl_b32 s22, s22, 18
    s_add_u32 s22, s22, s16
    s_add_u32 s22, s22, 0x0
    s_add_u32 m0, s17, 0x0
    s_nop 0
    buffer_load_dwordx4 v17, s[4:7], s22 offen lds
    ds_read_b64_tr_b16 v[90:91], v2 offset:53280
    s_add_u32 s23, s21, 0x1020800
    buffer_load_dwordx4 v[120:123], v4, s[8:11], s23 offen offset:1024 sc1
    s_waitcnt lgkmcnt(6)
    v_mfma_f32_16x16x32_bf16 v[68:71], v[100:103], v[148:151], v[68:71]
    ds_read_b64_tr_b16 v[92:93], v3 offset:49408
    v_mfma_f32_16x16x32_bf16 v[72:75], v[100:103], v[152:155], v[72:75]
    ds_read_b64_tr_b16 v[94:95], v3 offset:53504
    s_waitcnt lgkmcnt(6)
    v_mfma_f32_16x16x32_bf16 v[76:79], v[104:107], v[148:151], v[76:79]
    ds_read_b64_tr_b16 v[96:97], v2 offset:49440
    v_mfma_f32_16x16x32_bf16 v[80:83], v[104:107], v[152:155], v[80:83]
    s_bfe_u32 s22, s42, 0x30010
    s_or_b32 s22, s22, s62
    s_lshl_b32 s22, s22, 18
    s_add_u32 s22, s22, s16
    s_add_u32 s22, s22, 0x2000
    s_add_u32 m0, s17, 0x400
    s_nop 0
    buffer_load_dwordx4 v18, s[4:7], s22 offen lds
    ds_read_b64_tr_b16 v[98:99], v2 offset:53536
    s_waitcnt vmcnt(15) lgkmcnt(6)
    v_mfma_f32_16x16x32_bf16 v[20:23], v[84:87], v[156:159], v[20:23]
    ds_read_b64_tr_b16 v[100:101], v3 offset:49664
    s_waitcnt vmcnt(14)
    v_mfma_f32_16x16x32_bf16 v[24:27], v[84:87], v[160:163], v[24:27]
    ds_read_b64_tr_b16 v[102:103], v3 offset:53760
    s_waitcnt lgkmcnt(6)
    v_mfma_f32_16x16x32_bf16 v[28:31], v[88:91], v[156:159], v[28:31]
    ds_read_b64_tr_b16 v[104:105], v2 offset:49696
    v_mfma_f32_16x16x32_bf16 v[32:35], v[88:91], v[160:163], v[32:35]
    s_bfe_u32 s22, s42, 0x30010
    s_or_b32 s22, s22, s62
    s_lshl_b32 s22, s22, 18
    s_add_u32 s22, s22, s16
    s_add_u32 s22, s22, 0x4000
    s_add_u32 m0, s17, 0x800
    s_nop 0
    buffer_load_dwordx4 v17, s[4:7], s22 offen lds
    ds_read_b64_tr_b16 v[106:107], v2 offset:53792
    s_bfe_u32 s21, s42, 0x3000c
    s_or_b32 s21, s21, s62
    s_lshl_b32 s21, s21, 12
    s_add_u32 s23, s21, 0x1000000
    buffer_load_dwordx4 v[140:143], v4, s[8:11], s23 offen offset:0 sc1
    s_waitcnt lgkmcnt(6)
    v_mfma_f32_16x16x32_bf16 v[36:39], v[92:95], v[156:159], v[36:39]
    ds_read_b64_tr_b16 v[84:85], v3 offset:49920
    v_mfma_f32_16x16x32_bf16 v[40:43], v[92:95], v[160:163], v[40:43]
    ds_read_b64_tr_b16 v[86:87], v3 offset:54016
    s_waitcnt lgkmcnt(6)
    v_mfma_f32_16x16x32_bf16 v[44:47], v[96:99], v[156:159], v[44:47]
    ds_read_b64_tr_b16 v[88:89], v2 offset:49952
    v_mfma_f32_16x16x32_bf16 v[48:51], v[96:99], v[160:163], v[48:51]
    s_bfe_u32 s22, s42, 0x30010
    s_or_b32 s22, s22, s62
    s_lshl_b32 s22, s22, 18
    s_add_u32 s22, s22, s16
    s_add_u32 s22, s22, 0x6000
    s_add_u32 m0, s17, 0xc00
    s_nop 0
    buffer_load_dwordx4 v18, s[4:7], s22 offen lds
    ds_read_b64_tr_b16 v[90:91], v2 offset:54048
    s_waitcnt lgkmcnt(6)
    v_mfma_f32_16x16x32_bf16 v[52:55], v[100:103], v[156:159], v[52:55]
    ds_read_b64_tr_b16 v[92:93], v3 offset:57344
    v_mfma_f32_16x16x32_bf16 v[56:59], v[100:103], v[160:163], v[56:59]
    ds_read_b64_tr_b16 v[94:95], v3 offset:61440
    s_waitcnt lgkmcnt(6)
    v_mfma_f32_16x16x32_bf16 v[60:63], v[104:107], v[156:159], v[60:63]
    ds_read_b64_tr_b16 v[96:97], v2 offset:57376
    v_mfma_f32_16x16x32_bf16 v[64:67], v[104:107], v[160:163], v[64:67]
    ds_read_b64_tr_b16 v[98:99], v2 offset:61472
    s_add_u32 s23, s21, 0x1020000
    buffer_load_dwordx4 v[144:147], v4, s[8:11], s23 offen offset:0 sc1
    s_waitcnt lgkmcnt(6)
    v_mfma_f32_16x16x32_bf16 v[68:71], v[84:87], v[156:159], v[68:71]
    ds_read_b64_tr_b16 v[100:101], v3 offset:57600
    v_mfma_f32_16x16x32_bf16 v[72:75], v[84:87], v[160:163], v[72:75]
    ds_read_b64_tr_b16 v[102:103], v3 offset:61696
    s_waitcnt lgkmcnt(6)
    v_mfma_f32_16x16x32_bf16 v[76:79], v[88:91], v[156:159], v[76:79]
    ds_read_b64_tr_b16 v[104:105], v2 offset:57632
    v_mfma_f32_16x16x32_bf16 v[80:83], v[88:91], v[160:163], v[80:83]
    ds_read_b64_tr_b16 v[106:107], v2 offset:61728
    s_waitcnt vmcnt(17) lgkmcnt(6)
    v_mfma_f32_16x16x32_bf16 v[20:23], v[92:95], v[164:167], v[20:23]
    ds_read_b64_tr_b16 v[84:85], v3 offset:57856
    s_waitcnt vmcnt(16)
    v_mfma_f32_16x16x32_bf16 v[24:27], v[92:95], v[168:171], v[24:27]
    ds_read_b64_tr_b16 v[86:87], v3 offset:61952
    s_waitcnt lgkmcnt(6)
    v_mfma_f32_16x16x32_bf16 v[28:31], v[96:99], v[164:167], v[28:31]
    ds_read_b64_tr_b16 v[88:89], v2 offset:57888
    v_mfma_f32_16x16x32_bf16 v[32:35], v[96:99], v[168:171], v[32:35]
    ds_read_b64_tr_b16 v[90:91], v2 offset:61984
    s_add_u32 s23, s21, 0x1000000
    buffer_load_dwordx4 v[148:151], v4, s[8:11], s23 offen offset:1024 sc1
    s_waitcnt lgkmcnt(6)
    v_mfma_f32_16x16x32_bf16 v[36:39], v[100:103], v[164:167], v[36:39]
    ds_read_b64_tr_b16 v[92:93], v3 offset:58112
    v_mfma_f32_16x16x32_bf16 v[40:43], v[100:103], v[168:171], v[40:43]
    ds_read_b64_tr_b16 v[94:95], v3 offset:62208
    s_waitcnt lgkmcnt(6)
    v_mfma_f32_16x16x32_bf16 v[44:47], v[104:107], v[164:167], v[44:47]
    ds_read_b64_tr_b16 v[96:97], v2 offset:58144
    v_mfma_f32_16x16x32_bf16 v[48:51], v[104:107], v[168:171], v[48:51]
    ds_read_b64_tr_b16 v[98:99], v2 offset:62240
    s_waitcnt lgkmcnt(6)
    v_mfma_f32_16x16x32_bf16 v[52:55], v[84:87], v[164:167], v[52:55]
    v_mfma_f32_16x16x32_bf16 v[56:59], v[84:87], v[168:171], v[56:59]
    s_barrier
    ds_read_b64_tr_b16 v[100:101], v15 offset:0
    ds_read_b64_tr_b16 v[102:103], v15 offset:4096
    s_waitcnt lgkmcnt(6)
    v_mfma_f32_16x16x32_bf16 v[60:63], v[88:91], v[164:167], v[60:63]
    ds_read_b64_tr_b16 v[104:105], v16 offset:32
    v_mfma_f32_16x16x32_bf16 v[64:67], v[88:91], v[168:171], v[64:67]
    s_bfe_u32 s22, s42, 0x30010
    s_or_b32 s22, s22, s62
    s_lshl_b32 s22, s22, 18
    s_add_u32 s22, s22, s16
    s_add_u32 s22, s22, 0x20000
    s_add_u32 m0, s17, 0x4000
    s_nop 0
    buffer_load_dwordx4 v17, s[4:7], s22 offen lds
    ds_read_b64_tr_b16 v[106:107], v16 offset:4128
    s_add_u32 s23, s21, 0x1020000
    buffer_load_dwordx4 v[152:155], v4, s[8:11], s23 offen offset:1024 sc1
    s_waitcnt lgkmcnt(6)
    v_mfma_f32_16x16x32_bf16 v[68:71], v[92:95], v[164:167], v[68:71]
    ds_read_b64_tr_b16 v[84:85], v15 offset:256
    v_mfma_f32_16x16x32_bf16 v[72:75], v[92:95], v[168:171], v[72:75]
    ds_read_b64_tr_b16 v[86:87], v15 offset:4352
    s_waitcnt lgkmcnt(6)
    v_mfma_f32_16x16x32_bf16 v[76:79], v[96:99], v[164:167], v[76:79]
    ds_read_b64_tr_b16 v[88:89], v16 offset:288
    v_mfma_f32_16x16x32_bf16 v[80:83], v[96:99], v[168:171], v[80:83]
    s_bfe_u32 s22, s42, 0x30010
    s_or_b32 s22, s22, s62
    s_lshl_b32 s22, s22, 18
    s_add_u32 s22, s22, s16
    s_add_u32 s22, s22, 0x22000
    s_add_u32 m0, s17, 0x4400
    s_nop 0
    buffer_load_dwordx4 v18, s[4:7], s22 offen lds
    ds_read_b64_tr_b16 v[90:91], v16 offset:4384
    s_waitcnt vmcnt(19) lgkmcnt(6)
    v_mfma_f32_16x16x32_bf16 v[20:23], v[100:103], v[188:191], v[20:23]
    ds_read_b64_tr_b16 v[92:93], v15 offset:512
    s_waitcnt vmcnt(18)
    v_mfma_f32_16x16x32_bf16 v[24:27], v[100:103], v[192:195], v[24:27]
    ds_read_b64_tr_b16 v[94:95], v15 offset:4608
    s_waitcnt lgkmcnt(6)
    v_mfma_f32_16x16x32_bf16 v[28:31], v[104:107], v[188:191], v[28:31]
    ds_read_b64_tr_b16 v[96:97], v16 offset:544
    v_mfma_f32_16x16x32_bf16 v[32:35], v[104:107], v[192:195], v[32:35]
    s_bfe_u32 s22, s42, 0x30010
    s_or_b32 s22, s22, s62
    s_lshl_b32 s22, s22, 18
    s_add_u32 s22, s22, s16
    s_add_u32 s22, s22, 0x24000
    s_add_u32 m0, s17, 0x4800
    s_nop 0
    buffer_load_dwordx4 v17, s[4:7], s22 offen lds
    ds_read_b64_tr_b16 v[98:99], v16 offset:4640
    s_add_u32 s23, s21, 0x1000800
    buffer_load_dwordx4 v[156:159], v4, s[8:11], s23 offen offset:0 sc1
    s_waitcnt lgkmcnt(6)
    v_mfma_f32_16x16x32_bf16 v[36:39], v[84:87], v[188:191], v[36:39]
    ds_read_b64_tr_b16 v[100:101], v15 offset:768
    v_mfma_f32_16x16x32_bf16 v[40:43], v[84:87], v[192:195], v[40:43]
    ds_read_b64_tr_b16 v[102:103], v15 offset:4864
    s_waitcnt lgkmcnt(6)
    v_mfma_f32_16x16x32_bf16 v[44:47], v[88:91], v[188:191], v[44:47]
    ds_read_b64_tr_b16 v[104:105], v16 offset:800
    v_mfma_f32_16x16x32_bf16 v[48:51], v[88:91], v[192:195], v[48:51]
    s_bfe_u32 s22, s42, 0x30010
    s_or_b32 s22, s22, s62
    s_lshl_b32 s22, s22, 18
    s_add_u32 s22, s22, s16
    s_add_u32 s22, s22, 0x26000
    s_add_u32 m0, s17, 0x4c00
    s_nop 0
    buffer_load_dwordx4 v18, s[4:7], s22 offen lds
    ds_read_b64_tr_b16 v[106:107], v16 offset:4896
    s_waitcnt lgkmcnt(6)
    v_mfma_f32_16x16x32_bf16 v[52:55], v[92:95], v[188:191], v[52:55]
    ds_read_b64_tr_b16 v[84:85], v15 offset:8192
    v_mfma_f32_16x16x32_bf16 v[56:59], v[92:95], v[192:195], v[56:59]
    ds_read_b64_tr_b16 v[86:87], v15 offset:12288
    s_waitcnt lgkmcnt(6)
    v_mfma_f32_16x16x32_bf16 v[60:63], v[96:99], v[188:191], v[60:63]
    ds_read_b64_tr_b16 v[88:89], v16 offset:8224
    v_mfma_f32_16x16x32_bf16 v[64:67], v[96:99], v[192:195], v[64:67]
    ds_read_b64_tr_b16 v[90:91], v16 offset:12320
    s_add_u32 s23, s21, 0x1020800
    buffer_load_dwordx4 v[160:163], v4, s[8:11], s23 offen offset:0 sc1
    s_waitcnt lgkmcnt(6)
    v_mfma_f32_16x16x32_bf16 v[68:71], v[100:103], v[188:191], v[68:71]
    ds_read_b64_tr_b16 v[92:93], v15 offset:8448
    v_mfma_f32_16x16x32_bf16 v[72:75], v[100:103], v[192:195], v[72:75]
    ds_read_b64_tr_b16 v[94:95], v15 offset:12544
    s_waitcnt lgkmcnt(6)
    v_mfma_f32_16x16x32_bf16 v[76:79], v[104:107], v[188:191], v[76:79]
    ds_read_b64_tr_b16 v[96:97], v16 offset:8480
    v_mfma_f32_16x16x32_bf16 v[80:83], v[104:107], v[192:195], v[80:83]
    ds_read_b64_tr_b16 v[98:99], v16 offset:12576
    s_waitcnt vmcnt(21) lgkmcnt(6)
    v_mfma_f32_16x16x32_bf16 v[20:23], v[84:87], v[196:199], v[20:23]
    ds_read_b64_tr_b16 v[100:101], v15 offset:8704
    s_waitcnt vmcnt(20)
    v_mfma_f32_16x16x32_bf16 v[24:27], v[84:87], v[200:203], v[24:27]
    ds_read_b64_tr_b16 v[102:103], v15 offset:12800
    s_waitcnt lgkmcnt(6)
    v_mfma_f32_16x16x32_bf16 v[28:31], v[88:91], v[196:199], v[28:31]
    ds_read_b64_tr_b16 v[104:105], v16 offset:8736
    v_mfma_f32_16x16x32_bf16 v[32:35], v[88:91], v[200:203], v[32:35]
    ds_read_b64_tr_b16 v[106:107], v16 offset:12832
    s_add_u32 s23, s21, 0x1000800
    buffer_load_dwordx4 v[164:167], v4, s[8:11], s23 offen offset:1024 sc1
    s_waitcnt lgkmcnt(6)
    v_mfma_f32_16x16x32_bf16 v[36:39], v[92:95], v[196:199], v[36:39]
    ds_read_b64_tr_b16 v[84:85], v15 offset:8960
    v_mfma_f32_16x16x32_bf16 v[40:43], v[92:95], v[200:203], v[40:43]
    ds_read_b64_tr_b16 v[86:87], v15 offset:13056
    s_waitcnt lgkmcnt(6)
    v_mfma_f32_16x16x32_bf16 v[44:47], v[96:99], v[196:199], v[44:47]
    ds_read_b64_tr_b16 v[88:89], v16 offset:8992
    v_mfma_f32_16x16x32_bf16 v[48:51], v[96:99], v[200:203], v[48:51]
    ds_read_b64_tr_b16 v[90:91], v16 offset:13088
    s_waitcnt lgkmcnt(6)
    v_mfma_f32_16x16x32_bf16 v[52:55], v[100:103], v[196:199], v[52:55]
    v_mfma_f32_16x16x32_bf16 v[56:59], v[100:103], v[200:203], v[56:59]
    s_barrier
    ds_read_b64_tr_b16 v[92:93], v15 offset:16384
    ds_read_b64_tr_b16 v[94:95], v15 offset:20480
    s_waitcnt lgkmcnt(6)
    v_mfma_f32_16x16x32_bf16 v[60:63], v[104:107], v[196:199], v[60:63]
    ds_read_b64_tr_b16 v[96:97], v16 offset:16416
    v_mfma_f32_16x16x32_bf16 v[64:67], v[104:107], v[200:203], v[64:67]
    s_bfe_u32 s22, s42, 0x30014
    s_or_b32 s22, s22, s62
    s_lshl_b32 s22, s22, 18
    s_add_u32 s22, s22, s16
    s_add_u32 s22, s22, 0x0
    s_add_u32 m0, s17, 0x8000
    s_nop 0
    buffer_load_dwordx4 v17, s[4:7], s22 offen lds
    ds_read_b64_tr_b16 v[98:99], v16 offset:20512
    s_add_u32 s23, s21, 0x1020800
    buffer_load_dwordx4 v[168:171], v4, s[8:11], s23 offen offset:1024 sc1
    s_waitcnt lgkmcnt(6)
    v_mfma_f32_16x16x32_bf16 v[68:71], v[84:87], v[196:199], v[68:71]
    ds_read_b64_tr_b16 v[100:101], v15 offset:16640
    v_mfma_f32_16x16x32_bf16 v[72:75], v[84:87], v[200:203], v[72:75]
    ds_read_b64_tr_b16 v[102:103], v15 offset:20736
    s_waitcnt lgkmcnt(6)
    v_mfma_f32_16x16x32_bf16 v[76:79], v[88:91], v[196:199], v[76:79]
    ds_read_b64_tr_b16 v[104:105], v16 offset:16672
    v_mfma_f32_16x16x32_bf16 v[80:83], v[88:91], v[200:203], v[80:83]
    s_bfe_u32 s22, s42, 0x30014
    s_or_b32 s22, s22, s62
    s_lshl_b32 s22, s22, 18
    s_add_u32 s22, s22, s16
    s_add_u32 s22, s22, 0x2000
    s_add_u32 m0, s17, 0x8400
    s_nop 0
    buffer_load_dwordx4 v18, s[4:7], s22 offen lds
    ds_read_b64_tr_b16 v[106:107], v16 offset:20768
    s_waitcnt vmcnt(22) lgkmcnt(6)
    v_mfma_f32_16x16x32_bf16 v[20:23], v[92:95], v[108:111], v[20:23]
    ds_read_b64_tr_b16 v[84:85], v15 offset:16896
    s_waitcnt vmcnt(20)
    v_mfma_f32_16x16x32_bf16 v[24:27], v[92:95], v[112:115], v[24:27]
    ds_read_b64_tr_b16 v[86:87], v15 offset:20992
    s_waitcnt lgkmcnt(6)
    v_mfma_f32_16x16x32_bf16 v[28:31], v[96:99], v[108:111], v[28:31]
    ds_read_b64_tr_b16 v[88:89], v16 offset:16928
    v_mfma_f32_16x16x32_bf16 v[32:35], v[96:99], v[112:115], v[32:35]
    s_bfe_u32 s22, s42, 0x30014
    s_or_b32 s22, s22, s62
    s_lshl_b32 s22, s22, 18
    s_add_u32 s22, s22, s16
    s_add_u32 s22, s22, 0x4000
    s_add_u32 m0, s17, 0x8800
    s_nop 0
    buffer_load_dwordx4 v17, s[4:7], s22 offen lds
    ds_read_b64_tr_b16 v[90:91], v16 offset:21024
    s_bfe_u32 s21, s42, 0x30010
    s_or_b32 s21, s21, s62
    s_lshl_b32 s21, s21, 12
    s_add_u32 s23, s21, 0x1000000
    buffer_load_dwordx4 v[188:191], v4, s[8:11], s23 offen offset:0 sc1
    s_waitcnt lgkmcnt(6)
    v_mfma_f32_16x16x32_bf16 v[36:39], v[100:103], v[108:111], v[36:39]
    ds_read_b64_tr_b16 v[92:93], v15 offset:17152
    v_mfma_f32_16x16x32_bf16 v[40:43], v[100:103], v[112:115], v[40:43]
    ds_read_b64_tr_b16 v[94:95], v15 offset:21248
    s_waitcnt lgkmcnt(6)
    v_mfma_f32_16x16x32_bf16 v[44:47], v[104:107], v[108:111], v[44:47]
    ds_read_b64_tr_b16 v[96:97], v16 offset:17184
    v_mfma_f32_16x16x32_bf16 v[48:51], v[104:107], v[112:115], v[48:51]
    s_bfe_u32 s22, s42, 0x30014
    s_or_b32 s22, s22, s62
    s_lshl_b32 s22, s22, 18
    s_add_u32 s22, s22, s16
    s_add_u32 s22, s22, 0x6000
    s_add_u32 m0, s17, 0x8c00
    s_nop 0
    buffer_load_dwordx4 v18, s[4:7], s22 offen lds
    ds_read_b64_tr_b16 v[98:99], v16 offset:21280
    s_waitcnt lgkmcnt(6)
    v_mfma_f32_16x16x32_bf16 v[52:55], v[84:87], v[108:111], v[52:55]
    ds_read_b64_tr_b16 v[100:101], v15 offset:24576
    v_mfma_f32_16x16x32_bf16 v[56:59], v[84:87], v[112:115], v[56:59]
    ds_read_b64_tr_b16 v[102:103], v15 offset:28672
    s_waitcnt lgkmcnt(6)
    v_mfma_f32_16x16x32_bf16 v[60:63], v[88:91], v[108:111], v[60:63]
    ds_read_b64_tr_b16 v[104:105], v16 offset:24608
    v_mfma_f32_16x16x32_bf16 v[64:67], v[88:91], v[112:115], v[64:67]
    ds_read_b64_tr_b16 v[106:107], v16 offset:28704
    s_add_u32 s23, s21, 0x1020000
    buffer_load_dwordx4 v[192:195], v4, s[8:11], s23 offen offset:0 sc1
    s_waitcnt lgkmcnt(6)
    v_mfma_f32_16x16x32_bf16 v[68:71], v[92:95], v[108:111], v[68:71]
    ds_read_b64_tr_b16 v[84:85], v15 offset:24832
    v_mfma_f32_16x16x32_bf16 v[72:75], v[92:95], v[112:115], v[72:75]
    ds_read_b64_tr_b16 v[86:87], v15 offset:28928
    s_waitcnt lgkmcnt(6)
    v_mfma_f32_16x16x32_bf16 v[76:79], v[96:99], v[108:111], v[76:79]
    ds_read_b64_tr_b16 v[88:89], v16 offset:24864
    v_mfma_f32_16x16x32_bf16 v[80:83], v[96:99], v[112:115], v[80:83]
    ds_read_b64_tr_b16 v[90:91], v16 offset:28960
    s_waitcnt vmcnt(23) lgkmcnt(6)
    v_mfma_f32_16x16x32_bf16 v[20:23], v[100:103], v[116:119], v[20:23]
    ds_read_b64_tr_b16 v[92:93], v15 offset:25088
    s_waitcnt vmcnt(21)
    v_mfma_f32_16x16x32_bf16 v[24:27], v[100:103], v[120:123], v[24:27]
    ds_read_b64_tr_b16 v[94:95], v15 offset:29184
    s_waitcnt lgkmcnt(6)
    v_mfma_f32_16x16x32_bf16 v[28:31], v[104:107], v[116:119], v[28:31]
    ds_read_b64_tr_b16 v[96:97], v16 offset:25120
    v_mfma_f32_16x16x32_bf16 v[32:35], v[104:107], v[120:123], v[32:35]
    ds_read_b64_tr_b16 v[98:99], v16 offset:29216
    s_add_u32 s23, s21, 0x1000000
    buffer_load_dwordx4 v[196:199], v4, s[8:11], s23 offen offset:1024 sc1
    s_waitcnt lgkmcnt(6)
    v_mfma_f32_16x16x32_bf16 v[36:39], v[84:87], v[116:119], v[36:39]
    ds_read_b64_tr_b16 v[100:101], v15 offset:25344
    v_mfma_f32_16x16x32_bf16 v[40:43], v[84:87], v[120:123], v[40:43]
    ds_read_b64_tr_b16 v[102:103], v15 offset:29440
    s_waitcnt lgkmcnt(6)
    v_mfma_f32_16x16x32_bf16 v[44:47], v[88:91], v[116:119], v[44:47]
    ds_read_b64_tr_b16 v[104:105], v16 offset:25376
    v_mfma_f32_16x16x32_bf16 v[48:51], v[88:91], v[120:123], v[48:51]
    ds_read_b64_tr_b16 v[106:107], v16 offset:29472
    s_waitcnt lgkmcnt(6)
    v_mfma_f32_16x16x32_bf16 v[52:55], v[92:95], v[116:119], v[52:55]
    v_mfma_f32_16x16x32_bf16 v[56:59], v[92:95], v[120:123], v[56:59]
    s_barrier
    ds_read_b64_tr_b16 v[84:85], v15 offset:32768
    ds_read_b64_tr_b16 v[86:87], v15 offset:36864
    s_waitcnt lgkmcnt(6)
    v_mfma_f32_16x16x32_bf16 v[60:63], v[96:99], v[116:119], v[60:63]
    ds_read_b64_tr_b16 v[88:89], v16 offset:32800
    v_mfma_f32_16x16x32_bf16 v[64:67], v[96:99], v[120:123], v[64:67]
    s_bfe_u32 s22, s42, 0x30014
    s_or_b32 s22, s22, s62
    s_lshl_b32 s22, s22, 18
    s_add_u32 s22, s22, s16
    s_add_u32 s22, s22, 0x20000
    s_add_u32 m0, s17, 0xc000
    s_nop 0
    buffer_load_dwordx4 v17, s[4:7], s22 offen lds
    ds_read_b64_tr_b16 v[90:91], v16 offset:36896
    s_add_u32 s23, s21, 0x1020000
    buffer_load_dwordx4 v[200:203], v4, s[8:11], s23 offen offset:1024 sc1
    s_waitcnt lgkmcnt(6)
    v_mfma_f32_16x16x32_bf16 v[68:71], v[100:103], v[116:119], v[68:71]
    ds_read_b64_tr_b16 v[92:93], v15 offset:33024
    v_mfma_f32_16x16x32_bf16 v[72:75], v[100:103], v[120:123], v[72:75]
    ds_read_b64_tr_b16 v[94:95], v15 offset:37120
    s_waitcnt lgkmcnt(6)
    v_mfma_f32_16x16x32_bf16 v[76:79], v[104:107], v[116:119], v[76:79]
    ds_read_b64_tr_b16 v[96:97], v16 offset:33056
    v_mfma_f32_16x16x32_bf16 v[80:83], v[104:107], v[120:123], v[80:83]
    s_bfe_u32 s22, s42, 0x30014
    s_or_b32 s22, s22, s62
    s_lshl_b32 s22, s22, 18
    s_add_u32 s22, s22, s16
    s_add_u32 s22, s22, 0x22000
    s_add_u32 m0, s17, 0xc400
    s_nop 0
    buffer_load_dwordx4 v18, s[4:7], s22 offen lds
    ds_read_b64_tr_b16 v[98:99], v16 offset:37152
    s_waitcnt vmcnt(22) lgkmcnt(6)
    v_mfma_f32_16x16x32_bf16 v[20:23], v[84:87], v[140:143], v[20:23]
    ds_read_b64_tr_b16 v[100:101], v15 offset:33280
    s_waitcnt vmcnt(20)
    v_mfma_f32_16x16x32_bf16 v[24:27], v[84:87], v[144:147], v[24:27]
    ds_read_b64_tr_b16 v[102:103], v15 offset:37376
    s_waitcnt lgkmcnt(6)
    v_mfma_f32_16x16x32_bf16 v[28:31], v[88:91], v[140:143], v[28:31]
    ds_read_b64_tr_b16 v[104:105], v16 offset:33312
    v_mfma_f32_16x16x32_bf16 v[32:35], v[88:91], v[144:147], v[32:35]
    s_bfe_u32 s22, s42, 0x30014
    s_or_b32 s22, s22, s62
    s_lshl_b32 s22, s22, 18
    s_add_u32 s22, s22, s16
    s_add_u32 s22, s22, 0x24000
    s_add_u32 m0, s17, 0xc800
    s_nop 0
    buffer_load_dwordx4 v17, s[4:7], s22 offen lds
    ds_read_b64_tr_b16 v[106:107], v16 offset:37408
    s_add_u32 s23, s21, 0x1000800
    buffer_load_dwordx4 v[108:111], v4, s[8:11], s23 offen offset:0 sc1
    s_waitcnt lgkmcnt(6)
    v_mfma_f32_16x16x32_bf16 v[36:39], v[92:95], v[140:143], v[36:39]
    ds_read_b64_tr_b16 v[84:85], v15 offset:33536
    v_mfma_f32_16x16x32_bf16 v[40:43], v[92:95], v[144:147], v[40:43]
    ds_read_b64_tr_b16 v[86:87], v15 offset:37632
    s_waitcnt lgkmcnt(6)
    v_mfma_f32_16x16x32_bf16 v[44:47], v[96:99], v[140:143], v[44:47]
    ds_read_b64_tr_b16 v[88:89], v16 offset:33568
    v_mfma_f32_16x16x32_bf16 v[48:51], v[96:99], v[144:147], v[48:51]
    s_bfe_u32 s22, s42, 0x30014
    s_or_b32 s22, s22, s62
    s_lshl_b32 s22, s22, 18
    s_add_u32 s22, s22, s16
    s_add_u32 s22, s22, 0x26000
    s_add_u32 m0, s17, 0xcc00
    s_nop 0
    buffer_load_dwordx4 v18, s[4:7], s22 offen lds
    ds_read_b64_tr_b16 v[90:91], v16 offset:37664
    s_waitcnt lgkmcnt(6)
    v_mfma_f32_16x16x32_bf16 v[52:55], v[100:103], v[140:143], v[52:55]
    ds_read_b64_tr_b16 v[92:93], v15 offset:40960
    v_mfma_f32_16x16x32_bf16 v[56:59], v[100:103], v[144:147], v[56:59]
    ds_read_b64_tr_b16 v[94:95], v15 offset:45056
    s_waitcnt lgkmcnt(6)
    v_mfma_f32_16x16x32_bf16 v[60:63], v[104:107], v[140:143], v[60:63]
    ds_read_b64_tr_b16 v[96:97], v16 offset:40992
    v_mfma_f32_16x16x32_bf16 v[64:67], v[104:107], v[144:147], v[64:67]
    ds_read_b64_tr_b16 v[98:99], v16 offset:45088
    s_add_u32 s23, s21, 0x1020800
    buffer_load_dwordx4 v[112:115], v4, s[8:11], s23 offen offset:0 sc1
    s_waitcnt lgkmcnt(6)
    v_mfma_f32_16x16x32_bf16 v[68:71], v[84:87], v[140:143], v[68:71]
    ds_read_b64_tr_b16 v[100:101], v15 offset:41216
    v_mfma_f32_16x16x32_bf16 v[72:75], v[84:87], v[144:147], v[72:75]
    ds_read_b64_tr_b16 v[102:103], v15 offset:45312
    s_waitcnt lgkmcnt(6)
    v_mfma_f32_16x16x32_bf16 v[76:79], v[88:91], v[140:143], v[76:79]
    ds_read_b64_tr_b16 v[104:105], v16 offset:41248
    v_mfma_f32_16x16x32_bf16 v[80:83], v[88:91], v[144:147], v[80:83]
    ds_read_b64_tr_b16 v[106:107], v16 offset:45344
    s_waitcnt vmcnt(23) lgkmcnt(6)
    v_mfma_f32_16x16x32_bf16 v[20:23], v[92:95], v[148:151], v[20:23]
    ds_read_b64_tr_b16 v[84:85], v15 offset:41472
    s_waitcnt vmcnt(21)
    v_mfma_f32_16x16x32_bf16 v[24:27], v[92:95], v[152:155], v[24:27]
    ds_read_b64_tr_b16 v[86:87], v15 offset:45568
    s_waitcnt lgkmcnt(6)
    v_mfma_f32_16x16x32_bf16 v[28:31], v[96:99], v[148:151], v[28:31]
    ds_read_b64_tr_b16 v[88:89], v16 offset:41504
    v_mfma_f32_16x16x32_bf16 v[32:35], v[96:99], v[152:155], v[32:35]
    ds_read_b64_tr_b16 v[90:91], v16 offset:45600
    s_add_u32 s23, s21, 0x1000800
    buffer_load_dwordx4 v[116:119], v4, s[8:11], s23 offen offset:1024 sc1
    s_waitcnt lgkmcnt(6)
    v_mfma_f32_16x16x32_bf16 v[36:39], v[100:103], v[148:151], v[36:39]
    ds_read_b64_tr_b16 v[92:93], v15 offset:41728
    v_mfma_f32_16x16x32_bf16 v[40:43], v[100:103], v[152:155], v[40:43]
    ds_read_b64_tr_b16 v[94:95], v15 offset:45824
    s_waitcnt lgkmcnt(6)
    v_mfma_f32_16x16x32_bf16 v[44:47], v[104:107], v[148:151], v[44:47]
    ds_read_b64_tr_b16 v[96:97], v16 offset:41760
    v_mfma_f32_16x16x32_bf16 v[48:51], v[104:107], v[152:155], v[48:51]
    ds_read_b64_tr_b16 v[98:99], v16 offset:45856
    s_waitcnt lgkmcnt(6)
    v_mfma_f32_16x16x32_bf16 v[52:55], v[84:87], v[148:151], v[52:55]
    v_mfma_f32_16x16x32_bf16 v[56:59], v[84:87], v[152:155], v[56:59]
    s_barrier
    ds_read_b64_tr_b16 v[100:101], v15 offset:49152
    ds_read_b64_tr_b16 v[102:103], v15 offset:53248
    s_waitcnt lgkmcnt(6)
    v_mfma_f32_16x16x32_bf16 v[60:63], v[88:91], v[148:151], v[60:63]
    ds_read_b64_tr_b16 v[104:105], v16 offset:49184
    v_mfma_f32_16x16x32_bf16 v[64:67], v[88:91], v[152:155], v[64:67]
    s_bfe_u32 s22, s42, 0x30018
    s_or_b32 s22, s22, s62
    s_lshl_b32 s22, s22, 18
    s_add_u32 s22, s22, s16
    s_add_u32 s22, s22, 0x0
    s_add_u32 m0, s17, 0x10000
    s_nop 0
    buffer_load_dwordx4 v17, s[4:7], s22 offen lds
    ds_read_b64_tr_b16 v[106:107], v16 offset:53280
    s_add_u32 s23, s21, 0x1020800
    buffer_load_dwordx4 v[120:123], v4, s[8:11], s23 offen offset:1024 sc1
    s_waitcnt lgkmcnt(6)
    v_mfma_f32_16x16x32_bf16 v[68:71], v[92:95], v[148:151], v[68:71]
    ds_read_b64_tr_b16 v[84:85], v15 offset:49408
    v_mfma_f32_16x16x32_bf16 v[72:75], v[92:95], v[152:155], v[72:75]
    ds_read_b64_tr_b16 v[86:87], v15 offset:53504
    s_waitcnt lgkmcnt(6)
    v_mfma_f32_16x16x32_bf16 v[76:79], v[96:99], v[148:151], v[76:79]
    ds_read_b64_tr_b16 v[88:89], v16 offset:49440
    v_mfma_f32_16x16x32_bf16 v[80:83], v[96:99], v[152:155], v[80:83]
    s_bfe_u32 s22, s42, 0x30018
    s_or_b32 s22, s22, s62
    s_lshl_b32 s22, s22, 18
    s_add_u32 s22, s22, s16
    s_add_u32 s22, s22, 0x2000
    s_add_u32 m0, s17, 0x10400
    s_nop 0
    buffer_load_dwordx4 v18, s[4:7], s22 offen lds
    ds_read_b64_tr_b16 v[90:91], v16 offset:53536
    s_waitcnt vmcnt(22) lgkmcnt(6)
    v_mfma_f32_16x16x32_bf16 v[20:23], v[100:103], v[156:159], v[20:23]
    ds_read_b64_tr_b16 v[92:93], v15 offset:49664
    s_waitcnt vmcnt(20)
    v_mfma_f32_16x16x32_bf16 v[24:27], v[100:103], v[160:163], v[24:27]
    ds_read_b64_tr_b16 v[94:95], v15 offset:53760
    s_waitcnt lgkmcnt(6)
    v_mfma_f32_16x16x32_bf16 v[28:31], v[104:107], v[156:159], v[28:31]
    ds_read_b64_tr_b16 v[96:97], v16 offset:49696
    v_mfma_f32_16x16x32_bf16 v[32:35], v[104:107], v[160:163], v[32:35]
    s_bfe_u32 s22, s42, 0x30018
    s_or_b32 s22, s22, s62
    s_lshl_b32 s22, s22, 18
    s_add_u32 s22, s22, s16
    s_add_u32 s22, s22, 0x4000
    s_add_u32 m0, s17, 0x10800
    s_nop 0
    buffer_load_dwordx4 v17, s[4:7], s22 offen lds
    ds_read_b64_tr_b16 v[98:99], v16 offset:53792
    s_bfe_u32 s21, s42, 0x30014
    s_or_b32 s21, s21, s62
    s_lshl_b32 s21, s21, 12
    s_add_u32 s23, s21, 0x1000000
    buffer_load_dwordx4 v[140:143], v4, s[8:11], s23 offen offset:0 sc1
    s_waitcnt lgkmcnt(6)
    v_mfma_f32_16x16x32_bf16 v[36:39], v[84:87], v[156:159], v[36:39]
    ds_read_b64_tr_b16 v[100:101], v15 offset:49920
    v_mfma_f32_16x16x32_bf16 v[40:43], v[84:87], v[160:163], v[40:43]
    ds_read_b64_tr_b16 v[102:103], v15 offset:54016
    buffer_load_dword v10, v9, s[8:11], s20 offen sc1
    s_waitcnt lgkmcnt(6)
    v_mfma_f32_16x16x32_bf16 v[44:47], v[88:91], v[156:159], v[44:47]
    ds_read_b64_tr_b16 v[104:105], v16 offset:49952
    v_mfma_f32_16x16x32_bf16 v[48:51], v[88:91], v[160:163], v[48:51]
    s_bfe_u32 s22, s42, 0x30018
    s_or_b32 s22, s22, s62
    s_lshl_b32 s22, s22, 18
    s_add_u32 s22, s22, s16
    s_add_u32 s22, s22, 0x6000
    s_add_u32 m0, s17, 0x10c00
    s_nop 0
    buffer_load_dwordx4 v18, s[4:7], s22 offen lds
    ds_read_b64_tr_b16 v[106:107], v16 offset:54048
    s_waitcnt lgkmcnt(6)
    v_mfma_f32_16x16x32_bf16 v[52:55], v[92:95], v[156:159], v[52:55]
    ds_read_b64_tr_b16 v[84:85], v15 offset:57344
    v_mfma_f32_16x16x32_bf16 v[56:59], v[92:95], v[160:163], v[56:59]
    ds_read_b64_tr_b16 v[86:87], v15 offset:61440
    s_waitcnt lgkmcnt(6)
    v_mfma_f32_16x16x32_bf16 v[60:63], v[96:99], v[156:159], v[60:63]
    ds_read_b64_tr_b16 v[88:89], v16 offset:57376
    v_mfma_f32_16x16x32_bf16 v[64:67], v[96:99], v[160:163], v[64:67]
    ds_read_b64_tr_b16 v[90:91], v16 offset:61472
    s_add_u32 s23, s21, 0x1020000
    buffer_load_dwordx4 v[144:147], v4, s[8:11], s23 offen offset:0 sc1
    s_waitcnt lgkmcnt(6)
    v_mfma_f32_16x16x32_bf16 v[68:71], v[100:103], v[156:159], v[68:71]
    ds_read_b64_tr_b16 v[92:93], v15 offset:57600
    v_mfma_f32_16x16x32_bf16 v[72:75], v[100:103], v[160:163], v[72:75]
    ds_read_b64_tr_b16 v[94:95], v15 offset:61696
    s_waitcnt lgkmcnt(6)
    v_mfma_f32_16x16x32_bf16 v[76:79], v[104:107], v[156:159], v[76:79]
    ds_read_b64_tr_b16 v[96:97], v16 offset:57632
    v_mfma_f32_16x16x32_bf16 v[80:83], v[104:107], v[160:163], v[80:83]
    ds_read_b64_tr_b16 v[98:99], v16 offset:61728
    s_waitcnt vmcnt(24) lgkmcnt(6)
    v_mfma_f32_16x16x32_bf16 v[20:23], v[84:87], v[164:167], v[20:23]
    ds_read_b64_tr_b16 v[100:101], v15 offset:57856
    s_waitcnt vmcnt(22)
    v_mfma_f32_16x16x32_bf16 v[24:27], v[84:87], v[168:171], v[24:27]
    ds_read_b64_tr_b16 v[102:103], v15 offset:61952
    s_waitcnt lgkmcnt(6)
    v_mfma_f32_16x16x32_bf16 v[28:31], v[88:91], v[164:167], v[28:31]
    ds_read_b64_tr_b16 v[104:105], v16 offset:57888
    v_mfma_f32_16x16x32_bf16 v[32:35], v[88:91], v[168:171], v[32:35]
    ds_read_b64_tr_b16 v[106:107], v16 offset:61984
    s_add_u32 s23, s21, 0x1000000
    buffer_load_dwordx4 v[148:151], v4, s[8:11], s23 offen offset:1024 sc1
    s_waitcnt lgkmcnt(6)
    v_mfma_f32_16x16x32_bf16 v[36:39], v[92:95], v[164:167], v[36:39]
    ds_read_b64_tr_b16 v[84:85], v15 offset:58112
    v_mfma_f32_16x16x32_bf16 v[40:43], v[92:95], v[168:171], v[40:43]
    ds_read_b64_tr_b16 v[86:87], v15 offset:62208
    s_waitcnt lgkmcnt(6)
    v_mfma_f32_16x16x32_bf16 v[44:47], v[96:99], v[164:167], v[44:47]
    ds_read_b64_tr_b16 v[88:89], v16 offset:58144
    v_mfma_f32_16x16x32_bf16 v[48:51], v[96:99], v[168:171], v[48:51]
    ds_read_b64_tr_b16 v[90:91], v16 offset:62240
    s_waitcnt lgkmcnt(6)
    v_mfma_f32_16x16x32_bf16 v[52:55], v[100:103], v[164:167], v[52:55]
    v_mfma_f32_16x16x32_bf16 v[56:59], v[100:103], v[168:171], v[56:59]
    s_barrier
    ds_read_b64_tr_b16 v[92:93], v3 offset:0
    ds_read_b64_tr_b16 v[94:95], v3 offset:4096
    s_waitcnt lgkmcnt(6)
    v_mfma_f32_16x16x32_bf16 v[60:63], v[104:107], v[164:167], v[60:63]
    ds_read_b64_tr_b16 v[96:97], v2 offset:32
    v_mfma_f32_16x16x32_bf16 v[64:67], v[104:107], v[168:171], v[64:67]
    s_bfe_u32 s22, s42, 0x30018
    s_or_b32 s22, s22, s62
    s_lshl_b32 s22, s22, 18
    s_add_u32 s22, s22, s16
    s_add_u32 s22, s22, 0x20000
    s_add_u32 m0, s17, 0x14000
    s_nop 0
    buffer_load_dwordx4 v17, s[4:7], s22 offen lds
    ds_read_b64_tr_b16 v[98:99], v2 offset:4128
    s_add_u32 s23, s21, 0x1020000
    buffer_load_dwordx4 v[152:155], v4, s[8:11], s23 offen offset:1024 sc1
    s_waitcnt lgkmcnt(6)
    v_mfma_f32_16x16x32_bf16 v[68:71], v[84:87], v[164:167], v[68:71]
    ds_read_b64_tr_b16 v[100:101], v3 offset:256
    v_mfma_f32_16x16x32_bf16 v[72:75], v[84:87], v[168:171], v[72:75]
    ds_read_b64_tr_b16 v[102:103], v3 offset:4352
    s_waitcnt lgkmcnt(6)
    v_mfma_f32_16x16x32_bf16 v[76:79], v[88:91], v[164:167], v[76:79]
    ds_read_b64_tr_b16 v[104:105], v2 offset:288
    v_mfma_f32_16x16x32_bf16 v[80:83], v[88:91], v[168:171], v[80:83]
    s_bfe_u32 s22, s42, 0x30018
    s_or_b32 s22, s22, s62
    s_lshl_b32 s22, s22, 18
    s_add_u32 s22, s22, s16
    s_add_u32 s22, s22, 0x22000
    s_add_u32 m0, s17, 0x14400
    s_nop 0
    buffer_load_dwordx4 v18, s[4:7], s22 offen lds
    ds_read_b64_tr_b16 v[106:107], v2 offset:4384
    s_waitcnt vmcnt(23) lgkmcnt(6)
    v_mfma_f32_16x16x32_bf16 v[20:23], v[92:95], v[188:191], v[20:23]
    ds_read_b64_tr_b16 v[84:85], v3 offset:512
    s_waitcnt vmcnt(21)
    v_mfma_f32_16x16x32_bf16 v[24:27], v[92:95], v[192:195], v[24:27]
    ds_read_b64_tr_b16 v[86:87], v3 offset:4608
    s_waitcnt lgkmcnt(6)
    v_mfma_f32_16x16x32_bf16 v[28:31], v[96:99], v[188:191], v[28:31]
    ds_read_b64_tr_b16 v[88:89], v2 offset:544
    v_mfma_f32_16x16x32_bf16 v[32:35], v[96:99], v[192:195], v[32:35]
    s_bfe_u32 s22, s42, 0x30018
    s_or_b32 s22, s22, s62
    s_lshl_b32 s22, s22, 18
    s_add_u32 s22, s22, s16
    s_add_u32 s22, s22, 0x24000
    s_add_u32 m0, s17, 0x14800
    s_nop 0
    buffer_load_dwordx4 v17, s[4:7], s22 offen lds
    ds_read_b64_tr_b16 v[90:91], v2 offset:4640
    s_add_u32 s23, s21, 0x1000800
    buffer_load_dwordx4 v[156:159], v4, s[8:11], s23 offen offset:0 sc1
    s_waitcnt lgkmcnt(6)
    v_mfma_f32_16x16x32_bf16 v[36:39], v[100:103], v[188:191], v[36:39]
    ds_read_b64_tr_b16 v[92:93], v3 offset:768
    v_mfma_f32_16x16x32_bf16 v[40:43], v[100:103], v[192:195], v[40:43]
    ds_read_b64_tr_b16 v[94:95], v3 offset:4864
    s_waitcnt lgkmcnt(6)
    v_mfma_f32_16x16x32_bf16 v[44:47], v[104:107], v[188:191], v[44:47]
    ds_read_b64_tr_b16 v[96:97], v2 offset:800
    v_mfma_f32_16x16x32_bf16 v[48:51], v[104:107], v[192:195], v[48:51]
    s_bfe_u32 s22, s42, 0x30018
    s_or_b32 s22, s22, s62
    s_lshl_b32 s22, s22, 18
    s_add_u32 s22, s22, s16
    s_add_u32 s22, s22, 0x26000
    s_add_u32 m0, s17, 0x14c00
    s_nop 0
    buffer_load_dwordx4 v18, s[4:7], s22 offen lds
    ds_read_b64_tr_b16 v[98:99], v2 offset:4896
    s_waitcnt lgkmcnt(6)
    v_mfma_f32_16x16x32_bf16 v[52:55], v[84:87], v[188:191], v[52:55]
    ds_read_b64_tr_b16 v[100:101], v3 offset:8192
    v_mfma_f32_16x16x32_bf16 v[56:59], v[84:87], v[192:195], v[56:59]
    ds_read_b64_tr_b16 v[102:103], v3 offset:12288
    s_waitcnt lgkmcnt(6)
    v_mfma_f32_16x16x32_bf16 v[60:63], v[88:91], v[188:191], v[60:63]
    ds_read_b64_tr_b16 v[104:105], v2 offset:8224
    v_mfma_f32_16x16x32_bf16 v[64:67], v[88:91], v[192:195], v[64:67]
    ds_read_b64_tr_b16 v[106:107], v2 offset:12320
    s_add_u32 s23, s21, 0x1020800
    buffer_load_dwordx4 v[160:163], v4, s[8:11], s23 offen offset:0 sc1
    s_waitcnt lgkmcnt(6)
    v_mfma_f32_16x16x32_bf16 v[68:71], v[92:95], v[188:191], v[68:71]
    ds_read_b64_tr_b16 v[84:85], v3 offset:8448
    v_mfma_f32_16x16x32_bf16 v[72:75], v[92:95], v[192:195], v[72:75]
    ds_read_b64_tr_b16 v[86:87], v3 offset:12544
    s_waitcnt lgkmcnt(6)
    v_mfma_f32_16x16x32_bf16 v[76:79], v[96:99], v[188:191], v[76:79]
    ds_read_b64_tr_b16 v[88:89], v2 offset:8480
    v_mfma_f32_16x16x32_bf16 v[80:83], v[96:99], v[192:195], v[80:83]
    ds_read_b64_tr_b16 v[90:91], v2 offset:12576
    s_waitcnt vmcnt(24) lgkmcnt(6)
    v_mfma_f32_16x16x32_bf16 v[20:23], v[100:103], v[196:199], v[20:23]
    ds_read_b64_tr_b16 v[92:93], v3 offset:8704
    s_waitcnt vmcnt(22)
    v_mfma_f32_16x16x32_bf16 v[24:27], v[100:103], v[200:203], v[24:27]
    ds_read_b64_tr_b16 v[94:95], v3 offset:12800
    s_waitcnt lgkmcnt(6)
    v_mfma_f32_16x16x32_bf16 v[28:31], v[104:107], v[196:199], v[28:31]
    ds_read_b64_tr_b16 v[96:97], v2 offset:8736
    v_mfma_f32_16x16x32_bf16 v[32:35], v[104:107], v[200:203], v[32:35]
    ds_read_b64_tr_b16 v[98:99], v2 offset:12832
    s_add_u32 s23, s21, 0x1000800
    buffer_load_dwordx4 v[164:167], v4, s[8:11], s23 offen offset:1024 sc1
    s_waitcnt lgkmcnt(6)
    v_mfma_f32_16x16x32_bf16 v[36:39], v[84:87], v[196:199], v[36:39]
    ds_read_b64_tr_b16 v[100:101], v3 offset:8960
    v_mfma_f32_16x16x32_bf16 v[40:43], v[84:87], v[200:203], v[40:43]
    ds_read_b64_tr_b16 v[102:103], v3 offset:13056
    s_waitcnt lgkmcnt(6)
    v_mfma_f32_16x16x32_bf16 v[44:47], v[88:91], v[196:199], v[44:47]
    ds_read_b64_tr_b16 v[104:105], v2 offset:8992
    v_mfma_f32_16x16x32_bf16 v[48:51], v[88:91], v[200:203], v[48:51]
    ds_read_b64_tr_b16 v[106:107], v2 offset:13088
    s_waitcnt lgkmcnt(6)
    v_mfma_f32_16x16x32_bf16 v[52:55], v[92:95], v[196:199], v[52:55]
    v_mfma_f32_16x16x32_bf16 v[56:59], v[92:95], v[200:203], v[56:59]
    s_barrier
    ds_read_b64_tr_b16 v[84:85], v3 offset:16384
    ds_read_b64_tr_b16 v[86:87], v3 offset:20480
    s_waitcnt lgkmcnt(6)
    v_mfma_f32_16x16x32_bf16 v[60:63], v[96:99], v[196:199], v[60:63]
    ds_read_b64_tr_b16 v[88:89], v2 offset:16416
    v_mfma_f32_16x16x32_bf16 v[64:67], v[96:99], v[200:203], v[64:67]
    s_bfe_u32 s22, s42, 0x3001c
    s_or_b32 s22, s22, s62
    s_lshl_b32 s22, s22, 18
    s_add_u32 s22, s22, s16
    s_add_u32 s22, s22, 0x0
    s_add_u32 m0, s17, 0x18000
    s_nop 0
    buffer_load_dwordx4 v17, s[4:7], s22 offen lds
    ds_read_b64_tr_b16 v[90:91], v2 offset:20512
    s_add_u32 s23, s21, 0x1020800
    buffer_load_dwordx4 v[168:171], v4, s[8:11], s23 offen offset:1024 sc1
    s_waitcnt lgkmcnt(6)
    v_mfma_f32_16x16x32_bf16 v[68:71], v[100:103], v[196:199], v[68:71]
    ds_read_b64_tr_b16 v[92:93], v3 offset:16640
    v_mfma_f32_16x16x32_bf16 v[72:75], v[100:103], v[200:203], v[72:75]
    ds_read_b64_tr_b16 v[94:95], v3 offset:20736
    s_waitcnt lgkmcnt(6)
    v_mfma_f32_16x16x32_bf16 v[76:79], v[104:107], v[196:199], v[76:79]
    ds_read_b64_tr_b16 v[96:97], v2 offset:16672
    v_mfma_f32_16x16x32_bf16 v[80:83], v[104:107], v[200:203], v[80:83]
    s_bfe_u32 s22, s42, 0x3001c
    s_or_b32 s22, s22, s62
    s_lshl_b32 s22, s22, 18
    s_add_u32 s22, s22, s16
    s_add_u32 s22, s22, 0x2000
    s_add_u32 m0, s17, 0x18400
    s_nop 0
    buffer_load_dwordx4 v18, s[4:7], s22 offen lds
    ds_read_b64_tr_b16 v[98:99], v2 offset:20768
    s_waitcnt vmcnt(14)
    v_cmp_ne_u32 vcc, s14, v10
    s_cbranch_vccz fz_o2gA
    s_mov_b32 s27, 0
fz_o2pA:
    buffer_load_dword v10, v9, s[8:11], s20 offen sc1
    s_waitcnt vmcnt(0)
    v_cmp_ne_u32 vcc, s14, v10
    s_add_u32 s27, s27, 1
    s_cmp_ge_u32 s27, 65536
    s_nop 4
    s_cbranch_scc1 fz_o2gA
    s_cbranch_vccnz fz_o2pA
fz_o2gA:
    s_waitcnt lgkmcnt(6)
    v_mfma_f32_16x16x32_bf16 v[20:23], v[84:87], v[108:111], v[20:23]
    ds_read_b64_tr_b16 v[100:101], v3 offset:16896
    v_mfma_f32_16x16x32_bf16 v[24:27], v[84:87], v[112:115], v[24:27]
    ds_read_b64_tr_b16 v[102:103], v3 offset:20992
    s_waitcnt lgkmcnt(6)
    v_mfma_f32_16x16x32_bf16 v[28:31], v[88:91], v[108:111], v[28:31]
    ds_read_b64_tr_b16 v[104:105], v2 offset:16928
    v_mfma_f32_16x16x32_bf16 v[32:35], v[88:91], v[112:115], v[32:35]
    s_bfe_u32 s22, s42, 0x3001c
    s_or_b32 s22, s22, s62
    s_lshl_b32 s22, s22, 18
    s_add_u32 s22, s22, s16
    s_add_u32 s22, s22, 0x4000
    s_add_u32 m0, s17, 0x18800
    s_nop 0
    buffer_load_dwordx4 v17, s[4:7], s22 offen lds
    ds_read_b64_tr_b16 v[106:107], v2 offset:21024
    s_bfe_u32 s21, s42, 0x30018
    s_or_b32 s21, s21, s62
    s_lshl_b32 s21, s21, 12
    s_add_u32 s23, s21, 0x1000000
    buffer_load_dwordx4 v[188:191], v4, s[8:11], s23 offen offset:0 sc1
    s_waitcnt lgkmcnt(6)
    v_mfma_f32_16x16x32_bf16 v[36:39], v[92:95], v[108:111], v[36:39]
    ds_read_b64_tr_b16 v[84:85], v3 offset:17152
    v_mfma_f32_16x16x32_bf16 v[40:43], v[92:95], v[112:115], v[40:43]
    ds_read_b64_tr_b16 v[86:87], v3 offset:21248
    s_waitcnt lgkmcnt(6)
    v_mfma_f32_16x16x32_bf16 v[44:47], v[96:99], v[108:111], v[44:47]
    ds_read_b64_tr_b16 v[88:89], v2 offset:17184
    v_mfma_f32_16x16x32_bf16 v[48:51], v[96:99], v[112:115], v[48:51]
    s_bfe_u32 s22, s42, 0x3001c
    s_or_b32 s22, s22, s62
    s_lshl_b32 s22, s22, 18
    s_add_u32 s22, s22, s16
    s_add_u32 s22, s22, 0x6000
    s_add_u32 m0, s17, 0x18c00
    s_nop 0
    buffer_load_dwordx4 v18, s[4:7], s22 offen lds
    ds_read_b64_tr_b16 v[90:91], v2 offset:21280
    s_waitcnt lgkmcnt(6)
    v_mfma_f32_16x16x32_bf16 v[52:55], v[100:103], v[108:111], v[52:55]
    ds_read_b64_tr_b16 v[92:93], v3 offset:24576
    v_mfma_f32_16x16x32_bf16 v[56:59], v[100:103], v[112:115], v[56:59]
    ds_read_b64_tr_b16 v[94:95], v3 offset:28672
    s_waitcnt lgkmcnt(6)
    v_mfma_f32_16x16x32_bf16 v[60:63], v[104:107], v[108:111], v[60:63]
    ds_read_b64_tr_b16 v[96:97], v2 offset:24608
    v_mfma_f32_16x16x32_bf16 v[64:67], v[104:107], v[112:115], v[64:67]
    ds_read_b64_tr_b16 v[98:99], v2 offset:28704
    s_add_u32 s23, s21, 0x1020000
    buffer_load_dwordx4 v[192:195], v4, s[8:11], s23 offen offset:0 sc1
    s_waitcnt lgkmcnt(6)
    v_mfma_f32_16x16x32_bf16 v[68:71], v[84:87], v[108:111], v[68:71]
    ds_read_b64_tr_b16 v[100:101], v3 offset:24832
    v_mfma_f32_16x16x32_bf16 v[72:75], v[84:87], v[112:115], v[72:75]
    ds_read_b64_tr_b16 v[102:103], v3 offset:28928
    s_waitcnt lgkmcnt(6)
    v_mfma_f32_16x16x32_bf16 v[76:79], v[88:91], v[108:111], v[76:79]
    ds_read_b64_tr_b16 v[104:105], v2 offset:24864
    v_mfma_f32_16x16x32_bf16 v[80:83], v[88:91], v[112:115], v[80:83]
    ds_read_b64_tr_b16 v[106:107], v2 offset:28960
    s_waitcnt lgkmcnt(6)
    v_mfma_f32_16x16x32_bf16 v[20:23], v[92:95], v[116:119], v[20:23]
    ds_read_b64_tr_b16 v[84:85], v3 offset:25088
    v_mfma_f32_16x16x32_bf16 v[24:27], v[92:95], v[120:123], v[24:27]
    ds_read_b64_tr_b16 v[86:87], v3 offset:29184
    s_waitcnt lgkmcnt(6)
    v_mfma_f32_16x16x32_bf16 v[28:31], v[96:99], v[116:119], v[28:31]
    ds_read_b64_tr_b16 v[88:89], v2 offset:25120
    v_mfma_f32_16x16x32_bf16 v[32:35], v[96:99], v[120:123], v[32:35]
    ds_read_b64_tr_b16 v[90:91], v2 offset:29216
    s_add_u32 s23, s21, 0x1000000
    buffer_load_dwordx4 v[196:199], v4, s[8:11], s23 offen offset:1024 sc1
    s_waitcnt lgkmcnt(6)
    v_mfma_f32_16x16x32_bf16 v[36:39], v[100:103], v[116:119], v[36:39]
    ds_read_b64_tr_b16 v[92:93], v3 offset:25344
    v_mfma_f32_16x16x32_bf16 v[40:43], v[100:103], v[120:123], v[40:43]
    ds_read_b64_tr_b16 v[94:95], v3 offset:29440
    s_waitcnt lgkmcnt(6)
    v_mfma_f32_16x16x32_bf16 v[44:47], v[104:107], v[116:119], v[44:47]
    ds_read_b64_tr_b16 v[96:97], v2 offset:25376
    v_mfma_f32_16x16x32_bf16 v[48:51], v[104:107], v[120:123], v[48:51]
    ds_read_b64_tr_b16 v[98:99], v2 offset:29472
    s_waitcnt lgkmcnt(6)
    v_mfma_f32_16x16x32_bf16 v[52:55], v[84:87], v[116:119], v[52:55]
    v_mfma_f32_16x16x32_bf16 v[56:59], v[84:87], v[120:123], v[56:59]
    s_barrier
    ds_read_b64_tr_b16 v[100:101], v3 offset:32768
    ds_read_b64_tr_b16 v[102:103], v3 offset:36864
    s_waitcnt lgkmcnt(6)
    v_mfma_f32_16x16x32_bf16 v[60:63], v[88:91], v[116:119], v[60:63]
    ds_read_b64_tr_b16 v[104:105], v2 offset:32800
    v_mfma_f32_16x16x32_bf16 v[64:67], v[88:91], v[120:123], v[64:67]
    s_bfe_u32 s22, s42, 0x3001c
    s_or_b32 s22, s22, s62
    s_lshl_b32 s22, s22, 18
    s_add_u32 s22, s22, s16
    s_add_u32 s22, s22, 0x20000
    s_add_u32 m0, s17, 0x1c000
    s_nop 0
    buffer_load_dwordx4 v17, s[4:7], s22 offen lds
    ds_read_b64_tr_b16 v[106:107], v2 offset:36896
    s_add_u32 s23, s21, 0x1020000
    buffer_load_dwordx4 v[200:203], v4, s[8:11], s23 offen offset:1024 sc1
    s_waitcnt lgkmcnt(6)
    v_mfma_f32_16x16x32_bf16 v[68:71], v[92:95], v[116:119], v[68:71]
    ds_read_b64_tr_b16 v[84:85], v3 offset:33024
    v_mfma_f32_16x16x32_bf16 v[72:75], v[92:95], v[120:123], v[72:75]
    ds_read_b64_tr_b16 v[86:87], v3 offset:37120
    s_waitcnt lgkmcnt(6)
    v_mfma_f32_16x16x32_bf16 v[76:79], v[96:99], v[116:119], v[76:79]
    ds_read_b64_tr_b16 v[88:89], v2 offset:33056
    v_mfma_f32_16x16x32_bf16 v[80:83], v[96:99], v[120:123], v[80:83]
    s_bfe_u32 s22, s42, 0x3001c
    s_or_b32 s22, s22, s62
    s_lshl_b32 s22, s22, 18
    s_add_u32 s22, s22, s16
    s_add_u32 s22, s22, 0x22000
    s_add_u32 m0, s17, 0x1c400
    s_nop 0
    buffer_load_dwordx4 v18, s[4:7], s22 offen lds
    ds_read_b64_tr_b16 v[90:91], v2 offset:37152
    s_waitcnt lgkmcnt(6)
    v_mfma_f32_16x16x32_bf16 v[20:23], v[100:103], v[140:143], v[20:23]
    ds_read_b64_tr_b16 v[92:93], v3 offset:33280
    s_waitcnt vmcnt(20)
    v_mfma_f32_16x16x32_bf16 v[24:27], v[100:103], v[144:147], v[24:27]
    ds_read_b64_tr_b16 v[94:95], v3 offset:37376
    s_waitcnt lgkmcnt(6)
    v_mfma_f32_16x16x32_bf16 v[28:31], v[104:107], v[140:143], v[28:31]
    ds_read_b64_tr_b16 v[96:97], v2 offset:33312
    v_mfma_f32_16x16x32_bf16 v[32:35], v[104:107], v[144:147], v[32:35]
    s_bfe_u32 s22, s42, 0x3001c
    s_or_b32 s22, s22, s62
    s_lshl_b32 s22, s22, 18
    s_add_u32 s22, s22, s16
    s_add_u32 s22, s22, 0x24000
    s_add_u32 m0, s17, 0x1c800
    s_nop 0
    buffer_load_dwordx4 v17, s[4:7], s22 offen lds
    ds_read_b64_tr_b16 v[98:99], v2 offset:37408
    s_add_u32 s23, s21, 0x1000800
    buffer_load_dwordx4 v[108:111], v4, s[8:11], s23 offen offset:0 sc1
    s_waitcnt lgkmcnt(6)
    v_mfma_f32_16x16x32_bf16 v[36:39], v[84:87], v[140:143], v[36:39]
    ds_read_b64_tr_b16 v[100:101], v3 offset:33536
    v_mfma_f32_16x16x32_bf16 v[40:43], v[84:87], v[144:147], v[40:43]
    ds_read_b64_tr_b16 v[102:103], v3 offset:37632
    s_waitcnt lgkmcnt(6)
    v_mfma_f32_16x16x32_bf16 v[44:47], v[88:91], v[140:143], v[44:47]
    ds_read_b64_tr_b16 v[104:105], v2 offset:33568
    v_mfma_f32_16x16x32_bf16 v[48:51], v[88:91], v[144:147], v[48:51]
    s_bfe_u32 s22, s42, 0x3001c
    s_or_b32 s22, s22, s62
    s_lshl_b32 s22, s22, 18
    s_add_u32 s22, s22, s16
    s_add_u32 s22, s22, 0x26000
    s_add_u32 m0, s17, 0x1cc00
    s_nop 0
    buffer_load_dwordx4 v18, s[4:7], s22 offen lds
    ds_read_b64_tr_b16 v[106:107], v2 offset:37664
    s_waitcnt lgkmcnt(6)
    v_mfma_f32_16x16x32_bf16 v[52:55], v[92:95], v[140:143], v[52:55]
    ds_read_b64_tr_b16 v[84:85], v3 offset:40960
    v_mfma_f32_16x16x32_bf16 v[56:59], v[92:95], v[144:147], v[56:59]
    ds_read_b64_tr_b16 v[86:87], v3 offset:45056
    s_waitcnt lgkmcnt(6)
    v_mfma_f32_16x16x32_bf16 v[60:63], v[96:99], v[140:143], v[60:63]
    ds_read_b64_tr_b16 v[88:89], v2 offset:40992
    v_mfma_f32_16x16x32_bf16 v[64:67], v[96:99], v[144:147], v[64:67]
    ds_read_b64_tr_b16 v[90:91], v2 offset:45088
    s_add_u32 s23, s21, 0x1020800
    buffer_load_dwordx4 v[112:115], v4, s[8:11], s23 offen offset:0 sc1
    s_waitcnt lgkmcnt(6)
    v_mfma_f32_16x16x32_bf16 v[68:71], v[100:103], v[140:143], v[68:71]
    ds_read_b64_tr_b16 v[92:93], v3 offset:41216
    v_mfma_f32_16x16x32_bf16 v[72:75], v[100:103], v[144:147], v[72:75]
    ds_read_b64_tr_b16 v[94:95], v3 offset:45312
    s_waitcnt lgkmcnt(6)
    v_mfma_f32_16x16x32_bf16 v[76:79], v[104:107], v[140:143], v[76:79]
    ds_read_b64_tr_b16 v[96:97], v2 offset:41248
    v_mfma_f32_16x16x32_bf16 v[80:83], v[104:107], v[144:147], v[80:83]
    ds_read_b64_tr_b16 v[98:99], v2 offset:45344
    s_waitcnt vmcnt(23) lgkmcnt(6)
    v_mfma_f32_16x16x32_bf16 v[20:23], v[84:87], v[148:151], v[20:23]
    ds_read_b64_tr_b16 v[100:101], v3 offset:41472
    s_waitcnt vmcnt(21)
    v_mfma_f32_16x16x32_bf16 v[24:27], v[84:87], v[152:155], v[24:27]
    ds_read_b64_tr_b16 v[102:103], v3 offset:45568
    s_waitcnt lgkmcnt(6)
    v_mfma_f32_16x16x32_bf16 v[28:31], v[88:91], v[148:151], v[28:31]
    ds_read_b64_tr_b16 v[104:105], v2 offset:41504
    v_mfma_f32_16x16x32_bf16 v[32:35], v[88:91], v[152:155], v[32:35]
    ds_read_b64_tr_b16 v[106:107], v2 offset:45600
    s_add_u32 s23, s21, 0x1000800
    buffer_load_dwordx4 v[116:119], v4, s[8:11], s23 offen offset:1024 sc1
    s_waitcnt lgkmcnt(6)
    v_mfma_f32_16x16x32_bf16 v[36:39], v[92:95], v[148:151], v[36:39]
    ds_read_b64_tr_b16 v[84:85], v3 offset:41728
    v_mfma_f32_16x16x32_bf16 v[40:43], v[92:95], v[152:155], v[40:43]
    ds_read_b64_tr_b16 v[86:87], v3 offset:45824
    s_waitcnt lgkmcnt(6)
    v_mfma_f32_16x16x32_bf16 v[44:47], v[96:99], v[148:151], v[44:47]
    ds_read_b64_tr_b16 v[88:89], v2 offset:41760
    v_mfma_f32_16x16x32_bf16 v[48:51], v[96:99], v[152:155], v[48:51]
    ds_read_b64_tr_b16 v[90:91], v2 offset:45856
    s_waitcnt lgkmcnt(6)
    v_mfma_f32_16x16x32_bf16 v[52:55], v[100:103], v[148:151], v[52:55]
    v_mfma_f32_16x16x32_bf16 v[56:59], v[100:103], v[152:155], v[56:59]
    s_barrier
    ds_read_b64_tr_b16 v[92:93], v3 offset:49152
    ds_read_b64_tr_b16 v[94:95], v3 offset:53248
    s_waitcnt lgkmcnt(6)
    v_mfma_f32_16x16x32_bf16 v[60:63], v[104:107], v[148:151], v[60:63]
    ds_read_b64_tr_b16 v[96:97], v2 offset:49184
    v_mfma_f32_16x16x32_bf16 v[64:67], v[104:107], v[152:155], v[64:67]
    ds_read_b64_tr_b16 v[98:99], v2 offset:53280
    s_add_u32 s23, s21, 0x1020800
    buffer_load_dwordx4 v[120:123], v4, s[8:11], s23 offen offset:1024 sc1
    s_waitcnt lgkmcnt(6)
    v_mfma_f32_16x16x32_bf16 v[68:71], v[84:87], v[148:151], v[68:71]
    ds_read_b64_tr_b16 v[100:101], v3 offset:49408
    v_mfma_f32_16x16x32_bf16 v[72:75], v[84:87], v[152:155], v[72:75]
    ds_read_b64_tr_b16 v[102:103], v3 offset:53504
    s_waitcnt lgkmcnt(6)
    v_mfma_f32_16x16x32_bf16 v[76:79], v[88:91], v[148:151], v[76:79]
    ds_read_b64_tr_b16 v[104:105], v2 offset:49440
    v_mfma_f32_16x16x32_bf16 v[80:83], v[88:91], v[152:155], v[80:83]
    ds_read_b64_tr_b16 v[106:107], v2 offset:53536
    s_waitcnt vmcnt(20) lgkmcnt(6)
    v_mfma_f32_16x16x32_bf16 v[20:23], v[92:95], v[156:159], v[20:23]
    ds_read_b64_tr_b16 v[84:85], v3 offset:49664
    s_waitcnt vmcnt(18)
    v_mfma_f32_16x16x32_bf16 v[24:27], v[92:95], v[160:163], v[24:27]
    ds_read_b64_tr_b16 v[86:87], v3 offset:53760
    s_waitcnt lgkmcnt(6)
    v_mfma_f32_16x16x32_bf16 v[28:31], v[96:99], v[156:159], v[28:31]
    ds_read_b64_tr_b16 v[88:89], v2 offset:49696
    v_mfma_f32_16x16x32_bf16 v[32:35], v[96:99], v[160:163], v[32:35]
    ds_read_b64_tr_b16 v[90:91], v2 offset:53792
    s_bfe_u32 s21, s42, 0x3001c
    s_or_b32 s21, s21, s62
    s_lshl_b32 s21, s21, 12
    s_add_u32 s23, s21, 0x1000000
    buffer_load_dwordx4 v[140:143], v4, s[8:11], s23 offen offset:0 sc1
    s_waitcnt lgkmcnt(6)
    v_mfma_f32_16x16x32_bf16 v[36:39], v[100:103], v[156:159], v[36:39]
    ds_read_b64_tr_b16 v[92:93], v3 offset:49920
    v_mfma_f32_16x16x32_bf16 v[40:43], v[100:103], v[160:163], v[40:43]
    ds_read_b64_tr_b16 v[94:95], v3 offset:54016
    s_waitcnt lgkmcnt(6)
    v_mfma_f32_16x16x32_bf16 v[44:47], v[104:107], v[156:159], v[44:47]
    ds_read_b64_tr_b16 v[96:97], v2 offset:49952
    v_mfma_f32_16x16x32_bf16 v[48:51], v[104:107], v[160:163], v[48:51]
    ds_read_b64_tr_b16 v[98:99], v2 offset:54048
    s_waitcnt lgkmcnt(6)
    v_mfma_f32_16x16x32_bf16 v[52:55], v[84:87], v[156:159], v[52:55]
    ds_read_b64_tr_b16 v[100:101], v3 offset:57344
    v_mfma_f32_16x16x32_bf16 v[56:59], v[84:87], v[160:163], v[56:59]
    ds_read_b64_tr_b16 v[102:103], v3 offset:61440
    s_waitcnt lgkmcnt(6)
    v_mfma_f32_16x16x32_bf16 v[60:63], v[88:91], v[156:159], v[60:63]
    ds_read_b64_tr_b16 v[104:105], v2 offset:57376
    v_mfma_f32_16x16x32_bf16 v[64:67], v[88:91], v[160:163], v[64:67]
    ds_read_b64_tr_b16 v[106:107], v2 offset:61472
    s_add_u32 s23, s21, 0x1020000
    buffer_load_dwordx4 v[144:147], v4, s[8:11], s23 offen offset:0 sc1
    s_waitcnt lgkmcnt(6)
    v_mfma_f32_16x16x32_bf16 v[68:71], v[92:95], v[156:159], v[68:71]
    ds_read_b64_tr_b16 v[84:85], v3 offset:57600
    v_mfma_f32_16x16x32_bf16 v[72:75], v[92:95], v[160:163], v[72:75]
    ds_read_b64_tr_b16 v[86:87], v3 offset:61696
    s_waitcnt lgkmcnt(6)
    v_mfma_f32_16x16x32_bf16 v[76:79], v[96:99], v[156:159], v[76:79]
    ds_read_b64_tr_b16 v[88:89], v2 offset:57632
    v_mfma_f32_16x16x32_bf16 v[80:83], v[96:99], v[160:163], v[80:83]
    ds_read_b64_tr_b16 v[90:91], v2 offset:61728
    s_waitcnt vmcnt(19) lgkmcnt(6)
    v_mfma_f32_16x16x32_bf16 v[20:23], v[100:103], v[164:167], v[20:23]
    ds_read_b64_tr_b16 v[92:93], v3 offset:57856
    s_waitcnt vmcnt(17)
    v_mfma_f32_16x16x32_bf16 v[24:27], v[100:103], v[168:171], v[24:27]
    ds_read_b64_tr_b16 v[94:95], v3 offset:61952
    s_waitcnt lgkmcnt(6)
    v_mfma_f32_16x16x32_bf16 v[28:31], v[104:107], v[164:167], v[28:31]
    ds_read_b64_tr_b16 v[96:97], v2 offset:57888
    v_mfma_f32_16x16x32_bf16 v[32:35], v[104:107], v[168:171], v[32:35]
    ds_read_b64_tr_b16 v[98:99], v2 offset:61984
    s_add_u32 s23, s21, 0x1000000
    buffer_load_dwordx4 v[148:151], v4, s[8:11], s23 offen offset:1024 sc1
    s_waitcnt lgkmcnt(6)
    v_mfma_f32_16x16x32_bf16 v[36:39], v[84:87], v[164:167], v[36:39]
    ds_read_b64_tr_b16 v[100:101], v3 offset:58112
    v_mfma_f32_16x16x32_bf16 v[40:43], v[84:87], v[168:171], v[40:43]
    ds_read_b64_tr_b16 v[102:103], v3 offset:62208
    s_waitcnt lgkmcnt(6)
    v_mfma_f32_16x16x32_bf16 v[44:47], v[88:91], v[164:167], v[44:47]
    ds_read_b64_tr_b16 v[104:105], v2 offset:58144
    v_mfma_f32_16x16x32_bf16 v[48:51], v[88:91], v[168:171], v[48:51]
    ds_read_b64_tr_b16 v[106:107], v2 offset:62240
    s_waitcnt lgkmcnt(6)
    v_mfma_f32_16x16x32_bf16 v[52:55], v[92:95], v[164:167], v[52:55]
    v_mfma_f32_16x16x32_bf16 v[56:59], v[92:95], v[168:171], v[56:59]
    s_waitcnt vmcnt(6)
    s_barrier
    ds_read_b64_tr_b16 v[84:85], v15 offset:0
    ds_read_b64_tr_b16 v[86:87], v15 offset:4096
    s_waitcnt lgkmcnt(6)
    v_mfma_f32_16x16x32_bf16 v[60:63], v[96:99], v[164:167], v[60:63]
    ds_read_b64_tr_b16 v[88:89], v16 offset:32
    v_mfma_f32_16x16x32_bf16 v[64:67], v[96:99], v[168:171], v[64:67]
    ds_read_b64_tr_b16 v[90:91], v16 offset:4128
    s_add_u32 s23, s21, 0x1020000
    buffer_load_dwordx4 v[152:155], v4, s[8:11], s23 offen offset:1024 sc1
    s_waitcnt lgkmcnt(6)
    v_mfma_f32_16x16x32_bf16 v[68:71], v[100:103], v[164:167], v[68:71]
    ds_read_b64_tr_b16 v[92:93], v15 offset:256
    v_mfma_f32_16x16x32_bf16 v[72:75], v[100:103], v[168:171], v[72:75]
    ds_read_b64_tr_b16 v[94:95], v15 offset:4352
    s_waitcnt lgkmcnt(6)
    v_mfma_f32_16x16x32_bf16 v[76:79], v[104:107], v[164:167], v[76:79]
    ds_read_b64_tr_b16 v[96:97], v16 offset:288
    v_mfma_f32_16x16x32_bf16 v[80:83], v[104:107], v[168:171], v[80:83]
    ds_read_b64_tr_b16 v[98:99], v16 offset:4384
    s_waitcnt lgkmcnt(6)
    v_mfma_f32_16x16x32_bf16 v[20:23], v[84:87], v[188:191], v[20:23]
    ds_read_b64_tr_b16 v[100:101], v15 offset:512
    v_mfma_f32_16x16x32_bf16 v[24:27], v[84:87], v[192:195], v[24:27]
    ds_read_b64_tr_b16 v[102:103], v15 offset:4608
    s_waitcnt lgkmcnt(6)
    v_mfma_f32_16x16x32_bf16 v[28:31], v[88:91], v[188:191], v[28:31]
    ds_read_b64_tr_b16 v[104:105], v16 offset:544
    v_mfma_f32_16x16x32_bf16 v[32:35], v[88:91], v[192:195], v[32:35]
    ds_read_b64_tr_b16 v[106:107], v16 offset:4640
    s_add_u32 s23, s21, 0x1000800
    buffer_load_dwordx4 v[156:159], v4, s[8:11], s23 offen offset:0 sc1
    s_waitcnt lgkmcnt(6)
    v_mfma_f32_16x16x32_bf16 v[36:39], v[92:95], v[188:191], v[36:39]
    ds_read_b64_tr_b16 v[84:85], v15 offset:768
    v_mfma_f32_16x16x32_bf16 v[40:43], v[92:95], v[192:195], v[40:43]
    ds_read_b64_tr_b16 v[86:87], v15 offset:4864
    s_waitcnt lgkmcnt(6)
    v_mfma_f32_16x16x32_bf16 v[44:47], v[96:99], v[188:191], v[44:47]
    ds_read_b64_tr_b16 v[88:89], v16 offset:800
    v_mfma_f32_16x16x32_bf16 v[48:51], v[96:99], v[192:195], v[48:51]
    ds_read_b64_tr_b16 v[90:91], v16 offset:4896
    s_waitcnt lgkmcnt(6)
    v_mfma_f32_16x16x32_bf16 v[52:55], v[100:103], v[188:191], v[52:55]
    ds_read_b64_tr_b16 v[92:93], v15 offset:8192
    v_mfma_f32_16x16x32_bf16 v[56:59], v[100:103], v[192:195], v[56:59]
    ds_read_b64_tr_b16 v[94:95], v15 offset:12288
    s_waitcnt lgkmcnt(6)
    v_mfma_f32_16x16x32_bf16 v[60:63], v[104:107], v[188:191], v[60:63]
    ds_read_b64_tr_b16 v[96:97], v16 offset:8224
    v_mfma_f32_16x16x32_bf16 v[64:67], v[104:107], v[192:195], v[64:67]
    ds_read_b64_tr_b16 v[98:99], v16 offset:12320
    s_add_u32 s23, s21, 0x1020800
    buffer_load_dwordx4 v[160:163], v4, s[8:11], s23 offen offset:0 sc1
    s_waitcnt lgkmcnt(6)
    v_mfma_f32_16x16x32_bf16 v[68:71], v[84:87], v[188:191], v[68:71]
    ds_read_b64_tr_b16 v[100:101], v15 offset:8448
    v_mfma_f32_16x16x32_bf16 v[72:75], v[84:87], v[192:195], v[72:75]
    ds_read_b64_tr_b16 v[102:103], v15 offset:12544
    s_waitcnt lgkmcnt(6)
    v_mfma_f32_16x16x32_bf16 v[76:79], v[88:91], v[188:191], v[76:79]
    ds_read_b64_tr_b16 v[104:105], v16 offset:8480
    v_mfma_f32_16x16x32_bf16 v[80:83], v[88:91], v[192:195], v[80:83]
    ds_read_b64_tr_b16 v[106:107], v16 offset:12576
    s_waitcnt lgkmcnt(6)
    v_mfma_f32_16x16x32_bf16 v[20:23], v[92:95], v[196:199], v[20:23]
    ds_read_b64_tr_b16 v[84:85], v15 offset:8704
    v_mfma_f32_16x16x32_bf16 v[24:27], v[92:95], v[200:203], v[24:27]
    ds_read_b64_tr_b16 v[86:87], v15 offset:12800
    s_waitcnt lgkmcnt(6)
    v_mfma_f32_16x16x32_bf16 v[28:31], v[96:99], v[196:199], v[28:31]
    ds_read_b64_tr_b16 v[88:89], v16 offset:8736
    v_mfma_f32_16x16x32_bf16 v[32:35], v[96:99], v[200:203], v[32:35]
    ds_read_b64_tr_b16 v[90:91], v16 offset:12832
    s_add_u32 s23, s21, 0x1000800
    buffer_load_dwordx4 v[164:167], v4, s[8:11], s23 offen offset:1024 sc1
    s_waitcnt lgkmcnt(6)
    v_mfma_f32_16x16x32_bf16 v[36:39], v[100:103], v[196:199], v[36:39]
    ds_read_b64_tr_b16 v[92:93], v15 offset:8960
    v_mfma_f32_16x16x32_bf16 v[40:43], v[100:103], v[200:203], v[40:43]
    ds_read_b64_tr_b16 v[94:95], v15 offset:13056
    s_waitcnt lgkmcnt(6)
    v_mfma_f32_16x16x32_bf16 v[44:47], v[104:107], v[196:199], v[44:47]
    ds_read_b64_tr_b16 v[96:97], v16 offset:8992
    v_mfma_f32_16x16x32_bf16 v[48:51], v[104:107], v[200:203], v[48:51]
    ds_read_b64_tr_b16 v[98:99], v16 offset:13088
    s_waitcnt lgkmcnt(6)
    v_mfma_f32_16x16x32_bf16 v[52:55], v[84:87], v[196:199], v[52:55]
    ds_read_b64_tr_b16 v[100:101], v15 offset:16384
    v_mfma_f32_16x16x32_bf16 v[56:59], v[84:87], v[200:203], v[56:59]
    ds_read_b64_tr_b16 v[102:103], v15 offset:20480
    s_waitcnt lgkmcnt(6)
    v_mfma_f32_16x16x32_bf16 v[60:63], v[88:91], v[196:199], v[60:63]
    ds_read_b64_tr_b16 v[104:105], v16 offset:16416
    v_mfma_f32_16x16x32_bf16 v[64:67], v[88:91], v[200:203], v[64:67]
    ds_read_b64_tr_b16 v[106:107], v16 offset:20512
    s_add_u32 s23, s21, 0x1020800
    buffer_load_dwordx4 v[168:171], v4, s[8:11], s23 offen offset:1024 sc1
    s_waitcnt lgkmcnt(6)
    v_mfma_f32_16x16x32_bf16 v[68:71], v[92:95], v[196:199], v[68:71]
    ds_read_b64_tr_b16 v[84:85], v15 offset:24576
    v_mfma_f32_16x16x32_bf16 v[72:75], v[92:95], v[200:203], v[72:75]
    ds_read_b64_tr_b16 v[86:87], v15 offset:28672
    s_waitcnt lgkmcnt(6)
    v_mfma_f32_16x16x32_bf16 v[76:79], v[96:99], v[196:199], v[76:79]
    ds_read_b64_tr_b16 v[88:89], v16 offset:24608
    v_mfma_f32_16x16x32_bf16 v[80:83], v[96:99], v[200:203], v[80:83]
    ds_read_b64_tr_b16 v[90:91], v16 offset:28704
    s_waitcnt lgkmcnt(6)
    v_mfma_f32_16x16x32_bf16 v[20:23], v[100:103], v[108:111], v[20:23]
    ds_read_b64_tr_b16 v[92:93], v15 offset:32768
    s_waitcnt vmcnt(10)
    v_mfma_f32_16x16x32_bf16 v[24:27], v[100:103], v[112:115], v[24:27]
    ds_read_b64_tr_b16 v[94:95], v15 offset:36864
    s_waitcnt lgkmcnt(6)
    v_mfma_f32_16x16x32_bf16 v[28:31], v[104:107], v[108:111], v[28:31]
    ds_read_b64_tr_b16 v[96:97], v16 offset:32800
    v_mfma_f32_16x16x32_bf16 v[32:35], v[104:107], v[112:115], v[32:35]
    ds_read_b64_tr_b16 v[98:99], v16 offset:36896
    s_waitcnt vmcnt(9) lgkmcnt(6)
    v_mfma_f32_16x16x32_bf16 v[20:23], v[84:87], v[116:119], v[20:23]
    ds_read_b64_tr_b16 v[100:101], v15 offset:40960
    s_waitcnt vmcnt(8)
    v_mfma_f32_16x16x32_bf16 v[24:27], v[84:87], v[120:123], v[24:27]
    ds_read_b64_tr_b16 v[102:103], v15 offset:45056
    s_waitcnt lgkmcnt(6)
    v_mfma_f32_16x16x32_bf16 v[28:31], v[88:91], v[116:119], v[28:31]
    ds_read_b64_tr_b16 v[104:105], v16 offset:40992
    v_mfma_f32_16x16x32_bf16 v[32:35], v[88:91], v[120:123], v[32:35]
    ds_read_b64_tr_b16 v[106:107], v16 offset:45088
    s_waitcnt vmcnt(7) lgkmcnt(6)
    v_mfma_f32_16x16x32_bf16 v[20:23], v[92:95], v[140:143], v[20:23]
    ds_read_b64_tr_b16 v[84:85], v15 offset:49152
    s_waitcnt vmcnt(6)
    v_mfma_f32_16x16x32_bf16 v[24:27], v[92:95], v[144:147], v[24:27]
    ds_read_b64_tr_b16 v[86:87], v15 offset:53248
    s_waitcnt lgkmcnt(6)
    v_mfma_f32_16x16x32_bf16 v[28:31], v[96:99], v[140:143], v[28:31]
    ds_read_b64_tr_b16 v[88:89], v16 offset:49184
    v_mfma_f32_16x16x32_bf16 v[32:35], v[96:99], v[144:147], v[32:35]
    ds_read_b64_tr_b16 v[90:91], v16 offset:53280
    s_waitcnt vmcnt(5) lgkmcnt(6)
    v_mfma_f32_16x16x32_bf16 v[20:23], v[100:103], v[148:151], v[20:23]
    ds_read_b64_tr_b16 v[92:93], v15 offset:57344
    s_waitcnt vmcnt(4)
    v_mfma_f32_16x16x32_bf16 v[24:27], v[100:103], v[152:155], v[24:27]
    ds_read_b64_tr_b16 v[94:95], v15 offset:61440
    s_waitcnt lgkmcnt(6)
    v_mfma_f32_16x16x32_bf16 v[28:31], v[104:107], v[148:151], v[28:31]
    ds_read_b64_tr_b16 v[96:97], v16 offset:57376
    v_mfma_f32_16x16x32_bf16 v[32:35], v[104:107], v[152:155], v[32:35]
    ds_read_b64_tr_b16 v[98:99], v16 offset:61472
    s_waitcnt vmcnt(3) lgkmcnt(6)
    v_mfma_f32_16x16x32_bf16 v[20:23], v[84:87], v[156:159], v[20:23]
    ds_read_b64_tr_b16 v[100:101], v15 offset:16640
    s_waitcnt vmcnt(2)
    v_mfma_f32_16x16x32_bf16 v[24:27], v[84:87], v[160:163], v[24:27]
    ds_read_b64_tr_b16 v[102:103], v15 offset:20736
    s_waitcnt lgkmcnt(6)
    v_mfma_f32_16x16x32_bf16 v[28:31], v[88:91], v[156:159], v[28:31]
    ds_read_b64_tr_b16 v[104:105], v16 offset:16672
    v_mfma_f32_16x16x32_bf16 v[32:35], v[88:91], v[160:163], v[32:35]
    ds_read_b64_tr_b16 v[106:107], v16 offset:20768
    s_waitcnt vmcnt(1) lgkmcnt(6)
    v_mfma_f32_16x16x32_bf16 v[20:23], v[92:95], v[164:167], v[20:23]
    ds_read_b64_tr_b16 v[84:85], v15 offset:24832
    s_waitcnt vmcnt(0)
    v_mfma_f32_16x16x32_bf16 v[24:27], v[92:95], v[168:171], v[24:27]
    ds_read_b64_tr_b16 v[86:87], v15 offset:28928
    s_waitcnt lgkmcnt(6)
    v_mfma_f32_16x16x32_bf16 v[28:31], v[96:99], v[164:167], v[28:31]
    ds_read_b64_tr_b16 v[88:89], v16 offset:24864
    v_mfma_f32_16x16x32_bf16 v[32:35], v[96:99], v[168:171], v[32:35]
    ds_read_b64_tr_b16 v[90:91], v16 offset:28960
    ds_read_b128 v[124:127], v13 offset:0
    ds_read_b128 v[128:131], v13 offset:64
    s_waitcnt lgkmcnt(8)
    v_mfma_f32_16x16x32_bf16 v[36:39], v[100:103], v[108:111], v[36:39]
    ds_read_b64_tr_b16 v[92:93], v15 offset:33024
    v_mfma_f32_16x16x32_bf16 v[40:43], v[100:103], v[112:115], v[40:43]
    ds_read_b64_tr_b16 v[94:95], v15 offset:37120
    s_waitcnt lgkmcnt(8)
    v_mfma_f32_16x16x32_bf16 v[44:47], v[104:107], v[108:111], v[44:47]
    ds_read_b64_tr_b16 v[96:97], v16 offset:33056
    v_mfma_f32_16x16x32_bf16 v[48:51], v[104:107], v[112:115], v[48:51]
    ds_read_b64_tr_b16 v[98:99], v16 offset:37152
    s_waitcnt lgkmcnt(8)
    v_mfma_f32_16x16x32_bf16 v[36:39], v[84:87], v[116:119], v[36:39]
    s_waitcnt lgkmcnt(5)
    v_pk_mul_f32 v[132:133], v[20:21], v[124:125]
    v_pk_mul_f32 v[134:135], v[22:23], v[126:127]
    ds_read_b64_tr_b16 v[100:101], v15 offset:41216
    v_mfma_f32_16x16x32_bf16 v[40:43], v[84:87], v[120:123], v[40:43]
    s_waitcnt lgkmcnt(5)
    v_pk_mul_f32 v[136:137], v[28:29], v[128:129]
    ds_read_b64_tr_b16 v[102:103], v15 offset:45312
    v_mfma_f32_16x16x32_bf16 v[44:47], v[88:91], v[116:119], v[44:47]
    v_pk_mul_f32 v[138:139], v[30:31], v[130:131]
    v_cvt_pk_bf16_f32 v132, v132, v133
    ds_read_b64_tr_b16 v[104:105], v16 offset:41248
    v_mfma_f32_16x16x32_bf16 v[48:51], v[88:91], v[120:123], v[48:51]
    v_cvt_pk_bf16_f32 v133, v134, v135
    ds_read_b64_tr_b16 v[106:107], v16 offset:45344
    s_waitcnt lgkmcnt(6)
    v_mfma_f32_16x16x32_bf16 v[36:39], v[92:95], v[140:143], v[36:39]
    v_cvt_pk_bf16_f32 v134, v136, v137
    v_cvt_pk_bf16_f32 v135, v138, v139
    ds_read_b64_tr_b16 v[84:85], v15 offset:49408
    v_mfma_f32_16x16x32_bf16 v[40:43], v[92:95], v[144:147], v[40:43]
    v_permlane32_swap_b32 v132, v134
    ds_read_b64_tr_b16 v[86:87], v15 offset:53504
    s_waitcnt lgkmcnt(6)
    v_mfma_f32_16x16x32_bf16 v[44:47], v[96:99], v[140:143], v[44:47]
    v_permlane32_swap_b32 v133, v135
    v_permlane16_swap_b32 v132, v134
    ds_read_b64_tr_b16 v[88:89], v16 offset:49440
    v_mfma_f32_16x16x32_bf16 v[48:51], v[96:99], v[144:147], v[48:51]
    v_permlane16_swap_b32 v133, v135
    ds_read_b64_tr_b16 v[90:91], v16 offset:53536
    s_waitcnt lgkmcnt(6)
    v_mfma_f32_16x16x32_bf16 v[36:39], v[100:103], v[148:151], v[36:39]
    buffer_store_dwordx4 v[132:135], v14, s[8:11], s18 offen offset:0 sc1
    ds_read_b64_tr_b16 v[92:93], v15 offset:57600
    v_mfma_f32_16x16x32_bf16 v[40:43], v[100:103], v[152:155], v[40:43]
    v_pk_mul_f32 v[132:133], v[24:25], v[124:125]
    v_pk_mul_f32 v[134:135], v[26:27], v[126:127]
    ds_read_b64_tr_b16 v[94:95], v15 offset:61696
    s_waitcnt lgkmcnt(6)
    v_mfma_f32_16x16x32_bf16 v[44:47], v[104:107], v[148:151], v[44:47]
    v_pk_mul_f32 v[136:137], v[32:33], v[128:129]
    ds_read_b64_tr_b16 v[96:97], v16 offset:57632
    v_mfma_f32_16x16x32_bf16 v[48:51], v[104:107], v[152:155], v[48:51]
    v_pk_mul_f32 v[138:139], v[34:35], v[130:131]
    v_cvt_pk_bf16_f32 v132, v132, v133
    ds_read_b64_tr_b16 v[98:99], v16 offset:61728
    s_waitcnt lgkmcnt(6)
    v_mfma_f32_16x16x32_bf16 v[36:39], v[84:87], v[156:159], v[36:39]
    v_cvt_pk_bf16_f32 v133, v134, v135
    ds_read_b64_tr_b16 v[100:101], v15 offset:16896
    v_mfma_f32_16x16x32_bf16 v[40:43], v[84:87], v[160:163], v[40:43]
    v_cvt_pk_bf16_f32 v134, v136, v137
    v_cvt_pk_bf16_f32 v135, v138, v139
    ds_read_b64_tr_b16 v[102:103], v15 offset:20992
    s_waitcnt lgkmcnt(6)
    v_mfma_f32_16x16x32_bf16 v[44:47], v[88:91], v[156:159], v[44:47]
    v_permlane32_swap_b32 v132, v134
    ds_read_b64_tr_b16 v[104:105], v16 offset:16928
    v_mfma_f32_16x16x32_bf16 v[48:51], v[88:91], v[160:163], v[48:51]
    v_permlane32_swap_b32 v133, v135
    v_permlane16_swap_b32 v132, v134
    ds_read_b64_tr_b16 v[106:107], v16 offset:21024
    s_waitcnt lgkmcnt(6)
    v_mfma_f32_16x16x32_bf16 v[36:39], v[92:95], v[164:167], v[36:39]
    v_permlane16_swap_b32 v133, v135
    ds_read_b64_tr_b16 v[84:85], v15 offset:25088
    v_mfma_f32_16x16x32_bf16 v[40:43], v[92:95], v[168:171], v[40:43]
    buffer_store_dwordx4 v[132:135], v14, s[8:11], s19 offen offset:0 sc1
    ds_read_b64_tr_b16 v[86:87], v15 offset:29184
    s_waitcnt lgkmcnt(6)
    v_mfma_f32_16x16x32_bf16 v[44:47], v[96:99], v[164:167], v[44:47]
    ds_read_b64_tr_b16 v[88:89], v16 offset:25120
    v_mfma_f32_16x16x32_bf16 v[48:51], v[96:99], v[168:171], v[48:51]
    ds_read_b64_tr_b16 v[90:91], v16 offset:29216
    ds_read_b128 v[124:127], v13 offset:128
    ds_read_b128 v[128:131], v13 offset:192
    s_waitcnt lgkmcnt(8)
    v_mfma_f32_16x16x32_bf16 v[52:55], v[100:103], v[108:111], v[52:55]
    ds_read_b64_tr_b16 v[92:93], v15 offset:33280
    v_mfma_f32_16x16x32_bf16 v[56:59], v[100:103], v[112:115], v[56:59]
    ds_read_b64_tr_b16 v[94:95], v15 offset:37376
    s_waitcnt lgkmcnt(8)
    v_mfma_f32_16x16x32_bf16 v[60:63], v[104:107], v[108:111], v[60:63]
    ds_read_b64_tr_b16 v[96:97], v16 offset:33312
    v_mfma_f32_16x16x32_bf16 v[64:67], v[104:107], v[112:115], v[64:67]
    ds_read_b64_tr_b16 v[98:99], v16 offset:37408
    s_waitcnt lgkmcnt(8)
    v_mfma_f32_16x16x32_bf16 v[52:55], v[84:87], v[116:119], v[52:55]
    s_waitcnt lgkmcnt(5)
    v_pk_mul_f32 v[132:133], v[36:37], v[124:125]
    v_pk_mul_f32 v[134:135], v[38:39], v[126:127]
    ds_read_b64_tr_b16 v[100:101], v15 offset:41472
    v_mfma_f32_16x16x32_bf16 v[56:59], v[84:87], v[120:123], v[56:59]
    s_waitcnt lgkmcnt(5)
    v_pk_mul_f32 v[136:137], v[44:45], v[128:129]
    ds_read_b64_tr_b16 v[102:103], v15 offset:45568
    v_mfma_f32_16x16x32_bf16 v[60:63], v[88:91], v[116:119], v[60:63]
    v_pk_mul_f32 v[138:139], v[46:47], v[130:131]
    v_cvt_pk_bf16_f32 v132, v132, v133
    ds_read_b64_tr_b16 v[104:105], v16 offset:41504
    v_mfma_f32_16x16x32_bf16 v[64:67], v[88:91], v[120:123], v[64:67]
    v_cvt_pk_bf16_f32 v133, v134, v135
    ds_read_b64_tr_b16 v[106:107], v16 offset:45600
    s_waitcnt lgkmcnt(6)
    v_mfma_f32_16x16x32_bf16 v[52:55], v[92:95], v[140:143], v[52:55]
    v_cvt_pk_bf16_f32 v134, v136, v137
    v_cvt_pk_bf16_f32 v135, v138, v139
    ds_read_b64_tr_b16 v[84:85], v15 offset:49664
    v_mfma_f32_16x16x32_bf16 v[56:59], v[92:95], v[144:147], v[56:59]
    v_permlane32_swap_b32 v132, v134
    ds_read_b64_tr_b16 v[86:87], v15 offset:53760
    s_waitcnt lgkmcnt(6)
    v_mfma_f32_16x16x32_bf16 v[60:63], v[96:99], v[140:143], v[60:63]
    v_permlane32_swap_b32 v133, v135
    v_permlane16_swap_b32 v132, v134
    ds_read_b64_tr_b16 v[88:89], v16 offset:49696
    v_mfma_f32_16x16x32_bf16 v[64:67], v[96:99], v[144:147], v[64:67]
    v_permlane16_swap_b32 v133, v135
    ds_read_b64_tr_b16 v[90:91], v16 offset:53792
    s_waitcnt lgkmcnt(6)
    v_mfma_f32_16x16x32_bf16 v[52:55], v[100:103], v[148:151], v[52:55]
    buffer_store_dwordx4 v[132:135], v14, s[8:11], s18 offen offset:1024 sc1
    ds_read_b64_tr_b16 v[92:93], v15 offset:57856
    v_mfma_f32_16x16x32_bf16 v[56:59], v[100:103], v[152:155], v[56:59]
    v_pk_mul_f32 v[132:133], v[40:41], v[124:125]
    v_pk_mul_f32 v[134:135], v[42:43], v[126:127]
    ds_read_b64_tr_b16 v[94:95], v15 offset:61952
    s_waitcnt lgkmcnt(6)
    v_mfma_f32_16x16x32_bf16 v[60:63], v[104:107], v[148:151], v[60:63]
    v_pk_mul_f32 v[136:137], v[48:49], v[128:129]
    ds_read_b64_tr_b16 v[96:97], v16 offset:57888
    v_mfma_f32_16x16x32_bf16 v[64:67], v[104:107], v[152:155], v[64:67]
    v_pk_mul_f32 v[138:139], v[50:51], v[130:131]
    v_cvt_pk_bf16_f32 v132, v132, v133
    ds_read_b64_tr_b16 v[98:99], v16 offset:61984
    s_waitcnt lgkmcnt(6)
    v_mfma_f32_16x16x32_bf16 v[52:55], v[84:87], v[156:159], v[52:55]
    v_cvt_pk_bf16_f32 v133, v134, v135
    ds_read_b64_tr_b16 v[100:101], v15 offset:17152
    v_mfma_f32_16x16x32_bf16 v[56:59], v[84:87], v[160:163], v[56:59]
    v_cvt_pk_bf16_f32 v134, v136, v137
    v_cvt_pk_bf16_f32 v135, v138, v139
    ds_read_b64_tr_b16 v[102:103], v15 offset:21248
    s_waitcnt lgkmcnt(6)
    v_mfma_f32_16x16x32_bf16 v[60:63], v[88:91], v[156:159], v[60:63]
    v_permlane32_swap_b32 v132, v134
    ds_read_b64_tr_b16 v[104:105], v16 offset:17184
    v_mfma_f32_16x16x32_bf16 v[64:67], v[88:91], v[160:163], v[64:67]
    v_permlane32_swap_b32 v133, v135
    v_permlane16_swap_b32 v132, v134
    ds_read_b64_tr_b16 v[106:107], v16 offset:21280
    s_waitcnt lgkmcnt(6)
    v_mfma_f32_16x16x32_bf16 v[52:55], v[92:95], v[164:167], v[52:55]
    v_permlane16_swap_b32 v133, v135
    ds_read_b64_tr_b16 v[84:85], v15 offset:25344
    v_mfma_f32_16x16x32_bf16 v[56:59], v[92:95], v[168:171], v[56:59]
    buffer_store_dwordx4 v[132:135], v14, s[8:11], s19 offen offset:1024 sc1
    ds_read_b64_tr_b16 v[86:87], v15 offset:29440
    s_waitcnt lgkmcnt(6)
    v_mfma_f32_16x16x32_bf16 v[60:63], v[96:99], v[164:167], v[60:63]
    ds_read_b64_tr_b16 v[88:89], v16 offset:25376
    v_mfma_f32_16x16x32_bf16 v[64:67], v[96:99], v[168:171], v[64:67]
    ds_read_b64_tr_b16 v[90:91], v16 offset:29472
    ds_read_b128 v[124:127], v13 offset:256
    ds_read_b128 v[128:131], v13 offset:320
    s_waitcnt lgkmcnt(8)
    v_mfma_f32_16x16x32_bf16 v[68:71], v[100:103], v[108:111], v[68:71]
    ds_read_b64_tr_b16 v[92:93], v15 offset:33536
    v_mfma_f32_16x16x32_bf16 v[72:75], v[100:103], v[112:115], v[72:75]
    ds_read_b64_tr_b16 v[94:95], v15 offset:37632
    s_waitcnt lgkmcnt(8)
    v_mfma_f32_16x16x32_bf16 v[76:79], v[104:107], v[108:111], v[76:79]
    ds_read_b64_tr_b16 v[96:97], v16 offset:33568
    v_mfma_f32_16x16x32_bf16 v[80:83], v[104:107], v[112:115], v[80:83]
    ds_read_b64_tr_b16 v[98:99], v16 offset:37664
    s_waitcnt lgkmcnt(8)
    v_mfma_f32_16x16x32_bf16 v[68:71], v[84:87], v[116:119], v[68:71]
    s_waitcnt lgkmcnt(5)
    v_pk_mul_f32 v[132:133], v[52:53], v[124:125]
    v_pk_mul_f32 v[134:135], v[54:55], v[126:127]
    ds_read_b64_tr_b16 v[100:101], v15 offset:41728
    v_mfma_f32_16x16x32_bf16 v[72:75], v[84:87], v[120:123], v[72:75]
    s_waitcnt lgkmcnt(5)
    v_pk_mul_f32 v[136:137], v[60:61], v[128:129]
    ds_read_b64_tr_b16 v[102:103], v15 offset:45824
    v_mfma_f32_16x16x32_bf16 v[76:79], v[88:91], v[116:119], v[76:79]
    v_pk_mul_f32 v[138:139], v[62:63], v[130:131]
    v_cvt_pk_bf16_f32 v132, v132, v133
    ds_read_b64_tr_b16 v[104:105], v16 offset:41760
    v_mfma_f32_16x16x32_bf16 v[80:83], v[88:91], v[120:123], v[80:83]
    v_cvt_pk_bf16_f32 v133, v134, v135
    ds_read_b64_tr_b16 v[106:107], v16 offset:45856
    s_waitcnt lgkmcnt(6)
    v_mfma_f32_16x16x32_bf16 v[68:71], v[92:95], v[140:143], v[68:71]
    v_cvt_pk_bf16_f32 v134, v136, v137
    v_cvt_pk_bf16_f32 v135, v138, v139
    ds_read_b64_tr_b16 v[84:85], v15 offset:49920
    v_mfma_f32_16x16x32_bf16 v[72:75], v[92:95], v[144:147], v[72:75]
    v_permlane32_swap_b32 v132, v134
    ds_read_b64_tr_b16 v[86:87], v15 offset:54016
    s_waitcnt lgkmcnt(6)
    v_mfma_f32_16x16x32_bf16 v[76:79], v[96:99], v[140:143], v[76:79]
    v_permlane32_swap_b32 v133, v135
    v_permlane16_swap_b32 v132, v134
    ds_read_b64_tr_b16 v[88:89], v16 offset:49952
    v_mfma_f32_16x16x32_bf16 v[80:83], v[96:99], v[144:147], v[80:83]
    v_permlane16_swap_b32 v133, v135
    ds_read_b64_tr_b16 v[90:91], v16 offset:54048
    s_waitcnt lgkmcnt(6)
    v_mfma_f32_16x16x32_bf16 v[68:71], v[100:103], v[148:151], v[68:71]
    buffer_store_dwordx4 v[132:135], v14, s[8:11], s18 offen offset:2048 sc1
    ds_read_b64_tr_b16 v[92:93], v15 offset:58112
    v_mfma_f32_16x16x32_bf16 v[72:75], v[100:103], v[152:155], v[72:75]
    v_pk_mul_f32 v[132:133], v[56:57], v[124:125]
    v_pk_mul_f32 v[134:135], v[58:59], v[126:127]
    ds_read_b64_tr_b16 v[94:95], v15 offset:62208
    s_waitcnt lgkmcnt(6)
    v_mfma_f32_16x16x32_bf16 v[76:79], v[104:107], v[148:151], v[76:79]
    v_pk_mul_f32 v[136:137], v[64:65], v[128:129]
    ds_read_b64_tr_b16 v[96:97], v16 offset:58144
    v_mfma_f32_16x16x32_bf16 v[80:83], v[104:107], v[152:155], v[80:83]
    v_pk_mul_f32 v[138:139], v[66:67], v[130:131]
    v_cvt_pk_bf16_f32 v132, v132, v133
    ds_read_b64_tr_b16 v[98:99], v16 offset:62240
    s_waitcnt lgkmcnt(6)
    v_mfma_f32_16x16x32_bf16 v[68:71], v[84:87], v[156:159], v[68:71]
    v_cvt_pk_bf16_f32 v133, v134, v135
    v_mfma_f32_16x16x32_bf16 v[72:75], v[84:87], v[160:163], v[72:75]
    v_cvt_pk_bf16_f32 v134, v136, v137
    v_cvt_pk_bf16_f32 v135, v138, v139
    s_waitcnt lgkmcnt(4)
    v_mfma_f32_16x16x32_bf16 v[76:79], v[88:91], v[156:159], v[76:79]
    v_permlane32_swap_b32 v132, v134
    v_mfma_f32_16x16x32_bf16 v[80:83], v[88:91], v[160:163], v[80:83]
    v_permlane32_swap_b32 v133, v135
    v_permlane16_swap_b32 v132, v134
    s_waitcnt lgkmcnt(2)
    v_mfma_f32_16x16x32_bf16 v[68:71], v[92:95], v[164:167], v[68:71]
    v_permlane16_swap_b32 v133, v135
    v_mfma_f32_16x16x32_bf16 v[72:75], v[92:95], v[168:171], v[72:75]
    buffer_store_dwordx4 v[132:135], v14, s[8:11], s19 offen offset:2048 sc1
    s_waitcnt lgkmcnt(0)
    v_mfma_f32_16x16x32_bf16 v[76:79], v[96:99], v[164:167], v[76:79]
    v_mfma_f32_16x16x32_bf16 v[80:83], v[96:99], v[168:171], v[80:83]
    ds_read_b128 v[124:127], v13 offset:384
    ds_read_b128 v[128:131], v13 offset:448
    s_waitcnt lgkmcnt(1)
    v_pk_mul_f32 v[132:133], v[68:69], v[124:125]
    v_pk_mul_f32 v[134:135], v[70:71], v[126:127]
    s_waitcnt lgkmcnt(0)
    s_nop 0
    v_pk_mul_f32 v[136:137], v[76:77], v[128:129]
    v_pk_mul_f32 v[138:139], v[78:79], v[130:131]
    v_cvt_pk_bf16_f32 v132, v132, v133
    v_cvt_pk_bf16_f32 v133, v134, v135
    v_cvt_pk_bf16_f32 v134, v136, v137
    v_cvt_pk_bf16_f32 v135, v138, v139
    s_nop 0
    v_permlane32_swap_b32 v132, v134
    v_permlane32_swap_b32 v133, v135
    s_nop 0
    v_permlane16_swap_b32 v132, v134
    v_permlane16_swap_b32 v133, v135
    buffer_store_dwordx4 v[132:135], v14, s[8:11], s18 offen offset:3072 sc1
    s_nop 1
    v_pk_mul_f32 v[132:133], v[72:73], v[124:125]
    v_pk_mul_f32 v[134:135], v[74:75], v[126:127]
    v_pk_mul_f32 v[136:137], v[80:81], v[128:129]
    v_pk_mul_f32 v[138:139], v[82:83], v[130:131]
    v_cvt_pk_bf16_f32 v132, v132, v133
    v_cvt_pk_bf16_f32 v133, v134, v135
    v_cvt_pk_bf16_f32 v134, v136, v137
    v_cvt_pk_bf16_f32 v135, v138, v139
    s_nop 0
    v_permlane32_swap_b32 v132, v134
    v_permlane32_swap_b32 v133, v135
    s_nop 0
    v_permlane16_swap_b32 v132, v134
    v_permlane16_swap_b32 v133, v135
    buffer_store_dwordx4 v[132:135], v14, s[8:11], s19 offen offset:3072 sc1
    s_branch fz_p3e
fz_p3B:
    v_bfe_u32 v9, v0, 2, 2
    v_lshrrev_b32 v10, 4, v0
    v_and_b32 v11, 3, v0
    v_lshlrev_b32 v3, 10, v10
    v_lshl_add_u32 v3, v9, 6, v3
    v_lshl_add_u32 v3, v11, 3, v3
    v_bfe_u32 v12, v0, 4, 1
    v_lshlrev_b32 v12, 5, v12
    v_sub_u32 v2, v3, v12
    v_add_u32 v3, v3, v12
    s_lshl_b32 s19, s13, 3
    s_add_u32 s19, s19, s3
    s_mul_i32 s19, s19, 262144
    v_add_u32 v4, s19, v1
    s_and_b32 s62, s12, 24
    s_and_b32 s19, s12, 7
    s_lshl_b32 s20, s19, 2
    s_lshr_b32 s20, 0x54732160, s20
    s_and_b32 s20, s20, 7
    s_lshl_b32 s20, s20, 2
    s_bfm_b32 s21, s20, 0
    s_and_b32 s22, s21, 0x51764320
    s_lshl_b32 s22, s22, 4
    s_lshl_b32 s21, s21, 4
    s_or_b32 s21, s21, 15
    s_andn2_b32 s21, 0x51764320, s21
    s_or_b32 s42, s21, s22
    s_or_b32 s42, s42, s19
    s_bfe_u32 s96, s2, 0x10002
    s_mul_i32 s96, s96, 28
    s_lshr_b32 s26, s2, 3
    s_add_u32 s96, s96, s26
    s_and_b32 s97, s2, 1
    s_bfe_u32 s98, s2, 0x10001
    s_bfe_u32 s99, s2, 0x40003
    s_and_b32 s100, s2, 7
    s_lshl_b32 s100, s100, 1
    s_lshr_b32 s26, s2, 7
    s_add_u32 s100, s100, s26
    v_lshrrev_b32 v9, 4, v0
    v_lshlrev_b32 v13, 4, v9
    s_add_u32 s19, s12, 1
    s_and_b32 s19, s19, 7
    s_lshl_b32 s26, s19, 9
    s_add_u32 s26, s26, 0x22000
    v_add_u32 v13, s26, v13
    v_and_b32 v14, 15, v0
    v_lshlrev_b32 v14, 6, v14
    v_lshl_add_u32 v14, v9, 4, v14
    s_lshr_b32 s18, s12, 3
    s_lshl_b32 s18, s18, 22
    s_lshl_b32 s26, s13, 3
    s_add_u32 s26, s26, s3
    s_lshl_b32 s26, s26, 16
    s_add_u32 s18, s18, s26
    s_lshl_b32 s19, s19, 12
    s_add_u32 s18, s18, s19
    s_add_u32 s18, s18, 0x2000000
    s_add_u32 s19, s18, 0x8000
    v_add_u32 v15, 0x10000, v3
    v_add_u32 v16, 0x10000, v2
    s_lshl_b32 s26, s13, 3
    s_add_u32 s26, s26, s3
    s_lshl_b32 s26, s26, 2
    s_lshr_b32 s27, s12, 3
    s_add_u32 s26, s26, s27
    s_lshl_b32 s26, s26, 7
    s_add_u32 s20, s26, 0x540000
    s_and_b32 s27, s12, 7
    s_lshl_b32 s27, s27, 2
    s_add_u32 s26, s20, s27
    v_mov_b32 v9, s14
    v_mov_b32 v10, 0
    s_waitcnt vmcnt(0)
    s_mov_b64 exec, 1
    buffer_store_dword v9, v10, s[8:11], s26 offen sc1
    s_mov_b64 exec, -1
    s_waitcnt lgkmcnt(0)
    s_barrier
    ds_read_b64_tr_b16 v[84:85], v3 offset:0
    ds_read_b64_tr_b16 v[86:87], v3 offset:4096
    ds_read_b64_tr_b16 v[88:89], v2 offset:32
    ds_read_b64_tr_b16 v[90:91], v2 offset:4128
    ds_read_b64_tr_b16 v[92:93], v3 offset:256
    ds_read_b64_tr_b16 v[94:95], v3 offset:4352
    ds_read_b64_tr_b16 v[96:97], v2 offset:288
    ds_read_b64_tr_b16 v[98:99], v2 offset:4384
    s_waitcnt lgkmcnt(6)
    v_mfma_f32_16x16x32_bf16 v[20:23], v[84:87], v[108:111], 0
    ds_read_b64_tr_b16 v[100:101], v3 offset:512
    v_mfma_f32_16x16x32_bf16 v[24:27], v[84:87], v[124:127], 0
    ds_read_b64_tr_b16 v[102:103], v3 offset:4608
    s_waitcnt lgkmcnt(6)
    v_mfma_f32_16x16x32_bf16 v[28:31], v[88:91], v[108:111], 0
    ds_read_b64_tr_b16 v[104:105], v2 offset:544
    v_mfma_f32_16x16x32_bf16 v[32:35], v[88:91], v[124:127], 0
    ds_read_b64_tr_b16 v[106:107], v2 offset:4640
    s_waitcnt lgkmcnt(6)
    v_mfma_f32_16x16x32_bf16 v[36:39], v[92:95], v[108:111], 0
    ds_read_b64_tr_b16 v[84:85], v3 offset:768
    v_mfma_f32_16x16x32_bf16 v[40:43], v[92:95], v[124:127], 0
    ds_read_b64_tr_b16 v[86:87], v3 offset:4864
    s_waitcnt lgkmcnt(6)
    v_mfma_f32_16x16x32_bf16 v[44:47], v[96:99], v[108:111], 0
    ds_read_b64_tr_b16 v[88:89], v2 offset:800
    v_mfma_f32_16x16x32_bf16 v[48:51], v[96:99], v[124:127], 0
    ds_read_b64_tr_b16 v[90:91], v2 offset:4896
    s_waitcnt lgkmcnt(6)
    v_mfma_f32_16x16x32_bf16 v[52:55], v[100:103], v[108:111], 0
    ds_read_b64_tr_b16 v[92:93], v3 offset:8192
    v_mfma_f32_16x16x32_bf16 v[56:59], v[100:103], v[124:127], 0
    ds_read_b64_tr_b16 v[94:95], v3 offset:12288
    s_waitcnt lgkmcnt(6)
    v_mfma_f32_16x16x32_bf16 v[60:63], v[104:107], v[108:111], 0
    ds_read_b64_tr_b16 v[96:97], v2 offset:8224
    v_mfma_f32_16x16x32_bf16 v[64:67], v[104:107], v[124:127], 0
    ds_read_b64_tr_b16 v[98:99], v2 offset:12320
    s_waitcnt lgkmcnt(6)
    v_mfma_f32_16x16x32_bf16 v[68:71], v[84:87], v[108:111], 0
    ds_read_b64_tr_b16 v[100:101], v3 offset:8448
    v_mfma_f32_16x16x32_bf16 v[72:75], v[84:87], v[124:127], 0
    ds_read_b64_tr_b16 v[102:103], v3 offset:12544
    s_waitcnt lgkmcnt(6)
    v_mfma_f32_16x16x32_bf16 v[76:79], v[88:91], v[108:111], 0
    ds_read_b64_tr_b16 v[104:105], v2 offset:8480
    v_mfma_f32_16x16x32_bf16 v[80:83], v[88:91], v[124:127], 0
    ds_read_b64_tr_b16 v[106:107], v2 offset:12576
    s_waitcnt lgkmcnt(6)
    v_mfma_f32_16x16x32_bf16 v[20:23], v[92:95], v[112:115], v[20:23]
    ds_read_b64_tr_b16 v[84:85], v3 offset:8704
    v_mfma_f32_16x16x32_bf16 v[24:27], v[92:95], v[128:131], v[24:27]
    ds_read_b64_tr_b16 v[86:87], v3 offset:12800
    s_waitcnt lgkmcnt(6)
    v_mfma_f32_16x16x32_bf16 v[28:31], v[96:99], v[112:115], v[28:31]
    ds_read_b64_tr_b16 v[88:89], v2 offset:8736
    v_mfma_f32_16x16x32_bf16 v[32:35], v[96:99], v[128:131], v[32:35]
    ds_read_b64_tr_b16 v[90:91], v2 offset:12832
    s_waitcnt lgkmcnt(6)
    v_mfma_f32_16x16x32_bf16 v[36:39], v[100:103], v[112:115], v[36:39]
    ds_read_b64_tr_b16 v[92:93], v3 offset:8960
    v_mfma_f32_16x16x32_bf16 v[40:43], v[100:103], v[128:131], v[40:43]
    ds_read_b64_tr_b16 v[94:95], v3 offset:13056
    s_waitcnt lgkmcnt(6)
    v_mfma_f32_16x16x32_bf16 v[44:47], v[104:107], v[112:115], v[44:47]
    ds_read_b64_tr_b16 v[96:97], v2 offset:8992
    v_mfma_f32_16x16x32_bf16 v[48:51], v[104:107], v[128:131], v[48:51]
    ds_read_b64_tr_b16 v[98:99], v2 offset:13088
    s_waitcnt lgkmcnt(6)
    v_mfma_f32_16x16x32_bf16 v[52:55], v[84:87], v[112:115], v[52:55]
    v_mfma_f32_16x16x32_bf16 v[56:59], v[84:87], v[128:131], v[56:59]
    s_barrier
    ds_read_b64_tr_b16 v[100:101], v3 offset:16384
    ds_read_b64_tr_b16 v[102:103], v3 offset:20480
    s_waitcnt lgkmcnt(6)
    v_mfma_f32_16x16x32_bf16 v[60:63], v[88:91], v[112:115], v[60:63]
    ds_read_b64_tr_b16 v[104:105], v2 offset:16416
    v_mfma_f32_16x16x32_bf16 v[64:67], v[88:91], v[128:131], v[64:67]
    ds_read_b64_tr_b16 v[106:107], v2 offset:20512
    s_waitcnt lgkmcnt(6)
    v_mfma_f32_16x16x32_bf16 v[68:71], v[92:95], v[112:115], v[68:71]
    ds_read_b64_tr_b16 v[84:85], v3 offset:16640
    v_mfma_f32_16x16x32_bf16 v[72:75], v[92:95], v[128:131], v[72:75]
    ds_read_b64_tr_b16 v[86:87], v3 offset:20736
    s_waitcnt lgkmcnt(6)
    v_mfma_f32_16x16x32_bf16 v[76:79], v[96:99], v[112:115], v[76:79]
    ds_read_b64_tr_b16 v[88:89], v2 offset:16672
    v_mfma_f32_16x16x32_bf16 v[80:83], v[96:99], v[128:131], v[80:83]
    ds_read_b64_tr_b16 v[90:91], v2 offset:20768
    s_waitcnt lgkmcnt(6)
    v_mfma_f32_16x16x32_bf16 v[20:23], v[100:103], v[116:119], v[20:23]
    ds_read_b64_tr_b16 v[92:93], v3 offset:16896
    v_mfma_f32_16x16x32_bf16 v[24:27], v[100:103], v[132:135], v[24:27]
    ds_read_b64_tr_b16 v[94:95], v3 offset:20992
    s_waitcnt lgkmcnt(6)
    v_mfma_f32_16x16x32_bf16 v[28:31], v[104:107], v[116:119], v[28:31]
    ds_read_b64_tr_b16 v[96:97], v2 offset:16928
    v_mfma_f32_16x16x32_bf16 v[32:35], v[104:107], v[132:135], v[32:35]
    ds_read_b64_tr_b16 v[98:99], v2 offset:21024
    s_waitcnt lgkmcnt(6)
    v_mfma_f32_16x16x32_bf16 v[36:39], v[84:87], v[116:119], v[36:39]
    ds_read_b64_tr_b16 v[100:101], v3 offset:17152
    v_mfma_f32_16x16x32_bf16 v[40:43], v[84:87], v[132:135], v[40:43]
    ds_read_b64_tr_b16 v[102:103], v3 offset:21248
    s_waitcnt lgkmcnt(6)
    v_mfma_f32_16x16x32_bf16 v[44:47], v[88:91], v[116:119], v[44:47]
    ds_read_b64_tr_b16 v[104:105], v2 offset:17184
    v_mfma_f32_16x16x32_bf16 v[48:51], v[88:91], v[132:135], v[48:51]
    ds_read_b64_tr_b16 v[106:107], v2 offset:21280
    s_waitcnt lgkmcnt(6)
    v_mfma_f32_16x16x32_bf16 v[52:55], v[92:95], v[116:119], v[52:55]
    ds_read_b64_tr_b16 v[84:85], v3 offset:24576
    v_mfma_f32_16x16x32_bf16 v[56:59], v[92:95], v[132:135], v[56:59]
    ds_read_b64_tr_b16 v[86:87], v3 offset:28672
    s_waitcnt lgkmcnt(6)
    v_mfma_f32_16x16x32_bf16 v[60:63], v[96:99], v[116:119], v[60:63]
    ds_read_b64_tr_b16 v[88:89], v2 offset:24608
    v_mfma_f32_16x16x32_bf16 v[64:67], v[96:99], v[132:135], v[64:67]
    ds_read_b64_tr_b16 v[90:91], v2 offset:28704
    s_waitcnt lgkmcnt(6)
    v_mfma_f32_16x16x32_bf16 v[68:71], v[100:103], v[116:119], v[68:71]
    ds_read_b64_tr_b16 v[92:93], v3 offset:24832
    v_mfma_f32_16x16x32_bf16 v[72:75], v[100:103], v[132:135], v[72:75]
    ds_read_b64_tr_b16 v[94:95], v3 offset:28928
    s_waitcnt lgkmcnt(6)
    v_mfma_f32_16x16x32_bf16 v[76:79], v[104:107], v[116:119], v[76:79]
    ds_read_b64_tr_b16 v[96:97], v2 offset:24864
    v_mfma_f32_16x16x32_bf16 v[80:83], v[104:107], v[132:135], v[80:83]
    ds_read_b64_tr_b16 v[98:99], v2 offset:28960
    s_waitcnt lgkmcnt(6)
    v_mfma_f32_16x16x32_bf16 v[20:23], v[84:87], v[120:123], v[20:23]
    ds_read_b64_tr_b16 v[100:101], v3 offset:25088
    v_mfma_f32_16x16x32_bf16 v[24:27], v[84:87], v[136:139], v[24:27]
    ds_read_b64_tr_b16 v[102:103], v3 offset:29184
    s_waitcnt lgkmcnt(6)
    v_mfma_f32_16x16x32_bf16 v[28:31], v[88:91], v[120:123], v[28:31]
    ds_read_b64_tr_b16 v[104:105], v2 offset:25120
    v_mfma_f32_16x16x32_bf16 v[32:35], v[88:91], v[136:139], v[32:35]
    ds_read_b64_tr_b16 v[106:107], v2 offset:29216
    s_waitcnt lgkmcnt(6)
    v_mfma_f32_16x16x32_bf16 v[36:39], v[92:95], v[120:123], v[36:39]
    ds_read_b64_tr_b16 v[84:85], v3 offset:25344
    v_mfma_f32_16x16x32_bf16 v[40:43], v[92:95], v[136:139], v[40:43]
    ds_read_b64_tr_b16 v[86:87], v3 offset:29440
    s_waitcnt lgkmcnt(6)
    v_mfma_f32_16x16x32_bf16 v[44:47], v[96:99], v[120:123], v[44:47]
    ds_read_b64_tr_b16 v[88:89], v2 offset:25376
    v_mfma_f32_16x16x32_bf16 v[48:51], v[96:99], v[136:139], v[48:51]
    ds_read_b64_tr_b16 v[90:91], v2 offset:29472
    s_waitcnt lgkmcnt(6)
    v_mfma_f32_16x16x32_bf16 v[52:55], v[100:103], v[120:123], v[52:55]
    v_mfma_f32_16x16x32_bf16 v[56:59], v[100:103], v[136:139], v[56:59]
    s_barrier
    ds_read_b64_tr_b16 v[92:93], v3 offset:32768
    ds_read_b64_tr_b16 v[94:95], v3 offset:36864
    s_waitcnt lgkmcnt(6)
    v_mfma_f32_16x16x32_bf16 v[60:63], v[104:107], v[120:123], v[60:63]
    ds_read_b64_tr_b16 v[96:97], v2 offset:32800
    v_mfma_f32_16x16x32_bf16 v[64:67], v[104:107], v[136:139], v[64:67]
    ds_read_b64_tr_b16 v[98:99], v2 offset:36896
    s_waitcnt lgkmcnt(6)
    v_mfma_f32_16x16x32_bf16 v[68:71], v[84:87], v[120:123], v[68:71]
    ds_read_b64_tr_b16 v[100:101], v3 offset:33024
    v_mfma_f32_16x16x32_bf16 v[72:75], v[84:87], v[136:139], v[72:75]
    ds_read_b64_tr_b16 v[102:103], v3 offset:37120
    s_waitcnt lgkmcnt(6)
    v_mfma_f32_16x16x32_bf16 v[76:79], v[88:91], v[120:123], v[76:79]
    ds_read_b64_tr_b16 v[104:105], v2 offset:33056
    v_mfma_f32_16x16x32_bf16 v[80:83], v[88:91], v[136:139], v[80:83]
    ds_read_b64_tr_b16 v[106:107], v2 offset:37152
    v_and_b32 v9, 7, v0
    v_lshlrev_b32 v9, 2, v9
    s_mov_b32 s27, 0
fz_oBp:
    buffer_load_dword v10, v9, s[8:11], s20 offen sc1
    s_waitcnt vmcnt(0)
    v_cmp_ne_u32 vcc, s14, v10
    s_and_b32 vcc_lo, vcc_lo, 0xdd
    s_mov_b32 vcc_hi, 0
    s_add_u32 s27, s27, 1
    s_cmp_ge_u32 s27, 65536
    s_cbranch_scc1 fz_oBg
    s_cbranch_vccz fz_oBg
    s_sleep 1
    s_branch fz_oBp
fz_oBg:
    s_bfe_u32 s21, s42, 0x30004
    s_or_b32 s21, s21, s62
    s_lshl_b32 s21, s21, 12
    s_add_u32 s23, s21, 0x1000000
    buffer_load_dwordx4 v[140:143], v4, s[8:11], s23 offen offset:0 sc1
    s_add_u32 s23, s21, 0x1020000
    buffer_load_dwordx4 v[144:147], v4, s[8:11], s23 offen offset:0 sc1
    s_add_u32 s23, s21, 0x1000000
    buffer_load_dwordx4 v[148:151], v4, s[8:11], s23 offen offset:1024 sc1
    s_add_u32 s23, s21, 0x1020000
    buffer_load_dwordx4 v[152:155], v4, s[8:11], s23 offen offset:1024 sc1
    s_add_u32 s23, s21, 0x1000800
    buffer_load_dwordx4 v[156:159], v4, s[8:11], s23 offen offset:0 sc1
    s_add_u32 s23, s21, 0x1020800
    buffer_load_dwordx4 v[160:163], v4, s[8:11], s23 offen offset:0 sc1
    s_add_u32 s23, s21, 0x1000800
    buffer_load_dwordx4 v[164:167], v4, s[8:11], s23 offen offset:1024 sc1
    s_add_u32 s23, s21, 0x1020800
    buffer_load_dwordx4 v[168:171], v4, s[8:11], s23 offen offset:1024 sc1
    s_bfe_u32 s21, s42, 0x30008
    s_or_b32 s21, s21, s62
    s_lshl_b32 s21, s21, 12
    s_add_u32 s23, s21, 0x1000000
    buffer_load_dwordx4 v[188:191], v4, s[8:11], s23 offen offset:0 sc1
    s_add_u32 s23, s21, 0x1020000
    buffer_load_dwordx4 v[192:195], v4, s[8:11], s23 offen offset:0 sc1
    s_add_u32 s23, s21, 0x1000000
    buffer_load_dwordx4 v[196:199], v4, s[8:11], s23 offen offset:1024 sc1
    s_add_u32 s23, s21, 0x1020000
    buffer_load_dwordx4 v[200:203], v4, s[8:11], s23 offen offset:1024 sc1
    s_waitcnt vmcnt(11) lgkmcnt(6)
    v_mfma_f32_16x16x32_bf16 v[20:23], v[92:95], v[140:143], v[20:23]
    ds_read_b64_tr_b16 v[84:85], v3 offset:33280
    s_waitcnt vmcnt(10)
    v_mfma_f32_16x16x32_bf16 v[24:27], v[92:95], v[144:147], v[24:27]
    ds_read_b64_tr_b16 v[86:87], v3 offset:37376
    s_waitcnt lgkmcnt(6)
    v_mfma_f32_16x16x32_bf16 v[28:31], v[96:99], v[140:143], v[28:31]
    ds_read_b64_tr_b16 v[88:89], v2 offset:33312
    v_mfma_f32_16x16x32_bf16 v[32:35], v[96:99], v[144:147], v[32:35]
    ds_read_b64_tr_b16 v[90:91], v2 offset:37408
    s_add_u32 s23, s21, 0x1000800
    buffer_load_dwordx4 v[108:111], v4, s[8:11], s23 offen offset:0 sc1
    s_waitcnt lgkmcnt(6)
    v_mfma_f32_16x16x32_bf16 v[36:39], v[100:103], v[140:143], v[36:39]
    ds_read_b64_tr_b16 v[92:93], v3 offset:33536
    v_mfma_f32_16x16x32_bf16 v[40:43], v[100:103], v[144:147], v[40:43]
    ds_read_b64_tr_b16 v[94:95], v3 offset:37632
    s_waitcnt lgkmcnt(6)
    v_mfma_f32_16x16x32_bf16 v[44:47], v[104:107], v[140:143], v[44:47]
    ds_read_b64_tr_b16 v[96:97], v2 offset:33568
    v_mfma_f32_16x16x32_bf16 v[48:51], v[104:107], v[144:147], v[48:51]
    ds_read_b64_tr_b16 v[98:99], v2 offset:37664
    s_waitcnt lgkmcnt(6)
    v_mfma_f32_16x16x32_bf16 v[52:55], v[84:87], v[140:143], v[52:55]
    ds_read_b64_tr_b16 v[100:101], v3 offset:40960
    v_mfma_f32_16x16x32_bf16 v[56:59], v[84:87], v[144:147], v[56:59]
    ds_read_b64_tr_b16 v[102:103], v3 offset:45056
    s_waitcnt lgkmcnt(6)
    v_mfma_f32_16x16x32_bf16 v[60:63], v[88:91], v[140:143], v[60:63]
    ds_read_b64_tr_b16 v[104:105], v2 offset:40992
    v_mfma_f32_16x16x32_bf16 v[64:67], v[88:91], v[144:147], v[64:67]
    ds_read_b64_tr_b16 v[106:107], v2 offset:45088
    s_add_u32 s23, s21, 0x1020800
    buffer_load_dwordx4 v[112:115], v4, s[8:11], s23 offen offset:0 sc1
    s_waitcnt lgkmcnt(6)
    v_mfma_f32_16x16x32_bf16 v[68:71], v[92:95], v[140:143], v[68:71]
    ds_read_b64_tr_b16 v[84:85], v3 offset:41216
    v_mfma_f32_16x16x32_bf16 v[72:75], v[92:95], v[144:147], v[72:75]
    ds_read_b64_tr_b16 v[86:87], v3 offset:45312
    s_waitcnt lgkmcnt(6)
    v_mfma_f32_16x16x32_bf16 v[76:79], v[96:99], v[140:143], v[76:79]
    ds_read_b64_tr_b16 v[88:89], v2 offset:41248
    v_mfma_f32_16x16x32_bf16 v[80:83], v[96:99], v[144:147], v[80:83]
    ds_read_b64_tr_b16 v[90:91], v2 offset:45344
    s_waitcnt vmcnt(11) lgkmcnt(6)
    v_mfma_f32_16x16x32_bf16 v[20:23], v[100:103], v[148:151], v[20:23]
    ds_read_b64_tr_b16 v[92:93], v3 offset:41472
    s_waitcnt vmcnt(10)
    v_mfma_f32_16x16x32_bf16 v[24:27], v[100:103], v[152:155], v[24:27]
    ds_read_b64_tr_b16 v[94:95], v3 offset:45568
    s_waitcnt lgkmcnt(6)
    v_mfma_f32_16x16x32_bf16 v[28:31], v[104:107], v[148:151], v[28:31]
    ds_read_b64_tr_b16 v[96:97], v2 offset:41504
    v_mfma_f32_16x16x32_bf16 v[32:35], v[104:107], v[152:155], v[32:35]
    ds_read_b64_tr_b16 v[98:99], v2 offset:45600
    s_add_u32 s23, s21, 0x1000800
    buffer_load_dwordx4 v[116:119], v4, s[8:11], s23 offen offset:1024 sc1
    s_waitcnt lgkmcnt(6)
    v_mfma_f32_16x16x32_bf16 v[36:39], v[84:87], v[148:151], v[36:39]
    ds_read_b64_tr_b16 v[100:101], v3 offset:41728
    v_mfma_f32_16x16x32_bf16 v[40:43], v[84:87], v[152:155], v[40:43]
    ds_read_b64_tr_b16 v[102:103], v3 offset:45824
    s_waitcnt lgkmcnt(6)
    v_mfma_f32_16x16x32_bf16 v[44:47], v[88:91], v[148:151], v[44:47]
    ds_read_b64_tr_b16 v[104:105], v2 offset:41760
    v_mfma_f32_16x16x32_bf16 v[48:51], v[88:91], v[152:155], v[48:51]
    ds_read_b64_tr_b16 v[106:107], v2 offset:45856
    s_waitcnt lgkmcnt(6)
    v_mfma_f32_16x16x32_bf16 v[52:55], v[92:95], v[148:151], v[52:55]
    v_mfma_f32_16x16x32_bf16 v[56:59], v[92:95], v[152:155], v[56:59]
    s_barrier
    ds_read_b64_tr_b16 v[84:85], v3 offset:49152
    ds_read_b64_tr_b16 v[86:87], v3 offset:53248
    s_waitcnt lgkmcnt(6)
    v_mfma_f32_16x16x32_bf16 v[60:63], v[96:99], v[148:151], v[60:63]
    ds_read_b64_tr_b16 v[88:89], v2 offset:49184
    v_mfma_f32_16x16x32_bf16 v[64:67], v[96:99], v[152:155], v[64:67]
    ds_read_b64_tr_b16 v[90:91], v2 offset:53280
    s_add_u32 s23, s21, 0x1020800
    buffer_load_dwordx4 v[120:123], v4, s[8:11], s23 offen offset:1024 sc1
    s_waitcnt lgkmcnt(6)
    v_mfma_f32_16x16x32_bf16 v[68:71], v[100:103], v[148:151], v[68:71]
    ds_read_b64_tr_b16 v[92:93], v3 offset:49408
    v_mfma_f32_16x16x32_bf16 v[72:75], v[100:103], v[152:155], v[72:75]
    ds_read_b64_tr_b16 v[94:95], v3 offset:53504
    s_waitcnt lgkmcnt(6)
    v_mfma_f32_16x16x32_bf16 v[76:79], v[104:107], v[148:151], v[76:79]
    ds_read_b64_tr_b16 v[96:97], v2 offset:49440
    v_mfma_f32_16x16x32_bf16 v[80:83], v[104:107], v[152:155], v[80:83]
    ds_read_b64_tr_b16 v[98:99], v2 offset:53536
    s_waitcnt vmcnt(11) lgkmcnt(6)
    v_mfma_f32_16x16x32_bf16 v[20:23], v[84:87], v[156:159], v[20:23]
    ds_read_b64_tr_b16 v[100:101], v3 offset:49664
    s_waitcnt vmcnt(10)
    v_mfma_f32_16x16x32_bf16 v[24:27], v[84:87], v[160:163], v[24:27]
    ds_read_b64_tr_b16 v[102:103], v3 offset:53760
    s_waitcnt lgkmcnt(6)
    v_mfma_f32_16x16x32_bf16 v[28:31], v[88:91], v[156:159], v[28:31]
    ds_read_b64_tr_b16 v[104:105], v2 offset:49696
    v_mfma_f32_16x16x32_bf16 v[32:35], v[88:91], v[160:163], v[32:35]
    ds_read_b64_tr_b16 v[106:107], v2 offset:53792
    s_bfe_u32 s21, s42, 0x3000c
    s_or_b32 s21, s21, s62
    s_lshl_b32 s21, s21, 12
    s_add_u32 s23, s21, 0x1000000
    buffer_load_dwordx4 v[140:143], v4, s[8:11], s23 offen offset:0 sc1
    s_waitcnt lgkmcnt(6)
    v_mfma_f32_16x16x32_bf16 v[36:39], v[92:95], v[156:159], v[36:39]
    ds_read_b64_tr_b16 v[84:85], v3 offset:49920
    v_mfma_f32_16x16x32_bf16 v[40:43], v[92:95], v[160:163], v[40:43]
    ds_read_b64_tr_b16 v[86:87], v3 offset:54016
    s_waitcnt lgkmcnt(6)
    v_mfma_f32_16x16x32_bf16 v[44:47], v[96:99], v[156:159], v[44:47]
    ds_read_b64_tr_b16 v[88:89], v2 offset:49952
    v_mfma_f32_16x16x32_bf16 v[48:51], v[96:99], v[160:163], v[48:51]
    ds_read_b64_tr_b16 v[90:91], v2 offset:54048
    s_waitcnt lgkmcnt(6)
    v_mfma_f32_16x16x32_bf16 v[52:55], v[100:103], v[156:159], v[52:55]
    ds_read_b64_tr_b16 v[92:93], v3 offset:57344
    v_mfma_f32_16x16x32_bf16 v[56:59], v[100:103], v[160:163], v[56:59]
    ds_read_b64_tr_b16 v[94:95], v3 offset:61440
    s_waitcnt lgkmcnt(6)
    v_mfma_f32_16x16x32_bf16 v[60:63], v[104:107], v[156:159], v[60:63]
    ds_read_b64_tr_b16 v[96:97], v2 offset:57376
    v_mfma_f32_16x16x32_bf16 v[64:67], v[104:107], v[160:163], v[64:67]
    ds_read_b64_tr_b16 v[98:99], v2 offset:61472
    s_add_u32 s23, s21, 0x1020000
    buffer_load_dwordx4 v[144:147], v4, s[8:11], s23 offen offset:0 sc1
    s_waitcnt lgkmcnt(6)
    v_mfma_f32_16x16x32_bf16 v[68:71], v[84:87], v[156:159], v[68:71]
    ds_read_b64_tr_b16 v[100:101], v3 offset:57600
    v_mfma_f32_16x16x32_bf16 v[72:75], v[84:87], v[160:163], v[72:75]
    ds_read_b64_tr_b16 v[102:103], v3 offset:61696
    s_waitcnt lgkmcnt(6)
    v_mfma_f32_16x16x32_bf16 v[76:79], v[88:91], v[156:159], v[76:79]
    ds_read_b64_tr_b16 v[104:105], v2 offset:57632
    v_mfma_f32_16x16x32_bf16 v[80:83], v[88:91], v[160:163], v[80:83]
    ds_read_b64_tr_b16 v[106:107], v2 offset:61728
    s_waitcnt vmcnt(11) lgkmcnt(6)
    v_mfma_f32_16x16x32_bf16 v[20:23], v[92:95], v[164:167], v[20:23]
    ds_read_b64_tr_b16 v[84:85], v3 offset:57856
    s_waitcnt vmcnt(10)
    v_mfma_f32_16x16x32_bf16 v[24:27], v[92:95], v[168:171], v[24:27]
    ds_read_b64_tr_b16 v[86:87], v3 offset:61952
    s_waitcnt lgkmcnt(6)
    v_mfma_f32_16x16x32_bf16 v[28:31], v[96:99], v[164:167], v[28:31]
    ds_read_b64_tr_b16 v[88:89], v2 offset:57888
    v_mfma_f32_16x16x32_bf16 v[32:35], v[96:99], v[168:171], v[32:35]
    ds_read_b64_tr_b16 v[90:91], v2 offset:61984
    s_add_u32 s23, s21, 0x1000000
    buffer_load_dwordx4 v[148:151], v4, s[8:11], s23 offen offset:1024 sc1
    s_waitcnt lgkmcnt(6)
    v_mfma_f32_16x16x32_bf16 v[36:39], v[100:103], v[164:167], v[36:39]
    ds_read_b64_tr_b16 v[92:93], v3 offset:58112
    v_mfma_f32_16x16x32_bf16 v[40:43], v[100:103], v[168:171], v[40:43]
    ds_read_b64_tr_b16 v[94:95], v3 offset:62208
    s_waitcnt lgkmcnt(6)
    v_mfma_f32_16x16x32_bf16 v[44:47], v[104:107], v[164:167], v[44:47]
    ds_read_b64_tr_b16 v[96:97], v2 offset:58144
    v_mfma_f32_16x16x32_bf16 v[48:51], v[104:107], v[168:171], v[48:51]
    ds_read_b64_tr_b16 v[98:99], v2 offset:62240
    s_waitcnt lgkmcnt(6)
    v_mfma_f32_16x16x32_bf16 v[52:55], v[84:87], v[164:167], v[52:55]
    v_mfma_f32_16x16x32_bf16 v[56:59], v[84:87], v[168:171], v[56:59]
    s_barrier
    ds_read_b64_tr_b16 v[100:101], v15 offset:0
    ds_read_b64_tr_b16 v[102:103], v15 offset:4096
    s_waitcnt lgkmcnt(6)
    v_mfma_f32_16x16x32_bf16 v[60:63], v[88:91], v[164:167], v[60:63]
    ds_read_b64_tr_b16 v[104:105], v16 offset:32
    v_mfma_f32_16x16x32_bf16 v[64:67], v[88:91], v[168:171], v[64:67]
    ds_read_b64_tr_b16 v[106:107], v16 offset:4128
    s_add_u32 s23, s21, 0x1020000
    buffer_load_dwordx4 v[152:155], v4, s[8:11], s23 offen offset:1024 sc1
    s_waitcnt lgkmcnt(6)
    v_mfma_f32_16x16x32_bf16 v[68:71], v[92:95], v[164:167], v[68:71]
    ds_read_b64_tr_b16 v[84:85], v15 offset:256
    v_mfma_f32_16x16x32_bf16 v[72:75], v[92:95], v[168:171], v[72:75]
    ds_read_b64_tr_b16 v[86:87], v15 offset:4352
    s_waitcnt lgkmcnt(6)
    v_mfma_f32_16x16x32_bf16 v[76:79], v[96:99], v[164:167], v[76:79]
    ds_read_b64_tr_b16 v[88:89], v16 offset:288
    v_mfma_f32_16x16x32_bf16 v[80:83], v[96:99], v[168:171], v[80:83]
    ds_read_b64_tr_b16 v[90:91], v16 offset:4384
    s_waitcnt vmcnt(11) lgkmcnt(6)
    v_mfma_f32_16x16x32_bf16 v[20:23], v[100:103], v[188:191], v[20:23]
    ds_read_b64_tr_b16 v[92:93], v15 offset:512
    s_waitcnt vmcnt(10)
    v_mfma_f32_16x16x32_bf16 v[24:27], v[100:103], v[192:195], v[24:27]
    ds_read_b64_tr_b16 v[94:95], v15 offset:4608
    s_waitcnt lgkmcnt(6)
    v_mfma_f32_16x16x32_bf16 v[28:31], v[104:107], v[188:191], v[28:31]
    ds_read_b64_tr_b16 v[96:97], v16 offset:544
    v_mfma_f32_16x16x32_bf16 v[32:35], v[104:107], v[192:195], v[32:35]
    ds_read_b64_tr_b16 v[98:99], v16 offset:4640
    s_add_u32 s23, s21, 0x1000800
    buffer_load_dwordx4 v[156:159], v4, s[8:11], s23 offen offset:0 sc1
    s_waitcnt lgkmcnt(6)
    v_mfma_f32_16x16x32_bf16 v[36:39], v[84:87], v[188:191], v[36:39]
    ds_read_b64_tr_b16 v[100:101], v15 offset:768
    v_mfma_f32_16x16x32_bf16 v[40:43], v[84:87], v[192:195], v[40:43]
    ds_read_b64_tr_b16 v[102:103], v15 offset:4864
    s_waitcnt lgkmcnt(6)
    v_mfma_f32_16x16x32_bf16 v[44:47], v[88:91], v[188:191], v[44:47]
    ds_read_b64_tr_b16 v[104:105], v16 offset:800
    v_mfma_f32_16x16x32_bf16 v[48:51], v[88:91], v[192:195], v[48:51]
    ds_read_b64_tr_b16 v[106:107], v16 offset:4896
    s_waitcnt lgkmcnt(6)
    v_mfma_f32_16x16x32_bf16 v[52:55], v[92:95], v[188:191], v[52:55]
    ds_read_b64_tr_b16 v[84:85], v15 offset:8192
    v_mfma_f32_16x16x32_bf16 v[56:59], v[92:95], v[192:195], v[56:59]
    ds_read_b64_tr_b16 v[86:87], v15 offset:12288
    s_waitcnt lgkmcnt(6)
    v_mfma_f32_16x16x32_bf16 v[60:63], v[96:99], v[188:191], v[60:63]
    ds_read_b64_tr_b16 v[88:89], v16 offset:8224
    v_mfma_f32_16x16x32_bf16 v[64:67], v[96:99], v[192:195], v[64:67]
    ds_read_b64_tr_b16 v[90:91], v16 offset:12320
    s_add_u32 s23, s21, 0x1020800
    buffer_load_dwordx4 v[160:163], v4, s[8:11], s23 offen offset:0 sc1
    s_waitcnt lgkmcnt(6)
    v_mfma_f32_16x16x32_bf16 v[68:71], v[100:103], v[188:191], v[68:71]
    ds_read_b64_tr_b16 v[92:93], v15 offset:8448
    v_mfma_f32_16x16x32_bf16 v[72:75], v[100:103], v[192:195], v[72:75]
    ds_read_b64_tr_b16 v[94:95], v15 offset:12544
    s_waitcnt lgkmcnt(6)
    v_mfma_f32_16x16x32_bf16 v[76:79], v[104:107], v[188:191], v[76:79]
    ds_read_b64_tr_b16 v[96:97], v16 offset:8480
    v_mfma_f32_16x16x32_bf16 v[80:83], v[104:107], v[192:195], v[80:83]
    ds_read_b64_tr_b16 v[98:99], v16 offset:12576
    s_waitcnt vmcnt(11) lgkmcnt(6)
    v_mfma_f32_16x16x32_bf16 v[20:23], v[84:87], v[196:199], v[20:23]
    ds_read_b64_tr_b16 v[100:101], v15 offset:8704
    s_waitcnt vmcnt(10)
    v_mfma_f32_16x16x32_bf16 v[24:27], v[84:87], v[200:203], v[24:27]
    ds_read_b64_tr_b16 v[102:103], v15 offset:12800
    s_waitcnt lgkmcnt(6)
    v_mfma_f32_16x16x32_bf16 v[28:31], v[88:91], v[196:199], v[28:31]
    ds_read_b64_tr_b16 v[104:105], v16 offset:8736
    v_mfma_f32_16x16x32_bf16 v[32:35], v[88:91], v[200:203], v[32:35]
    ds_read_b64_tr_b16 v[106:107], v16 offset:12832
    s_add_u32 s23, s21, 0x1000800
    buffer_load_dwordx4 v[164:167], v4, s[8:11], s23 offen offset:1024 sc1
    s_waitcnt lgkmcnt(6)
    v_mfma_f32_16x16x32_bf16 v[36:39], v[92:95], v[196:199], v[36:39]
    ds_read_b64_tr_b16 v[84:85], v15 offset:8960
    v_mfma_f32_16x16x32_bf16 v[40:43], v[92:95], v[200:203], v[40:43]
    ds_read_b64_tr_b16 v[86:87], v15 offset:13056
    s_waitcnt lgkmcnt(6)
    v_mfma_f32_16x16x32_bf16 v[44:47], v[96:99], v[196:199], v[44:47]
    ds_read_b64_tr_b16 v[88:89], v16 offset:8992
    v_mfma_f32_16x16x32_bf16 v[48:51], v[96:99], v[200:203], v[48:51]
    ds_read_b64_tr_b16 v[90:91], v16 offset:13088
    s_waitcnt lgkmcnt(6)
    v_mfma_f32_16x16x32_bf16 v[52:55], v[100:103], v[196:199], v[52:55]
    v_mfma_f32_16x16x32_bf16 v[56:59], v[100:103], v[200:203], v[56:59]
    s_barrier
    ds_read_b64_tr_b16 v[92:93], v15 offset:16384
    ds_read_b64_tr_b16 v[94:95], v15 offset:20480
    s_waitcnt lgkmcnt(6)
    v_mfma_f32_16x16x32_bf16 v[60:63], v[104:107], v[196:199], v[60:63]
    ds_read_b64_tr_b16 v[96:97], v16 offset:16416
    v_mfma_f32_16x16x32_bf16 v[64:67], v[104:107], v[200:203], v[64:67]
    ds_read_b64_tr_b16 v[98:99], v16 offset:20512
    s_add_u32 s23, s21, 0x1020800
    buffer_load_dwordx4 v[168:171], v4, s[8:11], s23 offen offset:1024 sc1
    s_waitcnt lgkmcnt(6)
    v_mfma_f32_16x16x32_bf16 v[68:71], v[84:87], v[196:199], v[68:71]
    ds_read_b64_tr_b16 v[100:101], v15 offset:16640
    v_mfma_f32_16x16x32_bf16 v[72:75], v[84:87], v[200:203], v[72:75]
    ds_read_b64_tr_b16 v[102:103], v15 offset:20736
    s_waitcnt lgkmcnt(6)
    v_mfma_f32_16x16x32_bf16 v[76:79], v[88:91], v[196:199], v[76:79]
    ds_read_b64_tr_b16 v[104:105], v16 offset:16672
    v_mfma_f32_16x16x32_bf16 v[80:83], v[88:91], v[200:203], v[80:83]
    ds_read_b64_tr_b16 v[106:107], v16 offset:20768
    s_waitcnt vmcnt(11) lgkmcnt(6)
    v_mfma_f32_16x16x32_bf16 v[20:23], v[92:95], v[108:111], v[20:23]
    ds_read_b64_tr_b16 v[84:85], v15 offset:16896
    s_waitcnt vmcnt(10)
    v_mfma_f32_16x16x32_bf16 v[24:27], v[92:95], v[112:115], v[24:27]
    ds_read_b64_tr_b16 v[86:87], v15 offset:20992
    s_waitcnt lgkmcnt(6)
    v_mfma_f32_16x16x32_bf16 v[28:31], v[96:99], v[108:111], v[28:31]
    ds_read_b64_tr_b16 v[88:89], v16 offset:16928
    v_mfma_f32_16x16x32_bf16 v[32:35], v[96:99], v[112:115], v[32:35]
    ds_read_b64_tr_b16 v[90:91], v16 offset:21024
    s_bfe_u32 s21, s42, 0x30010
    s_or_b32 s21, s21, s62
    s_lshl_b32 s21, s21, 12
    s_add_u32 s23, s21, 0x1000000
    buffer_load_dwordx4 v[188:191], v4, s[8:11], s23 offen offset:0 sc1
    s_waitcnt lgkmcnt(6)
    v_mfma_f32_16x16x32_bf16 v[36:39], v[100:103], v[108:111], v[36:39]
    ds_read_b64_tr_b16 v[92:93], v15 offset:17152
    v_mfma_f32_16x16x32_bf16 v[40:43], v[100:103], v[112:115], v[40:43]
    ds_read_b64_tr_b16 v[94:95], v15 offset:21248
    s_waitcnt lgkmcnt(6)
    v_mfma_f32_16x16x32_bf16 v[44:47], v[104:107], v[108:111], v[44:47]
    ds_read_b64_tr_b16 v[96:97], v16 offset:17184
    v_mfma_f32_16x16x32_bf16 v[48:51], v[104:107], v[112:115], v[48:51]
    ds_read_b64_tr_b16 v[98:99], v16 offset:21280
    s_waitcnt lgkmcnt(6)
    v_mfma_f32_16x16x32_bf16 v[52:55], v[84:87], v[108:111], v[52:55]
    ds_read_b64_tr_b16 v[100:101], v15 offset:24576
    v_mfma_f32_16x16x32_bf16 v[56:59], v[84:87], v[112:115], v[56:59]
    ds_read_b64_tr_b16 v[102:103], v15 offset:28672
    s_waitcnt lgkmcnt(6)
    v_mfma_f32_16x16x32_bf16 v[60:63], v[88:91], v[108:111], v[60:63]
    ds_read_b64_tr_b16 v[104:105], v16 offset:24608
    v_mfma_f32_16x16x32_bf16 v[64:67], v[88:91], v[112:115], v[64:67]
    ds_read_b64_tr_b16 v[106:107], v16 offset:28704
    s_add_u32 s23, s21, 0x1020000
    buffer_load_dwordx4 v[192:195], v4, s[8:11], s23 offen offset:0 sc1
    s_waitcnt lgkmcnt(6)
    v_mfma_f32_16x16x32_bf16 v[68:71], v[92:95], v[108:111], v[68:71]
    ds_read_b64_tr_b16 v[84:85], v15 offset:24832
    v_mfma_f32_16x16x32_bf16 v[72:75], v[92:95], v[112:115], v[72:75]
    ds_read_b64_tr_b16 v[86:87], v15 offset:28928
    s_waitcnt lgkmcnt(6)
    v_mfma_f32_16x16x32_bf16 v[76:79], v[96:99], v[108:111], v[76:79]
    ds_read_b64_tr_b16 v[88:89], v16 offset:24864
    v_mfma_f32_16x16x32_bf16 v[80:83], v[96:99], v[112:115], v[80:83]
    ds_read_b64_tr_b16 v[90:91], v16 offset:28960
    s_waitcnt vmcnt(11) lgkmcnt(6)
    v_mfma_f32_16x16x32_bf16 v[20:23], v[100:103], v[116:119], v[20:23]
    ds_read_b64_tr_b16 v[92:93], v15 offset:25088
    s_waitcnt vmcnt(10)
    v_mfma_f32_16x16x32_bf16 v[24:27], v[100:103], v[120:123], v[24:27]
    ds_read_b64_tr_b16 v[94:95], v15 offset:29184
    s_waitcnt lgkmcnt(6)
    v_mfma_f32_16x16x32_bf16 v[28:31], v[104:107], v[116:119], v[28:31]
    ds_read_b64_tr_b16 v[96:97], v16 offset:25120
    v_mfma_f32_16x16x32_bf16 v[32:35], v[104:107], v[120:123], v[32:35]
    ds_read_b64_tr_b16 v[98:99], v16 offset:29216
    s_add_u32 s23, s21, 0x1000000
    buffer_load_dwordx4 v[196:199], v4, s[8:11], s23 offen offset:1024 sc1
    s_waitcnt lgkmcnt(6)
    v_mfma_f32_16x16x32_bf16 v[36:39], v[84:87], v[116:119], v[36:39]
    ds_read_b64_tr_b16 v[100:101], v15 offset:25344
    v_mfma_f32_16x16x32_bf16 v[40:43], v[84:87], v[120:123], v[40:43]
    ds_read_b64_tr_b16 v[102:103], v15 offset:29440
    s_waitcnt lgkmcnt(6)
    v_mfma_f32_16x16x32_bf16 v[44:47], v[88:91], v[116:119], v[44:47]
    ds_read_b64_tr_b16 v[104:105], v16 offset:25376
    v_mfma_f32_16x16x32_bf16 v[48:51], v[88:91], v[120:123], v[48:51]
    ds_read_b64_tr_b16 v[106:107], v16 offset:29472
    s_waitcnt lgkmcnt(6)
    v_mfma_f32_16x16x32_bf16 v[52:55], v[92:95], v[116:119], v[52:55]
    v_mfma_f32_16x16x32_bf16 v[56:59], v[92:95], v[120:123], v[56:59]
    s_barrier
    ds_read_b64_tr_b16 v[84:85], v15 offset:32768
    ds_read_b64_tr_b16 v[86:87], v15 offset:36864
    s_waitcnt lgkmcnt(6)
    v_mfma_f32_16x16x32_bf16 v[60:63], v[96:99], v[116:119], v[60:63]
    ds_read_b64_tr_b16 v[88:89], v16 offset:32800
    v_mfma_f32_16x16x32_bf16 v[64:67], v[96:99], v[120:123], v[64:67]
    ds_read_b64_tr_b16 v[90:91], v16 offset:36896
    s_add_u32 s23, s21, 0x1020000
    buffer_load_dwordx4 v[200:203], v4, s[8:11], s23 offen offset:1024 sc1
    s_waitcnt lgkmcnt(6)
    v_mfma_f32_16x16x32_bf16 v[68:71], v[100:103], v[116:119], v[68:71]
    ds_read_b64_tr_b16 v[92:93], v15 offset:33024
    v_mfma_f32_16x16x32_bf16 v[72:75], v[100:103], v[120:123], v[72:75]
    ds_read_b64_tr_b16 v[94:95], v15 offset:37120
    s_waitcnt lgkmcnt(6)
    v_mfma_f32_16x16x32_bf16 v[76:79], v[104:107], v[116:119], v[76:79]
    ds_read_b64_tr_b16 v[96:97], v16 offset:33056
    v_mfma_f32_16x16x32_bf16 v[80:83], v[104:107], v[120:123], v[80:83]
    ds_read_b64_tr_b16 v[98:99], v16 offset:37152
    s_waitcnt vmcnt(11) lgkmcnt(6)
    v_mfma_f32_16x16x32_bf16 v[20:23], v[84:87], v[140:143], v[20:23]
    ds_read_b64_tr_b16 v[100:101], v15 offset:33280
    s_waitcnt vmcnt(10)
    v_mfma_f32_16x16x32_bf16 v[24:27], v[84:87], v[144:147], v[24:27]
    ds_read_b64_tr_b16 v[102:103], v15 offset:37376
    s_waitcnt lgkmcnt(6)
    v_mfma_f32_16x16x32_bf16 v[28:31], v[88:91], v[140:143], v[28:31]
    ds_read_b64_tr_b16 v[104:105], v16 offset:33312
    v_mfma_f32_16x16x32_bf16 v[32:35], v[88:91], v[144:147], v[32:35]
    ds_read_b64_tr_b16 v[106:107], v16 offset:37408
    s_add_u32 s23, s21, 0x1000800
    buffer_load_dwordx4 v[108:111], v4, s[8:11], s23 offen offset:0 sc1
    s_waitcnt lgkmcnt(6)
    v_mfma_f32_16x16x32_bf16 v[36:39], v[92:95], v[140:143], v[36:39]
    ds_read_b64_tr_b16 v[84:85], v15 offset:33536
    v_mfma_f32_16x16x32_bf16 v[40:43], v[92:95], v[144:147], v[40:43]
    ds_read_b64_tr_b16 v[86:87], v15 offset:37632
    s_waitcnt lgkmcnt(6)
    v_mfma_f32_16x16x32_bf16 v[44:47], v[96:99], v[140:143], v[44:47]
    ds_read_b64_tr_b16 v[88:89], v16 offset:33568
    v_mfma_f32_16x16x32_bf16 v[48:51], v[96:99], v[144:147], v[48:51]
    ds_read_b64_tr_b16 v[90:91], v16 offset:37664
    s_waitcnt lgkmcnt(6)
    v_mfma_f32_16x16x32_bf16 v[52:55], v[100:103], v[140:143], v[52:55]
    ds_read_b64_tr_b16 v[92:93], v15 offset:40960
    v_mfma_f32_16x16x32_bf16 v[56:59], v[100:103], v[144:147], v[56:59]
    ds_read_b64_tr_b16 v[94:95], v15 offset:45056
    s_waitcnt lgkmcnt(6)
    v_mfma_f32_16x16x32_bf16 v[60:63], v[104:107], v[140:143], v[60:63]
    ds_read_b64_tr_b16 v[96:97], v16 offset:40992
    v_mfma_f32_16x16x32_bf16 v[64:67], v[104:107], v[144:147], v[64:67]
    ds_read_b64_tr_b16 v[98:99], v16 offset:45088
    s_add_u32 s23, s21, 0x1020800
    buffer_load_dwordx4 v[112:115], v4, s[8:11], s23 offen offset:0 sc1
    s_waitcnt lgkmcnt(6)
    v_mfma_f32_16x16x32_bf16 v[68:71], v[84:87], v[140:143], v[68:71]
    ds_read_b64_tr_b16 v[100:101], v15 offset:41216
    v_mfma_f32_16x16x32_bf16 v[72:75], v[84:87], v[144:147], v[72:75]
    ds_read_b64_tr_b16 v[102:103], v15 offset:45312
    s_waitcnt lgkmcnt(6)
    v_mfma_f32_16x16x32_bf16 v[76:79], v[88:91], v[140:143], v[76:79]
    ds_read_b64_tr_b16 v[104:105], v16 offset:41248
    v_mfma_f32_16x16x32_bf16 v[80:83], v[88:91], v[144:147], v[80:83]
    ds_read_b64_tr_b16 v[106:107], v16 offset:45344
    s_waitcnt vmcnt(11) lgkmcnt(6)
    v_mfma_f32_16x16x32_bf16 v[20:23], v[92:95], v[148:151], v[20:23]
    ds_read_b64_tr_b16 v[84:85], v15 offset:41472
    s_waitcnt vmcnt(10)
    v_mfma_f32_16x16x32_bf16 v[24:27], v[92:95], v[152:155], v[24:27]
    ds_read_b64_tr_b16 v[86:87], v15 offset:45568
    s_waitcnt lgkmcnt(6)
    v_mfma_f32_16x16x32_bf16 v[28:31], v[96:99], v[148:151], v[28:31]
    ds_read_b64_tr_b16 v[88:89], v16 offset:41504
    v_mfma_f32_16x16x32_bf16 v[32:35], v[96:99], v[152:155], v[32:35]
    ds_read_b64_tr_b16 v[90:91], v16 offset:45600
    s_add_u32 s23, s21, 0x1000800
    buffer_load_dwordx4 v[116:119], v4, s[8:11], s23 offen offset:1024 sc1
    s_waitcnt lgkmcnt(6)
    v_mfma_f32_16x16x32_bf16 v[36:39], v[100:103], v[148:151], v[36:39]
    ds_read_b64_tr_b16 v[92:93], v15 offset:41728
    v_mfma_f32_16x16x32_bf16 v[40:43], v[100:103], v[152:155], v[40:43]
    ds_read_b64_tr_b16 v[94:95], v15 offset:45824
    s_waitcnt lgkmcnt(6)
    v_mfma_f32_16x16x32_bf16 v[44:47], v[104:107], v[148:151], v[44:47]
    ds_read_b64_tr_b16 v[96:97], v16 offset:41760
    v_mfma_f32_16x16x32_bf16 v[48:51], v[104:107], v[152:155], v[48:51]
    ds_read_b64_tr_b16 v[98:99], v16 offset:45856
    s_waitcnt lgkmcnt(6)
    v_mfma_f32_16x16x32_bf16 v[52:55], v[84:87], v[148:151], v[52:55]
    v_mfma_f32_16x16x32_bf16 v[56:59], v[84:87], v[152:155], v[56:59]
    s_barrier
    ds_read_b64_tr_b16 v[100:101], v15 offset:49152
    ds_read_b64_tr_b16 v[102:103], v15 offset:53248
    s_waitcnt lgkmcnt(6)
    v_mfma_f32_16x16x32_bf16 v[60:63], v[88:91], v[148:151], v[60:63]
    ds_read_b64_tr_b16 v[104:105], v16 offset:49184
    v_mfma_f32_16x16x32_bf16 v[64:67], v[88:91], v[152:155], v[64:67]
    ds_read_b64_tr_b16 v[106:107], v16 offset:53280
    s_add_u32 s23, s21, 0x1020800
    buffer_load_dwordx4 v[120:123], v4, s[8:11], s23 offen offset:1024 sc1
    s_waitcnt lgkmcnt(6)
    v_mfma_f32_16x16x32_bf16 v[68:71], v[92:95], v[148:151], v[68:71]
    ds_read_b64_tr_b16 v[84:85], v15 offset:49408
    v_mfma_f32_16x16x32_bf16 v[72:75], v[92:95], v[152:155], v[72:75]
    ds_read_b64_tr_b16 v[86:87], v15 offset:53504
    s_waitcnt lgkmcnt(6)
    v_mfma_f32_16x16x32_bf16 v[76:79], v[96:99], v[148:151], v[76:79]
    ds_read_b64_tr_b16 v[88:89], v16 offset:49440
    v_mfma_f32_16x16x32_bf16 v[80:83], v[96:99], v[152:155], v[80:83]
    ds_read_b64_tr_b16 v[90:91], v16 offset:53536
    s_waitcnt vmcnt(11) lgkmcnt(6)
    v_mfma_f32_16x16x32_bf16 v[20:23], v[100:103], v[156:159], v[20:23]
    ds_read_b64_tr_b16 v[92:93], v15 offset:49664
    s_waitcnt vmcnt(10)
    v_mfma_f32_16x16x32_bf16 v[24:27], v[100:103], v[160:163], v[24:27]
    ds_read_b64_tr_b16 v[94:95], v15 offset:53760
    s_waitcnt lgkmcnt(6)
    v_mfma_f32_16x16x32_bf16 v[28:31], v[104:107], v[156:159], v[28:31]
    ds_read_b64_tr_b16 v[96:97], v16 offset:49696
    v_mfma_f32_16x16x32_bf16 v[32:35], v[104:107], v[160:163], v[32:35]
    ds_read_b64_tr_b16 v[98:99], v16 offset:53792
    s_bfe_u32 s21, s42, 0x30014
    s_or_b32 s21, s21, s62
    s_lshl_b32 s21, s21, 12
    s_add_u32 s23, s21, 0x1000000
    buffer_load_dwordx4 v[140:143], v4, s[8:11], s23 offen offset:0 sc1
    s_waitcnt lgkmcnt(6)
    v_mfma_f32_16x16x32_bf16 v[36:39], v[84:87], v[156:159], v[36:39]
    ds_read_b64_tr_b16 v[100:101], v15 offset:49920
    v_mfma_f32_16x16x32_bf16 v[40:43], v[84:87], v[160:163], v[40:43]
    ds_read_b64_tr_b16 v[102:103], v15 offset:54016
    buffer_load_dword v10, v9, s[8:11], s20 offen sc1
    s_waitcnt lgkmcnt(6)
    v_mfma_f32_16x16x32_bf16 v[44:47], v[88:91], v[156:159], v[44:47]
    ds_read_b64_tr_b16 v[104:105], v16 offset:49952
    v_mfma_f32_16x16x32_bf16 v[48:51], v[88:91], v[160:163], v[48:51]
    ds_read_b64_tr_b16 v[106:107], v16 offset:54048
    s_waitcnt lgkmcnt(6)
    v_mfma_f32_16x16x32_bf16 v[52:55], v[92:95], v[156:159], v[52:55]
    ds_read_b64_tr_b16 v[84:85], v15 offset:57344
    v_mfma_f32_16x16x32_bf16 v[56:59], v[92:95], v[160:163], v[56:59]
    ds_read_b64_tr_b16 v[86:87], v15 offset:61440
    s_waitcnt lgkmcnt(6)
    v_mfma_f32_16x16x32_bf16 v[60:63], v[96:99], v[156:159], v[60:63]
    ds_read_b64_tr_b16 v[88:89], v16 offset:57376
    v_mfma_f32_16x16x32_bf16 v[64:67], v[96:99], v[160:163], v[64:67]
    ds_read_b64_tr_b16 v[90:91], v16 offset:61472
    s_add_u32 s23, s21, 0x1020000
    buffer_load_dwordx4 v[144:147], v4, s[8:11], s23 offen offset:0 sc1
    s_waitcnt lgkmcnt(6)
    v_mfma_f32_16x16x32_bf16 v[68:71], v[100:103], v[156:159], v[68:71]
    ds_read_b64_tr_b16 v[92:93], v15 offset:57600
    v_mfma_f32_16x16x32_bf16 v[72:75], v[100:103], v[160:163], v[72:75]
    ds_read_b64_tr_b16 v[94:95], v15 offset:61696
    s_waitcnt lgkmcnt(6)
    v_mfma_f32_16x16x32_bf16 v[76:79], v[104:107], v[156:159], v[76:79]
    ds_read_b64_tr_b16 v[96:97], v16 offset:57632
    v_mfma_f32_16x16x32_bf16 v[80:83], v[104:107], v[160:163], v[80:83]
    ds_read_b64_tr_b16 v[98:99], v16 offset:61728
    s_waitcnt vmcnt(12) lgkmcnt(6)
    v_mfma_f32_16x16x32_bf16 v[20:23], v[84:87], v[164:167], v[20:23]
    ds_read_b64_tr_b16 v[100:101], v15 offset:57856
    s_waitcnt vmcnt(11)
    v_mfma_f32_16x16x32_bf16 v[24:27], v[84:87], v[168:171], v[24:27]
    ds_read_b64_tr_b16 v[102:103], v15 offset:61952
    s_waitcnt lgkmcnt(6)
    v_mfma_f32_16x16x32_bf16 v[28:31], v[88:91], v[164:167], v[28:31]
    ds_read_b64_tr_b16 v[104:105], v16 offset:57888
    v_mfma_f32_16x16x32_bf16 v[32:35], v[88:91], v[168:171], v[32:35]
    ds_read_b64_tr_b16 v[106:107], v16 offset:61984
    s_add_u32 s23, s21, 0x1000000
    buffer_load_dwordx4 v[148:151], v4, s[8:11], s23 offen offset:1024 sc1
    s_waitcnt lgkmcnt(6)
    v_mfma_f32_16x16x32_bf16 v[36:39], v[92:95], v[164:167], v[36:39]
    ds_read_b64_tr_b16 v[84:85], v15 offset:58112
    v_mfma_f32_16x16x32_bf16 v[40:43], v[92:95], v[168:171], v[40:43]
    ds_read_b64_tr_b16 v[86:87], v15 offset:62208
    s_waitcnt lgkmcnt(6)
    v_mfma_f32_16x16x32_bf16 v[44:47], v[96:99], v[164:167], v[44:47]
    ds_read_b64_tr_b16 v[88:89], v16 offset:58144
    v_mfma_f32_16x16x32_bf16 v[48:51], v[96:99], v[168:171], v[48:51]
    ds_read_b64_tr_b16 v[90:91], v16 offset:62240
    s_waitcnt lgkmcnt(6)
    v_mfma_f32_16x16x32_bf16 v[52:55], v[100:103], v[164:167], v[52:55]
    v_mfma_f32_16x16x32_bf16 v[56:59], v[100:103], v[168:171], v[56:59]
    s_barrier
    ds_read_b64_tr_b16 v[92:93], v3 offset:0
    ds_read_b64_tr_b16 v[94:95], v3 offset:4096
    s_waitcnt lgkmcnt(6)
    v_mfma_f32_16x16x32_bf16 v[60:63], v[104:107], v[164:167], v[60:63]
    ds_read_b64_tr_b16 v[96:97], v2 offset:32
    v_mfma_f32_16x16x32_bf16 v[64:67], v[104:107], v[168:171], v[64:67]
    ds_read_b64_tr_b16 v[98:99], v2 offset:4128
    s_add_u32 s23, s21, 0x1020000
    buffer_load_dwordx4 v[152:155], v4, s[8:11], s23 offen offset:1024 sc1
    s_waitcnt lgkmcnt(6)
    v_mfma_f32_16x16x32_bf16 v[68:71], v[84:87], v[164:167], v[68:71]
    ds_read_b64_tr_b16 v[100:101], v3 offset:256
    v_mfma_f32_16x16x32_bf16 v[72:75], v[84:87], v[168:171], v[72:75]
    ds_read_b64_tr_b16 v[102:103], v3 offset:4352
    s_waitcnt lgkmcnt(6)
    v_mfma_f32_16x16x32_bf16 v[76:79], v[88:91], v[164:167], v[76:79]
    ds_read_b64_tr_b16 v[104:105], v2 offset:288
    v_mfma_f32_16x16x32_bf16 v[80:83], v[88:91], v[168:171], v[80:83]
    ds_read_b64_tr_b16 v[106:107], v2 offset:4384
    s_waitcnt vmcnt(12) lgkmcnt(6)
    v_mfma_f32_16x16x32_bf16 v[20:23], v[92:95], v[188:191], v[20:23]
    ds_read_b64_tr_b16 v[84:85], v3 offset:512
    s_waitcnt vmcnt(11)
    v_mfma_f32_16x16x32_bf16 v[24:27], v[92:95], v[192:195], v[24:27]
    ds_read_b64_tr_b16 v[86:87], v3 offset:4608
    s_waitcnt lgkmcnt(6)
    v_mfma_f32_16x16x32_bf16 v[28:31], v[96:99], v[188:191], v[28:31]
    ds_read_b64_tr_b16 v[88:89], v2 offset:544
    v_mfma_f32_16x16x32_bf16 v[32:35], v[96:99], v[192:195], v[32:35]
    ds_read_b64_tr_b16 v[90:91], v2 offset:4640
    s_add_u32 s23, s21, 0x1000800
    buffer_load_dwordx4 v[156:159], v4, s[8:11], s23 offen offset:0 sc1
    s_waitcnt lgkmcnt(6)
    v_mfma_f32_16x16x32_bf16 v[36:39], v[100:103], v[188:191], v[36:39]
    ds_read_b64_tr_b16 v[92:93], v3 offset:768
    v_mfma_f32_16x16x32_bf16 v[40:43], v[100:103], v[192:195], v[40:43]
    ds_read_b64_tr_b16 v[94:95], v3 offset:4864
    s_waitcnt lgkmcnt(6)
    v_mfma_f32_16x16x32_bf16 v[44:47], v[104:107], v[188:191], v[44:47]
    ds_read_b64_tr_b16 v[96:97], v2 offset:800
    v_mfma_f32_16x16x32_bf16 v[48:51], v[104:107], v[192:195], v[48:51]
    ds_read_b64_tr_b16 v[98:99], v2 offset:4896
    s_waitcnt lgkmcnt(6)
    v_mfma_f32_16x16x32_bf16 v[52:55], v[84:87], v[188:191], v[52:55]
    ds_read_b64_tr_b16 v[100:101], v3 offset:8192
    v_mfma_f32_16x16x32_bf16 v[56:59], v[84:87], v[192:195], v[56:59]
    ds_read_b64_tr_b16 v[102:103], v3 offset:12288
    s_waitcnt lgkmcnt(6)
    v_mfma_f32_16x16x32_bf16 v[60:63], v[88:91], v[188:191], v[60:63]
    ds_read_b64_tr_b16 v[104:105], v2 offset:8224
    v_mfma_f32_16x16x32_bf16 v[64:67], v[88:91], v[192:195], v[64:67]
    ds_read_b64_tr_b16 v[106:107], v2 offset:12320
    s_add_u32 s23, s21, 0x1020800
    buffer_load_dwordx4 v[160:163], v4, s[8:11], s23 offen offset:0 sc1
    s_waitcnt lgkmcnt(6)
    v_mfma_f32_16x16x32_bf16 v[68:71], v[92:95], v[188:191], v[68:71]
    ds_read_b64_tr_b16 v[84:85], v3 offset:8448
    v_mfma_f32_16x16x32_bf16 v[72:75], v[92:95], v[192:195], v[72:75]
    ds_read_b64_tr_b16 v[86:87], v3 offset:12544
    s_waitcnt lgkmcnt(6)
    v_mfma_f32_16x16x32_bf16 v[76:79], v[96:99], v[188:191], v[76:79]
    ds_read_b64_tr_b16 v[88:89], v2 offset:8480
    v_mfma_f32_16x16x32_bf16 v[80:83], v[96:99], v[192:195], v[80:83]
    ds_read_b64_tr_b16 v[90:91], v2 offset:12576
    s_waitcnt vmcnt(12) lgkmcnt(6)
    v_mfma_f32_16x16x32_bf16 v[20:23], v[100:103], v[196:199], v[20:23]
    ds_read_b64_tr_b16 v[92:93], v3 offset:8704
    s_waitcnt vmcnt(11)
    v_mfma_f32_16x16x32_bf16 v[24:27], v[100:103], v[200:203], v[24:27]
    ds_read_b64_tr_b16 v[94:95], v3 offset:12800
    s_waitcnt lgkmcnt(6)
    v_mfma_f32_16x16x32_bf16 v[28:31], v[104:107], v[196:199], v[28:31]
    ds_read_b64_tr_b16 v[96:97], v2 offset:8736
    v_mfma_f32_16x16x32_bf16 v[32:35], v[104:107], v[200:203], v[32:35]
    ds_read_b64_tr_b16 v[98:99], v2 offset:12832
    s_add_u32 s23, s21, 0x1000800
    buffer_load_dwordx4 v[164:167], v4, s[8:11], s23 offen offset:1024 sc1
    s_waitcnt lgkmcnt(6)
    v_mfma_f32_16x16x32_bf16 v[36:39], v[84:87], v[196:199], v[36:39]
    ds_read_b64_tr_b16 v[100:101], v3 offset:8960
    v_mfma_f32_16x16x32_bf16 v[40:43], v[84:87], v[200:203], v[40:43]
    ds_read_b64_tr_b16 v[102:103], v3 offset:13056
    s_waitcnt lgkmcnt(6)
    v_mfma_f32_16x16x32_bf16 v[44:47], v[88:91], v[196:199], v[44:47]
    ds_read_b64_tr_b16 v[104:105], v2 offset:8992
    v_mfma_f32_16x16x32_bf16 v[48:51], v[88:91], v[200:203], v[48:51]
    ds_read_b64_tr_b16 v[106:107], v2 offset:13088
    s_waitcnt lgkmcnt(6)
    v_mfma_f32_16x16x32_bf16 v[52:55], v[92:95], v[196:199], v[52:55]
    v_mfma_f32_16x16x32_bf16 v[56:59], v[92:95], v[200:203], v[56:59]
    s_barrier
    ds_read_b64_tr_b16 v[84:85], v3 offset:16384
    ds_read_b64_tr_b16 v[86:87], v3 offset:20480
    s_waitcnt lgkmcnt(6)
    v_mfma_f32_16x16x32_bf16 v[60:63], v[96:99], v[196:199], v[60:63]
    ds_read_b64_tr_b16 v[88:89], v2 offset:16416
    v_mfma_f32_16x16x32_bf16 v[64:67], v[96:99], v[200:203], v[64:67]
    ds_read_b64_tr_b16 v[90:91], v2 offset:20512
    s_add_u32 s23, s21, 0x1020800
    buffer_load_dwordx4 v[168:171], v4, s[8:11], s23 offen offset:1024 sc1
    s_waitcnt lgkmcnt(6)
    v_mfma_f32_16x16x32_bf16 v[68:71], v[100:103], v[196:199], v[68:71]
    ds_read_b64_tr_b16 v[92:93], v3 offset:16640
    v_mfma_f32_16x16x32_bf16 v[72:75], v[100:103], v[200:203], v[72:75]
    ds_read_b64_tr_b16 v[94:95], v3 offset:20736
    s_waitcnt lgkmcnt(6)
    v_mfma_f32_16x16x32_bf16 v[76:79], v[104:107], v[196:199], v[76:79]
    ds_read_b64_tr_b16 v[96:97], v2 offset:16672
    v_mfma_f32_16x16x32_bf16 v[80:83], v[104:107], v[200:203], v[80:83]
    ds_read_b64_tr_b16 v[98:99], v2 offset:20768
    s_waitcnt vmcnt(7)
    v_cmp_ne_u32 vcc, s14, v10
    s_cbranch_vccz fz_o2gB
    s_mov_b32 s27, 0
fz_o2pB:
    buffer_load_dword v10, v9, s[8:11], s20 offen sc1
    s_waitcnt vmcnt(0)
    v_cmp_ne_u32 vcc, s14, v10
    s_add_u32 s27, s27, 1
    s_cmp_ge_u32 s27, 65536
    s_nop 4
    s_cbranch_scc1 fz_o2gB
    s_cbranch_vccnz fz_o2pB
fz_o2gB:
    s_waitcnt lgkmcnt(6)
    v_mfma_f32_16x16x32_bf16 v[20:23], v[84:87], v[108:111], v[20:23]
    ds_read_b64_tr_b16 v[100:101], v3 offset:16896
    v_mfma_f32_16x16x32_bf16 v[24:27], v[84:87], v[112:115], v[24:27]
    ds_read_b64_tr_b16 v[102:103], v3 offset:20992
    s_waitcnt lgkmcnt(6)
    v_mfma_f32_16x16x32_bf16 v[28:31], v[88:91], v[108:111], v[28:31]
    ds_read_b64_tr_b16 v[104:105], v2 offset:16928
    v_mfma_f32_16x16x32_bf16 v[32:35], v[88:91], v[112:115], v[32:35]
    ds_read_b64_tr_b16 v[106:107], v2 offset:21024
    s_bfe_u32 s21, s42, 0x30018
    s_or_b32 s21, s21, s62
    s_lshl_b32 s21, s21, 12
    s_add_u32 s23, s21, 0x1000000
    buffer_load_dwordx4 v[188:191], v4, s[8:11], s23 offen offset:0 sc1
    s_waitcnt lgkmcnt(6)
    v_mfma_f32_16x16x32_bf16 v[36:39], v[92:95], v[108:111], v[36:39]
    ds_read_b64_tr_b16 v[84:85], v3 offset:17152
    v_mfma_f32_16x16x32_bf16 v[40:43], v[92:95], v[112:115], v[40:43]
    ds_read_b64_tr_b16 v[86:87], v3 offset:21248
    s_waitcnt lgkmcnt(6)
    v_mfma_f32_16x16x32_bf16 v[44:47], v[96:99], v[108:111], v[44:47]
    ds_read_b64_tr_b16 v[88:89], v2 offset:17184
    v_mfma_f32_16x16x32_bf16 v[48:51], v[96:99], v[112:115], v[48:51]
    ds_read_b64_tr_b16 v[90:91], v2 offset:21280
    s_waitcnt lgkmcnt(6)
    v_mfma_f32_16x16x32_bf16 v[52:55], v[100:103], v[108:111], v[52:55]
    ds_read_b64_tr_b16 v[92:93], v3 offset:24576
    v_mfma_f32_16x16x32_bf16 v[56:59], v[100:103], v[112:115], v[56:59]
    ds_read_b64_tr_b16 v[94:95], v3 offset:28672
    s_waitcnt lgkmcnt(6)
    v_mfma_f32_16x16x32_bf16 v[60:63], v[104:107], v[108:111], v[60:63]
    ds_read_b64_tr_b16 v[96:97], v2 offset:24608
    v_mfma_f32_16x16x32_bf16 v[64:67], v[104:107], v[112:115], v[64:67]
    ds_read_b64_tr_b16 v[98:99], v2 offset:28704
    s_add_u32 s23, s21, 0x1020000
    buffer_load_dwordx4 v[192:195], v4, s[8:11], s23 offen offset:0 sc1
    s_waitcnt lgkmcnt(6)
    v_mfma_f32_16x16x32_bf16 v[68:71], v[84:87], v[108:111], v[68:71]
    ds_read_b64_tr_b16 v[100:101], v3 offset:24832
    v_mfma_f32_16x16x32_bf16 v[72:75], v[84:87], v[112:115], v[72:75]
    ds_read_b64_tr_b16 v[102:103], v3 offset:28928
    s_waitcnt lgkmcnt(6)
    v_mfma_f32_16x16x32_bf16 v[76:79], v[88:91], v[108:111], v[76:79]
    ds_read_b64_tr_b16 v[104:105], v2 offset:24864
    v_mfma_f32_16x16x32_bf16 v[80:83], v[88:91], v[112:115], v[80:83]
    ds_read_b64_tr_b16 v[106:107], v2 offset:28960
    s_waitcnt lgkmcnt(6)
    v_mfma_f32_16x16x32_bf16 v[20:23], v[92:95], v[116:119], v[20:23]
    ds_read_b64_tr_b16 v[84:85], v3 offset:25088
    v_mfma_f32_16x16x32_bf16 v[24:27], v[92:95], v[120:123], v[24:27]
    ds_read_b64_tr_b16 v[86:87], v3 offset:29184
    s_waitcnt lgkmcnt(6)
    v_mfma_f32_16x16x32_bf16 v[28:31], v[96:99], v[116:119], v[28:31]
    ds_read_b64_tr_b16 v[88:89], v2 offset:25120
    v_mfma_f32_16x16x32_bf16 v[32:35], v[96:99], v[120:123], v[32:35]
    ds_read_b64_tr_b16 v[90:91], v2 offset:29216
    s_add_u32 s23, s21, 0x1000000
    buffer_load_dwordx4 v[196:199], v4, s[8:11], s23 offen offset:1024 sc1
    s_waitcnt lgkmcnt(6)
    v_mfma_f32_16x16x32_bf16 v[36:39], v[100:103], v[116:119], v[36:39]
    ds_read_b64_tr_b16 v[92:93], v3 offset:25344
    v_mfma_f32_16x16x32_bf16 v[40:43], v[100:103], v[120:123], v[40:43]
    ds_read_b64_tr_b16 v[94:95], v3 offset:29440
    s_waitcnt lgkmcnt(6)
    v_mfma_f32_16x16x32_bf16 v[44:47], v[104:107], v[116:119], v[44:47]
    ds_read_b64_tr_b16 v[96:97], v2 offset:25376
    v_mfma_f32_16x16x32_bf16 v[48:51], v[104:107], v[120:123], v[48:51]
    ds_read_b64_tr_b16 v[98:99], v2 offset:29472
    s_waitcnt lgkmcnt(6)
    v_mfma_f32_16x16x32_bf16 v[52:55], v[84:87], v[116:119], v[52:55]
    v_mfma_f32_16x16x32_bf16 v[56:59], v[84:87], v[120:123], v[56:59]
    s_barrier
    ds_read_b64_tr_b16 v[100:101], v3 offset:32768
    ds_read_b64_tr_b16 v[102:103], v3 offset:36864
    s_waitcnt lgkmcnt(6)
    v_mfma_f32_16x16x32_bf16 v[60:63], v[88:91], v[116:119], v[60:63]
    ds_read_b64_tr_b16 v[104:105], v2 offset:32800
    v_mfma_f32_16x16x32_bf16 v[64:67], v[88:91], v[120:123], v[64:67]
    ds_read_b64_tr_b16 v[106:107], v2 offset:36896
    s_add_u32 s23, s21, 0x1020000
    buffer_load_dwordx4 v[200:203], v4, s[8:11], s23 offen offset:1024 sc1
    s_waitcnt lgkmcnt(6)
    v_mfma_f32_16x16x32_bf16 v[68:71], v[92:95], v[116:119], v[68:71]
    ds_read_b64_tr_b16 v[84:85], v3 offset:33024
    v_mfma_f32_16x16x32_bf16 v[72:75], v[92:95], v[120:123], v[72:75]
    ds_read_b64_tr_b16 v[86:87], v3 offset:37120
    s_waitcnt lgkmcnt(6)
    v_mfma_f32_16x16x32_bf16 v[76:79], v[96:99], v[116:119], v[76:79]
    ds_read_b64_tr_b16 v[88:89], v2 offset:33056
    v_mfma_f32_16x16x32_bf16 v[80:83], v[96:99], v[120:123], v[80:83]
    ds_read_b64_tr_b16 v[90:91], v2 offset:37152
    s_waitcnt lgkmcnt(6)
    v_mfma_f32_16x16x32_bf16 v[20:23], v[100:103], v[140:143], v[20:23]
    ds_read_b64_tr_b16 v[92:93], v3 offset:33280
    s_waitcnt vmcnt(10)
    v_mfma_f32_16x16x32_bf16 v[24:27], v[100:103], v[144:147], v[24:27]
    ds_read_b64_tr_b16 v[94:95], v3 offset:37376
    s_waitcnt lgkmcnt(6)
    v_mfma_f32_16x16x32_bf16 v[28:31], v[104:107], v[140:143], v[28:31]
    ds_read_b64_tr_b16 v[96:97], v2 offset:33312
    v_mfma_f32_16x16x32_bf16 v[32:35], v[104:107], v[144:147], v[32:35]
    ds_read_b64_tr_b16 v[98:99], v2 offset:37408
    s_add_u32 s23, s21, 0x1000800
    buffer_load_dwordx4 v[108:111], v4, s[8:11], s23 offen offset:0 sc1
    s_waitcnt lgkmcnt(6)
    v_mfma_f32_16x16x32_bf16 v[36:39], v[84:87], v[140:143], v[36:39]
    ds_read_b64_tr_b16 v[100:101], v3 offset:33536
    v_mfma_f32_16x16x32_bf16 v[40:43], v[84:87], v[144:147], v[40:43]
    ds_read_b64_tr_b16 v[102:103], v3 offset:37632
    s_waitcnt lgkmcnt(6)
    v_mfma_f32_16x16x32_bf16 v[44:47], v[88:91], v[140:143], v[44:47]
    ds_read_b64_tr_b16 v[104:105], v2 offset:33568
    v_mfma_f32_16x16x32_bf16 v[48:51], v[88:91], v[144:147], v[48:51]
    ds_read_b64_tr_b16 v[106:107], v2 offset:37664
    s_waitcnt lgkmcnt(6)
    v_mfma_f32_16x16x32_bf16 v[52:55], v[92:95], v[140:143], v[52:55]
    ds_read_b64_tr_b16 v[84:85], v3 offset:40960
    v_mfma_f32_16x16x32_bf16 v[56:59], v[92:95], v[144:147], v[56:59]
    ds_read_b64_tr_b16 v[86:87], v3 offset:45056
    s_waitcnt lgkmcnt(6)
    v_mfma_f32_16x16x32_bf16 v[60:63], v[96:99], v[140:143], v[60:63]
    ds_read_b64_tr_b16 v[88:89], v2 offset:40992
    v_mfma_f32_16x16x32_bf16 v[64:67], v[96:99], v[144:147], v[64:67]
    ds_read_b64_tr_b16 v[90:91], v2 offset:45088
    s_add_u32 s23, s21, 0x1020800
    buffer_load_dwordx4 v[112:115], v4, s[8:11], s23 offen offset:0 sc1
    s_waitcnt lgkmcnt(6)
    v_mfma_f32_16x16x32_bf16 v[68:71], v[100:103], v[140:143], v[68:71]
    ds_read_b64_tr_b16 v[92:93], v3 offset:41216
    v_mfma_f32_16x16x32_bf16 v[72:75], v[100:103], v[144:147], v[72:75]
    ds_read_b64_tr_b16 v[94:95], v3 offset:45312
    s_waitcnt lgkmcnt(6)
    v_mfma_f32_16x16x32_bf16 v[76:79], v[104:107], v[140:143], v[76:79]
    ds_read_b64_tr_b16 v[96:97], v2 offset:41248
    v_mfma_f32_16x16x32_bf16 v[80:83], v[104:107], v[144:147], v[80:83]
    ds_read_b64_tr_b16 v[98:99], v2 offset:45344
    s_waitcnt vmcnt(11) lgkmcnt(6)
    v_mfma_f32_16x16x32_bf16 v[20:23], v[84:87], v[148:151], v[20:23]
    ds_read_b64_tr_b16 v[100:101], v3 offset:41472
    s_waitcnt vmcnt(10)
    v_mfma_f32_16x16x32_bf16 v[24:27], v[84:87], v[152:155], v[24:27]
    ds_read_b64_tr_b16 v[102:103], v3 offset:45568
    s_waitcnt lgkmcnt(6)
    v_mfma_f32_16x16x32_bf16 v[28:31], v[88:91], v[148:151], v[28:31]
    ds_read_b64_tr_b16 v[104:105], v2 offset:41504
    v_mfma_f32_16x16x32_bf16 v[32:35], v[88:91], v[152:155], v[32:35]
    ds_read_b64_tr_b16 v[106:107], v2 offset:45600
    s_add_u32 s23, s21, 0x1000800
    buffer_load_dwordx4 v[116:119], v4, s[8:11], s23 offen offset:1024 sc1
    s_waitcnt lgkmcnt(6)
    v_mfma_f32_16x16x32_bf16 v[36:39], v[92:95], v[148:151], v[36:39]
    ds_read_b64_tr_b16 v[84:85], v3 offset:41728
    v_mfma_f32_16x16x32_bf16 v[40:43], v[92:95], v[152:155], v[40:43]
    ds_read_b64_tr_b16 v[86:87], v3 offset:45824
    s_waitcnt lgkmcnt(6)
    v_mfma_f32_16x16x32_bf16 v[44:47], v[96:99], v[148:151], v[44:47]
    ds_read_b64_tr_b16 v[88:89], v2 offset:41760
    v_mfma_f32_16x16x32_bf16 v[48:51], v[96:99], v[152:155], v[48:51]
    ds_read_b64_tr_b16 v[90:91], v2 offset:45856
    s_waitcnt lgkmcnt(6)
    v_mfma_f32_16x16x32_bf16 v[52:55], v[100:103], v[148:151], v[52:55]
    v_mfma_f32_16x16x32_bf16 v[56:59], v[100:103], v[152:155], v[56:59]
    s_barrier
    ds_read_b64_tr_b16 v[92:93], v3 offset:49152
    ds_read_b64_tr_b16 v[94:95], v3 offset:53248
    s_waitcnt lgkmcnt(6)
    v_mfma_f32_16x16x32_bf16 v[60:63], v[104:107], v[148:151], v[60:63]
    ds_read_b64_tr_b16 v[96:97], v2 offset:49184
    v_mfma_f32_16x16x32_bf16 v[64:67], v[104:107], v[152:155], v[64:67]
    ds_read_b64_tr_b16 v[98:99], v2 offset:53280
    s_add_u32 s23, s21, 0x1020800
    buffer_load_dwordx4 v[120:123], v4, s[8:11], s23 offen offset:1024 sc1
    s_waitcnt lgkmcnt(6)
    v_mfma_f32_16x16x32_bf16 v[68:71], v[84:87], v[148:151], v[68:71]
    ds_read_b64_tr_b16 v[100:101], v3 offset:49408
    v_mfma_f32_16x16x32_bf16 v[72:75], v[84:87], v[152:155], v[72:75]
    ds_read_b64_tr_b16 v[102:103], v3 offset:53504
    s_waitcnt lgkmcnt(6)
    v_mfma_f32_16x16x32_bf16 v[76:79], v[88:91], v[148:151], v[76:79]
    ds_read_b64_tr_b16 v[104:105], v2 offset:49440
    v_mfma_f32_16x16x32_bf16 v[80:83], v[88:91], v[152:155], v[80:83]
    ds_read_b64_tr_b16 v[106:107], v2 offset:53536
    s_waitcnt vmcnt(11) lgkmcnt(6)
    v_mfma_f32_16x16x32_bf16 v[20:23], v[92:95], v[156:159], v[20:23]
    ds_read_b64_tr_b16 v[84:85], v3 offset:49664
    s_waitcnt vmcnt(10)
    v_mfma_f32_16x16x32_bf16 v[24:27], v[92:95], v[160:163], v[24:27]
    ds_read_b64_tr_b16 v[86:87], v3 offset:53760
    s_waitcnt lgkmcnt(6)
    v_mfma_f32_16x16x32_bf16 v[28:31], v[96:99], v[156:159], v[28:31]
    ds_read_b64_tr_b16 v[88:89], v2 offset:49696
    v_mfma_f32_16x16x32_bf16 v[32:35], v[96:99], v[160:163], v[32:35]
    ds_read_b64_tr_b16 v[90:91], v2 offset:53792
    s_bfe_u32 s21, s42, 0x3001c
    s_or_b32 s21, s21, s62
    s_lshl_b32 s21, s21, 12
    s_add_u32 s23, s21, 0x1000000
    buffer_load_dwordx4 v[140:143], v4, s[8:11], s23 offen offset:0 sc1
    s_waitcnt lgkmcnt(6)
    v_mfma_f32_16x16x32_bf16 v[36:39], v[100:103], v[156:159], v[36:39]
    ds_read_b64_tr_b16 v[92:93], v3 offset:49920
    v_mfma_f32_16x16x32_bf16 v[40:43], v[100:103], v[160:163], v[40:43]
    ds_read_b64_tr_b16 v[94:95], v3 offset:54016
    s_waitcnt lgkmcnt(6)
    v_mfma_f32_16x16x32_bf16 v[44:47], v[104:107], v[156:159], v[44:47]
    ds_read_b64_tr_b16 v[96:97], v2 offset:49952
    v_mfma_f32_16x16x32_bf16 v[48:51], v[104:107], v[160:163], v[48:51]
    ds_read_b64_tr_b16 v[98:99], v2 offset:54048
    s_waitcnt lgkmcnt(6)
    v_mfma_f32_16x16x32_bf16 v[52:55], v[84:87], v[156:159], v[52:55]
    ds_read_b64_tr_b16 v[100:101], v3 offset:57344
    v_mfma_f32_16x16x32_bf16 v[56:59], v[84:87], v[160:163], v[56:59]
    ds_read_b64_tr_b16 v[102:103], v3 offset:61440
    s_waitcnt lgkmcnt(6)
    v_mfma_f32_16x16x32_bf16 v[60:63], v[88:91], v[156:159], v[60:63]
    ds_read_b64_tr_b16 v[104:105], v2 offset:57376
    v_mfma_f32_16x16x32_bf16 v[64:67], v[88:91], v[160:163], v[64:67]
    ds_read_b64_tr_b16 v[106:107], v2 offset:61472
    s_add_u32 s23, s21, 0x1020000
    buffer_load_dwordx4 v[144:147], v4, s[8:11], s23 offen offset:0 sc1
    s_waitcnt lgkmcnt(6)
    v_mfma_f32_16x16x32_bf16 v[68:71], v[92:95], v[156:159], v[68:71]
    ds_read_b64_tr_b16 v[84:85], v3 offset:57600
    v_mfma_f32_16x16x32_bf16 v[72:75], v[92:95], v[160:163], v[72:75]
    ds_read_b64_tr_b16 v[86:87], v3 offset:61696
    s_waitcnt lgkmcnt(6)
    v_mfma_f32_16x16x32_bf16 v[76:79], v[96:99], v[156:159], v[76:79]
    ds_read_b64_tr_b16 v[88:89], v2 offset:57632
    v_mfma_f32_16x16x32_bf16 v[80:83], v[96:99], v[160:163], v[80:83]
    ds_read_b64_tr_b16 v[90:91], v2 offset:61728
    s_waitcnt vmcnt(11) lgkmcnt(6)
    v_mfma_f32_16x16x32_bf16 v[20:23], v[100:103], v[164:167], v[20:23]
    ds_read_b64_tr_b16 v[92:93], v3 offset:57856
    s_waitcnt vmcnt(10)
    v_mfma_f32_16x16x32_bf16 v[24:27], v[100:103], v[168:171], v[24:27]
    ds_read_b64_tr_b16 v[94:95], v3 offset:61952
    s_waitcnt lgkmcnt(6)
    v_mfma_f32_16x16x32_bf16 v[28:31], v[104:107], v[164:167], v[28:31]
    ds_read_b64_tr_b16 v[96:97], v2 offset:57888
    v_mfma_f32_16x16x32_bf16 v[32:35], v[104:107], v[168:171], v[32:35]
    ds_read_b64_tr_b16 v[98:99], v2 offset:61984
    s_add_u32 s23, s21, 0x1000000
    buffer_load_dwordx4 v[148:151], v4, s[8:11], s23 offen offset:1024 sc1
    s_waitcnt lgkmcnt(6)
    v_mfma_f32_16x16x32_bf16 v[36:39], v[84:87], v[164:167], v[36:39]
    ds_read_b64_tr_b16 v[100:101], v3 offset:58112
    v_mfma_f32_16x16x32_bf16 v[40:43], v[84:87], v[168:171], v[40:43]
    ds_read_b64_tr_b16 v[102:103], v3 offset:62208
    s_waitcnt lgkmcnt(6)
    v_mfma_f32_16x16x32_bf16 v[44:47], v[88:91], v[164:167], v[44:47]
    ds_read_b64_tr_b16 v[104:105], v2 offset:58144
    v_mfma_f32_16x16x32_bf16 v[48:51], v[88:91], v[168:171], v[48:51]
    ds_read_b64_tr_b16 v[106:107], v2 offset:62240
    s_waitcnt lgkmcnt(6)
    v_mfma_f32_16x16x32_bf16 v[52:55], v[92:95], v[164:167], v[52:55]
    v_mfma_f32_16x16x32_bf16 v[56:59], v[92:95], v[168:171], v[56:59]
    s_barrier
    ds_read_b64_tr_b16 v[84:85], v15 offset:0
    ds_read_b64_tr_b16 v[86:87], v15 offset:4096
    s_waitcnt lgkmcnt(6)
    v_mfma_f32_16x16x32_bf16 v[60:63], v[96:99], v[164:167], v[60:63]
    ds_read_b64_tr_b16 v[88:89], v16 offset:32
    v_mfma_f32_16x16x32_bf16 v[64:67], v[96:99], v[168:171], v[64:67]
    ds_read_b64_tr_b16 v[90:91], v16 offset:4128
    s_add_u32 s23, s21, 0x1020000
    buffer_load_dwordx4 v[152:155], v4, s[8:11], s23 offen offset:1024 sc1
    s_waitcnt lgkmcnt(6)
    v_mfma_f32_16x16x32_bf16 v[68:71], v[100:103], v[164:167], v[68:71]
    ds_read_b64_tr_b16 v[92:93], v15 offset:256
    v_mfma_f32_16x16x32_bf16 v[72:75], v[100:103], v[168:171], v[72:75]
    ds_read_b64_tr_b16 v[94:95], v15 offset:4352
    s_waitcnt lgkmcnt(6)
    v_mfma_f32_16x16x32_bf16 v[76:79], v[104:107], v[164:167], v[76:79]
    ds_read_b64_tr_b16 v[96:97], v16 offset:288
    v_mfma_f32_16x16x32_bf16 v[80:83], v[104:107], v[168:171], v[80:83]
    ds_read_b64_tr_b16 v[98:99], v16 offset:4384
    s_waitcnt vmcnt(11) lgkmcnt(6)
    v_mfma_f32_16x16x32_bf16 v[20:23], v[84:87], v[188:191], v[20:23]
    ds_read_b64_tr_b16 v[100:101], v15 offset:512
    s_waitcnt vmcnt(10)
    v_mfma_f32_16x16x32_bf16 v[24:27], v[84:87], v[192:195], v[24:27]
    ds_read_b64_tr_b16 v[102:103], v15 offset:4608
    s_waitcnt lgkmcnt(6)
    v_mfma_f32_16x16x32_bf16 v[28:31], v[88:91], v[188:191], v[28:31]
    ds_read_b64_tr_b16 v[104:105], v16 offset:544
    v_mfma_f32_16x16x32_bf16 v[32:35], v[88:91], v[192:195], v[32:35]
    ds_read_b64_tr_b16 v[106:107], v16 offset:4640
    s_add_u32 s23, s21, 0x1000800
    buffer_load_dwordx4 v[156:159], v4, s[8:11], s23 offen offset:0 sc1
    s_waitcnt lgkmcnt(6)
    v_mfma_f32_16x16x32_bf16 v[36:39], v[92:95], v[188:191], v[36:39]
    ds_read_b64_tr_b16 v[84:85], v15 offset:768
    v_mfma_f32_16x16x32_bf16 v[40:43], v[92:95], v[192:195], v[40:43]
    ds_read_b64_tr_b16 v[86:87], v15 offset:4864
    s_waitcnt lgkmcnt(6)
    v_mfma_f32_16x16x32_bf16 v[44:47], v[96:99], v[188:191], v[44:47]
    ds_read_b64_tr_b16 v[88:89], v16 offset:800
    v_mfma_f32_16x16x32_bf16 v[48:51], v[96:99], v[192:195], v[48:51]
    ds_read_b64_tr_b16 v[90:91], v16 offset:4896
    s_waitcnt lgkmcnt(6)
    v_mfma_f32_16x16x32_bf16 v[52:55], v[100:103], v[188:191], v[52:55]
    ds_read_b64_tr_b16 v[92:93], v15 offset:8192
    v_mfma_f32_16x16x32_bf16 v[56:59], v[100:103], v[192:195], v[56:59]
    ds_read_b64_tr_b16 v[94:95], v15 offset:12288
    s_waitcnt lgkmcnt(6)
    v_mfma_f32_16x16x32_bf16 v[60:63], v[104:107], v[188:191], v[60:63]
    ds_read_b64_tr_b16 v[96:97], v16 offset:8224
    v_mfma_f32_16x16x32_bf16 v[64:67], v[104:107], v[192:195], v[64:67]
    ds_read_b64_tr_b16 v[98:99], v16 offset:12320
    s_add_u32 s23, s21, 0x1020800
    buffer_load_dwordx4 v[160:163], v4, s[8:11], s23 offen offset:0 sc1
    s_waitcnt lgkmcnt(6)
    v_mfma_f32_16x16x32_bf16 v[68:71], v[84:87], v[188:191], v[68:71]
    ds_read_b64_tr_b16 v[100:101], v15 offset:8448
    v_mfma_f32_16x16x32_bf16 v[72:75], v[84:87], v[192:195], v[72:75]
    ds_read_b64_tr_b16 v[102:103], v15 offset:12544
    s_waitcnt lgkmcnt(6)
    v_mfma_f32_16x16x32_bf16 v[76:79], v[88:91], v[188:191], v[76:79]
    ds_read_b64_tr_b16 v[104:105], v16 offset:8480
    v_mfma_f32_16x16x32_bf16 v[80:83], v[88:91], v[192:195], v[80:83]
    ds_read_b64_tr_b16 v[106:107], v16 offset:12576
    s_waitcnt vmcnt(11) lgkmcnt(6)
    v_mfma_f32_16x16x32_bf16 v[20:23], v[92:95], v[196:199], v[20:23]
    ds_read_b64_tr_b16 v[84:85], v15 offset:8704
    s_waitcnt vmcnt(10)
    v_mfma_f32_16x16x32_bf16 v[24:27], v[92:95], v[200:203], v[24:27]
    ds_read_b64_tr_b16 v[86:87], v15 offset:12800
    s_waitcnt lgkmcnt(6)
    v_mfma_f32_16x16x32_bf16 v[28:31], v[96:99], v[196:199], v[28:31]
    ds_read_b64_tr_b16 v[88:89], v16 offset:8736
    v_mfma_f32_16x16x32_bf16 v[32:35], v[96:99], v[200:203], v[32:35]
    ds_read_b64_tr_b16 v[90:91], v16 offset:12832
    s_add_u32 s23, s21, 0x1000800
    buffer_load_dwordx4 v[164:167], v4, s[8:11], s23 offen offset:1024 sc1
    s_waitcnt lgkmcnt(6)
    v_mfma_f32_16x16x32_bf16 v[36:39], v[100:103], v[196:199], v[36:39]
    ds_read_b64_tr_b16 v[92:93], v15 offset:8960
    v_mfma_f32_16x16x32_bf16 v[40:43], v[100:103], v[200:203], v[40:43]
    ds_read_b64_tr_b16 v[94:95], v15 offset:13056
    s_waitcnt lgkmcnt(6)
    v_mfma_f32_16x16x32_bf16 v[44:47], v[104:107], v[196:199], v[44:47]
    ds_read_b64_tr_b16 v[96:97], v16 offset:8992
    v_mfma_f32_16x16x32_bf16 v[48:51], v[104:107], v[200:203], v[48:51]
    ds_read_b64_tr_b16 v[98:99], v16 offset:13088
    s_waitcnt lgkmcnt(6)
    v_mfma_f32_16x16x32_bf16 v[52:55], v[84:87], v[196:199], v[52:55]
    ds_read_b64_tr_b16 v[100:101], v15 offset:16384
    v_mfma_f32_16x16x32_bf16 v[56:59], v[84:87], v[200:203], v[56:59]
    ds_read_b64_tr_b16 v[102:103], v15 offset:20480
    s_waitcnt lgkmcnt(6)
    v_mfma_f32_16x16x32_bf16 v[60:63], v[88:91], v[196:199], v[60:63]
    ds_read_b64_tr_b16 v[104:105], v16 offset:16416
    v_mfma_f32_16x16x32_bf16 v[64:67], v[88:91], v[200:203], v[64:67]
    ds_read_b64_tr_b16 v[106:107], v16 offset:20512
    s_add_u32 s23, s21, 0x1020800
    buffer_load_dwordx4 v[168:171], v4, s[8:11], s23 offen offset:1024 sc1
    s_waitcnt lgkmcnt(6)
    v_mfma_f32_16x16x32_bf16 v[68:71], v[92:95], v[196:199], v[68:71]
    ds_read_b64_tr_b16 v[84:85], v15 offset:24576
    v_mfma_f32_16x16x32_bf16 v[72:75], v[92:95], v[200:203], v[72:75]
    ds_read_b64_tr_b16 v[86:87], v15 offset:28672
    s_waitcnt lgkmcnt(6)
    v_mfma_f32_16x16x32_bf16 v[76:79], v[96:99], v[196:199], v[76:79]
    ds_read_b64_tr_b16 v[88:89], v16 offset:24608
    v_mfma_f32_16x16x32_bf16 v[80:83], v[96:99], v[200:203], v[80:83]
    ds_read_b64_tr_b16 v[90:91], v16 offset:28704
    s_waitcnt vmcnt(11) lgkmcnt(6)
    v_mfma_f32_16x16x32_bf16 v[20:23], v[100:103], v[108:111], v[20:23]
    ds_read_b64_tr_b16 v[92:93], v15 offset:32768
    s_waitcnt vmcnt(10)
    v_mfma_f32_16x16x32_bf16 v[24:27], v[100:103], v[112:115], v[24:27]
    ds_read_b64_tr_b16 v[94:95], v15 offset:36864
    s_waitcnt lgkmcnt(6)
    v_mfma_f32_16x16x32_bf16 v[28:31], v[104:107], v[108:111], v[28:31]
    ds_read_b64_tr_b16 v[96:97], v16 offset:32800
    v_mfma_f32_16x16x32_bf16 v[32:35], v[104:107], v[112:115], v[32:35]
    ds_read_b64_tr_b16 v[98:99], v16 offset:36896
    s_waitcnt vmcnt(9) lgkmcnt(6)
    v_mfma_f32_16x16x32_bf16 v[20:23], v[84:87], v[116:119], v[20:23]
    ds_read_b64_tr_b16 v[100:101], v15 offset:40960
    s_waitcnt vmcnt(8)
    v_mfma_f32_16x16x32_bf16 v[24:27], v[84:87], v[120:123], v[24:27]
    ds_read_b64_tr_b16 v[102:103], v15 offset:45056
    s_waitcnt lgkmcnt(6)
    v_mfma_f32_16x16x32_bf16 v[28:31], v[88:91], v[116:119], v[28:31]
    ds_read_b64_tr_b16 v[104:105], v16 offset:40992
    v_mfma_f32_16x16x32_bf16 v[32:35], v[88:91], v[120:123], v[32:35]
    ds_read_b64_tr_b16 v[106:107], v16 offset:45088
    s_waitcnt vmcnt(7) lgkmcnt(6)
    v_mfma_f32_16x16x32_bf16 v[20:23], v[92:95], v[140:143], v[20:23]
    ds_read_b64_tr_b16 v[84:85], v15 offset:49152
    s_waitcnt vmcnt(6)
    v_mfma_f32_16x16x32_bf16 v[24:27], v[92:95], v[144:147], v[24:27]
    ds_read_b64_tr_b16 v[86:87], v15 offset:53248
    s_waitcnt lgkmcnt(6)
    v_mfma_f32_16x16x32_bf16 v[28:31], v[96:99], v[140:143], v[28:31]
    ds_read_b64_tr_b16 v[88:89], v16 offset:49184
    v_mfma_f32_16x16x32_bf16 v[32:35], v[96:99], v[144:147], v[32:35]
    ds_read_b64_tr_b16 v[90:91], v16 offset:53280
    s_waitcnt vmcnt(5) lgkmcnt(6)
    v_mfma_f32_16x16x32_bf16 v[20:23], v[100:103], v[148:151], v[20:23]
    ds_read_b64_tr_b16 v[92:93], v15 offset:57344
    s_waitcnt vmcnt(4)
    v_mfma_f32_16x16x32_bf16 v[24:27], v[100:103], v[152:155], v[24:27]
    ds_read_b64_tr_b16 v[94:95], v15 offset:61440
    s_waitcnt lgkmcnt(6)
    v_mfma_f32_16x16x32_bf16 v[28:31], v[104:107], v[148:151], v[28:31]
    ds_read_b64_tr_b16 v[96:97], v16 offset:57376
    v_mfma_f32_16x16x32_bf16 v[32:35], v[104:107], v[152:155], v[32:35]
    ds_read_b64_tr_b16 v[98:99], v16 offset:61472
    s_waitcnt vmcnt(3) lgkmcnt(6)
    v_mfma_f32_16x16x32_bf16 v[20:23], v[84:87], v[156:159], v[20:23]
    ds_read_b64_tr_b16 v[100:101], v15 offset:16640
    s_waitcnt vmcnt(2)
    v_mfma_f32_16x16x32_bf16 v[24:27], v[84:87], v[160:163], v[24:27]
    ds_read_b64_tr_b16 v[102:103], v15 offset:20736
    s_waitcnt lgkmcnt(6)
    v_mfma_f32_16x16x32_bf16 v[28:31], v[88:91], v[156:159], v[28:31]
    ds_read_b64_tr_b16 v[104:105], v16 offset:16672
    v_mfma_f32_16x16x32_bf16 v[32:35], v[88:91], v[160:163], v[32:35]
    ds_read_b64_tr_b16 v[106:107], v16 offset:20768
    s_waitcnt vmcnt(1) lgkmcnt(6)
    v_mfma_f32_16x16x32_bf16 v[20:23], v[92:95], v[164:167], v[20:23]
    ds_read_b64_tr_b16 v[84:85], v15 offset:24832
    s_waitcnt vmcnt(0)
    v_mfma_f32_16x16x32_bf16 v[24:27], v[92:95], v[168:171], v[24:27]
    ds_read_b64_tr_b16 v[86:87], v15 offset:28928
    s_waitcnt lgkmcnt(6)
    v_mfma_f32_16x16x32_bf16 v[28:31], v[96:99], v[164:167], v[28:31]
    ds_read_b64_tr_b16 v[88:89], v16 offset:24864
    v_mfma_f32_16x16x32_bf16 v[32:35], v[96:99], v[168:171], v[32:35]
    ds_read_b64_tr_b16 v[90:91], v16 offset:28960
    ds_read_b128 v[124:127], v13 offset:0
    ds_read_b128 v[128:131], v13 offset:64
    s_waitcnt lgkmcnt(8)
    v_mfma_f32_16x16x32_bf16 v[36:39], v[100:103], v[108:111], v[36:39]
    ds_read_b64_tr_b16 v[92:93], v15 offset:33024
    v_mfma_f32_16x16x32_bf16 v[40:43], v[100:103], v[112:115], v[40:43]
    ds_read_b64_tr_b16 v[94:95], v15 offset:37120
    s_waitcnt lgkmcnt(8)
    v_mfma_f32_16x16x32_bf16 v[44:47], v[104:107], v[108:111], v[44:47]
    ds_read_b64_tr_b16 v[96:97], v16 offset:33056
    v_mfma_f32_16x16x32_bf16 v[48:51], v[104:107], v[112:115], v[48:51]
    ds_read_b64_tr_b16 v[98:99], v16 offset:37152
    s_waitcnt lgkmcnt(8)
    v_mfma_f32_16x16x32_bf16 v[36:39], v[84:87], v[116:119], v[36:39]
    s_waitcnt lgkmcnt(5)
    v_pk_mul_f32 v[132:133], v[20:21], v[124:125]
    v_pk_mul_f32 v[134:135], v[22:23], v[126:127]
    ds_read_b64_tr_b16 v[100:101], v15 offset:41216
    v_mfma_f32_16x16x32_bf16 v[40:43], v[84:87], v[120:123], v[40:43]
    s_waitcnt lgkmcnt(5)
    v_pk_mul_f32 v[136:137], v[28:29], v[128:129]
    ds_read_b64_tr_b16 v[102:103], v15 offset:45312
    v_mfma_f32_16x16x32_bf16 v[44:47], v[88:91], v[116:119], v[44:47]
    v_pk_mul_f32 v[138:139], v[30:31], v[130:131]
    v_cvt_pk_bf16_f32 v132, v132, v133
    ds_read_b64_tr_b16 v[104:105], v16 offset:41248
    v_mfma_f32_16x16x32_bf16 v[48:51], v[88:91], v[120:123], v[48:51]
    v_cvt_pk_bf16_f32 v133, v134, v135
    ds_read_b64_tr_b16 v[106:107], v16 offset:45344
    s_waitcnt lgkmcnt(6)
    v_mfma_f32_16x16x32_bf16 v[36:39], v[92:95], v[140:143], v[36:39]
    v_cvt_pk_bf16_f32 v134, v136, v137
    v_cvt_pk_bf16_f32 v135, v138, v139
    ds_read_b64_tr_b16 v[84:85], v15 offset:49408
    v_mfma_f32_16x16x32_bf16 v[40:43], v[92:95], v[144:147], v[40:43]
    v_permlane32_swap_b32 v132, v134
    ds_read_b64_tr_b16 v[86:87], v15 offset:53504
    s_waitcnt lgkmcnt(6)
    v_mfma_f32_16x16x32_bf16 v[44:47], v[96:99], v[140:143], v[44:47]
    v_permlane32_swap_b32 v133, v135
    v_permlane16_swap_b32 v132, v134
    ds_read_b64_tr_b16 v[88:89], v16 offset:49440
    v_mfma_f32_16x16x32_bf16 v[48:51], v[96:99], v[144:147], v[48:51]
    v_permlane16_swap_b32 v133, v135
    ds_read_b64_tr_b16 v[90:91], v16 offset:53536
    s_waitcnt lgkmcnt(6)
    v_mfma_f32_16x16x32_bf16 v[36:39], v[100:103], v[148:151], v[36:39]
    buffer_store_dwordx4 v[132:135], v14, s[8:11], s18 offen offset:0 sc1
    ds_read_b64_tr_b16 v[92:93], v15 offset:57600
    v_mfma_f32_16x16x32_bf16 v[40:43], v[100:103], v[152:155], v[40:43]
    v_pk_mul_f32 v[132:133], v[24:25], v[124:125]
    v_pk_mul_f32 v[134:135], v[26:27], v[126:127]
    ds_read_b64_tr_b16 v[94:95], v15 offset:61696
    s_waitcnt lgkmcnt(6)
    v_mfma_f32_16x16x32_bf16 v[44:47], v[104:107], v[148:151], v[44:47]
    v_pk_mul_f32 v[136:137], v[32:33], v[128:129]
    ds_read_b64_tr_b16 v[96:97], v16 offset:57632
    v_mfma_f32_16x16x32_bf16 v[48:51], v[104:107], v[152:155], v[48:51]
    v_pk_mul_f32 v[138:139], v[34:35], v[130:131]
    v_cvt_pk_bf16_f32 v132, v132, v133
    ds_read_b64_tr_b16 v[98:99], v16 offset:61728
    s_waitcnt lgkmcnt(6)
    v_mfma_f32_16x16x32_bf16 v[36:39], v[84:87], v[156:159], v[36:39]
    v_cvt_pk_bf16_f32 v133, v134, v135
    ds_read_b64_tr_b16 v[100:101], v15 offset:16896
    v_mfma_f32_16x16x32_bf16 v[40:43], v[84:87], v[160:163], v[40:43]
    v_cvt_pk_bf16_f32 v134, v136, v137
    v_cvt_pk_bf16_f32 v135, v138, v139
    ds_read_b64_tr_b16 v[102:103], v15 offset:20992
    s_waitcnt lgkmcnt(6)
    v_mfma_f32_16x16x32_bf16 v[44:47], v[88:91], v[156:159], v[44:47]
    v_permlane32_swap_b32 v132, v134
    ds_read_b64_tr_b16 v[104:105], v16 offset:16928
    v_mfma_f32_16x16x32_bf16 v[48:51], v[88:91], v[160:163], v[48:51]
    v_permlane32_swap_b32 v133, v135
    v_permlane16_swap_b32 v132, v134
    ds_read_b64_tr_b16 v[106:107], v16 offset:21024
    s_waitcnt lgkmcnt(6)
    v_mfma_f32_16x16x32_bf16 v[36:39], v[92:95], v[164:167], v[36:39]
    v_permlane16_swap_b32 v133, v135
    ds_read_b64_tr_b16 v[84:85], v15 offset:25088
    v_mfma_f32_16x16x32_bf16 v[40:43], v[92:95], v[168:171], v[40:43]
    buffer_store_dwordx4 v[132:135], v14, s[8:11], s19 offen offset:0 sc1
    ds_read_b64_tr_b16 v[86:87], v15 offset:29184
    s_waitcnt lgkmcnt(6)
    v_mfma_f32_16x16x32_bf16 v[44:47], v[96:99], v[164:167], v[44:47]
    ds_read_b64_tr_b16 v[88:89], v16 offset:25120
    v_mfma_f32_16x16x32_bf16 v[48:51], v[96:99], v[168:171], v[48:51]
    ds_read_b64_tr_b16 v[90:91], v16 offset:29216
    ds_read_b128 v[124:127], v13 offset:128
    ds_read_b128 v[128:131], v13 offset:192
    s_waitcnt lgkmcnt(8)
    v_mfma_f32_16x16x32_bf16 v[52:55], v[100:103], v[108:111], v[52:55]
    ds_read_b64_tr_b16 v[92:93], v15 offset:33280
    v_mfma_f32_16x16x32_bf16 v[56:59], v[100:103], v[112:115], v[56:59]
    ds_read_b64_tr_b16 v[94:95], v15 offset:37376
    s_waitcnt lgkmcnt(8)
    v_mfma_f32_16x16x32_bf16 v[60:63], v[104:107], v[108:111], v[60:63]
    ds_read_b64_tr_b16 v[96:97], v16 offset:33312
    v_mfma_f32_16x16x32_bf16 v[64:67], v[104:107], v[112:115], v[64:67]
    ds_read_b64_tr_b16 v[98:99], v16 offset:37408
    s_waitcnt lgkmcnt(8)
    v_mfma_f32_16x16x32_bf16 v[52:55], v[84:87], v[116:119], v[52:55]
    s_waitcnt lgkmcnt(5)
    v_pk_mul_f32 v[132:133], v[36:37], v[124:125]
    v_pk_mul_f32 v[134:135], v[38:39], v[126:127]
    ds_read_b64_tr_b16 v[100:101], v15 offset:41472
    v_mfma_f32_16x16x32_bf16 v[56:59], v[84:87], v[120:123], v[56:59]
    s_waitcnt lgkmcnt(5)
    v_pk_mul_f32 v[136:137], v[44:45], v[128:129]
    ds_read_b64_tr_b16 v[102:103], v15 offset:45568
    v_mfma_f32_16x16x32_bf16 v[60:63], v[88:91], v[116:119], v[60:63]
    v_pk_mul_f32 v[138:139], v[46:47], v[130:131]
    v_cvt_pk_bf16_f32 v132, v132, v133
    ds_read_b64_tr_b16 v[104:105], v16 offset:41504
    v_mfma_f32_16x16x32_bf16 v[64:67], v[88:91], v[120:123], v[64:67]
    v_cvt_pk_bf16_f32 v133, v134, v135
    ds_read_b64_tr_b16 v[106:107], v16 offset:45600
    s_waitcnt lgkmcnt(6)
    v_mfma_f32_16x16x32_bf16 v[52:55], v[92:95], v[140:143], v[52:55]
    v_cvt_pk_bf16_f32 v134, v136, v137
    v_cvt_pk_bf16_f32 v135, v138, v139
    ds_read_b64_tr_b16 v[84:85], v15 offset:49664
    v_mfma_f32_16x16x32_bf16 v[56:59], v[92:95], v[144:147], v[56:59]
    v_permlane32_swap_b32 v132, v134
    ds_read_b64_tr_b16 v[86:87], v15 offset:53760
    s_waitcnt lgkmcnt(6)
    v_mfma_f32_16x16x32_bf16 v[60:63], v[96:99], v[140:143], v[60:63]
    v_permlane32_swap_b32 v133, v135
    v_permlane16_swap_b32 v132, v134
    ds_read_b64_tr_b16 v[88:89], v16 offset:49696
    v_mfma_f32_16x16x32_bf16 v[64:67], v[96:99], v[144:147], v[64:67]
    v_permlane16_swap_b32 v133, v135
    ds_read_b64_tr_b16 v[90:91], v16 offset:53792
    s_waitcnt lgkmcnt(6)
    v_mfma_f32_16x16x32_bf16 v[52:55], v[100:103], v[148:151], v[52:55]
    buffer_store_dwordx4 v[132:135], v14, s[8:11], s18 offen offset:1024 sc1
    ds_read_b64_tr_b16 v[92:93], v15 offset:57856
    v_mfma_f32_16x16x32_bf16 v[56:59], v[100:103], v[152:155], v[56:59]
    v_pk_mul_f32 v[132:133], v[40:41], v[124:125]
    v_pk_mul_f32 v[134:135], v[42:43], v[126:127]
    ds_read_b64_tr_b16 v[94:95], v15 offset:61952
    s_waitcnt lgkmcnt(6)
    v_mfma_f32_16x16x32_bf16 v[60:63], v[104:107], v[148:151], v[60:63]
    v_pk_mul_f32 v[136:137], v[48:49], v[128:129]
    ds_read_b64_tr_b16 v[96:97], v16 offset:57888
    v_mfma_f32_16x16x32_bf16 v[64:67], v[104:107], v[152:155], v[64:67]
    v_pk_mul_f32 v[138:139], v[50:51], v[130:131]
    v_cvt_pk_bf16_f32 v132, v132, v133
    ds_read_b64_tr_b16 v[98:99], v16 offset:61984
    s_waitcnt lgkmcnt(6)
    v_mfma_f32_16x16x32_bf16 v[52:55], v[84:87], v[156:159], v[52:55]
    v_cvt_pk_bf16_f32 v133, v134, v135
    ds_read_b64_tr_b16 v[100:101], v15 offset:17152
    v_mfma_f32_16x16x32_bf16 v[56:59], v[84:87], v[160:163], v[56:59]
    v_cvt_pk_bf16_f32 v134, v136, v137
    v_cvt_pk_bf16_f32 v135, v138, v139
    ds_read_b64_tr_b16 v[102:103], v15 offset:21248
    s_waitcnt lgkmcnt(6)
    v_mfma_f32_16x16x32_bf16 v[60:63], v[88:91], v[156:159], v[60:63]
    v_permlane32_swap_b32 v132, v134
    ds_read_b64_tr_b16 v[104:105], v16 offset:17184
    v_mfma_f32_16x16x32_bf16 v[64:67], v[88:91], v[160:163], v[64:67]
    v_permlane32_swap_b32 v133, v135
    v_permlane16_swap_b32 v132, v134
    ds_read_b64_tr_b16 v[106:107], v16 offset:21280
    s_waitcnt lgkmcnt(6)
    v_mfma_f32_16x16x32_bf16 v[52:55], v[92:95], v[164:167], v[52:55]
    v_permlane16_swap_b32 v133, v135
    ds_read_b64_tr_b16 v[84:85], v15 offset:25344
    v_mfma_f32_16x16x32_bf16 v[56:59], v[92:95], v[168:171], v[56:59]
    buffer_store_dwordx4 v[132:135], v14, s[8:11], s19 offen offset:1024 sc1
    ds_read_b64_tr_b16 v[86:87], v15 offset:29440
    s_waitcnt lgkmcnt(6)
    v_mfma_f32_16x16x32_bf16 v[60:63], v[96:99], v[164:167], v[60:63]
    ds_read_b64_tr_b16 v[88:89], v16 offset:25376
    v_mfma_f32_16x16x32_bf16 v[64:67], v[96:99], v[168:171], v[64:67]
    ds_read_b64_tr_b16 v[90:91], v16 offset:29472
    ds_read_b128 v[124:127], v13 offset:256
    ds_read_b128 v[128:131], v13 offset:320
    s_waitcnt lgkmcnt(8)
    v_mfma_f32_16x16x32_bf16 v[68:71], v[100:103], v[108:111], v[68:71]
    ds_read_b64_tr_b16 v[92:93], v15 offset:33536
    v_mfma_f32_16x16x32_bf16 v[72:75], v[100:103], v[112:115], v[72:75]
    ds_read_b64_tr_b16 v[94:95], v15 offset:37632
    s_waitcnt lgkmcnt(8)
    v_mfma_f32_16x16x32_bf16 v[76:79], v[104:107], v[108:111], v[76:79]
    ds_read_b64_tr_b16 v[96:97], v16 offset:33568
    v_mfma_f32_16x16x32_bf16 v[80:83], v[104:107], v[112:115], v[80:83]
    ds_read_b64_tr_b16 v[98:99], v16 offset:37664
    s_waitcnt lgkmcnt(8)
    v_mfma_f32_16x16x32_bf16 v[68:71], v[84:87], v[116:119], v[68:71]
    s_waitcnt lgkmcnt(5)
    v_pk_mul_f32 v[132:133], v[52:53], v[124:125]
    v_pk_mul_f32 v[134:135], v[54:55], v[126:127]
    ds_read_b64_tr_b16 v[100:101], v15 offset:41728
    v_mfma_f32_16x16x32_bf16 v[72:75], v[84:87], v[120:123], v[72:75]
    s_waitcnt lgkmcnt(5)
    v_pk_mul_f32 v[136:137], v[60:61], v[128:129]
    ds_read_b64_tr_b16 v[102:103], v15 offset:45824
    v_mfma_f32_16x16x32_bf16 v[76:79], v[88:91], v[116:119], v[76:79]
    v_pk_mul_f32 v[138:139], v[62:63], v[130:131]
    v_cvt_pk_bf16_f32 v132, v132, v133
    ds_read_b64_tr_b16 v[104:105], v16 offset:41760
    v_mfma_f32_16x16x32_bf16 v[80:83], v[88:91], v[120:123], v[80:83]
    v_cvt_pk_bf16_f32 v133, v134, v135
    ds_read_b64_tr_b16 v[106:107], v16 offset:45856
    s_waitcnt lgkmcnt(6)
    v_mfma_f32_16x16x32_bf16 v[68:71], v[92:95], v[140:143], v[68:71]
    v_cvt_pk_bf16_f32 v134, v136, v137
    v_cvt_pk_bf16_f32 v135, v138, v139
    ds_read_b64_tr_b16 v[84:85], v15 offset:49920
    v_mfma_f32_16x16x32_bf16 v[72:75], v[92:95], v[144:147], v[72:75]
    v_permlane32_swap_b32 v132, v134
    ds_read_b64_tr_b16 v[86:87], v15 offset:54016
    s_waitcnt lgkmcnt(6)
    v_mfma_f32_16x16x32_bf16 v[76:79], v[96:99], v[140:143], v[76:79]
    v_permlane32_swap_b32 v133, v135
    v_permlane16_swap_b32 v132, v134
    ds_read_b64_tr_b16 v[88:89], v16 offset:49952
    v_mfma_f32_16x16x32_bf16 v[80:83], v[96:99], v[144:147], v[80:83]
    v_permlane16_swap_b32 v133, v135
    ds_read_b64_tr_b16 v[90:91], v16 offset:54048
    s_waitcnt lgkmcnt(6)
    v_mfma_f32_16x16x32_bf16 v[68:71], v[100:103], v[148:151], v[68:71]
    buffer_store_dwordx4 v[132:135], v14, s[8:11], s18 offen offset:2048 sc1
    ds_read_b64_tr_b16 v[92:93], v15 offset:58112
    v_mfma_f32_16x16x32_bf16 v[72:75], v[100:103], v[152:155], v[72:75]
    v_pk_mul_f32 v[132:133], v[56:57], v[124:125]
    v_pk_mul_f32 v[134:135], v[58:59], v[126:127]
    ds_read_b64_tr_b16 v[94:95], v15 offset:62208
    s_waitcnt lgkmcnt(6)
    v_mfma_f32_16x16x32_bf16 v[76:79], v[104:107], v[148:151], v[76:79]
    v_pk_mul_f32 v[136:137], v[64:65], v[128:129]
    ds_read_b64_tr_b16 v[96:97], v16 offset:58144
    v_mfma_f32_16x16x32_bf16 v[80:83], v[104:107], v[152:155], v[80:83]
    v_pk_mul_f32 v[138:139], v[66:67], v[130:131]
    v_cvt_pk_bf16_f32 v132, v132, v133
    ds_read_b64_tr_b16 v[98:99], v16 offset:62240
    s_waitcnt lgkmcnt(6)
    v_mfma_f32_16x16x32_bf16 v[68:71], v[84:87], v[156:159], v[68:71]
    v_cvt_pk_bf16_f32 v133, v134, v135
    v_mfma_f32_16x16x32_bf16 v[72:75], v[84:87], v[160:163], v[72:75]
    v_cvt_pk_bf16_f32 v134, v136, v137
    v_cvt_pk_bf16_f32 v135, v138, v139
    s_waitcnt lgkmcnt(4)
    v_mfma_f32_16x16x32_bf16 v[76:79], v[88:91], v[156:159], v[76:79]
    v_permlane32_swap_b32 v132, v134
    v_mfma_f32_16x16x32_bf16 v[80:83], v[88:91], v[160:163], v[80:83]
    v_permlane32_swap_b32 v133, v135
    v_permlane16_swap_b32 v132, v134
    s_waitcnt lgkmcnt(2)
    v_mfma_f32_16x16x32_bf16 v[68:71], v[92:95], v[164:167], v[68:71]
    v_permlane16_swap_b32 v133, v135
    v_mfma_f32_16x16x32_bf16 v[72:75], v[92:95], v[168:171], v[72:75]
    buffer_store_dwordx4 v[132:135], v14, s[8:11], s19 offen offset:2048 sc1
    s_waitcnt lgkmcnt(0)
    v_mfma_f32_16x16x32_bf16 v[76:79], v[96:99], v[164:167], v[76:79]
    v_mfma_f32_16x16x32_bf16 v[80:83], v[96:99], v[168:171], v[80:83]
    ds_read_b128 v[124:127], v13 offset:384
    ds_read_b128 v[128:131], v13 offset:448
    s_waitcnt lgkmcnt(1)
    v_pk_mul_f32 v[132:133], v[68:69], v[124:125]
    v_pk_mul_f32 v[134:135], v[70:71], v[126:127]
    s_waitcnt lgkmcnt(0)
    s_nop 0
    v_pk_mul_f32 v[136:137], v[76:77], v[128:129]
    v_pk_mul_f32 v[138:139], v[78:79], v[130:131]
    v_cvt_pk_bf16_f32 v132, v132, v133
    v_cvt_pk_bf16_f32 v133, v134, v135
    v_cvt_pk_bf16_f32 v134, v136, v137
    v_cvt_pk_bf16_f32 v135, v138, v139
    s_nop 0
    v_permlane32_swap_b32 v132, v134
    v_permlane32_swap_b32 v133, v135
    s_nop 0
    v_permlane16_swap_b32 v132, v134
    v_permlane16_swap_b32 v133, v135
    buffer_store_dwordx4 v[132:135], v14, s[8:11], s18 offen offset:3072 sc1
    s_nop 1
    v_pk_mul_f32 v[132:133], v[72:73], v[124:125]
    v_pk_mul_f32 v[134:135], v[74:75], v[126:127]
    v_pk_mul_f32 v[136:137], v[80:81], v[128:129]
    v_pk_mul_f32 v[138:139], v[82:83], v[130:131]
    v_cvt_pk_bf16_f32 v132, v132, v133
    v_cvt_pk_bf16_f32 v133, v134, v135
    v_cvt_pk_bf16_f32 v134, v136, v137
    v_cvt_pk_bf16_f32 v135, v138, v139
    s_nop 0
    v_permlane32_swap_b32 v132, v134
    v_permlane32_swap_b32 v133, v135
    s_nop 0
    v_permlane16_swap_b32 v132, v134
    v_permlane16_swap_b32 v133, v135
    buffer_store_dwordx4 v[132:135], v14, s[8:11], s19 offen offset:3072 sc1
fz_p3e:
    s_lshl_b32 s26, s13, 3
    s_add_u32 s26, s26, s3
    s_lshl_b32 s26, s26, 7
    s_lshl_b32 s27, s12, 2
    s_add_u32 s26, s26, s27
    s_add_u32 s26, s26, 0x550000
    v_mov_b32 v7, s14
    v_mov_b32 v6, 0
    v_mov_b32 v16, s3
    v_lshl_add_u32 v17, v16, 6, v0
    v_lshlrev_b32 v5, 2, v17
    v_lshrrev_b32 v13, 3, v8
    v_and_b32 v14, 7, v8
    s_lshl_b32 s16, s13, 8
    s_lshl_b32 s27, s12, 3
    s_add_u32 s16, s16, s27
    s_add_u32 s16, s16, s3
    s_lshl_b32 s17, s16, 11
    s_mov_b64 s[28:29], s[32:33]
    s_mov_b32 s30, 0x400000
    s_mov_b32 s31, 0x20000
    s_mov_b64 s[64:65], s[56:57]
    s_mov_b32 s66, 0x400000
    s_mov_b32 s67, 0x20000
    v_add_u32 v15, 0x20000, v1
    ds_read_b128 v[72:75], v15 offset:0
    ds_read_b128 v[76:79], v15 offset:1024
    ds_read_b128 v[80:83], v15 offset:2048
    ds_read_b128 v[84:87], v15 offset:3072
    ds_read_b128 v[88:91], v15 offset:4096
    ds_read_b128 v[92:95], v15 offset:5120
    ds_read_b128 v[96:99], v15 offset:6144
    ds_read_b128 v[100:103], v15 offset:7168
    s_waitcnt vmcnt(0)
    s_mov_b64 exec, 1
    buffer_store_dword v7, v6, s[8:11], s26 offen sc1
    s_mov_b64 exec, -1
    buffer_load_dwordx4 v[128:131], v1, s[28:31], s17 offen offset:0
    buffer_load_dwordx4 v[132:135], v1, s[28:31], s17 offen offset:1024
    v_mov_b32 v190, 0
    v_mov_b32 v196, 0
    s_waitcnt lgkmcnt(5)
    v_lshlrev_b32 v144, 16, v80
    v_and_b32 v145, 0xffff0000, v80
    s_waitcnt lgkmcnt(1)
    v_lshlrev_b32 v146, 16, v96
    v_and_b32 v147, 0xffff0000, v96
    v_pk_mul_f32 v[104:105], v[144:145], v[146:147]
    v_lshlrev_b32 v144, 16, v72
    v_and_b32 v145, 0xffff0000, v72
    v_fmac_f32 v190, v144, v146
    v_fmac_f32 v190, v145, v147
    v_add_f32 v196, v196, v104
    v_add_f32 v196, v196, v105
    v_lshlrev_b32 v144, 16, v81
    v_and_b32 v145, 0xffff0000, v81
    v_lshlrev_b32 v146, 16, v97
    v_and_b32 v147, 0xffff0000, v97
    v_pk_mul_f32 v[106:107], v[144:145], v[146:147]
    v_lshlrev_b32 v144, 16, v73
    v_and_b32 v145, 0xffff0000, v73
    v_fmac_f32 v190, v144, v146
    v_fmac_f32 v190, v145, v147
    v_add_f32 v196, v196, v106
    v_add_f32 v196, v196, v107
    v_lshlrev_b32 v144, 16, v82
    v_and_b32 v145, 0xffff0000, v82
    v_lshlrev_b32 v146, 16, v98
    v_and_b32 v147, 0xffff0000, v98
    v_pk_mul_f32 v[108:109], v[144:145], v[146:147]
    v_lshlrev_b32 v144, 16, v74
    v_and_b32 v145, 0xffff0000, v74
    v_fmac_f32 v190, v144, v146
    v_fmac_f32 v190, v145, v147
    v_add_f32 v196, v196, v108
    v_add_f32 v196, v196, v109
    v_lshlrev_b32 v144, 16, v83
    v_and_b32 v145, 0xffff0000, v83
    v_lshlrev_b32 v146, 16, v99
    v_and_b32 v147, 0xffff0000, v99
    v_pk_mul_f32 v[110:111], v[144:145], v[146:147]
    v_lshlrev_b32 v144, 16, v75
    v_and_b32 v145, 0xffff0000, v75
    v_fmac_f32 v190, v144, v146
    v_fmac_f32 v190, v145, v147
    v_add_f32 v196, v196, v110
    v_add_f32 v196, v196, v111
    v_lshlrev_b32 v144, 16, v84
    v_and_b32 v145, 0xffff0000, v84
    s_waitcnt lgkmcnt(0)
    v_lshlrev_b32 v146, 16, v100
    v_and_b32 v147, 0xffff0000, v100
    v_pk_mul_f32 v[112:113], v[144:145], v[146:147]
    v_lshlrev_b32 v144, 16, v76
    v_and_b32 v145, 0xffff0000, v76
    v_fmac_f32 v190, v144, v146
    v_fmac_f32 v190, v145, v147
    v_add_f32 v196, v196, v112
    v_add_f32 v196, v196, v113
    v_lshlrev_b32 v144, 16, v85
    v_and_b32 v145, 0xffff0000, v85
    v_lshlrev_b32 v146, 16, v101
    v_and_b32 v147, 0xffff0000, v101
    v_pk_mul_f32 v[114:115], v[144:145], v[146:147]
    v_lshlrev_b32 v144, 16, v77
    v_and_b32 v145, 0xffff0000, v77
    v_fmac_f32 v190, v144, v146
    v_fmac_f32 v190, v145, v147
    v_add_f32 v196, v196, v114
    v_add_f32 v196, v196, v115
    v_lshlrev_b32 v144, 16, v86
    v_and_b32 v145, 0xffff0000, v86
    v_lshlrev_b32 v146, 16, v102
    v_and_b32 v147, 0xffff0000, v102
    v_pk_mul_f32 v[116:117], v[144:145], v[146:147]
    v_lshlrev_b32 v144, 16, v78
    v_and_b32 v145, 0xffff0000, v78
    v_fmac_f32 v190, v144, v146
    v_fmac_f32 v190, v145, v147
    v_add_f32 v196, v196, v116
    v_add_f32 v196, v196, v117
    v_lshlrev_b32 v144, 16, v87
    v_and_b32 v145, 0xffff0000, v87
    v_lshlrev_b32 v146, 16, v103
    v_and_b32 v147, 0xffff0000, v103
    v_pk_mul_f32 v[118:119], v[144:145], v[146:147]
    v_lshlrev_b32 v144, 16, v79
    v_and_b32 v145, 0xffff0000, v79
    v_fmac_f32 v190, v144, v146
    v_fmac_f32 v190, v145, v147
    v_add_f32 v196, v196, v118
    v_add_f32 v196, v196, v119
    v_add_f32_dpp v190, v190, v190 row_ror:1 row_mask:0xf bank_mask:0xf
    s_nop 0
    v_add_f32_dpp v196, v196, v196 row_ror:1 row_mask:0xf bank_mask:0xf
    v_add_f32_dpp v190, v190, v190 row_ror:2 row_mask:0xf bank_mask:0xf
    s_nop 0
    v_add_f32_dpp v196, v196, v196 row_ror:2 row_mask:0xf bank_mask:0xf
    v_add_f32_dpp v190, v190, v190 row_ror:4 row_mask:0xf bank_mask:0xf
    s_nop 0
    v_add_f32_dpp v196, v196, v196 row_ror:4 row_mask:0xf bank_mask:0xf
    v_add_f32_dpp v190, v190, v190 row_ror:8 row_mask:0xf bank_mask:0xf
    s_nop 0
    v_add_f32_dpp v196, v196, v196 row_ror:8 row_mask:0xf bank_mask:0xf
    v_mov_b32 v144, v190
    s_nop 1
    v_permlane16_swap_b32 v190, v144
    v_add_f32 v190, v190, v144
    v_mov_b32 v145, v196
    s_nop 1
    v_permlane16_swap_b32 v196, v145
    v_add_f32 v196, v196, v145
    v_mov_b32 v144, v190
    s_nop 1
    v_permlane32_swap_b32 v190, v144
    v_add_f32 v190, v190, v144
    v_mov_b32 v145, v196
    s_nop 1
    v_permlane32_swap_b32 v196, v145
    v_add_f32 v196, v196, v145
    v_lshlrev_b32 v7, 2, v8
    s_lshl_b32 s25, s98, 10
    s_add_u32 s25, s25, 131072
    v_add_u32 v11, s25, v7
    ds_read_b32 v168, v11 offset:2048
    ds_read_b32 v170, v11
    s_lshl_b32 s18, s99, 7
    s_add_u32 s25, s18, 131072
    v_lshl_add_u32 v11, v0, 1, s25
    ds_read_u16 v125, v11 offset:2048
    ds_read_u16 v126, v11 offset:0
    ds_read_u16 v127, v11 offset:4096
    s_waitcnt lgkmcnt(2)
    v_lshlrev_b32 v125, 16, v125
    s_waitcnt lgkmcnt(1)
    v_lshlrev_b32 v126, 16, v126
    s_waitcnt lgkmcnt(0)
    v_lshlrev_b32 v127, 16, v127
    v_and_b32 v169, 0xffff0000, v168
    v_lshlrev_b32 v168, 16, v168
    v_and_b32 v171, 0xffff0000, v170
    v_lshlrev_b32 v170, 16, v170
    s_waitcnt vmcnt(1)
    v_lshlrev_b32 v24, 16, v128
    v_and_b32 v25, 0xffff0000, v128
    v_lshlrev_b32 v26, 16, v129
    v_and_b32 v27, 0xffff0000, v129
    v_lshlrev_b32 v28, 16, v130
    v_and_b32 v29, 0xffff0000, v130
    v_lshlrev_b32 v30, 16, v131
    v_and_b32 v31, 0xffff0000, v131
    s_waitcnt vmcnt(0)
    v_lshlrev_b32 v32, 16, v132
    v_and_b32 v33, 0xffff0000, v132
    v_lshlrev_b32 v34, 16, v133
    v_and_b32 v35, 0xffff0000, v133
    v_lshlrev_b32 v36, 16, v134
    v_and_b32 v37, 0xffff0000, v134
    v_lshlrev_b32 v38, 16, v135
    v_and_b32 v39, 0xffff0000, v135
    s_lshr_b32 s24, s16, 4
    s_lshl_b32 s24, s24, 15
    s_and_b32 s27, s16, 15
    s_lshl_b32 s27, s27, 6
    s_add_u32 s24, s24, s27
    s_add_u32 s24, s24, 0x2000000
    v_lshrrev_b32 v3, 2, v0
    v_lshlrev_b32 v3, 10, v3
    v_and_b32 v2, 3, v0
    v_lshl_add_u32 v3, v2, 4, v3
    v_and_b32 v11, 31, v0
    v_lshlrev_b32 v11, 2, v11
    s_lshl_b32 s22, s13, 3
    s_lshr_b32 s23, s12, 2
    s_add_u32 s22, s22, s23
    s_lshl_b32 s22, s22, 7
    s_add_u32 s22, s22, 0x550000
    s_mov_b32 s27, 0
fz_rp:
    buffer_load_dword v144, v11, s[8:11], s22 offen sc1
    s_waitcnt vmcnt(0)
    v_cmp_ne_u32 vcc, s14, v144
    s_add_u32 s27, s27, 1
    s_cmp_ge_u32 s27, 65536
    s_cbranch_scc1 fz_rg
    s_cbranch_vccz fz_rg
    s_sleep 1
    s_branch fz_rp
fz_rg:
    s_add_u32 s25, s24, 0x0
    buffer_load_dwordx4 v[40:43], v3, s[8:11], s25 offen sc1
    s_add_u32 s25, s24, 0x400000
    buffer_load_dwordx4 v[48:51], v3, s[8:11], s25 offen sc1
    s_add_u32 s25, s24, 0x800000
    buffer_load_dwordx4 v[56:59], v3, s[8:11], s25 offen sc1
    s_add_u32 s25, s24, 0xc00000
    buffer_load_dwordx4 v[64:67], v3, s[8:11], s25 offen sc1
    s_add_u32 s25, s24, 0x4000
    buffer_load_dwordx4 v[44:47], v3, s[8:11], s25 offen sc1
    s_add_u32 s25, s24, 0x404000
    buffer_load_dwordx4 v[52:55], v3, s[8:11], s25 offen sc1
    s_add_u32 s25, s24, 0x804000
    buffer_load_dwordx4 v[60:63], v3, s[8:11], s25 offen sc1
    s_add_u32 s25, s24, 0xc04000
    buffer_load_dwordx4 v[68:71], v3, s[8:11], s25 offen sc1
    s_waitcnt vmcnt(7)
    v_lshlrev_b32 v144, 16, v40
    v_and_b32 v145, 0xffff0000, v40
    s_waitcnt vmcnt(6)
    v_lshlrev_b32 v146, 16, v48
    v_and_b32 v147, 0xffff0000, v48
    v_pk_add_f32 v[144:145], v[144:145], v[146:147]
    s_waitcnt vmcnt(5)
    v_lshlrev_b32 v146, 16, v56
    v_and_b32 v147, 0xffff0000, v56
    v_pk_add_f32 v[144:145], v[144:145], v[146:147]
    s_waitcnt vmcnt(4)
    v_lshlrev_b32 v146, 16, v64
    v_and_b32 v147, 0xffff0000, v64
    v_pk_add_f32 v[144:145], v[144:145], v[146:147]
    v_pk_add_f32 v[24:25], v[24:25], v[144:145]
    v_cvt_pk_bf16_f32 v11, v24, v25
    v_lshlrev_b32 v24, 16, v11
    v_and_b32 v25, 0xffff0000, v11
    v_lshlrev_b32 v148, 16, v41
    v_and_b32 v149, 0xffff0000, v41
    v_lshlrev_b32 v150, 16, v49
    v_and_b32 v151, 0xffff0000, v49
    v_pk_add_f32 v[148:149], v[148:149], v[150:151]
    v_lshlrev_b32 v150, 16, v57
    v_and_b32 v151, 0xffff0000, v57
    v_pk_add_f32 v[148:149], v[148:149], v[150:151]
    v_lshlrev_b32 v150, 16, v65
    v_and_b32 v151, 0xffff0000, v65
    v_pk_add_f32 v[148:149], v[148:149], v[150:151]
    v_pk_add_f32 v[26:27], v[26:27], v[148:149]
    v_cvt_pk_bf16_f32 v12, v26, v27
    v_lshlrev_b32 v26, 16, v12
    v_and_b32 v27, 0xffff0000, v12
    v_lshlrev_b32 v144, 16, v42
    v_and_b32 v145, 0xffff0000, v42
    v_lshlrev_b32 v146, 16, v50
    v_and_b32 v147, 0xffff0000, v50
    v_pk_add_f32 v[144:145], v[144:145], v[146:147]
    v_lshlrev_b32 v146, 16, v58
    v_and_b32 v147, 0xffff0000, v58
    v_pk_add_f32 v[144:145], v[144:145], v[146:147]
    v_lshlrev_b32 v146, 16, v66
    v_and_b32 v147, 0xffff0000, v66
    v_pk_add_f32 v[144:145], v[144:145], v[146:147]
    v_pk_add_f32 v[28:29], v[28:29], v[144:145]
    v_cvt_pk_bf16_f32 v11, v28, v29
    v_lshlrev_b32 v28, 16, v11
    v_and_b32 v29, 0xffff0000, v11
    v_lshlrev_b32 v148, 16, v43
    v_and_b32 v149, 0xffff0000, v43
    v_lshlrev_b32 v150, 16, v51
    v_and_b32 v151, 0xffff0000, v51
    v_pk_add_f32 v[148:149], v[148:149], v[150:151]
    v_lshlrev_b32 v150, 16, v59
    v_and_b32 v151, 0xffff0000, v59
    v_pk_add_f32 v[148:149], v[148:149], v[150:151]
    v_lshlrev_b32 v150, 16, v67
    v_and_b32 v151, 0xffff0000, v67
    v_pk_add_f32 v[148:149], v[148:149], v[150:151]
    v_pk_add_f32 v[30:31], v[30:31], v[148:149]
    v_cvt_pk_bf16_f32 v12, v30, v31
    v_lshlrev_b32 v30, 16, v12
    v_and_b32 v31, 0xffff0000, v12
    s_waitcnt vmcnt(3)
    v_lshlrev_b32 v144, 16, v44
    v_and_b32 v145, 0xffff0000, v44
    s_waitcnt vmcnt(2)
    v_lshlrev_b32 v146, 16, v52
    v_and_b32 v147, 0xffff0000, v52
    v_pk_add_f32 v[144:145], v[144:145], v[146:147]
    s_waitcnt vmcnt(1)
    v_lshlrev_b32 v146, 16, v60
    v_and_b32 v147, 0xffff0000, v60
    v_pk_add_f32 v[144:145], v[144:145], v[146:147]
    s_waitcnt vmcnt(0)
    v_lshlrev_b32 v146, 16, v68
    v_and_b32 v147, 0xffff0000, v68
    v_pk_add_f32 v[144:145], v[144:145], v[146:147]
    v_pk_add_f32 v[32:33], v[32:33], v[144:145]
    v_cvt_pk_bf16_f32 v11, v32, v33
    v_lshlrev_b32 v32, 16, v11
    v_and_b32 v33, 0xffff0000, v11
    v_lshlrev_b32 v148, 16, v45
    v_and_b32 v149, 0xffff0000, v45
    v_lshlrev_b32 v150, 16, v53
    v_and_b32 v151, 0xffff0000, v53
    v_pk_add_f32 v[148:149], v[148:149], v[150:151]
    v_lshlrev_b32 v150, 16, v61
    v_and_b32 v151, 0xffff0000, v61
    v_pk_add_f32 v[148:149], v[148:149], v[150:151]
    v_lshlrev_b32 v150, 16, v69
    v_and_b32 v151, 0xffff0000, v69
    v_pk_add_f32 v[148:149], v[148:149], v[150:151]
    v_pk_add_f32 v[34:35], v[34:35], v[148:149]
    v_cvt_pk_bf16_f32 v12, v34, v35
    v_lshlrev_b32 v34, 16, v12
    v_and_b32 v35, 0xffff0000, v12
    v_lshlrev_b32 v144, 16, v46
    v_and_b32 v145, 0xffff0000, v46
    v_lshlrev_b32 v146, 16, v54
    v_and_b32 v147, 0xffff0000, v54
    v_pk_add_f32 v[144:145], v[144:145], v[146:147]
    v_lshlrev_b32 v146, 16, v62
    v_and_b32 v147, 0xffff0000, v62
    v_pk_add_f32 v[144:145], v[144:145], v[146:147]
    v_lshlrev_b32 v146, 16, v70
    v_and_b32 v147, 0xffff0000, v70
    v_pk_add_f32 v[144:145], v[144:145], v[146:147]
    v_pk_add_f32 v[36:37], v[36:37], v[144:145]
    v_cvt_pk_bf16_f32 v11, v36, v37
    v_lshlrev_b32 v36, 16, v11
    v_and_b32 v37, 0xffff0000, v11
    v_lshlrev_b32 v148, 16, v47
    v_and_b32 v149, 0xffff0000, v47
    v_lshlrev_b32 v150, 16, v55
    v_and_b32 v151, 0xffff0000, v55
    v_pk_add_f32 v[148:149], v[148:149], v[150:151]
    v_lshlrev_b32 v150, 16, v63
    v_and_b32 v151, 0xffff0000, v63
    v_pk_add_f32 v[148:149], v[148:149], v[150:151]
    v_lshlrev_b32 v150, 16, v71
    v_and_b32 v151, 0xffff0000, v71
    v_pk_add_f32 v[148:149], v[148:149], v[150:151]
    v_pk_add_f32 v[38:39], v[38:39], v[148:149]
    v_cvt_pk_bf16_f32 v12, v38, v39
    v_lshlrev_b32 v38, 16, v12
    v_and_b32 v39, 0xffff0000, v12
    v_readfirstlane_b32 s25, v24
    s_nop 1
    v_mov_b32 v188, s25
    v_pk_add_f32 v[40:41], v[24:25], v[188:189] op_sel_hi:[1,0] neg_lo:[0,1] neg_hi:[0,1]
    v_pk_add_f32 v[42:43], v[26:27], v[188:189] op_sel_hi:[1,0] neg_lo:[0,1] neg_hi:[0,1]
    v_pk_add_f32 v[44:45], v[28:29], v[188:189] op_sel_hi:[1,0] neg_lo:[0,1] neg_hi:[0,1]
    v_pk_add_f32 v[46:47], v[30:31], v[188:189] op_sel_hi:[1,0] neg_lo:[0,1] neg_hi:[0,1]
    v_pk_add_f32 v[48:49], v[32:33], v[188:189] op_sel_hi:[1,0] neg_lo:[0,1] neg_hi:[0,1]
    v_pk_add_f32 v[50:51], v[34:35], v[188:189] op_sel_hi:[1,0] neg_lo:[0,1] neg_hi:[0,1]
    v_pk_add_f32 v[52:53], v[36:37], v[188:189] op_sel_hi:[1,0] neg_lo:[0,1] neg_hi:[0,1]
    v_pk_add_f32 v[54:55], v[38:39], v[188:189] op_sel_hi:[1,0] neg_lo:[0,1] neg_hi:[0,1]
    v_pk_add_f32 v[148:149], v[40:41], v[42:43]
    v_pk_mul_f32 v[144:145], v[40:41], v[40:41]
    v_pk_mul_f32 v[146:147], v[40:41], v[104:105]
    v_pk_fma_f32 v[144:145], v[42:43], v[42:43], v[144:145]
    v_pk_fma_f32 v[146:147], v[42:43], v[106:107], v[146:147]
    v_pk_add_f32 v[148:149], v[148:149], v[44:45]
    v_pk_fma_f32 v[144:145], v[44:45], v[44:45], v[144:145]
    v_pk_fma_f32 v[146:147], v[44:45], v[108:109], v[146:147]
    v_pk_add_f32 v[148:149], v[148:149], v[46:47]
    v_pk_fma_f32 v[144:145], v[46:47], v[46:47], v[144:145]
    v_pk_fma_f32 v[146:147], v[46:47], v[110:111], v[146:147]
    v_pk_add_f32 v[148:149], v[148:149], v[48:49]
    v_pk_fma_f32 v[144:145], v[48:49], v[48:49], v[144:145]
    v_pk_fma_f32 v[146:147], v[48:49], v[112:113], v[146:147]
    v_pk_add_f32 v[148:149], v[148:149], v[50:51]
    v_pk_fma_f32 v[144:145], v[50:51], v[50:51], v[144:145]
    v_pk_fma_f32 v[146:147], v[50:51], v[114:115], v[146:147]
    v_pk_add_f32 v[148:149], v[148:149], v[52:53]
    v_pk_fma_f32 v[144:145], v[52:53], v[52:53], v[144:145]
    v_pk_fma_f32 v[146:147], v[52:53], v[116:117], v[146:147]
    v_pk_add_f32 v[148:149], v[148:149], v[54:55]
    v_pk_fma_f32 v[144:145], v[54:55], v[54:55], v[144:145]
    v_pk_fma_f32 v[146:147], v[54:55], v[118:119], v[146:147]
    v_add_f32 v192, v148, v149
    v_add_f32 v193, v144, v145
    v_add_f32 v194, v146, v147
    v_add_f32_dpp v192, v192, v192 row_ror:1 row_mask:0xf bank_mask:0xf
    v_add_f32_dpp v193, v193, v193 row_ror:1 row_mask:0xf bank_mask:0xf
    v_add_f32_dpp v194, v194, v194 row_ror:1 row_mask:0xf bank_mask:0xf
    v_add_f32_dpp v192, v192, v192 row_ror:2 row_mask:0xf bank_mask:0xf
    v_add_f32_dpp v193, v193, v193 row_ror:2 row_mask:0xf bank_mask:0xf
    v_add_f32_dpp v194, v194, v194 row_ror:2 row_mask:0xf bank_mask:0xf
    v_add_f32_dpp v192, v192, v192 row_ror:4 row_mask:0xf bank_mask:0xf
    v_add_f32_dpp v193, v193, v193 row_ror:4 row_mask:0xf bank_mask:0xf
    v_add_f32_dpp v194, v194, v194 row_ror:4 row_mask:0xf bank_mask:0xf
    v_add_f32_dpp v192, v192, v192 row_ror:8 row_mask:0xf bank_mask:0xf
    v_add_f32_dpp v193, v193, v193 row_ror:8 row_mask:0xf bank_mask:0xf
    v_add_f32_dpp v194, v194, v194 row_ror:8 row_mask:0xf bank_mask:0xf
    v_mov_b32 v144, v192
    s_nop 1
    v_permlane16_swap_b32 v192, v144
    v_add_f32 v192, v192, v144
    v_mov_b32 v145, v193
    s_nop 1
    v_permlane16_swap_b32 v193, v145
    v_add_f32 v193, v193, v145
    v_mov_b32 v146, v194
    s_nop 1
    v_permlane16_swap_b32 v194, v146
    v_add_f32 v194, v194, v146
    v_mov_b32 v144, v192
    s_nop 1
    v_permlane32_swap_b32 v192, v144
    v_add_f32 v192, v192, v144
    v_mov_b32 v145, v193
    s_nop 1
    v_permlane32_swap_b32 v193, v145
    v_add_f32 v193, v193, v145
    v_mov_b32 v146, v194
    s_nop 1
    v_permlane32_swap_b32 v194, v146
    v_add_f32 v194, v194, v146
    v_mul_f32 v192, 0x3a800000, v192
    v_mul_f32 v193, 0x3a800000, v193
    v_fma_f32 v193, -v192, v192, v193
    v_max_f32 v193, 0, v193
    v_fma_f32 v194, -v192, v196, v194
    v_add_f32 v192, s25, v192
    v_add_f32 v144, 0x3727c5ac, v193
    v_rsq_f32 v144, v144
    s_nop 0
    v_fma_f32 v23, v194, v144, v190
    v_cvt_pk_bf16_f32 v192, v192, v192
    v_lshlrev_b32 v192, 16, v192
    v_cvt_pk_bf16_f32 v193, v193, v193
    v_lshlrev_b32 v193, 16, v193
    v_add_f32 v193, 0x3727c5ac, v193
    v_cvt_pk_bf16_f32 v193, v193, v193
    v_lshlrev_b32 v193, 16, v193
    v_sqrt_f32 v194, v193
    s_nop 0
    v_cvt_pk_bf16_f32 v194, v194, v194
    v_lshlrev_b32 v194, 16, v194
    v_rcp_f32 v195, v194
    v_mov_b32 v21, v192
    v_mov_b32 v22, v194
    v_ashrrev_i32 v12, 31, v23
    v_or_b32 v12, 0x80000000, v12
    v_xor_b32 v20, v23, v12
    v_and_b32 v20, 0xfffff800, v20
    v_max_u32 v20, 0x800, v20
    s_sub_u32 s24, 2047, s16
    v_or_b32 v20, s24, v20
    v_lshlrev_b32 v11, 4, v16
    ds_write_b128 v11, v[20:23]
    s_waitcnt lgkmcnt(0)
    s_barrier
    s_cmp_lg_u32 s3, 0
    s_cbranch_scc1 fz_nk
    v_and_b32 v11, 7, v0
    v_lshlrev_b32 v11, 4, v11
    ds_read_b32 v144, v11 offset:0
    s_waitcnt lgkmcnt(0)
    v_mov_b32 v145, v144
    s_nop 1
    v_max_u32_dpp v145, v145, v145 row_ror:1 row_mask:0xf bank_mask:0xf
    s_nop 1
    v_max_u32_dpp v145, v145, v145 row_ror:2 row_mask:0xf bank_mask:0xf
    s_nop 1
    v_max_u32_dpp v145, v145, v145 row_ror:4 row_mask:0xf bank_mask:0xf
    v_cmp_eq_u32 vcc, v144, v145
    s_ff1_i32_b64 s26, vcc
    s_lshl_b32 s26, s26, 4
    v_mov_b32 v11, s26
    ds_read_b128 v[20:23], v11 offset:0
    s_lshl_b32 s24, s2, 4
    s_add_u32 s24, s24, 0xa70000
    s_mov_b64 exec, 1
    s_waitcnt lgkmcnt(0)
    buffer_store_dwordx4 v[20:23], v6, s[8:11], s24 offen sc1
    s_mov_b64 exec, -1
fz_nk:
    s_waitcnt lgkmcnt(0)
    v_lshlrev_b32 v2, 5, v14
    v_bfe_u32 v4, v0, 4, 2
    v_lshl_add_u32 v2, v4, 3, v2
    v_bfe_u32 v4, v17, 6, 2
    v_lshl_add_u32 v2, v4, 8, v2
    v_lshlrev_b32 v4, 2, v0
    s_cmp_lt_u32 s3, 4
    s_cbranch_scc1 fz_dn
    v_sub_f32 v40, v24, v192
    v_sub_f32 v41, v25, v192
    v_sub_f32 v42, v26, v192
    v_sub_f32 v43, v27, v192
    v_sub_f32 v44, v28, v192
    v_sub_f32 v45, v29, v192
    v_sub_f32 v46, v30, v192
    v_sub_f32 v47, v31, v192
    v_cvt_pk_bf16_f32 v12, v40, v41
    v_lshlrev_b32 v40, 16, v12
    v_and_b32 v41, 0xffff0000, v12
    v_cvt_pk_bf16_f32 v12, v42, v43
    v_lshlrev_b32 v42, 16, v12
    v_and_b32 v43, 0xffff0000, v12
    v_cvt_pk_bf16_f32 v12, v44, v45
    v_lshlrev_b32 v44, 16, v12
    v_and_b32 v45, 0xffff0000, v12
    v_cvt_pk_bf16_f32 v12, v46, v47
    v_lshlrev_b32 v46, 16, v12
    v_and_b32 v47, 0xffff0000, v12
    v_mul_f32 v40, v40, v195
    v_mul_f32 v41, v41, v195
    v_mul_f32 v42, v42, v195
    v_mul_f32 v43, v43, v195
    v_mul_f32 v44, v44, v195
    v_mul_f32 v45, v45, v195
    v_mul_f32 v46, v46, v195
    v_mul_f32 v47, v47, v195
    v_cvt_pk_bf16_f32 v12, v40, v41
    v_lshlrev_b32 v40, 16, v12
    v_and_b32 v41, 0xffff0000, v12
    v_cvt_pk_bf16_f32 v12, v42, v43
    v_lshlrev_b32 v42, 16, v12
    v_and_b32 v43, 0xffff0000, v12
    v_cvt_pk_bf16_f32 v12, v44, v45
    v_lshlrev_b32 v44, 16, v12
    v_and_b32 v45, 0xffff0000, v12
    v_cvt_pk_bf16_f32 v12, v46, v47
    v_lshlrev_b32 v46, 16, v12
    v_and_b32 v47, 0xffff0000, v12
    v_lshlrev_b32 v48, 16, v80
    v_and_b32 v49, 0xffff0000, v80
    v_lshlrev_b32 v50, 16, v81
    v_and_b32 v51, 0xffff0000, v81
    v_lshlrev_b32 v52, 16, v82
    v_and_b32 v53, 0xffff0000, v82
    v_lshlrev_b32 v54, 16, v83
    v_and_b32 v55, 0xffff0000, v83
    v_pk_mul_f32 v[40:41], v[40:41], v[48:49]
    v_pk_mul_f32 v[42:43], v[42:43], v[50:51]
    v_pk_mul_f32 v[44:45], v[44:45], v[52:53]
    v_pk_mul_f32 v[46:47], v[46:47], v[54:55]
    v_cvt_pk_bf16_f32 v12, v40, v41
    v_lshlrev_b32 v40, 16, v12
    v_and_b32 v41, 0xffff0000, v12
    v_cvt_pk_bf16_f32 v12, v42, v43
    v_lshlrev_b32 v42, 16, v12
    v_and_b32 v43, 0xffff0000, v12
    v_cvt_pk_bf16_f32 v12, v44, v45
    v_lshlrev_b32 v44, 16, v12
    v_and_b32 v45, 0xffff0000, v12
    v_cvt_pk_bf16_f32 v12, v46, v47
    v_lshlrev_b32 v46, 16, v12
    v_and_b32 v47, 0xffff0000, v12
    v_lshlrev_b32 v48, 16, v72
    v_and_b32 v49, 0xffff0000, v72
    v_lshlrev_b32 v50, 16, v73
    v_and_b32 v51, 0xffff0000, v73
    v_lshlrev_b32 v52, 16, v74
    v_and_b32 v53, 0xffff0000, v74
    v_lshlrev_b32 v54, 16, v75
    v_and_b32 v55, 0xffff0000, v75
    v_pk_add_f32 v[40:41], v[40:41], v[48:49]
    v_pk_add_f32 v[42:43], v[42:43], v[50:51]
    v_pk_add_f32 v[44:45], v[44:45], v[52:53]
    v_pk_add_f32 v[46:47], v[46:47], v[54:55]
    v_cvt_pk_bf16_f32 v12, v40, v41
    v_lshlrev_b32 v40, 16, v12
    v_and_b32 v41, 0xffff0000, v12
    v_cvt_pk_bf16_f32 v12, v42, v43
    v_lshlrev_b32 v42, 16, v12
    v_and_b32 v43, 0xffff0000, v12
    v_cvt_pk_bf16_f32 v12, v44, v45
    v_lshlrev_b32 v44, 16, v12
    v_and_b32 v45, 0xffff0000, v12
    v_cvt_pk_bf16_f32 v12, v46, v47
    v_lshlrev_b32 v46, 16, v12
    v_and_b32 v47, 0xffff0000, v12
    v_lshlrev_b32 v48, 16, v88
    v_and_b32 v49, 0xffff0000, v88
    v_lshlrev_b32 v50, 16, v89
    v_and_b32 v51, 0xffff0000, v89
    v_lshlrev_b32 v52, 16, v90
    v_and_b32 v53, 0xffff0000, v90
    v_lshlrev_b32 v54, 16, v91
    v_and_b32 v55, 0xffff0000, v91
    v_pk_mul_f32 v[40:41], v[40:41], v[48:49]
    v_pk_mul_f32 v[42:43], v[42:43], v[50:51]
    v_pk_mul_f32 v[44:45], v[44:45], v[52:53]
    v_pk_mul_f32 v[46:47], v[46:47], v[54:55]
    v_cvt_pk_bf16_f32 v12, v40, v41
    v_lshlrev_b32 v40, 16, v12
    v_and_b32 v41, 0xffff0000, v12
    v_cvt_pk_bf16_f32 v12, v42, v43
    v_lshlrev_b32 v42, 16, v12
    v_and_b32 v43, 0xffff0000, v12
    v_cvt_pk_bf16_f32 v12, v44, v45
    v_lshlrev_b32 v44, 16, v12
    v_and_b32 v45, 0xffff0000, v12
    v_cvt_pk_bf16_f32 v12, v46, v47
    v_lshlrev_b32 v46, 16, v12
    v_and_b32 v47, 0xffff0000, v12
    v_pk_add_f32 v[40:41], v[40:41], v[24:25]
    v_pk_add_f32 v[42:43], v[42:43], v[26:27]
    v_pk_add_f32 v[44:45], v[44:45], v[28:29]
    v_pk_add_f32 v[46:47], v[46:47], v[30:31]
    v_cvt_pk_bf16_f32 v56, v40, v41
    v_cvt_pk_bf16_f32 v57, v42, v43
    v_cvt_pk_bf16_f32 v58, v44, v45
    v_cvt_pk_bf16_f32 v59, v46, v47
    v_sub_f32 v40, v32, v192
    v_sub_f32 v41, v33, v192
    v_sub_f32 v42, v34, v192
    v_sub_f32 v43, v35, v192
    v_sub_f32 v44, v36, v192
    v_sub_f32 v45, v37, v192
    v_sub_f32 v46, v38, v192
    v_sub_f32 v47, v39, v192
    v_cvt_pk_bf16_f32 v12, v40, v41
    v_lshlrev_b32 v40, 16, v12
    v_and_b32 v41, 0xffff0000, v12
    v_cvt_pk_bf16_f32 v12, v42, v43
    v_lshlrev_b32 v42, 16, v12
    v_and_b32 v43, 0xffff0000, v12
    v_cvt_pk_bf16_f32 v12, v44, v45
    v_lshlrev_b32 v44, 16, v12
    v_and_b32 v45, 0xffff0000, v12
    v_cvt_pk_bf16_f32 v12, v46, v47
    v_lshlrev_b32 v46, 16, v12
    v_and_b32 v47, 0xffff0000, v12
    v_mul_f32 v40, v40, v195
    v_mul_f32 v41, v41, v195
    v_mul_f32 v42, v42, v195
    v_mul_f32 v43, v43, v195
    v_mul_f32 v44, v44, v195
    v_mul_f32 v45, v45, v195
    v_mul_f32 v46, v46, v195
    v_mul_f32 v47, v47, v195
    v_cvt_pk_bf16_f32 v12, v40, v41
    v_lshlrev_b32 v40, 16, v12
    v_and_b32 v41, 0xffff0000, v12
    v_cvt_pk_bf16_f32 v12, v42, v43
    v_lshlrev_b32 v42, 16, v12
    v_and_b32 v43, 0xffff0000, v12
    v_cvt_pk_bf16_f32 v12, v44, v45
    v_lshlrev_b32 v44, 16, v12
    v_and_b32 v45, 0xffff0000, v12
    v_cvt_pk_bf16_f32 v12, v46, v47
    v_lshlrev_b32 v46, 16, v12
    v_and_b32 v47, 0xffff0000, v12
    v_lshlrev_b32 v48, 16, v84
    v_and_b32 v49, 0xffff0000, v84
    v_lshlrev_b32 v50, 16, v85
    v_and_b32 v51, 0xffff0000, v85
    v_lshlrev_b32 v52, 16, v86
    v_and_b32 v53, 0xffff0000, v86
    v_lshlrev_b32 v54, 16, v87
    v_and_b32 v55, 0xffff0000, v87
    v_pk_mul_f32 v[40:41], v[40:41], v[48:49]
    v_pk_mul_f32 v[42:43], v[42:43], v[50:51]
    v_pk_mul_f32 v[44:45], v[44:45], v[52:53]
    v_pk_mul_f32 v[46:47], v[46:47], v[54:55]
    v_cvt_pk_bf16_f32 v12, v40, v41
    v_lshlrev_b32 v40, 16, v12
    v_and_b32 v41, 0xffff0000, v12
    v_cvt_pk_bf16_f32 v12, v42, v43
    v_lshlrev_b32 v42, 16, v12
    v_and_b32 v43, 0xffff0000, v12
    v_cvt_pk_bf16_f32 v12, v44, v45
    v_lshlrev_b32 v44, 16, v12
    v_and_b32 v45, 0xffff0000, v12
    v_cvt_pk_bf16_f32 v12, v46, v47
    v_lshlrev_b32 v46, 16, v12
    v_and_b32 v47, 0xffff0000, v12
    v_lshlrev_b32 v48, 16, v76
    v_and_b32 v49, 0xffff0000, v76
    v_lshlrev_b32 v50, 16, v77
    v_and_b32 v51, 0xffff0000, v77
    v_lshlrev_b32 v52, 16, v78
    v_and_b32 v53, 0xffff0000, v78
    v_lshlrev_b32 v54, 16, v79
    v_and_b32 v55, 0xffff0000, v79
    v_pk_add_f32 v[40:41], v[40:41], v[48:49]
    v_pk_add_f32 v[42:43], v[42:43], v[50:51]
    v_pk_add_f32 v[44:45], v[44:45], v[52:53]
    v_pk_add_f32 v[46:47], v[46:47], v[54:55]
    v_cvt_pk_bf16_f32 v12, v40, v41
    v_lshlrev_b32 v40, 16, v12
    v_and_b32 v41, 0xffff0000, v12
    v_cvt_pk_bf16_f32 v12, v42, v43
    v_lshlrev_b32 v42, 16, v12
    v_and_b32 v43, 0xffff0000, v12
    v_cvt_pk_bf16_f32 v12, v44, v45
    v_lshlrev_b32 v44, 16, v12
    v_and_b32 v45, 0xffff0000, v12
    v_cvt_pk_bf16_f32 v12, v46, v47
    v_lshlrev_b32 v46, 16, v12
    v_and_b32 v47, 0xffff0000, v12
    v_lshlrev_b32 v48, 16, v92
    v_and_b32 v49, 0xffff0000, v92
    v_lshlrev_b32 v50, 16, v93
    v_and_b32 v51, 0xffff0000, v93
    v_lshlrev_b32 v52, 16, v94
    v_and_b32 v53, 0xffff0000, v94
    v_lshlrev_b32 v54, 16, v95
    v_and_b32 v55, 0xffff0000, v95
    v_pk_mul_f32 v[40:41], v[40:41], v[48:49]
    v_pk_mul_f32 v[42:43], v[42:43], v[50:51]
    v_pk_mul_f32 v[44:45], v[44:45], v[52:53]
    v_pk_mul_f32 v[46:47], v[46:47], v[54:55]
    v_cvt_pk_bf16_f32 v12, v40, v41
    v_lshlrev_b32 v40, 16, v12
    v_and_b32 v41, 0xffff0000, v12
    v_cvt_pk_bf16_f32 v12, v42, v43
    v_lshlrev_b32 v42, 16, v12
    v_and_b32 v43, 0xffff0000, v12
    v_cvt_pk_bf16_f32 v12, v44, v45
    v_lshlrev_b32 v44, 16, v12
    v_and_b32 v45, 0xffff0000, v12
    v_cvt_pk_bf16_f32 v12, v46, v47
    v_lshlrev_b32 v46, 16, v12
    v_and_b32 v47, 0xffff0000, v12
    v_pk_add_f32 v[40:41], v[40:41], v[32:33]
    v_pk_add_f32 v[42:43], v[42:43], v[34:35]
    v_pk_add_f32 v[44:45], v[44:45], v[36:37]
    v_pk_add_f32 v[46:47], v[46:47], v[38:39]
    v_cvt_pk_bf16_f32 v60, v40, v41
    v_cvt_pk_bf16_f32 v61, v42, v43
    v_cvt_pk_bf16_f32 v62, v44, v45
    v_cvt_pk_bf16_f32 v63, v46, v47
    v_lshrrev_b32 v15, 6, v7
    v_lshlrev_b32 v15, 10, v15
    v_and_b32 v11, 63, v7
    v_add_u32 v15, v15, v11
    v_lshlrev_b32 v11, 2, v7
    s_mov_b32 s26, 0xa70000
    s_mov_b32 s27, 0
fz_wp:
    buffer_load_dwordx4 v[20:23], v11, s[8:11], s26 offen sc1
    s_waitcnt vmcnt(0)
    v_cmp_eq_u32 vcc, 0, v20
    s_add_u32 s27, s27, 1
    s_cmp_ge_u32 s27, 65536
    s_cbranch_scc1 fz_wg
    s_cbranch_vccz fz_wg
    s_sleep 1
    s_branch fz_wp
fz_wg:
    v_mov_b32 v144, v20
    s_nop 1
    v_max_u32_dpp v144, v144, v144 row_ror:1 row_mask:0xf bank_mask:0xf
    s_nop 1
    v_max_u32_dpp v144, v144, v144 row_ror:2 row_mask:0xf bank_mask:0xf
    s_nop 1
    v_max_u32_dpp v144, v144, v144 row_ror:4 row_mask:0xf bank_mask:0xf
    s_nop 1
    v_max_u32_dpp v144, v144, v144 row_ror:8 row_mask:0xf bank_mask:0xf
    v_mov_b32 v145, v144
    s_nop 1
    v_permlane16_swap_b32 v144, v145
    v_max_u32 v144, v144, v145
    v_mov_b32 v145, v144
    s_nop 1
    v_permlane32_swap_b32 v144, v145
    v_max_u32 v144, v144, v145
    v_cmp_eq_u32 vcc, v144, v20
    v_lshlrev_b32 v11, 4, v16
    s_and_saveexec_b64 s[26:27], vcc
    ds_write_b128 v11, v[20:23] offset:192
    s_mov_b64 exec, s[26:27]
    s_waitcnt lgkmcnt(0)
    s_barrier
    v_and_b32 v11, 3, v0
    v_lshlrev_b32 v11, 4, v11
    ds_read_b32 v144, v11 offset:256
    s_waitcnt lgkmcnt(0)
    v_mov_b32 v145, v144
    s_nop 1
    v_max_u32_dpp v145, v145, v145 row_ror:1 row_mask:0xf bank_mask:0xf
    s_nop 1
    v_max_u32_dpp v145, v145, v145 row_ror:2 row_mask:0xf bank_mask:0xf
    v_cmp_eq_u32 vcc, v144, v145
    s_ff1_i32_b64 s26, vcc
    s_lshl_b32 s26, s26, 4
    v_mov_b32 v11, s26
    ds_read_b128 v[20:23], v11 offset:256
    s_waitcnt lgkmcnt(0)
    v_and_b32 v144, 0x7ff, v20
    v_sub_u32 v144, 2047, v144
    s_nop 0
    v_readfirstlane_b32 s101, v144
    s_lshl_b32 s62, s101, 11
    v_rcp_f32 v167, v22
    s_cmp_lg_u32 s101, s16
    s_cselect_b32 s23, s17, 0x7ffffff0
    s_lshl_b32 s24, s98, 10
    s_add_u32 s24, s62, s24
    s_lshr_b32 s25, s101, 4
    s_lshl_b32 s25, s25, 15
    s_and_b32 s27, s101, 15
    s_lshl_b32 s27, s27, 6
    s_add_u32 s25, s25, s27
    s_add_u32 s25, s25, 0x2000000
    s_lshl_b32 s26, s98, 14
    s_add_u32 s25, s25, s26
    s_add_u32 s26, s25, 0x0
    buffer_load_dword v40, v15, s[8:11], s26 offen sc1
    s_add_u32 s26, s25, 0x400000
    buffer_load_dword v41, v15, s[8:11], s26 offen sc1
    s_add_u32 s26, s25, 0x800000
    buffer_load_dword v42, v15, s[8:11], s26 offen sc1
    s_add_u32 s26, s25, 0xc00000
    buffer_load_dword v43, v15, s[8:11], s26 offen sc1
    buffer_load_dword v166, v7, s[28:31], s24 offen
    s_waitcnt vmcnt(4)
    v_lshlrev_b32 v144, 16, v40
    v_and_b32 v145, 0xffff0000, v40
    s_waitcnt vmcnt(3)
    v_lshlrev_b32 v146, 16, v41
    v_and_b32 v147, 0xffff0000, v41
    v_pk_add_f32 v[128:129], v[144:145], v[146:147]
    s_waitcnt vmcnt(2)
    v_lshlrev_b32 v144, 16, v42
    v_and_b32 v145, 0xffff0000, v42
    v_pk_add_f32 v[128:129], v[144:145], v[128:129]
    s_waitcnt vmcnt(1)
    v_lshlrev_b32 v144, 16, v43
    v_and_b32 v145, 0xffff0000, v43
    v_pk_add_f32 v[128:129], v[144:145], v[128:129]
    s_waitcnt vmcnt(0)
    v_lshlrev_b32 v144, 16, v166
    v_and_b32 v145, 0xffff0000, v166
    v_pk_add_f32 v[128:129], v[144:145], v[128:129]
    v_cvt_pk_bf16_f32 v144, v128, v129
    v_lshlrev_b32 v128, 16, v144
    v_and_b32 v129, 0xffff0000, v144
    v_sub_f32 v128, v128, v21
    v_sub_f32 v129, v129, v21
    v_cvt_pk_bf16_f32 v144, v128, v129
    v_lshlrev_b32 v128, 16, v144
    v_and_b32 v129, 0xffff0000, v144
    v_mul_f32 v145, v128, v167
    v_fma_f32 v128, -v145, v22, v128
    v_fma_f32 v128, v128, v167, v145
    v_mul_f32 v145, v129, v167
    v_fma_f32 v129, -v145, v22, v129
    v_fma_f32 v129, v129, v167, v145
    v_cvt_pk_bf16_f32 v144, v128, v129
    v_lshlrev_b32 v128, 16, v144
    v_and_b32 v129, 0xffff0000, v144
    v_mul_f32 v128, v128, v168
    v_mul_f32 v129, v129, v169
    v_cvt_pk_bf16_f32 v144, v128, v129
    v_lshlrev_b32 v128, 16, v144
    v_and_b32 v129, 0xffff0000, v144
    v_add_f32 v128, v128, v170
    v_add_f32 v129, v129, v171
    v_cvt_pk_bf16_f32 v144, v128, v129
    v_lshlrev_b32 v128, 16, v144
    v_and_b32 v129, 0xffff0000, v144
    v_lshlrev_b32 v11, 1, v7
    ds_write_b64 v11, v[128:129] offset:512
    v_lshlrev_b32 v11, 6, v13
    s_waitcnt lgkmcnt(0)
    ds_read_b128 v[128:131], v11 offset:512
    ds_read_b128 v[132:135], v11 offset:528
    ds_read_b128 v[136:139], v11 offset:544
    ds_read_b128 v[140:143], v11 offset:560
    s_lshl_b32 s26, s97, 1
    s_add_u32 s26, s26, s98
    s_mul_i32 s26, s26, 14336
    s_lshl_b32 s25, s96, 8
    s_add_u32 s26, s26, s25
    s_add_u32 s26, s26, 0xa10000
    s_cmp_lt_u32 s2, 224
    s_cselect_b32 s26, s26, 0x7ffffff0
    s_cmp_eq_u32 s3, 4
    s_cselect_b32 s26, s26, 0x7ffffff0
    s_mov_b32 s25, s26
    s_waitcnt lgkmcnt(3)
    v_lshrrev_b32 v144, 16, v128
    v_dot2_f32_bf16 v157, v204, v128, 0
    v_dot2_f32_bf16 v156, v204, v144, 0
    v_dot2_f32_bf16 v159, v205, v128, 0
    v_dot2_f32_bf16 v158, v205, v144, 0
    v_dot2_f32_bf16 v161, v206, v128, 0
    v_dot2_f32_bf16 v160, v206, v144, 0
    v_dot2_f32_bf16 v163, v207, v128, 0
    v_dot2_f32_bf16 v162, v207, v144, 0
    v_lshrrev_b32 v145, 16, v129
    v_dot2c_f32_bf16 v157, v208, v129
    v_dot2c_f32_bf16 v156, v208, v145
    v_dot2c_f32_bf16 v159, v209, v129
    v_dot2c_f32_bf16 v158, v209, v145
    v_dot2c_f32_bf16 v161, v210, v129
    v_dot2c_f32_bf16 v160, v210, v145
    v_dot2c_f32_bf16 v163, v211, v129
    v_dot2c_f32_bf16 v162, v211, v145
    v_lshrrev_b32 v146, 16, v130
    v_dot2c_f32_bf16 v157, v212, v130
    v_dot2c_f32_bf16 v156, v212, v146
    v_dot2c_f32_bf16 v159, v213, v130
    v_dot2c_f32_bf16 v158, v213, v146
    v_dot2c_f32_bf16 v161, v214, v130
    v_dot2c_f32_bf16 v160, v214, v146
    v_dot2c_f32_bf16 v163, v215, v130
    v_dot2c_f32_bf16 v162, v215, v146
    v_lshrrev_b32 v147, 16, v131
    v_dot2c_f32_bf16 v157, v216, v131
    v_dot2c_f32_bf16 v156, v216, v147
    v_dot2c_f32_bf16 v159, v217, v131
    v_dot2c_f32_bf16 v158, v217, v147
    v_dot2c_f32_bf16 v161, v218, v131
    v_dot2c_f32_bf16 v160, v218, v147
    v_dot2c_f32_bf16 v163, v219, v131
    v_dot2c_f32_bf16 v162, v219, v147
    s_waitcnt lgkmcnt(2)
    v_lshrrev_b32 v148, 16, v132
    v_dot2c_f32_bf16 v157, v220, v132
    v_dot2c_f32_bf16 v156, v220, v148
    v_dot2c_f32_bf16 v159, v221, v132
    v_dot2c_f32_bf16 v158, v221, v148
    v_dot2c_f32_bf16 v161, v222, v132
    v_dot2c_f32_bf16 v160, v222, v148
    v_dot2c_f32_bf16 v163, v223, v132
    v_dot2c_f32_bf16 v162, v223, v148
    v_lshrrev_b32 v149, 16, v133
    v_dot2c_f32_bf16 v157, v224, v133
    v_dot2c_f32_bf16 v156, v224, v149
    v_dot2c_f32_bf16 v159, v225, v133
    v_dot2c_f32_bf16 v158, v225, v149
    v_dot2c_f32_bf16 v161, v226, v133
    v_dot2c_f32_bf16 v160, v226, v149
    v_dot2c_f32_bf16 v163, v227, v133
    v_dot2c_f32_bf16 v162, v227, v149
    v_lshrrev_b32 v150, 16, v134
    v_dot2c_f32_bf16 v157, v228, v134
    v_dot2c_f32_bf16 v156, v228, v150
    v_dot2c_f32_bf16 v159, v229, v134
    v_dot2c_f32_bf16 v158, v229, v150
    v_dot2c_f32_bf16 v161, v230, v134
    v_dot2c_f32_bf16 v160, v230, v150
    v_dot2c_f32_bf16 v163, v231, v134
    v_dot2c_f32_bf16 v162, v231, v150
    v_lshrrev_b32 v151, 16, v135
    v_dot2c_f32_bf16 v157, v232, v135
    v_dot2c_f32_bf16 v156, v232, v151
    v_dot2c_f32_bf16 v159, v233, v135
    v_dot2c_f32_bf16 v158, v233, v151
    v_dot2c_f32_bf16 v161, v234, v135
    v_dot2c_f32_bf16 v160, v234, v151
    v_dot2c_f32_bf16 v163, v235, v135
    v_dot2c_f32_bf16 v162, v235, v151
    s_waitcnt lgkmcnt(1)
    v_lshrrev_b32 v144, 16, v136
    v_dot2c_f32_bf16 v157, v236, v136
    v_dot2c_f32_bf16 v156, v236, v144
    v_dot2c_f32_bf16 v159, v237, v136
    v_dot2c_f32_bf16 v158, v237, v144
    v_dot2c_f32_bf16 v161, v238, v136
    v_dot2c_f32_bf16 v160, v238, v144
    v_dot2c_f32_bf16 v163, v239, v136
    v_dot2c_f32_bf16 v162, v239, v144
    v_lshrrev_b32 v145, 16, v137
    v_dot2c_f32_bf16 v157, v240, v137
    v_dot2c_f32_bf16 v156, v240, v145
    v_dot2c_f32_bf16 v159, v241, v137
    v_dot2c_f32_bf16 v158, v241, v145
    v_dot2c_f32_bf16 v161, v242, v137
    v_dot2c_f32_bf16 v160, v242, v145
    v_dot2c_f32_bf16 v163, v243, v137
    v_dot2c_f32_bf16 v162, v243, v145
    v_lshrrev_b32 v146, 16, v138
    v_dot2c_f32_bf16 v157, v244, v138
    v_dot2c_f32_bf16 v156, v244, v146
    v_dot2c_f32_bf16 v159, v245, v138
    v_dot2c_f32_bf16 v158, v245, v146
    v_dot2c_f32_bf16 v161, v246, v138
    v_dot2c_f32_bf16 v160, v246, v146
    v_dot2c_f32_bf16 v163, v247, v138
    v_dot2c_f32_bf16 v162, v247, v146
    v_lshrrev_b32 v147, 16, v139
    v_dot2c_f32_bf16 v157, v248, v139
    v_dot2c_f32_bf16 v156, v248, v147
    v_dot2c_f32_bf16 v159, v249, v139
    v_dot2c_f32_bf16 v158, v249, v147
    v_dot2c_f32_bf16 v161, v250, v139
    v_dot2c_f32_bf16 v160, v250, v147
    v_dot2c_f32_bf16 v163, v251, v139
    v_dot2c_f32_bf16 v162, v251, v147
    s_waitcnt lgkmcnt(0)
    v_lshrrev_b32 v148, 16, v140
    v_dot2c_f32_bf16 v157, v252, v140
    v_dot2c_f32_bf16 v156, v252, v148
    v_dot2c_f32_bf16 v159, v253, v140
    v_dot2c_f32_bf16 v158, v253, v148
    v_dot2c_f32_bf16 v161, v254, v140
    v_dot2c_f32_bf16 v160, v254, v148
    v_dot2c_f32_bf16 v163, v255, v140
    v_dot2c_f32_bf16 v162, v255, v148
    v_lshrrev_b32 v149, 16, v141
    v_dot2c_f32_bf16 v157, v180, v141
    v_dot2c_f32_bf16 v156, v180, v149
    v_dot2c_f32_bf16 v159, v181, v141
    v_dot2c_f32_bf16 v158, v181, v149
    v_dot2c_f32_bf16 v161, v182, v141
    v_dot2c_f32_bf16 v160, v182, v149
    v_dot2c_f32_bf16 v163, v183, v141
    v_dot2c_f32_bf16 v162, v183, v149
    v_lshrrev_b32 v150, 16, v142
    v_dot2c_f32_bf16 v157, v184, v142
    v_dot2c_f32_bf16 v156, v184, v150
    v_dot2c_f32_bf16 v159, v185, v142
    v_dot2c_f32_bf16 v158, v185, v150
    v_dot2c_f32_bf16 v161, v186, v142
    v_dot2c_f32_bf16 v160, v186, v150
    v_dot2c_f32_bf16 v163, v187, v142
    v_dot2c_f32_bf16 v162, v187, v150
    v_lshrrev_b32 v151, 16, v143
    v_dot2c_f32_bf16 v157, v172, v143
    v_dot2c_f32_bf16 v156, v172, v151
    v_dot2c_f32_bf16 v159, v173, v143
    v_dot2c_f32_bf16 v158, v173, v151
    v_dot2c_f32_bf16 v161, v174, v143
    v_dot2c_f32_bf16 v160, v174, v151
    v_dot2c_f32_bf16 v163, v175, v143
    v_dot2c_f32_bf16 v162, v175, v151
    s_nop 0
    v_permlane32_swap_b32 v156, v160
    v_permlane32_swap_b32 v157, v161
    v_permlane32_swap_b32 v158, v162
    v_permlane32_swap_b32 v159, v163
    v_add_f32 v156, v156, v160
    v_add_f32 v157, v157, v161
    v_add_f32 v158, v158, v162
    v_add_f32 v159, v159, v163
    s_nop 0
    v_permlane16_swap_b32 v156, v158
    v_permlane16_swap_b32 v157, v159
    v_add_f32 v156, v156, v158
    v_add_f32 v157, v157, v159
    s_nop 0
    v_add_f32_dpp v156, v156, v156 row_ror:8 row_mask:0xf bank_mask:0xf
    v_add_f32_dpp v157, v157, v157 row_ror:8 row_mask:0xf bank_mask:0xf
    ds_write_b64 v2, v[156:157] offset:4096
    s_waitcnt lgkmcnt(0)
    s_barrier
    ds_read_b32 v156, v4 offset:4096
    ds_read_b32 v157, v4 offset:4352
    ds_read_b32 v158, v4 offset:4608
    ds_read_b32 v159, v4 offset:4864
    s_waitcnt lgkmcnt(1)
    v_add_f32 v156, v156, v158
    s_waitcnt lgkmcnt(0)
    v_add_f32 v157, v157, v159
    v_add_f32 v156, v156, v157
    v_or_b32 v156, 1, v156
    buffer_store_dword v156, v4, s[8:11], s25 offen sc1
    s_cmp_lg_u32 s101, s16
    s_cselect_b32 s23, s17, 0x7ffffff0
    buffer_store_dwordx4 v[56:59], v1, s[64:67], s23 offen offset:0 sc1
    buffer_store_dwordx4 v[60:63], v1, s[64:67], s23 offen offset:1024 sc1
    s_branch fz_end
fz_dn:
    v_sub_f32 v40, v24, v192
    v_sub_f32 v41, v25, v192
    v_sub_f32 v42, v26, v192
    v_sub_f32 v43, v27, v192
    v_sub_f32 v44, v28, v192
    v_sub_f32 v45, v29, v192
    v_sub_f32 v46, v30, v192
    v_sub_f32 v47, v31, v192
    v_cvt_pk_bf16_f32 v12, v40, v41
    v_lshlrev_b32 v40, 16, v12
    v_and_b32 v41, 0xffff0000, v12
    v_cvt_pk_bf16_f32 v12, v42, v43
    v_lshlrev_b32 v42, 16, v12
    v_and_b32 v43, 0xffff0000, v12
    v_cvt_pk_bf16_f32 v12, v44, v45
    v_lshlrev_b32 v44, 16, v12
    v_and_b32 v45, 0xffff0000, v12
    v_cvt_pk_bf16_f32 v12, v46, v47
    v_lshlrev_b32 v46, 16, v12
    v_and_b32 v47, 0xffff0000, v12
    v_mul_f32 v40, v40, v195
    v_mul_f32 v41, v41, v195
    v_mul_f32 v42, v42, v195
    v_mul_f32 v43, v43, v195
    v_mul_f32 v44, v44, v195
    v_mul_f32 v45, v45, v195
    v_mul_f32 v46, v46, v195
    v_mul_f32 v47, v47, v195
    v_cvt_pk_bf16_f32 v12, v40, v41
    v_lshlrev_b32 v40, 16, v12
    v_and_b32 v41, 0xffff0000, v12
    v_cvt_pk_bf16_f32 v12, v42, v43
    v_lshlrev_b32 v42, 16, v12
    v_and_b32 v43, 0xffff0000, v12
    v_cvt_pk_bf16_f32 v12, v44, v45
    v_lshlrev_b32 v44, 16, v12
    v_and_b32 v45, 0xffff0000, v12
    v_cvt_pk_bf16_f32 v12, v46, v47
    v_lshlrev_b32 v46, 16, v12
    v_and_b32 v47, 0xffff0000, v12
    v_lshlrev_b32 v48, 16, v80
    v_and_b32 v49, 0xffff0000, v80
    v_lshlrev_b32 v50, 16, v81
    v_and_b32 v51, 0xffff0000, v81
    v_lshlrev_b32 v52, 16, v82
    v_and_b32 v53, 0xffff0000, v82
    v_lshlrev_b32 v54, 16, v83
    v_and_b32 v55, 0xffff0000, v83
    v_pk_mul_f32 v[40:41], v[40:41], v[48:49]
    v_pk_mul_f32 v[42:43], v[42:43], v[50:51]
    v_pk_mul_f32 v[44:45], v[44:45], v[52:53]
    v_pk_mul_f32 v[46:47], v[46:47], v[54:55]
    v_cvt_pk_bf16_f32 v12, v40, v41
    v_lshlrev_b32 v40, 16, v12
    v_and_b32 v41, 0xffff0000, v12
    v_cvt_pk_bf16_f32 v12, v42, v43
    v_lshlrev_b32 v42, 16, v12
    v_and_b32 v43, 0xffff0000, v12
    v_cvt_pk_bf16_f32 v12, v44, v45
    v_lshlrev_b32 v44, 16, v12
    v_and_b32 v45, 0xffff0000, v12
    v_cvt_pk_bf16_f32 v12, v46, v47
    v_lshlrev_b32 v46, 16, v12
    v_and_b32 v47, 0xffff0000, v12
    v_lshlrev_b32 v48, 16, v72
    v_and_b32 v49, 0xffff0000, v72
    v_lshlrev_b32 v50, 16, v73
    v_and_b32 v51, 0xffff0000, v73
    v_lshlrev_b32 v52, 16, v74
    v_and_b32 v53, 0xffff0000, v74
    v_lshlrev_b32 v54, 16, v75
    v_and_b32 v55, 0xffff0000, v75
    v_pk_add_f32 v[40:41], v[40:41], v[48:49]
    v_pk_add_f32 v[42:43], v[42:43], v[50:51]
    v_pk_add_f32 v[44:45], v[44:45], v[52:53]
    v_pk_add_f32 v[46:47], v[46:47], v[54:55]
    v_cvt_pk_bf16_f32 v12, v40, v41
    v_lshlrev_b32 v40, 16, v12
    v_and_b32 v41, 0xffff0000, v12
    v_cvt_pk_bf16_f32 v12, v42, v43
    v_lshlrev_b32 v42, 16, v12
    v_and_b32 v43, 0xffff0000, v12
    v_cvt_pk_bf16_f32 v12, v44, v45
    v_lshlrev_b32 v44, 16, v12
    v_and_b32 v45, 0xffff0000, v12
    v_cvt_pk_bf16_f32 v12, v46, v47
    v_lshlrev_b32 v46, 16, v12
    v_and_b32 v47, 0xffff0000, v12
    v_lshlrev_b32 v48, 16, v88
    v_and_b32 v49, 0xffff0000, v88
    v_lshlrev_b32 v50, 16, v89
    v_and_b32 v51, 0xffff0000, v89
    v_lshlrev_b32 v52, 16, v90
    v_and_b32 v53, 0xffff0000, v90
    v_lshlrev_b32 v54, 16, v91
    v_and_b32 v55, 0xffff0000, v91
    v_pk_mul_f32 v[40:41], v[40:41], v[48:49]
    v_pk_mul_f32 v[42:43], v[42:43], v[50:51]
    v_pk_mul_f32 v[44:45], v[44:45], v[52:53]
    v_pk_mul_f32 v[46:47], v[46:47], v[54:55]
    v_cvt_pk_bf16_f32 v12, v40, v41
    v_lshlrev_b32 v40, 16, v12
    v_and_b32 v41, 0xffff0000, v12
    v_cvt_pk_bf16_f32 v12, v42, v43
    v_lshlrev_b32 v42, 16, v12
    v_and_b32 v43, 0xffff0000, v12
    v_cvt_pk_bf16_f32 v12, v44, v45
    v_lshlrev_b32 v44, 16, v12
    v_and_b32 v45, 0xffff0000, v12
    v_cvt_pk_bf16_f32 v12, v46, v47
    v_lshlrev_b32 v46, 16, v12
    v_and_b32 v47, 0xffff0000, v12
    v_pk_add_f32 v[40:41], v[40:41], v[24:25]
    v_pk_add_f32 v[42:43], v[42:43], v[26:27]
    v_pk_add_f32 v[44:45], v[44:45], v[28:29]
    v_pk_add_f32 v[46:47], v[46:47], v[30:31]
    v_cvt_pk_bf16_f32 v56, v40, v41
    v_cvt_pk_bf16_f32 v57, v42, v43
    v_cvt_pk_bf16_f32 v58, v44, v45
    v_cvt_pk_bf16_f32 v59, v46, v47
    v_sub_f32 v40, v32, v192
    v_sub_f32 v41, v33, v192
    v_sub_f32 v42, v34, v192
    v_sub_f32 v43, v35, v192
    v_sub_f32 v44, v36, v192
    v_sub_f32 v45, v37, v192
    v_sub_f32 v46, v38, v192
    v_sub_f32 v47, v39, v192
    v_cvt_pk_bf16_f32 v12, v40, v41
    v_lshlrev_b32 v40, 16, v12
    v_and_b32 v41, 0xffff0000, v12
    v_cvt_pk_bf16_f32 v12, v42, v43
    v_lshlrev_b32 v42, 16, v12
    v_and_b32 v43, 0xffff0000, v12
    v_cvt_pk_bf16_f32 v12, v44, v45
    v_lshlrev_b32 v44, 16, v12
    v_and_b32 v45, 0xffff0000, v12
    v_cvt_pk_bf16_f32 v12, v46, v47
    v_lshlrev_b32 v46, 16, v12
    v_and_b32 v47, 0xffff0000, v12
    v_mul_f32 v40, v40, v195
    v_mul_f32 v41, v41, v195
    v_mul_f32 v42, v42, v195
    v_mul_f32 v43, v43, v195
    v_mul_f32 v44, v44, v195
    v_mul_f32 v45, v45, v195
    v_mul_f32 v46, v46, v195
    v_mul_f32 v47, v47, v195
    v_cvt_pk_bf16_f32 v12, v40, v41
    v_lshlrev_b32 v40, 16, v12
    v_and_b32 v41, 0xffff0000, v12
    v_cvt_pk_bf16_f32 v12, v42, v43
    v_lshlrev_b32 v42, 16, v12
    v_and_b32 v43, 0xffff0000, v12
    v_cvt_pk_bf16_f32 v12, v44, v45
    v_lshlrev_b32 v44, 16, v12
    v_and_b32 v45, 0xffff0000, v12
    v_cvt_pk_bf16_f32 v12, v46, v47
    v_lshlrev_b32 v46, 16, v12
    v_and_b32 v47, 0xffff0000, v12
    v_lshlrev_b32 v48, 16, v84
    v_and_b32 v49, 0xffff0000, v84
    v_lshlrev_b32 v50, 16, v85
    v_and_b32 v51, 0xffff0000, v85
    v_lshlrev_b32 v52, 16, v86
    v_and_b32 v53, 0xffff0000, v86
    v_lshlrev_b32 v54, 16, v87
    v_and_b32 v55, 0xffff0000, v87
    v_pk_mul_f32 v[40:41], v[40:41], v[48:49]
    v_pk_mul_f32 v[42:43], v[42:43], v[50:51]
    v_pk_mul_f32 v[44:45], v[44:45], v[52:53]
    v_pk_mul_f32 v[46:47], v[46:47], v[54:55]
    v_cvt_pk_bf16_f32 v12, v40, v41
    v_lshlrev_b32 v40, 16, v12
    v_and_b32 v41, 0xffff0000, v12
    v_cvt_pk_bf16_f32 v12, v42, v43
    v_lshlrev_b32 v42, 16, v12
    v_and_b32 v43, 0xffff0000, v12
    v_cvt_pk_bf16_f32 v12, v44, v45
    v_lshlrev_b32 v44, 16, v12
    v_and_b32 v45, 0xffff0000, v12
    v_cvt_pk_bf16_f32 v12, v46, v47
    v_lshlrev_b32 v46, 16, v12
    v_and_b32 v47, 0xffff0000, v12
    v_lshlrev_b32 v48, 16, v76
    v_and_b32 v49, 0xffff0000, v76
    v_lshlrev_b32 v50, 16, v77
    v_and_b32 v51, 0xffff0000, v77
    v_lshlrev_b32 v52, 16, v78
    v_and_b32 v53, 0xffff0000, v78
    v_lshlrev_b32 v54, 16, v79
    v_and_b32 v55, 0xffff0000, v79
    v_pk_add_f32 v[40:41], v[40:41], v[48:49]
    v_pk_add_f32 v[42:43], v[42:43], v[50:51]
    v_pk_add_f32 v[44:45], v[44:45], v[52:53]
    v_pk_add_f32 v[46:47], v[46:47], v[54:55]
    v_cvt_pk_bf16_f32 v12, v40, v41
    v_lshlrev_b32 v40, 16, v12
    v_and_b32 v41, 0xffff0000, v12
    v_cvt_pk_bf16_f32 v12, v42, v43
    v_lshlrev_b32 v42, 16, v12
    v_and_b32 v43, 0xffff0000, v12
    v_cvt_pk_bf16_f32 v12, v44, v45
    v_lshlrev_b32 v44, 16, v12
    v_and_b32 v45, 0xffff0000, v12
    v_cvt_pk_bf16_f32 v12, v46, v47
    v_lshlrev_b32 v46, 16, v12
    v_and_b32 v47, 0xffff0000, v12
    v_lshlrev_b32 v48, 16, v92
    v_and_b32 v49, 0xffff0000, v92
    v_lshlrev_b32 v50, 16, v93
    v_and_b32 v51, 0xffff0000, v93
    v_lshlrev_b32 v52, 16, v94
    v_and_b32 v53, 0xffff0000, v94
    v_lshlrev_b32 v54, 16, v95
    v_and_b32 v55, 0xffff0000, v95
    v_pk_mul_f32 v[40:41], v[40:41], v[48:49]
    v_pk_mul_f32 v[42:43], v[42:43], v[50:51]
    v_pk_mul_f32 v[44:45], v[44:45], v[52:53]
    v_pk_mul_f32 v[46:47], v[46:47], v[54:55]
    v_cvt_pk_bf16_f32 v12, v40, v41
    v_lshlrev_b32 v40, 16, v12
    v_and_b32 v41, 0xffff0000, v12
    v_cvt_pk_bf16_f32 v12, v42, v43
    v_lshlrev_b32 v42, 16, v12
    v_and_b32 v43, 0xffff0000, v12
    v_cvt_pk_bf16_f32 v12, v44, v45
    v_lshlrev_b32 v44, 16, v12
    v_and_b32 v45, 0xffff0000, v12
    v_cvt_pk_bf16_f32 v12, v46, v47
    v_lshlrev_b32 v46, 16, v12
    v_and_b32 v47, 0xffff0000, v12
    v_pk_add_f32 v[40:41], v[40:41], v[32:33]
    v_pk_add_f32 v[42:43], v[42:43], v[34:35]
    v_pk_add_f32 v[44:45], v[44:45], v[36:37]
    v_pk_add_f32 v[46:47], v[46:47], v[38:39]
    v_cvt_pk_bf16_f32 v60, v40, v41
    v_cvt_pk_bf16_f32 v61, v42, v43
    v_cvt_pk_bf16_f32 v62, v44, v45
    v_cvt_pk_bf16_f32 v63, v46, v47
    s_barrier
    v_and_b32 v11, 3, v0
    v_lshlrev_b32 v11, 4, v11
    ds_read_b32 v144, v11 offset:256
    s_waitcnt lgkmcnt(0)
    v_mov_b32 v145, v144
    s_nop 1
    v_max_u32_dpp v145, v145, v145 row_ror:1 row_mask:0xf bank_mask:0xf
    s_nop 1
    v_max_u32_dpp v145, v145, v145 row_ror:2 row_mask:0xf bank_mask:0xf
    v_cmp_eq_u32 vcc, v144, v145
    s_ff1_i32_b64 s26, vcc
    s_lshl_b32 s26, s26, 4
    v_mov_b32 v11, s26
    ds_read_b128 v[20:23], v11 offset:256
    s_waitcnt lgkmcnt(0)
    v_and_b32 v144, 0x7ff, v20
    v_sub_u32 v144, 2047, v144
    s_nop 0
    v_readfirstlane_b32 s101, v144
    s_lshl_b32 s62, s101, 11
    v_rcp_f32 v167, v22
    s_cmp_lg_u32 s101, s16
    s_cselect_b32 s23, s17, 0x7ffffff0
    s_add_u32 s62, s62, s18
    v_lshlrev_b32 v12, 1, v0
    s_lshr_b32 s25, s101, 4
    s_lshl_b32 s25, s25, 15
    s_and_b32 s27, s101, 15
    s_lshl_b32 s27, s27, 6
    s_add_u32 s25, s25, s27
    s_add_u32 s25, s25, 0x2000000
    s_lshl_b32 s26, s99, 11
    s_add_u32 s25, s25, s26
    v_lshrrev_b32 v15, 5, v0
    v_lshlrev_b32 v15, 10, v15
    v_and_b32 v11, 63, v12
    v_add_u32 v15, v15, v11
    s_add_u32 s26, s25, 0x0
    buffer_load_ushort v40, v15, s[8:11], s26 offen sc1
    s_add_u32 s26, s25, 0x400000
    buffer_load_ushort v41, v15, s[8:11], s26 offen sc1
    s_add_u32 s26, s25, 0x800000
    buffer_load_ushort v42, v15, s[8:11], s26 offen sc1
    s_add_u32 s26, s25, 0xc00000
    buffer_load_ushort v43, v15, s[8:11], s26 offen sc1
    buffer_load_ushort v44, v12, s[28:31], s62 offen
    buffer_store_dwordx4 v[56:59], v1, s[64:67], s23 offen offset:0 sc1
    buffer_store_dwordx4 v[60:63], v1, s[64:67], s23 offen offset:1024 sc1
    v_min_u32 v7, 223, v17
    v_lshlrev_b32 v7, 2, v7
    s_mul_i32 s24, s100, 896
    s_add_u32 s24, s24, 0xa10000
    v_mul_u32_u24 v11, 28, v13
    s_barrier
    s_mov_b32 s27, 0
fz_ap:
    s_add_u32 s25, s24, 0
    buffer_load_dword v120, v7, s[8:11], s25 offen sc1
    s_add_u32 s25, s24, 14336
    buffer_load_dword v121, v7, s[8:11], s25 offen sc1
    s_add_u32 s25, s24, 28672
    buffer_load_dword v122, v7, s[8:11], s25 offen sc1
    s_add_u32 s25, s24, 43008
    buffer_load_dword v123, v7, s[8:11], s25 offen sc1
    s_waitcnt vmcnt(2)
    v_min_u32 v124, v120, v121
    s_waitcnt vmcnt(0)
    v_min3_u32 v124, v124, v122, v123
    v_cmp_eq_u32 vcc, 0, v124
    s_add_u32 s27, s27, 1
    s_cmp_ge_u32 s27, 65536
    s_cbranch_scc1 fz_ag
    s_cbranch_vccz fz_ag
    s_branch fz_ap
fz_ag:
    v_add_f32 v120, v120, v121
    v_add_f32 v122, v122, v123
    v_cvt_pk_bf16_f32 v124, v120, v122
    v_lshlrev_b32 v120, 16, v124
    v_and_b32 v122, 0xffff0000, v124
    v_mul_f32 v124, 0xbfb8aa3b, v120
    v_exp_f32 v124, v124
    s_nop 0
    v_add_f32 v124, 1.0, v124
    v_rcp_f32 v124, v124
    s_nop 0
    v_mul_f32 v120, v120, v124
    v_cvt_pk_bf16_f32 v120, v120, v120
    v_lshlrev_b32 v120, 16, v120
    v_mul_f32 v120, v120, v122
    v_cvt_pk_bf16_f32 v120, v120, v120
    v_lshlrev_b32 v120, 16, v120
    ds_write_b32 v5, v120 offset:8192
    s_waitcnt lgkmcnt(0)
    s_barrier
    ds_read_b32 v128, v11 offset:8192
    ds_read_b32 v129, v11 offset:8196
    ds_read_b32 v130, v11 offset:8200
    ds_read_b32 v131, v11 offset:8204
    ds_read_b32 v132, v11 offset:8208
    ds_read_b32 v133, v11 offset:8212
    ds_read_b32 v134, v11 offset:8216
    s_lshl_b32 s24, s99, 12
    s_add_u32 s24, s24, 0xa00000
    s_lshl_b32 s25, s100, 8
    s_add_u32 s25, s25, s24
    s_waitcnt lgkmcnt(6)
    v_lshrrev_b32 v144, 16, v128
    v_dot2_f32_bf16 v157, v204, v128, 0
    v_dot2_f32_bf16 v156, v204, v144, 0
    v_dot2_f32_bf16 v159, v205, v128, 0
    v_dot2_f32_bf16 v158, v205, v144, 0
    v_dot2_f32_bf16 v161, v206, v128, 0
    v_dot2_f32_bf16 v160, v206, v144, 0
    v_dot2_f32_bf16 v163, v207, v128, 0
    v_dot2_f32_bf16 v162, v207, v144, 0
    s_waitcnt lgkmcnt(5)
    v_lshrrev_b32 v145, 16, v129
    v_dot2c_f32_bf16 v157, v208, v129
    v_dot2c_f32_bf16 v156, v208, v145
    v_dot2c_f32_bf16 v159, v209, v129
    v_dot2c_f32_bf16 v158, v209, v145
    v_dot2c_f32_bf16 v161, v210, v129
    v_dot2c_f32_bf16 v160, v210, v145
    v_dot2c_f32_bf16 v163, v211, v129
    v_dot2c_f32_bf16 v162, v211, v145
    s_waitcnt lgkmcnt(4)
    v_lshrrev_b32 v146, 16, v130
    v_dot2c_f32_bf16 v157, v212, v130
    v_dot2c_f32_bf16 v156, v212, v146
    v_dot2c_f32_bf16 v159, v213, v130
    v_dot2c_f32_bf16 v158, v213, v146
    v_dot2c_f32_bf16 v161, v214, v130
    v_dot2c_f32_bf16 v160, v214, v146
    v_dot2c_f32_bf16 v163, v215, v130
    v_dot2c_f32_bf16 v162, v215, v146
    s_waitcnt lgkmcnt(3)
    v_lshrrev_b32 v147, 16, v131
    v_dot2c_f32_bf16 v157, v216, v131
    v_dot2c_f32_bf16 v156, v216, v147
    v_dot2c_f32_bf16 v159, v217, v131
    v_dot2c_f32_bf16 v158, v217, v147
    v_dot2c_f32_bf16 v161, v218, v131
    v_dot2c_f32_bf16 v160, v218, v147
    v_dot2c_f32_bf16 v163, v219, v131
    v_dot2c_f32_bf16 v162, v219, v147
    s_waitcnt lgkmcnt(2)
    v_lshrrev_b32 v148, 16, v132
    v_dot2c_f32_bf16 v157, v220, v132
    v_dot2c_f32_bf16 v156, v220, v148
    v_dot2c_f32_bf16 v159, v221, v132
    v_dot2c_f32_bf16 v158, v221, v148
    v_dot2c_f32_bf16 v161, v222, v132
    v_dot2c_f32_bf16 v160, v222, v148
    v_dot2c_f32_bf16 v163, v223, v132
    v_dot2c_f32_bf16 v162, v223, v148
    s_waitcnt lgkmcnt(1)
    v_lshrrev_b32 v149, 16, v133
    v_dot2c_f32_bf16 v157, v224, v133
    v_dot2c_f32_bf16 v156, v224, v149
    v_dot2c_f32_bf16 v159, v225, v133
    v_dot2c_f32_bf16 v158, v225, v149
    v_dot2c_f32_bf16 v161, v226, v133
    v_dot2c_f32_bf16 v160, v226, v149
    v_dot2c_f32_bf16 v163, v227, v133
    v_dot2c_f32_bf16 v162, v227, v149
    s_waitcnt lgkmcnt(0)
    v_lshrrev_b32 v150, 16, v134
    v_dot2c_f32_bf16 v157, v228, v134
    v_dot2c_f32_bf16 v156, v228, v150
    v_dot2c_f32_bf16 v159, v229, v134
    v_dot2c_f32_bf16 v158, v229, v150
    v_dot2c_f32_bf16 v161, v230, v134
    v_dot2c_f32_bf16 v160, v230, v150
    v_dot2c_f32_bf16 v163, v231, v134
    v_dot2c_f32_bf16 v162, v231, v150
    s_nop 0
    v_permlane32_swap_b32 v156, v160
    v_permlane32_swap_b32 v157, v161
    v_permlane32_swap_b32 v158, v162
    v_permlane32_swap_b32 v159, v163
    v_add_f32 v156, v156, v160
    v_add_f32 v157, v157, v161
    v_add_f32 v158, v158, v162
    v_add_f32 v159, v159, v163
    s_nop 0
    v_permlane16_swap_b32 v156, v158
    v_permlane16_swap_b32 v157, v159
    v_add_f32 v156, v156, v158
    v_add_f32 v157, v157, v159
    s_nop 0
    v_add_f32_dpp v156, v156, v156 row_ror:8 row_mask:0xf bank_mask:0xf
    v_add_f32_dpp v157, v157, v157 row_ror:8 row_mask:0xf bank_mask:0xf
    ds_write_b64 v2, v[156:157] offset:12288
    s_waitcnt lgkmcnt(0)
    s_barrier
    ds_read_b32 v156, v4 offset:12288
    ds_read_b32 v157, v4 offset:12544
    ds_read_b32 v158, v4 offset:12800
    ds_read_b32 v159, v4 offset:13056
    s_waitcnt lgkmcnt(1)
    v_add_f32 v156, v156, v158
    s_waitcnt lgkmcnt(0)
    v_add_f32 v157, v157, v159
    v_add_f32 v156, v156, v157
    v_or_b32 v156, 1, v156
    s_cmp_lg_u32 s3, 0
    s_cbranch_scc1 fz_end
    buffer_store_dword v156, v4, s[8:11], s25 offen sc1
    s_cmp_lg_u32 s100, 15
    s_cbranch_scc1 fz_end
    v_mov_b32 v190, v23
    v_cvt_pk_bf16_f32 v190, v190, v190
    v_lshlrev_b32 v190, 16, v190
    v_mul_f32 v190, 0xbfb8aa3b, v190
    v_exp_f32 v190, v190
    s_nop 0
    v_add_f32 v190, 1.0, v190
    v_rcp_f32 v190, v190
    s_nop 0
    v_cvt_pk_bf16_f32 v190, v190, v190
    v_lshlrev_b32 v190, 16, v190
    v_lshlrev_b32 v40, 16, v40
    v_lshlrev_b32 v41, 16, v41
    v_lshlrev_b32 v42, 16, v42
    v_lshlrev_b32 v43, 16, v43
    v_lshlrev_b32 v44, 16, v44
    v_add_f32 v188, v40, v41
    v_add_f32 v188, v188, v42
    v_add_f32 v188, v188, v43
    v_add_f32 v188, v44, v188
    v_cvt_pk_bf16_f32 v188, v188, v188
    v_lshlrev_b32 v188, 16, v188
    v_mov_b32 v189, v188
    v_mov_b32 v191, v188
    v_sub_f32 v189, v189, v21
    v_sub_f32 v191, v191, v21
    v_cvt_pk_bf16_f32 v148, v189, v191
    v_lshlrev_b32 v189, 16, v148
    v_and_b32 v191, 0xffff0000, v148
    v_mul_f32 v149, v189, v167
    v_fma_f32 v189, -v149, v22, v189
    v_fma_f32 v189, v189, v167, v149
    v_mul_f32 v149, v191, v167
    v_fma_f32 v191, -v149, v22, v191
    v_fma_f32 v191, v191, v167, v149
    v_cvt_pk_bf16_f32 v148, v189, v191
    v_lshlrev_b32 v189, 16, v148
    v_and_b32 v191, 0xffff0000, v148
    v_mul_f32 v189, v189, v125
    v_mul_f32 v191, v191, v125
    v_cvt_pk_bf16_f32 v148, v189, v191
    v_lshlrev_b32 v189, 16, v148
    v_and_b32 v191, 0xffff0000, v148
    v_add_f32 v189, v189, v126
    v_add_f32 v191, v191, v126
    v_cvt_pk_bf16_f32 v189, v189, v189
    v_lshlrev_b32 v189, 16, v189
    s_mov_b32 s27, 0
fz_yp:
    buffer_load_dword v104, v4, s[8:11], s24 offen offset:0 sc1
    buffer_load_dword v105, v4, s[8:11], s24 offen offset:256 sc1
    buffer_load_dword v106, v4, s[8:11], s24 offen offset:512 sc1
    buffer_load_dword v107, v4, s[8:11], s24 offen offset:768 sc1
    buffer_load_dword v108, v4, s[8:11], s24 offen offset:1024 sc1
    buffer_load_dword v109, v4, s[8:11], s24 offen offset:1280 sc1
    buffer_load_dword v110, v4, s[8:11], s24 offen offset:1536 sc1
    buffer_load_dword v111, v4, s[8:11], s24 offen offset:1792 sc1
    buffer_load_dword v112, v4, s[8:11], s24 offen offset:2048 sc1
    buffer_load_dword v113, v4, s[8:11], s24 offen offset:2304 sc1
    buffer_load_dword v114, v4, s[8:11], s24 offen offset:2560 sc1
    buffer_load_dword v115, v4, s[8:11], s24 offen offset:2816 sc1
    buffer_load_dword v116, v4, s[8:11], s24 offen offset:3072 sc1
    buffer_load_dword v117, v4, s[8:11], s24 offen offset:3328 sc1
    buffer_load_dword v118, v4, s[8:11], s24 offen offset:3584 sc1
    s_waitcnt vmcnt(12)
    v_min3_u32 v7, v104, v105, v106
    s_waitcnt vmcnt(10)
    v_min3_u32 v7, v7, v107, v108
    s_waitcnt vmcnt(8)
    v_min3_u32 v7, v7, v109, v110
    s_waitcnt vmcnt(6)
    v_min3_u32 v7, v7, v111, v112
    s_waitcnt vmcnt(4)
    v_min3_u32 v7, v7, v113, v114
    s_waitcnt vmcnt(2)
    v_min3_u32 v7, v7, v115, v116
    s_waitcnt vmcnt(0)
    v_min3_u32 v7, v7, v117, v118
    v_cmp_eq_u32 vcc, 0, v7
    s_add_u32 s27, s27, 1
    s_cmp_ge_u32 s27, 65536
    s_cbranch_scc1 fz_yg
    s_cbranch_vccz fz_yg
    s_branch fz_yp
fz_yg:
    v_mov_b32 v119, v156
    v_add_f32 v104, v104, v112
    v_add_f32 v105, v105, v113
    v_add_f32 v106, v106, v114
    v_add_f32 v107, v107, v115
    v_add_f32 v108, v108, v116
    v_add_f32 v109, v109, v117
    v_add_f32 v110, v110, v118
    v_add_f32 v111, v111, v119
    v_add_f32 v104, v104, v108
    v_add_f32 v105, v105, v109
    v_add_f32 v106, v106, v110
    v_add_f32 v107, v107, v111
    v_add_f32 v104, v104, v106
    v_add_f32 v105, v105, v107
    v_add_f32 v104, v104, v105
    v_cvt_pk_bf16_f32 v104, v104, v104
    v_lshlrev_b32 v104, 16, v104
    v_mul_f32 v104, v104, v190
    v_cvt_pk_bf16_f32 v104, v104, v104
    v_lshlrev_b32 v104, 16, v104
    v_add_f32 v104, v104, v189
    v_cvt_pk_bf16_f32 v104, v104, v104
    v_lshlrev_b32 v104, 16, v104
    v_mul_f32 v104, v104, v127
    v_cvt_pk_bf16_f32 v104, v104, v104
    v_lshlrev_b32 v104, 16, v104
    v_add_f32 v104, v104, v188
    v_cvt_pk_bf16_f32 v104, v104, v104
    buffer_store_short v104, v12, s[64:67], s62 offen sc1
    s_cmp_lg_u32 s99, 0
    s_cbranch_scc1 fz_end
    s_mov_b32 s26, 0x570000
    v_mov_b32 v7, s14
    s_mov_b64 exec, 1
    buffer_store_dword v7, v6, s[8:11], s26 offen sc1
    s_mov_b64 exec, -1
    s_branch fz_end
fz_slow:
    s_waitcnt vmcnt(0) lgkmcnt(0)
    s_nop 15
    s_nop 3
    s_cmp_eq_u32 s15, 0x7777
    s_cbranch_scc1 fz_epi
    s_mov_b32 s15, 0x7777
    v_add_u32 v5, s18, v1
    v_mov_b32 v9, 0xff7fffff
    v_mov_b32 v10, 0xff7fffff
    s_mov_b32 s22, 0
fz_s1:
    s_add_u32 s23, s22, 4096
    buffer_load_dwordx4 v[84:87], v5, s[8:11], s22 offen offset:0 sc1
    buffer_load_dwordx4 v[88:91], v5, s[8:11], s22 offen offset:1024 sc1
    buffer_load_dwordx4 v[92:95], v5, s[8:11], s22 offen offset:2048 sc1
    buffer_load_dwordx4 v[96:99], v5, s[8:11], s22 offen offset:3072 sc1
    buffer_load_dwordx4 v[100:103], v5, s[8:11], s23 offen offset:0 sc1
    buffer_load_dwordx4 v[104:107], v5, s[8:11], s23 offen offset:1024 sc1
    buffer_load_dwordx4 v[156:159], v5, s[8:11], s23 offen offset:2048 sc1
    buffer_load_dwordx4 v[160:163], v5, s[8:11], s23 offen offset:3072 sc1
    s_waitcnt vmcnt(7)
    v_mfma_f32_16x16x32_bf16 v[140:143], v[84:87], v[108:111], 0
    v_mfma_f32_16x16x32_bf16 v[144:147], v[84:87], v[124:127], 0
    s_waitcnt vmcnt(6)
    v_mfma_f32_16x16x32_bf16 v[148:151], v[88:91], v[108:111], 0
    v_mfma_f32_16x16x32_bf16 v[152:155], v[88:91], v[124:127], 0
    s_waitcnt vmcnt(5)
    v_mfma_f32_16x16x32_bf16 v[140:143], v[92:95], v[112:115], v[140:143]
    v_mfma_f32_16x16x32_bf16 v[144:147], v[92:95], v[128:131], v[144:147]
    s_waitcnt vmcnt(4)
    v_mfma_f32_16x16x32_bf16 v[148:151], v[96:99], v[112:115], v[148:151]
    v_mfma_f32_16x16x32_bf16 v[152:155], v[96:99], v[128:131], v[152:155]
    s_waitcnt vmcnt(3)
    v_mfma_f32_16x16x32_bf16 v[140:143], v[100:103], v[116:119], v[140:143]
    v_mfma_f32_16x16x32_bf16 v[144:147], v[100:103], v[132:135], v[144:147]
    s_waitcnt vmcnt(2)
    v_mfma_f32_16x16x32_bf16 v[148:151], v[104:107], v[116:119], v[148:151]
    v_mfma_f32_16x16x32_bf16 v[152:155], v[104:107], v[132:135], v[152:155]
    s_waitcnt vmcnt(1)
    v_mfma_f32_16x16x32_bf16 v[140:143], v[156:159], v[120:123], v[140:143]
    v_mfma_f32_16x16x32_bf16 v[144:147], v[156:159], v[136:139], v[144:147]
    s_waitcnt vmcnt(0)
    v_mfma_f32_16x16x32_bf16 v[148:151], v[160:163], v[120:123], v[148:151]
    v_mfma_f32_16x16x32_bf16 v[152:155], v[160:163], v[136:139], v[152:155]
    s_nop 3
    v_max3_f32 v9, v9, v140, v141
    v_max3_f32 v9, v9, v142, v143
    v_max3_f32 v10, v10, v144, v145
    v_max3_f32 v10, v10, v146, v147
    v_max3_f32 v9, v9, v148, v149
    v_max3_f32 v9, v9, v150, v151
    v_max3_f32 v10, v10, v152, v153
    v_max3_f32 v10, v10, v154, v155
    s_add_u32 s22, s22, 16384
    s_cmp_lt_u32 s22, 0x40000
    s_cbranch_scc1 fz_s1
    v_mov_b32 v11, v9
    v_mov_b32 v12, v10
    s_nop 0
    v_permlane16_swap_b32 v9, v11
    v_permlane16_swap_b32 v10, v12
    v_max_f32 v9, v9, v11
    v_max_f32 v10, v10, v12
    v_mov_b32 v11, v9
    v_mov_b32 v12, v10
    s_nop 0
    v_permlane32_swap_b32 v9, v11
    v_permlane32_swap_b32 v10, v12
    v_max_f32 v9, v9, v11
    v_max_f32 v10, v10, v12
    v_sub_f32 v172, 0, v9
    v_sub_f32 v173, 0, v9
    v_sub_f32 v174, 0, v9
    v_sub_f32 v175, 0, v9
    v_sub_f32 v176, 0, v10
    v_sub_f32 v177, 0, v10
    v_sub_f32 v178, 0, v10
    v_sub_f32 v179, 0, v10
    v_mov_b32 v20, 0
    v_mov_b32 v21, 0
    v_mov_b32 v22, 0
    v_mov_b32 v23, 0
    v_mov_b32 v24, 0
    v_mov_b32 v25, 0
    v_mov_b32 v26, 0
    v_mov_b32 v27, 0
    v_mov_b32 v28, 0
    v_mov_b32 v29, 0
    v_mov_b32 v30, 0
    v_mov_b32 v31, 0
    v_mov_b32 v32, 0
    v_mov_b32 v33, 0
    v_mov_b32 v34, 0
    v_mov_b32 v35, 0
    v_mov_b32 v36, 0
    v_mov_b32 v37, 0
    v_mov_b32 v38, 0
    v_mov_b32 v39, 0
    v_mov_b32 v40, 0
    v_mov_b32 v41, 0
    v_mov_b32 v42, 0
    v_mov_b32 v43, 0
    v_mov_b32 v44, 0
    v_mov_b32 v45, 0
    v_mov_b32 v46, 0
    v_mov_b32 v47, 0
    v_mov_b32 v48, 0
    v_mov_b32 v49, 0
    v_mov_b32 v50, 0
    v_mov_b32 v51, 0
    v_mov_b32 v52, 0
    v_mov_b32 v53, 0
    v_mov_b32 v54, 0
    v_mov_b32 v55, 0
    v_mov_b32 v56, 0
    v_mov_b32 v57, 0
    v_mov_b32 v58, 0
    v_mov_b32 v59, 0
    v_mov_b32 v60, 0
    v_mov_b32 v61, 0
    v_mov_b32 v62, 0
    v_mov_b32 v63, 0
    v_mov_b32 v64, 0
    v_mov_b32 v65, 0
    v_mov_b32 v66, 0
    v_mov_b32 v67, 0
    v_mov_b32 v68, 0
    v_mov_b32 v69, 0
    v_mov_b32 v70, 0
    v_mov_b32 v71, 0
    v_mov_b32 v72, 0
    v_mov_b32 v73, 0
    v_mov_b32 v74, 0
    v_mov_b32 v75, 0
    v_mov_b32 v76, 0
    v_mov_b32 v77, 0
    v_mov_b32 v78, 0
    v_mov_b32 v79, 0
    v_mov_b32 v80, 0
    v_mov_b32 v81, 0
    v_mov_b32 v82, 0
    v_mov_b32 v83, 0
    v_mov_b32 v15, 0
    v_mov_b32 v16, 0
    s_mov_b32 s22, 0
fz_s2:
    s_add_u32 s23, s22, 4096
    buffer_load_dwordx4 v[84:87], v5, s[8:11], s22 offen offset:0 sc1
    buffer_load_dwordx4 v[88:91], v5, s[8:11], s22 offen offset:1024 sc1
    buffer_load_dwordx4 v[92:95], v5, s[8:11], s22 offen offset:2048 sc1
    buffer_load_dwordx4 v[96:99], v5, s[8:11], s22 offen offset:3072 sc1
    buffer_load_dwordx4 v[100:103], v5, s[8:11], s23 offen offset:0 sc1
    buffer_load_dwordx4 v[104:107], v5, s[8:11], s23 offen offset:1024 sc1
    buffer_load_dwordx4 v[156:159], v5, s[8:11], s23 offen offset:2048 sc1
    buffer_load_dwordx4 v[160:163], v5, s[8:11], s23 offen offset:3072 sc1
    s_waitcnt vmcnt(7)
    v_mfma_f32_16x16x32_bf16 v[140:143], v[84:87], v[108:111], v[172:175]
    v_mfma_f32_16x16x32_bf16 v[144:147], v[84:87], v[124:127], v[176:179]
    s_waitcnt vmcnt(6)
    v_mfma_f32_16x16x32_bf16 v[148:151], v[88:91], v[108:111], v[172:175]
    v_mfma_f32_16x16x32_bf16 v[152:155], v[88:91], v[124:127], v[176:179]
    s_waitcnt vmcnt(5)
    v_mfma_f32_16x16x32_bf16 v[140:143], v[92:95], v[112:115], v[140:143]
    v_mfma_f32_16x16x32_bf16 v[144:147], v[92:95], v[128:131], v[144:147]
    s_waitcnt vmcnt(4)
    v_mfma_f32_16x16x32_bf16 v[148:151], v[96:99], v[112:115], v[148:151]
    v_mfma_f32_16x16x32_bf16 v[152:155], v[96:99], v[128:131], v[152:155]
    s_waitcnt vmcnt(3)
    v_mfma_f32_16x16x32_bf16 v[140:143], v[100:103], v[116:119], v[140:143]
    v_mfma_f32_16x16x32_bf16 v[144:147], v[100:103], v[132:135], v[144:147]
    s_waitcnt vmcnt(2)
    v_mfma_f32_16x16x32_bf16 v[148:151], v[104:107], v[116:119], v[148:151]
    v_mfma_f32_16x16x32_bf16 v[152:155], v[104:107], v[132:135], v[152:155]
    s_waitcnt vmcnt(1)
    v_mfma_f32_16x16x32_bf16 v[140:143], v[156:159], v[120:123], v[140:143]
    v_mfma_f32_16x16x32_bf16 v[144:147], v[156:159], v[136:139], v[144:147]
    s_waitcnt vmcnt(0)
    v_mfma_f32_16x16x32_bf16 v[148:151], v[160:163], v[120:123], v[148:151]
    v_mfma_f32_16x16x32_bf16 v[152:155], v[160:163], v[136:139], v[152:155]
    s_add_u32 s26, s22, 8192
    s_add_u32 s23, s22, 12288
    buffer_load_dwordx4 v[84:87], v5, s[8:11], s26 offen offset:0 sc1
    buffer_load_dwordx4 v[88:91], v5, s[8:11], s26 offen offset:1024 sc1
    buffer_load_dwordx4 v[92:95], v5, s[8:11], s26 offen offset:2048 sc1
    buffer_load_dwordx4 v[96:99], v5, s[8:11], s26 offen offset:3072 sc1
    buffer_load_dwordx4 v[100:103], v5, s[8:11], s23 offen offset:0 sc1
    buffer_load_dwordx4 v[104:107], v5, s[8:11], s23 offen offset:1024 sc1
    buffer_load_dwordx4 v[156:159], v5, s[8:11], s23 offen offset:2048 sc1
    buffer_load_dwordx4 v[160:163], v5, s[8:11], s23 offen offset:3072 sc1
    v_exp_f32 v140, v140
    v_exp_f32 v141, v141
    v_add_f32 v15, v15, v140
    v_add_f32 v15, v15, v141
    v_cvt_pk_bf16_f32 v188, v140, v141
    v_exp_f32 v142, v142
    v_exp_f32 v143, v143
    v_add_f32 v15, v15, v142
    v_add_f32 v15, v15, v143
    v_cvt_pk_bf16_f32 v189, v142, v143
    v_exp_f32 v144, v144
    v_exp_f32 v145, v145
    v_add_f32 v16, v16, v144
    v_add_f32 v16, v16, v145
    v_cvt_pk_bf16_f32 v192, v144, v145
    v_exp_f32 v146, v146
    v_exp_f32 v147, v147
    v_add_f32 v16, v16, v146
    v_add_f32 v16, v16, v147
    v_cvt_pk_bf16_f32 v193, v146, v147
    v_exp_f32 v148, v148
    v_exp_f32 v149, v149
    v_add_f32 v15, v15, v148
    v_add_f32 v15, v15, v149
    v_cvt_pk_bf16_f32 v190, v148, v149
    v_exp_f32 v150, v150
    v_exp_f32 v151, v151
    v_add_f32 v15, v15, v150
    v_add_f32 v15, v15, v151
    v_cvt_pk_bf16_f32 v191, v150, v151
    v_exp_f32 v152, v152
    v_exp_f32 v153, v153
    v_add_f32 v16, v16, v152
    v_add_f32 v16, v16, v153
    v_cvt_pk_bf16_f32 v194, v152, v153
    v_exp_f32 v154, v154
    v_exp_f32 v155, v155
    v_add_f32 v16, v16, v154
    v_add_f32 v16, v16, v155
    v_cvt_pk_bf16_f32 v195, v154, v155
    s_waitcnt vmcnt(7)
    v_mfma_f32_16x16x32_bf16 v[20:23], v[84:87], v[188:191], v[20:23]
    v_mfma_f32_16x16x32_bf16 v[24:27], v[84:87], v[192:195], v[24:27]
    s_waitcnt vmcnt(6)
    v_mfma_f32_16x16x32_bf16 v[28:31], v[88:91], v[188:191], v[28:31]
    v_mfma_f32_16x16x32_bf16 v[32:35], v[88:91], v[192:195], v[32:35]
    s_waitcnt vmcnt(5)
    v_mfma_f32_16x16x32_bf16 v[36:39], v[92:95], v[188:191], v[36:39]
    v_mfma_f32_16x16x32_bf16 v[40:43], v[92:95], v[192:195], v[40:43]
    s_waitcnt vmcnt(4)
    v_mfma_f32_16x16x32_bf16 v[44:47], v[96:99], v[188:191], v[44:47]
    v_mfma_f32_16x16x32_bf16 v[48:51], v[96:99], v[192:195], v[48:51]
    s_waitcnt vmcnt(3)
    v_mfma_f32_16x16x32_bf16 v[52:55], v[100:103], v[188:191], v[52:55]
    v_mfma_f32_16x16x32_bf16 v[56:59], v[100:103], v[192:195], v[56:59]
    s_waitcnt vmcnt(2)
    v_mfma_f32_16x16x32_bf16 v[60:63], v[104:107], v[188:191], v[60:63]
    v_mfma_f32_16x16x32_bf16 v[64:67], v[104:107], v[192:195], v[64:67]
    s_waitcnt vmcnt(1)
    v_mfma_f32_16x16x32_bf16 v[68:71], v[156:159], v[188:191], v[68:71]
    v_mfma_f32_16x16x32_bf16 v[72:75], v[156:159], v[192:195], v[72:75]
    s_waitcnt vmcnt(0)
    v_mfma_f32_16x16x32_bf16 v[76:79], v[160:163], v[188:191], v[76:79]
    v_mfma_f32_16x16x32_bf16 v[80:83], v[160:163], v[192:195], v[80:83]
    s_add_u32 s22, s22, 16384
    s_cmp_lt_u32 s22, 0x40000
    s_cbranch_scc1 fz_s2
    s_waitcnt vmcnt(0) lgkmcnt(0)
    s_nop 15
    s_nop 3
    s_branch fz_chk
fz_end:
    s_endpgm
.section .rodata,"a"
.p2align 6
.amdhsa_kernel adaLN_cond__sliding_block_cached__moe_arch_mod__prompt_kernel
  .amdhsa_next_free_vgpr 256
  .amdhsa_next_free_sgpr 102
  .amdhsa_accum_offset 256
  .amdhsa_group_segment_fixed_size 0
  .amdhsa_kernarg_size 120
  .amdhsa_user_sgpr_count 2
  .amdhsa_user_sgpr_kernarg_segment_ptr 1
  .amdhsa_system_sgpr_workgroup_id_x 1
  .amdhsa_float_denorm_mode_32 3
.end_amdhsa_kernel
```

```asm
; @launch grid=(256,1,1) block=(512,1,1) lds=163840
.amdgcn_target "amdgcn-amd-amdhsa--gfx950"
.text
.globl adaLN_cond__sliding_block_cached__moe_arch_mod__prompt_kernel
.p2align 8
.type adaLN_cond__sliding_block_cached__moe_arch_mod__prompt_kernel,@function
adaLN_cond__sliding_block_cached__moe_arch_mod__prompt_kernel:
fz_start:
    s_cmp_ge_u32 s2, 256
    s_cbranch_scc1 fz_end
    s_load_dwordx16 s[32:47], s[0:1], 0
    s_load_dwordx8 s[48:55], s[0:1], 64
    s_load_dwordx4 s[56:59], s[0:1], 96
    s_load_dwordx2 s[60:61], s[0:1], 112
    s_and_b32 s12, s2, 3
    s_lshl_b32 s12, s12, 3
    s_bfe_u32 s13, s2, 0x30003
    s_add_u32 s12, s12, s13
    s_bfe_u32 s13, s2, 0x10002
    s_lshl_b32 s13, s13, 2
    s_lshr_b32 s19, s2, 6
    s_add_u32 s13, s13, s19
    s_mov_b32 s15, 0
    v_and_b32 v8, 255, v0
    v_lshrrev_b32 v9, 6, v0
    v_and_b32 v0, 63, v0
    v_readfirstlane_b32 s3, v9
    v_lshlrev_b32 v1, 4, v0
    s_mov_b32 s10, 0x3400000
    s_mov_b32 s11, 0x20000
    s_lshl_b32 s19, s13, 3
    s_add_u32 s19, s19, s3
    s_lshl_b32 s20, s19, 16
    v_add_u32 v4, s20, v1
    v_bfe_u32 v9, v0, 2, 2
    v_lshrrev_b32 v10, 4, v0
    v_and_b32 v11, 3, v0
    v_bfe_u32 v13, v0, 4, 1
    v_lshlrev_b32 v3, 11, v10
    v_lshl_add_u32 v3, v9, 6, v3
    v_lshl_add_u32 v3, v11, 3, v3
    v_lshlrev_b32 v16, 5, v13
    v_sub_u32 v15, v3, v16
    v_add_u32 v3, v3, v16
    v_lshlrev_b32 v2, 6, v10
    v_lshl_add_u32 v2, v11, 4, v2
    v_lshl_add_u32 v2, v9, 13, v2
    v_xor_b32 v16, 32, v2
    s_lshr_b32 s18, s12, 3
    s_lshl_b32 s18, s18, 18
    s_add_u32 s18, s18, 0x400000
    v_add_u32 v5, s18, v1
    v_mov_b32 v17, 0
    v_mov_b32 v18, 0
    v_mov_b32 v19, 0
    s_lshl_b32 s16, s3, 17
    s_lshl_b32 s17, s3, 12
    s_cmp_ge_u32 s3, 4
    s_cbranch_scc1 fz_roleB
    v_and_b32 v20, 7, v8
    v_bfe_u32 v26, v8, 3, 3
    v_lshlrev_b32 v22, 4, v26
    s_lshl_b32 s19, s3, 9
    v_add_u32 v22, s19, v22
    v_lshl_add_u32 v21, v20, 11, v22
    v_mov_b32 v25, 0
    s_lshl_b32 s25, s2, 14
    s_waitcnt lgkmcnt(0)
    s_mov_b64 s[8:9], s[60:61]
    s_mov_b64 s[28:29], s[32:33]
    s_mov_b32 s30, 0x400000
    s_mov_b32 s31, 0x20000
    s_barrier
    buffer_load_dwordx4 v[36:39], v21, s[28:31], s25 offen offset:0
    buffer_load_dwordx4 v[40:43], v21, s[28:31], s25 offen offset:128
    buffer_load_dwordx4 v[44:47], v21, s[28:31], s25 offen offset:256
    buffer_load_dwordx4 v[48:51], v21, s[28:31], s25 offen offset:384
    s_mov_b32 s27, 0x570000
    buffer_load_dword v24, v25, s[8:11], s27 offen sc1
    s_lshl_b32 s19, s12, 8
    s_add_u32 s4, s38, s19
    s_addc_u32 s5, s39, 0
    s_sub_u32 s6, 0x800000, s19
    s_mov_b32 s7, 0x20000
    s_waitcnt vmcnt(4)
    v_lshlrev_b32 v52, 16, v36
    v_and_b32 v53, 0xffff0000, v36
    v_lshlrev_b32 v54, 16, v37
    v_and_b32 v55, 0xffff0000, v37
    v_lshlrev_b32 v56, 16, v38
    v_and_b32 v57, 0xffff0000, v38
    v_lshlrev_b32 v58, 16, v39
    v_and_b32 v59, 0xffff0000, v39
    s_waitcnt vmcnt(3)
    v_lshlrev_b32 v60, 16, v40
    v_and_b32 v61, 0xffff0000, v40
    v_lshlrev_b32 v62, 16, v41
    v_and_b32 v63, 0xffff0000, v41
    v_lshlrev_b32 v64, 16, v42
    v_and_b32 v65, 0xffff0000, v42
    v_lshlrev_b32 v66, 16, v43
    v_and_b32 v67, 0xffff0000, v43
    s_waitcnt vmcnt(2)
    v_lshlrev_b32 v68, 16, v44
    v_and_b32 v69, 0xffff0000, v44
    v_lshlrev_b32 v70, 16, v45
    v_and_b32 v71, 0xffff0000, v45
    v_lshlrev_b32 v72, 16, v46
    v_and_b32 v73, 0xffff0000, v46
    v_lshlrev_b32 v74, 16, v47
    v_and_b32 v75, 0xffff0000, v47
    s_waitcnt vmcnt(1)
    v_lshlrev_b32 v76, 16, v48
    v_and_b32 v77, 0xffff0000, v48
    v_lshlrev_b32 v78, 16, v49
    v_and_b32 v79, 0xffff0000, v49
    v_lshlrev_b32 v80, 16, v50
    v_and_b32 v81, 0xffff0000, v50
    v_lshlrev_b32 v82, 16, v51
    v_and_b32 v83, 0xffff0000, v51
    s_waitcnt vmcnt(0)
    v_readfirstlane_b32 s14, v24
    s_add_u32 s14, s14, 1
    v_lshlrev_b32 v30, 5, v20
    s_lshl_b32 s19, s3, 3
    v_add_u32 v23, s19, v30
    v_add_f32 v31, v52, v53
    v_add_f32 v32, v54, v55
    v_add_f32 v31, v31, v56
    v_add_f32 v32, v32, v57
    v_add_f32 v31, v31, v58
    v_add_f32 v32, v32, v59
    v_add_f32 v31, v31, v60
    v_add_f32 v32, v32, v61
    v_add_f32 v31, v31, v62
    v_add_f32 v32, v32, v63
    v_add_f32 v31, v31, v64
    v_add_f32 v32, v32, v65
    v_add_f32 v31, v31, v66
    v_add_f32 v32, v32, v67
    v_add_f32 v31, v31, v68
    v_add_f32 v32, v32, v69
    v_add_f32 v31, v31, v70
    v_add_f32 v32, v32, v71
    v_add_f32 v31, v31, v72
    v_add_f32 v32, v32, v73
    v_add_f32 v31, v31, v74
    v_add_f32 v32, v32, v75
    v_add_f32 v31, v31, v76
    v_add_f32 v32, v32, v77
    v_add_f32 v31, v31, v78
    v_add_f32 v32, v32, v79
    v_add_f32 v31, v31, v80
    v_add_f32 v32, v32, v81
    v_add_f32 v31, v31, v82
    v_add_f32 v32, v32, v83
    v_add_f32 v26, v31, v32
    s_nop 1
    v_add_f32_dpp v26, v26, v26 row_ror:8 row_mask:0xf bank_mask:0xf
    v_mov_b32 v148, v26
    s_nop 1
    v_permlane16_swap_b32 v26, v148
    v_add_f32 v26, v26, v148
    v_mov_b32 v148, v26
    s_nop 1
    v_permlane32_swap_b32 v26, v148
    v_add_f32 v26, v26, v148
    v_mul_f32 v26, 0x3b800000, v26
    v_sub_f32 v28, v52, v26
    v_mul_f32 v31, v28, v28
    v_sub_f32 v29, v53, v26
    v_mul_f32 v32, v29, v29
    v_sub_f32 v28, v54, v26
    v_sub_f32 v29, v55, v26
    v_fmac_f32 v31, v28, v28
    v_fmac_f32 v32, v29, v29
    v_sub_f32 v28, v56, v26
    v_sub_f32 v29, v57, v26
    v_fmac_f32 v31, v28, v28
    v_fmac_f32 v32, v29, v29
    v_sub_f32 v28, v58, v26
    v_sub_f32 v29, v59, v26
    v_fmac_f32 v31, v28, v28
    v_fmac_f32 v32, v29, v29
    v_sub_f32 v28, v60, v26
    v_sub_f32 v29, v61, v26
    v_fmac_f32 v31, v28, v28
    v_fmac_f32 v32, v29, v29
    v_sub_f32 v28, v62, v26
    v_sub_f32 v29, v63, v26
    v_fmac_f32 v31, v28, v28
    v_fmac_f32 v32, v29, v29
    v_sub_f32 v28, v64, v26
    v_sub_f32 v29, v65, v26
    v_fmac_f32 v31, v28, v28
    v_fmac_f32 v32, v29, v29
    v_sub_f32 v28, v66, v26
    v_sub_f32 v29, v67, v26
    v_fmac_f32 v31, v28, v28
    v_fmac_f32 v32, v29, v29
    v_sub_f32 v28, v68, v26
    v_sub_f32 v29, v69, v26
    v_fmac_f32 v31, v28, v28
    v_fmac_f32 v32, v29, v29
    v_sub_f32 v28, v70, v26
    v_sub_f32 v29, v71, v26
    v_fmac_f32 v31, v28, v28
    v_fmac_f32 v32, v29, v29
    v_sub_f32 v28, v72, v26
    v_sub_f32 v29, v73, v26
    v_fmac_f32 v31, v28, v28
    v_fmac_f32 v32, v29, v29
    v_sub_f32 v28, v74, v26
    v_sub_f32 v29, v75, v26
    v_fmac_f32 v31, v28, v28
    v_fmac_f32 v32, v29, v29
    v_sub_f32 v28, v76, v26
    v_sub_f32 v29, v77, v26
    v_fmac_f32 v31, v28, v28
    v_fmac_f32 v32, v29, v29
    v_sub_f32 v28, v78, v26
    v_sub_f32 v29, v79, v26
    v_fmac_f32 v31, v28, v28
    v_fmac_f32 v32, v29, v29
    v_sub_f32 v28, v80, v26
    v_sub_f32 v29, v81, v26
    v_fmac_f32 v31, v28, v28
    v_fmac_f32 v32, v29, v29
    v_sub_f32 v28, v82, v26
    v_sub_f32 v29, v83, v26
    v_fmac_f32 v31, v28, v28
    v_fmac_f32 v32, v29, v29
    v_add_f32 v27, v31, v32
    s_nop 1
    v_add_f32_dpp v27, v27, v27 row_ror:8 row_mask:0xf bank_mask:0xf
    v_mov_b32 v148, v27
    s_nop 1
    v_permlane16_swap_b32 v27, v148
    v_add_f32 v27, v27, v148
    v_mov_b32 v148, v27
    s_nop 1
    v_permlane32_swap_b32 v27, v148
    v_add_f32 v27, v27, v148
    v_add_u32 v23, 0x20400, v23
    ds_write_b64 v23, v[26:27]
    v_add_u32 v30, 0x20400, v30
    s_waitcnt lgkmcnt(0)
    s_barrier
    ds_read_b128 v[148:151], v30
    ds_read_b128 v[152:155], v30 offset:16
    s_waitcnt lgkmcnt(1)
    v_add_f32 v31, v148, v150
    s_waitcnt lgkmcnt(0)
    v_add_f32 v32, v152, v154
    v_add_f32 v26, v31, v32
    v_mul_f32 v26, 0x3e800000, v26
    v_add_f32 v31, v149, v151
    v_add_f32 v32, v153, v155
    v_add_f32 v27, v31, v32
    v_sub_f32 v148, v148, v26
    v_sub_f32 v150, v150, v26
    v_sub_f32 v152, v152, v26
    v_sub_f32 v154, v154, v26
    v_mul_f32 v31, v148, v148
    v_fmac_f32 v31, v150, v150
    v_fmac_f32 v31, v152, v152
    v_fmac_f32 v31, v154, v154
    v_fmamk_f32 v27, v31, 0x43800000, v27
    v_mul_f32 v27, 0x3a800000, v27
    v_cvt_pk_bf16_f32 v26, v26, v26
    v_lshlrev_b32 v26, 16, v26
    v_cvt_pk_bf16_f32 v27, v27, v27
    v_lshlrev_b32 v27, 16, v27
    v_add_f32 v27, 0x3727c5ac, v27
    v_cvt_pk_bf16_f32 v27, v27, v27
    v_lshlrev_b32 v27, 16, v27
    v_sqrt_f32 v28, v27
    s_nop 0
    v_cvt_pk_bf16_f32 v28, v28, v28
    v_lshlrev_b32 v28, 16, v28
    v_rcp_f32 v29, v28
    s_nop 0
    v_mov_b32 v28, v29
    v_pk_add_f32 v[52:53], v[52:53], v[26:27] op_sel_hi:[1,0] neg_lo:[0,1] neg_hi:[0,1]
    v_pk_add_f32 v[54:55], v[54:55], v[26:27] op_sel_hi:[1,0] neg_lo:[0,1] neg_hi:[0,1]
    v_pk_add_f32 v[56:57], v[56:57], v[26:27] op_sel_hi:[1,0] neg_lo:[0,1] neg_hi:[0,1]
    v_pk_add_f32 v[58:59], v[58:59], v[26:27] op_sel_hi:[1,0] neg_lo:[0,1] neg_hi:[0,1]
    v_pk_add_f32 v[60:61], v[60:61], v[26:27] op_sel_hi:[1,0] neg_lo:[0,1] neg_hi:[0,1]
    v_pk_add_f32 v[62:63], v[62:63], v[26:27] op_sel_hi:[1,0] neg_lo:[0,1] neg_hi:[0,1]
    v_pk_add_f32 v[64:65], v[64:65], v[26:27] op_sel_hi:[1,0] neg_lo:[0,1] neg_hi:[0,1]
    v_pk_add_f32 v[66:67], v[66:67], v[26:27] op_sel_hi:[1,0] neg_lo:[0,1] neg_hi:[0,1]
    v_pk_add_f32 v[68:69], v[68:69], v[26:27] op_sel_hi:[1,0] neg_lo:[0,1] neg_hi:[0,1]
    v_pk_add_f32 v[70:71], v[70:71], v[26:27] op_sel_hi:[1,0] neg_lo:[0,1] neg_hi:[0,1]
    v_pk_add_f32 v[72:73], v[72:73], v[26:27] op_sel_hi:[1,0] neg_lo:[0,1] neg_hi:[0,1]
    v_pk_add_f32 v[74:75], v[74:75], v[26:27] op_sel_hi:[1,0] neg_lo:[0,1] neg_hi:[0,1]
    v_pk_add_f32 v[76:77], v[76:77], v[26:27] op_sel_hi:[1,0] neg_lo:[0,1] neg_hi:[0,1]
    v_pk_add_f32 v[78:79], v[78:79], v[26:27] op_sel_hi:[1,0] neg_lo:[0,1] neg_hi:[0,1]
    v_pk_add_f32 v[80:81], v[80:81], v[26:27] op_sel_hi:[1,0] neg_lo:[0,1] neg_hi:[0,1]
    v_pk_add_f32 v[82:83], v[82:83], v[26:27] op_sel_hi:[1,0] neg_lo:[0,1] neg_hi:[0,1]
    v_cvt_pk_bf16_f32 v31, v52, v53
    v_lshlrev_b32 v52, 16, v31
    v_and_b32 v53, 0xffff0000, v31
    v_cvt_pk_bf16_f32 v31, v54, v55
    v_lshlrev_b32 v54, 16, v31
    v_and_b32 v55, 0xffff0000, v31
    v_cvt_pk_bf16_f32 v31, v56, v57
    v_lshlrev_b32 v56, 16, v31
    v_and_b32 v57, 0xffff0000, v31
    v_cvt_pk_bf16_f32 v31, v58, v59
    v_lshlrev_b32 v58, 16, v31
    v_and_b32 v59, 0xffff0000, v31
    v_cvt_pk_bf16_f32 v31, v60, v61
    v_lshlrev_b32 v60, 16, v31
    v_and_b32 v61, 0xffff0000, v31
    v_cvt_pk_bf16_f32 v31, v62, v63
    v_lshlrev_b32 v62, 16, v31
    v_and_b32 v63, 0xffff0000, v31
    v_cvt_pk_bf16_f32 v31, v64, v65
    v_lshlrev_b32 v64, 16, v31
    v_and_b32 v65, 0xffff0000, v31
    v_cvt_pk_bf16_f32 v31, v66, v67
    v_lshlrev_b32 v66, 16, v31
    v_and_b32 v67, 0xffff0000, v31
    v_cvt_pk_bf16_f32 v31, v68, v69
    v_lshlrev_b32 v68, 16, v31
    v_and_b32 v69, 0xffff0000, v31
    v_cvt_pk_bf16_f32 v31, v70, v71
    v_lshlrev_b32 v70, 16, v31
    v_and_b32 v71, 0xffff0000, v31
    v_cvt_pk_bf16_f32 v31, v72, v73
    v_lshlrev_b32 v72, 16, v31
    v_and_b32 v73, 0xffff0000, v31
    v_cvt_pk_bf16_f32 v31, v74, v75
    v_lshlrev_b32 v74, 16, v31
    v_and_b32 v75, 0xffff0000, v31
    v_cvt_pk_bf16_f32 v31, v76, v77
    v_lshlrev_b32 v76, 16, v31
    v_and_b32 v77, 0xffff0000, v31
    v_cvt_pk_bf16_f32 v31, v78, v79
    v_lshlrev_b32 v78, 16, v31
    v_and_b32 v79, 0xffff0000, v31
    v_cvt_pk_bf16_f32 v31, v80, v81
    v_lshlrev_b32 v80, 16, v31
    v_and_b32 v81, 0xffff0000, v31
    v_cvt_pk_bf16_f32 v31, v82, v83
    v_lshlrev_b32 v82, 16, v31
    v_and_b32 v83, 0xffff0000, v31
    v_pk_mul_f32 v[52:53], v[52:53], v[28:29] op_sel_hi:[1,0]
    v_pk_mul_f32 v[54:55], v[54:55], v[28:29] op_sel_hi:[1,0]
    v_pk_mul_f32 v[56:57], v[56:57], v[28:29] op_sel_hi:[1,0]
    v_pk_mul_f32 v[58:59], v[58:59], v[28:29] op_sel_hi:[1,0]
    v_pk_mul_f32 v[60:61], v[60:61], v[28:29] op_sel_hi:[1,0]
    v_pk_mul_f32 v[62:63], v[62:63], v[28:29] op_sel_hi:[1,0]
    v_pk_mul_f32 v[64:65], v[64:65], v[28:29] op_sel_hi:[1,0]
    v_pk_mul_f32 v[66:67], v[66:67], v[28:29] op_sel_hi:[1,0]
    v_pk_mul_f32 v[68:69], v[68:69], v[28:29] op_sel_hi:[1,0]
    v_pk_mul_f32 v[70:71], v[70:71], v[28:29] op_sel_hi:[1,0]
    v_pk_mul_f32 v[72:73], v[72:73], v[28:29] op_sel_hi:[1,0]
    v_pk_mul_f32 v[74:75], v[74:75], v[28:29] op_sel_hi:[1,0]
    v_pk_mul_f32 v[76:77], v[76:77], v[28:29] op_sel_hi:[1,0]
    v_pk_mul_f32 v[78:79], v[78:79], v[28:29] op_sel_hi:[1,0]
    v_pk_mul_f32 v[80:81], v[80:81], v[28:29] op_sel_hi:[1,0]
    v_pk_mul_f32 v[82:83], v[82:83], v[28:29] op_sel_hi:[1,0]
    v_cvt_pk_bf16_f32 v31, v52, v53
    v_lshlrev_b32 v52, 16, v31
    v_and_b32 v53, 0xffff0000, v31
    v_cvt_pk_bf16_f32 v31, v54, v55
    v_lshlrev_b32 v54, 16, v31
    v_and_b32 v55, 0xffff0000, v31
    v_cvt_pk_bf16_f32 v31, v56, v57
    v_lshlrev_b32 v56, 16, v31
    v_and_b32 v57, 0xffff0000, v31
    v_cvt_pk_bf16_f32 v31, v58, v59
    v_lshlrev_b32 v58, 16, v31
    v_and_b32 v59, 0xffff0000, v31
    v_cvt_pk_bf16_f32 v31, v60, v61
    v_lshlrev_b32 v60, 16, v31
    v_and_b32 v61, 0xffff0000, v31
    v_cvt_pk_bf16_f32 v31, v62, v63
    v_lshlrev_b32 v62, 16, v31
    v_and_b32 v63, 0xffff0000, v31
    v_cvt_pk_bf16_f32 v31, v64, v65
    v_lshlrev_b32 v64, 16, v31
    v_and_b32 v65, 0xffff0000, v31
    v_cvt_pk_bf16_f32 v31, v66, v67
    v_lshlrev_b32 v66, 16, v31
    v_and_b32 v67, 0xffff0000, v31
    v_cvt_pk_bf16_f32 v31, v68, v69
    v_lshlrev_b32 v68, 16, v31
    v_and_b32 v69, 0xffff0000, v31
    v_cvt_pk_bf16_f32 v31, v70, v71
    v_lshlrev_b32 v70, 16, v31
    v_and_b32 v71, 0xffff0000, v31
    v_cvt_pk_bf16_f32 v31, v72, v73
    v_lshlrev_b32 v72, 16, v31
    v_and_b32 v73, 0xffff0000, v31
    v_cvt_pk_bf16_f32 v31, v74, v75
    v_lshlrev_b32 v74, 16, v31
    v_and_b32 v75, 0xffff0000, v31
    v_cvt_pk_bf16_f32 v31, v76, v77
    v_lshlrev_b32 v76, 16, v31
    v_and_b32 v77, 0xffff0000, v31
    v_cvt_pk_bf16_f32 v31, v78, v79
    v_lshlrev_b32 v78, 16, v31
    v_and_b32 v79, 0xffff0000, v31
    v_cvt_pk_bf16_f32 v31, v80, v81
    v_lshlrev_b32 v80, 16, v31
    v_and_b32 v81, 0xffff0000, v31
    v_cvt_pk_bf16_f32 v31, v82, v83
    v_lshlrev_b32 v82, 16, v31
    v_and_b32 v83, 0xffff0000, v31
    v_lshlrev_b32 v33, 1, v22
    v_add_u32 v33, 0x21000, v33
    v_lshlrev_b32 v23, 4, v22
    v_lshl_add_u32 v23, v20, 4, v23
    s_lshr_b32 s23, s2, 1
    s_lshl_b32 s23, s23, 15
    s_and_b32 s24, s2, 1
    s_lshl_b32 s24, s24, 7
    s_add_u32 s23, s23, s24
    s_barrier
    ds_read_b128 v[84:87], v33 offset:4096
    ds_read_b128 v[116:119], v33 offset:0
    ds_read_b128 v[88:91], v33 offset:4112
    ds_read_b128 v[120:123], v33 offset:16
    ds_read_b128 v[92:95], v33 offset:4352
    ds_read_b128 v[124:127], v33 offset:256
    ds_read_b128 v[96:99], v33 offset:4368
    ds_read_b128 v[128:131], v33 offset:272
    ds_read_b128 v[100:103], v33 offset:4608
    ds_read_b128 v[132:135], v33 offset:512
    ds_read_b128 v[104:107], v33 offset:4624
    ds_read_b128 v[136:139], v33 offset:528
    ds_read_b128 v[108:111], v33 offset:4864
    ds_read_b128 v[140:143], v33 offset:768
    ds_read_b128 v[112:115], v33 offset:4880
    ds_read_b128 v[144:147], v33 offset:784
    s_waitcnt lgkmcnt(15)
    v_pk_mul_f32 v[52:53], v[52:53], v[84:85]
    v_pk_mul_f32 v[54:55], v[54:55], v[86:87]
    s_waitcnt lgkmcnt(13)
    v_pk_mul_f32 v[56:57], v[56:57], v[88:89]
    v_pk_mul_f32 v[58:59], v[58:59], v[90:91]
    v_cvt_pk_bf16_f32 v31, v52, v53
    v_lshlrev_b32 v52, 16, v31
    v_and_b32 v53, 0xffff0000, v31
    v_cvt_pk_bf16_f32 v31, v54, v55
    v_lshlrev_b32 v54, 16, v31
    v_and_b32 v55, 0xffff0000, v31
    v_cvt_pk_bf16_f32 v31, v56, v57
    v_lshlrev_b32 v56, 16, v31
    v_and_b32 v57, 0xffff0000, v31
    v_cvt_pk_bf16_f32 v31, v58, v59
    v_lshlrev_b32 v58, 16, v31
    v_and_b32 v59, 0xffff0000, v31
    v_pk_add_f32 v[52:53], v[52:53], v[116:117]
    v_pk_add_f32 v[54:55], v[54:55], v[118:119]
    s_waitcnt lgkmcnt(12)
    v_pk_add_f32 v[56:57], v[56:57], v[120:121]
    v_pk_add_f32 v[58:59], v[58:59], v[122:123]
    v_cvt_pk_bf16_f32 v36, v52, v53
    v_cvt_pk_bf16_f32 v37, v54, v55
    v_cvt_pk_bf16_f32 v38, v56, v57
    v_cvt_pk_bf16_f32 v39, v58, v59
    s_add_u32 s24, s23, 0
    buffer_store_dwordx4 v[36:39], v23, s[8:11], s24 offen sc1
    s_waitcnt lgkmcnt(11)
    v_pk_mul_f32 v[60:61], v[60:61], v[92:93]
    v_pk_mul_f32 v[62:63], v[62:63], v[94:95]
    s_waitcnt lgkmcnt(9)
    v_pk_mul_f32 v[64:65], v[64:65], v[96:97]
    v_pk_mul_f32 v[66:67], v[66:67], v[98:99]
    v_cvt_pk_bf16_f32 v31, v60, v61
    v_lshlrev_b32 v60, 16, v31
    v_and_b32 v61, 0xffff0000, v31
    v_cvt_pk_bf16_f32 v31, v62, v63
    v_lshlrev_b32 v62, 16, v31
    v_and_b32 v63, 0xffff0000, v31
    v_cvt_pk_bf16_f32 v31, v64, v65
    v_lshlrev_b32 v64, 16, v31
    v_and_b32 v65, 0xffff0000, v31
    v_cvt_pk_bf16_f32 v31, v66, v67
    v_lshlrev_b32 v66, 16, v31
    v_and_b32 v67, 0xffff0000, v31
    v_pk_add_f32 v[60:61], v[60:61], v[124:125]
    v_pk_add_f32 v[62:63], v[62:63], v[126:127]
    s_waitcnt lgkmcnt(8)
    v_pk_add_f32 v[64:65], v[64:65], v[128:129]
    v_pk_add_f32 v[66:67], v[66:67], v[130:131]
    v_cvt_pk_bf16_f32 v40, v60, v61
    v_cvt_pk_bf16_f32 v41, v62, v63
    v_cvt_pk_bf16_f32 v42, v64, v65
    v_cvt_pk_bf16_f32 v43, v66, v67
    s_add_u32 s24, s23, 2048
    buffer_store_dwordx4 v[40:43], v23, s[8:11], s24 offen sc1
    s_waitcnt lgkmcnt(7)
    v_pk_mul_f32 v[68:69], v[68:69], v[100:101]
    v_pk_mul_f32 v[70:71], v[70:71], v[102:103]
    s_waitcnt lgkmcnt(5)
    v_pk_mul_f32 v[72:73], v[72:73], v[104:105]
    v_pk_mul_f32 v[74:75], v[74:75], v[106:107]
    v_cvt_pk_bf16_f32 v31, v68, v69
    v_lshlrev_b32 v68, 16, v31
    v_and_b32 v69, 0xffff0000, v31
    v_cvt_pk_bf16_f32 v31, v70, v71
    v_lshlrev_b32 v70, 16, v31
    v_and_b32 v71, 0xffff0000, v31
    v_cvt_pk_bf16_f32 v31, v72, v73
    v_lshlrev_b32 v72, 16, v31
    v_and_b32 v73, 0xffff0000, v31
    v_cvt_pk_bf16_f32 v31, v74, v75
    v_lshlrev_b32 v74, 16, v31
    v_and_b32 v75, 0xffff0000, v31
    v_pk_add_f32 v[68:69], v[68:69], v[132:133]
    v_pk_add_f32 v[70:71], v[70:71], v[134:135]
    s_waitcnt lgkmcnt(4)
    v_pk_add_f32 v[72:73], v[72:73], v[136:137]
    v_pk_add_f32 v[74:75], v[74:75], v[138:139]
    v_cvt_pk_bf16_f32 v44, v68, v69
    v_cvt_pk_bf16_f32 v45, v70, v71
    v_cvt_pk_bf16_f32 v46, v72, v73
    v_cvt_pk_bf16_f32 v47, v74, v75
    s_add_u32 s24, s23, 4096
    buffer_store_dwordx4 v[44:47], v23, s[8:11], s24 offen sc1
    s_waitcnt lgkmcnt(3)
    v_pk_mul_f32 v[76:77], v[76:77], v[108:109]
    v_pk_mul_f32 v[78:79], v[78:79], v[110:111]
    s_waitcnt lgkmcnt(1)
    v_pk_mul_f32 v[80:81], v[80:81], v[112:113]
    v_pk_mul_f32 v[82:83], v[82:83], v[114:115]
    v_cvt_pk_bf16_f32 v31, v76, v77
    v_lshlrev_b32 v76, 16, v31
    v_and_b32 v77, 0xffff0000, v31
    v_cvt_pk_bf16_f32 v31, v78, v79
    v_lshlrev_b32 v78, 16, v31
    v_and_b32 v79, 0xffff0000, v31
    v_cvt_pk_bf16_f32 v31, v80, v81
    v_lshlrev_b32 v80, 16, v31
    v_and_b32 v81, 0xffff0000, v31
    v_cvt_pk_bf16_f32 v31, v82, v83
    v_lshlrev_b32 v82, 16, v31
    v_and_b32 v83, 0xffff0000, v31
    v_pk_add_f32 v[76:77], v[76:77], v[140:141]
    v_pk_add_f32 v[78:79], v[78:79], v[142:143]
    s_waitcnt lgkmcnt(0)
    v_pk_add_f32 v[80:81], v[80:81], v[144:145]
    v_pk_add_f32 v[82:83], v[82:83], v[146:147]
    v_cvt_pk_bf16_f32 v48, v76, v77
    v_cvt_pk_bf16_f32 v49, v78, v79
    v_cvt_pk_bf16_f32 v50, v80, v81
    v_cvt_pk_bf16_f32 v51, v82, v83
    s_add_u32 s24, s23, 6144
    buffer_store_dwordx4 v[48:51], v23, s[8:11], s24 offen sc1
    s_lshl_b32 s26, s2, 7
    s_lshl_b32 s27, s3, 2
    s_add_u32 s26, s26, s27
    s_add_u32 s26, s26, 0x510000
    v_mov_b32 v24, s14
    s_waitcnt vmcnt(0)
    s_mov_b64 exec, 1
    buffer_store_dword v24, v25, s[8:11], s26 offen sc1
    s_mov_b64 exec, -1
    s_add_u32 s22, s16, 0x0
    s_add_u32 m0, s17, 0x0
    s_nop 0
    buffer_load_dwordx4 v2, s[4:7], s22 offen lds
    s_add_u32 s22, s16, 0x8000
    s_add_u32 m0, s17, 0x400
    s_nop 0
    buffer_load_dwordx4 v2, s[4:7], s22 offen lds
    s_add_u32 s22, s16, 0x10000
    s_add_u32 m0, s17, 0x800
    s_nop 0
    buffer_load_dwordx4 v16, s[4:7], s22 offen lds
    s_add_u32 s22, s16, 0x18000
    s_add_u32 m0, s17, 0xc00
    s_nop 0
    buffer_load_dwordx4 v16, s[4:7], s22 offen lds
    s_add_u32 s22, s16, 0x80000
    s_add_u32 m0, s17, 0x4000
    s_nop 0
    buffer_load_dwordx4 v2, s[4:7], s22 offen lds
    s_add_u32 s22, s16, 0x88000
    s_add_u32 m0, s17, 0x4400
    s_nop 0
    buffer_load_dwordx4 v2, s[4:7], s22 offen lds
    s_add_u32 s22, s16, 0x90000
    s_add_u32 m0, s17, 0x4800
    s_nop 0
    buffer_load_dwordx4 v16, s[4:7], s22 offen lds
    s_add_u32 s22, s16, 0x98000
    s_add_u32 m0, s17, 0x4c00
    s_nop 0
    buffer_load_dwordx4 v16, s[4:7], s22 offen lds
    s_add_u32 s22, s16, 0x100000
    s_add_u32 m0, s17, 0x8000
    s_nop 0
    buffer_load_dwordx4 v2, s[4:7], s22 offen lds
    s_add_u32 s22, s16, 0x108000
    s_add_u32 m0, s17, 0x8400
    s_nop 0
    buffer_load_dwordx4 v2, s[4:7], s22 offen lds
    s_add_u32 s22, s16, 0x110000
    s_add_u32 m0, s17, 0x8800
    s_nop 0
    buffer_load_dwordx4 v16, s[4:7], s22 offen lds
    s_add_u32 s22, s16, 0x118000
    s_add_u32 m0, s17, 0x8c00
    s_nop 0
    buffer_load_dwordx4 v16, s[4:7], s22 offen lds
    s_barrier
    s_lshl_b32 s26, s13, 5
    s_lshl_b32 s25, s3, 2
    s_add_u32 s26, s26, s25
    v_bfe_u32 v9, v0, 2, 2
    v_lshlrev_b32 v9, 7, v9
    v_and_b32 v10, 3, v0
    v_lshl_add_u32 v9, v10, 2, v9
    s_lshl_b32 s26, s26, 7
    s_add_u32 s26, s26, 0x510000
    s_mov_b32 s27, 0
fz_hAp:
    buffer_load_dword v10, v9, s[8:11], s26 offen sc1
    s_waitcnt vmcnt(0)
    v_cmp_ne_u32 vcc, s14, v10
    s_add_u32 s27, s27, 1
    s_cmp_ge_u32 s27, 65536
    s_cbranch_scc1 fz_hAg
    s_cbranch_vccz fz_hAg
    s_sleep 4
    s_branch fz_hAp
fz_hAg:
    s_mov_b32 s23, 0x0
    buffer_load_dwordx4 v[204:207], v4, s[8:11], s23 offen offset:0 sc1
    s_mov_b32 s23, 0x8000
    buffer_load_dwordx4 v[208:211], v4, s[8:11], s23 offen offset:0 sc1
    s_mov_b32 s23, 0x0
    buffer_load_dwordx4 v[212:215], v4, s[8:11], s23 offen offset:1024 sc1
    s_mov_b32 s23, 0x8000
    buffer_load_dwordx4 v[216:219], v4, s[8:11], s23 offen offset:1024 sc1
    s_barrier
    ds_read_b64_tr_b16 v[84:85], v3 offset:0
    ds_read_b64_tr_b16 v[86:87], v3 offset:1024
    ds_read_b64_tr_b16 v[88:89], v15 offset:32
    ds_read_b64_tr_b16 v[90:91], v15 offset:1056
    ds_read_b64_tr_b16 v[92:93], v3 offset:256
    ds_read_b64_tr_b16 v[94:95], v3 offset:1280
    ds_read_b64_tr_b16 v[96:97], v15 offset:288
    ds_read_b64_tr_b16 v[98:99], v15 offset:1312
    s_waitcnt vmcnt(3) lgkmcnt(6)
    v_mfma_f32_16x16x32_bf16 v[20:23], v[84:87], v[204:207], 0
    s_mov_b32 s23, 0x800
    buffer_load_dwordx4 v[220:223], v4, s[8:11], s23 offen offset:0 sc1
    ds_read_b64_tr_b16 v[100:101], v3 offset:512
    s_waitcnt vmcnt(3)
    v_mfma_f32_16x16x32_bf16 v[24:27], v[84:87], v[208:211], 0
    ds_read_b64_tr_b16 v[102:103], v3 offset:1536
    s_waitcnt lgkmcnt(6)
    v_mfma_f32_16x16x32_bf16 v[28:31], v[88:91], v[204:207], 0
    s_mov_b32 s23, 0x8800
    buffer_load_dwordx4 v[224:227], v4, s[8:11], s23 offen offset:0 sc1
    ds_read_b64_tr_b16 v[104:105], v15 offset:544
    v_mfma_f32_16x16x32_bf16 v[32:35], v[88:91], v[208:211], 0
    ds_read_b64_tr_b16 v[106:107], v15 offset:1568
    s_waitcnt lgkmcnt(6)
    v_mfma_f32_16x16x32_bf16 v[36:39], v[92:95], v[204:207], 0
    s_mov_b32 s23, 0x800
    buffer_load_dwordx4 v[228:231], v4, s[8:11], s23 offen offset:1024 sc1
    ds_read_b64_tr_b16 v[84:85], v3 offset:768
    v_mfma_f32_16x16x32_bf16 v[40:43], v[92:95], v[208:211], 0
    ds_read_b64_tr_b16 v[86:87], v3 offset:1792
    s_waitcnt lgkmcnt(6)
    v_mfma_f32_16x16x32_bf16 v[44:47], v[96:99], v[204:207], 0
    s_mov_b32 s23, 0x8800
    buffer_load_dwordx4 v[232:235], v4, s[8:11], s23 offen offset:1024 sc1
    ds_read_b64_tr_b16 v[88:89], v15 offset:800
    v_mfma_f32_16x16x32_bf16 v[48:51], v[96:99], v[208:211], 0
    ds_read_b64_tr_b16 v[90:91], v15 offset:1824
    s_mov_b32 s23, 0x1000
    buffer_load_dwordx4 v[140:143], v4, s[8:11], s23 offen offset:0 sc1
    s_waitcnt lgkmcnt(6)
    v_mfma_f32_16x16x32_bf16 v[52:55], v[100:103], v[204:207], 0
    ds_read_b64_tr_b16 v[92:93], v3 offset:8192
    v_mfma_f32_16x16x32_bf16 v[56:59], v[100:103], v[208:211], 0
    ds_read_b64_tr_b16 v[94:95], v3 offset:9216
    s_waitcnt lgkmcnt(6)
    v_mfma_f32_16x16x32_bf16 v[60:63], v[104:107], v[204:207], 0
    ds_read_b64_tr_b16 v[96:97], v15 offset:8224
    v_mfma_f32_16x16x32_bf16 v[64:67], v[104:107], v[208:211], 0
    ds_read_b64_tr_b16 v[98:99], v15 offset:9248
    s_waitcnt lgkmcnt(6)
    v_mfma_f32_16x16x32_bf16 v[68:71], v[84:87], v[204:207], 0
    ds_read_b64_tr_b16 v[100:101], v3 offset:8448
    v_mfma_f32_16x16x32_bf16 v[72:75], v[84:87], v[208:211], 0
    ds_read_b64_tr_b16 v[102:103], v3 offset:9472
    s_waitcnt lgkmcnt(6)
    v_mfma_f32_16x16x32_bf16 v[76:79], v[88:91], v[204:207], 0
    ds_read_b64_tr_b16 v[104:105], v15 offset:8480
    v_mfma_f32_16x16x32_bf16 v[80:83], v[88:91], v[208:211], 0
    ds_read_b64_tr_b16 v[106:107], v15 offset:9504
    s_mov_b32 s23, 0x9000
    buffer_load_dwordx4 v[144:147], v4, s[8:11], s23 offen offset:0 sc1
    s_waitcnt vmcnt(7) lgkmcnt(6)
    v_mfma_f32_16x16x32_bf16 v[20:23], v[92:95], v[212:215], v[20:23]
    ds_read_b64_tr_b16 v[84:85], v3 offset:8704
    s_waitcnt vmcnt(6)
    v_mfma_f32_16x16x32_bf16 v[24:27], v[92:95], v[216:219], v[24:27]
    ds_read_b64_tr_b16 v[86:87], v3 offset:9728
    s_waitcnt lgkmcnt(6)
    v_mfma_f32_16x16x32_bf16 v[28:31], v[96:99], v[212:215], v[28:31]
    ds_read_b64_tr_b16 v[88:89], v15 offset:8736
    v_mfma_f32_16x16x32_bf16 v[32:35], v[96:99], v[216:219], v[32:35]
    ds_read_b64_tr_b16 v[90:91], v15 offset:9760
    s_waitcnt lgkmcnt(6)
    v_mfma_f32_16x16x32_bf16 v[36:39], v[100:103], v[212:215], v[36:39]
    ds_read_b64_tr_b16 v[92:93], v3 offset:8960
    v_mfma_f32_16x16x32_bf16 v[40:43], v[100:103], v[216:219], v[40:43]
    ds_read_b64_tr_b16 v[94:95], v3 offset:9984
    s_waitcnt lgkmcnt(6)
    v_mfma_f32_16x16x32_bf16 v[44:47], v[104:107], v[212:215], v[44:47]
    ds_read_b64_tr_b16 v[96:97], v15 offset:8992
    v_mfma_f32_16x16x32_bf16 v[48:51], v[104:107], v[216:219], v[48:51]
    ds_read_b64_tr_b16 v[98:99], v15 offset:10016
    s_mov_b32 s23, 0x1000
    buffer_load_dwordx4 v[148:151], v4, s[8:11], s23 offen offset:1024 sc1
    s_waitcnt lgkmcnt(6)
    v_mfma_f32_16x16x32_bf16 v[52:55], v[84:87], v[212:215], v[52:55]
    v_mfma_f32_16x16x32_bf16 v[56:59], v[84:87], v[216:219], v[56:59]
    s_barrier
    ds_read_b64_tr_b16 v[100:101], v3 offset:16384
    ds_read_b64_tr_b16 v[102:103], v3 offset:17408
    s_waitcnt lgkmcnt(6)
    v_mfma_f32_16x16x32_bf16 v[60:63], v[88:91], v[212:215], v[60:63]
    ds_read_b64_tr_b16 v[104:105], v15 offset:16416
    v_mfma_f32_16x16x32_bf16 v[64:67], v[88:91], v[216:219], v[64:67]
    s_add_u32 s22, s16, 0x180000
    s_add_u32 m0, s17, 0xc000
    s_nop 0
    buffer_load_dwordx4 v2, s[4:7], s22 offen lds
    ds_read_b64_tr_b16 v[106:107], v15 offset:17440
    s_waitcnt lgkmcnt(6)
    v_mfma_f32_16x16x32_bf16 v[68:71], v[92:95], v[212:215], v[68:71]
    ds_read_b64_tr_b16 v[84:85], v3 offset:16640
    v_mfma_f32_16x16x32_bf16 v[72:75], v[92:95], v[216:219], v[72:75]
    ds_read_b64_tr_b16 v[86:87], v3 offset:17664
    s_waitcnt lgkmcnt(6)
    v_mfma_f32_16x16x32_bf16 v[76:79], v[96:99], v[212:215], v[76:79]
    ds_read_b64_tr_b16 v[88:89], v15 offset:16672
    v_mfma_f32_16x16x32_bf16 v[80:83], v[96:99], v[216:219], v[80:83]
    ds_read_b64_tr_b16 v[90:91], v15 offset:17696
    s_mov_b32 s23, 0x9000
    buffer_load_dwordx4 v[152:155], v4, s[8:11], s23 offen offset:1024 sc1
    s_waitcnt vmcnt(8) lgkmcnt(6)
    v_mfma_f32_16x16x32_bf16 v[20:23], v[100:103], v[220:223], v[20:23]
    ds_read_b64_tr_b16 v[92:93], v3 offset:16896
    s_waitcnt vmcnt(7)
    v_mfma_f32_16x16x32_bf16 v[24:27], v[100:103], v[224:227], v[24:27]
    ds_read_b64_tr_b16 v[94:95], v3 offset:17920
    s_waitcnt lgkmcnt(6)
    v_mfma_f32_16x16x32_bf16 v[28:31], v[104:107], v[220:223], v[28:31]
    ds_read_b64_tr_b16 v[96:97], v15 offset:16928
    v_mfma_f32_16x16x32_bf16 v[32:35], v[104:107], v[224:227], v[32:35]
    s_add_u32 s22, s16, 0x188000
    s_add_u32 m0, s17, 0xc400
    s_nop 0
    buffer_load_dwordx4 v2, s[4:7], s22 offen lds
    ds_read_b64_tr_b16 v[98:99], v15 offset:17952
    s_waitcnt lgkmcnt(6)
    v_mfma_f32_16x16x32_bf16 v[36:39], v[84:87], v[220:223], v[36:39]
    ds_read_b64_tr_b16 v[100:101], v3 offset:17152
    v_mfma_f32_16x16x32_bf16 v[40:43], v[84:87], v[224:227], v[40:43]
    ds_read_b64_tr_b16 v[102:103], v3 offset:18176
    s_waitcnt lgkmcnt(6)
    v_mfma_f32_16x16x32_bf16 v[44:47], v[88:91], v[220:223], v[44:47]
    ds_read_b64_tr_b16 v[104:105], v15 offset:17184
    v_mfma_f32_16x16x32_bf16 v[48:51], v[88:91], v[224:227], v[48:51]
    ds_read_b64_tr_b16 v[106:107], v15 offset:18208
    s_mov_b32 s23, 0x1800
    buffer_load_dwordx4 v[204:207], v4, s[8:11], s23 offen offset:0 sc1
    s_waitcnt lgkmcnt(6)
    v_mfma_f32_16x16x32_bf16 v[52:55], v[92:95], v[220:223], v[52:55]
    ds_read_b64_tr_b16 v[84:85], v3 offset:24576
    v_mfma_f32_16x16x32_bf16 v[56:59], v[92:95], v[224:227], v[56:59]
    ds_read_b64_tr_b16 v[86:87], v3 offset:25600
    s_waitcnt lgkmcnt(6)
    v_mfma_f32_16x16x32_bf16 v[60:63], v[96:99], v[220:223], v[60:63]
    ds_read_b64_tr_b16 v[88:89], v15 offset:24608
    v_mfma_f32_16x16x32_bf16 v[64:67], v[96:99], v[224:227], v[64:67]
    s_add_u32 s22, s16, 0x190000
    s_add_u32 m0, s17, 0xc800
    s_nop 0
    buffer_load_dwordx4 v16, s[4:7], s22 offen lds
    ds_read_b64_tr_b16 v[90:91], v15 offset:25632
    s_waitcnt lgkmcnt(6)
    v_mfma_f32_16x16x32_bf16 v[68:71], v[100:103], v[220:223], v[68:71]
    ds_read_b64_tr_b16 v[92:93], v3 offset:24832
    v_mfma_f32_16x16x32_bf16 v[72:75], v[100:103], v[224:227], v[72:75]
    ds_read_b64_tr_b16 v[94:95], v3 offset:25856
    s_waitcnt lgkmcnt(6)
    v_mfma_f32_16x16x32_bf16 v[76:79], v[104:107], v[220:223], v[76:79]
    ds_read_b64_tr_b16 v[96:97], v15 offset:24864
    v_mfma_f32_16x16x32_bf16 v[80:83], v[104:107], v[224:227], v[80:83]
    ds_read_b64_tr_b16 v[98:99], v15 offset:25888
    s_mov_b32 s23, 0x9800
    buffer_load_dwordx4 v[208:211], v4, s[8:11], s23 offen offset:0 sc1
    s_waitcnt vmcnt(10) lgkmcnt(6)
    v_mfma_f32_16x16x32_bf16 v[20:23], v[84:87], v[228:231], v[20:23]
    ds_read_b64_tr_b16 v[100:101], v3 offset:25088
    s_waitcnt vmcnt(9)
    v_mfma_f32_16x16x32_bf16 v[24:27], v[84:87], v[232:235], v[24:27]
    ds_read_b64_tr_b16 v[102:103], v3 offset:26112
    s_waitcnt lgkmcnt(6)
    v_mfma_f32_16x16x32_bf16 v[28:31], v[88:91], v[228:231], v[28:31]
    ds_read_b64_tr_b16 v[104:105], v15 offset:25120
    v_mfma_f32_16x16x32_bf16 v[32:35], v[88:91], v[232:235], v[32:35]
    s_add_u32 s22, s16, 0x198000
    s_add_u32 m0, s17, 0xcc00
    s_nop 0
    buffer_load_dwordx4 v16, s[4:7], s22 offen lds
    ds_read_b64_tr_b16 v[106:107], v15 offset:26144
    s_waitcnt lgkmcnt(6)
    v_mfma_f32_16x16x32_bf16 v[36:39], v[92:95], v[228:231], v[36:39]
    ds_read_b64_tr_b16 v[84:85], v3 offset:25344
    v_mfma_f32_16x16x32_bf16 v[40:43], v[92:95], v[232:235], v[40:43]
    ds_read_b64_tr_b16 v[86:87], v3 offset:26368
    s_waitcnt lgkmcnt(6)
    v_mfma_f32_16x16x32_bf16 v[44:47], v[96:99], v[228:231], v[44:47]
    ds_read_b64_tr_b16 v[88:89], v15 offset:25376
    v_mfma_f32_16x16x32_bf16 v[48:51], v[96:99], v[232:235], v[48:51]
    ds_read_b64_tr_b16 v[90:91], v15 offset:26400
    s_mov_b32 s23, 0x1800
    buffer_load_dwordx4 v[212:215], v4, s[8:11], s23 offen offset:1024 sc1
    s_waitcnt lgkmcnt(6)
    v_mfma_f32_16x16x32_bf16 v[52:55], v[100:103], v[228:231], v[52:55]
    v_mfma_f32_16x16x32_bf16 v[56:59], v[100:103], v[232:235], v[56:59]
    s_barrier
    ds_read_b64_tr_b16 v[92:93], v3 offset:32768
    ds_read_b64_tr_b16 v[94:95], v3 offset:33792
    s_waitcnt lgkmcnt(6)
    v_mfma_f32_16x16x32_bf16 v[60:63], v[104:107], v[228:231], v[60:63]
    ds_read_b64_tr_b16 v[96:97], v15 offset:32800
    v_mfma_f32_16x16x32_bf16 v[64:67], v[104:107], v[232:235], v[64:67]
    s_add_u32 s22, s16, 0x200000
    s_add_u32 m0, s17, 0x0
    s_nop 0
    buffer_load_dwordx4 v2, s[4:7], s22 offen lds
    ds_read_b64_tr_b16 v[98:99], v15 offset:33824
    s_waitcnt lgkmcnt(6)
    v_mfma_f32_16x16x32_bf16 v[68:71], v[84:87], v[228:231], v[68:71]
    ds_read_b64_tr_b16 v[100:101], v3 offset:33024
    v_mfma_f32_16x16x32_bf16 v[72:75], v[84:87], v[232:235], v[72:75]
    ds_read_b64_tr_b16 v[102:103], v3 offset:34048
    s_waitcnt lgkmcnt(6)
    v_mfma_f32_16x16x32_bf16 v[76:79], v[88:91], v[228:231], v[76:79]
    ds_read_b64_tr_b16 v[104:105], v15 offset:33056
    v_mfma_f32_16x16x32_bf16 v[80:83], v[88:91], v[232:235], v[80:83]
    ds_read_b64_tr_b16 v[106:107], v15 offset:34080
    s_mov_b32 s23, 0x9800
    buffer_load_dwordx4 v[216:219], v4, s[8:11], s23 offen offset:1024 sc1
    s_waitcnt vmcnt(12) lgkmcnt(6)
    v_mfma_f32_16x16x32_bf16 v[20:23], v[92:95], v[140:143], v[20:23]
    ds_read_b64_tr_b16 v[84:85], v3 offset:33280
    s_waitcnt vmcnt(11)
    v_mfma_f32_16x16x32_bf16 v[24:27], v[92:95], v[144:147], v[24:27]
    ds_read_b64_tr_b16 v[86:87], v3 offset:34304
    s_waitcnt lgkmcnt(6)
    v_mfma_f32_16x16x32_bf16 v[28:31], v[96:99], v[140:143], v[28:31]
    ds_read_b64_tr_b16 v[88:89], v15 offset:33312
    v_mfma_f32_16x16x32_bf16 v[32:35], v[96:99], v[144:147], v[32:35]
    s_add_u32 s22, s16, 0x208000
    s_add_u32 m0, s17, 0x400
    s_nop 0
    buffer_load_dwordx4 v2, s[4:7], s22 offen lds
    ds_read_b64_tr_b16 v[90:91], v15 offset:34336
    s_waitcnt lgkmcnt(6)
    v_mfma_f32_16x16x32_bf16 v[36:39], v[100:103], v[140:143], v[36:39]
    ds_read_b64_tr_b16 v[92:93], v3 offset:33536
    v_mfma_f32_16x16x32_bf16 v[40:43], v[100:103], v[144:147], v[40:43]
    ds_read_b64_tr_b16 v[94:95], v3 offset:34560
    s_waitcnt lgkmcnt(6)
    v_mfma_f32_16x16x32_bf16 v[44:47], v[104:107], v[140:143], v[44:47]
    ds_read_b64_tr_b16 v[96:97], v15 offset:33568
    v_mfma_f32_16x16x32_bf16 v[48:51], v[104:107], v[144:147], v[48:51]
    ds_read_b64_tr_b16 v[98:99], v15 offset:34592
    s_mov_b32 s23, 0x2000
    buffer_load_dwordx4 v[220:223], v4, s[8:11], s23 offen offset:0 sc1
    s_waitcnt lgkmcnt(6)
    v_mfma_f32_16x16x32_bf16 v[52:55], v[84:87], v[140:143], v[52:55]
    ds_read_b64_tr_b16 v[100:101], v3 offset:40960
    v_mfma_f32_16x16x32_bf16 v[56:59], v[84:87], v[144:147], v[56:59]
    ds_read_b64_tr_b16 v[102:103], v3 offset:41984
    s_waitcnt lgkmcnt(6)
    v_mfma_f32_16x16x32_bf16 v[60:63], v[88:91], v[140:143], v[60:63]
    ds_read_b64_tr_b16 v[104:105], v15 offset:40992
    v_mfma_f32_16x16x32_bf16 v[64:67], v[88:91], v[144:147], v[64:67]
    s_add_u32 s22, s16, 0x210000
    s_add_u32 m0, s17, 0x800
    s_nop 0
    buffer_load_dwordx4 v16, s[4:7], s22 offen lds
    ds_read_b64_tr_b16 v[106:107], v15 offset:42016
    s_waitcnt lgkmcnt(6)
    v_mfma_f32_16x16x32_bf16 v[68:71], v[92:95], v[140:143], v[68:71]
    ds_read_b64_tr_b16 v[84:85], v3 offset:41216
    v_mfma_f32_16x16x32_bf16 v[72:75], v[92:95], v[144:147], v[72:75]
    ds_read_b64_tr_b16 v[86:87], v3 offset:42240
    s_waitcnt lgkmcnt(6)
    v_mfma_f32_16x16x32_bf16 v[76:79], v[96:99], v[140:143], v[76:79]
    ds_read_b64_tr_b16 v[88:89], v15 offset:41248
    v_mfma_f32_16x16x32_bf16 v[80:83], v[96:99], v[144:147], v[80:83]
    ds_read_b64_tr_b16 v[90:91], v15 offset:42272
    s_mov_b32 s23, 0xa000
    buffer_load_dwordx4 v[224:227], v4, s[8:11], s23 offen offset:0 sc1
    s_waitcnt vmcnt(14) lgkmcnt(6)
    v_mfma_f32_16x16x32_bf16 v[20:23], v[100:103], v[148:151], v[20:23]
    ds_read_b64_tr_b16 v[92:93], v3 offset:41472
    s_waitcnt vmcnt(12)
    v_mfma_f32_16x16x32_bf16 v[24:27], v[100:103], v[152:155], v[24:27]
    ds_read_b64_tr_b16 v[94:95], v3 offset:42496
    s_waitcnt lgkmcnt(6)
    v_mfma_f32_16x16x32_bf16 v[28:31], v[104:107], v[148:151], v[28:31]
    ds_read_b64_tr_b16 v[96:97], v15 offset:41504
    v_mfma_f32_16x16x32_bf16 v[32:35], v[104:107], v[152:155], v[32:35]
    s_add_u32 s22, s16, 0x218000
    s_add_u32 m0, s17, 0xc00
    s_nop 0
    buffer_load_dwordx4 v16, s[4:7], s22 offen lds
    ds_read_b64_tr_b16 v[98:99], v15 offset:42528
    s_waitcnt lgkmcnt(6)
    v_mfma_f32_16x16x32_bf16 v[36:39], v[84:87], v[148:151], v[36:39]
    ds_read_b64_tr_b16 v[100:101], v3 offset:41728
    v_mfma_f32_16x16x32_bf16 v[40:43], v[84:87], v[152:155], v[40:43]
    ds_read_b64_tr_b16 v[102:103], v3 offset:42752
    s_waitcnt lgkmcnt(6)
    v_mfma_f32_16x16x32_bf16 v[44:47], v[88:91], v[148:151], v[44:47]
    ds_read_b64_tr_b16 v[104:105], v15 offset:41760
    v_mfma_f32_16x16x32_bf16 v[48:51], v[88:91], v[152:155], v[48:51]
    ds_read_b64_tr_b16 v[106:107], v15 offset:42784
    s_mov_b32 s23, 0x2000
    buffer_load_dwordx4 v[228:231], v4, s[8:11], s23 offen offset:1024 sc1
    s_waitcnt lgkmcnt(6)
    v_mfma_f32_16x16x32_bf16 v[52:55], v[92:95], v[148:151], v[52:55]
    v_mfma_f32_16x16x32_bf16 v[56:59], v[92:95], v[152:155], v[56:59]
    s_waitcnt vmcnt(9)
    s_barrier
    ds_read_b64_tr_b16 v[84:85], v3 offset:49152
    ds_read_b64_tr_b16 v[86:87], v3 offset:50176
    s_waitcnt lgkmcnt(6)
    v_mfma_f32_16x16x32_bf16 v[60:63], v[96:99], v[148:151], v[60:63]
    ds_read_b64_tr_b16 v[88:89], v15 offset:49184
    v_mfma_f32_16x16x32_bf16 v[64:67], v[96:99], v[152:155], v[64:67]
    s_add_u32 s22, s16, 0x280000
    s_add_u32 m0, s17, 0x4000
    s_nop 0
    buffer_load_dwordx4 v2, s[4:7], s22 offen lds
    ds_read_b64_tr_b16 v[90:91], v15 offset:50208
    s_waitcnt lgkmcnt(6)
    v_mfma_f32_16x16x32_bf16 v[68:71], v[100:103], v[148:151], v[68:71]
    ds_read_b64_tr_b16 v[92:93], v3 offset:49408
    v_mfma_f32_16x16x32_bf16 v[72:75], v[100:103], v[152:155], v[72:75]
    ds_read_b64_tr_b16 v[94:95], v3 offset:50432
    s_waitcnt lgkmcnt(6)
    v_mfma_f32_16x16x32_bf16 v[76:79], v[104:107], v[148:151], v[76:79]
    ds_read_b64_tr_b16 v[96:97], v15 offset:49440
    v_mfma_f32_16x16x32_bf16 v[80:83], v[104:107], v[152:155], v[80:83]
    ds_read_b64_tr_b16 v[98:99], v15 offset:50464
    s_mov_b32 s23, 0xa000
    buffer_load_dwordx4 v[232:235], v4, s[8:11], s23 offen offset:1024 sc1
    s_waitcnt lgkmcnt(6)
    v_mfma_f32_16x16x32_bf16 v[20:23], v[84:87], v[204:207], v[20:23]
    ds_read_b64_tr_b16 v[100:101], v3 offset:49664
    v_mfma_f32_16x16x32_bf16 v[24:27], v[84:87], v[208:211], v[24:27]
    ds_read_b64_tr_b16 v[102:103], v3 offset:50688
    s_waitcnt lgkmcnt(6)
    v_mfma_f32_16x16x32_bf16 v[28:31], v[88:91], v[204:207], v[28:31]
    ds_read_b64_tr_b16 v[104:105], v15 offset:49696
    v_mfma_f32_16x16x32_bf16 v[32:35], v[88:91], v[208:211], v[32:35]
    s_add_u32 s22, s16, 0x288000
    s_add_u32 m0, s17, 0x4400
    s_nop 0
    buffer_load_dwordx4 v2, s[4:7], s22 offen lds
    ds_read_b64_tr_b16 v[106:107], v15 offset:50720
    s_waitcnt lgkmcnt(6)
    v_mfma_f32_16x16x32_bf16 v[36:39], v[92:95], v[204:207], v[36:39]
    ds_read_b64_tr_b16 v[84:85], v3 offset:49920
    v_mfma_f32_16x16x32_bf16 v[40:43], v[92:95], v[208:211], v[40:43]
    ds_read_b64_tr_b16 v[86:87], v3 offset:50944
    s_waitcnt lgkmcnt(6)
    v_mfma_f32_16x16x32_bf16 v[44:47], v[96:99], v[204:207], v[44:47]
    ds_read_b64_tr_b16 v[88:89], v15 offset:49952
    v_mfma_f32_16x16x32_bf16 v[48:51], v[96:99], v[208:211], v[48:51]
    ds_read_b64_tr_b16 v[90:91], v15 offset:50976
    s_mov_b32 s23, 0x2800
    buffer_load_dwordx4 v[140:143], v4, s[8:11], s23 offen offset:0 sc1
    s_waitcnt lgkmcnt(6)
    v_mfma_f32_16x16x32_bf16 v[52:55], v[100:103], v[204:207], v[52:55]
    ds_read_b64_tr_b16 v[92:93], v3 offset:57344
    v_mfma_f32_16x16x32_bf16 v[56:59], v[100:103], v[208:211], v[56:59]
    ds_read_b64_tr_b16 v[94:95], v3 offset:58368
    s_waitcnt lgkmcnt(6)
    v_mfma_f32_16x16x32_bf16 v[60:63], v[104:107], v[204:207], v[60:63]
    ds_read_b64_tr_b16 v[96:97], v15 offset:57376
    v_mfma_f32_16x16x32_bf16 v[64:67], v[104:107], v[208:211], v[64:67]
    s_add_u32 s22, s16, 0x290000
    s_add_u32 m0, s17, 0x4800
    s_nop 0
    buffer_load_dwordx4 v16, s[4:7], s22 offen lds
    ds_read_b64_tr_b16 v[98:99], v15 offset:58400
    s_waitcnt lgkmcnt(6)
    v_mfma_f32_16x16x32_bf16 v[68:71], v[84:87], v[204:207], v[68:71]
    ds_read_b64_tr_b16 v[100:101], v3 offset:57600
    v_mfma_f32_16x16x32_bf16 v[72:75], v[84:87], v[208:211], v[72:75]
    ds_read_b64_tr_b16 v[102:103], v3 offset:58624
    s_waitcnt lgkmcnt(6)
    v_mfma_f32_16x16x32_bf16 v[76:79], v[88:91], v[204:207], v[76:79]
    ds_read_b64_tr_b16 v[104:105], v15 offset:57632
    v_mfma_f32_16x16x32_bf16 v[80:83], v[88:91], v[208:211], v[80:83]
    ds_read_b64_tr_b16 v[106:107], v15 offset:58656
    s_mov_b32 s23, 0xa800
    buffer_load_dwordx4 v[144:147], v4, s[8:11], s23 offen offset:0 sc1
    s_waitcnt vmcnt(14) lgkmcnt(6)
    v_mfma_f32_16x16x32_bf16 v[20:23], v[92:95], v[212:215], v[20:23]
    ds_read_b64_tr_b16 v[84:85], v3 offset:57856
    s_waitcnt vmcnt(12)
    v_mfma_f32_16x16x32_bf16 v[24:27], v[92:95], v[216:219], v[24:27]
    ds_read_b64_tr_b16 v[86:87], v3 offset:58880
    s_waitcnt lgkmcnt(6)
    v_mfma_f32_16x16x32_bf16 v[28:31], v[96:99], v[212:215], v[28:31]
    ds_read_b64_tr_b16 v[88:89], v15 offset:57888
    v_mfma_f32_16x16x32_bf16 v[32:35], v[96:99], v[216:219], v[32:35]
    s_add_u32 s22, s16, 0x298000
    s_add_u32 m0, s17, 0x4c00
    s_nop 0
    buffer_load_dwordx4 v16, s[4:7], s22 offen lds
    ds_read_b64_tr_b16 v[90:91], v15 offset:58912
    s_waitcnt lgkmcnt(6)
    v_mfma_f32_16x16x32_bf16 v[36:39], v[100:103], v[212:215], v[36:39]
    ds_read_b64_tr_b16 v[92:93], v3 offset:58112
    v_mfma_f32_16x16x32_bf16 v[40:43], v[100:103], v[216:219], v[40:43]
    ds_read_b64_tr_b16 v[94:95], v3 offset:59136
    s_waitcnt lgkmcnt(6)
    v_mfma_f32_16x16x32_bf16 v[44:47], v[104:107], v[212:215], v[44:47]
    ds_read_b64_tr_b16 v[96:97], v15 offset:58144
    v_mfma_f32_16x16x32_bf16 v[48:51], v[104:107], v[216:219], v[48:51]
    ds_read_b64_tr_b16 v[98:99], v15 offset:59168
    s_mov_b32 s23, 0x2800
    buffer_load_dwordx4 v[148:151], v4, s[8:11], s23 offen offset:1024 sc1
    s_waitcnt lgkmcnt(6)
    v_mfma_f32_16x16x32_bf16 v[52:55], v[84:87], v[212:215], v[52:55]
    v_mfma_f32_16x16x32_bf16 v[56:59], v[84:87], v[216:219], v[56:59]
    s_waitcnt vmcnt(9)
    s_barrier
    ds_read_b64_tr_b16 v[100:101], v3 offset:0
    ds_read_b64_tr_b16 v[102:103], v3 offset:1024
    s_waitcnt lgkmcnt(6)
    v_mfma_f32_16x16x32_bf16 v[60:63], v[88:91], v[212:215], v[60:63]
    ds_read_b64_tr_b16 v[104:105], v15 offset:32
    v_mfma_f32_16x16x32_bf16 v[64:67], v[88:91], v[216:219], v[64:67]
    s_add_u32 s22, s16, 0x300000
    s_add_u32 m0, s17, 0x8000
    s_nop 0
    buffer_load_dwordx4 v2, s[4:7], s22 offen lds
    ds_read_b64_tr_b16 v[106:107], v15 offset:1056
    s_waitcnt lgkmcnt(6)
    v_mfma_f32_16x16x32_bf16 v[68:71], v[92:95], v[212:215], v[68:71]
    ds_read_b64_tr_b16 v[84:85], v3 offset:256
    v_mfma_f32_16x16x32_bf16 v[72:75], v[92:95], v[216:219], v[72:75]
    ds_read_b64_tr_b16 v[86:87], v3 offset:1280
    s_waitcnt lgkmcnt(6)
    v_mfma_f32_16x16x32_bf16 v[76:79], v[96:99], v[212:215], v[76:79]
    ds_read_b64_tr_b16 v[88:89], v15 offset:288
    v_mfma_f32_16x16x32_bf16 v[80:83], v[96:99], v[216:219], v[80:83]
    ds_read_b64_tr_b16 v[90:91], v15 offset:1312
    s_mov_b32 s23, 0xa800
    buffer_load_dwordx4 v[152:155], v4, s[8:11], s23 offen offset:1024 sc1
    s_waitcnt lgkmcnt(6)
    v_mfma_f32_16x16x32_bf16 v[20:23], v[100:103], v[220:223], v[20:23]
    ds_read_b64_tr_b16 v[92:93], v3 offset:512
    v_mfma_f32_16x16x32_bf16 v[24:27], v[100:103], v[224:227], v[24:27]
    ds_read_b64_tr_b16 v[94:95], v3 offset:1536
    s_waitcnt lgkmcnt(6)
    v_mfma_f32_16x16x32_bf16 v[28:31], v[104:107], v[220:223], v[28:31]
    ds_read_b64_tr_b16 v[96:97], v15 offset:544
    v_mfma_f32_16x16x32_bf16 v[32:35], v[104:107], v[224:227], v[32:35]
    s_add_u32 s22, s16, 0x308000
    s_add_u32 m0, s17, 0x8400
    s_nop 0
    buffer_load_dwordx4 v2, s[4:7], s22 offen lds
    ds_read_b64_tr_b16 v[98:99], v15 offset:1568
    s_waitcnt lgkmcnt(6)
    v_mfma_f32_16x16x32_bf16 v[36:39], v[84:87], v[220:223], v[36:39]
    ds_read_b64_tr_b16 v[100:101], v3 offset:768
    v_mfma_f32_16x16x32_bf16 v[40:43], v[84:87], v[224:227], v[40:43]
    ds_read_b64_tr_b16 v[102:103], v3 offset:1792
    s_waitcnt lgkmcnt(6)
    v_mfma_f32_16x16x32_bf16 v[44:47], v[88:91], v[220:223], v[44:47]
    ds_read_b64_tr_b16 v[104:105], v15 offset:800
    v_mfma_f32_16x16x32_bf16 v[48:51], v[88:91], v[224:227], v[48:51]
    ds_read_b64_tr_b16 v[106:107], v15 offset:1824
    s_mov_b32 s23, 0x3000
    buffer_load_dwordx4 v[204:207], v4, s[8:11], s23 offen offset:0 sc1
    s_waitcnt lgkmcnt(6)
    v_mfma_f32_16x16x32_bf16 v[52:55], v[92:95], v[220:223], v[52:55]
    ds_read_b64_tr_b16 v[84:85], v3 offset:8192
    v_mfma_f32_16x16x32_bf16 v[56:59], v[92:95], v[224:227], v[56:59]
    ds_read_b64_tr_b16 v[86:87], v3 offset:9216
    s_waitcnt lgkmcnt(6)
    v_mfma_f32_16x16x32_bf16 v[60:63], v[96:99], v[220:223], v[60:63]
    ds_read_b64_tr_b16 v[88:89], v15 offset:8224
    v_mfma_f32_16x16x32_bf16 v[64:67], v[96:99], v[224:227], v[64:67]
    s_add_u32 s22, s16, 0x310000
    s_add_u32 m0, s17, 0x8800
    s_nop 0
    buffer_load_dwordx4 v16, s[4:7], s22 offen lds
    ds_read_b64_tr_b16 v[90:91], v15 offset:9248
    s_waitcnt lgkmcnt(6)
    v_mfma_f32_16x16x32_bf16 v[68:71], v[100:103], v[220:223], v[68:71]
    ds_read_b64_tr_b16 v[92:93], v3 offset:8448
    v_mfma_f32_16x16x32_bf16 v[72:75], v[100:103], v[224:227], v[72:75]
    ds_read_b64_tr_b16 v[94:95], v3 offset:9472
    s_waitcnt lgkmcnt(6)
    v_mfma_f32_16x16x32_bf16 v[76:79], v[104:107], v[220:223], v[76:79]
    ds_read_b64_tr_b16 v[96:97], v15 offset:8480
    v_mfma_f32_16x16x32_bf16 v[80:83], v[104:107], v[224:227], v[80:83]
    ds_read_b64_tr_b16 v[98:99], v15 offset:9504
    s_mov_b32 s23, 0xb000
    buffer_load_dwordx4 v[208:211], v4, s[8:11], s23 offen offset:0 sc1
    s_waitcnt vmcnt(14) lgkmcnt(6)
    v_mfma_f32_16x16x32_bf16 v[20:23], v[84:87], v[228:231], v[20:23]
    ds_read_b64_tr_b16 v[100:101], v3 offset:8704
    s_waitcnt vmcnt(12)
    v_mfma_f32_16x16x32_bf16 v[24:27], v[84:87], v[232:235], v[24:27]
    ds_read_b64_tr_b16 v[102:103], v3 offset:9728
    s_waitcnt lgkmcnt(6)
    v_mfma_f32_16x16x32_bf16 v[28:31], v[88:91], v[228:231], v[28:31]
    ds_read_b64_tr_b16 v[104:105], v15 offset:8736
    v_mfma_f32_16x16x32_bf16 v[32:35], v[88:91], v[232:235], v[32:35]
    s_add_u32 s22, s16, 0x318000
    s_add_u32 m0, s17, 0x8c00
    s_nop 0
    buffer_load_dwordx4 v16, s[4:7], s22 offen lds
    ds_read_b64_tr_b16 v[106:107], v15 offset:9760
    s_waitcnt lgkmcnt(6)
    v_mfma_f32_16x16x32_bf16 v[36:39], v[92:95], v[228:231], v[36:39]
    ds_read_b64_tr_b16 v[84:85], v3 offset:8960
    v_mfma_f32_16x16x32_bf16 v[40:43], v[92:95], v[232:235], v[40:43]
    ds_read_b64_tr_b16 v[86:87], v3 offset:9984
    s_waitcnt lgkmcnt(6)
    v_mfma_f32_16x16x32_bf16 v[44:47], v[96:99], v[228:231], v[44:47]
    ds_read_b64_tr_b16 v[88:89], v15 offset:8992
    v_mfma_f32_16x16x32_bf16 v[48:51], v[96:99], v[232:235], v[48:51]
    ds_read_b64_tr_b16 v[90:91], v15 offset:10016
    s_mov_b32 s23, 0x3000
    buffer_load_dwordx4 v[212:215], v4, s[8:11], s23 offen offset:1024 sc1
    s_waitcnt lgkmcnt(6)
    v_mfma_f32_16x16x32_bf16 v[52:55], v[100:103], v[228:231], v[52:55]
    v_mfma_f32_16x16x32_bf16 v[56:59], v[100:103], v[232:235], v[56:59]
    s_waitcnt vmcnt(9)
    s_barrier
    ds_read_b64_tr_b16 v[92:93], v3 offset:16384
    ds_read_b64_tr_b16 v[94:95], v3 offset:17408
    s_waitcnt lgkmcnt(6)
    v_mfma_f32_16x16x32_bf16 v[60:63], v[104:107], v[228:231], v[60:63]
    ds_read_b64_tr_b16 v[96:97], v15 offset:16416
    v_mfma_f32_16x16x32_bf16 v[64:67], v[104:107], v[232:235], v[64:67]
    s_add_u32 s22, s16, 0x380000
    s_add_u32 m0, s17, 0xc000
    s_nop 0
    buffer_load_dwordx4 v2, s[4:7], s22 offen lds
    ds_read_b64_tr_b16 v[98:99], v15 offset:17440
    s_waitcnt lgkmcnt(6)
    v_mfma_f32_16x16x32_bf16 v[68:71], v[84:87], v[228:231], v[68:71]
    ds_read_b64_tr_b16 v[100:101], v3 offset:16640
    v_mfma_f32_16x16x32_bf16 v[72:75], v[84:87], v[232:235], v[72:75]
    ds_read_b64_tr_b16 v[102:103], v3 offset:17664
    s_waitcnt lgkmcnt(6)
    v_mfma_f32_16x16x32_bf16 v[76:79], v[88:91], v[228:231], v[76:79]
    ds_read_b64_tr_b16 v[104:105], v15 offset:16672
    v_mfma_f32_16x16x32_bf16 v[80:83], v[88:91], v[232:235], v[80:83]
    ds_read_b64_tr_b16 v[106:107], v15 offset:17696
    s_mov_b32 s23, 0xb000
    buffer_load_dwordx4 v[216:219], v4, s[8:11], s23 offen offset:1024 sc1
    s_waitcnt lgkmcnt(6)
    v_mfma_f32_16x16x32_bf16 v[20:23], v[92:95], v[140:143], v[20:23]
    ds_read_b64_tr_b16 v[84:85], v3 offset:16896
    v_mfma_f32_16x16x32_bf16 v[24:27], v[92:95], v[144:147], v[24:27]
    ds_read_b64_tr_b16 v[86:87], v3 offset:17920
    s_waitcnt lgkmcnt(6)
    v_mfma_f32_16x16x32_bf16 v[28:31], v[96:99], v[140:143], v[28:31]
    ds_read_b64_tr_b16 v[88:89], v15 offset:16928
    v_mfma_f32_16x16x32_bf16 v[32:35], v[96:99], v[144:147], v[32:35]
    s_add_u32 s22, s16, 0x388000
    s_add_u32 m0, s17, 0xc400
    s_nop 0
    buffer_load_dwordx4 v2, s[4:7], s22 offen lds
    ds_read_b64_tr_b16 v[90:91], v15 offset:17952
    s_waitcnt lgkmcnt(6)
    v_mfma_f32_16x16x32_bf16 v[36:39], v[100:103], v[140:143], v[36:39]
    ds_read_b64_tr_b16 v[92:93], v3 offset:17152
    v_mfma_f32_16x16x32_bf16 v[40:43], v[100:103], v[144:147], v[40:43]
    ds_read_b64_tr_b16 v[94:95], v3 offset:18176
    s_waitcnt lgkmcnt(6)
    v_mfma_f32_16x16x32_bf16 v[44:47], v[104:107], v[140:143], v[44:47]
    ds_read_b64_tr_b16 v[96:97], v15 offset:17184
    v_mfma_f32_16x16x32_bf16 v[48:51], v[104:107], v[144:147], v[48:51]
    ds_read_b64_tr_b16 v[98:99], v15 offset:18208
    s_mov_b32 s23, 0x3800
    buffer_load_dwordx4 v[220:223], v4, s[8:11], s23 offen offset:0 sc1
    s_waitcnt lgkmcnt(6)
    v_mfma_f32_16x16x32_bf16 v[52:55], v[84:87], v[140:143], v[52:55]
    ds_read_b64_tr_b16 v[100:101], v3 offset:24576
    v_mfma_f32_16x16x32_bf16 v[56:59], v[84:87], v[144:147], v[56:59]
    ds_read_b64_tr_b16 v[102:103], v3 offset:25600
    s_waitcnt lgkmcnt(6)
    v_mfma_f32_16x16x32_bf16 v[60:63], v[88:91], v[140:143], v[60:63]
    ds_read_b64_tr_b16 v[104:105], v15 offset:24608
    v_mfma_f32_16x16x32_bf16 v[64:67], v[88:91], v[144:147], v[64:67]
    s_add_u32 s22, s16, 0x390000
    s_add_u32 m0, s17, 0xc800
    s_nop 0
    buffer_load_dwordx4 v16, s[4:7], s22 offen lds
    ds_read_b64_tr_b16 v[106:107], v15 offset:25632
    s_waitcnt lgkmcnt(6)
    v_mfma_f32_16x16x32_bf16 v[68:71], v[92:95], v[140:143], v[68:71]
    ds_read_b64_tr_b16 v[84:85], v3 offset:24832
    v_mfma_f32_16x16x32_bf16 v[72:75], v[92:95], v[144:147], v[72:75]
    ds_read_b64_tr_b16 v[86:87], v3 offset:25856
    s_waitcnt lgkmcnt(6)
    v_mfma_f32_16x16x32_bf16 v[76:79], v[96:99], v[140:143], v[76:79]
    ds_read_b64_tr_b16 v[88:89], v15 offset:24864
    v_mfma_f32_16x16x32_bf16 v[80:83], v[96:99], v[144:147], v[80:83]
    ds_read_b64_tr_b16 v[90:91], v15 offset:25888
    s_mov_b32 s23, 0xb800
    buffer_load_dwordx4 v[224:227], v4, s[8:11], s23 offen offset:0 sc1
    s_waitcnt vmcnt(14) lgkmcnt(6)
    v_mfma_f32_16x16x32_bf16 v[20:23], v[100:103], v[148:151], v[20:23]
    ds_read_b64_tr_b16 v[92:93], v3 offset:25088
    s_waitcnt vmcnt(12)
    v_mfma_f32_16x16x32_bf16 v[24:27], v[100:103], v[152:155], v[24:27]
    ds_read_b64_tr_b16 v[94:95], v3 offset:26112
    s_waitcnt lgkmcnt(6)
    v_mfma_f32_16x16x32_bf16 v[28:31], v[104:107], v[148:151], v[28:31]
    ds_read_b64_tr_b16 v[96:97], v15 offset:25120
    v_mfma_f32_16x16x32_bf16 v[32:35], v[104:107], v[152:155], v[32:35]
    s_add_u32 s22, s16, 0x398000
    s_add_u32 m0, s17, 0xcc00
    s_nop 0
    buffer_load_dwordx4 v16, s[4:7], s22 offen lds
    ds_read_b64_tr_b16 v[98:99], v15 offset:26144
    s_waitcnt lgkmcnt(6)
    v_mfma_f32_16x16x32_bf16 v[36:39], v[84:87], v[148:151], v[36:39]
    ds_read_b64_tr_b16 v[100:101], v3 offset:25344
    v_mfma_f32_16x16x32_bf16 v[40:43], v[84:87], v[152:155], v[40:43]
    ds_read_b64_tr_b16 v[102:103], v3 offset:26368
    s_waitcnt lgkmcnt(6)
    v_mfma_f32_16x16x32_bf16 v[44:47], v[88:91], v[148:151], v[44:47]
    ds_read_b64_tr_b16 v[104:105], v15 offset:25376
    v_mfma_f32_16x16x32_bf16 v[48:51], v[88:91], v[152:155], v[48:51]
    ds_read_b64_tr_b16 v[106:107], v15 offset:26400
    s_mov_b32 s23, 0x3800
    buffer_load_dwordx4 v[228:231], v4, s[8:11], s23 offen offset:1024 sc1
    s_waitcnt lgkmcnt(6)
    v_mfma_f32_16x16x32_bf16 v[52:55], v[92:95], v[148:151], v[52:55]
    v_mfma_f32_16x16x32_bf16 v[56:59], v[92:95], v[152:155], v[56:59]
    s_waitcnt vmcnt(9)
    s_barrier
    ds_read_b64_tr_b16 v[84:85], v3 offset:32768
    ds_read_b64_tr_b16 v[86:87], v3 offset:33792
    s_waitcnt lgkmcnt(6)
    v_mfma_f32_16x16x32_bf16 v[60:63], v[96:99], v[148:151], v[60:63]
    ds_read_b64_tr_b16 v[88:89], v15 offset:32800
    v_mfma_f32_16x16x32_bf16 v[64:67], v[96:99], v[152:155], v[64:67]
    s_add_u32 s22, s16, 0x400000
    s_add_u32 m0, s17, 0x0
    s_nop 0
    buffer_load_dwordx4 v2, s[4:7], s22 offen lds
    ds_read_b64_tr_b16 v[90:91], v15 offset:33824
    s_waitcnt lgkmcnt(6)
    v_mfma_f32_16x16x32_bf16 v[68:71], v[100:103], v[148:151], v[68:71]
    ds_read_b64_tr_b16 v[92:93], v3 offset:33024
    v_mfma_f32_16x16x32_bf16 v[72:75], v[100:103], v[152:155], v[72:75]
    ds_read_b64_tr_b16 v[94:95], v3 offset:34048
    s_waitcnt lgkmcnt(6)
    v_mfma_f32_16x16x32_bf16 v[76:79], v[104:107], v[148:151], v[76:79]
    ds_read_b64_tr_b16 v[96:97], v15 offset:33056
    v_mfma_f32_16x16x32_bf16 v[80:83], v[104:107], v[152:155], v[80:83]
    ds_read_b64_tr_b16 v[98:99], v15 offset:34080
    s_mov_b32 s23, 0xb800
    buffer_load_dwordx4 v[232:235], v4, s[8:11], s23 offen offset:1024 sc1
    s_waitcnt lgkmcnt(6)
    v_mfma_f32_16x16x32_bf16 v[20:23], v[84:87], v[204:207], v[20:23]
    ds_read_b64_tr_b16 v[100:101], v3 offset:33280
    v_mfma_f32_16x16x32_bf16 v[24:27], v[84:87], v[208:211], v[24:27]
    ds_read_b64_tr_b16 v[102:103], v3 offset:34304
    s_waitcnt lgkmcnt(6)
    v_mfma_f32_16x16x32_bf16 v[28:31], v[88:91], v[204:207], v[28:31]
    ds_read_b64_tr_b16 v[104:105], v15 offset:33312
    v_mfma_f32_16x16x32_bf16 v[32:35], v[88:91], v[208:211], v[32:35]
    s_add_u32 s22, s16, 0x408000
    s_add_u32 m0, s17, 0x400
    s_nop 0
    buffer_load_dwordx4 v2, s[4:7], s22 offen lds
    ds_read_b64_tr_b16 v[106:107], v15 offset:34336
    s_waitcnt lgkmcnt(6)
    v_mfma_f32_16x16x32_bf16 v[36:39], v[92:95], v[204:207], v[36:39]
    ds_read_b64_tr_b16 v[84:85], v3 offset:33536
    v_mfma_f32_16x16x32_bf16 v[40:43], v[92:95], v[208:211], v[40:43]
    ds_read_b64_tr_b16 v[86:87], v3 offset:34560
    s_waitcnt lgkmcnt(6)
    v_mfma_f32_16x16x32_bf16 v[44:47], v[96:99], v[204:207], v[44:47]
    ds_read_b64_tr_b16 v[88:89], v15 offset:33568
    v_mfma_f32_16x16x32_bf16 v[48:51], v[96:99], v[208:211], v[48:51]
    ds_read_b64_tr_b16 v[90:91], v15 offset:34592
    s_mov_b32 s23, 0x4000
    buffer_load_dwordx4 v[140:143], v4, s[8:11], s23 offen offset:0 sc1
    s_waitcnt lgkmcnt(6)
    v_mfma_f32_16x16x32_bf16 v[52:55], v[100:103], v[204:207], v[52:55]
    ds_read_b64_tr_b16 v[92:93], v3 offset:40960
    v_mfma_f32_16x16x32_bf16 v[56:59], v[100:103], v[208:211], v[56:59]
    ds_read_b64_tr_b16 v[94:95], v3 offset:41984
    s_waitcnt lgkmcnt(6)
    v_mfma_f32_16x16x32_bf16 v[60:63], v[104:107], v[204:207], v[60:63]
    ds_read_b64_tr_b16 v[96:97], v15 offset:40992
    v_mfma_f32_16x16x32_bf16 v[64:67], v[104:107], v[208:211], v[64:67]
    s_add_u32 s22, s16, 0x410000
    s_add_u32 m0, s17, 0x800
    s_nop 0
    buffer_load_dwordx4 v16, s[4:7], s22 offen lds
    ds_read_b64_tr_b16 v[98:99], v15 offset:42016
    s_waitcnt lgkmcnt(6)
    v_mfma_f32_16x16x32_bf16 v[68:71], v[84:87], v[204:207], v[68:71]
    ds_read_b64_tr_b16 v[100:101], v3 offset:41216
    v_mfma_f32_16x16x32_bf16 v[72:75], v[84:87], v[208:211], v[72:75]
    ds_read_b64_tr_b16 v[102:103], v3 offset:42240
    s_waitcnt lgkmcnt(6)
    v_mfma_f32_16x16x32_bf16 v[76:79], v[88:91], v[204:207], v[76:79]
    ds_read_b64_tr_b16 v[104:105], v15 offset:41248
    v_mfma_f32_16x16x32_bf16 v[80:83], v[88:91], v[208:211], v[80:83]
    ds_read_b64_tr_b16 v[106:107], v15 offset:42272
    s_mov_b32 s23, 0xc000
    buffer_load_dwordx4 v[144:147], v4, s[8:11], s23 offen offset:0 sc1
    s_waitcnt vmcnt(14) lgkmcnt(6)
    v_mfma_f32_16x16x32_bf16 v[20:23], v[92:95], v[212:215], v[20:23]
    ds_read_b64_tr_b16 v[84:85], v3 offset:41472
    s_waitcnt vmcnt(12)
    v_mfma_f32_16x16x32_bf16 v[24:27], v[92:95], v[216:219], v[24:27]
    ds_read_b64_tr_b16 v[86:87], v3 offset:42496
    s_waitcnt lgkmcnt(6)
    v_mfma_f32_16x16x32_bf16 v[28:31], v[96:99], v[212:215], v[28:31]
    ds_read_b64_tr_b16 v[88:89], v15 offset:41504
    v_mfma_f32_16x16x32_bf16 v[32:35], v[96:99], v[216:219], v[32:35]
    s_add_u32 s22, s16, 0x418000
    s_add_u32 m0, s17, 0xc00
    s_nop 0
    buffer_load_dwordx4 v16, s[4:7], s22 offen lds
    ds_read_b64_tr_b16 v[90:91], v15 offset:42528
    s_waitcnt lgkmcnt(6)
    v_mfma_f32_16x16x32_bf16 v[36:39], v[100:103], v[212:215], v[36:39]
    ds_read_b64_tr_b16 v[92:93], v3 offset:41728
    v_mfma_f32_16x16x32_bf16 v[40:43], v[100:103], v[216:219], v[40:43]
    ds_read_b64_tr_b16 v[94:95], v3 offset:42752
    s_waitcnt lgkmcnt(6)
    v_mfma_f32_16x16x32_bf16 v[44:47], v[104:107], v[212:215], v[44:47]
    ds_read_b64_tr_b16 v[96:97], v15 offset:41760
    v_mfma_f32_16x16x32_bf16 v[48:51], v[104:107], v[216:219], v[48:51]
    ds_read_b64_tr_b16 v[98:99], v15 offset:42784
    s_mov_b32 s23, 0x4000
    buffer_load_dwordx4 v[148:151], v4, s[8:11], s23 offen offset:1024 sc1
    s_waitcnt lgkmcnt(6)
    v_mfma_f32_16x16x32_bf16 v[52:55], v[84:87], v[212:215], v[52:55]
    v_mfma_f32_16x16x32_bf16 v[56:59], v[84:87], v[216:219], v[56:59]
    s_waitcnt vmcnt(9)
    s_barrier
    ds_read_b64_tr_b16 v[100:101], v3 offset:49152
    ds_read_b64_tr_b16 v[102:103], v3 offset:50176
    s_waitcnt lgkmcnt(6)
    v_mfma_f32_16x16x32_bf16 v[60:63], v[88:91], v[212:215], v[60:63]
    ds_read_b64_tr_b16 v[104:105], v15 offset:49184
    v_mfma_f32_16x16x32_bf16 v[64:67], v[88:91], v[216:219], v[64:67]
    s_add_u32 s22, s16, 0x480000
    s_add_u32 m0, s17, 0x4000
    s_nop 0
    buffer_load_dwordx4 v2, s[4:7], s22 offen lds
    ds_read_b64_tr_b16 v[106:107], v15 offset:50208
    s_waitcnt lgkmcnt(6)
    v_mfma_f32_16x16x32_bf16 v[68:71], v[92:95], v[212:215], v[68:71]
    ds_read_b64_tr_b16 v[84:85], v3 offset:49408
    v_mfma_f32_16x16x32_bf16 v[72:75], v[92:95], v[216:219], v[72:75]
    ds_read_b64_tr_b16 v[86:87], v3 offset:50432
    s_waitcnt lgkmcnt(6)
    v_mfma_f32_16x16x32_bf16 v[76:79], v[96:99], v[212:215], v[76:79]
    ds_read_b64_tr_b16 v[88:89], v15 offset:49440
    v_mfma_f32_16x16x32_bf16 v[80:83], v[96:99], v[216:219], v[80:83]
    ds_read_b64_tr_b16 v[90:91], v15 offset:50464
    s_mov_b32 s23, 0xc000
    buffer_load_dwordx4 v[152:155], v4, s[8:11], s23 offen offset:1024 sc1
    s_waitcnt lgkmcnt(6)
    v_mfma_f32_16x16x32_bf16 v[20:23], v[100:103], v[220:223], v[20:23]
    ds_read_b64_tr_b16 v[92:93], v3 offset:49664
    v_mfma_f32_16x16x32_bf16 v[24:27], v[100:103], v[224:227], v[24:27]
    ds_read_b64_tr_b16 v[94:95], v3 offset:50688
    s_waitcnt lgkmcnt(6)
    v_mfma_f32_16x16x32_bf16 v[28:31], v[104:107], v[220:223], v[28:31]
    ds_read_b64_tr_b16 v[96:97], v15 offset:49696
    v_mfma_f32_16x16x32_bf16 v[32:35], v[104:107], v[224:227], v[32:35]
    s_add_u32 s22, s16, 0x488000
    s_add_u32 m0, s17, 0x4400
    s_nop 0
    buffer_load_dwordx4 v2, s[4:7], s22 offen lds
    ds_read_b64_tr_b16 v[98:99], v15 offset:50720
    s_waitcnt lgkmcnt(6)
    v_mfma_f32_16x16x32_bf16 v[36:39], v[84:87], v[220:223], v[36:39]
    ds_read_b64_tr_b16 v[100:101], v3 offset:49920
    v_mfma_f32_16x16x32_bf16 v[40:43], v[84:87], v[224:227], v[40:43]
    ds_read_b64_tr_b16 v[102:103], v3 offset:50944
    s_waitcnt lgkmcnt(6)
    v_mfma_f32_16x16x32_bf16 v[44:47], v[88:91], v[220:223], v[44:47]
    ds_read_b64_tr_b16 v[104:105], v15 offset:49952
    v_mfma_f32_16x16x32_bf16 v[48:51], v[88:91], v[224:227], v[48:51]
    ds_read_b64_tr_b16 v[106:107], v15 offset:50976
    s_mov_b32 s23, 0x4800
    buffer_load_dwordx4 v[204:207], v4, s[8:11], s23 offen offset:0 sc1
    s_waitcnt lgkmcnt(6)
    v_mfma_f32_16x16x32_bf16 v[52:55], v[92:95], v[220:223], v[52:55]
    ds_read_b64_tr_b16 v[84:85], v3 offset:57344
    v_mfma_f32_16x16x32_bf16 v[56:59], v[92:95], v[224:227], v[56:59]
    ds_read_b64_tr_b16 v[86:87], v3 offset:58368
    s_waitcnt lgkmcnt(6)
    v_mfma_f32_16x16x32_bf16 v[60:63], v[96:99], v[220:223], v[60:63]
    ds_read_b64_tr_b16 v[88:89], v15 offset:57376
    v_mfma_f32_16x16x32_bf16 v[64:67], v[96:99], v[224:227], v[64:67]
    s_add_u32 s22, s16, 0x490000
    s_add_u32 m0, s17, 0x4800
    s_nop 0
    buffer_load_dwordx4 v16, s[4:7], s22 offen lds
    ds_read_b64_tr_b16 v[90:91], v15 offset:58400
    s_waitcnt lgkmcnt(6)
    v_mfma_f32_16x16x32_bf16 v[68:71], v[100:103], v[220:223], v[68:71]
    ds_read_b64_tr_b16 v[92:93], v3 offset:57600
    v_mfma_f32_16x16x32_bf16 v[72:75], v[100:103], v[224:227], v[72:75]
    ds_read_b64_tr_b16 v[94:95], v3 offset:58624
    s_waitcnt lgkmcnt(6)
    v_mfma_f32_16x16x32_bf16 v[76:79], v[104:107], v[220:223], v[76:79]
    ds_read_b64_tr_b16 v[96:97], v15 offset:57632
    v_mfma_f32_16x16x32_bf16 v[80:83], v[104:107], v[224:227], v[80:83]
    ds_read_b64_tr_b16 v[98:99], v15 offset:58656
    s_mov_b32 s23, 0xc800
    buffer_load_dwordx4 v[208:211], v4, s[8:11], s23 offen offset:0 sc1
    s_waitcnt vmcnt(14) lgkmcnt(6)
    v_mfma_f32_16x16x32_bf16 v[20:23], v[84:87], v[228:231], v[20:23]
    ds_read_b64_tr_b16 v[100:101], v3 offset:57856
    s_waitcnt vmcnt(12)
    v_mfma_f32_16x16x32_bf16 v[24:27], v[84:87], v[232:235], v[24:27]
    ds_read_b64_tr_b16 v[102:103], v3 offset:58880
    s_waitcnt lgkmcnt(6)
    v_mfma_f32_16x16x32_bf16 v[28:31], v[88:91], v[228:231], v[28:31]
    ds_read_b64_tr_b16 v[104:105], v15 offset:57888
    v_mfma_f32_16x16x32_bf16 v[32:35], v[88:91], v[232:235], v[32:35]
    s_add_u32 s22, s16, 0x498000
    s_add_u32 m0, s17, 0x4c00
    s_nop 0
    buffer_load_dwordx4 v16, s[4:7], s22 offen lds
    ds_read_b64_tr_b16 v[106:107], v15 offset:58912
    s_waitcnt lgkmcnt(6)
    v_mfma_f32_16x16x32_bf16 v[36:39], v[92:95], v[228:231], v[36:39]
    ds_read_b64_tr_b16 v[84:85], v3 offset:58112
    v_mfma_f32_16x16x32_bf16 v[40:43], v[92:95], v[232:235], v[40:43]
    ds_read_b64_tr_b16 v[86:87], v3 offset:59136
    s_waitcnt lgkmcnt(6)
    v_mfma_f32_16x16x32_bf16 v[44:47], v[96:99], v[228:231], v[44:47]
    ds_read_b64_tr_b16 v[88:89], v15 offset:58144
    v_mfma_f32_16x16x32_bf16 v[48:51], v[96:99], v[232:235], v[48:51]
    ds_read_b64_tr_b16 v[90:91], v15 offset:59168
    s_mov_b32 s23, 0x4800
    buffer_load_dwordx4 v[212:215], v4, s[8:11], s23 offen offset:1024 sc1
    s_waitcnt lgkmcnt(6)
    v_mfma_f32_16x16x32_bf16 v[52:55], v[100:103], v[228:231], v[52:55]
    v_mfma_f32_16x16x32_bf16 v[56:59], v[100:103], v[232:235], v[56:59]
    s_waitcnt vmcnt(9)
    s_barrier
    ds_read_b64_tr_b16 v[92:93], v3 offset:0
    ds_read_b64_tr_b16 v[94:95], v3 offset:1024
    s_waitcnt lgkmcnt(6)
    v_mfma_f32_16x16x32_bf16 v[60:63], v[104:107], v[228:231], v[60:63]
    ds_read_b64_tr_b16 v[96:97], v15 offset:32
    v_mfma_f32_16x16x32_bf16 v[64:67], v[104:107], v[232:235], v[64:67]
    s_add_u32 s22, s16, 0x500000
    s_add_u32 m0, s17, 0x8000
    s_nop 0
    buffer_load_dwordx4 v2, s[4:7], s22 offen lds
    ds_read_b64_tr_b16 v[98:99], v15 offset:1056
    s_waitcnt lgkmcnt(6)
    v_mfma_f32_16x16x32_bf16 v[68:71], v[84:87], v[228:231], v[68:71]
    ds_read_b64_tr_b16 v[100:101], v3 offset:256
    v_mfma_f32_16x16x32_bf16 v[72:75], v[84:87], v[232:235], v[72:75]
    ds_read_b64_tr_b16 v[102:103], v3 offset:1280
    s_waitcnt lgkmcnt(6)
    v_mfma_f32_16x16x32_bf16 v[76:79], v[88:91], v[228:231], v[76:79]
    ds_read_b64_tr_b16 v[104:105], v15 offset:288
    v_mfma_f32_16x16x32_bf16 v[80:83], v[88:91], v[232:235], v[80:83]
    ds_read_b64_tr_b16 v[106:107], v15 offset:1312
    s_mov_b32 s23, 0xc800
    buffer_load_dwordx4 v[216:219], v4, s[8:11], s23 offen offset:1024 sc1
    s_waitcnt lgkmcnt(6)
    v_mfma_f32_16x16x32_bf16 v[20:23], v[92:95], v[140:143], v[20:23]
    ds_read_b64_tr_b16 v[84:85], v3 offset:512
    v_mfma_f32_16x16x32_bf16 v[24:27], v[92:95], v[144:147], v[24:27]
    ds_read_b64_tr_b16 v[86:87], v3 offset:1536
    s_waitcnt lgkmcnt(6)
    v_mfma_f32_16x16x32_bf16 v[28:31], v[96:99], v[140:143], v[28:31]
    ds_read_b64_tr_b16 v[88:89], v15 offset:544
    v_mfma_f32_16x16x32_bf16 v[32:35], v[96:99], v[144:147], v[32:35]
    s_add_u32 s22, s16, 0x508000
    s_add_u32 m0, s17, 0x8400
    s_nop 0
    buffer_load_dwordx4 v2, s[4:7], s22 offen lds
    ds_read_b64_tr_b16 v[90:91], v15 offset:1568
    s_waitcnt lgkmcnt(6)
    v_mfma_f32_16x16x32_bf16 v[36:39], v[100:103], v[140:143], v[36:39]
    ds_read_b64_tr_b16 v[92:93], v3 offset:768
    v_mfma_f32_16x16x32_bf16 v[40:43], v[100:103], v[144:147], v[40:43]
    ds_read_b64_tr_b16 v[94:95], v3 offset:1792
    s_waitcnt lgkmcnt(6)
    v_mfma_f32_16x16x32_bf16 v[44:47], v[104:107], v[140:143], v[44:47]
    ds_read_b64_tr_b16 v[96:97], v15 offset:800
    v_mfma_f32_16x16x32_bf16 v[48:51], v[104:107], v[144:147], v[48:51]
    ds_read_b64_tr_b16 v[98:99], v15 offset:1824
    s_mov_b32 s23, 0x5000
    buffer_load_dwordx4 v[220:223], v4, s[8:11], s23 offen offset:0 sc1
    s_waitcnt lgkmcnt(6)
    v_mfma_f32_16x16x32_bf16 v[52:55], v[84:87], v[140:143], v[52:55]
    ds_read_b64_tr_b16 v[100:101], v3 offset:8192
    v_mfma_f32_16x16x32_bf16 v[56:59], v[84:87], v[144:147], v[56:59]
    ds_read_b64_tr_b16 v[102:103], v3 offset:9216
    s_waitcnt lgkmcnt(6)
    v_mfma_f32_16x16x32_bf16 v[60:63], v[88:91], v[140:143], v[60:63]
    ds_read_b64_tr_b16 v[104:105], v15 offset:8224
    v_mfma_f32_16x16x32_bf16 v[64:67], v[88:91], v[144:147], v[64:67]
    s_add_u32 s22, s16, 0x510000
    s_add_u32 m0, s17, 0x8800
    s_nop 0
    buffer_load_dwordx4 v16, s[4:7], s22 offen lds
    ds_read_b64_tr_b16 v[106:107], v15 offset:9248
    s_waitcnt lgkmcnt(6)
    v_mfma_f32_16x16x32_bf16 v[68:71], v[92:95], v[140:143], v[68:71]
    ds_read_b64_tr_b16 v[84:85], v3 offset:8448
    v_mfma_f32_16x16x32_bf16 v[72:75], v[92:95], v[144:147], v[72:75]
    ds_read_b64_tr_b16 v[86:87], v3 offset:9472
    s_waitcnt lgkmcnt(6)
    v_mfma_f32_16x16x32_bf16 v[76:79], v[96:99], v[140:143], v[76:79]
    ds_read_b64_tr_b16 v[88:89], v15 offset:8480
    v_mfma_f32_16x16x32_bf16 v[80:83], v[96:99], v[144:147], v[80:83]
    ds_read_b64_tr_b16 v[90:91], v15 offset:9504
    s_mov_b32 s23, 0xd000
    buffer_load_dwordx4 v[224:227], v4, s[8:11], s23 offen offset:0 sc1
    s_waitcnt vmcnt(14) lgkmcnt(6)
    v_mfma_f32_16x16x32_bf16 v[20:23], v[100:103], v[148:151], v[20:23]
    ds_read_b64_tr_b16 v[92:93], v3 offset:8704
    s_waitcnt vmcnt(12)
    v_mfma_f32_16x16x32_bf16 v[24:27], v[100:103], v[152:155], v[24:27]
    ds_read_b64_tr_b16 v[94:95], v3 offset:9728
    s_waitcnt lgkmcnt(6)
    v_mfma_f32_16x16x32_bf16 v[28:31], v[104:107], v[148:151], v[28:31]
    ds_read_b64_tr_b16 v[96:97], v15 offset:8736
    v_mfma_f32_16x16x32_bf16 v[32:35], v[104:107], v[152:155], v[32:35]
    s_add_u32 s22, s16, 0x518000
    s_add_u32 m0, s17, 0x8c00
    s_nop 0
    buffer_load_dwordx4 v16, s[4:7], s22 offen lds
    ds_read_b64_tr_b16 v[98:99], v15 offset:9760
    s_waitcnt lgkmcnt(6)
    v_mfma_f32_16x16x32_bf16 v[36:39], v[84:87], v[148:151], v[36:39]
    ds_read_b64_tr_b16 v[100:101], v3 offset:8960
    v_mfma_f32_16x16x32_bf16 v[40:43], v[84:87], v[152:155], v[40:43]
    ds_read_b64_tr_b16 v[102:103], v3 offset:9984
    s_waitcnt lgkmcnt(6)
    v_mfma_f32_16x16x32_bf16 v[44:47], v[88:91], v[148:151], v[44:47]
    ds_read_b64_tr_b16 v[104:105], v15 offset:8992
    v_mfma_f32_16x16x32_bf16 v[48:51], v[88:91], v[152:155], v[48:51]
    ds_read_b64_tr_b16 v[106:107], v15 offset:10016
    s_mov_b32 s23, 0x5000
    buffer_load_dwordx4 v[228:231], v4, s[8:11], s23 offen offset:1024 sc1
    s_waitcnt lgkmcnt(6)
    v_mfma_f32_16x16x32_bf16 v[52:55], v[92:95], v[148:151], v[52:55]
    v_mfma_f32_16x16x32_bf16 v[56:59], v[92:95], v[152:155], v[56:59]
    s_waitcnt vmcnt(9)
    s_barrier
    ds_read_b64_tr_b16 v[84:85], v3 offset:16384
    ds_read_b64_tr_b16 v[86:87], v3 offset:17408
    s_waitcnt lgkmcnt(6)
    v_mfma_f32_16x16x32_bf16 v[60:63], v[96:99], v[148:151], v[60:63]
    ds_read_b64_tr_b16 v[88:89], v15 offset:16416
    v_mfma_f32_16x16x32_bf16 v[64:67], v[96:99], v[152:155], v[64:67]
    s_add_u32 s22, s16, 0x580000
    s_add_u32 m0, s17, 0xc000
    s_nop 0
    buffer_load_dwordx4 v2, s[4:7], s22 offen lds
    ds_read_b64_tr_b16 v[90:91], v15 offset:17440
    s_waitcnt lgkmcnt(6)
    v_mfma_f32_16x16x32_bf16 v[68:71], v[100:103], v[148:151], v[68:71]
    ds_read_b64_tr_b16 v[92:93], v3 offset:16640
    v_mfma_f32_16x16x32_bf16 v[72:75], v[100:103], v[152:155], v[72:75]
    ds_read_b64_tr_b16 v[94:95], v3 offset:17664
    s_waitcnt lgkmcnt(6)
    v_mfma_f32_16x16x32_bf16 v[76:79], v[104:107], v[148:151], v[76:79]
    ds_read_b64_tr_b16 v[96:97], v15 offset:16672
    v_mfma_f32_16x16x32_bf16 v[80:83], v[104:107], v[152:155], v[80:83]
    ds_read_b64_tr_b16 v[98:99], v15 offset:17696
    s_mov_b32 s23, 0xd000
    buffer_load_dwordx4 v[232:235], v4, s[8:11], s23 offen offset:1024 sc1
    s_waitcnt lgkmcnt(6)
    v_mfma_f32_16x16x32_bf16 v[20:23], v[84:87], v[204:207], v[20:23]
    ds_read_b64_tr_b16 v[100:101], v3 offset:16896
    v_mfma_f32_16x16x32_bf16 v[24:27], v[84:87], v[208:211], v[24:27]
    ds_read_b64_tr_b16 v[102:103], v3 offset:17920
    s_waitcnt lgkmcnt(6)
    v_mfma_f32_16x16x32_bf16 v[28:31], v[88:91], v[204:207], v[28:31]
    ds_read_b64_tr_b16 v[104:105], v15 offset:16928
    v_mfma_f32_16x16x32_bf16 v[32:35], v[88:91], v[208:211], v[32:35]
    s_add_u32 s22, s16, 0x588000
    s_add_u32 m0, s17, 0xc400
    s_nop 0
    buffer_load_dwordx4 v2, s[4:7], s22 offen lds
    ds_read_b64_tr_b16 v[106:107], v15 offset:17952
    s_waitcnt lgkmcnt(6)
    v_mfma_f32_16x16x32_bf16 v[36:39], v[92:95], v[204:207], v[36:39]
    ds_read_b64_tr_b16 v[84:85], v3 offset:17152
    v_mfma_f32_16x16x32_bf16 v[40:43], v[92:95], v[208:211], v[40:43]
    ds_read_b64_tr_b16 v[86:87], v3 offset:18176
    s_waitcnt lgkmcnt(6)
    v_mfma_f32_16x16x32_bf16 v[44:47], v[96:99], v[204:207], v[44:47]
    ds_read_b64_tr_b16 v[88:89], v15 offset:17184
    v_mfma_f32_16x16x32_bf16 v[48:51], v[96:99], v[208:211], v[48:51]
    ds_read_b64_tr_b16 v[90:91], v15 offset:18208
    s_mov_b32 s23, 0x5800
    buffer_load_dwordx4 v[140:143], v4, s[8:11], s23 offen offset:0 sc1
    s_waitcnt lgkmcnt(6)
    v_mfma_f32_16x16x32_bf16 v[52:55], v[100:103], v[204:207], v[52:55]
    ds_read_b64_tr_b16 v[92:93], v3 offset:24576
    v_mfma_f32_16x16x32_bf16 v[56:59], v[100:103], v[208:211], v[56:59]
    ds_read_b64_tr_b16 v[94:95], v3 offset:25600
    s_waitcnt lgkmcnt(6)
    v_mfma_f32_16x16x32_bf16 v[60:63], v[104:107], v[204:207], v[60:63]
    ds_read_b64_tr_b16 v[96:97], v15 offset:24608
    v_mfma_f32_16x16x32_bf16 v[64:67], v[104:107], v[208:211], v[64:67]
    s_add_u32 s22, s16, 0x590000
    s_add_u32 m0, s17, 0xc800
    s_nop 0
    buffer_load_dwordx4 v16, s[4:7], s22 offen lds
    ds_read_b64_tr_b16 v[98:99], v15 offset:25632
    s_waitcnt lgkmcnt(6)
    v_mfma_f32_16x16x32_bf16 v[68:71], v[84:87], v[204:207], v[68:71]
    ds_read_b64_tr_b16 v[100:101], v3 offset:24832
    v_mfma_f32_16x16x32_bf16 v[72:75], v[84:87], v[208:211], v[72:75]
    ds_read_b64_tr_b16 v[102:103], v3 offset:25856
    s_waitcnt lgkmcnt(6)
    v_mfma_f32_16x16x32_bf16 v[76:79], v[88:91], v[204:207], v[76:79]
    ds_read_b64_tr_b16 v[104:105], v15 offset:24864
    v_mfma_f32_16x16x32_bf16 v[80:83], v[88:91], v[208:211], v[80:83]
    ds_read_b64_tr_b16 v[106:107], v15 offset:25888
    s_mov_b32 s23, 0xd800
    buffer_load_dwordx4 v[144:147], v4, s[8:11], s23 offen offset:0 sc1
    s_waitcnt vmcnt(14) lgkmcnt(6)
    v_mfma_f32_16x16x32_bf16 v[20:23], v[92:95], v[212:215], v[20:23]
    ds_read_b64_tr_b16 v[84:85], v3 offset:25088
    s_waitcnt vmcnt(12)
    v_mfma_f32_16x16x32_bf16 v[24:27], v[92:95], v[216:219], v[24:27]
    ds_read_b64_tr_b16 v[86:87], v3 offset:26112
    s_waitcnt lgkmcnt(6)
    v_mfma_f32_16x16x32_bf16 v[28:31], v[96:99], v[212:215], v[28:31]
    ds_read_b64_tr_b16 v[88:89], v15 offset:25120
    v_mfma_f32_16x16x32_bf16 v[32:35], v[96:99], v[216:219], v[32:35]
    s_add_u32 s22, s16, 0x598000
    s_add_u32 m0, s17, 0xcc00
    s_nop 0
    buffer_load_dwordx4 v16, s[4:7], s22 offen lds
    ds_read_b64_tr_b16 v[90:91], v15 offset:26144
    s_waitcnt lgkmcnt(6)
    v_mfma_f32_16x16x32_bf16 v[36:39], v[100:103], v[212:215], v[36:39]
    ds_read_b64_tr_b16 v[92:93], v3 offset:25344
    v_mfma_f32_16x16x32_bf16 v[40:43], v[100:103], v[216:219], v[40:43]
    ds_read_b64_tr_b16 v[94:95], v3 offset:26368
    s_waitcnt lgkmcnt(6)
    v_mfma_f32_16x16x32_bf16 v[44:47], v[104:107], v[212:215], v[44:47]
    ds_read_b64_tr_b16 v[96:97], v15 offset:25376
    v_mfma_f32_16x16x32_bf16 v[48:51], v[104:107], v[216:219], v[48:51]
    ds_read_b64_tr_b16 v[98:99], v15 offset:26400
    s_mov_b32 s23, 0x5800
    buffer_load_dwordx4 v[148:151], v4, s[8:11], s23 offen offset:1024 sc1
    s_waitcnt lgkmcnt(6)
    v_mfma_f32_16x16x32_bf16 v[52:55], v[84:87], v[212:215], v[52:55]
    v_mfma_f32_16x16x32_bf16 v[56:59], v[84:87], v[216:219], v[56:59]
    s_waitcnt vmcnt(9)
    s_barrier
    ds_read_b64_tr_b16 v[100:101], v3 offset:32768
    ds_read_b64_tr_b16 v[102:103], v3 offset:33792
    s_waitcnt lgkmcnt(6)
    v_mfma_f32_16x16x32_bf16 v[60:63], v[88:91], v[212:215], v[60:63]
    ds_read_b64_tr_b16 v[104:105], v15 offset:32800
    v_mfma_f32_16x16x32_bf16 v[64:67], v[88:91], v[216:219], v[64:67]
    s_add_u32 s22, s16, 0x600000
    s_add_u32 m0, s17, 0x0
    s_nop 0
    buffer_load_dwordx4 v2, s[4:7], s22 offen lds
    ds_read_b64_tr_b16 v[106:107], v15 offset:33824
    s_waitcnt lgkmcnt(6)
    v_mfma_f32_16x16x32_bf16 v[68:71], v[92:95], v[212:215], v[68:71]
    ds_read_b64_tr_b16 v[84:85], v3 offset:33024
    v_mfma_f32_16x16x32_bf16 v[72:75], v[92:95], v[216:219], v[72:75]
    ds_read_b64_tr_b16 v[86:87], v3 offset:34048
    s_waitcnt lgkmcnt(6)
    v_mfma_f32_16x16x32_bf16 v[76:79], v[96:99], v[212:215], v[76:79]
    ds_read_b64_tr_b16 v[88:89], v15 offset:33056
    v_mfma_f32_16x16x32_bf16 v[80:83], v[96:99], v[216:219], v[80:83]
    ds_read_b64_tr_b16 v[90:91], v15 offset:34080
    s_mov_b32 s23, 0xd800
    buffer_load_dwordx4 v[152:155], v4, s[8:11], s23 offen offset:1024 sc1
    s_waitcnt lgkmcnt(6)
    v_mfma_f32_16x16x32_bf16 v[20:23], v[100:103], v[220:223], v[20:23]
    ds_read_b64_tr_b16 v[92:93], v3 offset:33280
    v_mfma_f32_16x16x32_bf16 v[24:27], v[100:103], v[224:227], v[24:27]
    ds_read_b64_tr_b16 v[94:95], v3 offset:34304
    s_waitcnt lgkmcnt(6)
    v_mfma_f32_16x16x32_bf16 v[28:31], v[104:107], v[220:223], v[28:31]
    ds_read_b64_tr_b16 v[96:97], v15 offset:33312
    v_mfma_f32_16x16x32_bf16 v[32:35], v[104:107], v[224:227], v[32:35]
    s_add_u32 s22, s16, 0x608000
    s_add_u32 m0, s17, 0x400
    s_nop 0
    buffer_load_dwordx4 v2, s[4:7], s22 offen lds
    ds_read_b64_tr_b16 v[98:99], v15 offset:34336
    s_waitcnt lgkmcnt(6)
    v_mfma_f32_16x16x32_bf16 v[36:39], v[84:87], v[220:223], v[36:39]
    ds_read_b64_tr_b16 v[100:101], v3 offset:33536
    v_mfma_f32_16x16x32_bf16 v[40:43], v[84:87], v[224:227], v[40:43]
    ds_read_b64_tr_b16 v[102:103], v3 offset:34560
    s_waitcnt lgkmcnt(6)
    v_mfma_f32_16x16x32_bf16 v[44:47], v[88:91], v[220:223], v[44:47]
    ds_read_b64_tr_b16 v[104:105], v15 offset:33568
    v_mfma_f32_16x16x32_bf16 v[48:51], v[88:91], v[224:227], v[48:51]
    ds_read_b64_tr_b16 v[106:107], v15 offset:34592
    s_mov_b32 s23, 0x6000
    buffer_load_dwordx4 v[204:207], v4, s[8:11], s23 offen offset:0 sc1
    s_waitcnt lgkmcnt(6)
    v_mfma_f32_16x16x32_bf16 v[52:55], v[92:95], v[220:223], v[52:55]
    ds_read_b64_tr_b16 v[84:85], v3 offset:40960
    v_mfma_f32_16x16x32_bf16 v[56:59], v[92:95], v[224:227], v[56:59]
    ds_read_b64_tr_b16 v[86:87], v3 offset:41984
    s_waitcnt lgkmcnt(6)
    v_mfma_f32_16x16x32_bf16 v[60:63], v[96:99], v[220:223], v[60:63]
    ds_read_b64_tr_b16 v[88:89], v15 offset:40992
    v_mfma_f32_16x16x32_bf16 v[64:67], v[96:99], v[224:227], v[64:67]
    s_add_u32 s22, s16, 0x610000
    s_add_u32 m0, s17, 0x800
    s_nop 0
    buffer_load_dwordx4 v16, s[4:7], s22 offen lds
    ds_read_b64_tr_b16 v[90:91], v15 offset:42016
    s_waitcnt lgkmcnt(6)
    v_mfma_f32_16x16x32_bf16 v[68:71], v[100:103], v[220:223], v[68:71]
    ds_read_b64_tr_b16 v[92:93], v3 offset:41216
    v_mfma_f32_16x16x32_bf16 v[72:75], v[100:103], v[224:227], v[72:75]
    ds_read_b64_tr_b16 v[94:95], v3 offset:42240
    s_waitcnt lgkmcnt(6)
    v_mfma_f32_16x16x32_bf16 v[76:79], v[104:107], v[220:223], v[76:79]
    ds_read_b64_tr_b16 v[96:97], v15 offset:41248
    v_mfma_f32_16x16x32_bf16 v[80:83], v[104:107], v[224:227], v[80:83]
    ds_read_b64_tr_b16 v[98:99], v15 offset:42272
    s_mov_b32 s23, 0xe000
    buffer_load_dwordx4 v[208:211], v4, s[8:11], s23 offen offset:0 sc1
    s_waitcnt vmcnt(14) lgkmcnt(6)
    v_mfma_f32_16x16x32_bf16 v[20:23], v[84:87], v[228:231], v[20:23]
    ds_read_b64_tr_b16 v[100:101], v3 offset:41472
    s_waitcnt vmcnt(12)
    v_mfma_f32_16x16x32_bf16 v[24:27], v[84:87], v[232:235], v[24:27]
    ds_read_b64_tr_b16 v[102:103], v3 offset:42496
    s_waitcnt lgkmcnt(6)
    v_mfma_f32_16x16x32_bf16 v[28:31], v[88:91], v[228:231], v[28:31]
    ds_read_b64_tr_b16 v[104:105], v15 offset:41504
    v_mfma_f32_16x16x32_bf16 v[32:35], v[88:91], v[232:235], v[32:35]
    s_add_u32 s22, s16, 0x618000
    s_add_u32 m0, s17, 0xc00
    s_nop 0
    buffer_load_dwordx4 v16, s[4:7], s22 offen lds
    ds_read_b64_tr_b16 v[106:107], v15 offset:42528
    s_waitcnt lgkmcnt(6)
    v_mfma_f32_16x16x32_bf16 v[36:39], v[92:95], v[228:231], v[36:39]
    ds_read_b64_tr_b16 v[84:85], v3 offset:41728
    v_mfma_f32_16x16x32_bf16 v[40:43], v[92:95], v[232:235], v[40:43]
    ds_read_b64_tr_b16 v[86:87], v3 offset:42752
    s_waitcnt lgkmcnt(6)
    v_mfma_f32_16x16x32_bf16 v[44:47], v[96:99], v[228:231], v[44:47]
    ds_read_b64_tr_b16 v[88:89], v15 offset:41760
    v_mfma_f32_16x16x32_bf16 v[48:51], v[96:99], v[232:235], v[48:51]
    ds_read_b64_tr_b16 v[90:91], v15 offset:42784
    s_mov_b32 s23, 0x6000
    buffer_load_dwordx4 v[212:215], v4, s[8:11], s23 offen offset:1024 sc1
    s_waitcnt lgkmcnt(6)
    v_mfma_f32_16x16x32_bf16 v[52:55], v[100:103], v[228:231], v[52:55]
    v_mfma_f32_16x16x32_bf16 v[56:59], v[100:103], v[232:235], v[56:59]
    s_waitcnt vmcnt(9)
    s_barrier
    ds_read_b64_tr_b16 v[92:93], v3 offset:49152
    ds_read_b64_tr_b16 v[94:95], v3 offset:50176
    s_waitcnt lgkmcnt(6)
    v_mfma_f32_16x16x32_bf16 v[60:63], v[104:107], v[228:231], v[60:63]
    s_lshr_b32 s26, s12, 3
    s_lshl_b32 s26, s26, 10
    s_add_u32 s62, s26, 0x530000
    buffer_load_dword v17, v1, s[8:11], s62 offen offset:0 sc1
    buffer_load_dword v18, v1, s[8:11], s62 offen offset:4 sc1
    buffer_load_dword v19, v1, s[8:11], s62 offen offset:8 sc1
    buffer_load_dword v6, v1, s[8:11], s62 offen offset:12 sc1
    ds_read_b64_tr_b16 v[96:97], v15 offset:49184
    v_mfma_f32_16x16x32_bf16 v[64:67], v[104:107], v[232:235], v[64:67]
    s_add_u32 s22, s16, 0x680000
    s_add_u32 m0, s17, 0x4000
    s_nop 0
    buffer_load_dwordx4 v2, s[4:7], s22 offen lds
    ds_read_b64_tr_b16 v[98:99], v15 offset:50208
    s_waitcnt lgkmcnt(6)
    v_mfma_f32_16x16x32_bf16 v[68:71], v[84:87], v[228:231], v[68:71]
    ds_read_b64_tr_b16 v[100:101], v3 offset:49408
    v_mfma_f32_16x16x32_bf16 v[72:75], v[84:87], v[232:235], v[72:75]
    ds_read_b64_tr_b16 v[102:103], v3 offset:50432
    s_waitcnt lgkmcnt(6)
    v_mfma_f32_16x16x32_bf16 v[76:79], v[88:91], v[228:231], v[76:79]
    ds_read_b64_tr_b16 v[104:105], v15 offset:49440
    v_mfma_f32_16x16x32_bf16 v[80:83], v[88:91], v[232:235], v[80:83]
    ds_read_b64_tr_b16 v[106:107], v15 offset:50464
    s_mov_b32 s23, 0xe000
    buffer_load_dwordx4 v[216:219], v4, s[8:11], s23 offen offset:1024 sc1
    s_waitcnt lgkmcnt(6)
    v_mfma_f32_16x16x32_bf16 v[20:23], v[92:95], v[140:143], v[20:23]
    ds_read_b64_tr_b16 v[84:85], v3 offset:49664
    v_mfma_f32_16x16x32_bf16 v[24:27], v[92:95], v[144:147], v[24:27]
    ds_read_b64_tr_b16 v[86:87], v3 offset:50688
    s_waitcnt lgkmcnt(6)
    v_mfma_f32_16x16x32_bf16 v[28:31], v[96:99], v[140:143], v[28:31]
    ds_read_b64_tr_b16 v[88:89], v15 offset:49696
    v_mfma_f32_16x16x32_bf16 v[32:35], v[96:99], v[144:147], v[32:35]
    s_add_u32 s22, s16, 0x688000
    s_add_u32 m0, s17, 0x4400
    s_nop 0
    buffer_load_dwordx4 v2, s[4:7], s22 offen lds
    ds_read_b64_tr_b16 v[90:91], v15 offset:50720
    s_waitcnt lgkmcnt(6)
    v_mfma_f32_16x16x32_bf16 v[36:39], v[100:103], v[140:143], v[36:39]
    ds_read_b64_tr_b16 v[92:93], v3 offset:49920
    v_mfma_f32_16x16x32_bf16 v[40:43], v[100:103], v[144:147], v[40:43]
    ds_read_b64_tr_b16 v[94:95], v3 offset:50944
    s_waitcnt lgkmcnt(6)
    v_mfma_f32_16x16x32_bf16 v[44:47], v[104:107], v[140:143], v[44:47]
    ds_read_b64_tr_b16 v[96:97], v15 offset:49952
    v_mfma_f32_16x16x32_bf16 v[48:51], v[104:107], v[144:147], v[48:51]
    ds_read_b64_tr_b16 v[98:99], v15 offset:50976
    s_mov_b32 s23, 0x6800
    buffer_load_dwordx4 v[220:223], v4, s[8:11], s23 offen offset:0 sc1
    s_waitcnt lgkmcnt(6)
    v_mfma_f32_16x16x32_bf16 v[52:55], v[84:87], v[140:143], v[52:55]
    ds_read_b64_tr_b16 v[100:101], v3 offset:57344
    v_mfma_f32_16x16x32_bf16 v[56:59], v[84:87], v[144:147], v[56:59]
    ds_read_b64_tr_b16 v[102:103], v3 offset:58368
    s_waitcnt lgkmcnt(6)
    v_mfma_f32_16x16x32_bf16 v[60:63], v[88:91], v[140:143], v[60:63]
    ds_read_b64_tr_b16 v[104:105], v15 offset:57376
    v_mfma_f32_16x16x32_bf16 v[64:67], v[88:91], v[144:147], v[64:67]
    s_add_u32 s22, s16, 0x690000
    s_add_u32 m0, s17, 0x4800
    s_nop 0
    buffer_load_dwordx4 v16, s[4:7], s22 offen lds
    ds_read_b64_tr_b16 v[106:107], v15 offset:58400
    s_waitcnt lgkmcnt(6)
    v_mfma_f32_16x16x32_bf16 v[68:71], v[92:95], v[140:143], v[68:71]
    ds_read_b64_tr_b16 v[84:85], v3 offset:57600
    v_mfma_f32_16x16x32_bf16 v[72:75], v[92:95], v[144:147], v[72:75]
    ds_read_b64_tr_b16 v[86:87], v3 offset:58624
    s_waitcnt lgkmcnt(6)
    v_mfma_f32_16x16x32_bf16 v[76:79], v[96:99], v[140:143], v[76:79]
    ds_read_b64_tr_b16 v[88:89], v15 offset:57632
    v_mfma_f32_16x16x32_bf16 v[80:83], v[96:99], v[144:147], v[80:83]
    ds_read_b64_tr_b16 v[90:91], v15 offset:58656
    s_mov_b32 s23, 0xe800
    buffer_load_dwordx4 v[224:227], v4, s[8:11], s23 offen offset:0 sc1
    s_waitcnt vmcnt(18) lgkmcnt(6)
    v_mfma_f32_16x16x32_bf16 v[20:23], v[100:103], v[148:151], v[20:23]
    ds_read_b64_tr_b16 v[92:93], v3 offset:57856
    s_waitcnt vmcnt(16)
    v_mfma_f32_16x16x32_bf16 v[24:27], v[100:103], v[152:155], v[24:27]
    ds_read_b64_tr_b16 v[94:95], v3 offset:58880
    s_waitcnt lgkmcnt(6)
    v_mfma_f32_16x16x32_bf16 v[28:31], v[104:107], v[148:151], v[28:31]
    ds_read_b64_tr_b16 v[96:97], v15 offset:57888
    v_mfma_f32_16x16x32_bf16 v[32:35], v[104:107], v[152:155], v[32:35]
    s_add_u32 s22, s16, 0x698000
    s_add_u32 m0, s17, 0x4c00
    s_nop 0
    buffer_load_dwordx4 v16, s[4:7], s22 offen lds
    ds_read_b64_tr_b16 v[98:99], v15 offset:58912
    s_waitcnt lgkmcnt(6)
    v_mfma_f32_16x16x32_bf16 v[36:39], v[84:87], v[148:151], v[36:39]
    ds_read_b64_tr_b16 v[100:101], v3 offset:58112
    v_mfma_f32_16x16x32_bf16 v[40:43], v[84:87], v[152:155], v[40:43]
    ds_read_b64_tr_b16 v[102:103], v3 offset:59136
    s_waitcnt lgkmcnt(6)
    v_mfma_f32_16x16x32_bf16 v[44:47], v[88:91], v[148:151], v[44:47]
    ds_read_b64_tr_b16 v[104:105], v15 offset:58144
    v_mfma_f32_16x16x32_bf16 v[48:51], v[88:91], v[152:155], v[48:51]
    ds_read_b64_tr_b16 v[106:107], v15 offset:59168
    s_mov_b32 s23, 0x6800
    buffer_load_dwordx4 v[228:231], v4, s[8:11], s23 offen offset:1024 sc1
    s_waitcnt lgkmcnt(6)
    v_mfma_f32_16x16x32_bf16 v[52:55], v[92:95], v[148:151], v[52:55]
    v_mfma_f32_16x16x32_bf16 v[56:59], v[92:95], v[152:155], v[56:59]
    s_waitcnt vmcnt(13)
    s_barrier
    ds_read_b64_tr_b16 v[84:85], v3 offset:0
    ds_read_b64_tr_b16 v[86:87], v3 offset:1024
    s_waitcnt lgkmcnt(6)
    v_mfma_f32_16x16x32_bf16 v[60:63], v[96:99], v[148:151], v[60:63]
    ds_read_b64_tr_b16 v[88:89], v15 offset:32
    v_mfma_f32_16x16x32_bf16 v[64:67], v[96:99], v[152:155], v[64:67]
    s_add_u32 s22, s16, 0x700000
    s_add_u32 m0, s17, 0x8000
    s_nop 0
    buffer_load_dwordx4 v2, s[4:7], s22 offen lds
    ds_read_b64_tr_b16 v[90:91], v15 offset:1056
    s_waitcnt lgkmcnt(6)
    v_mfma_f32_16x16x32_bf16 v[68:71], v[100:103], v[148:151], v[68:71]
    ds_read_b64_tr_b16 v[92:93], v3 offset:256
    v_mfma_f32_16x16x32_bf16 v[72:75], v[100:103], v[152:155], v[72:75]
    ds_read_b64_tr_b16 v[94:95], v3 offset:1280
    s_waitcnt lgkmcnt(6)
    v_mfma_f32_16x16x32_bf16 v[76:79], v[104:107], v[148:151], v[76:79]
    ds_read_b64_tr_b16 v[96:97], v15 offset:288
    v_mfma_f32_16x16x32_bf16 v[80:83], v[104:107], v[152:155], v[80:83]
    ds_read_b64_tr_b16 v[98:99], v15 offset:1312
    s_mov_b32 s23, 0xe800
    buffer_load_dwordx4 v[232:235], v4, s[8:11], s23 offen offset:1024 sc1
    s_waitcnt lgkmcnt(6)
    v_mfma_f32_16x16x32_bf16 v[20:23], v[84:87], v[204:207], v[20:23]
    ds_read_b64_tr_b16 v[100:101], v3 offset:512
    v_mfma_f32_16x16x32_bf16 v[24:27], v[84:87], v[208:211], v[24:27]
    ds_read_b64_tr_b16 v[102:103], v3 offset:1536
    s_waitcnt lgkmcnt(6)
    v_mfma_f32_16x16x32_bf16 v[28:31], v[88:91], v[204:207], v[28:31]
    ds_read_b64_tr_b16 v[104:105], v15 offset:544
    v_mfma_f32_16x16x32_bf16 v[32:35], v[88:91], v[208:211], v[32:35]
    s_add_u32 s22, s16, 0x708000
    s_add_u32 m0, s17, 0x8400
    s_nop 0
    buffer_load_dwordx4 v2, s[4:7], s22 offen lds
    ds_read_b64_tr_b16 v[106:107], v15 offset:1568
    s_waitcnt lgkmcnt(6)
    v_mfma_f32_16x16x32_bf16 v[36:39], v[92:95], v[204:207], v[36:39]
    ds_read_b64_tr_b16 v[84:85], v3 offset:768
    v_mfma_f32_16x16x32_bf16 v[40:43], v[92:95], v[208:211], v[40:43]
    ds_read_b64_tr_b16 v[86:87], v3 offset:1792
    s_waitcnt lgkmcnt(6)
    v_mfma_f32_16x16x32_bf16 v[44:47], v[96:99], v[204:207], v[44:47]
    ds_read_b64_tr_b16 v[88:89], v15 offset:800
    v_mfma_f32_16x16x32_bf16 v[48:51], v[96:99], v[208:211], v[48:51]
    ds_read_b64_tr_b16 v[90:91], v15 offset:1824
    s_mov_b32 s23, 0x7000
    buffer_load_dwordx4 v[140:143], v4, s[8:11], s23 offen offset:0 sc1
    s_waitcnt lgkmcnt(6)
    v_mfma_f32_16x16x32_bf16 v[52:55], v[100:103], v[204:207], v[52:55]
    ds_read_b64_tr_b16 v[92:93], v3 offset:8192
    v_mfma_f32_16x16x32_bf16 v[56:59], v[100:103], v[208:211], v[56:59]
    ds_read_b64_tr_b16 v[94:95], v3 offset:9216
    s_waitcnt lgkmcnt(6)
    v_mfma_f32_16x16x32_bf16 v[60:63], v[104:107], v[204:207], v[60:63]
    ds_read_b64_tr_b16 v[96:97], v15 offset:8224
    v_mfma_f32_16x16x32_bf16 v[64:67], v[104:107], v[208:211], v[64:67]
    s_add_u32 s22, s16, 0x710000
    s_add_u32 m0, s17, 0x8800
    s_nop 0
    buffer_load_dwordx4 v16, s[4:7], s22 offen lds
    ds_read_b64_tr_b16 v[98:99], v15 offset:9248
    s_waitcnt lgkmcnt(6)
    v_mfma_f32_16x16x32_bf16 v[68:71], v[84:87], v[204:207], v[68:71]
    ds_read_b64_tr_b16 v[100:101], v3 offset:8448
    v_mfma_f32_16x16x32_bf16 v[72:75], v[84:87], v[208:211], v[72:75]
    ds_read_b64_tr_b16 v[102:103], v3 offset:9472
    s_waitcnt lgkmcnt(6)
    v_mfma_f32_16x16x32_bf16 v[76:79], v[88:91], v[204:207], v[76:79]
    ds_read_b64_tr_b16 v[104:105], v15 offset:8480
    v_mfma_f32_16x16x32_bf16 v[80:83], v[88:91], v[208:211], v[80:83]
    ds_read_b64_tr_b16 v[106:107], v15 offset:9504
    s_mov_b32 s23, 0xf000
    buffer_load_dwordx4 v[144:147], v4, s[8:11], s23 offen offset:0 sc1
    s_waitcnt vmcnt(18) lgkmcnt(6)
    v_mfma_f32_16x16x32_bf16 v[20:23], v[92:95], v[212:215], v[20:23]
    ds_read_b64_tr_b16 v[84:85], v3 offset:8704
    s_waitcnt vmcnt(12)
    v_mfma_f32_16x16x32_bf16 v[24:27], v[92:95], v[216:219], v[24:27]
    ds_read_b64_tr_b16 v[86:87], v3 offset:9728
    s_waitcnt lgkmcnt(6)
    v_mfma_f32_16x16x32_bf16 v[28:31], v[96:99], v[212:215], v[28:31]
    ds_read_b64_tr_b16 v[88:89], v15 offset:8736
    v_mfma_f32_16x16x32_bf16 v[32:35], v[96:99], v[216:219], v[32:35]
    s_add_u32 s22, s16, 0x718000
    s_add_u32 m0, s17, 0x8c00
    s_nop 0
    buffer_load_dwordx4 v16, s[4:7], s22 offen lds
    ds_read_b64_tr_b16 v[90:91], v15 offset:9760
    s_waitcnt lgkmcnt(6)
    v_mfma_f32_16x16x32_bf16 v[36:39], v[100:103], v[212:215], v[36:39]
    ds_read_b64_tr_b16 v[92:93], v3 offset:8960
    v_mfma_f32_16x16x32_bf16 v[40:43], v[100:103], v[216:219], v[40:43]
    ds_read_b64_tr_b16 v[94:95], v3 offset:9984
    s_waitcnt lgkmcnt(6)
    v_mfma_f32_16x16x32_bf16 v[44:47], v[104:107], v[212:215], v[44:47]
    ds_read_b64_tr_b16 v[96:97], v15 offset:8992
    v_mfma_f32_16x16x32_bf16 v[48:51], v[104:107], v[216:219], v[48:51]
    ds_read_b64_tr_b16 v[98:99], v15 offset:10016
    s_mov_b32 s23, 0x7000
    buffer_load_dwordx4 v[148:151], v4, s[8:11], s23 offen offset:1024 sc1
    s_waitcnt lgkmcnt(6)
    v_mfma_f32_16x16x32_bf16 v[52:55], v[84:87], v[212:215], v[52:55]
    v_mfma_f32_16x16x32_bf16 v[56:59], v[84:87], v[216:219], v[56:59]
    s_waitcnt vmcnt(9)
    s_barrier
    ds_read_b64_tr_b16 v[100:101], v3 offset:16384
    ds_read_b64_tr_b16 v[102:103], v3 offset:17408
    s_waitcnt lgkmcnt(6)
    v_mfma_f32_16x16x32_bf16 v[60:63], v[88:91], v[212:215], v[60:63]
    ds_read_b64_tr_b16 v[104:105], v15 offset:16416
    v_mfma_f32_16x16x32_bf16 v[64:67], v[88:91], v[216:219], v[64:67]
    s_add_u32 s22, s16, 0x780000
    s_add_u32 m0, s17, 0xc000
    s_nop 0
    buffer_load_dwordx4 v2, s[4:7], s22 offen lds
    ds_read_b64_tr_b16 v[106:107], v15 offset:17440
    s_waitcnt lgkmcnt(6)
    v_mfma_f32_16x16x32_bf16 v[68:71], v[92:95], v[212:215], v[68:71]
    ds_read_b64_tr_b16 v[84:85], v3 offset:16640
    v_mfma_f32_16x16x32_bf16 v[72:75], v[92:95], v[216:219], v[72:75]
    ds_read_b64_tr_b16 v[86:87], v3 offset:17664
    s_waitcnt lgkmcnt(6)
    v_mfma_f32_16x16x32_bf16 v[76:79], v[96:99], v[212:215], v[76:79]
    ds_read_b64_tr_b16 v[88:89], v15 offset:16672
    v_mfma_f32_16x16x32_bf16 v[80:83], v[96:99], v[216:219], v[80:83]
    ds_read_b64_tr_b16 v[90:91], v15 offset:17696
    s_mov_b32 s23, 0xf000
    buffer_load_dwordx4 v[152:155], v4, s[8:11], s23 offen offset:1024 sc1
    s_waitcnt lgkmcnt(6)
    v_mfma_f32_16x16x32_bf16 v[20:23], v[100:103], v[220:223], v[20:23]
    ds_read_b64_tr_b16 v[92:93], v3 offset:16896
    v_mfma_f32_16x16x32_bf16 v[24:27], v[100:103], v[224:227], v[24:27]
    ds_read_b64_tr_b16 v[94:95], v3 offset:17920
    s_waitcnt lgkmcnt(6)
    v_mfma_f32_16x16x32_bf16 v[28:31], v[104:107], v[220:223], v[28:31]
    ds_read_b64_tr_b16 v[96:97], v15 offset:16928
    v_mfma_f32_16x16x32_bf16 v[32:35], v[104:107], v[224:227], v[32:35]
    s_add_u32 s22, s16, 0x788000
    s_add_u32 m0, s17, 0xc400
    s_nop 0
    buffer_load_dwordx4 v2, s[4:7], s22 offen lds
    ds_read_b64_tr_b16 v[98:99], v15 offset:17952
    s_waitcnt lgkmcnt(6)
    v_mfma_f32_16x16x32_bf16 v[36:39], v[84:87], v[220:223], v[36:39]
    ds_read_b64_tr_b16 v[100:101], v3 offset:17152
    v_mfma_f32_16x16x32_bf16 v[40:43], v[84:87], v[224:227], v[40:43]
    ds_read_b64_tr_b16 v[102:103], v3 offset:18176
    s_waitcnt lgkmcnt(6)
    v_mfma_f32_16x16x32_bf16 v[44:47], v[88:91], v[220:223], v[44:47]
    ds_read_b64_tr_b16 v[104:105], v15 offset:17184
    v_mfma_f32_16x16x32_bf16 v[48:51], v[88:91], v[224:227], v[48:51]
    ds_read_b64_tr_b16 v[106:107], v15 offset:18208
    s_mov_b32 s23, 0x7800
    buffer_load_dwordx4 v[204:207], v4, s[8:11], s23 offen offset:0 sc1
    s_waitcnt lgkmcnt(6)
    v_mfma_f32_16x16x32_bf16 v[52:55], v[92:95], v[220:223], v[52:55]
    ds_read_b64_tr_b16 v[84:85], v3 offset:24576
    v_mfma_f32_16x16x32_bf16 v[56:59], v[92:95], v[224:227], v[56:59]
    ds_read_b64_tr_b16 v[86:87], v3 offset:25600
    s_waitcnt lgkmcnt(6)
    v_mfma_f32_16x16x32_bf16 v[60:63], v[96:99], v[220:223], v[60:63]
    ds_read_b64_tr_b16 v[88:89], v15 offset:24608
    v_mfma_f32_16x16x32_bf16 v[64:67], v[96:99], v[224:227], v[64:67]
    s_add_u32 s22, s16, 0x790000
    s_add_u32 m0, s17, 0xc800
    s_nop 0
    buffer_load_dwordx4 v16, s[4:7], s22 offen lds
    ds_read_b64_tr_b16 v[90:91], v15 offset:25632
    s_waitcnt lgkmcnt(6)
    v_mfma_f32_16x16x32_bf16 v[68:71], v[100:103], v[220:223], v[68:71]
    ds_read_b64_tr_b16 v[92:93], v3 offset:24832
    v_mfma_f32_16x16x32_bf16 v[72:75], v[100:103], v[224:227], v[72:75]
    ds_read_b64_tr_b16 v[94:95], v3 offset:25856
    s_waitcnt lgkmcnt(6)
    v_mfma_f32_16x16x32_bf16 v[76:79], v[104:107], v[220:223], v[76:79]
    ds_read_b64_tr_b16 v[96:97], v15 offset:24864
    v_mfma_f32_16x16x32_bf16 v[80:83], v[104:107], v[224:227], v[80:83]
    ds_read_b64_tr_b16 v[98:99], v15 offset:25888
    s_mov_b32 s23, 0xf800
    buffer_load_dwordx4 v[208:211], v4, s[8:11], s23 offen offset:0 sc1
    s_waitcnt vmcnt(14) lgkmcnt(6)
    v_mfma_f32_16x16x32_bf16 v[20:23], v[84:87], v[228:231], v[20:23]
    ds_read_b64_tr_b16 v[100:101], v3 offset:25088
    s_waitcnt vmcnt(12)
    v_mfma_f32_16x16x32_bf16 v[24:27], v[84:87], v[232:235], v[24:27]
    ds_read_b64_tr_b16 v[102:103], v3 offset:26112
    s_waitcnt lgkmcnt(6)
    v_mfma_f32_16x16x32_bf16 v[28:31], v[88:91], v[228:231], v[28:31]
    ds_read_b64_tr_b16 v[104:105], v15 offset:25120
    v_mfma_f32_16x16x32_bf16 v[32:35], v[88:91], v[232:235], v[32:35]
    s_add_u32 s22, s16, 0x798000
    s_add_u32 m0, s17, 0xcc00
    s_nop 0
    buffer_load_dwordx4 v16, s[4:7], s22 offen lds
    ds_read_b64_tr_b16 v[106:107], v15 offset:26144
    s_waitcnt lgkmcnt(6)
    v_mfma_f32_16x16x32_bf16 v[36:39], v[92:95], v[228:231], v[36:39]
    ds_read_b64_tr_b16 v[84:85], v3 offset:25344
    v_mfma_f32_16x16x32_bf16 v[40:43], v[92:95], v[232:235], v[40:43]
    ds_read_b64_tr_b16 v[86:87], v3 offset:26368
    s_waitcnt lgkmcnt(6)
    v_mfma_f32_16x16x32_bf16 v[44:47], v[96:99], v[228:231], v[44:47]
    ds_read_b64_tr_b16 v[88:89], v15 offset:25376
    v_mfma_f32_16x16x32_bf16 v[48:51], v[96:99], v[232:235], v[48:51]
    ds_read_b64_tr_b16 v[90:91], v15 offset:26400
    s_mov_b32 s23, 0x7800
    buffer_load_dwordx4 v[212:215], v4, s[8:11], s23 offen offset:1024 sc1
    s_waitcnt lgkmcnt(6)
    v_mfma_f32_16x16x32_bf16 v[52:55], v[100:103], v[228:231], v[52:55]
    v_mfma_f32_16x16x32_bf16 v[56:59], v[100:103], v[232:235], v[56:59]
    s_waitcnt vmcnt(9)
    s_barrier
    v_xor_b32 v17, s14, v17
    v_xor_b32 v18, s14, v18
    v_xor_b32 v19, s14, v19
    v_xor_b32 v6, s14, v6
    v_or3_b32 v17, v17, v18, v19
    v_or_b32 v17, v17, v6
    v_cmp_ne_u32 vcc, 0, v17
    s_cbranch_vccz fz_kvg
    s_mov_b32 s27, 0
fz_kvp:
    buffer_load_dword v17, v1, s[8:11], s62 offen offset:0 sc1
    buffer_load_dword v18, v1, s[8:11], s62 offen offset:4 sc1
    buffer_load_dword v19, v1, s[8:11], s62 offen offset:8 sc1
    buffer_load_dword v6, v1, s[8:11], s62 offen offset:12 sc1
    s_waitcnt vmcnt(0)
    v_xor_b32 v17, s14, v17
    v_xor_b32 v18, s14, v18
    v_xor_b32 v19, s14, v19
    v_xor_b32 v6, s14, v6
    v_or3_b32 v17, v17, v18, v19
    v_or_b32 v17, v17, v6
    v_cmp_ne_u32 vcc, 0, v17
    s_add_u32 s27, s27, 1
    s_cmp_ge_u32 s27, 65536
    s_nop 4
    s_cbranch_scc1 fz_kvg
    s_cbranch_vccnz fz_kvp
fz_kvg:
    ds_read_b64_tr_b16 v[92:93], v3 offset:32768
    ds_read_b64_tr_b16 v[94:95], v3 offset:33792
    s_waitcnt lgkmcnt(6)
    v_mfma_f32_16x16x32_bf16 v[60:63], v[104:107], v[228:231], v[60:63]
    ds_read_b64_tr_b16 v[96:97], v15 offset:32800
    v_mfma_f32_16x16x32_bf16 v[64:67], v[104:107], v[232:235], v[64:67]
    s_add_u32 s22, s17, 0x0
    s_add_u32 m0, s17, 0x10000
    s_nop 0
    buffer_load_dwordx4 v5, s[8:11], s22 offen sc1 lds
    ds_read_b64_tr_b16 v[98:99], v15 offset:33824
    s_waitcnt lgkmcnt(6)
    v_mfma_f32_16x16x32_bf16 v[68:71], v[84:87], v[228:231], v[68:71]
    ds_read_b64_tr_b16 v[100:101], v3 offset:33024
    v_mfma_f32_16x16x32_bf16 v[72:75], v[84:87], v[232:235], v[72:75]
    ds_read_b64_tr_b16 v[102:103], v3 offset:34048
    s_waitcnt lgkmcnt(6)
    v_mfma_f32_16x16x32_bf16 v[76:79], v[88:91], v[228:231], v[76:79]
    ds_read_b64_tr_b16 v[104:105], v15 offset:33056
    v_mfma_f32_16x16x32_bf16 v[80:83], v[88:91], v[232:235], v[80:83]
    ds_read_b64_tr_b16 v[106:107], v15 offset:34080
    s_mov_b32 s23, 0xf800
    buffer_load_dwordx4 v[216:219], v4, s[8:11], s23 offen offset:1024 sc1
    s_waitcnt lgkmcnt(6)
    v_mfma_f32_16x16x32_bf16 v[20:23], v[92:95], v[140:143], v[20:23]
    ds_read_b64_tr_b16 v[84:85], v3 offset:33280
    v_mfma_f32_16x16x32_bf16 v[24:27], v[92:95], v[144:147], v[24:27]
    ds_read_b64_tr_b16 v[86:87], v3 offset:34304
    s_waitcnt lgkmcnt(6)
    v_mfma_f32_16x16x32_bf16 v[28:31], v[96:99], v[140:143], v[28:31]
    ds_read_b64_tr_b16 v[88:89], v15 offset:33312
    v_mfma_f32_16x16x32_bf16 v[32:35], v[96:99], v[144:147], v[32:35]
    s_add_u32 s22, s17, 0x400
    s_add_u32 m0, s17, 0x10400
    s_nop 0
    buffer_load_dwordx4 v5, s[8:11], s22 offen sc1 lds
    ds_read_b64_tr_b16 v[90:91], v15 offset:34336
    s_waitcnt lgkmcnt(6)
    v_mfma_f32_16x16x32_bf16 v[36:39], v[100:103], v[140:143], v[36:39]
    ds_read_b64_tr_b16 v[92:93], v3 offset:33536
    v_mfma_f32_16x16x32_bf16 v[40:43], v[100:103], v[144:147], v[40:43]
    ds_read_b64_tr_b16 v[94:95], v3 offset:34560
    s_waitcnt lgkmcnt(6)
    v_mfma_f32_16x16x32_bf16 v[44:47], v[104:107], v[140:143], v[44:47]
    ds_read_b64_tr_b16 v[96:97], v15 offset:33568
    v_mfma_f32_16x16x32_bf16 v[48:51], v[104:107], v[144:147], v[48:51]
    ds_read_b64_tr_b16 v[98:99], v15 offset:34592
    s_waitcnt lgkmcnt(6)
    v_mfma_f32_16x16x32_bf16 v[52:55], v[84:87], v[140:143], v[52:55]
    ds_read_b64_tr_b16 v[100:101], v3 offset:40960
    v_mfma_f32_16x16x32_bf16 v[56:59], v[84:87], v[144:147], v[56:59]
    ds_read_b64_tr_b16 v[102:103], v3 offset:41984
    s_waitcnt lgkmcnt(6)
    v_mfma_f32_16x16x32_bf16 v[60:63], v[88:91], v[140:143], v[60:63]
    ds_read_b64_tr_b16 v[104:105], v15 offset:40992
    v_mfma_f32_16x16x32_bf16 v[64:67], v[88:91], v[144:147], v[64:67]
    s_add_u32 s22, s17, 0x800
    s_add_u32 m0, s17, 0x10800
    s_nop 0
    buffer_load_dwordx4 v5, s[8:11], s22 offen sc1 lds
    ds_read_b64_tr_b16 v[106:107], v15 offset:42016
    s_waitcnt lgkmcnt(6)
    v_mfma_f32_16x16x32_bf16 v[68:71], v[92:95], v[140:143], v[68:71]
    ds_read_b64_tr_b16 v[84:85], v3 offset:41216
    v_mfma_f32_16x16x32_bf16 v[72:75], v[92:95], v[144:147], v[72:75]
    ds_read_b64_tr_b16 v[86:87], v3 offset:42240
    s_waitcnt lgkmcnt(6)
    v_mfma_f32_16x16x32_bf16 v[76:79], v[96:99], v[140:143], v[76:79]
    ds_read_b64_tr_b16 v[88:89], v15 offset:41248
    v_mfma_f32_16x16x32_bf16 v[80:83], v[96:99], v[144:147], v[80:83]
    ds_read_b64_tr_b16 v[90:91], v15 offset:42272
    s_waitcnt vmcnt(12) lgkmcnt(6)
    v_mfma_f32_16x16x32_bf16 v[20:23], v[100:103], v[148:151], v[20:23]
    ds_read_b64_tr_b16 v[92:93], v3 offset:41472
    s_waitcnt vmcnt(10)
    v_mfma_f32_16x16x32_bf16 v[24:27], v[100:103], v[152:155], v[24:27]
    ds_read_b64_tr_b16 v[94:95], v3 offset:42496
    s_add_u32 s22, s17, 0x8000
    s_add_u32 m0, s17, 0x18000
    s_nop 0
    buffer_load_dwordx4 v5, s[8:11], s22 offen sc1 lds
    s_waitcnt lgkmcnt(6)
    v_mfma_f32_16x16x32_bf16 v[28:31], v[104:107], v[148:151], v[28:31]
    ds_read_b64_tr_b16 v[96:97], v15 offset:41504
    v_mfma_f32_16x16x32_bf16 v[32:35], v[104:107], v[152:155], v[32:35]
    s_add_u32 s22, s17, 0xc00
    s_add_u32 m0, s17, 0x10c00
    s_nop 0
    buffer_load_dwordx4 v5, s[8:11], s22 offen sc1 lds
    ds_read_b64_tr_b16 v[98:99], v15 offset:42528
    s_add_u32 s22, s17, 0x8400
    s_add_u32 m0, s17, 0x18400
    s_nop 0
    buffer_load_dwordx4 v5, s[8:11], s22 offen sc1 lds
    s_waitcnt lgkmcnt(6)
    v_mfma_f32_16x16x32_bf16 v[36:39], v[84:87], v[148:151], v[36:39]
    ds_read_b64_tr_b16 v[100:101], v3 offset:41728
    v_mfma_f32_16x16x32_bf16 v[40:43], v[84:87], v[152:155], v[40:43]
    ds_read_b64_tr_b16 v[102:103], v3 offset:42752
    s_add_u32 s22, s17, 0x8800
    s_add_u32 m0, s17, 0x18800
    s_nop 0
    buffer_load_dwordx4 v5, s[8:11], s22 offen sc1 lds
    s_waitcnt lgkmcnt(6)
    v_mfma_f32_16x16x32_bf16 v[44:47], v[88:91], v[148:151], v[44:47]
    ds_read_b64_tr_b16 v[104:105], v15 offset:41760
    v_mfma_f32_16x16x32_bf16 v[48:51], v[88:91], v[152:155], v[48:51]
    ds_read_b64_tr_b16 v[106:107], v15 offset:42784
    s_add_u32 s22, s17, 0x8c00
    s_add_u32 m0, s17, 0x18c00
    s_nop 0
    buffer_load_dwordx4 v5, s[8:11], s22 offen sc1 lds
    s_waitcnt lgkmcnt(6)
    v_mfma_f32_16x16x32_bf16 v[52:55], v[92:95], v[148:151], v[52:55]
    v_mfma_f32_16x16x32_bf16 v[56:59], v[92:95], v[152:155], v[56:59]
    s_waitcnt vmcnt(10)
    s_barrier
    ds_read_b64_tr_b16 v[84:85], v3 offset:49152
    ds_read_b64_tr_b16 v[86:87], v3 offset:50176
    s_add_u32 s22, s17, 0xc000
    s_add_u32 m0, s17, 0x1c000
    s_nop 0
    buffer_load_dwordx4 v5, s[8:11], s22 offen sc1 lds
    s_waitcnt lgkmcnt(6)
    v_mfma_f32_16x16x32_bf16 v[60:63], v[96:99], v[148:151], v[60:63]
    ds_read_b64_tr_b16 v[88:89], v15 offset:49184
    v_mfma_f32_16x16x32_bf16 v[64:67], v[96:99], v[152:155], v[64:67]
    s_add_u32 s22, s17, 0x4000
    s_add_u32 m0, s17, 0x14000
    s_nop 0
    buffer_load_dwordx4 v5, s[8:11], s22 offen sc1 lds
    ds_read_b64_tr_b16 v[90:91], v15 offset:50208
    s_add_u32 s22, s17, 0xc400
    s_add_u32 m0, s17, 0x1c400
    s_nop 0
    buffer_load_dwordx4 v5, s[8:11], s22 offen sc1 lds
    s_waitcnt lgkmcnt(6)
    v_mfma_f32_16x16x32_bf16 v[68:71], v[100:103], v[148:151], v[68:71]
    ds_read_b64_tr_b16 v[92:93], v3 offset:49408
    v_mfma_f32_16x16x32_bf16 v[72:75], v[100:103], v[152:155], v[72:75]
    ds_read_b64_tr_b16 v[94:95], v3 offset:50432
    s_add_u32 s22, s17, 0xc800
    s_add_u32 m0, s17, 0x1c800
    s_nop 0
    buffer_load_dwordx4 v5, s[8:11], s22 offen sc1 lds
    s_waitcnt lgkmcnt(6)
    v_mfma_f32_16x16x32_bf16 v[76:79], v[104:107], v[148:151], v[76:79]
    ds_read_b64_tr_b16 v[96:97], v15 offset:49440
    v_mfma_f32_16x16x32_bf16 v[80:83], v[104:107], v[152:155], v[80:83]
    ds_read_b64_tr_b16 v[98:99], v15 offset:50464
    s_add_u32 s22, s17, 0xcc00
    s_add_u32 m0, s17, 0x1cc00
    s_nop 0
    buffer_load_dwordx4 v5, s[8:11], s22 offen sc1 lds
    s_waitcnt lgkmcnt(6)
    v_mfma_f32_16x16x32_bf16 v[20:23], v[84:87], v[204:207], v[20:23]
    ds_read_b64_tr_b16 v[100:101], v3 offset:49664
    v_mfma_f32_16x16x32_bf16 v[24:27], v[84:87], v[208:211], v[24:27]
    ds_read_b64_tr_b16 v[102:103], v3 offset:50688
    s_waitcnt lgkmcnt(6)
    v_mfma_f32_16x16x32_bf16 v[28:31], v[88:91], v[204:207], v[28:31]
    ds_read_b64_tr_b16 v[104:105], v15 offset:49696
    v_mfma_f32_16x16x32_bf16 v[32:35], v[88:91], v[208:211], v[32:35]
    s_add_u32 s22, s17, 0x4400
    s_add_u32 m0, s17, 0x14400
    s_nop 0
    buffer_load_dwordx4 v5, s[8:11], s22 offen sc1 lds
    ds_read_b64_tr_b16 v[106:107], v15 offset:50720
    s_waitcnt lgkmcnt(6)
    v_mfma_f32_16x16x32_bf16 v[36:39], v[92:95], v[204:207], v[36:39]
    ds_read_b64_tr_b16 v[84:85], v3 offset:49920
    v_mfma_f32_16x16x32_bf16 v[40:43], v[92:95], v[208:211], v[40:43]
    ds_read_b64_tr_b16 v[86:87], v3 offset:50944
    s_waitcnt lgkmcnt(6)
    v_mfma_f32_16x16x32_bf16 v[44:47], v[96:99], v[204:207], v[44:47]
    ds_read_b64_tr_b16 v[88:89], v15 offset:49952
    v_mfma_f32_16x16x32_bf16 v[48:51], v[96:99], v[208:211], v[48:51]
    ds_read_b64_tr_b16 v[90:91], v15 offset:50976
    s_waitcnt lgkmcnt(6)
    v_mfma_f32_16x16x32_bf16 v[52:55], v[100:103], v[204:207], v[52:55]
    ds_read_b64_tr_b16 v[92:93], v3 offset:57344
    v_mfma_f32_16x16x32_bf16 v[56:59], v[100:103], v[208:211], v[56:59]
    ds_read_b64_tr_b16 v[94:95], v3 offset:58368
    s_waitcnt lgkmcnt(6)
    v_mfma_f32_16x16x32_bf16 v[60:63], v[104:107], v[204:207], v[60:63]
    ds_read_b64_tr_b16 v[96:97], v15 offset:57376
    v_mfma_f32_16x16x32_bf16 v[64:67], v[104:107], v[208:211], v[64:67]
    s_add_u32 s22, s17, 0x4800
    s_add_u32 m0, s17, 0x14800
    s_nop 0
    buffer_load_dwordx4 v5, s[8:11], s22 offen sc1 lds
    ds_read_b64_tr_b16 v[98:99], v15 offset:58400
    s_waitcnt lgkmcnt(6)
    v_mfma_f32_16x16x32_bf16 v[68:71], v[84:87], v[204:207], v[68:71]
    ds_read_b64_tr_b16 v[100:101], v3 offset:57600
    v_mfma_f32_16x16x32_bf16 v[72:75], v[84:87], v[208:211], v[72:75]
    ds_read_b64_tr_b16 v[102:103], v3 offset:58624
    s_waitcnt lgkmcnt(6)
    v_mfma_f32_16x16x32_bf16 v[76:79], v[88:91], v[204:207], v[76:79]
    ds_read_b64_tr_b16 v[104:105], v15 offset:57632
    v_mfma_f32_16x16x32_bf16 v[80:83], v[88:91], v[208:211], v[80:83]
    ds_read_b64_tr_b16 v[106:107], v15 offset:58656
    s_waitcnt vmcnt(16) lgkmcnt(6)
    v_mfma_f32_16x16x32_bf16 v[20:23], v[92:95], v[212:215], v[20:23]
    ds_read_b64_tr_b16 v[84:85], v3 offset:57856
    s_waitcnt vmcnt(14)
    v_mfma_f32_16x16x32_bf16 v[24:27], v[92:95], v[216:219], v[24:27]
    ds_read_b64_tr_b16 v[86:87], v3 offset:58880
    s_add_u32 s22, s17, 0x10000
    s_add_u32 m0, s17, 0x20000
    s_nop 0
    buffer_load_dwordx4 v5, s[8:11], s22 offen sc1 lds
    s_waitcnt lgkmcnt(6)
    v_mfma_f32_16x16x32_bf16 v[28:31], v[96:99], v[212:215], v[28:31]
    ds_read_b64_tr_b16 v[88:89], v15 offset:57888
    v_mfma_f32_16x16x32_bf16 v[32:35], v[96:99], v[216:219], v[32:35]
    s_add_u32 s22, s17, 0x4c00
    s_add_u32 m0, s17, 0x14c00
    s_nop 0
    buffer_load_dwordx4 v5, s[8:11], s22 offen sc1 lds
    ds_read_b64_tr_b16 v[90:91], v15 offset:58912
    s_add_u32 s22, s17, 0x10400
    s_add_u32 m0, s17, 0x20400
    s_nop 0
    buffer_load_dwordx4 v5, s[8:11], s22 offen sc1 lds
    s_waitcnt lgkmcnt(6)
    v_mfma_f32_16x16x32_bf16 v[36:39], v[100:103], v[212:215], v[36:39]
    ds_read_b64_tr_b16 v[92:93], v3 offset:58112
    v_mfma_f32_16x16x32_bf16 v[40:43], v[100:103], v[216:219], v[40:43]
    ds_read_b64_tr_b16 v[94:95], v3 offset:59136
    s_add_u32 s22, s17, 0x10800
    s_add_u32 m0, s17, 0x20800
    s_nop 0
    buffer_load_dwordx4 v5, s[8:11], s22 offen sc1 lds
    s_waitcnt lgkmcnt(6)
    v_mfma_f32_16x16x32_bf16 v[44:47], v[104:107], v[212:215], v[44:47]
    ds_read_b64_tr_b16 v[96:97], v15 offset:58144
    v_mfma_f32_16x16x32_bf16 v[48:51], v[104:107], v[216:219], v[48:51]
    ds_read_b64_tr_b16 v[98:99], v15 offset:59168
    s_add_u32 s22, s17, 0x10c00
    s_add_u32 m0, s17, 0x20c00
    s_nop 0
    buffer_load_dwordx4 v5, s[8:11], s22 offen sc1 lds
    s_waitcnt lgkmcnt(6)
    v_mfma_f32_16x16x32_bf16 v[52:55], v[84:87], v[212:215], v[52:55]
    v_mfma_f32_16x16x32_bf16 v[56:59], v[84:87], v[216:219], v[56:59]
    s_add_u32 s22, s17, 0x14000
    s_add_u32 m0, s17, 0x24000
    s_nop 0
    buffer_load_dwordx4 v5, s[8:11], s22 offen sc1 lds
    s_waitcnt lgkmcnt(4)
    v_mfma_f32_16x16x32_bf16 v[60:63], v[88:91], v[212:215], v[60:63]
    v_mfma_f32_16x16x32_bf16 v[64:67], v[88:91], v[216:219], v[64:67]
    s_add_u32 s22, s17, 0x14400
    s_add_u32 m0, s17, 0x24400
    s_nop 0
    buffer_load_dwordx4 v5, s[8:11], s22 offen sc1 lds
    s_waitcnt lgkmcnt(2)
    v_mfma_f32_16x16x32_bf16 v[68:71], v[92:95], v[212:215], v[68:71]
    v_mfma_f32_16x16x32_bf16 v[72:75], v[92:95], v[216:219], v[72:75]
    s_add_u32 s22, s17, 0x14800
    s_add_u32 m0, s17, 0x24800
    s_nop 0
    buffer_load_dwordx4 v5, s[8:11], s22 offen sc1 lds
    s_waitcnt lgkmcnt(0)
    v_mfma_f32_16x16x32_bf16 v[76:79], v[96:99], v[212:215], v[76:79]
    v_mfma_f32_16x16x32_bf16 v[80:83], v[96:99], v[216:219], v[80:83]
    s_add_u32 s22, s17, 0x14c00
    s_add_u32 m0, s17, 0x24c00
    s_nop 0
    buffer_load_dwordx4 v5, s[8:11], s22 offen sc1 lds
    s_mov_b32 s24, 0x3e0293ee
    v_mul_f32 v9, s24, v20
    v_mul_f32 v10, s24, v21
    v_cvt_pk_bf16_f32 v108, v9, v10
    v_mul_f32 v11, s24, v22
    v_mul_f32 v12, s24, v23
    v_cvt_pk_bf16_f32 v109, v11, v12
    v_mul_f32 v9, s24, v24
    v_mul_f32 v10, s24, v25
    v_cvt_pk_bf16_f32 v124, v9, v10
    v_mul_f32 v11, s24, v26
    v_mul_f32 v12, s24, v27
    v_cvt_pk_bf16_f32 v125, v11, v12
    v_mul_f32 v9, s24, v28
    v_mul_f32 v10, s24, v29
    v_cvt_pk_bf16_f32 v110, v9, v10
    v_mul_f32 v11, s24, v30
    v_mul_f32 v12, s24, v31
    v_cvt_pk_bf16_f32 v111, v11, v12
    v_mul_f32 v9, s24, v32
    v_mul_f32 v10, s24, v33
    v_cvt_pk_bf16_f32 v126, v9, v10
    v_mul_f32 v11, s24, v34
    v_mul_f32 v12, s24, v35
    v_cvt_pk_bf16_f32 v127, v11, v12
    v_mul_f32 v9, s24, v36
    v_mul_f32 v10, s24, v37
    v_cvt_pk_bf16_f32 v112, v9, v10
    v_mul_f32 v11, s24, v38
    v_mul_f32 v12, s24, v39
    v_cvt_pk_bf16_f32 v113, v11, v12
    v_mul_f32 v9, s24, v40
    v_mul_f32 v10, s24, v41
    v_cvt_pk_bf16_f32 v128, v9, v10
    v_mul_f32 v11, s24, v42
    v_mul_f32 v12, s24, v43
    v_cvt_pk_bf16_f32 v129, v11, v12
    v_mul_f32 v9, s24, v44
    v_mul_f32 v10, s24, v45
    v_cvt_pk_bf16_f32 v114, v9, v10
    v_mul_f32 v11, s24, v46
    v_mul_f32 v12, s24, v47
    v_cvt_pk_bf16_f32 v115, v11, v12
    v_mul_f32 v9, s24, v48
    v_mul_f32 v10, s24, v49
    v_cvt_pk_bf16_f32 v130, v9, v10
    v_mul_f32 v11, s24, v50
    v_mul_f32 v12, s24, v51
    v_cvt_pk_bf16_f32 v131, v11, v12
    v_mul_f32 v9, s24, v52
    v_mul_f32 v10, s24, v53
    v_cvt_pk_bf16_f32 v116, v9, v10
    v_mul_f32 v11, s24, v54
    v_mul_f32 v12, s24, v55
    v_cvt_pk_bf16_f32 v117, v11, v12
    v_mul_f32 v9, s24, v56
    v_mul_f32 v10, s24, v57
    v_cvt_pk_bf16_f32 v132, v9, v10
    v_mul_f32 v11, s24, v58
    v_mul_f32 v12, s24, v59
    v_cvt_pk_bf16_f32 v133, v11, v12
    v_mul_f32 v9, s24, v60
    v_mul_f32 v10, s24, v61
    v_cvt_pk_bf16_f32 v118, v9, v10
    v_mul_f32 v11, s24, v62
    v_mul_f32 v12, s24, v63
    v_cvt_pk_bf16_f32 v119, v11, v12
    v_mul_f32 v9, s24, v64
    v_mul_f32 v10, s24, v65
    v_cvt_pk_bf16_f32 v134, v9, v10
    v_mul_f32 v11, s24, v66
    v_mul_f32 v12, s24, v67
    v_cvt_pk_bf16_f32 v135, v11, v12
    v_mul_f32 v9, s24, v68
    v_mul_f32 v10, s24, v69
    v_cvt_pk_bf16_f32 v120, v9, v10
    v_mul_f32 v11, s24, v70
    v_mul_f32 v12, s24, v71
    v_cvt_pk_bf16_f32 v121, v11, v12
    v_mul_f32 v9, s24, v72
    v_mul_f32 v10, s24, v73
    v_cvt_pk_bf16_f32 v136, v9, v10
    v_mul_f32 v11, s24, v74
    v_mul_f32 v12, s24, v75
    v_cvt_pk_bf16_f32 v137, v11, v12
    v_mul_f32 v9, s24, v76
    v_mul_f32 v10, s24, v77
    v_cvt_pk_bf16_f32 v122, v9, v10
    v_mul_f32 v11, s24, v78
    v_mul_f32 v12, s24, v79
    v_cvt_pk_bf16_f32 v123, v11, v12
    v_mul_f32 v9, s24, v80
    v_mul_f32 v10, s24, v81
    v_cvt_pk_bf16_f32 v138, v9, v10
    v_mul_f32 v11, s24, v82
    v_mul_f32 v12, s24, v83
    v_cvt_pk_bf16_f32 v139, v11, v12
    v_add_u32 v2, 0x10000, v1
    v_add_u32 v3, 0x20000, v1
    s_and_b32 s62, s12, 24
    s_and_b32 s19, s12, 7
    s_lshl_b32 s20, s19, 2
    s_lshr_b32 s20, 0x54732160, s20
    s_and_b32 s20, s20, 7
    s_lshl_b32 s20, s20, 2
    s_bfm_b32 s21, s20, 0
    s_and_b32 s22, s21, 0x51764320
    s_lshl_b32 s22, s22, 4
    s_lshl_b32 s21, s21, 4
    s_or_b32 s21, s21, 15
    s_andn2_b32 s21, 0x51764320, s21
    s_or_b32 s42, s21, s22
    s_or_b32 s42, s42, s19
    s_add_u32 s19, s12, 1
    s_and_b32 s19, s19, 7
    s_lshl_b32 s19, s19, 8
    s_add_u32 s4, s40, s19
    s_addc_u32 s5, s41, 0
    s_sub_u32 s6, 0x800000, s19
    s_mov_b32 s7, 0x20000
    s_lshl_b32 s16, s3, 15
    v_bfe_u32 v9, v0, 2, 2
    v_lshrrev_b32 v10, 4, v0
    v_and_b32 v11, 3, v0
    v_lshlrev_b32 v17, 6, v10
    v_lshl_add_u32 v17, v11, 4, v17
    v_lshl_add_u32 v17, v9, 11, v17
    v_xor_b32 v18, 32, v17
    s_waitcnt vmcnt(19)
    s_barrier
    ds_read_b128 v[84:87], v2 offset:0
    ds_read_b128 v[88:91], v2 offset:1024
    ds_read_b128 v[92:95], v2 offset:2048
    ds_read_b128 v[96:99], v2 offset:3072
    s_waitcnt lgkmcnt(3)
    v_mfma_f32_16x16x32_bf16 v[140:143], v[84:87], v[108:111], 0
    v_mfma_f32_16x16x32_bf16 v[144:147], v[84:87], v[124:127], 0
    ds_read_b128 v[100:103], v2 offset:4096
    s_waitcnt lgkmcnt(3)
    v_mfma_f32_16x16x32_bf16 v[148:151], v[88:91], v[108:111], 0
    v_mfma_f32_16x16x32_bf16 v[152:155], v[88:91], v[124:127], 0
    ds_read_b128 v[104:107], v2 offset:5120
    s_waitcnt lgkmcnt(3)
    v_mfma_f32_16x16x32_bf16 v[140:143], v[92:95], v[112:115], v[140:143]
    v_mfma_f32_16x16x32_bf16 v[144:147], v[92:95], v[128:131], v[144:147]
    ds_read_b128 v[84:87], v2 offset:6144
    s_waitcnt lgkmcnt(3)
    v_mfma_f32_16x16x32_bf16 v[148:151], v[96:99], v[112:115], v[148:151]
    v_mfma_f32_16x16x32_bf16 v[152:155], v[96:99], v[128:131], v[152:155]
    ds_read_b128 v[88:91], v2 offset:7168
    s_waitcnt lgkmcnt(3)
    v_mfma_f32_16x16x32_bf16 v[140:143], v[100:103], v[116:119], v[140:143]
    v_mfma_f32_16x16x32_bf16 v[144:147], v[100:103], v[132:135], v[144:147]
    s_waitcnt vmcnt(7)
    s_barrier
    ds_read_b128 v[92:95], v2 offset:16384
    s_waitcnt lgkmcnt(3)
    v_mfma_f32_16x16x32_bf16 v[148:151], v[104:107], v[116:119], v[148:151]
    v_mfma_f32_16x16x32_bf16 v[152:155], v[104:107], v[132:135], v[152:155]
    ds_read_b128 v[96:99], v2 offset:17408
    s_waitcnt lgkmcnt(3)
    v_mfma_f32_16x16x32_bf16 v[140:143], v[84:87], v[120:123], v[140:143]
    v_mfma_f32_16x16x32_bf16 v[144:147], v[84:87], v[136:139], v[144:147]
    ds_read_b128 v[100:103], v2 offset:18432
    s_waitcnt lgkmcnt(3)
    v_mfma_f32_16x16x32_bf16 v[148:151], v[88:91], v[120:123], v[148:151]
    v_mfma_f32_16x16x32_bf16 v[152:155], v[88:91], v[136:139], v[152:155]
    ds_read_b128 v[104:107], v2 offset:19456
    s_waitcnt lgkmcnt(3)
    v_mfma_f32_16x16x32_bf16 v[156:159], v[92:95], v[108:111], 0
    v_mfma_f32_16x16x32_bf16 v[160:163], v[92:95], v[124:127], 0
    ds_read_b128 v[84:87], v2 offset:20480
    s_waitcnt lgkmcnt(3)
    v_mfma_f32_16x16x32_bf16 v[164:167], v[96:99], v[108:111], 0
    v_mfma_f32_16x16x32_bf16 v[168:171], v[96:99], v[124:127], 0
    ds_read_b128 v[88:91], v2 offset:21504
    s_waitcnt lgkmcnt(3)
    v_mfma_f32_16x16x32_bf16 v[156:159], v[100:103], v[112:115], v[156:159]
    v_mfma_f32_16x16x32_bf16 v[160:163], v[100:103], v[128:131], v[160:163]
    ds_read_b128 v[92:95], v2 offset:22528
    s_waitcnt lgkmcnt(3)
    v_mfma_f32_16x16x32_bf16 v[164:167], v[104:107], v[112:115], v[164:167]
    v_max3_f32 v9, v140, v141, v142
    v_mfma_f32_16x16x32_bf16 v[168:171], v[104:107], v[128:131], v[168:171]
    ds_read_b128 v[96:99], v2 offset:23552
    v_max3_f32 v9, v9, v143, v148
    s_waitcnt lgkmcnt(3)
    v_mfma_f32_16x16x32_bf16 v[156:159], v[84:87], v[116:119], v[156:159]
    v_max3_f32 v9, v9, v149, v150
    v_mfma_f32_16x16x32_bf16 v[160:163], v[84:87], v[132:135], v[160:163]
    s_barrier
    s_setprio 3
    ds_read_b128 v[100:103], v2 offset:32768
    v_max_f32 v9, v9, v151
    s_waitcnt lgkmcnt(3)
    v_mfma_f32_16x16x32_bf16 v[164:167], v[88:91], v[116:119], v[164:167]
    v_max3_f32 v10, v144, v145, v146
    v_mfma_f32_16x16x32_bf16 v[168:171], v[88:91], v[132:135], v[168:171]
    ds_read_b128 v[104:107], v2 offset:33792
    v_max3_f32 v10, v10, v147, v152
    s_waitcnt lgkmcnt(3)
    v_mfma_f32_16x16x32_bf16 v[156:159], v[92:95], v[120:123], v[156:159]
    v_max3_f32 v10, v10, v153, v154
    v_mfma_f32_16x16x32_bf16 v[160:163], v[92:95], v[136:139], v[160:163]
    ds_read_b128 v[84:87], v2 offset:34816
    v_max_f32 v10, v10, v155
    s_waitcnt lgkmcnt(3)
    v_mfma_f32_16x16x32_bf16 v[164:167], v[96:99], v[120:123], v[164:167]
    v_mfma_f32_16x16x32_bf16 v[168:171], v[96:99], v[136:139], v[168:171]
    ds_read_b128 v[88:91], v2 offset:35840
    v_max3_f32 v9, v9, v156, v157
    v_max3_f32 v9, v9, v158, v159
    s_nop 3
    v_max3_f32 v9, v9, v164, v165
    v_max3_f32 v9, v9, v166, v167
    v_max3_f32 v10, v10, v160, v161
    v_max3_f32 v10, v10, v162, v163
    v_max3_f32 v10, v10, v168, v169
    v_max3_f32 v10, v10, v170, v171
    v_mov_b32 v11, v9
    v_mov_b32 v12, v10
    s_nop 0
    v_permlane16_swap_b32 v9, v11
    v_permlane16_swap_b32 v10, v12
    v_max_f32 v9, v9, v11
    v_max_f32 v10, v10, v12
    v_mov_b32 v11, v9
    v_mov_b32 v12, v10
    s_nop 0
    v_permlane32_swap_b32 v9, v11
    v_permlane32_swap_b32 v10, v12
    v_max_f32 v9, v9, v11
    v_max_f32 v10, v10, v12
    v_sub_f32 v172, 0, v9
    v_sub_f32 v173, 0, v9
    v_sub_f32 v174, 0, v9
    v_sub_f32 v175, 0, v9
    v_sub_f32 v176, 0, v10
    v_sub_f32 v177, 0, v10
    v_sub_f32 v178, 0, v10
    v_sub_f32 v179, 0, v10
    v_add_f32 v140, v140, v172
    v_add_f32 v141, v141, v172
    v_exp_f32 v140, v140
    v_exp_f32 v141, v141
    s_nop 0
    v_add_f32 v15, v140, v141
    v_cvt_pk_bf16_f32 v188, v140, v141
    v_add_f32 v142, v142, v172
    v_add_f32 v143, v143, v172
    v_exp_f32 v142, v142
    v_exp_f32 v143, v143
    v_add_f32 v15, v15, v142
    v_add_f32 v15, v15, v143
    v_cvt_pk_bf16_f32 v189, v142, v143
    v_add_f32 v144, v144, v176
    v_add_f32 v145, v145, v176
    v_exp_f32 v144, v144
    v_exp_f32 v145, v145
    s_nop 0
    v_add_f32 v16, v144, v145
    v_cvt_pk_bf16_f32 v192, v144, v145
    v_add_f32 v146, v146, v176
    v_add_f32 v147, v147, v176
    v_exp_f32 v146, v146
    v_exp_f32 v147, v147
    v_add_f32 v16, v16, v146
    v_add_f32 v16, v16, v147
    v_cvt_pk_bf16_f32 v193, v146, v147
    v_add_f32 v148, v148, v172
    v_add_f32 v149, v149, v172
    v_exp_f32 v148, v148
    v_exp_f32 v149, v149
    v_add_f32 v15, v15, v148
    v_add_f32 v15, v15, v149
    v_cvt_pk_bf16_f32 v190, v148, v149
    v_add_f32 v150, v150, v172
    v_add_f32 v151, v151, v172
    v_exp_f32 v150, v150
    v_exp_f32 v151, v151
    v_add_f32 v15, v15, v150
    v_add_f32 v15, v15, v151
    v_cvt_pk_bf16_f32 v191, v150, v151
    v_add_f32 v152, v152, v176
    v_add_f32 v153, v153, v176
    v_exp_f32 v152, v152
    v_exp_f32 v153, v153
    v_add_f32 v16, v16, v152
    v_add_f32 v16, v16, v153
    v_cvt_pk_bf16_f32 v194, v152, v153
    v_add_f32 v154, v154, v176
    v_add_f32 v155, v155, v176
    v_exp_f32 v154, v154
    v_exp_f32 v155, v155
    v_add_f32 v16, v16, v154
    v_add_f32 v16, v16, v155
    v_cvt_pk_bf16_f32 v195, v154, v155
    s_waitcnt lgkmcnt(3)
    v_mfma_f32_16x16x32_bf16 v[140:143], v[100:103], v[108:111], v[172:175]
    v_add_f32 v156, v156, v172
    v_add_f32 v157, v157, v172
    v_mfma_f32_16x16x32_bf16 v[144:147], v[100:103], v[124:127], v[176:179]
    ds_read_b128 v[92:95], v2 offset:36864
    v_exp_f32 v156, v156
    v_exp_f32 v157, v157
    s_waitcnt lgkmcnt(3)
    v_mfma_f32_16x16x32_bf16 v[148:151], v[104:107], v[108:111], v[172:175]
    v_add_f32 v15, v15, v156
    v_add_f32 v15, v15, v157
    v_mfma_f32_16x16x32_bf16 v[152:155], v[104:107], v[124:127], v[176:179]
    ds_read_b128 v[96:99], v2 offset:37888
    v_cvt_pk_bf16_f32 v196, v156, v157
    s_waitcnt lgkmcnt(3)
    v_mfma_f32_16x16x32_bf16 v[140:143], v[84:87], v[112:115], v[140:143]
    v_add_f32 v158, v158, v172
    v_add_f32 v159, v159, v172
    v_mfma_f32_16x16x32_bf16 v[144:147], v[84:87], v[128:131], v[144:147]
    ds_read_b128 v[100:103], v2 offset:38912
    v_exp_f32 v158, v158
    v_exp_f32 v159, v159
    s_waitcnt lgkmcnt(3)
    v_mfma_f32_16x16x32_bf16 v[148:151], v[88:91], v[112:115], v[148:151]
    v_add_f32 v15, v15, v158
    v_add_f32 v15, v15, v159
    v_mfma_f32_16x16x32_bf16 v[152:155], v[88:91], v[128:131], v[152:155]
    ds_read_b128 v[104:107], v2 offset:39936
    v_cvt_pk_bf16_f32 v197, v158, v159
    s_waitcnt lgkmcnt(3)
    v_mfma_f32_16x16x32_bf16 v[140:143], v[92:95], v[116:119], v[140:143]
    v_add_f32 v160, v160, v176
    v_add_f32 v161, v161, v176
    v_mfma_f32_16x16x32_bf16 v[144:147], v[92:95], v[132:135], v[144:147]
    ds_read_b128 v[84:87], v2 offset:8192
    v_exp_f32 v160, v160
    v_exp_f32 v161, v161
    s_waitcnt lgkmcnt(3)
    v_mfma_f32_16x16x32_bf16 v[148:151], v[96:99], v[116:119], v[148:151]
    v_add_f32 v16, v16, v160
    v_add_f32 v16, v16, v161
    v_mfma_f32_16x16x32_bf16 v[152:155], v[96:99], v[132:135], v[152:155]
    ds_read_b128 v[88:91], v2 offset:9216
    v_cvt_pk_bf16_f32 v200, v160, v161
    s_waitcnt lgkmcnt(3)
    v_mfma_f32_16x16x32_bf16 v[140:143], v[100:103], v[120:123], v[140:143]
    v_add_f32 v162, v162, v176
    v_add_f32 v163, v163, v176
    v_mfma_f32_16x16x32_bf16 v[144:147], v[100:103], v[136:139], v[144:147]
    ds_read_b128 v[92:95], v2 offset:10240
    v_exp_f32 v162, v162
    v_exp_f32 v163, v163
    s_waitcnt lgkmcnt(3)
    v_mfma_f32_16x16x32_bf16 v[148:151], v[104:107], v[120:123], v[148:151]
    v_add_f32 v16, v16, v162
    v_add_f32 v16, v16, v163
    v_mfma_f32_16x16x32_bf16 v[152:155], v[104:107], v[136:139], v[152:155]
    ds_read_b128 v[96:99], v2 offset:11264
    v_cvt_pk_bf16_f32 v201, v162, v163
    s_waitcnt lgkmcnt(3)
    v_mfma_f32_16x16x32_bf16 v[20:23], v[84:87], v[188:191], 0
    v_add_f32 v164, v164, v172
    v_add_f32 v165, v165, v172
    v_mfma_f32_16x16x32_bf16 v[24:27], v[84:87], v[192:195], 0
    ds_read_b128 v[100:103], v2 offset:12288
    v_exp_f32 v164, v164
    v_exp_f32 v165, v165
    s_waitcnt lgkmcnt(3)
    v_mfma_f32_16x16x32_bf16 v[28:31], v[88:91], v[188:191], 0
    v_add_f32 v15, v15, v164
    v_add_f32 v15, v15, v165
    v_mfma_f32_16x16x32_bf16 v[32:35], v[88:91], v[192:195], 0
    ds_read_b128 v[104:107], v2 offset:13312
    v_cvt_pk_bf16_f32 v198, v164, v165
    s_waitcnt lgkmcnt(3)
    v_mfma_f32_16x16x32_bf16 v[36:39], v[92:95], v[188:191], 0
    v_add_f32 v166, v166, v172
    v_add_f32 v167, v167, v172
    v_mfma_f32_16x16x32_bf16 v[40:43], v[92:95], v[192:195], 0
    ds_read_b128 v[84:87], v2 offset:14336
    v_exp_f32 v166, v166
    v_exp_f32 v167, v167
    s_waitcnt lgkmcnt(3)
    v_mfma_f32_16x16x32_bf16 v[44:47], v[96:99], v[188:191], 0
    v_add_f32 v15, v15, v166
    v_add_f32 v15, v15, v167
    v_mfma_f32_16x16x32_bf16 v[48:51], v[96:99], v[192:195], 0
    ds_read_b128 v[88:91], v2 offset:15360
    v_cvt_pk_bf16_f32 v199, v166, v167
    s_waitcnt lgkmcnt(3)
    v_mfma_f32_16x16x32_bf16 v[52:55], v[100:103], v[188:191], 0
    v_add_f32 v168, v168, v176
    v_add_f32 v169, v169, v176
    v_mfma_f32_16x16x32_bf16 v[56:59], v[100:103], v[192:195], 0
    s_barrier
    ds_read_b128 v[92:95], v2 offset:49152
    v_exp_f32 v168, v168
    v_exp_f32 v169, v169
    s_waitcnt lgkmcnt(3)
    v_mfma_f32_16x16x32_bf16 v[60:63], v[104:107], v[188:191], 0
    v_add_f32 v16, v16, v168
    v_add_f32 v16, v16, v169
    v_mfma_f32_16x16x32_bf16 v[64:67], v[104:107], v[192:195], 0
    ds_read_b128 v[96:99], v2 offset:50176
    v_cvt_pk_bf16_f32 v202, v168, v169
    s_waitcnt lgkmcnt(3)
    v_mfma_f32_16x16x32_bf16 v[68:71], v[84:87], v[188:191], 0
    v_add_f32 v170, v170, v176
    v_add_f32 v171, v171, v176
    v_mfma_f32_16x16x32_bf16 v[72:75], v[84:87], v[192:195], 0
    ds_read_b128 v[100:103], v2 offset:51200
    v_exp_f32 v170, v170
    v_exp_f32 v171, v171
    s_waitcnt lgkmcnt(3)
    v_mfma_f32_16x16x32_bf16 v[76:79], v[88:91], v[188:191], 0
    v_add_f32 v16, v16, v170
    v_add_f32 v16, v16, v171
    v_mfma_f32_16x16x32_bf16 v[80:83], v[88:91], v[192:195], 0
    ds_read_b128 v[104:107], v2 offset:52224
    v_cvt_pk_bf16_f32 v203, v170, v171
    s_waitcnt lgkmcnt(3)
    v_mfma_f32_16x16x32_bf16 v[156:159], v[92:95], v[108:111], v[172:175]
    v_exp_f32 v140, v140
    v_exp_f32 v141, v141
    v_mfma_f32_16x16x32_bf16 v[160:163], v[92:95], v[124:127], v[176:179]
    ds_read_b128 v[84:87], v2 offset:53248
    v_add_f32 v15, v15, v140
    s_waitcnt lgkmcnt(3)
    v_mfma_f32_16x16x32_bf16 v[164:167], v[96:99], v[108:111], v[172:175]
    v_add_f32 v15, v15, v141
    v_mfma_f32_16x16x32_bf16 v[168:171], v[96:99], v[124:127], v[176:179]
    ds_read_b128 v[88:91], v2 offset:54272
    v_cvt_pk_bf16_f32 v188, v140, v141
    s_waitcnt lgkmcnt(3)
    v_mfma_f32_16x16x32_bf16 v[156:159], v[100:103], v[112:115], v[156:159]
    v_exp_f32 v142, v142
    v_exp_f32 v143, v143
    v_mfma_f32_16x16x32_bf16 v[160:163], v[100:103], v[128:131], v[160:163]
    ds_read_b128 v[92:95], v2 offset:55296
    v_add_f32 v15, v15, v142
    s_waitcnt lgkmcnt(3)
    v_mfma_f32_16x16x32_bf16 v[164:167], v[104:107], v[112:115], v[164:167]
    v_add_f32 v15, v15, v143
    v_mfma_f32_16x16x32_bf16 v[168:171], v[104:107], v[128:131], v[168:171]
    ds_read_b128 v[96:99], v2 offset:56320
    v_cvt_pk_bf16_f32 v189, v142, v143
    s_waitcnt lgkmcnt(3)
    v_mfma_f32_16x16x32_bf16 v[156:159], v[84:87], v[116:119], v[156:159]
    v_exp_f32 v144, v144
    v_exp_f32 v145, v145
    v_mfma_f32_16x16x32_bf16 v[160:163], v[84:87], v[132:135], v[160:163]
    ds_read_b128 v[100:103], v2 offset:24576
    v_add_f32 v16, v16, v144
    s_waitcnt lgkmcnt(3)
    v_mfma_f32_16x16x32_bf16 v[164:167], v[88:91], v[116:119], v[164:167]
    v_add_f32 v16, v16, v145
    v_mfma_f32_16x16x32_bf16 v[168:171], v[88:91], v[132:135], v[168:171]
    ds_read_b128 v[104:107], v2 offset:25600
    v_cvt_pk_bf16_f32 v192, v144, v145
    s_waitcnt lgkmcnt(3)
    v_mfma_f32_16x16x32_bf16 v[156:159], v[92:95], v[120:123], v[156:159]
    v_exp_f32 v146, v146
    v_exp_f32 v147, v147
    v_mfma_f32_16x16x32_bf16 v[160:163], v[92:95], v[136:139], v[160:163]
    ds_read_b128 v[84:87], v2 offset:26624
    v_add_f32 v16, v16, v146
    s_waitcnt lgkmcnt(3)
    v_mfma_f32_16x16x32_bf16 v[164:167], v[96:99], v[120:123], v[164:167]
    v_add_f32 v16, v16, v147
    v_mfma_f32_16x16x32_bf16 v[168:171], v[96:99], v[136:139], v[168:171]
    ds_read_b128 v[88:91], v2 offset:27648
    v_cvt_pk_bf16_f32 v193, v146, v147
    s_waitcnt lgkmcnt(3)
    v_mfma_f32_16x16x32_bf16 v[20:23], v[100:103], v[196:199], v[20:23]
    v_exp_f32 v148, v148
    v_exp_f32 v149, v149
    v_mfma_f32_16x16x32_bf16 v[24:27], v[100:103], v[200:203], v[24:27]
    ds_read_b128 v[92:95], v2 offset:28672
    v_add_f32 v15, v15, v148
    s_waitcnt lgkmcnt(3)
    v_mfma_f32_16x16x32_bf16 v[28:31], v[104:107], v[196:199], v[28:31]
    v_add_f32 v15, v15, v149
    v_mfma_f32_16x16x32_bf16 v[32:35], v[104:107], v[200:203], v[32:35]
    ds_read_b128 v[96:99], v2 offset:29696
    v_cvt_pk_bf16_f32 v190, v148, v149
    s_waitcnt lgkmcnt(3)
    v_mfma_f32_16x16x32_bf16 v[36:39], v[84:87], v[196:199], v[36:39]
    v_exp_f32 v150, v150
    v_exp_f32 v151, v151
    v_mfma_f32_16x16x32_bf16 v[40:43], v[84:87], v[200:203], v[40:43]
    ds_read_b128 v[100:103], v2 offset:30720
    v_add_f32 v15, v15, v150
    s_waitcnt lgkmcnt(3)
    v_mfma_f32_16x16x32_bf16 v[44:47], v[88:91], v[196:199], v[44:47]
    v_add_f32 v15, v15, v151
    v_mfma_f32_16x16x32_bf16 v[48:51], v[88:91], v[200:203], v[48:51]
    ds_read_b128 v[104:107], v2 offset:31744
    v_cvt_pk_bf16_f32 v191, v150, v151
    s_waitcnt lgkmcnt(3)
    v_mfma_f32_16x16x32_bf16 v[52:55], v[92:95], v[196:199], v[52:55]
    v_exp_f32 v152, v152
    v_exp_f32 v153, v153
    v_mfma_f32_16x16x32_bf16 v[56:59], v[92:95], v[200:203], v[56:59]
    s_waitcnt vmcnt(4)
    s_barrier
    ds_read_b128 v[84:87], v3 offset:0
    v_add_f32 v16, v16, v152
    s_waitcnt lgkmcnt(3)
    v_mfma_f32_16x16x32_bf16 v[60:63], v[96:99], v[196:199], v[60:63]
    v_add_f32 v16, v16, v153
    v_mfma_f32_16x16x32_bf16 v[64:67], v[96:99], v[200:203], v[64:67]
    s_add_u32 s22, s17, 0x18000
    s_add_u32 m0, s17, 0x10000
    s_nop 0
    buffer_load_dwordx4 v5, s[8:11], s22 offen sc1 lds
    ds_read_b128 v[88:91], v3 offset:1024
    v_cvt_pk_bf16_f32 v194, v152, v153
    s_waitcnt lgkmcnt(3)
    v_mfma_f32_16x16x32_bf16 v[68:71], v[100:103], v[196:199], v[68:71]
    v_exp_f32 v154, v154
    v_exp_f32 v155, v155
    v_mfma_f32_16x16x32_bf16 v[72:75], v[100:103], v[200:203], v[72:75]
    ds_read_b128 v[92:95], v3 offset:2048
    v_add_f32 v16, v16, v154
    s_waitcnt lgkmcnt(3)
    v_mfma_f32_16x16x32_bf16 v[76:79], v[104:107], v[196:199], v[76:79]
    v_add_f32 v16, v16, v155
    v_mfma_f32_16x16x32_bf16 v[80:83], v[104:107], v[200:203], v[80:83]
    s_add_u32 s22, s17, 0x18400
    s_add_u32 m0, s17, 0x10400
    s_nop 0
    buffer_load_dwordx4 v5, s[8:11], s22 offen sc1 lds
    ds_read_b128 v[96:99], v3 offset:3072
    v_cvt_pk_bf16_f32 v195, v154, v155
    s_waitcnt lgkmcnt(3)
    v_mfma_f32_16x16x32_bf16 v[140:143], v[84:87], v[108:111], v[172:175]
    v_exp_f32 v156, v156
    v_exp_f32 v157, v157
    v_mfma_f32_16x16x32_bf16 v[144:147], v[84:87], v[124:127], v[176:179]
    ds_read_b128 v[100:103], v3 offset:4096
    v_add_f32 v15, v15, v156
    s_waitcnt lgkmcnt(3)
    v_mfma_f32_16x16x32_bf16 v[148:151], v[88:91], v[108:111], v[172:175]
    v_add_f32 v15, v15, v157
    v_mfma_f32_16x16x32_bf16 v[152:155], v[88:91], v[124:127], v[176:179]
    s_add_u32 s22, s17, 0x18800
    s_add_u32 m0, s17, 0x10800
    s_nop 0
    buffer_load_dwordx4 v5, s[8:11], s22 offen sc1 lds
    ds_read_b128 v[104:107], v3 offset:5120
    v_cvt_pk_bf16_f32 v196, v156, v157
    s_waitcnt lgkmcnt(3)
    v_mfma_f32_16x16x32_bf16 v[140:143], v[92:95], v[112:115], v[140:143]
    v_exp_f32 v158, v158
    v_exp_f32 v159, v159
    v_mfma_f32_16x16x32_bf16 v[144:147], v[92:95], v[128:131], v[144:147]
    ds_read_b128 v[84:87], v3 offset:6144
    v_add_f32 v15, v15, v158
    s_waitcnt lgkmcnt(3)
    v_mfma_f32_16x16x32_bf16 v[148:151], v[96:99], v[112:115], v[148:151]
    v_add_f32 v15, v15, v159
    v_mfma_f32_16x16x32_bf16 v[152:155], v[96:99], v[128:131], v[152:155]
    s_add_u32 s22, s17, 0x18c00
    s_add_u32 m0, s17, 0x10c00
    s_nop 0
    buffer_load_dwordx4 v5, s[8:11], s22 offen sc1 lds
    ds_read_b128 v[88:91], v3 offset:7168
    v_cvt_pk_bf16_f32 v197, v158, v159
    s_waitcnt lgkmcnt(3)
    v_mfma_f32_16x16x32_bf16 v[140:143], v[100:103], v[116:119], v[140:143]
    v_exp_f32 v160, v160
    v_exp_f32 v161, v161
    v_mfma_f32_16x16x32_bf16 v[144:147], v[100:103], v[132:135], v[144:147]
    ds_read_b128 v[92:95], v2 offset:40960
    v_add_f32 v16, v16, v160
    s_waitcnt lgkmcnt(3)
    v_mfma_f32_16x16x32_bf16 v[148:151], v[104:107], v[116:119], v[148:151]
    v_add_f32 v16, v16, v161
    v_mfma_f32_16x16x32_bf16 v[152:155], v[104:107], v[132:135], v[152:155]
    ds_read_b128 v[96:99], v2 offset:41984
    v_cvt_pk_bf16_f32 v200, v160, v161
    s_waitcnt lgkmcnt(3)
    v_mfma_f32_16x16x32_bf16 v[140:143], v[84:87], v[120:123], v[140:143]
    v_exp_f32 v162, v162
    v_exp_f32 v163, v163
    v_mfma_f32_16x16x32_bf16 v[144:147], v[84:87], v[136:139], v[144:147]
    ds_read_b128 v[100:103], v2 offset:43008
    v_add_f32 v16, v16, v162
    s_waitcnt lgkmcnt(3)
    v_mfma_f32_16x16x32_bf16 v[148:151], v[88:91], v[120:123], v[148:151]
    v_add_f32 v16, v16, v163
    v_mfma_f32_16x16x32_bf16 v[152:155], v[88:91], v[136:139], v[152:155]
    ds_read_b128 v[104:107], v2 offset:44032
    v_cvt_pk_bf16_f32 v201, v162, v163
    s_waitcnt lgkmcnt(3)
    v_mfma_f32_16x16x32_bf16 v[20:23], v[92:95], v[188:191], v[20:23]
    v_exp_f32 v164, v164
    v_exp_f32 v165, v165
    v_mfma_f32_16x16x32_bf16 v[24:27], v[92:95], v[192:195], v[24:27]
    ds_read_b128 v[84:87], v2 offset:45056
    v_add_f32 v15, v15, v164
    s_waitcnt lgkmcnt(3)
    v_mfma_f32_16x16x32_bf16 v[28:31], v[96:99], v[188:191], v[28:31]
    v_add_f32 v15, v15, v165
    v_mfma_f32_16x16x32_bf16 v[32:35], v[96:99], v[192:195], v[32:35]
    ds_read_b128 v[88:91], v2 offset:46080
    v_cvt_pk_bf16_f32 v198, v164, v165
    s_waitcnt lgkmcnt(3)
    v_mfma_f32_16x16x32_bf16 v[36:39], v[100:103], v[188:191], v[36:39]
    v_exp_f32 v166, v166
    v_exp_f32 v167, v167
    v_mfma_f32_16x16x32_bf16 v[40:43], v[100:103], v[192:195], v[40:43]
    ds_read_b128 v[92:95], v2 offset:47104
    v_add_f32 v15, v15, v166
    s_waitcnt lgkmcnt(3)
    v_mfma_f32_16x16x32_bf16 v[44:47], v[104:107], v[188:191], v[44:47]
    v_add_f32 v15, v15, v167
    v_mfma_f32_16x16x32_bf16 v[48:51], v[104:107], v[192:195], v[48:51]
    ds_read_b128 v[96:99], v2 offset:48128
    v_cvt_pk_bf16_f32 v199, v166, v167
    v_lshrrev_b32 v6, 3, v8
    v_and_b32 v7, 7, v8
    s_mov_b64 s[64:65], s[50:51]
    s_mov_b32 s66, 0x700000
    s_mov_b32 s67, 0x20000
    v_mul_u32_u24 v19, 14336, v6
    v_lshl_add_u32 v19, v7, 4, v19
    s_and_b32 s24, s2, 7
    s_lshl_b32 s24, s24, 1
    s_lshr_b32 s26, s2, 7
    s_add_u32 s24, s24, s26
    s_mul_i32 s24, s24, 458752
    s_bfe_u32 s25, s2, 0x40003
    s_lshl_b32 s25, s25, 7
    s_add_u32 s24, s24, s25
    s_waitcnt lgkmcnt(3)
    v_mfma_f32_16x16x32_bf16 v[52:55], v[84:87], v[188:191], v[52:55]
    v_exp_f32 v168, v168
    v_exp_f32 v169, v169
    v_mfma_f32_16x16x32_bf16 v[56:59], v[84:87], v[192:195], v[56:59]
    s_waitcnt vmcnt(4)
    s_barrier
    ds_read_b128 v[100:103], v3 offset:16384
    v_add_f32 v16, v16, v168
    s_add_u32 s25, s24, 0
    buffer_load_dwordx4 v[204:207], v19, s[64:67], s25 offen
    s_waitcnt lgkmcnt(3)
    v_mfma_f32_16x16x32_bf16 v[60:63], v[88:91], v[188:191], v[60:63]
    v_add_f32 v16, v16, v169
    v_mfma_f32_16x16x32_bf16 v[64:67], v[88:91], v[192:195], v[64:67]
    s_add_u32 s22, s17, 0x1c000
    s_add_u32 m0, s17, 0x14000
    s_nop 0
    buffer_load_dwordx4 v5, s[8:11], s22 offen sc1 lds
    ds_read_b128 v[104:107], v3 offset:17408
    v_cvt_pk_bf16_f32 v202, v168, v169
    s_waitcnt lgkmcnt(3)
    v_mfma_f32_16x16x32_bf16 v[68:71], v[92:95], v[188:191], v[68:71]
    v_exp_f32 v170, v170
    v_exp_f32 v171, v171
    v_mfma_f32_16x16x32_bf16 v[72:75], v[92:95], v[192:195], v[72:75]
    ds_read_b128 v[84:87], v3 offset:18432
    v_add_f32 v16, v16, v170
    s_waitcnt lgkmcnt(3)
    v_mfma_f32_16x16x32_bf16 v[76:79], v[96:99], v[188:191], v[76:79]
    v_add_f32 v16, v16, v171
    v_mfma_f32_16x16x32_bf16 v[80:83], v[96:99], v[192:195], v[80:83]
    s_add_u32 s22, s17, 0x1c400
    s_add_u32 m0, s17, 0x14400
    s_nop 0
    buffer_load_dwordx4 v5, s[8:11], s22 offen sc1 lds
    ds_read_b128 v[88:91], v3 offset:19456
    v_cvt_pk_bf16_f32 v203, v170, v171
    s_waitcnt lgkmcnt(3)
    v_mfma_f32_16x16x32_bf16 v[156:159], v[100:103], v[108:111], v[172:175]
    v_exp_f32 v140, v140
    v_exp_f32 v141, v141
    v_mfma_f32_16x16x32_bf16 v[160:163], v[100:103], v[124:127], v[176:179]
    ds_read_b128 v[92:95], v3 offset:20480
    v_add_f32 v15, v15, v140
    s_waitcnt lgkmcnt(3)
    v_mfma_f32_16x16x32_bf16 v[164:167], v[104:107], v[108:111], v[172:175]
    v_add_f32 v15, v15, v141
    v_mfma_f32_16x16x32_bf16 v[168:171], v[104:107], v[124:127], v[176:179]
    s_add_u32 s22, s17, 0x1c800
    s_add_u32 m0, s17, 0x14800
    s_nop 0
    buffer_load_dwordx4 v5, s[8:11], s22 offen sc1 lds
    ds_read_b128 v[96:99], v3 offset:21504
    v_cvt_pk_bf16_f32 v188, v140, v141
    s_add_u32 s25, s24, 2048
    buffer_load_dwordx4 v[208:211], v19, s[64:67], s25 offen
    s_waitcnt lgkmcnt(3)
    v_mfma_f32_16x16x32_bf16 v[156:159], v[84:87], v[112:115], v[156:159]
    v_exp_f32 v142, v142
    v_exp_f32 v143, v143
    v_mfma_f32_16x16x32_bf16 v[160:163], v[84:87], v[128:131], v[160:163]
    ds_read_b128 v[100:103], v3 offset:22528
    v_add_f32 v15, v15, v142
    s_waitcnt lgkmcnt(3)
    v_mfma_f32_16x16x32_bf16 v[164:167], v[88:91], v[112:115], v[164:167]
    v_add_f32 v15, v15, v143
    v_mfma_f32_16x16x32_bf16 v[168:171], v[88:91], v[128:131], v[168:171]
    s_add_u32 s22, s17, 0x1cc00
    s_add_u32 m0, s17, 0x14c00
    s_nop 0
    buffer_load_dwordx4 v5, s[8:11], s22 offen sc1 lds
    ds_read_b128 v[104:107], v3 offset:23552
    v_cvt_pk_bf16_f32 v189, v142, v143
    s_waitcnt lgkmcnt(3)
    v_mfma_f32_16x16x32_bf16 v[156:159], v[92:95], v[116:119], v[156:159]
    v_exp_f32 v144, v144
    v_exp_f32 v145, v145
    v_mfma_f32_16x16x32_bf16 v[160:163], v[92:95], v[132:135], v[160:163]
    ds_read_b128 v[84:87], v2 offset:57344
    v_add_f32 v16, v16, v144
    s_waitcnt lgkmcnt(3)
    v_mfma_f32_16x16x32_bf16 v[164:167], v[96:99], v[116:119], v[164:167]
    v_add_f32 v16, v16, v145
    v_mfma_f32_16x16x32_bf16 v[168:171], v[96:99], v[132:135], v[168:171]
    ds_read_b128 v[88:91], v2 offset:58368
    v_cvt_pk_bf16_f32 v192, v144, v145
    s_waitcnt lgkmcnt(3)
    v_mfma_f32_16x16x32_bf16 v[156:159], v[100:103], v[120:123], v[156:159]
    v_exp_f32 v146, v146
    v_exp_f32 v147, v147
    v_mfma_f32_16x16x32_bf16 v[160:163], v[100:103], v[136:139], v[160:163]
    ds_read_b128 v[92:95], v2 offset:59392
    v_add_f32 v16, v16, v146
    s_waitcnt lgkmcnt(3)
    v_mfma_f32_16x16x32_bf16 v[164:167], v[104:107], v[120:123], v[164:167]
    v_add_f32 v16, v16, v147
    v_mfma_f32_16x16x32_bf16 v[168:171], v[104:107], v[136:139], v[168:171]
    ds_read_b128 v[96:99], v2 offset:60416
    v_cvt_pk_bf16_f32 v193, v146, v147
    s_add_u32 s25, s24, 4096
    buffer_load_dwordx4 v[212:215], v19, s[64:67], s25 offen
    s_waitcnt lgkmcnt(3)
    v_mfma_f32_16x16x32_bf16 v[20:23], v[84:87], v[196:199], v[20:23]
    v_exp_f32 v148, v148
    v_exp_f32 v149, v149
    v_mfma_f32_16x16x32_bf16 v[24:27], v[84:87], v[200:203], v[24:27]
    ds_read_b128 v[100:103], v2 offset:61440
    v_add_f32 v15, v15, v148
    s_waitcnt lgkmcnt(3)
    v_mfma_f32_16x16x32_bf16 v[28:31], v[88:91], v[196:199], v[28:31]
    v_add_f32 v15, v15, v149
    v_mfma_f32_16x16x32_bf16 v[32:35], v[88:91], v[200:203], v[32:35]
    ds_read_b128 v[104:107], v2 offset:62464
    v_cvt_pk_bf16_f32 v190, v148, v149
    s_waitcnt lgkmcnt(3)
    v_mfma_f32_16x16x32_bf16 v[36:39], v[92:95], v[196:199], v[36:39]
    v_exp_f32 v150, v150
    v_exp_f32 v151, v151
    v_mfma_f32_16x16x32_bf16 v[40:43], v[92:95], v[200:203], v[40:43]
    ds_read_b128 v[84:87], v2 offset:63488
    v_add_f32 v15, v15, v150
    s_waitcnt lgkmcnt(3)
    v_mfma_f32_16x16x32_bf16 v[44:47], v[96:99], v[196:199], v[44:47]
    v_add_f32 v15, v15, v151
    v_mfma_f32_16x16x32_bf16 v[48:51], v[96:99], v[200:203], v[48:51]
    ds_read_b128 v[88:91], v2 offset:64512
    v_cvt_pk_bf16_f32 v191, v150, v151
    s_waitcnt lgkmcnt(3)
    v_mfma_f32_16x16x32_bf16 v[52:55], v[100:103], v[196:199], v[52:55]
    v_exp_f32 v152, v152
    v_exp_f32 v153, v153
    v_mfma_f32_16x16x32_bf16 v[56:59], v[100:103], v[200:203], v[56:59]
    s_waitcnt vmcnt(7)
    s_barrier
    ds_read_b128 v[92:95], v2 offset:0
    v_add_f32 v16, v16, v152
    s_waitcnt lgkmcnt(3)
    v_mfma_f32_16x16x32_bf16 v[60:63], v[104:107], v[196:199], v[60:63]
    v_add_f32 v16, v16, v153
    v_mfma_f32_16x16x32_bf16 v[64:67], v[104:107], v[200:203], v[64:67]
    s_add_u32 s22, s17, 0x20000
    s_add_u32 m0, s17, 0x18000
    s_nop 0
    buffer_load_dwordx4 v5, s[8:11], s22 offen sc1 lds
    ds_read_b128 v[96:99], v2 offset:1024
    v_cvt_pk_bf16_f32 v194, v152, v153
    s_add_u32 s25, s24, 6144
    buffer_load_dwordx4 v[216:219], v19, s[64:67], s25 offen
    s_waitcnt lgkmcnt(3)
    v_mfma_f32_16x16x32_bf16 v[68:71], v[84:87], v[196:199], v[68:71]
    v_exp_f32 v154, v154
    v_exp_f32 v155, v155
    v_mfma_f32_16x16x32_bf16 v[72:75], v[84:87], v[200:203], v[72:75]
    ds_read_b128 v[100:103], v2 offset:2048
    v_add_f32 v16, v16, v154
    s_waitcnt lgkmcnt(3)
    v_mfma_f32_16x16x32_bf16 v[76:79], v[88:91], v[196:199], v[76:79]
    v_add_f32 v16, v16, v155
    v_mfma_f32_16x16x32_bf16 v[80:83], v[88:91], v[200:203], v[80:83]
    s_add_u32 s22, s17, 0x20400
    s_add_u32 m0, s17, 0x18400
    s_nop 0
    buffer_load_dwordx4 v5, s[8:11], s22 offen sc1 lds
    ds_read_b128 v[104:107], v2 offset:3072
    v_cvt_pk_bf16_f32 v195, v154, v155
    s_waitcnt lgkmcnt(3)
    v_mfma_f32_16x16x32_bf16 v[140:143], v[92:95], v[108:111], v[172:175]
    v_exp_f32 v156, v156
    v_exp_f32 v157, v157
    v_mfma_f32_16x16x32_bf16 v[144:147], v[92:95], v[124:127], v[176:179]
    ds_read_b128 v[84:87], v2 offset:4096
    v_add_f32 v15, v15, v156
    s_waitcnt lgkmcnt(3)
    v_mfma_f32_16x16x32_bf16 v[148:151], v[96:99], v[108:111], v[172:175]
    v_add_f32 v15, v15, v157
    v_mfma_f32_16x16x32_bf16 v[152:155], v[96:99], v[124:127], v[176:179]
    s_add_u32 s22, s17, 0x20800
    s_add_u32 m0, s17, 0x18800
    s_nop 0
    buffer_load_dwordx4 v5, s[8:11], s22 offen sc1 lds
    ds_read_b128 v[88:91], v2 offset:5120
    v_cvt_pk_bf16_f32 v196, v156, v157
    s_waitcnt lgkmcnt(3)
    v_mfma_f32_16x16x32_bf16 v[140:143], v[100:103], v[112:115], v[140:143]
    v_exp_f32 v158, v158
    v_exp_f32 v159, v159
    v_mfma_f32_16x16x32_bf16 v[144:147], v[100:103], v[128:131], v[144:147]
    ds_read_b128 v[92:95], v2 offset:6144
    v_add_f32 v15, v15, v158
    s_add_u32 s25, s24, 8192
    buffer_load_dwordx4 v[220:223], v19, s[64:67], s25 offen
    s_waitcnt lgkmcnt(3)
    v_mfma_f32_16x16x32_bf16 v[148:151], v[104:107], v[112:115], v[148:151]
    v_add_f32 v15, v15, v159
    v_mfma_f32_16x16x32_bf16 v[152:155], v[104:107], v[128:131], v[152:155]
    s_add_u32 s22, s17, 0x20c00
    s_add_u32 m0, s17, 0x18c00
    s_nop 0
    buffer_load_dwordx4 v5, s[8:11], s22 offen sc1 lds
    ds_read_b128 v[96:99], v2 offset:7168
    v_cvt_pk_bf16_f32 v197, v158, v159
    s_waitcnt lgkmcnt(3)
    v_mfma_f32_16x16x32_bf16 v[140:143], v[84:87], v[116:119], v[140:143]
    v_exp_f32 v160, v160
    v_exp_f32 v161, v161
    v_mfma_f32_16x16x32_bf16 v[144:147], v[84:87], v[132:135], v[144:147]
    ds_read_b128 v[100:103], v3 offset:8192
    v_add_f32 v16, v16, v160
    s_waitcnt lgkmcnt(3)
    v_mfma_f32_16x16x32_bf16 v[148:151], v[88:91], v[116:119], v[148:151]
    v_add_f32 v16, v16, v161
    v_mfma_f32_16x16x32_bf16 v[152:155], v[88:91], v[132:135], v[152:155]
    ds_read_b128 v[104:107], v3 offset:9216
    v_cvt_pk_bf16_f32 v200, v160, v161
    s_waitcnt lgkmcnt(3)
    v_mfma_f32_16x16x32_bf16 v[140:143], v[92:95], v[120:123], v[140:143]
    v_exp_f32 v162, v162
    v_exp_f32 v163, v163
    v_mfma_f32_16x16x32_bf16 v[144:147], v[92:95], v[136:139], v[144:147]
    ds_read_b128 v[84:87], v3 offset:10240
    v_add_f32 v16, v16, v162
    s_waitcnt lgkmcnt(3)
    v_mfma_f32_16x16x32_bf16 v[148:151], v[96:99], v[120:123], v[148:151]
    v_add_f32 v16, v16, v163
    v_mfma_f32_16x16x32_bf16 v[152:155], v[96:99], v[136:139], v[152:155]
    ds_read_b128 v[88:91], v3 offset:11264
    v_cvt_pk_bf16_f32 v201, v162, v163
    s_waitcnt lgkmcnt(3)
    v_mfma_f32_16x16x32_bf16 v[20:23], v[100:103], v[188:191], v[20:23]
    v_exp_f32 v164, v164
    v_exp_f32 v165, v165
    v_mfma_f32_16x16x32_bf16 v[24:27], v[100:103], v[192:195], v[24:27]
    ds_read_b128 v[92:95], v3 offset:12288
    v_add_f32 v15, v15, v164
    s_add_u32 s25, s24, 10240
    buffer_load_dwordx4 v[224:227], v19, s[64:67], s25 offen
    s_waitcnt lgkmcnt(3)
    v_mfma_f32_16x16x32_bf16 v[28:31], v[104:107], v[188:191], v[28:31]
    v_add_f32 v15, v15, v165
    v_mfma_f32_16x16x32_bf16 v[32:35], v[104:107], v[192:195], v[32:35]
    ds_read_b128 v[96:99], v3 offset:13312
    v_cvt_pk_bf16_f32 v198, v164, v165
    s_waitcnt lgkmcnt(3)
    v_mfma_f32_16x16x32_bf16 v[36:39], v[84:87], v[188:191], v[36:39]
    v_exp_f32 v166, v166
    v_exp_f32 v167, v167
    v_mfma_f32_16x16x32_bf16 v[40:43], v[84:87], v[192:195], v[40:43]
    ds_read_b128 v[100:103], v3 offset:14336
    v_add_f32 v15, v15, v166
    s_waitcnt lgkmcnt(3)
    v_mfma_f32_16x16x32_bf16 v[44:47], v[88:91], v[188:191], v[44:47]
    v_add_f32 v15, v15, v167
    v_mfma_f32_16x16x32_bf16 v[48:51], v[88:91], v[192:195], v[48:51]
    ds_read_b128 v[104:107], v3 offset:15360
    v_cvt_pk_bf16_f32 v199, v166, v167
    s_waitcnt lgkmcnt(3)
    v_mfma_f32_16x16x32_bf16 v[52:55], v[92:95], v[188:191], v[52:55]
    v_exp_f32 v168, v168
    v_exp_f32 v169, v169
    v_mfma_f32_16x16x32_bf16 v[56:59], v[92:95], v[192:195], v[56:59]
    s_waitcnt vmcnt(8)
    s_barrier
    ds_read_b128 v[84:87], v2 offset:16384
    v_add_f32 v16, v16, v168
    s_waitcnt lgkmcnt(3)
    v_mfma_f32_16x16x32_bf16 v[60:63], v[96:99], v[188:191], v[60:63]
    v_add_f32 v16, v16, v169
    v_mfma_f32_16x16x32_bf16 v[64:67], v[96:99], v[192:195], v[64:67]
    s_add_u32 s22, s17, 0x24000
    s_add_u32 m0, s17, 0x1c000
    s_nop 0
    buffer_load_dwordx4 v5, s[8:11], s22 offen sc1 lds
    ds_read_b128 v[88:91], v2 offset:17408
    v_cvt_pk_bf16_f32 v202, v168, v169
    s_waitcnt lgkmcnt(3)
    v_mfma_f32_16x16x32_bf16 v[68:71], v[100:103], v[188:191], v[68:71]
    v_exp_f32 v170, v170
    v_exp_f32 v171, v171
    v_mfma_f32_16x16x32_bf16 v[72:75], v[100:103], v[192:195], v[72:75]
    ds_read_b128 v[92:95], v2 offset:18432
    v_add_f32 v16, v16, v170
    s_add_u32 s25, s24, 12288
    buffer_load_dwordx4 v[228:231], v19, s[64:67], s25 offen
    s_waitcnt lgkmcnt(3)
    v_mfma_f32_16x16x32_bf16 v[76:79], v[104:107], v[188:191], v[76:79]
    v_add_f32 v16, v16, v171
    v_mfma_f32_16x16x32_bf16 v[80:83], v[104:107], v[192:195], v[80:83]
    s_add_u32 s22, s17, 0x24400
    s_add_u32 m0, s17, 0x1c400
    s_nop 0
    buffer_load_dwordx4 v5, s[8:11], s22 offen sc1 lds
    ds_read_b128 v[96:99], v2 offset:19456
    v_cvt_pk_bf16_f32 v203, v170, v171
    s_waitcnt lgkmcnt(3)
    v_mfma_f32_16x16x32_bf16 v[156:159], v[84:87], v[108:111], v[172:175]
    v_exp_f32 v140, v140
    v_exp_f32 v141, v141
    v_mfma_f32_16x16x32_bf16 v[160:163], v[84:87], v[124:127], v[176:179]
    ds_read_b128 v[100:103], v2 offset:20480
    v_add_f32 v15, v15, v140
    s_waitcnt lgkmcnt(3)
    v_mfma_f32_16x16x32_bf16 v[164:167], v[88:91], v[108:111], v[172:175]
    v_add_f32 v15, v15, v141
    v_mfma_f32_16x16x32_bf16 v[168:171], v[88:91], v[124:127], v[176:179]
    s_add_u32 s22, s17, 0x24800
    s_add_u32 m0, s17, 0x1c800
    s_nop 0
    buffer_load_dwordx4 v5, s[8:11], s22 offen sc1 lds
    ds_read_b128 v[104:107], v2 offset:21504
    v_cvt_pk_bf16_f32 v188, v140, v141
    s_waitcnt lgkmcnt(3)
    v_mfma_f32_16x16x32_bf16 v[156:159], v[92:95], v[112:115], v[156:159]
    v_exp_f32 v142, v142
    v_exp_f32 v143, v143
    v_mfma_f32_16x16x32_bf16 v[160:163], v[92:95], v[128:131], v[160:163]
    ds_read_b128 v[84:87], v2 offset:22528
    v_add_f32 v15, v15, v142
    s_waitcnt lgkmcnt(3)
    v_mfma_f32_16x16x32_bf16 v[164:167], v[96:99], v[112:115], v[164:167]
    v_add_f32 v15, v15, v143
    v_mfma_f32_16x16x32_bf16 v[168:171], v[96:99], v[128:131], v[168:171]
    s_add_u32 s22, s17, 0x24c00
    s_add_u32 m0, s17, 0x1cc00
    s_nop 0
    buffer_load_dwordx4 v5, s[8:11], s22 offen sc1 lds
    ds_read_b128 v[88:91], v2 offset:23552
    v_cvt_pk_bf16_f32 v189, v142, v143
    s_waitcnt lgkmcnt(3)
    v_mfma_f32_16x16x32_bf16 v[156:159], v[100:103], v[116:119], v[156:159]
    v_exp_f32 v144, v144
    v_exp_f32 v145, v145
    v_mfma_f32_16x16x32_bf16 v[160:163], v[100:103], v[132:135], v[160:163]
    ds_read_b128 v[92:95], v3 offset:24576
    v_add_f32 v16, v16, v144
    s_waitcnt lgkmcnt(3)
    v_mfma_f32_16x16x32_bf16 v[164:167], v[104:107], v[116:119], v[164:167]
    v_add_f32 v16, v16, v145
    v_mfma_f32_16x16x32_bf16 v[168:171], v[104:107], v[132:135], v[168:171]
    ds_read_b128 v[96:99], v3 offset:25600
    v_cvt_pk_bf16_f32 v192, v144, v145
    s_waitcnt lgkmcnt(3)
    v_mfma_f32_16x16x32_bf16 v[156:159], v[84:87], v[120:123], v[156:159]
    v_exp_f32 v146, v146
    v_exp_f32 v147, v147
    v_mfma_f32_16x16x32_bf16 v[160:163], v[84:87], v[136:139], v[160:163]
    ds_read_b128 v[100:103], v3 offset:26624
    v_add_f32 v16, v16, v146
    s_waitcnt lgkmcnt(3)
    v_mfma_f32_16x16x32_bf16 v[164:167], v[88:91], v[120:123], v[164:167]
    v_add_f32 v16, v16, v147
    v_mfma_f32_16x16x32_bf16 v[168:171], v[88:91], v[136:139], v[168:171]
    ds_read_b128 v[104:107], v3 offset:27648
    v_cvt_pk_bf16_f32 v193, v146, v147
    s_waitcnt lgkmcnt(3)
    v_mfma_f32_16x16x32_bf16 v[20:23], v[92:95], v[196:199], v[20:23]
    v_exp_f32 v148, v148
    v_exp_f32 v149, v149
    v_mfma_f32_16x16x32_bf16 v[24:27], v[92:95], v[200:203], v[24:27]
    ds_read_b128 v[84:87], v3 offset:28672
    v_add_f32 v15, v15, v148
    s_waitcnt lgkmcnt(3)
    v_mfma_f32_16x16x32_bf16 v[28:31], v[96:99], v[196:199], v[28:31]
    v_add_f32 v15, v15, v149
    v_mfma_f32_16x16x32_bf16 v[32:35], v[96:99], v[200:203], v[32:35]
    ds_read_b128 v[88:91], v3 offset:29696
    v_cvt_pk_bf16_f32 v190, v148, v149
    s_waitcnt lgkmcnt(3)
    v_mfma_f32_16x16x32_bf16 v[36:39], v[100:103], v[196:199], v[36:39]
    v_exp_f32 v150, v150
    v_exp_f32 v151, v151
    v_mfma_f32_16x16x32_bf16 v[40:43], v[100:103], v[200:203], v[40:43]
    ds_read_b128 v[92:95], v3 offset:30720
    v_add_f32 v15, v15, v150
    s_waitcnt lgkmcnt(3)
    v_mfma_f32_16x16x32_bf16 v[44:47], v[104:107], v[196:199], v[44:47]
    v_add_f32 v15, v15, v151
    v_mfma_f32_16x16x32_bf16 v[48:51], v[104:107], v[200:203], v[48:51]
    ds_read_b128 v[96:99], v3 offset:31744
    v_cvt_pk_bf16_f32 v191, v150, v151
    s_waitcnt lgkmcnt(3)
    v_mfma_f32_16x16x32_bf16 v[52:55], v[84:87], v[196:199], v[52:55]
    v_exp_f32 v152, v152
    v_exp_f32 v153, v153
    v_mfma_f32_16x16x32_bf16 v[56:59], v[84:87], v[200:203], v[56:59]
    s_waitcnt vmcnt(6)
    s_barrier
    ds_read_b128 v[100:103], v2 offset:32768
    v_add_f32 v16, v16, v152
    s_waitcnt lgkmcnt(3)
    v_mfma_f32_16x16x32_bf16 v[60:63], v[88:91], v[196:199], v[60:63]
    v_add_f32 v16, v16, v153
    v_mfma_f32_16x16x32_bf16 v[64:67], v[88:91], v[200:203], v[64:67]
    s_add_u32 s22, s17, 0x28000
    s_add_u32 m0, s17, 0x20000
    s_nop 0
    buffer_load_dwordx4 v5, s[8:11], s22 offen sc1 lds
    ds_read_b128 v[104:107], v2 offset:33792
    v_cvt_pk_bf16_f32 v194, v152, v153
    s_waitcnt lgkmcnt(3)
    v_mfma_f32_16x16x32_bf16 v[68:71], v[92:95], v[196:199], v[68:71]
    v_exp_f32 v154, v154
    v_exp_f32 v155, v155
    v_mfma_f32_16x16x32_bf16 v[72:75], v[92:95], v[200:203], v[72:75]
    ds_read_b128 v[84:87], v2 offset:34816
    v_add_f32 v16, v16, v154
    s_waitcnt lgkmcnt(3)
    v_mfma_f32_16x16x32_bf16 v[76:79], v[96:99], v[196:199], v[76:79]
    v_add_f32 v16, v16, v155
    v_mfma_f32_16x16x32_bf16 v[80:83], v[96:99], v[200:203], v[80:83]
    s_add_u32 s22, s17, 0x28400
    s_add_u32 m0, s17, 0x20400
    s_nop 0
    buffer_load_dwordx4 v5, s[8:11], s22 offen sc1 lds
    ds_read_b128 v[88:91], v2 offset:35840
    v_cvt_pk_bf16_f32 v195, v154, v155
    s_waitcnt lgkmcnt(3)
    v_mfma_f32_16x16x32_bf16 v[140:143], v[100:103], v[108:111], v[172:175]
    v_exp_f32 v156, v156
    v_exp_f32 v157, v157
    v_mfma_f32_16x16x32_bf16 v[144:147], v[100:103], v[124:127], v[176:179]
    ds_read_b128 v[92:95], v2 offset:36864
    v_add_f32 v15, v15, v156
    s_waitcnt lgkmcnt(3)
    v_mfma_f32_16x16x32_bf16 v[148:151], v[104:107], v[108:111], v[172:175]
    v_add_f32 v15, v15, v157
    v_mfma_f32_16x16x32_bf16 v[152:155], v[104:107], v[124:127], v[176:179]
    s_add_u32 s22, s17, 0x28800
    s_add_u32 m0, s17, 0x20800
    s_nop 0
    buffer_load_dwordx4 v5, s[8:11], s22 offen sc1 lds
    ds_read_b128 v[96:99], v2 offset:37888
    v_cvt_pk_bf16_f32 v196, v156, v157
    s_waitcnt lgkmcnt(3)
    v_mfma_f32_16x16x32_bf16 v[140:143], v[84:87], v[112:115], v[140:143]
    v_exp_f32 v158, v158
    v_exp_f32 v159, v159
    v_mfma_f32_16x16x32_bf16 v[144:147], v[84:87], v[128:131], v[144:147]
    ds_read_b128 v[100:103], v2 offset:38912
    v_add_f32 v15, v15, v158
    s_waitcnt lgkmcnt(3)
    v_mfma_f32_16x16x32_bf16 v[148:151], v[88:91], v[112:115], v[148:151]
    v_add_f32 v15, v15, v159
    v_mfma_f32_16x16x32_bf16 v[152:155], v[88:91], v[128:131], v[152:155]
    s_add_u32 s22, s17, 0x28c00
    s_add_u32 m0, s17, 0x20c00
    s_nop 0
    buffer_load_dwordx4 v5, s[8:11], s22 offen sc1 lds
    ds_read_b128 v[104:107], v2 offset:39936
    v_cvt_pk_bf16_f32 v197, v158, v159
    s_waitcnt lgkmcnt(3)
    v_mfma_f32_16x16x32_bf16 v[140:143], v[92:95], v[116:119], v[140:143]
    v_exp_f32 v160, v160
    v_exp_f32 v161, v161
    v_mfma_f32_16x16x32_bf16 v[144:147], v[92:95], v[132:135], v[144:147]
    ds_read_b128 v[84:87], v2 offset:8192
    v_add_f32 v16, v16, v160
    s_waitcnt lgkmcnt(3)
    v_mfma_f32_16x16x32_bf16 v[148:151], v[96:99], v[116:119], v[148:151]
    v_add_f32 v16, v16, v161
    v_mfma_f32_16x16x32_bf16 v[152:155], v[96:99], v[132:135], v[152:155]
    ds_read_b128 v[88:91], v2 offset:9216
    v_cvt_pk_bf16_f32 v200, v160, v161
    s_waitcnt lgkmcnt(3)
    v_mfma_f32_16x16x32_bf16 v[140:143], v[100:103], v[120:123], v[140:143]
    v_exp_f32 v162, v162
    v_exp_f32 v163, v163
    v_mfma_f32_16x16x32_bf16 v[144:147], v[100:103], v[136:139], v[144:147]
    ds_read_b128 v[92:95], v2 offset:10240
    v_add_f32 v16, v16, v162
    s_waitcnt lgkmcnt(3)
    v_mfma_f32_16x16x32_bf16 v[148:151], v[104:107], v[120:123], v[148:151]
    v_add_f32 v16, v16, v163
    v_mfma_f32_16x16x32_bf16 v[152:155], v[104:107], v[136:139], v[152:155]
    ds_read_b128 v[96:99], v2 offset:11264
    v_cvt_pk_bf16_f32 v201, v162, v163
    s_waitcnt lgkmcnt(3)
    v_mfma_f32_16x16x32_bf16 v[20:23], v[84:87], v[188:191], v[20:23]
    v_exp_f32 v164, v164
    v_exp_f32 v165, v165
    v_mfma_f32_16x16x32_bf16 v[24:27], v[84:87], v[192:195], v[24:27]
    ds_read_b128 v[100:103], v2 offset:12288
    v_add_f32 v15, v15, v164
    s_waitcnt lgkmcnt(3)
    v_mfma_f32_16x16x32_bf16 v[28:31], v[88:91], v[188:191], v[28:31]
    v_add_f32 v15, v15, v165
    v_mfma_f32_16x16x32_bf16 v[32:35], v[88:91], v[192:195], v[32:35]
    ds_read_b128 v[104:107], v2 offset:13312
    v_cvt_pk_bf16_f32 v198, v164, v165
    s_waitcnt lgkmcnt(3)
    v_mfma_f32_16x16x32_bf16 v[36:39], v[92:95], v[188:191], v[36:39]
    v_exp_f32 v166, v166
    v_exp_f32 v167, v167
    v_mfma_f32_16x16x32_bf16 v[40:43], v[92:95], v[192:195], v[40:43]
    ds_read_b128 v[84:87], v2 offset:14336
    v_add_f32 v15, v15, v166
    s_waitcnt lgkmcnt(3)
    v_mfma_f32_16x16x32_bf16 v[44:47], v[96:99], v[188:191], v[44:47]
    v_add_f32 v15, v15, v167
    v_mfma_f32_16x16x32_bf16 v[48:51], v[96:99], v[192:195], v[48:51]
    ds_read_b128 v[88:91], v2 offset:15360
    v_cvt_pk_bf16_f32 v199, v166, v167
    s_waitcnt lgkmcnt(3)
    v_mfma_f32_16x16x32_bf16 v[52:55], v[100:103], v[188:191], v[52:55]
    v_exp_f32 v168, v168
    v_exp_f32 v169, v169
    v_mfma_f32_16x16x32_bf16 v[56:59], v[100:103], v[192:195], v[56:59]
    s_waitcnt vmcnt(4)
    s_barrier
    ds_read_b128 v[92:95], v2 offset:49152
    v_add_f32 v16, v16, v168
    s_waitcnt lgkmcnt(3)
    v_mfma_f32_16x16x32_bf16 v[60:63], v[104:107], v[188:191], v[60:63]
    v_add_f32 v16, v16, v169
    v_mfma_f32_16x16x32_bf16 v[64:67], v[104:107], v[192:195], v[64:67]
    s_add_u32 s22, s17, 0x2c000
    s_add_u32 m0, s17, 0x24000
    s_nop 0
    buffer_load_dwordx4 v5, s[8:11], s22 offen sc1 lds
    ds_read_b128 v[96:99], v2 offset:50176
    v_cvt_pk_bf16_f32 v202, v168, v169
    s_waitcnt lgkmcnt(3)
    v_mfma_f32_16x16x32_bf16 v[68:71], v[84:87], v[188:191], v[68:71]
    v_exp_f32 v170, v170
    v_exp_f32 v171, v171
    v_mfma_f32_16x16x32_bf16 v[72:75], v[84:87], v[192:195], v[72:75]
    ds_read_b128 v[100:103], v2 offset:51200
    v_add_f32 v16, v16, v170
    s_waitcnt lgkmcnt(3)
    v_mfma_f32_16x16x32_bf16 v[76:79], v[88:91], v[188:191], v[76:79]
    v_add_f32 v16, v16, v171
    v_mfma_f32_16x16x32_bf16 v[80:83], v[88:91], v[192:195], v[80:83]
    s_add_u32 s22, s17, 0x2c400
    s_add_u32 m0, s17, 0x24400
    s_nop 0
    buffer_load_dwordx4 v5, s[8:11], s22 offen sc1 lds
    ds_read_b128 v[104:107], v2 offset:52224
    v_cvt_pk_bf16_f32 v203, v170, v171
    s_waitcnt lgkmcnt(3)
    v_mfma_f32_16x16x32_bf16 v[156:159], v[92:95], v[108:111], v[172:175]
    v_exp_f32 v140, v140
    v_exp_f32 v141, v141
    v_mfma_f32_16x16x32_bf16 v[160:163], v[92:95], v[124:127], v[176:179]
    ds_read_b128 v[84:87], v2 offset:53248
    v_add_f32 v15, v15, v140
    s_waitcnt lgkmcnt(3)
    v_mfma_f32_16x16x32_bf16 v[164:167], v[96:99], v[108:111], v[172:175]
    v_add_f32 v15, v15, v141
    v_mfma_f32_16x16x32_bf16 v[168:171], v[96:99], v[124:127], v[176:179]
    s_add_u32 s22, s17, 0x2c800
    s_add_u32 m0, s17, 0x24800
    s_nop 0
    buffer_load_dwordx4 v5, s[8:11], s22 offen sc1 lds
    ds_read_b128 v[88:91], v2 offset:54272
    v_cvt_pk_bf16_f32 v188, v140, v141
    s_waitcnt lgkmcnt(3)
    v_mfma_f32_16x16x32_bf16 v[156:159], v[100:103], v[112:115], v[156:159]
    v_exp_f32 v142, v142
    v_exp_f32 v143, v143
    v_mfma_f32_16x16x32_bf16 v[160:163], v[100:103], v[128:131], v[160:163]
    ds_read_b128 v[92:95], v2 offset:55296
    v_add_f32 v15, v15, v142
    s_waitcnt lgkmcnt(3)
    v_mfma_f32_16x16x32_bf16 v[164:167], v[104:107], v[112:115], v[164:167]
    v_add_f32 v15, v15, v143
    v_mfma_f32_16x16x32_bf16 v[168:171], v[104:107], v[128:131], v[168:171]
    s_add_u32 s22, s17, 0x2cc00
    s_add_u32 m0, s17, 0x24c00
    s_nop 0
    buffer_load_dwordx4 v5, s[8:11], s22 offen sc1 lds
    ds_read_b128 v[96:99], v2 offset:56320
    v_cvt_pk_bf16_f32 v189, v142, v143
    s_waitcnt lgkmcnt(3)
    v_mfma_f32_16x16x32_bf16 v[156:159], v[84:87], v[116:119], v[156:159]
    v_exp_f32 v144, v144
    v_exp_f32 v145, v145
    v_mfma_f32_16x16x32_bf16 v[160:163], v[84:87], v[132:135], v[160:163]
    ds_read_b128 v[100:103], v2 offset:24576
    v_add_f32 v16, v16, v144
    s_waitcnt lgkmcnt(3)
    v_mfma_f32_16x16x32_bf16 v[164:167], v[88:91], v[116:119], v[164:167]
    v_add_f32 v16, v16, v145
    v_mfma_f32_16x16x32_bf16 v[168:171], v[88:91], v[132:135], v[168:171]
    ds_read_b128 v[104:107], v2 offset:25600
    v_cvt_pk_bf16_f32 v192, v144, v145
    s_waitcnt lgkmcnt(3)
    v_mfma_f32_16x16x32_bf16 v[156:159], v[92:95], v[120:123], v[156:159]
    v_exp_f32 v146, v146
    v_exp_f32 v147, v147
    v_mfma_f32_16x16x32_bf16 v[160:163], v[92:95], v[136:139], v[160:163]
    ds_read_b128 v[84:87], v2 offset:26624
    v_add_f32 v16, v16, v146
    s_waitcnt lgkmcnt(3)
    v_mfma_f32_16x16x32_bf16 v[164:167], v[96:99], v[120:123], v[164:167]
    v_add_f32 v16, v16, v147
    v_mfma_f32_16x16x32_bf16 v[168:171], v[96:99], v[136:139], v[168:171]
    ds_read_b128 v[88:91], v2 offset:27648
    v_cvt_pk_bf16_f32 v193, v146, v147
    s_waitcnt lgkmcnt(3)
    v_mfma_f32_16x16x32_bf16 v[20:23], v[100:103], v[196:199], v[20:23]
    v_exp_f32 v148, v148
    v_exp_f32 v149, v149
    v_mfma_f32_16x16x32_bf16 v[24:27], v[100:103], v[200:203], v[24:27]
    ds_read_b128 v[92:95], v2 offset:28672
    v_add_f32 v15, v15, v148
    s_waitcnt lgkmcnt(3)
    v_mfma_f32_16x16x32_bf16 v[28:31], v[104:107], v[196:199], v[28:31]
    v_add_f32 v15, v15, v149
    v_mfma_f32_16x16x32_bf16 v[32:35], v[104:107], v[200:203], v[32:35]
    ds_read_b128 v[96:99], v2 offset:29696
    v_cvt_pk_bf16_f32 v190, v148, v149
    s_waitcnt lgkmcnt(3)
    v_mfma_f32_16x16x32_bf16 v[36:39], v[84:87], v[196:199], v[36:39]
    v_exp_f32 v150, v150
    v_exp_f32 v151, v151
    v_mfma_f32_16x16x32_bf16 v[40:43], v[84:87], v[200:203], v[40:43]
    ds_read_b128 v[100:103], v2 offset:30720
    v_add_f32 v15, v15, v150
    s_waitcnt lgkmcnt(3)
    v_mfma_f32_16x16x32_bf16 v[44:47], v[88:91], v[196:199], v[44:47]
    v_add_f32 v15, v15, v151
    v_mfma_f32_16x16x32_bf16 v[48:51], v[88:91], v[200:203], v[48:51]
    ds_read_b128 v[104:107], v2 offset:31744
    v_cvt_pk_bf16_f32 v191, v150, v151
    s_waitcnt lgkmcnt(3)
    v_mfma_f32_16x16x32_bf16 v[52:55], v[92:95], v[196:199], v[52:55]
    v_exp_f32 v152, v152
    v_exp_f32 v153, v153
    v_mfma_f32_16x16x32_bf16 v[56:59], v[92:95], v[200:203], v[56:59]
    s_waitcnt vmcnt(4)
    s_barrier
    ds_read_b128 v[84:87], v3 offset:0
    v_add_f32 v16, v16, v152
    s_waitcnt lgkmcnt(3)
    v_mfma_f32_16x16x32_bf16 v[60:63], v[96:99], v[196:199], v[60:63]
    v_add_f32 v16, v16, v153
    v_mfma_f32_16x16x32_bf16 v[64:67], v[96:99], v[200:203], v[64:67]
    s_add_u32 s22, s17, 0x30000
    s_add_u32 m0, s17, 0x10000
    s_nop 0
    buffer_load_dwordx4 v5, s[8:11], s22 offen sc1 lds
    ds_read_b128 v[88:91], v3 offset:1024
    v_cvt_pk_bf16_f32 v194, v152, v153
    s_waitcnt lgkmcnt(3)
    v_mfma_f32_16x16x32_bf16 v[68:71], v[100:103], v[196:199], v[68:71]
    v_exp_f32 v154, v154
    v_exp_f32 v155, v155
    v_mfma_f32_16x16x32_bf16 v[72:75], v[100:103], v[200:203], v[72:75]
    ds_read_b128 v[92:95], v3 offset:2048
    v_add_f32 v16, v16, v154
    s_waitcnt lgkmcnt(3)
    v_mfma_f32_16x16x32_bf16 v[76:79], v[104:107], v[196:199], v[76:79]
    v_add_f32 v16, v16, v155
    v_mfma_f32_16x16x32_bf16 v[80:83], v[104:107], v[200:203], v[80:83]
    s_add_u32 s22, s17, 0x30400
    s_add_u32 m0, s17, 0x10400
    s_nop 0
    buffer_load_dwordx4 v5, s[8:11], s22 offen sc1 lds
    ds_read_b128 v[96:99], v3 offset:3072
    v_cvt_pk_bf16_f32 v195, v154, v155
    s_waitcnt lgkmcnt(3)
    v_mfma_f32_16x16x32_bf16 v[140:143], v[84:87], v[108:111], v[172:175]
    v_exp_f32 v156, v156
    v_exp_f32 v157, v157
    v_mfma_f32_16x16x32_bf16 v[144:147], v[84:87], v[124:127], v[176:179]
    ds_read_b128 v[100:103], v3 offset:4096
    v_add_f32 v15, v15, v156
    s_waitcnt lgkmcnt(3)
    v_mfma_f32_16x16x32_bf16 v[148:151], v[88:91], v[108:111], v[172:175]
    v_add_f32 v15, v15, v157
    v_mfma_f32_16x16x32_bf16 v[152:155], v[88:91], v[124:127], v[176:179]
    s_add_u32 s22, s17, 0x30800
    s_add_u32 m0, s17, 0x10800
    s_nop 0
    buffer_load_dwordx4 v5, s[8:11], s22 offen sc1 lds
    ds_read_b128 v[104:107], v3 offset:5120
    v_cvt_pk_bf16_f32 v196, v156, v157
    s_waitcnt lgkmcnt(3)
    v_mfma_f32_16x16x32_bf16 v[140:143], v[92:95], v[112:115], v[140:143]
    v_exp_f32 v158, v158
    v_exp_f32 v159, v159
    v_mfma_f32_16x16x32_bf16 v[144:147], v[92:95], v[128:131], v[144:147]
    ds_read_b128 v[84:87], v3 offset:6144
    v_add_f32 v15, v15, v158
    s_waitcnt lgkmcnt(3)
    v_mfma_f32_16x16x32_bf16 v[148:151], v[96:99], v[112:115], v[148:151]
    v_add_f32 v15, v15, v159
    v_mfma_f32_16x16x32_bf16 v[152:155], v[96:99], v[128:131], v[152:155]
    s_add_u32 s22, s17, 0x30c00
    s_add_u32 m0, s17, 0x10c00
    s_nop 0
    buffer_load_dwordx4 v5, s[8:11], s22 offen sc1 lds
    ds_read_b128 v[88:91], v3 offset:7168
    v_cvt_pk_bf16_f32 v197, v158, v159
    s_waitcnt lgkmcnt(3)
    v_mfma_f32_16x16x32_bf16 v[140:143], v[100:103], v[116:119], v[140:143]
    v_exp_f32 v160, v160
    v_exp_f32 v161, v161
    v_mfma_f32_16x16x32_bf16 v[144:147], v[100:103], v[132:135], v[144:147]
    ds_read_b128 v[92:95], v2 offset:40960
    v_add_f32 v16, v16, v160
    s_waitcnt lgkmcnt(3)
    v_mfma_f32_16x16x32_bf16 v[148:151], v[104:107], v[116:119], v[148:151]
    v_add_f32 v16, v16, v161
    v_mfma_f32_16x16x32_bf16 v[152:155], v[104:107], v[132:135], v[152:155]
    ds_read_b128 v[96:99], v2 offset:41984
    v_cvt_pk_bf16_f32 v200, v160, v161
    s_waitcnt lgkmcnt(3)
    v_mfma_f32_16x16x32_bf16 v[140:143], v[84:87], v[120:123], v[140:143]
    v_exp_f32 v162, v162
    v_exp_f32 v163, v163
    v_mfma_f32_16x16x32_bf16 v[144:147], v[84:87], v[136:139], v[144:147]
    ds_read_b128 v[100:103], v2 offset:43008
    v_add_f32 v16, v16, v162
    s_waitcnt lgkmcnt(3)
    v_mfma_f32_16x16x32_bf16 v[148:151], v[88:91], v[120:123], v[148:151]
    v_add_f32 v16, v16, v163
    v_mfma_f32_16x16x32_bf16 v[152:155], v[88:91], v[136:139], v[152:155]
    ds_read_b128 v[104:107], v2 offset:44032
    v_cvt_pk_bf16_f32 v201, v162, v163
    s_waitcnt lgkmcnt(3)
    v_mfma_f32_16x16x32_bf16 v[20:23], v[92:95], v[188:191], v[20:23]
    v_exp_f32 v164, v164
    v_exp_f32 v165, v165
    v_mfma_f32_16x16x32_bf16 v[24:27], v[92:95], v[192:195], v[24:27]
    ds_read_b128 v[84:87], v2 offset:45056
    v_add_f32 v15, v15, v164
    s_waitcnt lgkmcnt(3)
    v_mfma_f32_16x16x32_bf16 v[28:31], v[96:99], v[188:191], v[28:31]
    v_add_f32 v15, v15, v165
    v_mfma_f32_16x16x32_bf16 v[32:35], v[96:99], v[192:195], v[32:35]
    ds_read_b128 v[88:91], v2 offset:46080
    v_cvt_pk_bf16_f32 v198, v164, v165
    s_waitcnt lgkmcnt(3)
    v_mfma_f32_16x16x32_bf16 v[36:39], v[100:103], v[188:191], v[36:39]
    v_exp_f32 v166, v166
    v_exp_f32 v167, v167
    v_mfma_f32_16x16x32_bf16 v[40:43], v[100:103], v[192:195], v[40:43]
    ds_read_b128 v[92:95], v2 offset:47104
    v_add_f32 v15, v15, v166
    s_waitcnt lgkmcnt(3)
    v_mfma_f32_16x16x32_bf16 v[44:47], v[104:107], v[188:191], v[44:47]
    v_add_f32 v15, v15, v167
    v_mfma_f32_16x16x32_bf16 v[48:51], v[104:107], v[192:195], v[48:51]
    ds_read_b128 v[96:99], v2 offset:48128
    v_cvt_pk_bf16_f32 v199, v166, v167
    s_waitcnt lgkmcnt(3)
    v_mfma_f32_16x16x32_bf16 v[52:55], v[84:87], v[188:191], v[52:55]
    v_exp_f32 v168, v168
    v_exp_f32 v169, v169
    v_mfma_f32_16x16x32_bf16 v[56:59], v[84:87], v[192:195], v[56:59]
    s_waitcnt vmcnt(4)
    s_barrier
    ds_read_b128 v[100:103], v3 offset:16384
    v_add_f32 v16, v16, v168
    s_waitcnt lgkmcnt(3)
    v_mfma_f32_16x16x32_bf16 v[60:63], v[88:91], v[188:191], v[60:63]
    v_add_f32 v16, v16, v169
    v_mfma_f32_16x16x32_bf16 v[64:67], v[88:91], v[192:195], v[64:67]
    s_add_u32 s22, s17, 0x34000
    s_add_u32 m0, s17, 0x14000
    s_nop 0
    buffer_load_dwordx4 v5, s[8:11], s22 offen sc1 lds
    ds_read_b128 v[104:107], v3 offset:17408
    v_cvt_pk_bf16_f32 v202, v168, v169
    s_waitcnt lgkmcnt(3)
    v_mfma_f32_16x16x32_bf16 v[68:71], v[92:95], v[188:191], v[68:71]
    v_exp_f32 v170, v170
    v_exp_f32 v171, v171
    v_mfma_f32_16x16x32_bf16 v[72:75], v[92:95], v[192:195], v[72:75]
    ds_read_b128 v[84:87], v3 offset:18432
    v_add_f32 v16, v16, v170
    s_waitcnt lgkmcnt(3)
    v_mfma_f32_16x16x32_bf16 v[76:79], v[96:99], v[188:191], v[76:79]
    v_add_f32 v16, v16, v171
    v_mfma_f32_16x16x32_bf16 v[80:83], v[96:99], v[192:195], v[80:83]
    s_add_u32 s22, s17, 0x34400
    s_add_u32 m0, s17, 0x14400
    s_nop 0
    buffer_load_dwordx4 v5, s[8:11], s22 offen sc1 lds
    ds_read_b128 v[88:91], v3 offset:19456
    v_cvt_pk_bf16_f32 v203, v170, v171
    s_waitcnt lgkmcnt(3)
    v_mfma_f32_16x16x32_bf16 v[156:159], v[100:103], v[108:111], v[172:175]
    v_exp_f32 v140, v140
    v_exp_f32 v141, v141
    v_mfma_f32_16x16x32_bf16 v[160:163], v[100:103], v[124:127], v[176:179]
    ds_read_b128 v[92:95], v3 offset:20480
    v_add_f32 v15, v15, v140
    s_waitcnt lgkmcnt(3)
    v_mfma_f32_16x16x32_bf16 v[164:167], v[104:107], v[108:111], v[172:175]
    v_add_f32 v15, v15, v141
    v_mfma_f32_16x16x32_bf16 v[168:171], v[104:107], v[124:127], v[176:179]
    s_add_u32 s22, s17, 0x34800
    s_add_u32 m0, s17, 0x14800
    s_nop 0
    buffer_load_dwordx4 v5, s[8:11], s22 offen sc1 lds
    ds_read_b128 v[96:99], v3 offset:21504
    v_cvt_pk_bf16_f32 v188, v140, v141
    s_waitcnt lgkmcnt(3)
    v_mfma_f32_16x16x32_bf16 v[156:159], v[84:87], v[112:115], v[156:159]
    v_exp_f32 v142, v142
    v_exp_f32 v143, v143
    v_mfma_f32_16x16x32_bf16 v[160:163], v[84:87], v[128:131], v[160:163]
    ds_read_b128 v[100:103], v3 offset:22528
    v_add_f32 v15, v15, v142
    s_waitcnt lgkmcnt(3)
    v_mfma_f32_16x16x32_bf16 v[164:167], v[88:91], v[112:115], v[164:167]
    v_add_f32 v15, v15, v143
    v_mfma_f32_16x16x32_bf16 v[168:171], v[88:91], v[128:131], v[168:171]
    s_add_u32 s22, s17, 0x34c00
    s_add_u32 m0, s17, 0x14c00
    s_nop 0
    buffer_load_dwordx4 v5, s[8:11], s22 offen sc1 lds
    ds_read_b128 v[104:107], v3 offset:23552
    v_cvt_pk_bf16_f32 v189, v142, v143
    s_waitcnt lgkmcnt(3)
    v_mfma_f32_16x16x32_bf16 v[156:159], v[92:95], v[116:119], v[156:159]
    v_exp_f32 v144, v144
    v_exp_f32 v145, v145
    v_mfma_f32_16x16x32_bf16 v[160:163], v[92:95], v[132:135], v[160:163]
    ds_read_b128 v[84:87], v2 offset:57344
    v_add_f32 v16, v16, v144
    s_waitcnt lgkmcnt(3)
    v_mfma_f32_16x16x32_bf16 v[164:167], v[96:99], v[116:119], v[164:167]
    v_add_f32 v16, v16, v145
    v_mfma_f32_16x16x32_bf16 v[168:171], v[96:99], v[132:135], v[168:171]
    ds_read_b128 v[88:91], v2 offset:58368
    v_cvt_pk_bf16_f32 v192, v144, v145
    s_waitcnt lgkmcnt(3)
    v_mfma_f32_16x16x32_bf16 v[156:159], v[100:103], v[120:123], v[156:159]
    v_exp_f32 v146, v146
    v_exp_f32 v147, v147
    v_mfma_f32_16x16x32_bf16 v[160:163], v[100:103], v[136:139], v[160:163]
    ds_read_b128 v[92:95], v2 offset:59392
    v_add_f32 v16, v16, v146
    s_waitcnt lgkmcnt(3)
    v_mfma_f32_16x16x32_bf16 v[164:167], v[104:107], v[120:123], v[164:167]
    v_add_f32 v16, v16, v147
    v_mfma_f32_16x16x32_bf16 v[168:171], v[104:107], v[136:139], v[168:171]
    ds_read_b128 v[96:99], v2 offset:60416
    v_cvt_pk_bf16_f32 v193, v146, v147
    s_waitcnt lgkmcnt(3)
    v_mfma_f32_16x16x32_bf16 v[20:23], v[84:87], v[196:199], v[20:23]
    v_exp_f32 v148, v148
    v_exp_f32 v149, v149
    v_mfma_f32_16x16x32_bf16 v[24:27], v[84:87], v[200:203], v[24:27]
    ds_read_b128 v[100:103], v2 offset:61440
    v_add_f32 v15, v15, v148
    s_waitcnt lgkmcnt(3)
    v_mfma_f32_16x16x32_bf16 v[28:31], v[88:91], v[196:199], v[28:31]
    v_add_f32 v15, v15, v149
    v_mfma_f32_16x16x32_bf16 v[32:35], v[88:91], v[200:203], v[32:35]
    ds_read_b128 v[104:107], v2 offset:62464
    v_cvt_pk_bf16_f32 v190, v148, v149
    s_waitcnt lgkmcnt(3)
    v_mfma_f32_16x16x32_bf16 v[36:39], v[92:95], v[196:199], v[36:39]
    v_exp_f32 v150, v150
    v_exp_f32 v151, v151
    v_mfma_f32_16x16x32_bf16 v[40:43], v[92:95], v[200:203], v[40:43]
    ds_read_b128 v[84:87], v2 offset:63488
    v_add_f32 v15, v15, v150
    s_waitcnt lgkmcnt(3)
    v_mfma_f32_16x16x32_bf16 v[44:47], v[96:99], v[196:199], v[44:47]
    v_add_f32 v15, v15, v151
    v_mfma_f32_16x16x32_bf16 v[48:51], v[96:99], v[200:203], v[48:51]
    ds_read_b128 v[88:91], v2 offset:64512
    v_cvt_pk_bf16_f32 v191, v150, v151
    s_waitcnt lgkmcnt(3)
    v_mfma_f32_16x16x32_bf16 v[52:55], v[100:103], v[196:199], v[52:55]
    v_exp_f32 v152, v152
    v_exp_f32 v153, v153
    v_mfma_f32_16x16x32_bf16 v[56:59], v[100:103], v[200:203], v[56:59]
    s_waitcnt vmcnt(4)
    s_barrier
    ds_read_b128 v[92:95], v2 offset:0
    v_add_f32 v16, v16, v152
    s_waitcnt lgkmcnt(3)
    v_mfma_f32_16x16x32_bf16 v[60:63], v[104:107], v[196:199], v[60:63]
    v_add_f32 v16, v16, v153
    v_mfma_f32_16x16x32_bf16 v[64:67], v[104:107], v[200:203], v[64:67]
    s_add_u32 s22, s17, 0x38000
    s_add_u32 m0, s17, 0x18000
    s_nop 0
    buffer_load_dwordx4 v5, s[8:11], s22 offen sc1 lds
    ds_read_b128 v[96:99], v2 offset:1024
    v_cvt_pk_bf16_f32 v194, v152, v153
    s_waitcnt lgkmcnt(3)
    v_mfma_f32_16x16x32_bf16 v[68:71], v[84:87], v[196:199], v[68:71]
    v_exp_f32 v154, v154
    v_exp_f32 v155, v155
    v_mfma_f32_16x16x32_bf16 v[72:75], v[84:87], v[200:203], v[72:75]
    ds_read_b128 v[100:103], v2 offset:2048
    v_add_f32 v16, v16, v154
    s_waitcnt lgkmcnt(3)
    v_mfma_f32_16x16x32_bf16 v[76:79], v[88:91], v[196:199], v[76:79]
    v_add_f32 v16, v16, v155
    v_mfma_f32_16x16x32_bf16 v[80:83], v[88:91], v[200:203], v[80:83]
    s_add_u32 s22, s17, 0x38400
    s_add_u32 m0, s17, 0x18400
    s_nop 0
    buffer_load_dwordx4 v5, s[8:11], s22 offen sc1 lds
    ds_read_b128 v[104:107], v2 offset:3072
    v_cvt_pk_bf16_f32 v195, v154, v155
    s_waitcnt lgkmcnt(3)
    v_mfma_f32_16x16x32_bf16 v[140:143], v[92:95], v[108:111], v[172:175]
    v_exp_f32 v156, v156
    v_exp_f32 v157, v157
    v_mfma_f32_16x16x32_bf16 v[144:147], v[92:95], v[124:127], v[176:179]
    ds_read_b128 v[84:87], v2 offset:4096
    v_add_f32 v15, v15, v156
    s_waitcnt lgkmcnt(3)
    v_mfma_f32_16x16x32_bf16 v[148:151], v[96:99], v[108:111], v[172:175]
    v_add_f32 v15, v15, v157
    v_mfma_f32_16x16x32_bf16 v[152:155], v[96:99], v[124:127], v[176:179]
    s_add_u32 s22, s17, 0x38800
    s_add_u32 m0, s17, 0x18800
    s_nop 0
    buffer_load_dwordx4 v5, s[8:11], s22 offen sc1 lds
    ds_read_b128 v[88:91], v2 offset:5120
    v_cvt_pk_bf16_f32 v196, v156, v157
    s_waitcnt lgkmcnt(3)
    v_mfma_f32_16x16x32_bf16 v[140:143], v[100:103], v[112:115], v[140:143]
    v_exp_f32 v158, v158
    v_exp_f32 v159, v159
    v_mfma_f32_16x16x32_bf16 v[144:147], v[100:103], v[128:131], v[144:147]
    ds_read_b128 v[92:95], v2 offset:6144
    v_add_f32 v15, v15, v158
    s_waitcnt lgkmcnt(3)
    v_mfma_f32_16x16x32_bf16 v[148:151], v[104:107], v[112:115], v[148:151]
    v_add_f32 v15, v15, v159
    v_mfma_f32_16x16x32_bf16 v[152:155], v[104:107], v[128:131], v[152:155]
    s_add_u32 s22, s17, 0x38c00
    s_add_u32 m0, s17, 0x18c00
    s_nop 0
    buffer_load_dwordx4 v5, s[8:11], s22 offen sc1 lds
    ds_read_b128 v[96:99], v2 offset:7168
    v_cvt_pk_bf16_f32 v197, v158, v159
    s_waitcnt lgkmcnt(3)
    v_mfma_f32_16x16x32_bf16 v[140:143], v[84:87], v[116:119], v[140:143]
    v_exp_f32 v160, v160
    v_exp_f32 v161, v161
    v_mfma_f32_16x16x32_bf16 v[144:147], v[84:87], v[132:135], v[144:147]
    ds_read_b128 v[100:103], v3 offset:8192
    v_add_f32 v16, v16, v160
    s_waitcnt lgkmcnt(3)
    v_mfma_f32_16x16x32_bf16 v[148:151], v[88:91], v[116:119], v[148:151]
    v_add_f32 v16, v16, v161
    v_mfma_f32_16x16x32_bf16 v[152:155], v[88:91], v[132:135], v[152:155]
    ds_read_b128 v[104:107], v3 offset:9216
    v_cvt_pk_bf16_f32 v200, v160, v161
    s_waitcnt lgkmcnt(3)
    v_mfma_f32_16x16x32_bf16 v[140:143], v[92:95], v[120:123], v[140:143]
    v_exp_f32 v162, v162
    v_exp_f32 v163, v163
    v_mfma_f32_16x16x32_bf16 v[144:147], v[92:95], v[136:139], v[144:147]
    ds_read_b128 v[84:87], v3 offset:10240
    v_add_f32 v16, v16, v162
    s_waitcnt lgkmcnt(3)
    v_mfma_f32_16x16x32_bf16 v[148:151], v[96:99], v[120:123], v[148:151]
    v_add_f32 v16, v16, v163
    v_mfma_f32_16x16x32_bf16 v[152:155], v[96:99], v[136:139], v[152:155]
    ds_read_b128 v[88:91], v3 offset:11264
    v_cvt_pk_bf16_f32 v201, v162, v163
    s_waitcnt lgkmcnt(3)
    v_mfma_f32_16x16x32_bf16 v[20:23], v[100:103], v[188:191], v[20:23]
    v_exp_f32 v164, v164
    v_exp_f32 v165, v165
    v_mfma_f32_16x16x32_bf16 v[24:27], v[100:103], v[192:195], v[24:27]
    ds_read_b128 v[92:95], v3 offset:12288
    v_add_f32 v15, v15, v164
    s_waitcnt lgkmcnt(3)
    v_mfma_f32_16x16x32_bf16 v[28:31], v[104:107], v[188:191], v[28:31]
    v_add_f32 v15, v15, v165
    v_mfma_f32_16x16x32_bf16 v[32:35], v[104:107], v[192:195], v[32:35]
    ds_read_b128 v[96:99], v3 offset:13312
    v_cvt_pk_bf16_f32 v198, v164, v165
    s_waitcnt lgkmcnt(3)
    v_mfma_f32_16x16x32_bf16 v[36:39], v[84:87], v[188:191], v[36:39]
    v_exp_f32 v166, v166
    v_exp_f32 v167, v167
    v_mfma_f32_16x16x32_bf16 v[40:43], v[84:87], v[192:195], v[40:43]
    ds_read_b128 v[100:103], v3 offset:14336
    v_add_f32 v15, v15, v166
    s_waitcnt lgkmcnt(3)
    v_mfma_f32_16x16x32_bf16 v[44:47], v[88:91], v[188:191], v[44:47]
    v_add_f32 v15, v15, v167
    v_mfma_f32_16x16x32_bf16 v[48:51], v[88:91], v[192:195], v[48:51]
    ds_read_b128 v[104:107], v3 offset:15360
    v_cvt_pk_bf16_f32 v199, v166, v167
    s_waitcnt lgkmcnt(3)
    v_mfma_f32_16x16x32_bf16 v[52:55], v[92:95], v[188:191], v[52:55]
    v_exp_f32 v168, v168
    v_exp_f32 v169, v169
    v_mfma_f32_16x16x32_bf16 v[56:59], v[92:95], v[192:195], v[56:59]
    s_waitcnt vmcnt(4)
    s_barrier
    ds_read_b128 v[84:87], v2 offset:16384
    v_add_f32 v16, v16, v168
    s_waitcnt lgkmcnt(3)
    v_mfma_f32_16x16x32_bf16 v[60:63], v[96:99], v[188:191], v[60:63]
    v_add_f32 v16, v16, v169
    v_mfma_f32_16x16x32_bf16 v[64:67], v[96:99], v[192:195], v[64:67]
    s_add_u32 s22, s17, 0x3c000
    s_add_u32 m0, s17, 0x1c000
    s_nop 0
    buffer_load_dwordx4 v5, s[8:11], s22 offen sc1 lds
    ds_read_b128 v[88:91], v2 offset:17408
    v_cvt_pk_bf16_f32 v202, v168, v169
    s_waitcnt lgkmcnt(3)
    v_mfma_f32_16x16x32_bf16 v[68:71], v[100:103], v[188:191], v[68:71]
    v_exp_f32 v170, v170
    v_exp_f32 v171, v171
    v_mfma_f32_16x16x32_bf16 v[72:75], v[100:103], v[192:195], v[72:75]
    ds_read_b128 v[92:95], v2 offset:18432
    v_add_f32 v16, v16, v170
    s_waitcnt lgkmcnt(3)
    v_mfma_f32_16x16x32_bf16 v[76:79], v[104:107], v[188:191], v[76:79]
    v_add_f32 v16, v16, v171
    v_mfma_f32_16x16x32_bf16 v[80:83], v[104:107], v[192:195], v[80:83]
    s_add_u32 s22, s17, 0x3c400
    s_add_u32 m0, s17, 0x1c400
    s_nop 0
    buffer_load_dwordx4 v5, s[8:11], s22 offen sc1 lds
    ds_read_b128 v[96:99], v2 offset:19456
    v_cvt_pk_bf16_f32 v203, v170, v171
    s_waitcnt lgkmcnt(3)
    v_mfma_f32_16x16x32_bf16 v[156:159], v[84:87], v[108:111], v[172:175]
    v_exp_f32 v140, v140
    v_exp_f32 v141, v141
    v_mfma_f32_16x16x32_bf16 v[160:163], v[84:87], v[124:127], v[176:179]
    ds_read_b128 v[100:103], v2 offset:20480
    v_add_f32 v15, v15, v140
    s_waitcnt lgkmcnt(3)
    v_mfma_f32_16x16x32_bf16 v[164:167], v[88:91], v[108:111], v[172:175]
    v_add_f32 v15, v15, v141
    v_mfma_f32_16x16x32_bf16 v[168:171], v[88:91], v[124:127], v[176:179]
    s_add_u32 s22, s17, 0x3c800
    s_add_u32 m0, s17, 0x1c800
    s_nop 0
    buffer_load_dwordx4 v5, s[8:11], s22 offen sc1 lds
    ds_read_b128 v[104:107], v2 offset:21504
    v_cvt_pk_bf16_f32 v188, v140, v141
    s_waitcnt lgkmcnt(3)
    v_mfma_f32_16x16x32_bf16 v[156:159], v[92:95], v[112:115], v[156:159]
    v_exp_f32 v142, v142
    v_exp_f32 v143, v143
    v_mfma_f32_16x16x32_bf16 v[160:163], v[92:95], v[128:131], v[160:163]
    ds_read_b128 v[84:87], v2 offset:22528
    v_add_f32 v15, v15, v142
    s_waitcnt lgkmcnt(3)
    v_mfma_f32_16x16x32_bf16 v[164:167], v[96:99], v[112:115], v[164:167]
    v_add_f32 v15, v15, v143
    v_mfma_f32_16x16x32_bf16 v[168:171], v[96:99], v[128:131], v[168:171]
    s_add_u32 s22, s17, 0x3cc00
    s_add_u32 m0, s17, 0x1cc00
    s_nop 0
    buffer_load_dwordx4 v5, s[8:11], s22 offen sc1 lds
    ds_read_b128 v[88:91], v2 offset:23552
    v_cvt_pk_bf16_f32 v189, v142, v143
    s_waitcnt lgkmcnt(3)
    v_mfma_f32_16x16x32_bf16 v[156:159], v[100:103], v[116:119], v[156:159]
    v_exp_f32 v144, v144
    v_exp_f32 v145, v145
    v_mfma_f32_16x16x32_bf16 v[160:163], v[100:103], v[132:135], v[160:163]
    ds_read_b128 v[92:95], v3 offset:24576
    v_add_f32 v16, v16, v144
    s_waitcnt lgkmcnt(3)
    v_mfma_f32_16x16x32_bf16 v[164:167], v[104:107], v[116:119], v[164:167]
    v_add_f32 v16, v16, v145
    v_mfma_f32_16x16x32_bf16 v[168:171], v[104:107], v[132:135], v[168:171]
    ds_read_b128 v[96:99], v3 offset:25600
    v_cvt_pk_bf16_f32 v192, v144, v145
    s_waitcnt lgkmcnt(3)
    v_mfma_f32_16x16x32_bf16 v[156:159], v[84:87], v[120:123], v[156:159]
    v_exp_f32 v146, v146
    v_exp_f32 v147, v147
    v_mfma_f32_16x16x32_bf16 v[160:163], v[84:87], v[136:139], v[160:163]
    ds_read_b128 v[100:103], v3 offset:26624
    v_add_f32 v16, v16, v146
    s_waitcnt lgkmcnt(3)
    v_mfma_f32_16x16x32_bf16 v[164:167], v[88:91], v[120:123], v[164:167]
    v_add_f32 v16, v16, v147
    v_mfma_f32_16x16x32_bf16 v[168:171], v[88:91], v[136:139], v[168:171]
    ds_read_b128 v[104:107], v3 offset:27648
    v_cvt_pk_bf16_f32 v193, v146, v147
    s_waitcnt lgkmcnt(3)
    v_mfma_f32_16x16x32_bf16 v[20:23], v[92:95], v[196:199], v[20:23]
    v_exp_f32 v148, v148
    v_exp_f32 v149, v149
    v_mfma_f32_16x16x32_bf16 v[24:27], v[92:95], v[200:203], v[24:27]
    ds_read_b128 v[84:87], v3 offset:28672
    v_add_f32 v15, v15, v148
    s_waitcnt lgkmcnt(3)
    v_mfma_f32_16x16x32_bf16 v[28:31], v[96:99], v[196:199], v[28:31]
    v_add_f32 v15, v15, v149
    v_mfma_f32_16x16x32_bf16 v[32:35], v[96:99], v[200:203], v[32:35]
    ds_read_b128 v[88:91], v3 offset:29696
    v_cvt_pk_bf16_f32 v190, v148, v149
    s_waitcnt lgkmcnt(3)
    v_mfma_f32_16x16x32_bf16 v[36:39], v[100:103], v[196:199], v[36:39]
    v_exp_f32 v150, v150
    v_exp_f32 v151, v151
    v_mfma_f32_16x16x32_bf16 v[40:43], v[100:103], v[200:203], v[40:43]
    ds_read_b128 v[92:95], v3 offset:30720
    v_add_f32 v15, v15, v150
    s_waitcnt lgkmcnt(3)
    v_mfma_f32_16x16x32_bf16 v[44:47], v[104:107], v[196:199], v[44:47]
    v_add_f32 v15, v15, v151
    v_mfma_f32_16x16x32_bf16 v[48:51], v[104:107], v[200:203], v[48:51]
    ds_read_b128 v[96:99], v3 offset:31744
    v_cvt_pk_bf16_f32 v191, v150, v151
    s_waitcnt lgkmcnt(3)
    v_mfma_f32_16x16x32_bf16 v[52:55], v[84:87], v[196:199], v[52:55]
    v_exp_f32 v152, v152
    v_exp_f32 v153, v153
    v_mfma_f32_16x16x32_bf16 v[56:59], v[84:87], v[200:203], v[56:59]
    s_waitcnt vmcnt(4)
    s_barrier
    ds_read_b128 v[100:103], v2 offset:32768
    v_add_f32 v16, v16, v152
    s_waitcnt lgkmcnt(3)
    v_mfma_f32_16x16x32_bf16 v[60:63], v[88:91], v[196:199], v[60:63]
    v_add_f32 v16, v16, v153
    v_mfma_f32_16x16x32_bf16 v[64:67], v[88:91], v[200:203], v[64:67]
    ds_read_b128 v[104:107], v2 offset:33792
    v_cvt_pk_bf16_f32 v194, v152, v153
    s_waitcnt lgkmcnt(3)
    v_mfma_f32_16x16x32_bf16 v[68:71], v[92:95], v[196:199], v[68:71]
    v_exp_f32 v154, v154
    v_exp_f32 v155, v155
    v_mfma_f32_16x16x32_bf16 v[72:75], v[92:95], v[200:203], v[72:75]
    ds_read_b128 v[84:87], v2 offset:34816
    v_add_f32 v16, v16, v154
    s_waitcnt lgkmcnt(3)
    v_mfma_f32_16x16x32_bf16 v[76:79], v[96:99], v[196:199], v[76:79]
    v_add_f32 v16, v16, v155
    v_mfma_f32_16x16x32_bf16 v[80:83], v[96:99], v[200:203], v[80:83]
    ds_read_b128 v[88:91], v2 offset:35840
    v_cvt_pk_bf16_f32 v195, v154, v155
    s_waitcnt lgkmcnt(3)
    v_mfma_f32_16x16x32_bf16 v[140:143], v[100:103], v[108:111], v[172:175]
    v_exp_f32 v156, v156
    v_exp_f32 v157, v157
    v_mfma_f32_16x16x32_bf16 v[144:147], v[100:103], v[124:127], v[176:179]
    ds_read_b128 v[92:95], v2 offset:36864
    v_add_f32 v15, v15, v156
    s_waitcnt lgkmcnt(3)
    v_mfma_f32_16x16x32_bf16 v[148:151], v[104:107], v[108:111], v[172:175]
    v_add_f32 v15, v15, v157
    v_mfma_f32_16x16x32_bf16 v[152:155], v[104:107], v[124:127], v[176:179]
    ds_read_b128 v[96:99], v2 offset:37888
    v_cvt_pk_bf16_f32 v196, v156, v157
    s_waitcnt lgkmcnt(3)
    v_mfma_f32_16x16x32_bf16 v[140:143], v[84:87], v[112:115], v[140:143]
    v_exp_f32 v158, v158
    v_exp_f32 v159, v159
    v_mfma_f32_16x16x32_bf16 v[144:147], v[84:87], v[128:131], v[144:147]
    ds_read_b128 v[100:103], v2 offset:38912
    v_add_f32 v15, v15, v158
    s_waitcnt lgkmcnt(3)
    v_mfma_f32_16x16x32_bf16 v[148:151], v[88:91], v[112:115], v[148:151]
    v_add_f32 v15, v15, v159
    v_mfma_f32_16x16x32_bf16 v[152:155], v[88:91], v[128:131], v[152:155]
    ds_read_b128 v[104:107], v2 offset:39936
    v_cvt_pk_bf16_f32 v197, v158, v159
    s_waitcnt lgkmcnt(3)
    v_mfma_f32_16x16x32_bf16 v[140:143], v[92:95], v[116:119], v[140:143]
    v_exp_f32 v160, v160
    v_exp_f32 v161, v161
    v_mfma_f32_16x16x32_bf16 v[144:147], v[92:95], v[132:135], v[144:147]
    ds_read_b128 v[84:87], v2 offset:8192
    v_add_f32 v16, v16, v160
    s_waitcnt lgkmcnt(3)
    v_mfma_f32_16x16x32_bf16 v[148:151], v[96:99], v[116:119], v[148:151]
    v_add_f32 v16, v16, v161
    v_mfma_f32_16x16x32_bf16 v[152:155], v[96:99], v[132:135], v[152:155]
    ds_read_b128 v[88:91], v2 offset:9216
    v_cvt_pk_bf16_f32 v200, v160, v161
    s_bfe_u32 s22, s42, 0x30000
    s_or_b32 s22, s22, s62
    s_lshl_b32 s22, s22, 18
    s_add_u32 s22, s22, s16
    s_add_u32 s22, s22, 0x0
    s_add_u32 m0, s17, 0x0
    s_nop 0
    buffer_load_dwordx4 v17, s[4:7], s22 offen lds
    s_waitcnt lgkmcnt(3)
    v_mfma_f32_16x16x32_bf16 v[140:143], v[100:103], v[120:123], v[140:143]
    v_exp_f32 v162, v162
    v_exp_f32 v163, v163
    v_mfma_f32_16x16x32_bf16 v[144:147], v[100:103], v[136:139], v[144:147]
    ds_read_b128 v[92:95], v2 offset:10240
    v_add_f32 v16, v16, v162
    s_waitcnt lgkmcnt(3)
    v_mfma_f32_16x16x32_bf16 v[148:151], v[104:107], v[120:123], v[148:151]
    v_add_f32 v16, v16, v163
    v_mfma_f32_16x16x32_bf16 v[152:155], v[104:107], v[136:139], v[152:155]
    ds_read_b128 v[96:99], v2 offset:11264
    v_cvt_pk_bf16_f32 v201, v162, v163
    s_bfe_u32 s22, s42, 0x30000
    s_or_b32 s22, s22, s62
    s_lshl_b32 s22, s22, 18
    s_add_u32 s22, s22, s16
    s_add_u32 s22, s22, 0x2000
    s_add_u32 m0, s17, 0x400
    s_nop 0
    buffer_load_dwordx4 v18, s[4:7], s22 offen lds
    s_waitcnt lgkmcnt(3)
    v_mfma_f32_16x16x32_bf16 v[20:23], v[84:87], v[188:191], v[20:23]
    v_exp_f32 v164, v164
    v_exp_f32 v165, v165
    v_mfma_f32_16x16x32_bf16 v[24:27], v[84:87], v[192:195], v[24:27]
    ds_read_b128 v[100:103], v2 offset:12288
    v_add_f32 v15, v15, v164
    s_waitcnt lgkmcnt(3)
    v_mfma_f32_16x16x32_bf16 v[28:31], v[88:91], v[188:191], v[28:31]
    v_add_f32 v15, v15, v165
    v_mfma_f32_16x16x32_bf16 v[32:35], v[88:91], v[192:195], v[32:35]
    ds_read_b128 v[104:107], v2 offset:13312
    v_cvt_pk_bf16_f32 v198, v164, v165
    s_bfe_u32 s22, s42, 0x30000
    s_or_b32 s22, s22, s62
    s_lshl_b32 s22, s22, 18
    s_add_u32 s22, s22, s16
    s_add_u32 s22, s22, 0x4000
    s_add_u32 m0, s17, 0x800
    s_nop 0
    buffer_load_dwordx4 v17, s[4:7], s22 offen lds
    s_waitcnt lgkmcnt(3)
    v_mfma_f32_16x16x32_bf16 v[36:39], v[92:95], v[188:191], v[36:39]
    v_exp_f32 v166, v166
    v_exp_f32 v167, v167
    v_mfma_f32_16x16x32_bf16 v[40:43], v[92:95], v[192:195], v[40:43]
    ds_read_b128 v[84:87], v2 offset:14336
    v_add_f32 v15, v15, v166
    s_waitcnt lgkmcnt(3)
    v_mfma_f32_16x16x32_bf16 v[44:47], v[96:99], v[188:191], v[44:47]
    v_add_f32 v15, v15, v167
    v_mfma_f32_16x16x32_bf16 v[48:51], v[96:99], v[192:195], v[48:51]
    ds_read_b128 v[88:91], v2 offset:15360
    v_cvt_pk_bf16_f32 v199, v166, v167
    s_bfe_u32 s22, s42, 0x30000
    s_or_b32 s22, s22, s62
    s_lshl_b32 s22, s22, 18
    s_add_u32 s22, s22, s16
    s_add_u32 s22, s22, 0x6000
    s_add_u32 m0, s17, 0xc00
    s_nop 0
    buffer_load_dwordx4 v18, s[4:7], s22 offen lds
    s_waitcnt lgkmcnt(3)
    v_mfma_f32_16x16x32_bf16 v[52:55], v[100:103], v[188:191], v[52:55]
    v_exp_f32 v168, v168
    v_exp_f32 v169, v169
    v_mfma_f32_16x16x32_bf16 v[56:59], v[100:103], v[192:195], v[56:59]
    s_waitcnt vmcnt(4)
    s_barrier
    ds_read_b128 v[92:95], v2 offset:49152
    v_add_f32 v16, v16, v168
    s_waitcnt lgkmcnt(3)
    v_mfma_f32_16x16x32_bf16 v[60:63], v[104:107], v[188:191], v[60:63]
    v_add_f32 v16, v16, v169
    v_mfma_f32_16x16x32_bf16 v[64:67], v[104:107], v[192:195], v[64:67]
    ds_read_b128 v[96:99], v2 offset:50176
    v_cvt_pk_bf16_f32 v202, v168, v169
    s_waitcnt lgkmcnt(3)
    v_mfma_f32_16x16x32_bf16 v[68:71], v[84:87], v[188:191], v[68:71]
    v_exp_f32 v170, v170
    v_exp_f32 v171, v171
    v_mfma_f32_16x16x32_bf16 v[72:75], v[84:87], v[192:195], v[72:75]
    ds_read_b128 v[100:103], v2 offset:51200
    v_add_f32 v16, v16, v170
    s_waitcnt lgkmcnt(3)
    v_mfma_f32_16x16x32_bf16 v[76:79], v[88:91], v[188:191], v[76:79]
    v_add_f32 v16, v16, v171
    v_mfma_f32_16x16x32_bf16 v[80:83], v[88:91], v[192:195], v[80:83]
    ds_read_b128 v[104:107], v2 offset:52224
    v_cvt_pk_bf16_f32 v203, v170, v171
    s_waitcnt lgkmcnt(3)
    v_mfma_f32_16x16x32_bf16 v[156:159], v[92:95], v[108:111], v[172:175]
    v_exp_f32 v140, v140
    v_exp_f32 v141, v141
    v_mfma_f32_16x16x32_bf16 v[160:163], v[92:95], v[124:127], v[176:179]
    ds_read_b128 v[84:87], v2 offset:53248
    v_add_f32 v15, v15, v140
    v_lshlrev_b32 v6, 4, v8
    s_mov_b64 s[68:69], s[44:45]
    s_mov_b32 s70, 0x800
    s_mov_b32 s71, 0x20000
    v_lshlrev_b32 v7, 3, v8
    buffer_load_dwordx2 v[186:187], v7, s[68:71], 0 offen
    s_mov_b32 s26, 0xa20000
    buffer_load_dwordx4 v[236:239], v6, s[8:11], s26 offen sc1
    s_mov_b32 s26, 0xa21000
    buffer_load_dwordx4 v[240:243], v6, s[8:11], s26 offen sc1
    s_mov_b32 s26, 0xa22000
    buffer_load_dwordx4 v[244:247], v6, s[8:11], s26 offen sc1
    s_mov_b32 s26, 0xa23000
    buffer_load_dwordx4 v[248:251], v6, s[8:11], s26 offen sc1
    s_waitcnt lgkmcnt(3)
    v_mfma_f32_16x16x32_bf16 v[164:167], v[96:99], v[108:111], v[172:175]
    v_add_f32 v15, v15, v141
    v_mfma_f32_16x16x32_bf16 v[168:171], v[96:99], v[124:127], v[176:179]
    ds_read_b128 v[88:91], v2 offset:54272
    v_cvt_pk_bf16_f32 v188, v140, v141
    s_waitcnt lgkmcnt(3)
    v_mfma_f32_16x16x32_bf16 v[156:159], v[100:103], v[112:115], v[156:159]
    v_exp_f32 v142, v142
    v_exp_f32 v143, v143
    v_mfma_f32_16x16x32_bf16 v[160:163], v[100:103], v[128:131], v[160:163]
    ds_read_b128 v[92:95], v2 offset:55296
    v_add_f32 v15, v15, v142
    s_waitcnt lgkmcnt(3)
    v_mfma_f32_16x16x32_bf16 v[164:167], v[104:107], v[112:115], v[164:167]
    v_add_f32 v15, v15, v143
    v_mfma_f32_16x16x32_bf16 v[168:171], v[104:107], v[128:131], v[168:171]
    ds_read_b128 v[96:99], v2 offset:56320
    v_cvt_pk_bf16_f32 v189, v142, v143
    s_waitcnt lgkmcnt(3)
    v_mfma_f32_16x16x32_bf16 v[156:159], v[84:87], v[116:119], v[156:159]
    v_exp_f32 v144, v144
    v_exp_f32 v145, v145
    v_mfma_f32_16x16x32_bf16 v[160:163], v[84:87], v[132:135], v[160:163]
    ds_read_b128 v[100:103], v2 offset:24576
    v_add_f32 v16, v16, v144
    s_waitcnt lgkmcnt(3)
    v_mfma_f32_16x16x32_bf16 v[164:167], v[88:91], v[116:119], v[164:167]
    v_add_f32 v16, v16, v145
    v_mfma_f32_16x16x32_bf16 v[168:171], v[88:91], v[132:135], v[168:171]
    ds_read_b128 v[104:107], v2 offset:25600
    v_cvt_pk_bf16_f32 v192, v144, v145
    s_bfe_u32 s22, s42, 0x30000
    s_or_b32 s22, s22, s62
    s_lshl_b32 s22, s22, 18
    s_add_u32 s22, s22, s16
    s_add_u32 s22, s22, 0x20000
    s_add_u32 m0, s17, 0x4000
    s_nop 0
    buffer_load_dwordx4 v17, s[4:7], s22 offen lds
    s_waitcnt lgkmcnt(3)
    v_mfma_f32_16x16x32_bf16 v[156:159], v[92:95], v[120:123], v[156:159]
    v_exp_f32 v146, v146
    v_exp_f32 v147, v147
    v_mfma_f32_16x16x32_bf16 v[160:163], v[92:95], v[136:139], v[160:163]
    ds_read_b128 v[84:87], v2 offset:26624
    v_add_f32 v16, v16, v146
    s_waitcnt lgkmcnt(3)
    v_mfma_f32_16x16x32_bf16 v[164:167], v[96:99], v[120:123], v[164:167]
    v_add_f32 v16, v16, v147
    v_mfma_f32_16x16x32_bf16 v[168:171], v[96:99], v[136:139], v[168:171]
    ds_read_b128 v[88:91], v2 offset:27648
    v_cvt_pk_bf16_f32 v193, v146, v147
    s_bfe_u32 s22, s42, 0x30000
    s_or_b32 s22, s22, s62
    s_lshl_b32 s22, s22, 18
    s_add_u32 s22, s22, s16
    s_add_u32 s22, s22, 0x22000
    s_add_u32 m0, s17, 0x4400
    s_nop 0
    buffer_load_dwordx4 v18, s[4:7], s22 offen lds
    s_waitcnt lgkmcnt(3)
    v_mfma_f32_16x16x32_bf16 v[20:23], v[100:103], v[196:199], v[20:23]
    v_exp_f32 v148, v148
    v_exp_f32 v149, v149
    v_mfma_f32_16x16x32_bf16 v[24:27], v[100:103], v[200:203], v[24:27]
    ds_read_b128 v[92:95], v2 offset:28672
    v_add_f32 v15, v15, v148
    s_waitcnt lgkmcnt(3)
    v_mfma_f32_16x16x32_bf16 v[28:31], v[104:107], v[196:199], v[28:31]
    v_add_f32 v15, v15, v149
    v_mfma_f32_16x16x32_bf16 v[32:35], v[104:107], v[200:203], v[32:35]
    ds_read_b128 v[96:99], v2 offset:29696
    v_cvt_pk_bf16_f32 v190, v148, v149
    s_bfe_u32 s22, s42, 0x30000
    s_or_b32 s22, s22, s62
    s_lshl_b32 s22, s22, 18
    s_add_u32 s22, s22, s16
    s_add_u32 s22, s22, 0x24000
    s_add_u32 m0, s17, 0x4800
    s_nop 0
    buffer_load_dwordx4 v17, s[4:7], s22 offen lds
    s_waitcnt lgkmcnt(3)
    v_mfma_f32_16x16x32_bf16 v[36:39], v[84:87], v[196:199], v[36:39]
    v_exp_f32 v150, v150
    v_exp_f32 v151, v151
    v_mfma_f32_16x16x32_bf16 v[40:43], v[84:87], v[200:203], v[40:43]
    ds_read_b128 v[100:103], v2 offset:30720
    v_add_f32 v15, v15, v150
    s_waitcnt lgkmcnt(3)
    v_mfma_f32_16x16x32_bf16 v[44:47], v[88:91], v[196:199], v[44:47]
    v_add_f32 v15, v15, v151
    v_mfma_f32_16x16x32_bf16 v[48:51], v[88:91], v[200:203], v[48:51]
    ds_read_b128 v[104:107], v2 offset:31744
    v_cvt_pk_bf16_f32 v191, v150, v151
    s_bfe_u32 s22, s42, 0x30000
    s_or_b32 s22, s22, s62
    s_lshl_b32 s22, s22, 18
    s_add_u32 s22, s22, s16
    s_add_u32 s22, s22, 0x26000
    s_add_u32 m0, s17, 0x4c00
    s_nop 0
    buffer_load_dwordx4 v18, s[4:7], s22 offen lds
    s_waitcnt lgkmcnt(3)
    v_mfma_f32_16x16x32_bf16 v[52:55], v[92:95], v[196:199], v[52:55]
    v_exp_f32 v152, v152
    v_exp_f32 v153, v153
    v_mfma_f32_16x16x32_bf16 v[56:59], v[92:95], v[200:203], v[56:59]
    ds_read_b128 v[84:87], v2 offset:40960
    v_add_f32 v16, v16, v152
    s_waitcnt lgkmcnt(3)
    v_mfma_f32_16x16x32_bf16 v[60:63], v[96:99], v[196:199], v[60:63]
    v_add_f32 v16, v16, v153
    v_mfma_f32_16x16x32_bf16 v[64:67], v[96:99], v[200:203], v[64:67]
    ds_read_b128 v[88:91], v2 offset:41984
    v_cvt_pk_bf16_f32 v194, v152, v153
    s_waitcnt lgkmcnt(3)
    v_mfma_f32_16x16x32_bf16 v[68:71], v[100:103], v[196:199], v[68:71]
    v_exp_f32 v154, v154
    v_exp_f32 v155, v155
    v_mfma_f32_16x16x32_bf16 v[72:75], v[100:103], v[200:203], v[72:75]
    ds_read_b128 v[92:95], v2 offset:43008
    v_add_f32 v16, v16, v154
    s_waitcnt lgkmcnt(3)
    v_mfma_f32_16x16x32_bf16 v[76:79], v[104:107], v[196:199], v[76:79]
    v_add_f32 v16, v16, v155
    v_mfma_f32_16x16x32_bf16 v[80:83], v[104:107], v[200:203], v[80:83]
    ds_read_b128 v[96:99], v2 offset:44032
    v_cvt_pk_bf16_f32 v195, v154, v155
    s_waitcnt lgkmcnt(3)
    v_mfma_f32_16x16x32_bf16 v[20:23], v[84:87], v[188:191], v[20:23]
    v_exp_f32 v156, v156
    v_exp_f32 v157, v157
    v_add_f32 v15, v15, v156
    v_mfma_f32_16x16x32_bf16 v[24:27], v[84:87], v[192:195], v[24:27]
    ds_read_b128 v[100:103], v2 offset:45056
    v_add_f32 v15, v15, v157
    v_cvt_pk_bf16_f32 v196, v156, v157
    s_waitcnt vmcnt(7)
    v_min3_u32 v13, v236, v237, v238
    s_waitcnt vmcnt(6)
    v_min3_u32 v13, v13, v239, v240
    v_min3_u32 v13, v13, v241, v242
    s_waitcnt vmcnt(5)
    v_min3_u32 v13, v13, v243, v244
    v_min3_u32 v13, v13, v245, v246
    s_waitcnt vmcnt(4)
    v_min3_u32 v13, v13, v247, v248
    v_min3_u32 v13, v13, v249, v250
    v_min_u32 v13, v13, v251
    v_cmp_eq_u32 vcc, 0, v13
    s_cbranch_vccz fz_mfg
    s_mov_b32 s27, 0
fz_mfp:
    s_mov_b32 s26, 0xa20000
    buffer_load_dwordx4 v[236:239], v6, s[8:11], s26 offen sc1
    s_mov_b32 s26, 0xa21000
    buffer_load_dwordx4 v[240:243], v6, s[8:11], s26 offen sc1
    s_mov_b32 s26, 0xa22000
    buffer_load_dwordx4 v[244:247], v6, s[8:11], s26 offen sc1
    s_mov_b32 s26, 0xa23000
    buffer_load_dwordx4 v[248:251], v6, s[8:11], s26 offen sc1
    s_waitcnt vmcnt(0)
    v_min3_u32 v13, v236, v237, v238
    v_min3_u32 v13, v13, v239, v240
    v_min3_u32 v13, v13, v241, v242
    v_min3_u32 v13, v13, v243, v244
    v_min3_u32 v13, v13, v245, v246
    v_min3_u32 v13, v13, v247, v248
    v_min3_u32 v13, v13, v249, v250
    v_min_u32 v13, v13, v251
    v_cmp_eq_u32 vcc, 0, v13
    s_add_u32 s27, s27, 1
    s_cmp_ge_u32 s27, 65536
    s_nop 4
    s_cbranch_scc1 fz_mfg
    s_cbranch_vccnz fz_mfp
fz_mfg:
    s_mov_b32 s26, 0x07060302
    v_perm_b32 v180, v241, v240, s26
    v_perm_b32 v181, v243, v242, s26
    v_perm_b32 v182, v245, v244, s26
    v_perm_b32 v183, v247, v246, s26
    v_perm_b32 v184, v249, v248, s26
    v_perm_b32 v185, v251, v250, s26
    v_add_u32 v7, 0x20000, v7
    ds_write_b64 v7, v[180:181] offset:0
    ds_write_b64 v7, v[182:183] offset:2048
    ds_write_b64 v7, v[184:185] offset:4096
    ds_write_b64 v7, v[186:187] offset:6144
    v_and_b32 v236, 0xffff0000, v236
    v_and_b32 v237, 0xffff0000, v237
    v_and_b32 v238, 0xffff0000, v238
    v_and_b32 v239, 0xffff0000, v239
    v_add_u32 v6, 0x22000, v6
    ds_write_b128 v6, v[236:239]
    s_waitcnt lgkmcnt(0)
    v_mfma_f32_16x16x32_bf16 v[28:31], v[88:91], v[188:191], v[28:31]
    v_exp_f32 v158, v158
    v_exp_f32 v159, v159
    v_add_f32 v15, v15, v158
    v_mfma_f32_16x16x32_bf16 v[32:35], v[88:91], v[192:195], v[32:35]
    ds_read_b128 v[104:107], v2 offset:46080
    v_add_f32 v15, v15, v159
    v_cvt_pk_bf16_f32 v197, v158, v159
    v_mfma_f32_16x16x32_bf16 v[36:39], v[92:95], v[188:191], v[36:39]
    v_exp_f32 v160, v160
    v_exp_f32 v161, v161
    v_add_f32 v16, v16, v160
    v_mfma_f32_16x16x32_bf16 v[40:43], v[92:95], v[192:195], v[40:43]
    ds_read_b128 v[84:87], v2 offset:47104
    v_add_f32 v16, v16, v161
    v_cvt_pk_bf16_f32 v200, v160, v161
    v_mfma_f32_16x16x32_bf16 v[44:47], v[96:99], v[188:191], v[44:47]
    v_exp_f32 v162, v162
    v_exp_f32 v163, v163
    v_add_f32 v16, v16, v162
    v_mfma_f32_16x16x32_bf16 v[48:51], v[96:99], v[192:195], v[48:51]
    ds_read_b128 v[88:91], v2 offset:48128
    v_add_f32 v16, v16, v163
    v_cvt_pk_bf16_f32 v201, v162, v163
    v_mfma_f32_16x16x32_bf16 v[52:55], v[100:103], v[188:191], v[52:55]
    v_exp_f32 v164, v164
    v_exp_f32 v165, v165
    v_add_f32 v15, v15, v164
    v_mfma_f32_16x16x32_bf16 v[56:59], v[100:103], v[192:195], v[56:59]
    ds_read_b128 v[92:95], v2 offset:57344
    v_add_f32 v15, v15, v165
    v_cvt_pk_bf16_f32 v198, v164, v165
    s_waitcnt lgkmcnt(3)
    v_mfma_f32_16x16x32_bf16 v[60:63], v[104:107], v[188:191], v[60:63]
    v_exp_f32 v166, v166
    v_exp_f32 v167, v167
    v_add_f32 v15, v15, v166
    v_mfma_f32_16x16x32_bf16 v[64:67], v[104:107], v[192:195], v[64:67]
    ds_read_b128 v[96:99], v2 offset:58368
    v_add_f32 v15, v15, v167
    v_cvt_pk_bf16_f32 v199, v166, v167
    s_bfe_u32 s22, s42, 0x30004
    s_or_b32 s22, s22, s62
    s_lshl_b32 s22, s22, 18
    s_add_u32 s22, s22, s16
    s_add_u32 s22, s22, 0x0
    s_add_u32 m0, s17, 0x8000
    s_nop 0
    buffer_load_dwordx4 v17, s[4:7], s22 offen lds
    s_waitcnt lgkmcnt(3)
    v_mfma_f32_16x16x32_bf16 v[68:71], v[84:87], v[188:191], v[68:71]
    v_exp_f32 v168, v168
    v_exp_f32 v169, v169
    v_add_f32 v16, v16, v168
    v_mfma_f32_16x16x32_bf16 v[72:75], v[84:87], v[192:195], v[72:75]
    ds_read_b128 v[100:103], v2 offset:59392
    v_add_f32 v16, v16, v169
    v_cvt_pk_bf16_f32 v202, v168, v169
    s_waitcnt lgkmcnt(3)
    v_mfma_f32_16x16x32_bf16 v[76:79], v[88:91], v[188:191], v[76:79]
    v_exp_f32 v170, v170
    v_exp_f32 v171, v171
    v_add_f32 v16, v16, v170
    v_mfma_f32_16x16x32_bf16 v[80:83], v[88:91], v[192:195], v[80:83]
    ds_read_b128 v[104:107], v2 offset:60416
    v_add_f32 v16, v16, v171
    v_cvt_pk_bf16_f32 v203, v170, v171
    s_bfe_u32 s22, s42, 0x30004
    s_or_b32 s22, s22, s62
    s_lshl_b32 s22, s22, 18
    s_add_u32 s22, s22, s16
    s_add_u32 s22, s22, 0x2000
    s_add_u32 m0, s17, 0x8400
    s_nop 0
    buffer_load_dwordx4 v18, s[4:7], s22 offen lds
    s_waitcnt lgkmcnt(3)
    v_mfma_f32_16x16x32_bf16 v[20:23], v[92:95], v[196:199], v[20:23]
    v_mfma_f32_16x16x32_bf16 v[24:27], v[92:95], v[200:203], v[24:27]
    ds_read_b128 v[84:87], v2 offset:61440
    s_waitcnt lgkmcnt(3)
    v_mfma_f32_16x16x32_bf16 v[28:31], v[96:99], v[196:199], v[28:31]
    v_mfma_f32_16x16x32_bf16 v[32:35], v[96:99], v[200:203], v[32:35]
    ds_read_b128 v[88:91], v2 offset:62464
    s_bfe_u32 s22, s42, 0x30004
    s_or_b32 s22, s22, s62
    s_lshl_b32 s22, s22, 18
    s_add_u32 s22, s22, s16
    s_add_u32 s22, s22, 0x4000
    s_add_u32 m0, s17, 0x8800
    s_nop 0
    buffer_load_dwordx4 v17, s[4:7], s22 offen lds
    s_waitcnt lgkmcnt(3)
    v_mfma_f32_16x16x32_bf16 v[36:39], v[100:103], v[196:199], v[36:39]
    v_mfma_f32_16x16x32_bf16 v[40:43], v[100:103], v[200:203], v[40:43]
    ds_read_b128 v[92:95], v2 offset:63488
    s_waitcnt lgkmcnt(3)
    v_mfma_f32_16x16x32_bf16 v[44:47], v[104:107], v[196:199], v[44:47]
    v_mfma_f32_16x16x32_bf16 v[48:51], v[104:107], v[200:203], v[48:51]
    ds_read_b128 v[96:99], v2 offset:64512
    s_bfe_u32 s22, s42, 0x30004
    s_or_b32 s22, s22, s62
    s_lshl_b32 s22, s22, 18
    s_add_u32 s22, s22, s16
    s_add_u32 s22, s22, 0x6000
    s_add_u32 m0, s17, 0x8c00
    s_nop 0
    buffer_load_dwordx4 v18, s[4:7], s22 offen lds
    s_waitcnt lgkmcnt(3)
    v_mfma_f32_16x16x32_bf16 v[52:55], v[84:87], v[196:199], v[52:55]
    v_mfma_f32_16x16x32_bf16 v[56:59], v[84:87], v[200:203], v[56:59]
    s_waitcnt lgkmcnt(2)
    v_mfma_f32_16x16x32_bf16 v[60:63], v[88:91], v[196:199], v[60:63]
    v_mfma_f32_16x16x32_bf16 v[64:67], v[88:91], v[200:203], v[64:67]
    s_waitcnt lgkmcnt(1)
    v_mfma_f32_16x16x32_bf16 v[68:71], v[92:95], v[196:199], v[68:71]
    v_mfma_f32_16x16x32_bf16 v[72:75], v[92:95], v[200:203], v[72:75]
    s_waitcnt lgkmcnt(0)
    v_mfma_f32_16x16x32_bf16 v[76:79], v[96:99], v[196:199], v[76:79]
    v_mfma_f32_16x16x32_bf16 v[80:83], v[96:99], v[200:203], v[80:83]
    s_branch fz_chk
fz_roleB:
    s_and_b32 s20, s2, 7
    s_lshl_b32 s20, s20, 3
    s_bfe_u32 s21, s2, 0x30003
    s_add_u32 s20, s20, s21
    s_lshr_b32 s21, s2, 6
    v_lshrrev_b32 v31, 2, v8
    v_mul_u32_u24 v28, 49152, v31
    v_and_b32 v32, 3, v8
    v_lshl_add_u32 v28, v32, 4, v28
    v_lshlrev_b32 v29, 3, v31
    s_mul_i32 s22, s21, 3145728
    s_lshl_b32 s23, s20, 6
    s_add_u32 s22, s22, s23
    s_lshl_b32 s24, s21, 9
    v_mov_b32 v24, 0
    v_mov_b32 v25, 0
    v_mov_b32 v26, 0
    v_mov_b32 v27, 0
    v_lshlrev_b32 v33, 3, v8
    s_lshl_b32 s26, s2, 11
    s_add_u32 s26, s26, 0xa00000
    s_sub_u32 s19, s3, 4
    v_mov_b32 v39, 0x20200
    ds_write_b32 v39, v24
    s_waitcnt lgkmcnt(0)
    s_mov_b64 s[8:9], s[60:61]
    s_mov_b64 s[64:65], s[52:53]
    s_mov_b32 s66, 0x800
    s_mov_b32 s67, 0x20000
    s_mov_b64 s[68:69], s[54:55]
    s_mov_b32 s70, 0xc00000
    s_mov_b32 s71, 0x20000
    s_mov_b64 s[4:5], s[38:39]
    s_mov_b32 s6, 0x800000
    s_mov_b32 s7, 0x20000
    buffer_store_dwordx2 v[24:25], v33, s[8:11], s26 offen sc1
    buffer_load_dwordx2 v[60:61], v29, s[64:67], s24 offen
    s_add_u32 s25, s22, 0
    buffer_load_dwordx4 v[44:47], v28, s[68:71], s25 offen
    s_add_u32 s25, s22, 12288
    buffer_load_dwordx4 v[48:51], v28, s[68:71], s25 offen
    s_add_u32 s25, s22, 24576
    buffer_load_dwordx4 v[52:55], v28, s[68:71], s25 offen
    s_add_u32 s25, s22, 36864
    buffer_load_dwordx4 v[56:59], v28, s[68:71], s25 offen
    s_mov_b32 s27, 0x570000
    buffer_load_dword v20, v24, s[8:11], s27 offen sc1
    s_cmp_lg_u32 s3, 4
    s_cbranch_scc1 fz_ncp
    s_getpc_b64 s[22:23]
fz_pc:
    s_add_u32 s22, s22, fz_start-fz_pc
    s_addc_u32 s23, s23, -1
    s_lshr_b32 s24, s2, 3
    s_lshl_b32 s24, s24, 12
    v_lshl_add_u32 v35, v0, 7, s24
    v_min_u32 v35, fz_end-fz_start, v35
    s_mov_b64 exec, 0xffffffff
    global_load_dword v7, v35, s[22:23]
    s_mov_b64 exec, -1
fz_ncp:
    s_barrier
    v_lshrrev_b32 v34, 4, v0
    s_waitcnt vmcnt(5)
    v_lshlrev_b32 v62, 16, v61
    v_and_b32 v63, 0xffff0000, v61
    v_and_b32 v61, 0xffff0000, v60
    v_lshlrev_b32 v60, 16, v60
    v_mul_f32 v72, 0xbfb8aa3b, v60
    v_exp_f32 v72, v72
    s_nop 0
    v_add_f32 v72, 1.0, v72
    v_rcp_f32 v72, v72
    s_nop 0
    v_mul_f32 v60, v60, v72
    v_mul_f32 v73, 0xbfb8aa3b, v61
    v_exp_f32 v73, v73
    s_nop 0
    v_add_f32 v73, 1.0, v73
    v_rcp_f32 v73, v73
    s_nop 0
    v_mul_f32 v61, v61, v73
    v_mul_f32 v74, 0xbfb8aa3b, v62
    v_exp_f32 v74, v74
    s_nop 0
    v_add_f32 v74, 1.0, v74
    v_rcp_f32 v74, v74
    s_nop 0
    v_mul_f32 v62, v62, v74
    v_mul_f32 v75, 0xbfb8aa3b, v63
    v_exp_f32 v75, v75
    s_nop 0
    v_add_f32 v75, 1.0, v75
    v_rcp_f32 v75, v75
    s_nop 0
    v_mul_f32 v63, v63, v75
    v_cvt_pk_bf16_f32 v72, v60, v61
    v_lshlrev_b32 v60, 16, v72
    v_and_b32 v61, 0xffff0000, v72
    v_cvt_pk_bf16_f32 v73, v62, v63
    v_lshlrev_b32 v62, 16, v73
    v_and_b32 v63, 0xffff0000, v73
    s_waitcnt vmcnt(4)
    v_lshlrev_b32 v72, 16, v44
    v_and_b32 v73, 0xffff0000, v44
    v_lshlrev_b32 v74, 16, v45
    v_and_b32 v75, 0xffff0000, v45
    v_lshlrev_b32 v76, 16, v46
    v_and_b32 v77, 0xffff0000, v46
    v_lshlrev_b32 v78, 16, v47
    v_and_b32 v79, 0xffff0000, v47
    v_mul_f32 v64, v60, v72
    v_mul_f32 v65, v60, v73
    v_mul_f32 v66, v60, v74
    v_mul_f32 v67, v60, v75
    v_mul_f32 v68, v60, v76
    v_mul_f32 v69, v60, v77
    v_mul_f32 v70, v60, v78
    v_mul_f32 v71, v60, v79
    s_waitcnt vmcnt(3)
    v_lshlrev_b32 v72, 16, v48
    v_and_b32 v73, 0xffff0000, v48
    v_lshlrev_b32 v74, 16, v49
    v_and_b32 v75, 0xffff0000, v49
    v_lshlrev_b32 v76, 16, v50
    v_and_b32 v77, 0xffff0000, v50
    v_lshlrev_b32 v78, 16, v51
    v_and_b32 v79, 0xffff0000, v51
    v_fmac_f32 v64, v61, v72
    v_fmac_f32 v65, v61, v73
    v_fmac_f32 v66, v61, v74
    v_fmac_f32 v67, v61, v75
    v_fmac_f32 v68, v61, v76
    v_fmac_f32 v69, v61, v77
    v_fmac_f32 v70, v61, v78
    v_fmac_f32 v71, v61, v79
    s_waitcnt vmcnt(2)
    v_lshlrev_b32 v72, 16, v52
    v_and_b32 v73, 0xffff0000, v52
    v_lshlrev_b32 v74, 16, v53
    v_and_b32 v75, 0xffff0000, v53
    v_lshlrev_b32 v76, 16, v54
    v_and_b32 v77, 0xffff0000, v54
    v_lshlrev_b32 v78, 16, v55
    v_and_b32 v79, 0xffff0000, v55
    v_fmac_f32 v64, v62, v72
    v_fmac_f32 v65, v62, v73
    v_fmac_f32 v66, v62, v74
    v_fmac_f32 v67, v62, v75
    v_fmac_f32 v68, v62, v76
    v_fmac_f32 v69, v62, v77
    v_fmac_f32 v70, v62, v78
    v_fmac_f32 v71, v62, v79
    s_waitcnt vmcnt(1)
    v_lshlrev_b32 v72, 16, v56
    v_and_b32 v73, 0xffff0000, v56
    v_lshlrev_b32 v74, 16, v57
    v_and_b32 v75, 0xffff0000, v57
    v_lshlrev_b32 v76, 16, v58
    v_and_b32 v77, 0xffff0000, v58
    v_lshlrev_b32 v78, 16, v59
    v_and_b32 v79, 0xffff0000, v59
    v_fmac_f32 v64, v63, v72
    v_fmac_f32 v65, v63, v73
    v_fmac_f32 v66, v63, v74
    v_fmac_f32 v67, v63, v75
    v_fmac_f32 v68, v63, v76
    v_fmac_f32 v69, v63, v77
    v_fmac_f32 v70, v63, v78
    v_fmac_f32 v71, v63, v79
    v_permlane32_swap_b32 v64, v68
    v_permlane32_swap_b32 v65, v69
    v_permlane32_swap_b32 v66, v70
    v_permlane32_swap_b32 v67, v71
    v_add_f32 v64, v64, v68
    v_add_f32 v65, v65, v69
    v_add_f32 v66, v66, v70
    v_add_f32 v67, v67, v71
    s_nop 0
    v_permlane16_swap_b32 v64, v66
    v_permlane16_swap_b32 v65, v67
    v_add_f32 v64, v64, v66
    v_add_f32 v65, v65, v67
    s_nop 0
    v_add_f32_dpp v64, v64, v64 row_ror:8 row_mask:0xf bank_mask:0xf
    v_add_f32_dpp v65, v65, v65 row_ror:8 row_mask:0xf bank_mask:0xf
    s_nop 0
    v_add_f32_dpp v64, v64, v64 row_ror:4 row_mask:0xf bank_mask:0xf
    v_add_f32_dpp v65, v65, v65 row_ror:4 row_mask:0xf bank_mask:0xf
    v_lshlrev_b32 v36, 5, v32
    v_lshl_add_u32 v36, v34, 3, v36
    s_lshl_b32 s26, s19, 7
    s_add_u32 s26, s26, 0x20000
    v_add_u32 v36, s26, v36
    ds_write_b64 v36, v[64:65]
    v_mov_b32 v40, 1
    s_mov_b64 exec, 1
    ds_add_rtn_u32 v40, v39, v40
    s_mov_b64 exec, -1
    s_waitcnt vmcnt(0)
    v_readfirstlane_b32 s14, v20
    s_add_u32 s14, s14, 1
    v_add_u32 v37, 0x20000, v1
    s_waitcnt lgkmcnt(0)
    v_readfirstlane_b32 s26, v40
    s_cmp_lg_u32 s26, 3
    s_cbranch_scc1 fz_np
    ds_read_b128 v[80:83], v37 offset:0
    ds_read_b128 v[84:87], v37 offset:128
    ds_read_b128 v[88:91], v37 offset:256
    ds_read_b128 v[92:95], v37 offset:384
    v_mov_b32 v30, 0xff
    s_lshl_b32 s26, s21, 13
    s_lshl_b32 s27, s20, 7
    s_add_u32 s26, s26, s27
    s_add_u32 s26, s26, 0x500000
    s_waitcnt lgkmcnt(2)
    v_pk_add_f32 v[80:81], v[80:81], v[84:85]
    v_pk_add_f32 v[82:83], v[82:83], v[86:87]
    s_waitcnt lgkmcnt(0)
    v_pk_add_f32 v[88:89], v[88:89], v[92:93]
    v_pk_add_f32 v[90:91], v[90:91], v[94:95]
    v_pk_add_f32 v[80:81], v[80:81], v[88:89]
    v_pk_add_f32 v[82:83], v[82:83], v[90:91]
    v_bfi_b32 v80, v30, s14, v80
    s_lshr_b32 s27, s14, 8
    v_bfi_b32 v81, v30, s27, v81
    s_lshr_b32 s27, s14, 16
    v_bfi_b32 v82, v30, s27, v82
    s_lshr_b32 s27, s14, 24
    v_bfi_b32 v83, v30, s27, v83
    s_mov_b64 exec, 0xff
    buffer_store_dwordx4 v[80:83], v1, s[8:11], s26 offen sc1
    s_mov_b64 exec, -1
    s_waitcnt vmcnt(0)
fz_np:
    s_waitcnt vmcnt(0)
    s_barrier
    v_lshlrev_b32 v38, 4, v8
    s_mov_b32 s24, 0x0c0c0400
    s_mov_b32 s25, 0x04000c0c
    s_mov_b32 s27, 0
fz_gp:
    s_mov_b32 s21, 0x500000
    buffer_load_dwordx4 v[96:99], v38, s[8:11], s21 offen sc1
    s_mov_b32 s21, 0x501000
    buffer_load_dwordx4 v[100:103], v38, s[8:11], s21 offen sc1
    s_mov_b32 s21, 0x502000
    buffer_load_dwordx4 v[104:107], v38, s[8:11], s21 offen sc1
    s_mov_b32 s21, 0x503000
    buffer_load_dwordx4 v[108:111], v38, s[8:11], s21 offen sc1
    s_mov_b32 s21, 0x504000
    buffer_load_dwordx4 v[112:115], v38, s[8:11], s21 offen sc1
    s_mov_b32 s21, 0x505000
    buffer_load_dwordx4 v[116:119], v38, s[8:11], s21 offen sc1
    s_mov_b32 s21, 0x506000
    buffer_load_dwordx4 v[120:123], v38, s[8:11], s21 offen sc1
    s_mov_b32 s21, 0x507000
    buffer_load_dwordx4 v[124:127], v38, s[8:11], s21 offen sc1
    s_waitcnt vmcnt(7)
    v_perm_b32 v36, v97, v96, s24
    v_perm_b32 v37, v99, v98, s25
    v_or_b32 v36, v36, v37
    v_xor_b32 v35, s14, v36
    s_waitcnt vmcnt(6)
    v_perm_b32 v36, v101, v100, s24
    v_perm_b32 v37, v103, v102, s25
    v_or_b32 v36, v36, v37
    v_xor_b32 v36, s14, v36
    v_or_b32 v35, v35, v36
    s_waitcnt vmcnt(5)
    v_perm_b32 v36, v105, v104, s24
    v_perm_b32 v37, v107, v106, s25
    v_or_b32 v36, v36, v37
    v_xor_b32 v36, s14, v36
    v_or_b32 v35, v35, v36
    s_waitcnt vmcnt(4)
    v_perm_b32 v36, v109, v108, s24
    v_perm_b32 v37, v111, v110, s25
    v_or_b32 v36, v36, v37
    v_xor_b32 v36, s14, v36
    v_or_b32 v35, v35, v36
    s_waitcnt vmcnt(3)
    v_perm_b32 v36, v113, v112, s24
    v_perm_b32 v37, v115, v114, s25
    v_or_b32 v36, v36, v37
    v_xor_b32 v36, s14, v36
    v_or_b32 v35, v35, v36
    s_waitcnt vmcnt(2)
    v_perm_b32 v36, v117, v116, s24
    v_perm_b32 v37, v119, v118, s25
    v_or_b32 v36, v36, v37
    v_xor_b32 v36, s14, v36
    v_or_b32 v35, v35, v36
    s_waitcnt vmcnt(1)
    v_perm_b32 v36, v121, v120, s24
    v_perm_b32 v37, v123, v122, s25
    v_or_b32 v36, v36, v37
    v_xor_b32 v36, s14, v36
    v_or_b32 v35, v35, v36
    s_waitcnt vmcnt(0)
    v_perm_b32 v36, v125, v124, s24
    v_perm_b32 v37, v127, v126, s25
    v_or_b32 v36, v36, v37
    v_xor_b32 v36, s14, v36
    v_or_b32 v35, v35, v36
    v_cmp_ne_u32 vcc, 0, v35
    s_add_u32 s27, s27, 1
    s_cmp_ge_u32 s27, 65536
    s_cbranch_scc1 fz_gg
    s_cbranch_vccz fz_gg
    s_sleep 1
    s_branch fz_gp
fz_gg:
    v_and_b32 v96, 0xffffff00, v96
    v_and_b32 v97, 0xffffff00, v97
    v_and_b32 v98, 0xffffff00, v98
    v_and_b32 v99, 0xffffff00, v99
    v_and_b32 v100, 0xffffff00, v100
    v_and_b32 v101, 0xffffff00, v101
    v_and_b32 v102, 0xffffff00, v102
    v_and_b32 v103, 0xffffff00, v103
    v_and_b32 v104, 0xffffff00, v104
    v_and_b32 v105, 0xffffff00, v105
    v_and_b32 v106, 0xffffff00, v106
    v_and_b32 v107, 0xffffff00, v107
    v_and_b32 v108, 0xffffff00, v108
    v_and_b32 v109, 0xffffff00, v109
    v_and_b32 v110, 0xffffff00, v110
    v_and_b32 v111, 0xffffff00, v111
    v_and_b32 v112, 0xffffff00, v112
    v_and_b32 v113, 0xffffff00, v113
    v_and_b32 v114, 0xffffff00, v114
    v_and_b32 v115, 0xffffff00, v115
    v_and_b32 v116, 0xffffff00, v116
    v_and_b32 v117, 0xffffff00, v117
    v_and_b32 v118, 0xffffff00, v118
    v_and_b32 v119, 0xffffff00, v119
    v_and_b32 v120, 0xffffff00, v120
    v_and_b32 v121, 0xffffff00, v121
    v_and_b32 v122, 0xffffff00, v122
    v_and_b32 v123, 0xffffff00, v123
    v_and_b32 v124, 0xffffff00, v124
    v_and_b32 v125, 0xffffff00, v125
    v_and_b32 v126, 0xffffff00, v126
    v_and_b32 v127, 0xffffff00, v127
    v_pk_add_f32 v[96:97], v[96:97], v[112:113]
    v_pk_add_f32 v[98:99], v[98:99], v[114:115]
    v_pk_add_f32 v[100:101], v[100:101], v[116:117]
    v_pk_add_f32 v[102:103], v[102:103], v[118:119]
    v_pk_add_f32 v[104:105], v[104:105], v[120:121]
    v_pk_add_f32 v[106:107], v[106:107], v[122:123]
    v_pk_add_f32 v[108:109], v[108:109], v[124:125]
    v_pk_add_f32 v[110:111], v[110:111], v[126:127]
    v_pk_add_f32 v[96:97], v[96:97], v[104:105]
    v_pk_add_f32 v[98:99], v[98:99], v[106:107]
    v_pk_add_f32 v[100:101], v[100:101], v[108:109]
    v_pk_add_f32 v[102:103], v[102:103], v[110:111]
    v_cvt_pk_bf16_f32 v31, v96, v97
    v_lshlrev_b32 v96, 16, v31
    v_and_b32 v97, 0xffff0000, v31
    v_cvt_pk_bf16_f32 v31, v98, v99
    v_lshlrev_b32 v98, 16, v31
    v_and_b32 v99, 0xffff0000, v31
    v_cvt_pk_bf16_f32 v31, v100, v101
    v_lshlrev_b32 v100, 16, v31
    v_and_b32 v101, 0xffff0000, v31
    v_cvt_pk_bf16_f32 v31, v102, v103
    v_lshlrev_b32 v102, 16, v31
    v_and_b32 v103, 0xffff0000, v31
    v_add_f32 v100, 1.0, v100
    v_add_f32 v101, 1.0, v101
    v_add_f32 v102, 1.0, v102
    v_add_f32 v103, 1.0, v103
    v_cvt_pk_bf16_f32 v31, v100, v101
    v_lshlrev_b32 v100, 16, v31
    v_and_b32 v101, 0xffff0000, v31
    v_cvt_pk_bf16_f32 v31, v102, v103
    v_lshlrev_b32 v102, 16, v31
    v_and_b32 v103, 0xffff0000, v31
    v_add_u32 v38, 0x21000, v38
    ds_write_b128 v38, v[96:99]
    ds_write_b128 v38, v[100:103] offset:4096
    s_waitcnt lgkmcnt(0)
    s_barrier
    s_barrier
    s_lshl_b32 s26, s13, 5
    s_lshl_b32 s25, s3, 2
    s_add_u32 s26, s26, s25
    v_bfe_u32 v9, v0, 2, 2
    v_lshlrev_b32 v9, 7, v9
    v_and_b32 v10, 3, v0
    v_lshl_add_u32 v9, v10, 2, v9
    s_lshl_b32 s26, s26, 7
    s_add_u32 s26, s26, 0x510000
    s_mov_b32 s27, 0
fz_hBp:
    buffer_load_dword v10, v9, s[8:11], s26 offen sc1
    s_waitcnt vmcnt(0)
    v_cmp_ne_u32 vcc, s14, v10
    s_add_u32 s27, s27, 1
    s_cmp_ge_u32 s27, 65536
    s_cbranch_scc1 fz_hBg
    s_cbranch_vccz fz_hBg
    s_sleep 4
    s_branch fz_hBp
fz_hBg:
    s_mov_b32 s23, 0x0
    buffer_load_dwordx4 v[204:207], v4, s[8:11], s23 offen offset:0 sc1
    s_mov_b32 s23, 0x8000
    buffer_load_dwordx4 v[208:211], v4, s[8:11], s23 offen offset:0 sc1
    s_mov_b32 s23, 0x0
    buffer_load_dwordx4 v[212:215], v4, s[8:11], s23 offen offset:1024 sc1
    s_mov_b32 s23, 0x8000
    buffer_load_dwordx4 v[216:219], v4, s[8:11], s23 offen offset:1024 sc1
    s_barrier
    ds_read_b64_tr_b16 v[84:85], v3 offset:0
    ds_read_b64_tr_b16 v[86:87], v3 offset:1024
    ds_read_b64_tr_b16 v[88:89], v15 offset:32
    ds_read_b64_tr_b16 v[90:91], v15 offset:1056
    ds_read_b64_tr_b16 v[92:93], v3 offset:256
    ds_read_b64_tr_b16 v[94:95], v3 offset:1280
    ds_read_b64_tr_b16 v[96:97], v15 offset:288
    ds_read_b64_tr_b16 v[98:99], v15 offset:1312
    s_waitcnt vmcnt(3) lgkmcnt(6)
    v_mfma_f32_16x16x32_bf16 v[20:23], v[84:87], v[204:207], 0
    s_mov_b32 s23, 0x800
    buffer_load_dwordx4 v[220:223], v4, s[8:11], s23 offen offset:0 sc1
    ds_read_b64_tr_b16 v[100:101], v3 offset:512
    s_sub_u32 s26, s3, 4
    s_lshl_b32 s26, s26, 3
    v_add_u32 v17, s26, v0
    v_lshrrev_b32 v18, 4, v17
    v_lshlrev_b32 v18, 13, v18
    v_and_b32 v17, 15, v17
    v_lshl_add_u32 v17, v17, 7, v18
    s_lshr_b32 s26, s2, 3
    s_lshl_b32 s26, s26, 14
    s_and_b32 s27, s2, 3
    s_lshl_b32 s27, s27, 11
    s_add_u32 s26, s26, s27
    v_add_u32 v17, s26, v17
    v_cmp_gt_u32 vcc, 8, v0
    v_bfrev_b32 v18, -2
    s_nop 0
    v_cndmask_b32 v17, v18, v17, vcc
    s_mov_b64 s[68:69], s[38:39]
    s_mov_b32 s70, 0x800000
    s_mov_b32 s71, 0x20000
    s_waitcnt vmcnt(3)
    v_mfma_f32_16x16x32_bf16 v[24:27], v[84:87], v[208:211], 0
    ds_read_b64_tr_b16 v[102:103], v3 offset:1536
    s_mov_b32 s26, 0x180000
    buffer_load_dword v18, v17, s[68:71], s26 offen
    s_waitcnt lgkmcnt(6)
    v_mfma_f32_16x16x32_bf16 v[28:31], v[88:91], v[204:207], 0
    s_mov_b32 s23, 0x8800
    buffer_load_dwordx4 v[224:227], v4, s[8:11], s23 offen offset:0 sc1
    ds_read_b64_tr_b16 v[104:105], v15 offset:544
    v_mfma_f32_16x16x32_bf16 v[32:35], v[88:91], v[208:211], 0
    ds_read_b64_tr_b16 v[106:107], v15 offset:1568
    s_mov_b32 s23, 0x1000
    buffer_load_dwordx4 v[140:143], v4, s[8:11], s23 offen offset:0 sc1
    s_waitcnt lgkmcnt(6)
    v_mfma_f32_16x16x32_bf16 v[36:39], v[92:95], v[204:207], 0
    s_mov_b32 s23, 0x800
    buffer_load_dwordx4 v[228:231], v4, s[8:11], s23 offen offset:1024 sc1
    ds_read_b64_tr_b16 v[84:85], v3 offset:768
    v_mfma_f32_16x16x32_bf16 v[40:43], v[92:95], v[208:211], 0
    ds_read_b64_tr_b16 v[86:87], v3 offset:1792
    s_waitcnt lgkmcnt(6)
    v_mfma_f32_16x16x32_bf16 v[44:47], v[96:99], v[204:207], 0
    s_mov_b32 s23, 0x8800
    buffer_load_dwordx4 v[232:235], v4, s[8:11], s23 offen offset:1024 sc1
    ds_read_b64_tr_b16 v[88:89], v15 offset:800
    v_mfma_f32_16x16x32_bf16 v[48:51], v[96:99], v[208:211], 0
    ds_read_b64_tr_b16 v[90:91], v15 offset:1824
    s_mov_b32 s26, 0x200000
    buffer_load_dword v18, v17, s[68:71], s26 offen
    s_waitcnt lgkmcnt(6)
    v_mfma_f32_16x16x32_bf16 v[52:55], v[100:103], v[204:207], 0
    ds_read_b64_tr_b16 v[92:93], v3 offset:8192
    v_mfma_f32_16x16x32_bf16 v[56:59], v[100:103], v[208:211], 0
    ds_read_b64_tr_b16 v[94:95], v3 offset:9216
    s_waitcnt lgkmcnt(6)
    v_mfma_f32_16x16x32_bf16 v[60:63], v[104:107], v[204:207], 0
    ds_read_b64_tr_b16 v[96:97], v15 offset:8224
    v_mfma_f32_16x16x32_bf16 v[64:67], v[104:107], v[208:211], 0
    ds_read_b64_tr_b16 v[98:99], v15 offset:9248
    s_mov_b32 s23, 0x9000
    buffer_load_dwordx4 v[144:147], v4, s[8:11], s23 offen offset:0 sc1
    s_waitcnt lgkmcnt(6)
    v_mfma_f32_16x16x32_bf16 v[68:71], v[84:87], v[204:207], 0
    ds_read_b64_tr_b16 v[100:101], v3 offset:8448
    v_mfma_f32_16x16x32_bf16 v[72:75], v[84:87], v[208:211], 0
    ds_read_b64_tr_b16 v[102:103], v3 offset:9472
    s_waitcnt lgkmcnt(6)
    v_mfma_f32_16x16x32_bf16 v[76:79], v[88:91], v[204:207], 0
    ds_read_b64_tr_b16 v[104:105], v15 offset:8480
    v_mfma_f32_16x16x32_bf16 v[80:83], v[88:91], v[208:211], 0
    ds_read_b64_tr_b16 v[106:107], v15 offset:9504
    s_waitcnt vmcnt(9) lgkmcnt(6)
    v_mfma_f32_16x16x32_bf16 v[20:23], v[92:95], v[212:215], v[20:23]
    ds_read_b64_tr_b16 v[84:85], v3 offset:8704
    s_waitcnt vmcnt(8)
    v_mfma_f32_16x16x32_bf16 v[24:27], v[92:95], v[216:219], v[24:27]
    ds_read_b64_tr_b16 v[86:87], v3 offset:9728
    s_waitcnt lgkmcnt(6)
    v_mfma_f32_16x16x32_bf16 v[28:31], v[96:99], v[212:215], v[28:31]
    ds_read_b64_tr_b16 v[88:89], v15 offset:8736
    v_mfma_f32_16x16x32_bf16 v[32:35], v[96:99], v[216:219], v[32:35]
    ds_read_b64_tr_b16 v[90:91], v15 offset:9760
    s_mov_b32 s23, 0x1000
    buffer_load_dwordx4 v[148:151], v4, s[8:11], s23 offen offset:1024 sc1
    s_waitcnt lgkmcnt(6)
    v_mfma_f32_16x16x32_bf16 v[36:39], v[100:103], v[212:215], v[36:39]
    ds_read_b64_tr_b16 v[92:93], v3 offset:8960
    v_mfma_f32_16x16x32_bf16 v[40:43], v[100:103], v[216:219], v[40:43]
    ds_read_b64_tr_b16 v[94:95], v3 offset:9984
    s_waitcnt lgkmcnt(6)
    v_mfma_f32_16x16x32_bf16 v[44:47], v[104:107], v[212:215], v[44:47]
    ds_read_b64_tr_b16 v[96:97], v15 offset:8992
    v_mfma_f32_16x16x32_bf16 v[48:51], v[104:107], v[216:219], v[48:51]
    ds_read_b64_tr_b16 v[98:99], v15 offset:10016
    s_waitcnt lgkmcnt(6)
    v_mfma_f32_16x16x32_bf16 v[52:55], v[84:87], v[212:215], v[52:55]
    v_mfma_f32_16x16x32_bf16 v[56:59], v[84:87], v[216:219], v[56:59]
    s_barrier
    ds_read_b64_tr_b16 v[100:101], v3 offset:16384
    ds_read_b64_tr_b16 v[102:103], v3 offset:17408
    s_waitcnt lgkmcnt(6)
    v_mfma_f32_16x16x32_bf16 v[60:63], v[88:91], v[212:215], v[60:63]
    ds_read_b64_tr_b16 v[104:105], v15 offset:16416
    v_mfma_f32_16x16x32_bf16 v[64:67], v[88:91], v[216:219], v[64:67]
    ds_read_b64_tr_b16 v[106:107], v15 offset:17440
    s_mov_b32 s23, 0x9000
    buffer_load_dwordx4 v[152:155], v4, s[8:11], s23 offen offset:1024 sc1
    s_waitcnt lgkmcnt(6)
    v_mfma_f32_16x16x32_bf16 v[68:71], v[92:95], v[212:215], v[68:71]
    ds_read_b64_tr_b16 v[84:85], v3 offset:16640
    v_mfma_f32_16x16x32_bf16 v[72:75], v[92:95], v[216:219], v[72:75]
    ds_read_b64_tr_b16 v[86:87], v3 offset:17664
    s_waitcnt lgkmcnt(6)
    v_mfma_f32_16x16x32_bf16 v[76:79], v[96:99], v[212:215], v[76:79]
    ds_read_b64_tr_b16 v[88:89], v15 offset:16672
    v_mfma_f32_16x16x32_bf16 v[80:83], v[96:99], v[216:219], v[80:83]
    ds_read_b64_tr_b16 v[90:91], v15 offset:17696
    s_waitcnt vmcnt(9) lgkmcnt(6)
    v_mfma_f32_16x16x32_bf16 v[20:23], v[100:103], v[220:223], v[20:23]
    ds_read_b64_tr_b16 v[92:93], v3 offset:16896
    s_waitcnt vmcnt(7)
    v_mfma_f32_16x16x32_bf16 v[24:27], v[100:103], v[224:227], v[24:27]
    ds_read_b64_tr_b16 v[94:95], v3 offset:17920
    s_sub_u32 s19, s3, 4
    s_lshl_b32 s25, s2, 2
    s_add_u32 s63, s25, s19
    s_lshr_b32 s20, s63, 8
    s_bfe_u32 s21, s63, 0x40004
    s_and_b32 s24, s63, 15
    s_lshl_b32 s20, s20, 19
    s_lshl_b32 s21, s21, 13
    s_add_u32 s20, s20, s21
    s_add_u32 s20, s20, 393216
    v_and_b32 v168, 15, v0
    v_lshrrev_b32 v169, 4, v0
    s_mov_b64 s[28:29], s[34:35]
    s_mov_b32 s30, 0x200000
    s_mov_b32 s31, 0x20000
    s_cmp_lt_u32 s24, 8
    s_cselect_b32 s30, s30, 0
    v_lshlrev_b32 v170, 8, v168
    v_lshl_add_u32 v170, v169, 3, v170
    s_and_b32 s26, s24, 1
    s_lshl_b32 s26, s26, 12
    s_add_u32 s21, s20, s26
    s_bfe_u32 s26, s24, 0x20001
    s_lshl_b32 s26, s26, 6
    s_add_u32 s21, s21, s26
    buffer_load_dwordx2 v[156:157], v170, s[28:31], s21 offen
    buffer_load_dwordx2 v[158:159], v170, s[28:31], s21 offen offset:32
    s_mov_b64 s[64:65], s[36:37]
    s_mov_b32 s66, 0x200000
    s_mov_b32 s67, 0x20000
    s_cmp_ge_u32 s24, 8
    s_cselect_b32 s66, s66, 0
    s_and_b32 s26, s24, 7
    s_lshl_b32 s26, s26, 5
    s_add_u32 s20, s20, s26
    s_add_u32 s26, s20, 4096
    v_lshlrev_b32 v171, 10, v169
    v_lshl_add_u32 v171, v168, 1, v171
    buffer_load_ushort v160, v171, s[64:67], s20 offen offset:0
    buffer_load_ushort v161, v171, s[64:67], s20 offen offset:256
    buffer_load_ushort v162, v171, s[64:67], s20 offen offset:512
    buffer_load_ushort v163, v171, s[64:67], s20 offen offset:768
    buffer_load_ushort v164, v171, s[64:67], s26 offen offset:0
    buffer_load_ushort v165, v171, s[64:67], s26 offen offset:256
    buffer_load_ushort v166, v171, s[64:67], s26 offen offset:512
    buffer_load_ushort v167, v171, s[64:67], s26 offen offset:768
    s_waitcnt lgkmcnt(6)
    v_mfma_f32_16x16x32_bf16 v[28:31], v[104:107], v[220:223], v[28:31]
    ds_read_b64_tr_b16 v[96:97], v15 offset:16928
    v_mfma_f32_16x16x32_bf16 v[32:35], v[104:107], v[224:227], v[32:35]
    ds_read_b64_tr_b16 v[98:99], v15 offset:17952
    s_mov_b32 s23, 0x1800
    buffer_load_dwordx4 v[204:207], v4, s[8:11], s23 offen offset:0 sc1
    s_waitcnt lgkmcnt(6)
    v_mfma_f32_16x16x32_bf16 v[36:39], v[84:87], v[220:223], v[36:39]
    ds_read_b64_tr_b16 v[100:101], v3 offset:17152
    v_mfma_f32_16x16x32_bf16 v[40:43], v[84:87], v[224:227], v[40:43]
    ds_read_b64_tr_b16 v[102:103], v3 offset:18176
    s_waitcnt lgkmcnt(6)
    v_mfma_f32_16x16x32_bf16 v[44:47], v[88:91], v[220:223], v[44:47]
    ds_read_b64_tr_b16 v[104:105], v15 offset:17184
    v_mfma_f32_16x16x32_bf16 v[48:51], v[88:91], v[224:227], v[48:51]
    ds_read_b64_tr_b16 v[106:107], v15 offset:18208
    s_mov_b32 s26, 0x280000
    buffer_load_dword v18, v17, s[68:71], s26 offen
    s_waitcnt lgkmcnt(6)
    v_mfma_f32_16x16x32_bf16 v[52:55], v[92:95], v[220:223], v[52:55]
    ds_read_b64_tr_b16 v[84:85], v3 offset:24576
    v_mfma_f32_16x16x32_bf16 v[56:59], v[92:95], v[224:227], v[56:59]
    ds_read_b64_tr_b16 v[86:87], v3 offset:25600
    s_waitcnt lgkmcnt(6)
    v_mfma_f32_16x16x32_bf16 v[60:63], v[96:99], v[220:223], v[60:63]
    ds_read_b64_tr_b16 v[88:89], v15 offset:24608
    v_mfma_f32_16x16x32_bf16 v[64:67], v[96:99], v[224:227], v[64:67]
    ds_read_b64_tr_b16 v[90:91], v15 offset:25632
    s_mov_b32 s23, 0x9800
    buffer_load_dwordx4 v[208:211], v4, s[8:11], s23 offen offset:0 sc1
    s_waitcnt lgkmcnt(6)
    v_mfma_f32_16x16x32_bf16 v[68:71], v[100:103], v[220:223], v[68:71]
    ds_read_b64_tr_b16 v[92:93], v3 offset:24832
    v_mfma_f32_16x16x32_bf16 v[72:75], v[100:103], v[224:227], v[72:75]
    ds_read_b64_tr_b16 v[94:95], v3 offset:25856
    s_waitcnt lgkmcnt(6)
    v_mfma_f32_16x16x32_bf16 v[76:79], v[104:107], v[220:223], v[76:79]
    ds_read_b64_tr_b16 v[96:97], v15 offset:24864
    v_mfma_f32_16x16x32_bf16 v[80:83], v[104:107], v[224:227], v[80:83]
    ds_read_b64_tr_b16 v[98:99], v15 offset:25888
    s_waitcnt vmcnt(18) lgkmcnt(6)
    v_mfma_f32_16x16x32_bf16 v[20:23], v[84:87], v[228:231], v[20:23]
    ds_read_b64_tr_b16 v[100:101], v3 offset:25088
    s_waitcnt vmcnt(17)
    v_mfma_f32_16x16x32_bf16 v[24:27], v[84:87], v[232:235], v[24:27]
    ds_read_b64_tr_b16 v[102:103], v3 offset:26112
    s_waitcnt lgkmcnt(6)
    v_mfma_f32_16x16x32_bf16 v[28:31], v[88:91], v[228:231], v[28:31]
    ds_read_b64_tr_b16 v[104:105], v15 offset:25120
    v_mfma_f32_16x16x32_bf16 v[32:35], v[88:91], v[232:235], v[32:35]
    ds_read_b64_tr_b16 v[106:107], v15 offset:26144
    s_mov_b32 s23, 0x1800
    buffer_load_dwordx4 v[212:215], v4, s[8:11], s23 offen offset:1024 sc1
    s_waitcnt lgkmcnt(6)
    v_mfma_f32_16x16x32_bf16 v[36:39], v[92:95], v[228:231], v[36:39]
    ds_read_b64_tr_b16 v[84:85], v3 offset:25344
    v_mfma_f32_16x16x32_bf16 v[40:43], v[92:95], v[232:235], v[40:43]
    ds_read_b64_tr_b16 v[86:87], v3 offset:26368
    s_waitcnt lgkmcnt(6)
    v_mfma_f32_16x16x32_bf16 v[44:47], v[96:99], v[228:231], v[44:47]
    ds_read_b64_tr_b16 v[88:89], v15 offset:25376
    v_mfma_f32_16x16x32_bf16 v[48:51], v[96:99], v[232:235], v[48:51]
    ds_read_b64_tr_b16 v[90:91], v15 offset:26400
    s_waitcnt lgkmcnt(6)
    v_mfma_f32_16x16x32_bf16 v[52:55], v[100:103], v[228:231], v[52:55]
    v_mfma_f32_16x16x32_bf16 v[56:59], v[100:103], v[232:235], v[56:59]
    s_barrier
    ds_read_b64_tr_b16 v[92:93], v3 offset:32768
    ds_read_b64_tr_b16 v[94:95], v3 offset:33792
    s_waitcnt lgkmcnt(6)
    v_mfma_f32_16x16x32_bf16 v[60:63], v[104:107], v[228:231], v[60:63]
    ds_read_b64_tr_b16 v[96:97], v15 offset:32800
    v_mfma_f32_16x16x32_bf16 v[64:67], v[104:107], v[232:235], v[64:67]
    ds_read_b64_tr_b16 v[98:99], v15 offset:33824
    s_mov_b32 s23, 0x9800
    buffer_load_dwordx4 v[216:219], v4, s[8:11], s23 offen offset:1024 sc1
    s_waitcnt lgkmcnt(6)
    v_mfma_f32_16x16x32_bf16 v[68:71], v[84:87], v[228:231], v[68:71]
    ds_read_b64_tr_b16 v[100:101], v3 offset:33024
    v_mfma_f32_16x16x32_bf16 v[72:75], v[84:87], v[232:235], v[72:75]
    ds_read_b64_tr_b16 v[102:103], v3 offset:34048
    s_waitcnt lgkmcnt(6)
    v_mfma_f32_16x16x32_bf16 v[76:79], v[88:91], v[228:231], v[76:79]
    ds_read_b64_tr_b16 v[104:105], v15 offset:33056
    v_mfma_f32_16x16x32_bf16 v[80:83], v[88:91], v[232:235], v[80:83]
    ds_read_b64_tr_b16 v[106:107], v15 offset:34080
    s_waitcnt lgkmcnt(6)
    v_mfma_f32_16x16x32_bf16 v[20:23], v[92:95], v[140:143], v[20:23]
    ds_read_b64_tr_b16 v[84:85], v3 offset:33280
    s_waitcnt vmcnt(17)
    v_mfma_f32_16x16x32_bf16 v[24:27], v[92:95], v[144:147], v[24:27]
    ds_read_b64_tr_b16 v[86:87], v3 offset:34304
    s_waitcnt lgkmcnt(6)
    v_mfma_f32_16x16x32_bf16 v[28:31], v[96:99], v[140:143], v[28:31]
    ds_read_b64_tr_b16 v[88:89], v15 offset:33312
    v_mfma_f32_16x16x32_bf16 v[32:35], v[96:99], v[144:147], v[32:35]
    ds_read_b64_tr_b16 v[90:91], v15 offset:34336
    s_mov_b32 s23, 0x2000
    buffer_load_dwordx4 v[220:223], v4, s[8:11], s23 offen offset:0 sc1
    s_waitcnt lgkmcnt(6)
    v_mfma_f32_16x16x32_bf16 v[36:39], v[100:103], v[140:143], v[36:39]
    ds_read_b64_tr_b16 v[92:93], v3 offset:33536
    v_mfma_f32_16x16x32_bf16 v[40:43], v[100:103], v[144:147], v[40:43]
    ds_read_b64_tr_b16 v[94:95], v3 offset:34560
    s_waitcnt lgkmcnt(6)
    v_mfma_f32_16x16x32_bf16 v[44:47], v[104:107], v[140:143], v[44:47]
    ds_read_b64_tr_b16 v[96:97], v15 offset:33568
    v_mfma_f32_16x16x32_bf16 v[48:51], v[104:107], v[144:147], v[48:51]
    ds_read_b64_tr_b16 v[98:99], v15 offset:34592
    s_mov_b32 s26, 0x300000
    buffer_load_dword v18, v17, s[68:71], s26 offen
    s_waitcnt lgkmcnt(6)
    v_mfma_f32_16x16x32_bf16 v[52:55], v[84:87], v[140:143], v[52:55]
    ds_read_b64_tr_b16 v[100:101], v3 offset:40960
    v_mfma_f32_16x16x32_bf16 v[56:59], v[84:87], v[144:147], v[56:59]
    ds_read_b64_tr_b16 v[102:103], v3 offset:41984
    s_waitcnt lgkmcnt(6)
    v_mfma_f32_16x16x32_bf16 v[60:63], v[88:91], v[140:143], v[60:63]
    ds_read_b64_tr_b16 v[104:105], v15 offset:40992
    v_mfma_f32_16x16x32_bf16 v[64:67], v[88:91], v[144:147], v[64:67]
    ds_read_b64_tr_b16 v[106:107], v15 offset:42016
    s_mov_b32 s23, 0xa000
    buffer_load_dwordx4 v[224:227], v4, s[8:11], s23 offen offset:0 sc1
    s_waitcnt lgkmcnt(6)
    v_mfma_f32_16x16x32_bf16 v[68:71], v[92:95], v[140:143], v[68:71]
    ds_read_b64_tr_b16 v[84:85], v3 offset:41216
    v_mfma_f32_16x16x32_bf16 v[72:75], v[92:95], v[144:147], v[72:75]
    ds_read_b64_tr_b16 v[86:87], v3 offset:42240
    s_waitcnt lgkmcnt(6)
    v_mfma_f32_16x16x32_bf16 v[76:79], v[96:99], v[140:143], v[76:79]
    ds_read_b64_tr_b16 v[88:89], v15 offset:41248
    v_mfma_f32_16x16x32_bf16 v[80:83], v[96:99], v[144:147], v[80:83]
    ds_read_b64_tr_b16 v[90:91], v15 offset:42272
    s_waitcnt vmcnt(19) lgkmcnt(6)
    v_mfma_f32_16x16x32_bf16 v[20:23], v[100:103], v[148:151], v[20:23]
    ds_read_b64_tr_b16 v[92:93], v3 offset:41472
    s_waitcnt vmcnt(18)
    v_mfma_f32_16x16x32_bf16 v[24:27], v[100:103], v[152:155], v[24:27]
    ds_read_b64_tr_b16 v[94:95], v3 offset:42496
    s_waitcnt lgkmcnt(6)
    v_mfma_f32_16x16x32_bf16 v[28:31], v[104:107], v[148:151], v[28:31]
    ds_read_b64_tr_b16 v[96:97], v15 offset:41504
    v_mfma_f32_16x16x32_bf16 v[32:35], v[104:107], v[152:155], v[32:35]
    ds_read_b64_tr_b16 v[98:99], v15 offset:42528
    s_mov_b32 s23, 0x2000
    buffer_load_dwordx4 v[228:231], v4, s[8:11], s23 offen offset:1024 sc1
    s_waitcnt lgkmcnt(6)
    v_mfma_f32_16x16x32_bf16 v[36:39], v[84:87], v[148:151], v[36:39]
    ds_read_b64_tr_b16 v[100:101], v3 offset:41728
    v_mfma_f32_16x16x32_bf16 v[40:43], v[84:87], v[152:155], v[40:43]
    ds_read_b64_tr_b16 v[102:103], v3 offset:42752
    s_waitcnt lgkmcnt(6)
    v_mfma_f32_16x16x32_bf16 v[44:47], v[88:91], v[148:151], v[44:47]
    ds_read_b64_tr_b16 v[104:105], v15 offset:41760
    v_mfma_f32_16x16x32_bf16 v[48:51], v[88:91], v[152:155], v[48:51]
    ds_read_b64_tr_b16 v[106:107], v15 offset:42784
    s_waitcnt lgkmcnt(6)
    v_mfma_f32_16x16x32_bf16 v[52:55], v[92:95], v[148:151], v[52:55]
    v_mfma_f32_16x16x32_bf16 v[56:59], v[92:95], v[152:155], v[56:59]
    s_barrier
    ds_read_b64_tr_b16 v[84:85], v3 offset:49152
    ds_read_b64_tr_b16 v[86:87], v3 offset:50176
    s_waitcnt lgkmcnt(6)
    v_mfma_f32_16x16x32_bf16 v[60:63], v[96:99], v[148:151], v[60:63]
    ds_read_b64_tr_b16 v[88:89], v15 offset:49184
    v_mfma_f32_16x16x32_bf16 v[64:67], v[96:99], v[152:155], v[64:67]
    ds_read_b64_tr_b16 v[90:91], v15 offset:50208
    s_mov_b32 s23, 0xa000
    buffer_load_dwordx4 v[232:235], v4, s[8:11], s23 offen offset:1024 sc1
    s_waitcnt lgkmcnt(6)
    v_mfma_f32_16x16x32_bf16 v[68:71], v[100:103], v[148:151], v[68:71]
    ds_read_b64_tr_b16 v[92:93], v3 offset:49408
    v_mfma_f32_16x16x32_bf16 v[72:75], v[100:103], v[152:155], v[72:75]
    ds_read_b64_tr_b16 v[94:95], v3 offset:50432
    s_waitcnt lgkmcnt(6)
    v_mfma_f32_16x16x32_bf16 v[76:79], v[104:107], v[148:151], v[76:79]
    ds_read_b64_tr_b16 v[96:97], v15 offset:49440
    v_mfma_f32_16x16x32_bf16 v[80:83], v[104:107], v[152:155], v[80:83]
    ds_read_b64_tr_b16 v[98:99], v15 offset:50464
    s_waitcnt vmcnt(9) lgkmcnt(6)
    v_mfma_f32_16x16x32_bf16 v[20:23], v[84:87], v[204:207], v[20:23]
    ds_read_b64_tr_b16 v[100:101], v3 offset:49664
    s_waitcnt vmcnt(7)
    v_mfma_f32_16x16x32_bf16 v[24:27], v[84:87], v[208:211], v[24:27]
    ds_read_b64_tr_b16 v[102:103], v3 offset:50688
    v_lshl_or_b32 v160, v161, 16, v160
    v_or_b32 v156, v156, v160
    v_lshl_or_b32 v162, v163, 16, v162
    v_or_b32 v157, v157, v162
    v_lshl_or_b32 v164, v165, 16, v164
    v_or_b32 v158, v158, v164
    v_lshl_or_b32 v166, v167, 16, v166
    v_or_b32 v159, v159, v166
    s_lshl_b32 s27, s63, 10
    s_add_u32 s27, s27, 0x400000
    buffer_store_dwordx4 v[156:159], v1, s[8:11], s27 offen sc1
    s_waitcnt lgkmcnt(6)
    v_mfma_f32_16x16x32_bf16 v[28:31], v[88:91], v[204:207], v[28:31]
    ds_read_b64_tr_b16 v[104:105], v15 offset:49696
    v_mfma_f32_16x16x32_bf16 v[32:35], v[88:91], v[208:211], v[32:35]
    ds_read_b64_tr_b16 v[106:107], v15 offset:50720
    s_mov_b32 s23, 0x2800
    buffer_load_dwordx4 v[140:143], v4, s[8:11], s23 offen offset:0 sc1
    s_waitcnt lgkmcnt(6)
    v_mfma_f32_16x16x32_bf16 v[36:39], v[92:95], v[204:207], v[36:39]
    ds_read_b64_tr_b16 v[84:85], v3 offset:49920
    v_mfma_f32_16x16x32_bf16 v[40:43], v[92:95], v[208:211], v[40:43]
    ds_read_b64_tr_b16 v[86:87], v3 offset:50944
    s_waitcnt lgkmcnt(6)
    v_mfma_f32_16x16x32_bf16 v[44:47], v[96:99], v[204:207], v[44:47]
    ds_read_b64_tr_b16 v[88:89], v15 offset:49952
    v_mfma_f32_16x16x32_bf16 v[48:51], v[96:99], v[208:211], v[48:51]
    ds_read_b64_tr_b16 v[90:91], v15 offset:50976
    s_mov_b32 s26, 0x380000
    buffer_load_dword v18, v17, s[68:71], s26 offen
    s_waitcnt lgkmcnt(6)
    v_mfma_f32_16x16x32_bf16 v[52:55], v[100:103], v[204:207], v[52:55]
    ds_read_b64_tr_b16 v[92:93], v3 offset:57344
    v_mfma_f32_16x16x32_bf16 v[56:59], v[100:103], v[208:211], v[56:59]
    ds_read_b64_tr_b16 v[94:95], v3 offset:58368
    s_waitcnt lgkmcnt(6)
    v_mfma_f32_16x16x32_bf16 v[60:63], v[104:107], v[204:207], v[60:63]
    ds_read_b64_tr_b16 v[96:97], v15 offset:57376
    v_mfma_f32_16x16x32_bf16 v[64:67], v[104:107], v[208:211], v[64:67]
    ds_read_b64_tr_b16 v[98:99], v15 offset:58400
    s_mov_b32 s23, 0xa800
    buffer_load_dwordx4 v[144:147], v4, s[8:11], s23 offen offset:0 sc1
    s_waitcnt lgkmcnt(6)
    v_mfma_f32_16x16x32_bf16 v[68:71], v[84:87], v[204:207], v[68:71]
    ds_read_b64_tr_b16 v[100:101], v3 offset:57600
    v_mfma_f32_16x16x32_bf16 v[72:75], v[84:87], v[208:211], v[72:75]
    ds_read_b64_tr_b16 v[102:103], v3 offset:58624
    s_waitcnt lgkmcnt(6)
    v_mfma_f32_16x16x32_bf16 v[76:79], v[88:91], v[204:207], v[76:79]
    ds_read_b64_tr_b16 v[104:105], v15 offset:57632
    v_mfma_f32_16x16x32_bf16 v[80:83], v[88:91], v[208:211], v[80:83]
    ds_read_b64_tr_b16 v[106:107], v15 offset:58656
    s_waitcnt vmcnt(10) lgkmcnt(6)
    v_mfma_f32_16x16x32_bf16 v[20:23], v[92:95], v[212:215], v[20:23]
    ds_read_b64_tr_b16 v[84:85], v3 offset:57856
    s_waitcnt vmcnt(9)
    v_mfma_f32_16x16x32_bf16 v[24:27], v[92:95], v[216:219], v[24:27]
    ds_read_b64_tr_b16 v[86:87], v3 offset:58880
    s_waitcnt lgkmcnt(6)
    v_mfma_f32_16x16x32_bf16 v[28:31], v[96:99], v[212:215], v[28:31]
    ds_read_b64_tr_b16 v[88:89], v15 offset:57888
    v_mfma_f32_16x16x32_bf16 v[32:35], v[96:99], v[216:219], v[32:35]
    ds_read_b64_tr_b16 v[90:91], v15 offset:58912
    s_mov_b32 s23, 0x2800
    buffer_load_dwordx4 v[148:151], v4, s[8:11], s23 offen offset:1024 sc1
    s_waitcnt lgkmcnt(6)
    v_mfma_f32_16x16x32_bf16 v[36:39], v[100:103], v[212:215], v[36:39]
    ds_read_b64_tr_b16 v[92:93], v3 offset:58112
    v_mfma_f32_16x16x32_bf16 v[40:43], v[100:103], v[216:219], v[40:43]
    ds_read_b64_tr_b16 v[94:95], v3 offset:59136
    s_waitcnt lgkmcnt(6)
    v_mfma_f32_16x16x32_bf16 v[44:47], v[104:107], v[212:215], v[44:47]
    ds_read_b64_tr_b16 v[96:97], v15 offset:58144
    v_mfma_f32_16x16x32_bf16 v[48:51], v[104:107], v[216:219], v[48:51]
    ds_read_b64_tr_b16 v[98:99], v15 offset:59168
    s_waitcnt lgkmcnt(6)
    v_mfma_f32_16x16x32_bf16 v[52:55], v[84:87], v[212:215], v[52:55]
    v_mfma_f32_16x16x32_bf16 v[56:59], v[84:87], v[216:219], v[56:59]
    s_barrier
    ds_read_b64_tr_b16 v[100:101], v3 offset:0
    ds_read_b64_tr_b16 v[102:103], v3 offset:1024
    s_waitcnt lgkmcnt(6)
    v_mfma_f32_16x16x32_bf16 v[60:63], v[88:91], v[212:215], v[60:63]
    ds_read_b64_tr_b16 v[104:105], v15 offset:32
    v_mfma_f32_16x16x32_bf16 v[64:67], v[88:91], v[216:219], v[64:67]
    ds_read_b64_tr_b16 v[106:107], v15 offset:1056
    s_mov_b32 s23, 0xa800
    buffer_load_dwordx4 v[152:155], v4, s[8:11], s23 offen offset:1024 sc1
    s_waitcnt lgkmcnt(6)
    v_mfma_f32_16x16x32_bf16 v[68:71], v[92:95], v[212:215], v[68:71]
    ds_read_b64_tr_b16 v[84:85], v3 offset:256
    v_mfma_f32_16x16x32_bf16 v[72:75], v[92:95], v[216:219], v[72:75]
    ds_read_b64_tr_b16 v[86:87], v3 offset:1280
    s_waitcnt lgkmcnt(6)
    v_mfma_f32_16x16x32_bf16 v[76:79], v[96:99], v[212:215], v[76:79]
    ds_read_b64_tr_b16 v[88:89], v15 offset:288
    v_mfma_f32_16x16x32_bf16 v[80:83], v[96:99], v[216:219], v[80:83]
    ds_read_b64_tr_b16 v[90:91], v15 offset:1312
    s_waitcnt vmcnt(10) lgkmcnt(6)
    v_mfma_f32_16x16x32_bf16 v[20:23], v[100:103], v[220:223], v[20:23]
    ds_read_b64_tr_b16 v[92:93], v3 offset:512
    s_waitcnt vmcnt(8)
    v_mfma_f32_16x16x32_bf16 v[24:27], v[100:103], v[224:227], v[24:27]
    ds_read_b64_tr_b16 v[94:95], v3 offset:1536
    s_waitcnt lgkmcnt(6)
    v_mfma_f32_16x16x32_bf16 v[28:31], v[104:107], v[220:223], v[28:31]
    ds_read_b64_tr_b16 v[96:97], v15 offset:544
    v_mfma_f32_16x16x32_bf16 v[32:35], v[104:107], v[224:227], v[32:35]
    ds_read_b64_tr_b16 v[98:99], v15 offset:1568
    s_mov_b32 s23, 0x3000
    buffer_load_dwordx4 v[204:207], v4, s[8:11], s23 offen offset:0 sc1
    s_waitcnt lgkmcnt(6)
    v_mfma_f32_16x16x32_bf16 v[36:39], v[84:87], v[220:223], v[36:39]
    ds_read_b64_tr_b16 v[100:101], v3 offset:768
    v_mfma_f32_16x16x32_bf16 v[40:43], v[84:87], v[224:227], v[40:43]
    ds_read_b64_tr_b16 v[102:103], v3 offset:1792
    s_waitcnt lgkmcnt(6)
    v_mfma_f32_16x16x32_bf16 v[44:47], v[88:91], v[220:223], v[44:47]
    ds_read_b64_tr_b16 v[104:105], v15 offset:800
    v_mfma_f32_16x16x32_bf16 v[48:51], v[88:91], v[224:227], v[48:51]
    ds_read_b64_tr_b16 v[106:107], v15 offset:1824
    s_mov_b32 s26, 0x400000
    buffer_load_dword v18, v17, s[68:71], s26 offen
    s_waitcnt lgkmcnt(6)
    v_mfma_f32_16x16x32_bf16 v[52:55], v[92:95], v[220:223], v[52:55]
    ds_read_b64_tr_b16 v[84:85], v3 offset:8192
    v_mfma_f32_16x16x32_bf16 v[56:59], v[92:95], v[224:227], v[56:59]
    ds_read_b64_tr_b16 v[86:87], v3 offset:9216
    s_waitcnt lgkmcnt(6)
    v_mfma_f32_16x16x32_bf16 v[60:63], v[96:99], v[220:223], v[60:63]
    ds_read_b64_tr_b16 v[88:89], v15 offset:8224
    v_mfma_f32_16x16x32_bf16 v[64:67], v[96:99], v[224:227], v[64:67]
    ds_read_b64_tr_b16 v[90:91], v15 offset:9248
    s_mov_b32 s23, 0xb000
    buffer_load_dwordx4 v[208:211], v4, s[8:11], s23 offen offset:0 sc1
    s_waitcnt lgkmcnt(6)
    v_mfma_f32_16x16x32_bf16 v[68:71], v[100:103], v[220:223], v[68:71]
    ds_read_b64_tr_b16 v[92:93], v3 offset:8448
    v_mfma_f32_16x16x32_bf16 v[72:75], v[100:103], v[224:227], v[72:75]
    ds_read_b64_tr_b16 v[94:95], v3 offset:9472
    s_waitcnt lgkmcnt(6)
    v_mfma_f32_16x16x32_bf16 v[76:79], v[104:107], v[220:223], v[76:79]
    ds_read_b64_tr_b16 v[96:97], v15 offset:8480
    v_mfma_f32_16x16x32_bf16 v[80:83], v[104:107], v[224:227], v[80:83]
    ds_read_b64_tr_b16 v[98:99], v15 offset:9504
    s_waitcnt vmcnt(10) lgkmcnt(6)
    v_mfma_f32_16x16x32_bf16 v[20:23], v[84:87], v[228:231], v[20:23]
    ds_read_b64_tr_b16 v[100:101], v3 offset:8704
    s_waitcnt vmcnt(9)
    v_mfma_f32_16x16x32_bf16 v[24:27], v[84:87], v[232:235], v[24:27]
    ds_read_b64_tr_b16 v[102:103], v3 offset:9728
    s_waitcnt lgkmcnt(6)
    v_mfma_f32_16x16x32_bf16 v[28:31], v[88:91], v[228:231], v[28:31]
    ds_read_b64_tr_b16 v[104:105], v15 offset:8736
    v_mfma_f32_16x16x32_bf16 v[32:35], v[88:91], v[232:235], v[32:35]
    ds_read_b64_tr_b16 v[106:107], v15 offset:9760
    s_mov_b32 s23, 0x3000
    buffer_load_dwordx4 v[212:215], v4, s[8:11], s23 offen offset:1024 sc1
    s_waitcnt lgkmcnt(6)
    v_mfma_f32_16x16x32_bf16 v[36:39], v[92:95], v[228:231], v[36:39]
    ds_read_b64_tr_b16 v[84:85], v3 offset:8960
    v_mfma_f32_16x16x32_bf16 v[40:43], v[92:95], v[232:235], v[40:43]
    ds_read_b64_tr_b16 v[86:87], v3 offset:9984
    s_waitcnt lgkmcnt(6)
    v_mfma_f32_16x16x32_bf16 v[44:47], v[96:99], v[228:231], v[44:47]
    ds_read_b64_tr_b16 v[88:89], v15 offset:8992
    v_mfma_f32_16x16x32_bf16 v[48:51], v[96:99], v[232:235], v[48:51]
    ds_read_b64_tr_b16 v[90:91], v15 offset:10016
    s_waitcnt lgkmcnt(6)
    v_mfma_f32_16x16x32_bf16 v[52:55], v[100:103], v[228:231], v[52:55]
    v_mfma_f32_16x16x32_bf16 v[56:59], v[100:103], v[232:235], v[56:59]
    s_barrier
    ds_read_b64_tr_b16 v[92:93], v3 offset:16384
    ds_read_b64_tr_b16 v[94:95], v3 offset:17408
    s_waitcnt lgkmcnt(6)
    v_mfma_f32_16x16x32_bf16 v[60:63], v[104:107], v[228:231], v[60:63]
    ds_read_b64_tr_b16 v[96:97], v15 offset:16416
    v_mfma_f32_16x16x32_bf16 v[64:67], v[104:107], v[232:235], v[64:67]
    ds_read_b64_tr_b16 v[98:99], v15 offset:17440
    s_mov_b32 s23, 0xb000
    buffer_load_dwordx4 v[216:219], v4, s[8:11], s23 offen offset:1024 sc1
    s_waitcnt lgkmcnt(6)
    v_mfma_f32_16x16x32_bf16 v[68:71], v[84:87], v[228:231], v[68:71]
    ds_read_b64_tr_b16 v[100:101], v3 offset:16640
    v_mfma_f32_16x16x32_bf16 v[72:75], v[84:87], v[232:235], v[72:75]
    ds_read_b64_tr_b16 v[102:103], v3 offset:17664
    s_waitcnt lgkmcnt(6)
    v_mfma_f32_16x16x32_bf16 v[76:79], v[88:91], v[228:231], v[76:79]
    ds_read_b64_tr_b16 v[104:105], v15 offset:16672
    v_mfma_f32_16x16x32_bf16 v[80:83], v[88:91], v[232:235], v[80:83]
    ds_read_b64_tr_b16 v[106:107], v15 offset:17696
    s_waitcnt vmcnt(9) lgkmcnt(6)
    v_mfma_f32_16x16x32_bf16 v[20:23], v[92:95], v[140:143], v[20:23]
    ds_read_b64_tr_b16 v[84:85], v3 offset:16896
    s_waitcnt vmcnt(7)
    v_mfma_f32_16x16x32_bf16 v[24:27], v[92:95], v[144:147], v[24:27]
    ds_read_b64_tr_b16 v[86:87], v3 offset:17920
    s_lshl_b32 s26, s63, 2
    s_add_u32 s26, s26, 0x530000
    v_mov_b32 v168, s14
    v_mov_b32 v169, 0
    s_mov_b64 exec, 1
    buffer_store_dword v168, v169, s[8:11], s26 offen sc1
    s_mov_b64 exec, -1
    s_nop 3
    s_waitcnt lgkmcnt(6)
    v_mfma_f32_16x16x32_bf16 v[28:31], v[96:99], v[140:143], v[28:31]
    ds_read_b64_tr_b16 v[88:89], v15 offset:16928
    v_mfma_f32_16x16x32_bf16 v[32:35], v[96:99], v[144:147], v[32:35]
    ds_read_b64_tr_b16 v[90:91], v15 offset:17952
    s_mov_b32 s23, 0x3800
    buffer_load_dwordx4 v[220:223], v4, s[8:11], s23 offen offset:0 sc1
    s_waitcnt lgkmcnt(6)
    v_mfma_f32_16x16x32_bf16 v[36:39], v[100:103], v[140:143], v[36:39]
    ds_read_b64_tr_b16 v[92:93], v3 offset:17152
    v_mfma_f32_16x16x32_bf16 v[40:43], v[100:103], v[144:147], v[40:43]
    ds_read_b64_tr_b16 v[94:95], v3 offset:18176
    s_waitcnt lgkmcnt(6)
    v_mfma_f32_16x16x32_bf16 v[44:47], v[104:107], v[140:143], v[44:47]
    ds_read_b64_tr_b16 v[96:97], v15 offset:17184
    v_mfma_f32_16x16x32_bf16 v[48:51], v[104:107], v[144:147], v[48:51]
    ds_read_b64_tr_b16 v[98:99], v15 offset:18208
    s_mov_b32 s26, 0x480000
    buffer_load_dword v18, v17, s[68:71], s26 offen
    s_waitcnt lgkmcnt(6)
    v_mfma_f32_16x16x32_bf16 v[52:55], v[84:87], v[140:143], v[52:55]
    ds_read_b64_tr_b16 v[100:101], v3 offset:24576
    v_mfma_f32_16x16x32_bf16 v[56:59], v[84:87], v[144:147], v[56:59]
    ds_read_b64_tr_b16 v[102:103], v3 offset:25600
    s_waitcnt lgkmcnt(6)
    v_mfma_f32_16x16x32_bf16 v[60:63], v[88:91], v[140:143], v[60:63]
    ds_read_b64_tr_b16 v[104:105], v15 offset:24608
    v_mfma_f32_16x16x32_bf16 v[64:67], v[88:91], v[144:147], v[64:67]
    ds_read_b64_tr_b16 v[106:107], v15 offset:25632
    s_mov_b32 s23, 0xb800
    buffer_load_dwordx4 v[224:227], v4, s[8:11], s23 offen offset:0 sc1
    s_waitcnt lgkmcnt(6)
    v_mfma_f32_16x16x32_bf16 v[68:71], v[92:95], v[140:143], v[68:71]
    ds_read_b64_tr_b16 v[84:85], v3 offset:24832
    v_mfma_f32_16x16x32_bf16 v[72:75], v[92:95], v[144:147], v[72:75]
    ds_read_b64_tr_b16 v[86:87], v3 offset:25856
    s_waitcnt lgkmcnt(6)
    v_mfma_f32_16x16x32_bf16 v[76:79], v[96:99], v[140:143], v[76:79]
    ds_read_b64_tr_b16 v[88:89], v15 offset:24864
    v_mfma_f32_16x16x32_bf16 v[80:83], v[96:99], v[144:147], v[80:83]
    ds_read_b64_tr_b16 v[90:91], v15 offset:25888
    s_waitcnt vmcnt(10) lgkmcnt(6)
    v_mfma_f32_16x16x32_bf16 v[20:23], v[100:103], v[148:151], v[20:23]
    ds_read_b64_tr_b16 v[92:93], v3 offset:25088
    s_waitcnt vmcnt(9)
    v_mfma_f32_16x16x32_bf16 v[24:27], v[100:103], v[152:155], v[24:27]
    ds_read_b64_tr_b16 v[94:95], v3 offset:26112
    s_waitcnt lgkmcnt(6)
    v_mfma_f32_16x16x32_bf16 v[28:31], v[104:107], v[148:151], v[28:31]
    ds_read_b64_tr_b16 v[96:97], v15 offset:25120
    v_mfma_f32_16x16x32_bf16 v[32:35], v[104:107], v[152:155], v[32:35]
    ds_read_b64_tr_b16 v[98:99], v15 offset:26144
    s_mov_b32 s23, 0x3800
    buffer_load_dwordx4 v[228:231], v4, s[8:11], s23 offen offset:1024 sc1
    s_waitcnt lgkmcnt(6)
    v_mfma_f32_16x16x32_bf16 v[36:39], v[84:87], v[148:151], v[36:39]
    ds_read_b64_tr_b16 v[100:101], v3 offset:25344
    v_mfma_f32_16x16x32_bf16 v[40:43], v[84:87], v[152:155], v[40:43]
    ds_read_b64_tr_b16 v[102:103], v3 offset:26368
    s_waitcnt lgkmcnt(6)
    v_mfma_f32_16x16x32_bf16 v[44:47], v[88:91], v[148:151], v[44:47]
    ds_read_b64_tr_b16 v[104:105], v15 offset:25376
    v_mfma_f32_16x16x32_bf16 v[48:51], v[88:91], v[152:155], v[48:51]
    ds_read_b64_tr_b16 v[106:107], v15 offset:26400
    s_waitcnt lgkmcnt(6)
    v_mfma_f32_16x16x32_bf16 v[52:55], v[92:95], v[148:151], v[52:55]
    v_mfma_f32_16x16x32_bf16 v[56:59], v[92:95], v[152:155], v[56:59]
    s_barrier
    ds_read_b64_tr_b16 v[84:85], v3 offset:32768
    ds_read_b64_tr_b16 v[86:87], v3 offset:33792
    s_waitcnt lgkmcnt(6)
    v_mfma_f32_16x16x32_bf16 v[60:63], v[96:99], v[148:151], v[60:63]
    ds_read_b64_tr_b16 v[88:89], v15 offset:32800
    v_mfma_f32_16x16x32_bf16 v[64:67], v[96:99], v[152:155], v[64:67]
    ds_read_b64_tr_b16 v[90:91], v15 offset:33824
    s_mov_b32 s23, 0xb800
    buffer_load_dwordx4 v[232:235], v4, s[8:11], s23 offen offset:1024 sc1
    s_waitcnt lgkmcnt(6)
    v_mfma_f32_16x16x32_bf16 v[68:71], v[100:103], v[148:151], v[68:71]
    ds_read_b64_tr_b16 v[92:93], v3 offset:33024
    v_mfma_f32_16x16x32_bf16 v[72:75], v[100:103], v[152:155], v[72:75]
    ds_read_b64_tr_b16 v[94:95], v3 offset:34048
    s_waitcnt lgkmcnt(6)
    v_mfma_f32_16x16x32_bf16 v[76:79], v[104:107], v[148:151], v[76:79]
    ds_read_b64_tr_b16 v[96:97], v15 offset:33056
    v_mfma_f32_16x16x32_bf16 v[80:83], v[104:107], v[152:155], v[80:83]
    ds_read_b64_tr_b16 v[98:99], v15 offset:34080
    s_waitcnt vmcnt(10) lgkmcnt(6)
    v_mfma_f32_16x16x32_bf16 v[20:23], v[84:87], v[204:207], v[20:23]
    ds_read_b64_tr_b16 v[100:101], v3 offset:33280
    s_waitcnt vmcnt(8)
    v_mfma_f32_16x16x32_bf16 v[24:27], v[84:87], v[208:211], v[24:27]
    ds_read_b64_tr_b16 v[102:103], v3 offset:34304
    s_waitcnt lgkmcnt(6)
    v_mfma_f32_16x16x32_bf16 v[28:31], v[88:91], v[204:207], v[28:31]
    ds_read_b64_tr_b16 v[104:105], v15 offset:33312
    v_mfma_f32_16x16x32_bf16 v[32:35], v[88:91], v[208:211], v[32:35]
    ds_read_b64_tr_b16 v[106:107], v15 offset:34336
    s_mov_b32 s23, 0x4000
    buffer_load_dwordx4 v[140:143], v4, s[8:11], s23 offen offset:0 sc1
    s_waitcnt lgkmcnt(6)
    v_mfma_f32_16x16x32_bf16 v[36:39], v[92:95], v[204:207], v[36:39]
    ds_read_b64_tr_b16 v[84:85], v3 offset:33536
    v_mfma_f32_16x16x32_bf16 v[40:43], v[92:95], v[208:211], v[40:43]
    ds_read_b64_tr_b16 v[86:87], v3 offset:34560
    s_waitcnt lgkmcnt(6)
    v_mfma_f32_16x16x32_bf16 v[44:47], v[96:99], v[204:207], v[44:47]
    ds_read_b64_tr_b16 v[88:89], v15 offset:33568
    v_mfma_f32_16x16x32_bf16 v[48:51], v[96:99], v[208:211], v[48:51]
    ds_read_b64_tr_b16 v[90:91], v15 offset:34592
    s_mov_b32 s26, 0x500000
    buffer_load_dword v18, v17, s[68:71], s26 offen
    s_waitcnt lgkmcnt(6)
    v_mfma_f32_16x16x32_bf16 v[52:55], v[100:103], v[204:207], v[52:55]
    ds_read_b64_tr_b16 v[92:93], v3 offset:40960
    v_mfma_f32_16x16x32_bf16 v[56:59], v[100:103], v[208:211], v[56:59]
    ds_read_b64_tr_b16 v[94:95], v3 offset:41984
    s_waitcnt lgkmcnt(6)
    v_mfma_f32_16x16x32_bf16 v[60:63], v[104:107], v[204:207], v[60:63]
    ds_read_b64_tr_b16 v[96:97], v15 offset:40992
    v_mfma_f32_16x16x32_bf16 v[64:67], v[104:107], v[208:211], v[64:67]
    ds_read_b64_tr_b16 v[98:99], v15 offset:42016
    s_mov_b32 s23, 0xc000
    buffer_load_dwordx4 v[144:147], v4, s[8:11], s23 offen offset:0 sc1
    s_waitcnt lgkmcnt(6)
    v_mfma_f32_16x16x32_bf16 v[68:71], v[84:87], v[204:207], v[68:71]
    ds_read_b64_tr_b16 v[100:101], v3 offset:41216
    v_mfma_f32_16x16x32_bf16 v[72:75], v[84:87], v[208:211], v[72:75]
    ds_read_b64_tr_b16 v[102:103], v3 offset:42240
    s_waitcnt lgkmcnt(6)
    v_mfma_f32_16x16x32_bf16 v[76:79], v[88:91], v[204:207], v[76:79]
    ds_read_b64_tr_b16 v[104:105], v15 offset:41248
    v_mfma_f32_16x16x32_bf16 v[80:83], v[88:91], v[208:211], v[80:83]
    ds_read_b64_tr_b16 v[106:107], v15 offset:42272
    s_waitcnt vmcnt(10) lgkmcnt(6)
    v_mfma_f32_16x16x32_bf16 v[20:23], v[92:95], v[212:215], v[20:23]
    ds_read_b64_tr_b16 v[84:85], v3 offset:41472
    s_waitcnt vmcnt(9)
    v_mfma_f32_16x16x32_bf16 v[24:27], v[92:95], v[216:219], v[24:27]
    ds_read_b64_tr_b16 v[86:87], v3 offset:42496
    s_waitcnt lgkmcnt(6)
    v_mfma_f32_16x16x32_bf16 v[28:31], v[96:99], v[212:215], v[28:31]
    ds_read_b64_tr_b16 v[88:89], v15 offset:41504
    v_mfma_f32_16x16x32_bf16 v[32:35], v[96:99], v[216:219], v[32:35]
    ds_read_b64_tr_b16 v[90:91], v15 offset:42528
    s_mov_b32 s23, 0x4000
    buffer_load_dwordx4 v[148:151], v4, s[8:11], s23 offen offset:1024 sc1
    s_waitcnt lgkmcnt(6)
    v_mfma_f32_16x16x32_bf16 v[36:39], v[100:103], v[212:215], v[36:39]
    ds_read_b64_tr_b16 v[92:93], v3 offset:41728
    v_mfma_f32_16x16x32_bf16 v[40:43], v[100:103], v[216:219], v[40:43]
    ds_read_b64_tr_b16 v[94:95], v3 offset:42752
    s_waitcnt lgkmcnt(6)
    v_mfma_f32_16x16x32_bf16 v[44:47], v[104:107], v[212:215], v[44:47]
    ds_read_b64_tr_b16 v[96:97], v15 offset:41760
    v_mfma_f32_16x16x32_bf16 v[48:51], v[104:107], v[216:219], v[48:51]
    ds_read_b64_tr_b16 v[98:99], v15 offset:42784
    s_waitcnt lgkmcnt(6)
    v_mfma_f32_16x16x32_bf16 v[52:55], v[84:87], v[212:215], v[52:55]
    v_mfma_f32_16x16x32_bf16 v[56:59], v[84:87], v[216:219], v[56:59]
    s_barrier
    ds_read_b64_tr_b16 v[100:101], v3 offset:49152
    ds_read_b64_tr_b16 v[102:103], v3 offset:50176
    s_waitcnt lgkmcnt(6)
    v_mfma_f32_16x16x32_bf16 v[60:63], v[88:91], v[212:215], v[60:63]
    ds_read_b64_tr_b16 v[104:105], v15 offset:49184
    v_mfma_f32_16x16x32_bf16 v[64:67], v[88:91], v[216:219], v[64:67]
    ds_read_b64_tr_b16 v[106:107], v15 offset:50208
    s_mov_b32 s23, 0xc000
    buffer_load_dwordx4 v[152:155], v4, s[8:11], s23 offen offset:1024 sc1
    s_waitcnt lgkmcnt(6)
    v_mfma_f32_16x16x32_bf16 v[68:71], v[92:95], v[212:215], v[68:71]
    ds_read_b64_tr_b16 v[84:85], v3 offset:49408
    v_mfma_f32_16x16x32_bf16 v[72:75], v[92:95], v[216:219], v[72:75]
    ds_read_b64_tr_b16 v[86:87], v3 offset:50432
    s_waitcnt lgkmcnt(6)
    v_mfma_f32_16x16x32_bf16 v[76:79], v[96:99], v[212:215], v[76:79]
    ds_read_b64_tr_b16 v[88:89], v15 offset:49440
    v_mfma_f32_16x16x32_bf16 v[80:83], v[96:99], v[216:219], v[80:83]
    ds_read_b64_tr_b16 v[90:91], v15 offset:50464
    s_waitcnt vmcnt(9) lgkmcnt(6)
    v_mfma_f32_16x16x32_bf16 v[20:23], v[100:103], v[220:223], v[20:23]
    ds_read_b64_tr_b16 v[92:93], v3 offset:49664
    s_waitcnt vmcnt(7)
    v_mfma_f32_16x16x32_bf16 v[24:27], v[100:103], v[224:227], v[24:27]
    ds_read_b64_tr_b16 v[94:95], v3 offset:50688
    s_waitcnt lgkmcnt(6)
    v_mfma_f32_16x16x32_bf16 v[28:31], v[104:107], v[220:223], v[28:31]
    ds_read_b64_tr_b16 v[96:97], v15 offset:49696
    v_mfma_f32_16x16x32_bf16 v[32:35], v[104:107], v[224:227], v[32:35]
    ds_read_b64_tr_b16 v[98:99], v15 offset:50720
    s_mov_b32 s23, 0x4800
    buffer_load_dwordx4 v[204:207], v4, s[8:11], s23 offen offset:0 sc1
    s_waitcnt lgkmcnt(6)
    v_mfma_f32_16x16x32_bf16 v[36:39], v[84:87], v[220:223], v[36:39]
    ds_read_b64_tr_b16 v[100:101], v3 offset:49920
    v_mfma_f32_16x16x32_bf16 v[40:43], v[84:87], v[224:227], v[40:43]
    ds_read_b64_tr_b16 v[102:103], v3 offset:50944
    s_waitcnt lgkmcnt(6)
    v_mfma_f32_16x16x32_bf16 v[44:47], v[88:91], v[220:223], v[44:47]
    ds_read_b64_tr_b16 v[104:105], v15 offset:49952
    v_mfma_f32_16x16x32_bf16 v[48:51], v[88:91], v[224:227], v[48:51]
    ds_read_b64_tr_b16 v[106:107], v15 offset:50976
    s_mov_b32 s26, 0x580000
    buffer_load_dword v18, v17, s[68:71], s26 offen
    s_waitcnt lgkmcnt(6)
    v_mfma_f32_16x16x32_bf16 v[52:55], v[92:95], v[220:223], v[52:55]
    ds_read_b64_tr_b16 v[84:85], v3 offset:57344
    v_mfma_f32_16x16x32_bf16 v[56:59], v[92:95], v[224:227], v[56:59]
    ds_read_b64_tr_b16 v[86:87], v3 offset:58368
    s_waitcnt lgkmcnt(6)
    v_mfma_f32_16x16x32_bf16 v[60:63], v[96:99], v[220:223], v[60:63]
    ds_read_b64_tr_b16 v[88:89], v15 offset:57376
    v_mfma_f32_16x16x32_bf16 v[64:67], v[96:99], v[224:227], v[64:67]
    ds_read_b64_tr_b16 v[90:91], v15 offset:58400
    s_mov_b32 s23, 0xc800
    buffer_load_dwordx4 v[208:211], v4, s[8:11], s23 offen offset:0 sc1
    s_waitcnt lgkmcnt(6)
    v_mfma_f32_16x16x32_bf16 v[68:71], v[100:103], v[220:223], v[68:71]
    ds_read_b64_tr_b16 v[92:93], v3 offset:57600
    v_mfma_f32_16x16x32_bf16 v[72:75], v[100:103], v[224:227], v[72:75]
    ds_read_b64_tr_b16 v[94:95], v3 offset:58624
    s_waitcnt lgkmcnt(6)
    v_mfma_f32_16x16x32_bf16 v[76:79], v[104:107], v[220:223], v[76:79]
    ds_read_b64_tr_b16 v[96:97], v15 offset:57632
    v_mfma_f32_16x16x32_bf16 v[80:83], v[104:107], v[224:227], v[80:83]
    ds_read_b64_tr_b16 v[98:99], v15 offset:58656
    s_waitcnt vmcnt(9) lgkmcnt(6)
    v_mfma_f32_16x16x32_bf16 v[20:23], v[84:87], v[228:231], v[20:23]
    ds_read_b64_tr_b16 v[100:101], v3 offset:57856
    s_waitcnt vmcnt(8)
    v_mfma_f32_16x16x32_bf16 v[24:27], v[84:87], v[232:235], v[24:27]
    ds_read_b64_tr_b16 v[102:103], v3 offset:58880
    s_waitcnt lgkmcnt(6)
    v_mfma_f32_16x16x32_bf16 v[28:31], v[88:91], v[228:231], v[28:31]
    ds_read_b64_tr_b16 v[104:105], v15 offset:57888
    v_mfma_f32_16x16x32_bf16 v[32:35], v[88:91], v[232:235], v[32:35]
    ds_read_b64_tr_b16 v[106:107], v15 offset:58912
    s_mov_b32 s23, 0x4800
    buffer_load_dwordx4 v[212:215], v4, s[8:11], s23 offen offset:1024 sc1
    s_waitcnt lgkmcnt(6)
    v_mfma_f32_16x16x32_bf16 v[36:39], v[92:95], v[228:231], v[36:39]
    ds_read_b64_tr_b16 v[84:85], v3 offset:58112
    v_mfma_f32_16x16x32_bf16 v[40:43], v[92:95], v[232:235], v[40:43]
    ds_read_b64_tr_b16 v[86:87], v3 offset:59136
    s_waitcnt lgkmcnt(6)
    v_mfma_f32_16x16x32_bf16 v[44:47], v[96:99], v[228:231], v[44:47]
    ds_read_b64_tr_b16 v[88:89], v15 offset:58144
    v_mfma_f32_16x16x32_bf16 v[48:51], v[96:99], v[232:235], v[48:51]
    ds_read_b64_tr_b16 v[90:91], v15 offset:59168
    s_waitcnt lgkmcnt(6)
    v_mfma_f32_16x16x32_bf16 v[52:55], v[100:103], v[228:231], v[52:55]
    v_mfma_f32_16x16x32_bf16 v[56:59], v[100:103], v[232:235], v[56:59]
    s_barrier
    ds_read_b64_tr_b16 v[92:93], v3 offset:0
    ds_read_b64_tr_b16 v[94:95], v3 offset:1024
    s_waitcnt lgkmcnt(6)
    v_mfma_f32_16x16x32_bf16 v[60:63], v[104:107], v[228:231], v[60:63]
    ds_read_b64_tr_b16 v[96:97], v15 offset:32
    v_mfma_f32_16x16x32_bf16 v[64:67], v[104:107], v[232:235], v[64:67]
    ds_read_b64_tr_b16 v[98:99], v15 offset:1056
    s_mov_b32 s23, 0xc800
    buffer_load_dwordx4 v[216:219], v4, s[8:11], s23 offen offset:1024 sc1
    s_waitcnt lgkmcnt(6)
    v_mfma_f32_16x16x32_bf16 v[68:71], v[84:87], v[228:231], v[68:71]
    ds_read_b64_tr_b16 v[100:101], v3 offset:256
    v_mfma_f32_16x16x32_bf16 v[72:75], v[84:87], v[232:235], v[72:75]
    ds_read_b64_tr_b16 v[102:103], v3 offset:1280
    s_waitcnt lgkmcnt(6)
    v_mfma_f32_16x16x32_bf16 v[76:79], v[88:91], v[228:231], v[76:79]
    ds_read_b64_tr_b16 v[104:105], v15 offset:288
    v_mfma_f32_16x16x32_bf16 v[80:83], v[88:91], v[232:235], v[80:83]
    ds_read_b64_tr_b16 v[106:107], v15 offset:1312
    s_waitcnt vmcnt(9) lgkmcnt(6)
    v_mfma_f32_16x16x32_bf16 v[20:23], v[92:95], v[140:143], v[20:23]
    ds_read_b64_tr_b16 v[84:85], v3 offset:512
    s_waitcnt vmcnt(7)
    v_mfma_f32_16x16x32_bf16 v[24:27], v[92:95], v[144:147], v[24:27]
    ds_read_b64_tr_b16 v[86:87], v3 offset:1536
    s_waitcnt lgkmcnt(6)
    v_mfma_f32_16x16x32_bf16 v[28:31], v[96:99], v[140:143], v[28:31]
    ds_read_b64_tr_b16 v[88:89], v15 offset:544
    v_mfma_f32_16x16x32_bf16 v[32:35], v[96:99], v[144:147], v[32:35]
    ds_read_b64_tr_b16 v[90:91], v15 offset:1568
    s_mov_b32 s23, 0x5000
    buffer_load_dwordx4 v[220:223], v4, s[8:11], s23 offen offset:0 sc1
    s_waitcnt lgkmcnt(6)
    v_mfma_f32_16x16x32_bf16 v[36:39], v[100:103], v[140:143], v[36:39]
    ds_read_b64_tr_b16 v[92:93], v3 offset:768
    v_mfma_f32_16x16x32_bf16 v[40:43], v[100:103], v[144:147], v[40:43]
    ds_read_b64_tr_b16 v[94:95], v3 offset:1792
    s_waitcnt lgkmcnt(6)
    v_mfma_f32_16x16x32_bf16 v[44:47], v[104:107], v[140:143], v[44:47]
    ds_read_b64_tr_b16 v[96:97], v15 offset:800
    v_mfma_f32_16x16x32_bf16 v[48:51], v[104:107], v[144:147], v[48:51]
    ds_read_b64_tr_b16 v[98:99], v15 offset:1824
    s_mov_b32 s26, 0x600000
    buffer_load_dword v18, v17, s[68:71], s26 offen
    s_waitcnt lgkmcnt(6)
    v_mfma_f32_16x16x32_bf16 v[52:55], v[84:87], v[140:143], v[52:55]
    ds_read_b64_tr_b16 v[100:101], v3 offset:8192
    v_mfma_f32_16x16x32_bf16 v[56:59], v[84:87], v[144:147], v[56:59]
    ds_read_b64_tr_b16 v[102:103], v3 offset:9216
    s_waitcnt lgkmcnt(6)
    v_mfma_f32_16x16x32_bf16 v[60:63], v[88:91], v[140:143], v[60:63]
    ds_read_b64_tr_b16 v[104:105], v15 offset:8224
    v_mfma_f32_16x16x32_bf16 v[64:67], v[88:91], v[144:147], v[64:67]
    ds_read_b64_tr_b16 v[106:107], v15 offset:9248
    s_mov_b32 s23, 0xd000
    buffer_load_dwordx4 v[224:227], v4, s[8:11], s23 offen offset:0 sc1
    s_waitcnt lgkmcnt(6)
    v_mfma_f32_16x16x32_bf16 v[68:71], v[92:95], v[140:143], v[68:71]
    ds_read_b64_tr_b16 v[84:85], v3 offset:8448
    v_mfma_f32_16x16x32_bf16 v[72:75], v[92:95], v[144:147], v[72:75]
    ds_read_b64_tr_b16 v[86:87], v3 offset:9472
    s_waitcnt lgkmcnt(6)
    v_mfma_f32_16x16x32_bf16 v[76:79], v[96:99], v[140:143], v[76:79]
    ds_read_b64_tr_b16 v[88:89], v15 offset:8480
    v_mfma_f32_16x16x32_bf16 v[80:83], v[96:99], v[144:147], v[80:83]
    ds_read_b64_tr_b16 v[90:91], v15 offset:9504
    s_waitcnt vmcnt(9) lgkmcnt(6)
    v_mfma_f32_16x16x32_bf16 v[20:23], v[100:103], v[148:151], v[20:23]
    ds_read_b64_tr_b16 v[92:93], v3 offset:8704
    s_waitcnt vmcnt(8)
    v_mfma_f32_16x16x32_bf16 v[24:27], v[100:103], v[152:155], v[24:27]
    ds_read_b64_tr_b16 v[94:95], v3 offset:9728
    s_waitcnt lgkmcnt(6)
    v_mfma_f32_16x16x32_bf16 v[28:31], v[104:107], v[148:151], v[28:31]
    ds_read_b64_tr_b16 v[96:97], v15 offset:8736
    v_mfma_f32_16x16x32_bf16 v[32:35], v[104:107], v[152:155], v[32:35]
    ds_read_b64_tr_b16 v[98:99], v15 offset:9760
    s_mov_b32 s23, 0x5000
    buffer_load_dwordx4 v[228:231], v4, s[8:11], s23 offen offset:1024 sc1
    s_waitcnt lgkmcnt(6)
    v_mfma_f32_16x16x32_bf16 v[36:39], v[84:87], v[148:151], v[36:39]
    ds_read_b64_tr_b16 v[100:101], v3 offset:8960
    v_mfma_f32_16x16x32_bf16 v[40:43], v[84:87], v[152:155], v[40:43]
    ds_read_b64_tr_b16 v[102:103], v3 offset:9984
    s_waitcnt lgkmcnt(6)
    v_mfma_f32_16x16x32_bf16 v[44:47], v[88:91], v[148:151], v[44:47]
    ds_read_b64_tr_b16 v[104:105], v15 offset:8992
    v_mfma_f32_16x16x32_bf16 v[48:51], v[88:91], v[152:155], v[48:51]
    ds_read_b64_tr_b16 v[106:107], v15 offset:10016
    s_waitcnt lgkmcnt(6)
    v_mfma_f32_16x16x32_bf16 v[52:55], v[92:95], v[148:151], v[52:55]
    v_mfma_f32_16x16x32_bf16 v[56:59], v[92:95], v[152:155], v[56:59]
    s_barrier
    ds_read_b64_tr_b16 v[84:85], v3 offset:16384
    ds_read_b64_tr_b16 v[86:87], v3 offset:17408
    s_waitcnt lgkmcnt(6)
    v_mfma_f32_16x16x32_bf16 v[60:63], v[96:99], v[148:151], v[60:63]
    ds_read_b64_tr_b16 v[88:89], v15 offset:16416
    v_mfma_f32_16x16x32_bf16 v[64:67], v[96:99], v[152:155], v[64:67]
    ds_read_b64_tr_b16 v[90:91], v15 offset:17440
    s_mov_b32 s23, 0xd000
    buffer_load_dwordx4 v[232:235], v4, s[8:11], s23 offen offset:1024 sc1
    s_waitcnt lgkmcnt(6)
    v_mfma_f32_16x16x32_bf16 v[68:71], v[100:103], v[148:151], v[68:71]
    ds_read_b64_tr_b16 v[92:93], v3 offset:16640
    v_mfma_f32_16x16x32_bf16 v[72:75], v[100:103], v[152:155], v[72:75]
    ds_read_b64_tr_b16 v[94:95], v3 offset:17664
    s_waitcnt lgkmcnt(6)
    v_mfma_f32_16x16x32_bf16 v[76:79], v[104:107], v[148:151], v[76:79]
    ds_read_b64_tr_b16 v[96:97], v15 offset:16672
    v_mfma_f32_16x16x32_bf16 v[80:83], v[104:107], v[152:155], v[80:83]
    ds_read_b64_tr_b16 v[98:99], v15 offset:17696
    s_waitcnt vmcnt(9) lgkmcnt(6)
    v_mfma_f32_16x16x32_bf16 v[20:23], v[84:87], v[204:207], v[20:23]
    ds_read_b64_tr_b16 v[100:101], v3 offset:16896
    s_waitcnt vmcnt(7)
    v_mfma_f32_16x16x32_bf16 v[24:27], v[84:87], v[208:211], v[24:27]
    ds_read_b64_tr_b16 v[102:103], v3 offset:17920
    s_waitcnt lgkmcnt(6)
    v_mfma_f32_16x16x32_bf16 v[28:31], v[88:91], v[204:207], v[28:31]
    ds_read_b64_tr_b16 v[104:105], v15 offset:16928
    v_mfma_f32_16x16x32_bf16 v[32:35], v[88:91], v[208:211], v[32:35]
    ds_read_b64_tr_b16 v[106:107], v15 offset:17952
    s_mov_b32 s23, 0x5800
    buffer_load_dwordx4 v[140:143], v4, s[8:11], s23 offen offset:0 sc1
    s_waitcnt lgkmcnt(6)
    v_mfma_f32_16x16x32_bf16 v[36:39], v[92:95], v[204:207], v[36:39]
    ds_read_b64_tr_b16 v[84:85], v3 offset:17152
    v_mfma_f32_16x16x32_bf16 v[40:43], v[92:95], v[208:211], v[40:43]
    ds_read_b64_tr_b16 v[86:87], v3 offset:18176
    s_waitcnt lgkmcnt(6)
    v_mfma_f32_16x16x32_bf16 v[44:47], v[96:99], v[204:207], v[44:47]
    ds_read_b64_tr_b16 v[88:89], v15 offset:17184
    v_mfma_f32_16x16x32_bf16 v[48:51], v[96:99], v[208:211], v[48:51]
    ds_read_b64_tr_b16 v[90:91], v15 offset:18208
    s_mov_b32 s26, 0x680000
    buffer_load_dword v18, v17, s[68:71], s26 offen
    s_waitcnt lgkmcnt(6)
    v_mfma_f32_16x16x32_bf16 v[52:55], v[100:103], v[204:207], v[52:55]
    ds_read_b64_tr_b16 v[92:93], v3 offset:24576
    v_mfma_f32_16x16x32_bf16 v[56:59], v[100:103], v[208:211], v[56:59]
    ds_read_b64_tr_b16 v[94:95], v3 offset:25600
    s_waitcnt lgkmcnt(6)
    v_mfma_f32_16x16x32_bf16 v[60:63], v[104:107], v[204:207], v[60:63]
    ds_read_b64_tr_b16 v[96:97], v15 offset:24608
    v_mfma_f32_16x16x32_bf16 v[64:67], v[104:107], v[208:211], v[64:67]
    ds_read_b64_tr_b16 v[98:99], v15 offset:25632
    s_mov_b32 s23, 0xd800
    buffer_load_dwordx4 v[144:147], v4, s[8:11], s23 offen offset:0 sc1
    s_waitcnt lgkmcnt(6)
    v_mfma_f32_16x16x32_bf16 v[68:71], v[84:87], v[204:207], v[68:71]
    ds_read_b64_tr_b16 v[100:101], v3 offset:24832
    v_mfma_f32_16x16x32_bf16 v[72:75], v[84:87], v[208:211], v[72:75]
    ds_read_b64_tr_b16 v[102:103], v3 offset:25856
    s_waitcnt lgkmcnt(6)
    v_mfma_f32_16x16x32_bf16 v[76:79], v[88:91], v[204:207], v[76:79]
    ds_read_b64_tr_b16 v[104:105], v15 offset:24864
    v_mfma_f32_16x16x32_bf16 v[80:83], v[88:91], v[208:211], v[80:83]
    ds_read_b64_tr_b16 v[106:107], v15 offset:25888
    s_waitcnt vmcnt(9) lgkmcnt(6)
    v_mfma_f32_16x16x32_bf16 v[20:23], v[92:95], v[212:215], v[20:23]
    ds_read_b64_tr_b16 v[84:85], v3 offset:25088
    s_waitcnt vmcnt(8)
    v_mfma_f32_16x16x32_bf16 v[24:27], v[92:95], v[216:219], v[24:27]
    ds_read_b64_tr_b16 v[86:87], v3 offset:26112
    s_waitcnt lgkmcnt(6)
    v_mfma_f32_16x16x32_bf16 v[28:31], v[96:99], v[212:215], v[28:31]
    ds_read_b64_tr_b16 v[88:89], v15 offset:25120
    v_mfma_f32_16x16x32_bf16 v[32:35], v[96:99], v[216:219], v[32:35]
    ds_read_b64_tr_b16 v[90:91], v15 offset:26144
    s_mov_b32 s23, 0x5800
    buffer_load_dwordx4 v[148:151], v4, s[8:11], s23 offen offset:1024 sc1
    s_waitcnt lgkmcnt(6)
    v_mfma_f32_16x16x32_bf16 v[36:39], v[100:103], v[212:215], v[36:39]
    ds_read_b64_tr_b16 v[92:93], v3 offset:25344
    v_mfma_f32_16x16x32_bf16 v[40:43], v[100:103], v[216:219], v[40:43]
    ds_read_b64_tr_b16 v[94:95], v3 offset:26368
    s_waitcnt lgkmcnt(6)
    v_mfma_f32_16x16x32_bf16 v[44:47], v[104:107], v[212:215], v[44:47]
    ds_read_b64_tr_b16 v[96:97], v15 offset:25376
    v_mfma_f32_16x16x32_bf16 v[48:51], v[104:107], v[216:219], v[48:51]
    ds_read_b64_tr_b16 v[98:99], v15 offset:26400
    s_waitcnt lgkmcnt(6)
    v_mfma_f32_16x16x32_bf16 v[52:55], v[84:87], v[212:215], v[52:55]
    v_mfma_f32_16x16x32_bf16 v[56:59], v[84:87], v[216:219], v[56:59]
    s_barrier
    ds_read_b64_tr_b16 v[100:101], v3 offset:32768
    ds_read_b64_tr_b16 v[102:103], v3 offset:33792
    s_waitcnt lgkmcnt(6)
    v_mfma_f32_16x16x32_bf16 v[60:63], v[88:91], v[212:215], v[60:63]
    ds_read_b64_tr_b16 v[104:105], v15 offset:32800
    v_mfma_f32_16x16x32_bf16 v[64:67], v[88:91], v[216:219], v[64:67]
    ds_read_b64_tr_b16 v[106:107], v15 offset:33824
    s_mov_b32 s23, 0xd800
    buffer_load_dwordx4 v[152:155], v4, s[8:11], s23 offen offset:1024 sc1
    s_waitcnt lgkmcnt(6)
    v_mfma_f32_16x16x32_bf16 v[68:71], v[92:95], v[212:215], v[68:71]
    ds_read_b64_tr_b16 v[84:85], v3 offset:33024
    v_mfma_f32_16x16x32_bf16 v[72:75], v[92:95], v[216:219], v[72:75]
    ds_read_b64_tr_b16 v[86:87], v3 offset:34048
    s_waitcnt lgkmcnt(6)
    v_mfma_f32_16x16x32_bf16 v[76:79], v[96:99], v[212:215], v[76:79]
    ds_read_b64_tr_b16 v[88:89], v15 offset:33056
    v_mfma_f32_16x16x32_bf16 v[80:83], v[96:99], v[216:219], v[80:83]
    ds_read_b64_tr_b16 v[90:91], v15 offset:34080
    s_waitcnt vmcnt(9) lgkmcnt(6)
    v_mfma_f32_16x16x32_bf16 v[20:23], v[100:103], v[220:223], v[20:23]
    ds_read_b64_tr_b16 v[92:93], v3 offset:33280
    s_waitcnt vmcnt(7)
    v_mfma_f32_16x16x32_bf16 v[24:27], v[100:103], v[224:227], v[24:27]
    ds_read_b64_tr_b16 v[94:95], v3 offset:34304
    s_waitcnt lgkmcnt(6)
    v_mfma_f32_16x16x32_bf16 v[28:31], v[104:107], v[220:223], v[28:31]
    ds_read_b64_tr_b16 v[96:97], v15 offset:33312
    v_mfma_f32_16x16x32_bf16 v[32:35], v[104:107], v[224:227], v[32:35]
    ds_read_b64_tr_b16 v[98:99], v15 offset:34336
    s_mov_b32 s23, 0x6000
    buffer_load_dwordx4 v[204:207], v4, s[8:11], s23 offen offset:0 sc1
    s_waitcnt lgkmcnt(6)
    v_mfma_f32_16x16x32_bf16 v[36:39], v[84:87], v[220:223], v[36:39]
    ds_read_b64_tr_b16 v[100:101], v3 offset:33536
    v_mfma_f32_16x16x32_bf16 v[40:43], v[84:87], v[224:227], v[40:43]
    ds_read_b64_tr_b16 v[102:103], v3 offset:34560
    s_waitcnt lgkmcnt(6)
    v_mfma_f32_16x16x32_bf16 v[44:47], v[88:91], v[220:223], v[44:47]
    ds_read_b64_tr_b16 v[104:105], v15 offset:33568
    v_mfma_f32_16x16x32_bf16 v[48:51], v[88:91], v[224:227], v[48:51]
    ds_read_b64_tr_b16 v[106:107], v15 offset:34592
    s_mov_b32 s26, 0x700000
    buffer_load_dword v18, v17, s[68:71], s26 offen
    s_waitcnt lgkmcnt(6)
    v_mfma_f32_16x16x32_bf16 v[52:55], v[92:95], v[220:223], v[52:55]
    ds_read_b64_tr_b16 v[84:85], v3 offset:40960
    v_mfma_f32_16x16x32_bf16 v[56:59], v[92:95], v[224:227], v[56:59]
    ds_read_b64_tr_b16 v[86:87], v3 offset:41984
    s_waitcnt lgkmcnt(6)
    v_mfma_f32_16x16x32_bf16 v[60:63], v[96:99], v[220:223], v[60:63]
    ds_read_b64_tr_b16 v[88:89], v15 offset:40992
    v_mfma_f32_16x16x32_bf16 v[64:67], v[96:99], v[224:227], v[64:67]
    ds_read_b64_tr_b16 v[90:91], v15 offset:42016
    s_mov_b32 s23, 0xe000
    buffer_load_dwordx4 v[208:211], v4, s[8:11], s23 offen offset:0 sc1
    s_waitcnt lgkmcnt(6)
    v_mfma_f32_16x16x32_bf16 v[68:71], v[100:103], v[220:223], v[68:71]
    ds_read_b64_tr_b16 v[92:93], v3 offset:41216
    v_mfma_f32_16x16x32_bf16 v[72:75], v[100:103], v[224:227], v[72:75]
    ds_read_b64_tr_b16 v[94:95], v3 offset:42240
    s_waitcnt lgkmcnt(6)
    v_mfma_f32_16x16x32_bf16 v[76:79], v[104:107], v[220:223], v[76:79]
    ds_read_b64_tr_b16 v[96:97], v15 offset:41248
    v_mfma_f32_16x16x32_bf16 v[80:83], v[104:107], v[224:227], v[80:83]
    ds_read_b64_tr_b16 v[98:99], v15 offset:42272
    s_waitcnt vmcnt(9) lgkmcnt(6)
    v_mfma_f32_16x16x32_bf16 v[20:23], v[84:87], v[228:231], v[20:23]
    ds_read_b64_tr_b16 v[100:101], v3 offset:41472
    s_waitcnt vmcnt(8)
    v_mfma_f32_16x16x32_bf16 v[24:27], v[84:87], v[232:235], v[24:27]
    ds_read_b64_tr_b16 v[102:103], v3 offset:42496
    s_waitcnt lgkmcnt(6)
    v_mfma_f32_16x16x32_bf16 v[28:31], v[88:91], v[228:231], v[28:31]
    ds_read_b64_tr_b16 v[104:105], v15 offset:41504
    v_mfma_f32_16x16x32_bf16 v[32:35], v[88:91], v[232:235], v[32:35]
    ds_read_b64_tr_b16 v[106:107], v15 offset:42528
    s_mov_b32 s23, 0x6000
    buffer_load_dwordx4 v[212:215], v4, s[8:11], s23 offen offset:1024 sc1
    s_waitcnt lgkmcnt(6)
    v_mfma_f32_16x16x32_bf16 v[36:39], v[92:95], v[228:231], v[36:39]
    ds_read_b64_tr_b16 v[84:85], v3 offset:41728
    v_mfma_f32_16x16x32_bf16 v[40:43], v[92:95], v[232:235], v[40:43]
    ds_read_b64_tr_b16 v[86:87], v3 offset:42752
    s_waitcnt lgkmcnt(6)
    v_mfma_f32_16x16x32_bf16 v[44:47], v[96:99], v[228:231], v[44:47]
    ds_read_b64_tr_b16 v[88:89], v15 offset:41760
    v_mfma_f32_16x16x32_bf16 v[48:51], v[96:99], v[232:235], v[48:51]
    ds_read_b64_tr_b16 v[90:91], v15 offset:42784
    s_waitcnt lgkmcnt(6)
    v_mfma_f32_16x16x32_bf16 v[52:55], v[100:103], v[228:231], v[52:55]
    v_mfma_f32_16x16x32_bf16 v[56:59], v[100:103], v[232:235], v[56:59]
    s_barrier
    ds_read_b64_tr_b16 v[92:93], v3 offset:49152
    ds_read_b64_tr_b16 v[94:95], v3 offset:50176
    s_waitcnt lgkmcnt(6)
    v_mfma_f32_16x16x32_bf16 v[60:63], v[104:107], v[228:231], v[60:63]
    ds_read_b64_tr_b16 v[96:97], v15 offset:49184
    v_mfma_f32_16x16x32_bf16 v[64:67], v[104:107], v[232:235], v[64:67]
    ds_read_b64_tr_b16 v[98:99], v15 offset:50208
    s_mov_b32 s23, 0xe000
    buffer_load_dwordx4 v[216:219], v4, s[8:11], s23 offen offset:1024 sc1
    s_waitcnt lgkmcnt(6)
    v_mfma_f32_16x16x32_bf16 v[68:71], v[84:87], v[228:231], v[68:71]
    ds_read_b64_tr_b16 v[100:101], v3 offset:49408
    v_mfma_f32_16x16x32_bf16 v[72:75], v[84:87], v[232:235], v[72:75]
    ds_read_b64_tr_b16 v[102:103], v3 offset:50432
    s_waitcnt lgkmcnt(6)
    v_mfma_f32_16x16x32_bf16 v[76:79], v[88:91], v[228:231], v[76:79]
    ds_read_b64_tr_b16 v[104:105], v15 offset:49440
    v_mfma_f32_16x16x32_bf16 v[80:83], v[88:91], v[232:235], v[80:83]
    ds_read_b64_tr_b16 v[106:107], v15 offset:50464
    s_waitcnt vmcnt(9) lgkmcnt(6)
    v_mfma_f32_16x16x32_bf16 v[20:23], v[92:95], v[140:143], v[20:23]
    ds_read_b64_tr_b16 v[84:85], v3 offset:49664
    s_waitcnt vmcnt(7)
    v_mfma_f32_16x16x32_bf16 v[24:27], v[92:95], v[144:147], v[24:27]
    ds_read_b64_tr_b16 v[86:87], v3 offset:50688
    s_waitcnt lgkmcnt(6)
    v_mfma_f32_16x16x32_bf16 v[28:31], v[96:99], v[140:143], v[28:31]
    ds_read_b64_tr_b16 v[88:89], v15 offset:49696
    v_mfma_f32_16x16x32_bf16 v[32:35], v[96:99], v[144:147], v[32:35]
    ds_read_b64_tr_b16 v[90:91], v15 offset:50720
    s_mov_b32 s23, 0x6800
    buffer_load_dwordx4 v[220:223], v4, s[8:11], s23 offen offset:0 sc1
    s_waitcnt lgkmcnt(6)
    v_mfma_f32_16x16x32_bf16 v[36:39], v[100:103], v[140:143], v[36:39]
    ds_read_b64_tr_b16 v[92:93], v3 offset:49920
    v_mfma_f32_16x16x32_bf16 v[40:43], v[100:103], v[144:147], v[40:43]
    ds_read_b64_tr_b16 v[94:95], v3 offset:50944
    s_waitcnt lgkmcnt(6)
    v_mfma_f32_16x16x32_bf16 v[44:47], v[104:107], v[140:143], v[44:47]
    ds_read_b64_tr_b16 v[96:97], v15 offset:49952
    v_mfma_f32_16x16x32_bf16 v[48:51], v[104:107], v[144:147], v[48:51]
    ds_read_b64_tr_b16 v[98:99], v15 offset:50976
    s_mov_b32 s26, 0x780000
    buffer_load_dword v18, v17, s[68:71], s26 offen
    s_waitcnt lgkmcnt(6)
    v_mfma_f32_16x16x32_bf16 v[52:55], v[84:87], v[140:143], v[52:55]
    ds_read_b64_tr_b16 v[100:101], v3 offset:57344
    v_mfma_f32_16x16x32_bf16 v[56:59], v[84:87], v[144:147], v[56:59]
    ds_read_b64_tr_b16 v[102:103], v3 offset:58368
    s_waitcnt lgkmcnt(6)
    v_mfma_f32_16x16x32_bf16 v[60:63], v[88:91], v[140:143], v[60:63]
    ds_read_b64_tr_b16 v[104:105], v15 offset:57376
    v_mfma_f32_16x16x32_bf16 v[64:67], v[88:91], v[144:147], v[64:67]
    ds_read_b64_tr_b16 v[106:107], v15 offset:58400
    s_mov_b32 s23, 0xe800
    buffer_load_dwordx4 v[224:227], v4, s[8:11], s23 offen offset:0 sc1
    s_waitcnt lgkmcnt(6)
    v_mfma_f32_16x16x32_bf16 v[68:71], v[92:95], v[140:143], v[68:71]
    ds_read_b64_tr_b16 v[84:85], v3 offset:57600
    v_mfma_f32_16x16x32_bf16 v[72:75], v[92:95], v[144:147], v[72:75]
    ds_read_b64_tr_b16 v[86:87], v3 offset:58624
    s_waitcnt lgkmcnt(6)
    v_mfma_f32_16x16x32_bf16 v[76:79], v[96:99], v[140:143], v[76:79]
    ds_read_b64_tr_b16 v[88:89], v15 offset:57632
    v_mfma_f32_16x16x32_bf16 v[80:83], v[96:99], v[144:147], v[80:83]
    ds_read_b64_tr_b16 v[90:91], v15 offset:58656
    s_waitcnt vmcnt(9) lgkmcnt(6)
    v_mfma_f32_16x16x32_bf16 v[20:23], v[100:103], v[148:151], v[20:23]
    ds_read_b64_tr_b16 v[92:93], v3 offset:57856
    s_waitcnt vmcnt(8)
    v_mfma_f32_16x16x32_bf16 v[24:27], v[100:103], v[152:155], v[24:27]
    ds_read_b64_tr_b16 v[94:95], v3 offset:58880
    s_waitcnt lgkmcnt(6)
    v_mfma_f32_16x16x32_bf16 v[28:31], v[104:107], v[148:151], v[28:31]
    ds_read_b64_tr_b16 v[96:97], v15 offset:57888
    v_mfma_f32_16x16x32_bf16 v[32:35], v[104:107], v[152:155], v[32:35]
    ds_read_b64_tr_b16 v[98:99], v15 offset:58912
    s_mov_b32 s23, 0x6800
    buffer_load_dwordx4 v[228:231], v4, s[8:11], s23 offen offset:1024 sc1
    s_waitcnt lgkmcnt(6)
    v_mfma_f32_16x16x32_bf16 v[36:39], v[84:87], v[148:151], v[36:39]
    ds_read_b64_tr_b16 v[100:101], v3 offset:58112
    v_mfma_f32_16x16x32_bf16 v[40:43], v[84:87], v[152:155], v[40:43]
    ds_read_b64_tr_b16 v[102:103], v3 offset:59136
    s_waitcnt lgkmcnt(6)
    v_mfma_f32_16x16x32_bf16 v[44:47], v[88:91], v[148:151], v[44:47]
    ds_read_b64_tr_b16 v[104:105], v15 offset:58144
    v_mfma_f32_16x16x32_bf16 v[48:51], v[88:91], v[152:155], v[48:51]
    ds_read_b64_tr_b16 v[106:107], v15 offset:59168
    s_waitcnt lgkmcnt(6)
    v_mfma_f32_16x16x32_bf16 v[52:55], v[92:95], v[148:151], v[52:55]
    v_mfma_f32_16x16x32_bf16 v[56:59], v[92:95], v[152:155], v[56:59]
    s_barrier
    ds_read_b64_tr_b16 v[84:85], v3 offset:0
    ds_read_b64_tr_b16 v[86:87], v3 offset:1024
    s_waitcnt lgkmcnt(6)
    v_mfma_f32_16x16x32_bf16 v[60:63], v[96:99], v[148:151], v[60:63]
    ds_read_b64_tr_b16 v[88:89], v15 offset:32
    v_mfma_f32_16x16x32_bf16 v[64:67], v[96:99], v[152:155], v[64:67]
    ds_read_b64_tr_b16 v[90:91], v15 offset:1056
    s_mov_b32 s23, 0xe800
    buffer_load_dwordx4 v[232:235], v4, s[8:11], s23 offen offset:1024 sc1
    s_waitcnt lgkmcnt(6)
    v_mfma_f32_16x16x32_bf16 v[68:71], v[100:103], v[148:151], v[68:71]
    ds_read_b64_tr_b16 v[92:93], v3 offset:256
    v_mfma_f32_16x16x32_bf16 v[72:75], v[100:103], v[152:155], v[72:75]
    ds_read_b64_tr_b16 v[94:95], v3 offset:1280
    s_waitcnt lgkmcnt(6)
    v_mfma_f32_16x16x32_bf16 v[76:79], v[104:107], v[148:151], v[76:79]
    ds_read_b64_tr_b16 v[96:97], v15 offset:288
    v_mfma_f32_16x16x32_bf16 v[80:83], v[104:107], v[152:155], v[80:83]
    ds_read_b64_tr_b16 v[98:99], v15 offset:1312
    s_waitcnt vmcnt(9) lgkmcnt(6)
    v_mfma_f32_16x16x32_bf16 v[20:23], v[84:87], v[204:207], v[20:23]
    ds_read_b64_tr_b16 v[100:101], v3 offset:512
    s_waitcnt vmcnt(7)
    v_mfma_f32_16x16x32_bf16 v[24:27], v[84:87], v[208:211], v[24:27]
    ds_read_b64_tr_b16 v[102:103], v3 offset:1536
    s_waitcnt lgkmcnt(6)
    v_mfma_f32_16x16x32_bf16 v[28:31], v[88:91], v[204:207], v[28:31]
    ds_read_b64_tr_b16 v[104:105], v15 offset:544
    v_mfma_f32_16x16x32_bf16 v[32:35], v[88:91], v[208:211], v[32:35]
    ds_read_b64_tr_b16 v[106:107], v15 offset:1568
    s_mov_b32 s23, 0x7000
    buffer_load_dwordx4 v[140:143], v4, s[8:11], s23 offen offset:0 sc1
    s_waitcnt lgkmcnt(6)
    v_mfma_f32_16x16x32_bf16 v[36:39], v[92:95], v[204:207], v[36:39]
    ds_read_b64_tr_b16 v[84:85], v3 offset:768
    v_mfma_f32_16x16x32_bf16 v[40:43], v[92:95], v[208:211], v[40:43]
    ds_read_b64_tr_b16 v[86:87], v3 offset:1792
    s_waitcnt lgkmcnt(6)
    v_mfma_f32_16x16x32_bf16 v[44:47], v[96:99], v[204:207], v[44:47]
    ds_read_b64_tr_b16 v[88:89], v15 offset:800
    v_mfma_f32_16x16x32_bf16 v[48:51], v[96:99], v[208:211], v[48:51]
    ds_read_b64_tr_b16 v[90:91], v15 offset:1824
    s_waitcnt lgkmcnt(6)
    v_mfma_f32_16x16x32_bf16 v[52:55], v[100:103], v[204:207], v[52:55]
    ds_read_b64_tr_b16 v[92:93], v3 offset:8192
    v_mfma_f32_16x16x32_bf16 v[56:59], v[100:103], v[208:211], v[56:59]
    ds_read_b64_tr_b16 v[94:95], v3 offset:9216
    s_waitcnt lgkmcnt(6)
    v_mfma_f32_16x16x32_bf16 v[60:63], v[104:107], v[204:207], v[60:63]
    ds_read_b64_tr_b16 v[96:97], v15 offset:8224
    v_mfma_f32_16x16x32_bf16 v[64:67], v[104:107], v[208:211], v[64:67]
    ds_read_b64_tr_b16 v[98:99], v15 offset:9248
    s_mov_b32 s23, 0xf000
    buffer_load_dwordx4 v[144:147], v4, s[8:11], s23 offen offset:0 sc1
    s_waitcnt lgkmcnt(6)
    v_mfma_f32_16x16x32_bf16 v[68:71], v[84:87], v[204:207], v[68:71]
    ds_read_b64_tr_b16 v[100:101], v3 offset:8448
    v_mfma_f32_16x16x32_bf16 v[72:75], v[84:87], v[208:211], v[72:75]
    ds_read_b64_tr_b16 v[102:103], v3 offset:9472
    s_waitcnt lgkmcnt(6)
    v_mfma_f32_16x16x32_bf16 v[76:79], v[88:91], v[204:207], v[76:79]
    ds_read_b64_tr_b16 v[104:105], v15 offset:8480
    v_mfma_f32_16x16x32_bf16 v[80:83], v[88:91], v[208:211], v[80:83]
    ds_read_b64_tr_b16 v[106:107], v15 offset:9504
    s_waitcnt vmcnt(8) lgkmcnt(6)
    v_mfma_f32_16x16x32_bf16 v[20:23], v[92:95], v[212:215], v[20:23]
    ds_read_b64_tr_b16 v[84:85], v3 offset:8704
    s_waitcnt vmcnt(7)
    v_mfma_f32_16x16x32_bf16 v[24:27], v[92:95], v[216:219], v[24:27]
    ds_read_b64_tr_b16 v[86:87], v3 offset:9728
    s_waitcnt lgkmcnt(6)
    v_mfma_f32_16x16x32_bf16 v[28:31], v[96:99], v[212:215], v[28:31]
    ds_read_b64_tr_b16 v[88:89], v15 offset:8736
    v_mfma_f32_16x16x32_bf16 v[32:35], v[96:99], v[216:219], v[32:35]
    ds_read_b64_tr_b16 v[90:91], v15 offset:9760
    s_mov_b32 s23, 0x7000
    buffer_load_dwordx4 v[148:151], v4, s[8:11], s23 offen offset:1024 sc1
    s_waitcnt lgkmcnt(6)
    v_mfma_f32_16x16x32_bf16 v[36:39], v[100:103], v[212:215], v[36:39]
    ds_read_b64_tr_b16 v[92:93], v3 offset:8960
    v_mfma_f32_16x16x32_bf16 v[40:43], v[100:103], v[216:219], v[40:43]
    ds_read_b64_tr_b16 v[94:95], v3 offset:9984
    s_waitcnt lgkmcnt(6)
    v_mfma_f32_16x16x32_bf16 v[44:47], v[104:107], v[212:215], v[44:47]
    ds_read_b64_tr_b16 v[96:97], v15 offset:8992
    v_mfma_f32_16x16x32_bf16 v[48:51], v[104:107], v[216:219], v[48:51]
    ds_read_b64_tr_b16 v[98:99], v15 offset:10016
    s_waitcnt lgkmcnt(6)
    v_mfma_f32_16x16x32_bf16 v[52:55], v[84:87], v[212:215], v[52:55]
    v_mfma_f32_16x16x32_bf16 v[56:59], v[84:87], v[216:219], v[56:59]
    s_barrier
    ds_read_b64_tr_b16 v[100:101], v3 offset:16384
    ds_read_b64_tr_b16 v[102:103], v3 offset:17408
    s_waitcnt lgkmcnt(6)
    v_mfma_f32_16x16x32_bf16 v[60:63], v[88:91], v[212:215], v[60:63]
    ds_read_b64_tr_b16 v[104:105], v15 offset:16416
    v_mfma_f32_16x16x32_bf16 v[64:67], v[88:91], v[216:219], v[64:67]
    ds_read_b64_tr_b16 v[106:107], v15 offset:17440
    s_mov_b32 s23, 0xf000
    buffer_load_dwordx4 v[152:155], v4, s[8:11], s23 offen offset:1024 sc1
    s_waitcnt lgkmcnt(6)
    v_mfma_f32_16x16x32_bf16 v[68:71], v[92:95], v[212:215], v[68:71]
    ds_read_b64_tr_b16 v[84:85], v3 offset:16640
    v_mfma_f32_16x16x32_bf16 v[72:75], v[92:95], v[216:219], v[72:75]
    ds_read_b64_tr_b16 v[86:87], v3 offset:17664
    s_waitcnt lgkmcnt(6)
    v_mfma_f32_16x16x32_bf16 v[76:79], v[96:99], v[212:215], v[76:79]
    ds_read_b64_tr_b16 v[88:89], v15 offset:16672
    v_mfma_f32_16x16x32_bf16 v[80:83], v[96:99], v[216:219], v[80:83]
    ds_read_b64_tr_b16 v[90:91], v15 offset:17696
    s_waitcnt vmcnt(8) lgkmcnt(6)
    v_mfma_f32_16x16x32_bf16 v[20:23], v[100:103], v[220:223], v[20:23]
    ds_read_b64_tr_b16 v[92:93], v3 offset:16896
    s_waitcnt vmcnt(6)
    v_mfma_f32_16x16x32_bf16 v[24:27], v[100:103], v[224:227], v[24:27]
    ds_read_b64_tr_b16 v[94:95], v3 offset:17920
    s_waitcnt lgkmcnt(6)
    v_mfma_f32_16x16x32_bf16 v[28:31], v[104:107], v[220:223], v[28:31]
    ds_read_b64_tr_b16 v[96:97], v15 offset:16928
    v_mfma_f32_16x16x32_bf16 v[32:35], v[104:107], v[224:227], v[32:35]
    ds_read_b64_tr_b16 v[98:99], v15 offset:17952
    s_mov_b32 s23, 0x7800
    buffer_load_dwordx4 v[204:207], v4, s[8:11], s23 offen offset:0 sc1
    s_waitcnt lgkmcnt(6)
    v_mfma_f32_16x16x32_bf16 v[36:39], v[84:87], v[220:223], v[36:39]
    ds_read_b64_tr_b16 v[100:101], v3 offset:17152
    v_mfma_f32_16x16x32_bf16 v[40:43], v[84:87], v[224:227], v[40:43]
    ds_read_b64_tr_b16 v[102:103], v3 offset:18176
    s_waitcnt lgkmcnt(6)
    v_mfma_f32_16x16x32_bf16 v[44:47], v[88:91], v[220:223], v[44:47]
    ds_read_b64_tr_b16 v[104:105], v15 offset:17184
    v_mfma_f32_16x16x32_bf16 v[48:51], v[88:91], v[224:227], v[48:51]
    ds_read_b64_tr_b16 v[106:107], v15 offset:18208
    s_waitcnt lgkmcnt(6)
    v_mfma_f32_16x16x32_bf16 v[52:55], v[92:95], v[220:223], v[52:55]
    ds_read_b64_tr_b16 v[84:85], v3 offset:24576
    v_mfma_f32_16x16x32_bf16 v[56:59], v[92:95], v[224:227], v[56:59]
    ds_read_b64_tr_b16 v[86:87], v3 offset:25600
    s_waitcnt lgkmcnt(6)
    v_mfma_f32_16x16x32_bf16 v[60:63], v[96:99], v[220:223], v[60:63]
    ds_read_b64_tr_b16 v[88:89], v15 offset:24608
    v_mfma_f32_16x16x32_bf16 v[64:67], v[96:99], v[224:227], v[64:67]
    ds_read_b64_tr_b16 v[90:91], v15 offset:25632
    s_mov_b32 s23, 0xf800
    buffer_load_dwordx4 v[208:211], v4, s[8:11], s23 offen offset:0 sc1
    s_waitcnt lgkmcnt(6)
    v_mfma_f32_16x16x32_bf16 v[68:71], v[100:103], v[220:223], v[68:71]
    ds_read_b64_tr_b16 v[92:93], v3 offset:24832
    v_mfma_f32_16x16x32_bf16 v[72:75], v[100:103], v[224:227], v[72:75]
    ds_read_b64_tr_b16 v[94:95], v3 offset:25856
    s_waitcnt lgkmcnt(6)
    v_mfma_f32_16x16x32_bf16 v[76:79], v[104:107], v[220:223], v[76:79]
    ds_read_b64_tr_b16 v[96:97], v15 offset:24864
    v_mfma_f32_16x16x32_bf16 v[80:83], v[104:107], v[224:227], v[80:83]
    ds_read_b64_tr_b16 v[98:99], v15 offset:25888
    s_waitcnt vmcnt(7) lgkmcnt(6)
    v_mfma_f32_16x16x32_bf16 v[20:23], v[84:87], v[228:231], v[20:23]
    ds_read_b64_tr_b16 v[100:101], v3 offset:25088
    s_waitcnt vmcnt(6)
    v_mfma_f32_16x16x32_bf16 v[24:27], v[84:87], v[232:235], v[24:27]
    ds_read_b64_tr_b16 v[102:103], v3 offset:26112
    s_waitcnt lgkmcnt(6)
    v_mfma_f32_16x16x32_bf16 v[28:31], v[88:91], v[228:231], v[28:31]
    ds_read_b64_tr_b16 v[104:105], v15 offset:25120
    v_mfma_f32_16x16x32_bf16 v[32:35], v[88:91], v[232:235], v[32:35]
    ds_read_b64_tr_b16 v[106:107], v15 offset:26144
    s_mov_b32 s23, 0x7800
    buffer_load_dwordx4 v[212:215], v4, s[8:11], s23 offen offset:1024 sc1
    s_waitcnt lgkmcnt(6)
    v_mfma_f32_16x16x32_bf16 v[36:39], v[92:95], v[228:231], v[36:39]
    ds_read_b64_tr_b16 v[84:85], v3 offset:25344
    v_mfma_f32_16x16x32_bf16 v[40:43], v[92:95], v[232:235], v[40:43]
    ds_read_b64_tr_b16 v[86:87], v3 offset:26368
    s_waitcnt lgkmcnt(6)
    v_mfma_f32_16x16x32_bf16 v[44:47], v[96:99], v[228:231], v[44:47]
    ds_read_b64_tr_b16 v[88:89], v15 offset:25376
    v_mfma_f32_16x16x32_bf16 v[48:51], v[96:99], v[232:235], v[48:51]
    ds_read_b64_tr_b16 v[90:91], v15 offset:26400
    s_waitcnt lgkmcnt(6)
    v_mfma_f32_16x16x32_bf16 v[52:55], v[100:103], v[228:231], v[52:55]
    v_mfma_f32_16x16x32_bf16 v[56:59], v[100:103], v[232:235], v[56:59]
    s_barrier
    ds_read_b64_tr_b16 v[92:93], v3 offset:32768
    ds_read_b64_tr_b16 v[94:95], v3 offset:33792
    s_waitcnt lgkmcnt(6)
    v_mfma_f32_16x16x32_bf16 v[60:63], v[104:107], v[228:231], v[60:63]
    ds_read_b64_tr_b16 v[96:97], v15 offset:32800
    v_mfma_f32_16x16x32_bf16 v[64:67], v[104:107], v[232:235], v[64:67]
    ds_read_b64_tr_b16 v[98:99], v15 offset:33824
    s_mov_b32 s23, 0xf800
    buffer_load_dwordx4 v[216:219], v4, s[8:11], s23 offen offset:1024 sc1
    s_waitcnt lgkmcnt(6)
    v_mfma_f32_16x16x32_bf16 v[68:71], v[84:87], v[228:231], v[68:71]
    ds_read_b64_tr_b16 v[100:101], v3 offset:33024
    v_mfma_f32_16x16x32_bf16 v[72:75], v[84:87], v[232:235], v[72:75]
    ds_read_b64_tr_b16 v[102:103], v3 offset:34048
    s_waitcnt lgkmcnt(6)
    v_mfma_f32_16x16x32_bf16 v[76:79], v[88:91], v[228:231], v[76:79]
    ds_read_b64_tr_b16 v[104:105], v15 offset:33056
    v_mfma_f32_16x16x32_bf16 v[80:83], v[88:91], v[232:235], v[80:83]
    ds_read_b64_tr_b16 v[106:107], v15 offset:34080
    s_waitcnt vmcnt(7) lgkmcnt(6)
    v_mfma_f32_16x16x32_bf16 v[20:23], v[92:95], v[140:143], v[20:23]
    ds_read_b64_tr_b16 v[84:85], v3 offset:33280
    s_waitcnt vmcnt(6)
    v_mfma_f32_16x16x32_bf16 v[24:27], v[92:95], v[144:147], v[24:27]
    ds_read_b64_tr_b16 v[86:87], v3 offset:34304
    s_waitcnt lgkmcnt(6)
    v_mfma_f32_16x16x32_bf16 v[28:31], v[96:99], v[140:143], v[28:31]
    ds_read_b64_tr_b16 v[88:89], v15 offset:33312
    v_mfma_f32_16x16x32_bf16 v[32:35], v[96:99], v[144:147], v[32:35]
    ds_read_b64_tr_b16 v[90:91], v15 offset:34336
    s_waitcnt lgkmcnt(6)
    v_mfma_f32_16x16x32_bf16 v[36:39], v[100:103], v[140:143], v[36:39]
    ds_read_b64_tr_b16 v[92:93], v3 offset:33536
    v_mfma_f32_16x16x32_bf16 v[40:43], v[100:103], v[144:147], v[40:43]
    ds_read_b64_tr_b16 v[94:95], v3 offset:34560
    s_waitcnt lgkmcnt(6)
    v_mfma_f32_16x16x32_bf16 v[44:47], v[104:107], v[140:143], v[44:47]
    ds_read_b64_tr_b16 v[96:97], v15 offset:33568
    v_mfma_f32_16x16x32_bf16 v[48:51], v[104:107], v[144:147], v[48:51]
    ds_read_b64_tr_b16 v[98:99], v15 offset:34592
    s_waitcnt lgkmcnt(6)
    v_mfma_f32_16x16x32_bf16 v[52:55], v[84:87], v[140:143], v[52:55]
    ds_read_b64_tr_b16 v[100:101], v3 offset:40960
    v_mfma_f32_16x16x32_bf16 v[56:59], v[84:87], v[144:147], v[56:59]
    ds_read_b64_tr_b16 v[102:103], v3 offset:41984
    s_waitcnt lgkmcnt(6)
    v_mfma_f32_16x16x32_bf16 v[60:63], v[88:91], v[140:143], v[60:63]
    ds_read_b64_tr_b16 v[104:105], v15 offset:40992
    v_mfma_f32_16x16x32_bf16 v[64:67], v[88:91], v[144:147], v[64:67]
    ds_read_b64_tr_b16 v[106:107], v15 offset:42016
    s_waitcnt lgkmcnt(6)
    v_mfma_f32_16x16x32_bf16 v[68:71], v[92:95], v[140:143], v[68:71]
    ds_read_b64_tr_b16 v[84:85], v3 offset:41216
    v_mfma_f32_16x16x32_bf16 v[72:75], v[92:95], v[144:147], v[72:75]
    ds_read_b64_tr_b16 v[86:87], v3 offset:42240
    s_waitcnt lgkmcnt(6)
    v_mfma_f32_16x16x32_bf16 v[76:79], v[96:99], v[140:143], v[76:79]
    ds_read_b64_tr_b16 v[88:89], v15 offset:41248
    v_mfma_f32_16x16x32_bf16 v[80:83], v[96:99], v[144:147], v[80:83]
    ds_read_b64_tr_b16 v[90:91], v15 offset:42272
    s_waitcnt vmcnt(5) lgkmcnt(6)
    v_mfma_f32_16x16x32_bf16 v[20:23], v[100:103], v[148:151], v[20:23]
    ds_read_b64_tr_b16 v[92:93], v3 offset:41472
    s_waitcnt vmcnt(4)
    v_mfma_f32_16x16x32_bf16 v[24:27], v[100:103], v[152:155], v[24:27]
    ds_read_b64_tr_b16 v[94:95], v3 offset:42496
    s_waitcnt lgkmcnt(6)
    v_mfma_f32_16x16x32_bf16 v[28:31], v[104:107], v[148:151], v[28:31]
    ds_read_b64_tr_b16 v[96:97], v15 offset:41504
    v_mfma_f32_16x16x32_bf16 v[32:35], v[104:107], v[152:155], v[32:35]
    ds_read_b64_tr_b16 v[98:99], v15 offset:42528
    s_waitcnt lgkmcnt(6)
    v_mfma_f32_16x16x32_bf16 v[36:39], v[84:87], v[148:151], v[36:39]
    ds_read_b64_tr_b16 v[100:101], v3 offset:41728
    v_mfma_f32_16x16x32_bf16 v[40:43], v[84:87], v[152:155], v[40:43]
    ds_read_b64_tr_b16 v[102:103], v3 offset:42752
    s_waitcnt lgkmcnt(6)
    v_mfma_f32_16x16x32_bf16 v[44:47], v[88:91], v[148:151], v[44:47]
    ds_read_b64_tr_b16 v[104:105], v15 offset:41760
    v_mfma_f32_16x16x32_bf16 v[48:51], v[88:91], v[152:155], v[48:51]
    ds_read_b64_tr_b16 v[106:107], v15 offset:42784
    s_waitcnt lgkmcnt(6)
    v_mfma_f32_16x16x32_bf16 v[52:55], v[92:95], v[148:151], v[52:55]
    v_mfma_f32_16x16x32_bf16 v[56:59], v[92:95], v[152:155], v[56:59]
    s_barrier
    ds_read_b64_tr_b16 v[84:85], v3 offset:49152
    ds_read_b64_tr_b16 v[86:87], v3 offset:50176
    s_waitcnt lgkmcnt(6)
    v_mfma_f32_16x16x32_bf16 v[60:63], v[96:99], v[148:151], v[60:63]
    ds_read_b64_tr_b16 v[88:89], v15 offset:49184
    v_mfma_f32_16x16x32_bf16 v[64:67], v[96:99], v[152:155], v[64:67]
    ds_read_b64_tr_b16 v[90:91], v15 offset:50208
    s_waitcnt lgkmcnt(6)
    v_mfma_f32_16x16x32_bf16 v[68:71], v[100:103], v[148:151], v[68:71]
    ds_read_b64_tr_b16 v[92:93], v3 offset:49408
    v_mfma_f32_16x16x32_bf16 v[72:75], v[100:103], v[152:155], v[72:75]
    ds_read_b64_tr_b16 v[94:95], v3 offset:50432
    s_waitcnt lgkmcnt(6)
    v_mfma_f32_16x16x32_bf16 v[76:79], v[104:107], v[148:151], v[76:79]
    ds_read_b64_tr_b16 v[96:97], v15 offset:49440
    v_mfma_f32_16x16x32_bf16 v[80:83], v[104:107], v[152:155], v[80:83]
    ds_read_b64_tr_b16 v[98:99], v15 offset:50464
    s_waitcnt vmcnt(3) lgkmcnt(6)
    v_mfma_f32_16x16x32_bf16 v[20:23], v[84:87], v[204:207], v[20:23]
    ds_read_b64_tr_b16 v[100:101], v3 offset:49664
    s_waitcnt vmcnt(2)
    v_mfma_f32_16x16x32_bf16 v[24:27], v[84:87], v[208:211], v[24:27]
    ds_read_b64_tr_b16 v[102:103], v3 offset:50688
    s_waitcnt lgkmcnt(6)
    v_mfma_f32_16x16x32_bf16 v[28:31], v[88:91], v[204:207], v[28:31]
    ds_read_b64_tr_b16 v[104:105], v15 offset:49696
    v_mfma_f32_16x16x32_bf16 v[32:35], v[88:91], v[208:211], v[32:35]
    ds_read_b64_tr_b16 v[106:107], v15 offset:50720
    s_waitcnt lgkmcnt(6)
    v_mfma_f32_16x16x32_bf16 v[36:39], v[92:95], v[204:207], v[36:39]
    ds_read_b64_tr_b16 v[84:85], v3 offset:49920
    v_mfma_f32_16x16x32_bf16 v[40:43], v[92:95], v[208:211], v[40:43]
    ds_read_b64_tr_b16 v[86:87], v3 offset:50944
    s_waitcnt lgkmcnt(6)
    v_mfma_f32_16x16x32_bf16 v[44:47], v[96:99], v[204:207], v[44:47]
    ds_read_b64_tr_b16 v[88:89], v15 offset:49952
    v_mfma_f32_16x16x32_bf16 v[48:51], v[96:99], v[208:211], v[48:51]
    ds_read_b64_tr_b16 v[90:91], v15 offset:50976
    s_waitcnt lgkmcnt(6)
    v_mfma_f32_16x16x32_bf16 v[52:55], v[100:103], v[204:207], v[52:55]
    ds_read_b64_tr_b16 v[92:93], v3 offset:57344
    v_mfma_f32_16x16x32_bf16 v[56:59], v[100:103], v[208:211], v[56:59]
    ds_read_b64_tr_b16 v[94:95], v3 offset:58368
    s_waitcnt lgkmcnt(6)
    v_mfma_f32_16x16x32_bf16 v[60:63], v[104:107], v[204:207], v[60:63]
    ds_read_b64_tr_b16 v[96:97], v15 offset:57376
    v_mfma_f32_16x16x32_bf16 v[64:67], v[104:107], v[208:211], v[64:67]
    ds_read_b64_tr_b16 v[98:99], v15 offset:58400
    s_waitcnt lgkmcnt(6)
    v_mfma_f32_16x16x32_bf16 v[68:71], v[84:87], v[204:207], v[68:71]
    ds_read_b64_tr_b16 v[100:101], v3 offset:57600
    v_mfma_f32_16x16x32_bf16 v[72:75], v[84:87], v[208:211], v[72:75]
    ds_read_b64_tr_b16 v[102:103], v3 offset:58624
    s_waitcnt lgkmcnt(6)
    v_mfma_f32_16x16x32_bf16 v[76:79], v[88:91], v[204:207], v[76:79]
    ds_read_b64_tr_b16 v[104:105], v15 offset:57632
    v_mfma_f32_16x16x32_bf16 v[80:83], v[88:91], v[208:211], v[80:83]
    ds_read_b64_tr_b16 v[106:107], v15 offset:58656
    s_waitcnt vmcnt(1) lgkmcnt(6)
    v_mfma_f32_16x16x32_bf16 v[20:23], v[92:95], v[212:215], v[20:23]
    ds_read_b64_tr_b16 v[84:85], v3 offset:57856
    s_waitcnt vmcnt(0)
    v_mfma_f32_16x16x32_bf16 v[24:27], v[92:95], v[216:219], v[24:27]
    ds_read_b64_tr_b16 v[86:87], v3 offset:58880
    s_waitcnt lgkmcnt(6)
    v_mfma_f32_16x16x32_bf16 v[28:31], v[96:99], v[212:215], v[28:31]
    ds_read_b64_tr_b16 v[88:89], v15 offset:57888
    v_mfma_f32_16x16x32_bf16 v[32:35], v[96:99], v[216:219], v[32:35]
    ds_read_b64_tr_b16 v[90:91], v15 offset:58912
    s_waitcnt lgkmcnt(6)
    v_mfma_f32_16x16x32_bf16 v[36:39], v[100:103], v[212:215], v[36:39]
    ds_read_b64_tr_b16 v[92:93], v3 offset:58112
    v_mfma_f32_16x16x32_bf16 v[40:43], v[100:103], v[216:219], v[40:43]
    ds_read_b64_tr_b16 v[94:95], v3 offset:59136
    s_waitcnt lgkmcnt(6)
    v_mfma_f32_16x16x32_bf16 v[44:47], v[104:107], v[212:215], v[44:47]
    ds_read_b64_tr_b16 v[96:97], v15 offset:58144
    v_mfma_f32_16x16x32_bf16 v[48:51], v[104:107], v[216:219], v[48:51]
    ds_read_b64_tr_b16 v[98:99], v15 offset:59168
    s_waitcnt lgkmcnt(6)
    v_mfma_f32_16x16x32_bf16 v[52:55], v[84:87], v[212:215], v[52:55]
    v_mfma_f32_16x16x32_bf16 v[56:59], v[84:87], v[216:219], v[56:59]
    s_waitcnt lgkmcnt(4)
    v_mfma_f32_16x16x32_bf16 v[60:63], v[88:91], v[212:215], v[60:63]
    v_mfma_f32_16x16x32_bf16 v[64:67], v[88:91], v[216:219], v[64:67]
    s_waitcnt lgkmcnt(2)
    v_mfma_f32_16x16x32_bf16 v[68:71], v[92:95], v[212:215], v[68:71]
    v_mfma_f32_16x16x32_bf16 v[72:75], v[92:95], v[216:219], v[72:75]
    s_waitcnt lgkmcnt(0)
    v_mfma_f32_16x16x32_bf16 v[76:79], v[96:99], v[212:215], v[76:79]
    v_mfma_f32_16x16x32_bf16 v[80:83], v[96:99], v[216:219], v[80:83]
    s_mov_b32 s24, 0x3e0293ee
    v_mul_f32 v9, s24, v20
    v_mul_f32 v10, s24, v21
    v_cvt_pk_bf16_f32 v108, v9, v10
    v_mul_f32 v11, s24, v22
    v_mul_f32 v12, s24, v23
    v_cvt_pk_bf16_f32 v109, v11, v12
    v_mul_f32 v9, s24, v24
    v_mul_f32 v10, s24, v25
    v_cvt_pk_bf16_f32 v124, v9, v10
    v_mul_f32 v11, s24, v26
    v_mul_f32 v12, s24, v27
    v_cvt_pk_bf16_f32 v125, v11, v12
    v_mul_f32 v9, s24, v28
    v_mul_f32 v10, s24, v29
    v_cvt_pk_bf16_f32 v110, v9, v10
    v_mul_f32 v11, s24, v30
    v_mul_f32 v12, s24, v31
    v_cvt_pk_bf16_f32 v111, v11, v12
    v_mul_f32 v9, s24, v32
    v_mul_f32 v10, s24, v33
    v_cvt_pk_bf16_f32 v126, v9, v10
    v_mul_f32 v11, s24, v34
    v_mul_f32 v12, s24, v35
    v_cvt_pk_bf16_f32 v127, v11, v12
    v_mul_f32 v9, s24, v36
    v_mul_f32 v10, s24, v37
    v_cvt_pk_bf16_f32 v112, v9, v10
    v_mul_f32 v11, s24, v38
    v_mul_f32 v12, s24, v39
    v_cvt_pk_bf16_f32 v113, v11, v12
    v_mul_f32 v9, s24, v40
    v_mul_f32 v10, s24, v41
    v_cvt_pk_bf16_f32 v128, v9, v10
    v_mul_f32 v11, s24, v42
    v_mul_f32 v12, s24, v43
    v_cvt_pk_bf16_f32 v129, v11, v12
    v_mul_f32 v9, s24, v44
    v_mul_f32 v10, s24, v45
    v_cvt_pk_bf16_f32 v114, v9, v10
    v_mul_f32 v11, s24, v46
    v_mul_f32 v12, s24, v47
    v_cvt_pk_bf16_f32 v115, v11, v12
    v_mul_f32 v9, s24, v48
    v_mul_f32 v10, s24, v49
    v_cvt_pk_bf16_f32 v130, v9, v10
    v_mul_f32 v11, s24, v50
    v_mul_f32 v12, s24, v51
    v_cvt_pk_bf16_f32 v131, v11, v12
    v_mul_f32 v9, s24, v52
    v_mul_f32 v10, s24, v53
    v_cvt_pk_bf16_f32 v116, v9, v10
    v_mul_f32 v11, s24, v54
    v_mul_f32 v12, s24, v55
    v_cvt_pk_bf16_f32 v117, v11, v12
    v_mul_f32 v9, s24, v56
    v_mul_f32 v10, s24, v57
    v_cvt_pk_bf16_f32 v132, v9, v10
    v_mul_f32 v11, s24, v58
    v_mul_f32 v12, s24, v59
    v_cvt_pk_bf16_f32 v133, v11, v12
    v_mul_f32 v9, s24, v60
    v_mul_f32 v10, s24, v61
    v_cvt_pk_bf16_f32 v118, v9, v10
    v_mul_f32 v11, s24, v62
    v_mul_f32 v12, s24, v63
    v_cvt_pk_bf16_f32 v119, v11, v12
    v_mul_f32 v9, s24, v64
    v_mul_f32 v10, s24, v65
    v_cvt_pk_bf16_f32 v134, v9, v10
    v_mul_f32 v11, s24, v66
    v_mul_f32 v12, s24, v67
    v_cvt_pk_bf16_f32 v135, v11, v12
    v_mul_f32 v9, s24, v68
    v_mul_f32 v10, s24, v69
    v_cvt_pk_bf16_f32 v120, v9, v10
    v_mul_f32 v11, s24, v70
    v_mul_f32 v12, s24, v71
    v_cvt_pk_bf16_f32 v121, v11, v12
    v_mul_f32 v9, s24, v72
    v_mul_f32 v10, s24, v73
    v_cvt_pk_bf16_f32 v136, v9, v10
    v_mul_f32 v11, s24, v74
    v_mul_f32 v12, s24, v75
    v_cvt_pk_bf16_f32 v137, v11, v12
    v_mul_f32 v9, s24, v76
    v_mul_f32 v10, s24, v77
    v_cvt_pk_bf16_f32 v122, v9, v10
    v_mul_f32 v11, s24, v78
    v_mul_f32 v12, s24, v79
    v_cvt_pk_bf16_f32 v123, v11, v12
    v_mul_f32 v9, s24, v80
    v_mul_f32 v10, s24, v81
    v_cvt_pk_bf16_f32 v138, v9, v10
    v_mul_f32 v11, s24, v82
    v_mul_f32 v12, s24, v83
    v_cvt_pk_bf16_f32 v139, v11, v12
    v_add_u32 v2, 0x10000, v1
    v_add_u32 v3, 0x20000, v1
    s_barrier
    ds_read_b128 v[84:87], v2 offset:0
    ds_read_b128 v[88:91], v2 offset:1024
    ds_read_b128 v[92:95], v2 offset:2048
    ds_read_b128 v[96:99], v2 offset:3072
    s_waitcnt lgkmcnt(3)
    v_mfma_f32_16x16x32_bf16 v[140:143], v[84:87], v[108:111], 0
    v_mfma_f32_16x16x32_bf16 v[144:147], v[84:87], v[124:127], 0
    ds_read_b128 v[100:103], v2 offset:4096
    s_waitcnt lgkmcnt(3)
    v_mfma_f32_16x16x32_bf16 v[148:151], v[88:91], v[108:111], 0
    v_mfma_f32_16x16x32_bf16 v[152:155], v[88:91], v[124:127], 0
    ds_read_b128 v[104:107], v2 offset:5120
    s_mov_b64 s[64:65], s[52:53]
    s_mov_b32 s66, 0x800
    s_mov_b32 s67, 0x20000
    s_mov_b64 s[68:69], s[54:55]
    s_mov_b32 s70, 0xc00000
    s_mov_b32 s71, 0x20000
    s_and_b32 s100, s2, 7
    s_lshl_b32 s100, s100, 5
    s_lshr_b32 s26, s2, 3
    s_add_u32 s100, s100, s26
    v_lshrrev_b32 v13, 1, v8
    v_lshlrev_b32 v14, 4, v13
    buffer_load_dwordx4 v[244:247], v14, s[64:67], 0 offen
    s_mov_b32 s26, 98304
    v_mul_lo_u32 v13, s26, v13
    v_and_b32 v14, 1, v8
    v_lshl_add_u32 v13, v14, 4, v13
    s_lshl_b32 s25, s100, 5
    s_add_u32 s25, s25, 4096
    s_waitcnt lgkmcnt(3)
    v_mfma_f32_16x16x32_bf16 v[140:143], v[92:95], v[112:115], v[140:143]
    v_mfma_f32_16x16x32_bf16 v[144:147], v[92:95], v[128:131], v[144:147]
    ds_read_b128 v[84:87], v2 offset:6144
    s_waitcnt lgkmcnt(3)
    v_mfma_f32_16x16x32_bf16 v[148:151], v[96:99], v[112:115], v[148:151]
    v_mfma_f32_16x16x32_bf16 v[152:155], v[96:99], v[128:131], v[152:155]
    ds_read_b128 v[88:91], v2 offset:7168
    s_add_u32 s26, s25, 0
    buffer_load_dwordx4 v[204:207], v13, s[68:71], s26 offen
    s_waitcnt lgkmcnt(3)
    v_mfma_f32_16x16x32_bf16 v[140:143], v[100:103], v[116:119], v[140:143]
    v_mfma_f32_16x16x32_bf16 v[144:147], v[100:103], v[132:135], v[144:147]
    s_barrier
    ds_read_b128 v[92:95], v2 offset:16384
    s_waitcnt lgkmcnt(3)
    v_mfma_f32_16x16x32_bf16 v[148:151], v[104:107], v[116:119], v[148:151]
    v_mfma_f32_16x16x32_bf16 v[152:155], v[104:107], v[132:135], v[152:155]
    ds_read_b128 v[96:99], v2 offset:17408
    s_add_u32 s26, s25, 12288
    buffer_load_dwordx4 v[208:211], v13, s[68:71], s26 offen
    s_waitcnt lgkmcnt(3)
    v_mfma_f32_16x16x32_bf16 v[140:143], v[84:87], v[120:123], v[140:143]
    v_mfma_f32_16x16x32_bf16 v[144:147], v[84:87], v[136:139], v[144:147]
    ds_read_b128 v[100:103], v2 offset:18432
    s_waitcnt lgkmcnt(3)
    v_mfma_f32_16x16x32_bf16 v[148:151], v[88:91], v[120:123], v[148:151]
    v_mfma_f32_16x16x32_bf16 v[152:155], v[88:91], v[136:139], v[152:155]
    ds_read_b128 v[104:107], v2 offset:19456
    s_add_u32 s26, s25, 24576
    buffer_load_dwordx4 v[212:215], v13, s[68:71], s26 offen
    s_waitcnt lgkmcnt(3)
    v_mfma_f32_16x16x32_bf16 v[156:159], v[92:95], v[108:111], 0
    v_mfma_f32_16x16x32_bf16 v[160:163], v[92:95], v[124:127], 0
    ds_read_b128 v[84:87], v2 offset:20480
    s_waitcnt lgkmcnt(3)
    v_mfma_f32_16x16x32_bf16 v[164:167], v[96:99], v[108:111], 0
    v_mfma_f32_16x16x32_bf16 v[168:171], v[96:99], v[124:127], 0
    ds_read_b128 v[88:91], v2 offset:21504
    s_add_u32 s26, s25, 36864
    buffer_load_dwordx4 v[216:219], v13, s[68:71], s26 offen
    s_waitcnt lgkmcnt(3)
    v_mfma_f32_16x16x32_bf16 v[156:159], v[100:103], v[112:115], v[156:159]
    v_mfma_f32_16x16x32_bf16 v[160:163], v[100:103], v[128:131], v[160:163]
    ds_read_b128 v[92:95], v2 offset:22528
    s_waitcnt lgkmcnt(3)
    v_mfma_f32_16x16x32_bf16 v[164:167], v[104:107], v[112:115], v[164:167]
    v_max3_f32 v9, v140, v141, v142
    v_mfma_f32_16x16x32_bf16 v[168:171], v[104:107], v[128:131], v[168:171]
    ds_read_b128 v[96:99], v2 offset:23552
    v_max3_f32 v9, v9, v143, v148
    s_add_u32 s26, s25, 49152
    buffer_load_dwordx4 v[220:223], v13, s[68:71], s26 offen
    s_waitcnt lgkmcnt(3)
    v_mfma_f32_16x16x32_bf16 v[156:159], v[84:87], v[116:119], v[156:159]
    v_max3_f32 v9, v9, v149, v150
    v_mfma_f32_16x16x32_bf16 v[160:163], v[84:87], v[132:135], v[160:163]
    s_barrier
    ds_read_b128 v[100:103], v2 offset:32768
    v_max_f32 v9, v9, v151
    s_waitcnt lgkmcnt(3)
    v_mfma_f32_16x16x32_bf16 v[164:167], v[88:91], v[116:119], v[164:167]
    v_max3_f32 v10, v144, v145, v146
    v_mfma_f32_16x16x32_bf16 v[168:171], v[88:91], v[132:135], v[168:171]
    ds_read_b128 v[104:107], v2 offset:33792
    v_max3_f32 v10, v10, v147, v152
    s_add_u32 s26, s25, 61440
    buffer_load_dwordx4 v[224:227], v13, s[68:71], s26 offen
    s_waitcnt lgkmcnt(3)
    v_mfma_f32_16x16x32_bf16 v[156:159], v[92:95], v[120:123], v[156:159]
    v_max3_f32 v10, v10, v153, v154
    v_mfma_f32_16x16x32_bf16 v[160:163], v[92:95], v[136:139], v[160:163]
    ds_read_b128 v[84:87], v2 offset:34816
    v_max_f32 v10, v10, v155
    s_waitcnt lgkmcnt(3)
    v_mfma_f32_16x16x32_bf16 v[164:167], v[96:99], v[120:123], v[164:167]
    v_mfma_f32_16x16x32_bf16 v[168:171], v[96:99], v[136:139], v[168:171]
    ds_read_b128 v[88:91], v2 offset:35840
    v_max3_f32 v9, v9, v156, v157
    v_max3_f32 v9, v9, v158, v159
    s_nop 3
    v_max3_f32 v9, v9, v164, v165
    v_max3_f32 v9, v9, v166, v167
    v_max3_f32 v10, v10, v160, v161
    v_max3_f32 v10, v10, v162, v163
    v_max3_f32 v10, v10, v168, v169
    v_max3_f32 v10, v10, v170, v171
    v_mov_b32 v11, v9
    v_mov_b32 v12, v10
    s_nop 0
    v_permlane16_swap_b32 v9, v11
    v_permlane16_swap_b32 v10, v12
    v_max_f32 v9, v9, v11
    v_max_f32 v10, v10, v12
    v_mov_b32 v11, v9
    v_mov_b32 v12, v10
    s_nop 0
    v_permlane32_swap_b32 v9, v11
    v_permlane32_swap_b32 v10, v12
    v_max_f32 v9, v9, v11
    v_max_f32 v10, v10, v12
    v_sub_f32 v172, 0, v9
    v_sub_f32 v173, 0, v9
    v_sub_f32 v174, 0, v9
    v_sub_f32 v175, 0, v9
    v_sub_f32 v176, 0, v10
    v_sub_f32 v177, 0, v10
    v_sub_f32 v178, 0, v10
    v_sub_f32 v179, 0, v10
    v_add_f32 v140, v140, v172
    v_add_f32 v141, v141, v172
    v_exp_f32 v140, v140
    v_exp_f32 v141, v141
    s_nop 0
    v_add_f32 v15, v140, v141
    v_cvt_pk_bf16_f32 v188, v140, v141
    v_add_f32 v142, v142, v172
    v_add_f32 v143, v143, v172
    v_exp_f32 v142, v142
    v_exp_f32 v143, v143
    v_add_f32 v15, v15, v142
    v_add_f32 v15, v15, v143
    v_cvt_pk_bf16_f32 v189, v142, v143
    v_add_f32 v144, v144, v176
    v_add_f32 v145, v145, v176
    v_exp_f32 v144, v144
    v_exp_f32 v145, v145
    s_nop 0
    v_add_f32 v16, v144, v145
    v_cvt_pk_bf16_f32 v192, v144, v145
    v_add_f32 v146, v146, v176
    v_add_f32 v147, v147, v176
    v_exp_f32 v146, v146
    v_exp_f32 v147, v147
    v_add_f32 v16, v16, v146
    v_add_f32 v16, v16, v147
    v_cvt_pk_bf16_f32 v193, v146, v147
    v_add_f32 v148, v148, v172
    v_add_f32 v149, v149, v172
    v_exp_f32 v148, v148
    v_exp_f32 v149, v149
    v_add_f32 v15, v15, v148
    v_add_f32 v15, v15, v149
    v_cvt_pk_bf16_f32 v190, v148, v149
    v_add_f32 v150, v150, v172
    v_add_f32 v151, v151, v172
    v_exp_f32 v150, v150
    v_exp_f32 v151, v151
    v_add_f32 v15, v15, v150
    v_add_f32 v15, v15, v151
    v_cvt_pk_bf16_f32 v191, v150, v151
    v_add_f32 v152, v152, v176
    v_add_f32 v153, v153, v176
    v_exp_f32 v152, v152
    v_exp_f32 v153, v153
    v_add_f32 v16, v16, v152
    v_add_f32 v16, v16, v153
    v_cvt_pk_bf16_f32 v194, v152, v153
    v_add_f32 v154, v154, v176
    v_add_f32 v155, v155, v176
    v_exp_f32 v154, v154
    v_exp_f32 v155, v155
    v_add_f32 v16, v16, v154
    v_add_f32 v16, v16, v155
    v_cvt_pk_bf16_f32 v195, v154, v155
    s_add_u32 s26, s25, 73728
    buffer_load_dwordx4 v[228:231], v13, s[68:71], s26 offen
    s_waitcnt lgkmcnt(3)
    v_mfma_f32_16x16x32_bf16 v[140:143], v[100:103], v[108:111], v[172:175]
    v_add_f32 v156, v156, v172
    v_add_f32 v157, v157, v172
    v_mfma_f32_16x16x32_bf16 v[144:147], v[100:103], v[124:127], v[176:179]
    ds_read_b128 v[92:95], v2 offset:36864
    v_exp_f32 v156, v156
    v_exp_f32 v157, v157
    s_waitcnt lgkmcnt(3)
    v_mfma_f32_16x16x32_bf16 v[148:151], v[104:107], v[108:111], v[172:175]
    v_add_f32 v15, v15, v156
    v_add_f32 v15, v15, v157
    v_mfma_f32_16x16x32_bf16 v[152:155], v[104:107], v[124:127], v[176:179]
    ds_read_b128 v[96:99], v2 offset:37888
    v_cvt_pk_bf16_f32 v196, v156, v157
    s_add_u32 s26, s25, 86016
    buffer_load_dwordx4 v[232:235], v13, s[68:71], s26 offen
    s_waitcnt lgkmcnt(3)
    v_mfma_f32_16x16x32_bf16 v[140:143], v[84:87], v[112:115], v[140:143]
    v_add_f32 v158, v158, v172
    v_add_f32 v159, v159, v172
    v_mfma_f32_16x16x32_bf16 v[144:147], v[84:87], v[128:131], v[144:147]
    ds_read_b128 v[100:103], v2 offset:38912
    v_exp_f32 v158, v158
    v_exp_f32 v159, v159
    s_waitcnt lgkmcnt(3)
    v_mfma_f32_16x16x32_bf16 v[148:151], v[88:91], v[112:115], v[148:151]
    v_add_f32 v15, v15, v158
    v_add_f32 v15, v15, v159
    v_mfma_f32_16x16x32_bf16 v[152:155], v[88:91], v[128:131], v[152:155]
    ds_read_b128 v[104:107], v2 offset:39936
    v_cvt_pk_bf16_f32 v197, v158, v159
    s_waitcnt lgkmcnt(3)
    v_mfma_f32_16x16x32_bf16 v[140:143], v[92:95], v[116:119], v[140:143]
    v_add_f32 v160, v160, v176
    v_add_f32 v161, v161, v176
    v_mfma_f32_16x16x32_bf16 v[144:147], v[92:95], v[132:135], v[144:147]
    ds_read_b128 v[84:87], v2 offset:8192
    v_exp_f32 v160, v160
    v_exp_f32 v161, v161
    s_waitcnt lgkmcnt(3)
    v_mfma_f32_16x16x32_bf16 v[148:151], v[96:99], v[116:119], v[148:151]
    v_add_f32 v16, v16, v160
    v_add_f32 v16, v16, v161
    v_mfma_f32_16x16x32_bf16 v[152:155], v[96:99], v[132:135], v[152:155]
    ds_read_b128 v[88:91], v2 offset:9216
    v_cvt_pk_bf16_f32 v200, v160, v161
    s_waitcnt lgkmcnt(3)
    v_mfma_f32_16x16x32_bf16 v[140:143], v[100:103], v[120:123], v[140:143]
    v_add_f32 v162, v162, v176
    v_add_f32 v163, v163, v176
    v_mfma_f32_16x16x32_bf16 v[144:147], v[100:103], v[136:139], v[144:147]
    ds_read_b128 v[92:95], v2 offset:10240
    v_exp_f32 v162, v162
    v_exp_f32 v163, v163
    s_waitcnt lgkmcnt(3)
    v_mfma_f32_16x16x32_bf16 v[148:151], v[104:107], v[120:123], v[148:151]
    v_add_f32 v16, v16, v162
    v_add_f32 v16, v16, v163
    v_mfma_f32_16x16x32_bf16 v[152:155], v[104:107], v[136:139], v[152:155]
    ds_read_b128 v[96:99], v2 offset:11264
    v_cvt_pk_bf16_f32 v201, v162, v163
    s_waitcnt lgkmcnt(3)
    v_mfma_f32_16x16x32_bf16 v[20:23], v[84:87], v[188:191], 0
    v_add_f32 v164, v164, v172
    v_add_f32 v165, v165, v172
    v_mfma_f32_16x16x32_bf16 v[24:27], v[84:87], v[192:195], 0
    ds_read_b128 v[100:103], v2 offset:12288
    v_exp_f32 v164, v164
    v_exp_f32 v165, v165
    s_waitcnt lgkmcnt(3)
    v_mfma_f32_16x16x32_bf16 v[28:31], v[88:91], v[188:191], 0
    v_add_f32 v15, v15, v164
    v_add_f32 v15, v15, v165
    v_mfma_f32_16x16x32_bf16 v[32:35], v[88:91], v[192:195], 0
    ds_read_b128 v[104:107], v2 offset:13312
    v_cvt_pk_bf16_f32 v198, v164, v165
    s_waitcnt lgkmcnt(3)
    v_mfma_f32_16x16x32_bf16 v[36:39], v[92:95], v[188:191], 0
    v_add_f32 v166, v166, v172
    v_add_f32 v167, v167, v172
    v_mfma_f32_16x16x32_bf16 v[40:43], v[92:95], v[192:195], 0
    ds_read_b128 v[84:87], v2 offset:14336
    v_exp_f32 v166, v166
    v_exp_f32 v167, v167
    s_waitcnt lgkmcnt(3)
    v_mfma_f32_16x16x32_bf16 v[44:47], v[96:99], v[188:191], 0
    v_add_f32 v15, v15, v166
    v_add_f32 v15, v15, v167
    v_mfma_f32_16x16x32_bf16 v[48:51], v[96:99], v[192:195], 0
    ds_read_b128 v[88:91], v2 offset:15360
    v_cvt_pk_bf16_f32 v199, v166, v167
    s_waitcnt lgkmcnt(3)
    v_mfma_f32_16x16x32_bf16 v[52:55], v[100:103], v[188:191], 0
    v_add_f32 v168, v168, v176
    v_add_f32 v169, v169, v176
    v_mfma_f32_16x16x32_bf16 v[56:59], v[100:103], v[192:195], 0
    s_barrier
    ds_read_b128 v[92:95], v2 offset:49152
    v_exp_f32 v168, v168
    v_exp_f32 v169, v169
    s_waitcnt lgkmcnt(3)
    v_mfma_f32_16x16x32_bf16 v[60:63], v[104:107], v[188:191], 0
    v_add_f32 v16, v16, v168
    v_add_f32 v16, v16, v169
    v_mfma_f32_16x16x32_bf16 v[64:67], v[104:107], v[192:195], 0
    ds_read_b128 v[96:99], v2 offset:50176
    v_cvt_pk_bf16_f32 v202, v168, v169
    s_waitcnt lgkmcnt(3)
    v_mfma_f32_16x16x32_bf16 v[68:71], v[84:87], v[188:191], 0
    v_add_f32 v170, v170, v176
    v_add_f32 v171, v171, v176
    v_mfma_f32_16x16x32_bf16 v[72:75], v[84:87], v[192:195], 0
    ds_read_b128 v[100:103], v2 offset:51200
    v_exp_f32 v170, v170
    v_exp_f32 v171, v171
    s_waitcnt lgkmcnt(3)
    v_mfma_f32_16x16x32_bf16 v[76:79], v[88:91], v[188:191], 0
    v_add_f32 v16, v16, v170
    v_add_f32 v16, v16, v171
    v_mfma_f32_16x16x32_bf16 v[80:83], v[88:91], v[192:195], 0
    ds_read_b128 v[104:107], v2 offset:52224
    v_cvt_pk_bf16_f32 v203, v170, v171
    s_waitcnt lgkmcnt(3)
    v_mfma_f32_16x16x32_bf16 v[156:159], v[92:95], v[108:111], v[172:175]
    v_exp_f32 v140, v140
    v_exp_f32 v141, v141
    v_mfma_f32_16x16x32_bf16 v[160:163], v[92:95], v[124:127], v[176:179]
    ds_read_b128 v[84:87], v2 offset:53248
    v_add_f32 v15, v15, v140
    s_waitcnt lgkmcnt(3)
    v_mfma_f32_16x16x32_bf16 v[164:167], v[96:99], v[108:111], v[172:175]
    v_add_f32 v15, v15, v141
    v_mfma_f32_16x16x32_bf16 v[168:171], v[96:99], v[124:127], v[176:179]
    ds_read_b128 v[88:91], v2 offset:54272
    v_cvt_pk_bf16_f32 v188, v140, v141
    s_waitcnt lgkmcnt(3)
    v_mfma_f32_16x16x32_bf16 v[156:159], v[100:103], v[112:115], v[156:159]
    v_exp_f32 v142, v142
    v_exp_f32 v143, v143
    v_mfma_f32_16x16x32_bf16 v[160:163], v[100:103], v[128:131], v[160:163]
    ds_read_b128 v[92:95], v2 offset:55296
    v_add_f32 v15, v15, v142
    s_waitcnt lgkmcnt(3)
    v_mfma_f32_16x16x32_bf16 v[164:167], v[104:107], v[112:115], v[164:167]
    v_add_f32 v15, v15, v143
    v_mfma_f32_16x16x32_bf16 v[168:171], v[104:107], v[128:131], v[168:171]
    ds_read_b128 v[96:99], v2 offset:56320
    v_cvt_pk_bf16_f32 v189, v142, v143
    s_waitcnt lgkmcnt(3)
    v_mfma_f32_16x16x32_bf16 v[156:159], v[84:87], v[116:119], v[156:159]
    v_exp_f32 v144, v144
    v_exp_f32 v145, v145
    v_mfma_f32_16x16x32_bf16 v[160:163], v[84:87], v[132:135], v[160:163]
    ds_read_b128 v[100:103], v2 offset:24576
    v_add_f32 v16, v16, v144
    s_waitcnt lgkmcnt(3)
    v_mfma_f32_16x16x32_bf16 v[164:167], v[88:91], v[116:119], v[164:167]
    v_add_f32 v16, v16, v145
    v_mfma_f32_16x16x32_bf16 v[168:171], v[88:91], v[132:135], v[168:171]
    ds_read_b128 v[104:107], v2 offset:25600
    v_cvt_pk_bf16_f32 v192, v144, v145
    s_waitcnt lgkmcnt(3)
    v_mfma_f32_16x16x32_bf16 v[156:159], v[92:95], v[120:123], v[156:159]
    v_exp_f32 v146, v146
    v_exp_f32 v147, v147
    v_mfma_f32_16x16x32_bf16 v[160:163], v[92:95], v[136:139], v[160:163]
    ds_read_b128 v[84:87], v2 offset:26624
    v_add_f32 v16, v16, v146
    s_waitcnt lgkmcnt(3)
    v_mfma_f32_16x16x32_bf16 v[164:167], v[96:99], v[120:123], v[164:167]
    v_add_f32 v16, v16, v147
    v_mfma_f32_16x16x32_bf16 v[168:171], v[96:99], v[136:139], v[168:171]
    ds_read_b128 v[88:91], v2 offset:27648
    v_cvt_pk_bf16_f32 v193, v146, v147
    s_waitcnt lgkmcnt(3)
    v_mfma_f32_16x16x32_bf16 v[20:23], v[100:103], v[196:199], v[20:23]
    v_exp_f32 v148, v148
    v_exp_f32 v149, v149
    v_mfma_f32_16x16x32_bf16 v[24:27], v[100:103], v[200:203], v[24:27]
    ds_read_b128 v[92:95], v2 offset:28672
    v_add_f32 v15, v15, v148
    s_waitcnt lgkmcnt(3)
    v_mfma_f32_16x16x32_bf16 v[28:31], v[104:107], v[196:199], v[28:31]
    v_add_f32 v15, v15, v149
    v_mfma_f32_16x16x32_bf16 v[32:35], v[104:107], v[200:203], v[32:35]
    ds_read_b128 v[96:99], v2 offset:29696
    v_cvt_pk_bf16_f32 v190, v148, v149
    s_waitcnt lgkmcnt(3)
    v_mfma_f32_16x16x32_bf16 v[36:39], v[84:87], v[196:199], v[36:39]
    v_exp_f32 v150, v150
    v_exp_f32 v151, v151
    v_mfma_f32_16x16x32_bf16 v[40:43], v[84:87], v[200:203], v[40:43]
    ds_read_b128 v[100:103], v2 offset:30720
    v_add_f32 v15, v15, v150
    s_waitcnt lgkmcnt(3)
    v_mfma_f32_16x16x32_bf16 v[44:47], v[88:91], v[196:199], v[44:47]
    v_add_f32 v15, v15, v151
    v_mfma_f32_16x16x32_bf16 v[48:51], v[88:91], v[200:203], v[48:51]
    ds_read_b128 v[104:107], v2 offset:31744
    v_cvt_pk_bf16_f32 v191, v150, v151
    s_waitcnt lgkmcnt(3)
    v_mfma_f32_16x16x32_bf16 v[52:55], v[92:95], v[196:199], v[52:55]
    v_exp_f32 v152, v152
    v_exp_f32 v153, v153
    v_mfma_f32_16x16x32_bf16 v[56:59], v[92:95], v[200:203], v[56:59]
    s_barrier
    ds_read_b128 v[84:87], v3 offset:0
    v_add_f32 v16, v16, v152
    s_waitcnt lgkmcnt(3)
    v_mfma_f32_16x16x32_bf16 v[60:63], v[96:99], v[196:199], v[60:63]
    v_add_f32 v16, v16, v153
    v_mfma_f32_16x16x32_bf16 v[64:67], v[96:99], v[200:203], v[64:67]
    ds_read_b128 v[88:91], v3 offset:1024
    v_cvt_pk_bf16_f32 v194, v152, v153
    s_waitcnt lgkmcnt(3)
    v_mfma_f32_16x16x32_bf16 v[68:71], v[100:103], v[196:199], v[68:71]
    v_exp_f32 v154, v154
    v_exp_f32 v155, v155
    v_mfma_f32_16x16x32_bf16 v[72:75], v[100:103], v[200:203], v[72:75]
    ds_read_b128 v[92:95], v3 offset:2048
    v_add_f32 v16, v16, v154
    s_waitcnt lgkmcnt(3)
    v_mfma_f32_16x16x32_bf16 v[76:79], v[104:107], v[196:199], v[76:79]
    v_add_f32 v16, v16, v155
    v_mfma_f32_16x16x32_bf16 v[80:83], v[104:107], v[200:203], v[80:83]
    ds_read_b128 v[96:99], v3 offset:3072
    v_cvt_pk_bf16_f32 v195, v154, v155
    s_waitcnt lgkmcnt(3)
    v_mfma_f32_16x16x32_bf16 v[140:143], v[84:87], v[108:111], v[172:175]
    v_exp_f32 v156, v156
    v_exp_f32 v157, v157
    v_mfma_f32_16x16x32_bf16 v[144:147], v[84:87], v[124:127], v[176:179]
    ds_read_b128 v[100:103], v3 offset:4096
    v_add_f32 v15, v15, v156
    s_waitcnt lgkmcnt(3)
    v_mfma_f32_16x16x32_bf16 v[148:151], v[88:91], v[108:111], v[172:175]
    v_add_f32 v15, v15, v157
    v_mfma_f32_16x16x32_bf16 v[152:155], v[88:91], v[124:127], v[176:179]
    ds_read_b128 v[104:107], v3 offset:5120
    v_cvt_pk_bf16_f32 v196, v156, v157
    s_waitcnt lgkmcnt(3)
    v_mfma_f32_16x16x32_bf16 v[140:143], v[92:95], v[112:115], v[140:143]
    v_exp_f32 v158, v158
    v_exp_f32 v159, v159
    v_mfma_f32_16x16x32_bf16 v[144:147], v[92:95], v[128:131], v[144:147]
    ds_read_b128 v[84:87], v3 offset:6144
    v_add_f32 v15, v15, v158
    s_waitcnt lgkmcnt(3)
    v_mfma_f32_16x16x32_bf16 v[148:151], v[96:99], v[112:115], v[148:151]
    v_add_f32 v15, v15, v159
    v_mfma_f32_16x16x32_bf16 v[152:155], v[96:99], v[128:131], v[152:155]
    ds_read_b128 v[88:91], v3 offset:7168
    v_cvt_pk_bf16_f32 v197, v158, v159
    s_waitcnt lgkmcnt(3)
    v_mfma_f32_16x16x32_bf16 v[140:143], v[100:103], v[116:119], v[140:143]
    v_exp_f32 v160, v160
    v_exp_f32 v161, v161
    v_mfma_f32_16x16x32_bf16 v[144:147], v[100:103], v[132:135], v[144:147]
    ds_read_b128 v[92:95], v2 offset:40960
    v_add_f32 v16, v16, v160
    s_waitcnt lgkmcnt(3)
    v_mfma_f32_16x16x32_bf16 v[148:151], v[104:107], v[116:119], v[148:151]
    v_add_f32 v16, v16, v161
    v_mfma_f32_16x16x32_bf16 v[152:155], v[104:107], v[132:135], v[152:155]
    ds_read_b128 v[96:99], v2 offset:41984
    v_cvt_pk_bf16_f32 v200, v160, v161
    s_waitcnt lgkmcnt(3)
    v_mfma_f32_16x16x32_bf16 v[140:143], v[84:87], v[120:123], v[140:143]
    v_exp_f32 v162, v162
    v_exp_f32 v163, v163
    v_mfma_f32_16x16x32_bf16 v[144:147], v[84:87], v[136:139], v[144:147]
    ds_read_b128 v[100:103], v2 offset:43008
    v_add_f32 v16, v16, v162
    s_waitcnt lgkmcnt(3)
    v_mfma_f32_16x16x32_bf16 v[148:151], v[88:91], v[120:123], v[148:151]
    v_add_f32 v16, v16, v163
    v_mfma_f32_16x16x32_bf16 v[152:155], v[88:91], v[136:139], v[152:155]
    ds_read_b128 v[104:107], v2 offset:44032
    v_cvt_pk_bf16_f32 v201, v162, v163
    s_waitcnt lgkmcnt(3)
    v_mfma_f32_16x16x32_bf16 v[20:23], v[92:95], v[188:191], v[20:23]
    v_exp_f32 v164, v164
    v_exp_f32 v165, v165
    v_mfma_f32_16x16x32_bf16 v[24:27], v[92:95], v[192:195], v[24:27]
    ds_read_b128 v[84:87], v2 offset:45056
    v_add_f32 v15, v15, v164
    s_waitcnt lgkmcnt(3)
    v_mfma_f32_16x16x32_bf16 v[28:31], v[96:99], v[188:191], v[28:31]
    v_add_f32 v15, v15, v165
    v_mfma_f32_16x16x32_bf16 v[32:35], v[96:99], v[192:195], v[32:35]
    ds_read_b128 v[88:91], v2 offset:46080
    v_cvt_pk_bf16_f32 v198, v164, v165
    s_waitcnt lgkmcnt(3)
    v_mfma_f32_16x16x32_bf16 v[36:39], v[100:103], v[188:191], v[36:39]
    v_exp_f32 v166, v166
    v_exp_f32 v167, v167
    v_mfma_f32_16x16x32_bf16 v[40:43], v[100:103], v[192:195], v[40:43]
    ds_read_b128 v[92:95], v2 offset:47104
    v_add_f32 v15, v15, v166
    s_waitcnt lgkmcnt(3)
    v_mfma_f32_16x16x32_bf16 v[44:47], v[104:107], v[188:191], v[44:47]
    v_add_f32 v15, v15, v167
    v_mfma_f32_16x16x32_bf16 v[48:51], v[104:107], v[192:195], v[48:51]
    ds_read_b128 v[96:99], v2 offset:48128
    v_cvt_pk_bf16_f32 v199, v166, v167
    s_waitcnt lgkmcnt(3)
    v_mfma_f32_16x16x32_bf16 v[52:55], v[84:87], v[188:191], v[52:55]
    v_exp_f32 v168, v168
    v_exp_f32 v169, v169
    v_mfma_f32_16x16x32_bf16 v[56:59], v[84:87], v[192:195], v[56:59]
    s_barrier
    ds_read_b128 v[100:103], v3 offset:16384
    v_add_f32 v16, v16, v168
    s_waitcnt lgkmcnt(3)
    v_mfma_f32_16x16x32_bf16 v[60:63], v[88:91], v[188:191], v[60:63]
    v_add_f32 v16, v16, v169
    v_mfma_f32_16x16x32_bf16 v[64:67], v[88:91], v[192:195], v[64:67]
    ds_read_b128 v[104:107], v3 offset:17408
    v_cvt_pk_bf16_f32 v202, v168, v169
    s_waitcnt lgkmcnt(3)
    v_mfma_f32_16x16x32_bf16 v[68:71], v[92:95], v[188:191], v[68:71]
    v_exp_f32 v170, v170
    v_exp_f32 v171, v171
    v_mfma_f32_16x16x32_bf16 v[72:75], v[92:95], v[192:195], v[72:75]
    ds_read_b128 v[84:87], v3 offset:18432
    v_add_f32 v16, v16, v170
    s_waitcnt lgkmcnt(3)
    v_mfma_f32_16x16x32_bf16 v[76:79], v[96:99], v[188:191], v[76:79]
    v_add_f32 v16, v16, v171
    v_mfma_f32_16x16x32_bf16 v[80:83], v[96:99], v[192:195], v[80:83]
    ds_read_b128 v[88:91], v3 offset:19456
    v_cvt_pk_bf16_f32 v203, v170, v171
    s_waitcnt lgkmcnt(3)
    v_mfma_f32_16x16x32_bf16 v[156:159], v[100:103], v[108:111], v[172:175]
    v_exp_f32 v140, v140
    v_exp_f32 v141, v141
    v_mfma_f32_16x16x32_bf16 v[160:163], v[100:103], v[124:127], v[176:179]
    ds_read_b128 v[92:95], v3 offset:20480
    v_add_f32 v15, v15, v140
    s_waitcnt vmcnt(8)
    v_lshlrev_b32 v236, 16, v244
    v_and_b32 v237, 0xffff0000, v244
    v_lshlrev_b32 v238, 16, v245
    v_and_b32 v239, 0xffff0000, v245
    v_lshlrev_b32 v240, 16, v246
    v_and_b32 v241, 0xffff0000, v246
    v_lshlrev_b32 v242, 16, v247
    s_waitcnt lgkmcnt(3)
    v_mfma_f32_16x16x32_bf16 v[164:167], v[104:107], v[108:111], v[172:175]
    v_add_f32 v15, v15, v141
    v_mfma_f32_16x16x32_bf16 v[168:171], v[104:107], v[124:127], v[176:179]
    ds_read_b128 v[96:99], v3 offset:21504
    v_cvt_pk_bf16_f32 v188, v140, v141
    v_and_b32 v243, 0xffff0000, v247
    v_mul_f32 v4, 0xbfb8aa3b, v236
    v_exp_f32 v4, v4
    s_nop 0
    v_add_f32 v4, 1.0, v4
    v_rcp_f32 v4, v4
    s_nop 0
    v_mul_f32 v236, v236, v4
    v_mul_f32 v10, 0xbfb8aa3b, v237
    s_waitcnt lgkmcnt(3)
    v_mfma_f32_16x16x32_bf16 v[156:159], v[84:87], v[112:115], v[156:159]
    v_exp_f32 v142, v142
    v_exp_f32 v143, v143
    v_mfma_f32_16x16x32_bf16 v[160:163], v[84:87], v[128:131], v[160:163]
    ds_read_b128 v[100:103], v3 offset:22528
    v_add_f32 v15, v15, v142
    v_exp_f32 v10, v10
    s_nop 0
    v_add_f32 v10, 1.0, v10
    v_rcp_f32 v10, v10
    s_nop 0
    v_mul_f32 v237, v237, v10
    v_mul_f32 v5, 0xbfb8aa3b, v238
    v_exp_f32 v5, v5
    s_nop 0
    v_add_f32 v5, 1.0, v5
    s_waitcnt lgkmcnt(3)
    v_mfma_f32_16x16x32_bf16 v[164:167], v[88:91], v[112:115], v[164:167]
    v_add_f32 v15, v15, v143
    v_mfma_f32_16x16x32_bf16 v[168:171], v[88:91], v[128:131], v[168:171]
    ds_read_b128 v[104:107], v3 offset:23552
    v_cvt_pk_bf16_f32 v189, v142, v143
    v_rcp_f32 v5, v5
    s_nop 0
    v_mul_f32 v238, v238, v5
    v_mul_f32 v12, 0xbfb8aa3b, v239
    v_exp_f32 v12, v12
    s_nop 0
    v_add_f32 v12, 1.0, v12
    v_rcp_f32 v12, v12
    s_nop 0
    v_mul_f32 v239, v239, v12
    s_waitcnt lgkmcnt(3)
    v_mfma_f32_16x16x32_bf16 v[156:159], v[92:95], v[116:119], v[156:159]
    v_exp_f32 v144, v144
    v_exp_f32 v145, v145
    v_mfma_f32_16x16x32_bf16 v[160:163], v[92:95], v[132:135], v[160:163]
    ds_read_b128 v[84:87], v2 offset:57344
    v_add_f32 v16, v16, v144
    v_mul_f32 v4, 0xbfb8aa3b, v240
    v_exp_f32 v4, v4
    s_nop 0
    v_add_f32 v4, 1.0, v4
    v_rcp_f32 v4, v4
    s_nop 0
    v_mul_f32 v240, v240, v4
    v_mul_f32 v10, 0xbfb8aa3b, v241
    v_exp_f32 v10, v10
    s_waitcnt lgkmcnt(3)
    v_mfma_f32_16x16x32_bf16 v[164:167], v[96:99], v[116:119], v[164:167]
    v_add_f32 v16, v16, v145
    v_mfma_f32_16x16x32_bf16 v[168:171], v[96:99], v[132:135], v[168:171]
    ds_read_b128 v[88:91], v2 offset:58368
    v_cvt_pk_bf16_f32 v192, v144, v145
    v_add_f32 v10, 1.0, v10
    v_rcp_f32 v10, v10
    s_nop 0
    v_mul_f32 v241, v241, v10
    v_mul_f32 v5, 0xbfb8aa3b, v242
    v_exp_f32 v5, v5
    s_nop 0
    v_add_f32 v5, 1.0, v5
    v_rcp_f32 v5, v5
    s_and_b32 s26, s12, 24
    s_lshl_b32 s26, s26, 18
    s_lshr_b32 s27, s2, 3
    s_lshl_b32 s27, s27, 16
    s_add_u32 s26, s26, s27
    v_lshrrev_b32 v17, 6, v8
    v_lshlrev_b32 v17, 10, v17
    v_lshl_add_u32 v17, v0, 7, v17
    v_add_u32 v17, s26, v17
    v_cmp_gt_u32 vcc, 8, v0
    v_bfrev_b32 v18, -2
    s_nop 0
    v_cndmask_b32 v17, v18, v17, vcc
    s_waitcnt lgkmcnt(3)
    v_mfma_f32_16x16x32_bf16 v[156:159], v[100:103], v[120:123], v[156:159]
    v_exp_f32 v146, v146
    v_exp_f32 v147, v147
    v_mfma_f32_16x16x32_bf16 v[160:163], v[100:103], v[136:139], v[160:163]
    ds_read_b128 v[92:95], v2 offset:59392
    v_add_f32 v16, v16, v146
    v_mul_f32 v242, v242, v5
    v_mul_f32 v12, 0xbfb8aa3b, v243
    v_exp_f32 v12, v12
    s_nop 0
    v_add_f32 v12, 1.0, v12
    v_rcp_f32 v12, v12
    s_nop 0
    v_mul_f32 v243, v243, v12
    s_mov_b64 s[20:21], s[40:41]
    s_mov_b32 s22, 0x800000
    s_mov_b32 s23, 0x20000
    s_mov_b32 s26, 0x0
    buffer_load_dword v18, v17, s[20:23], s26 offen
    s_waitcnt lgkmcnt(3)
    v_mfma_f32_16x16x32_bf16 v[164:167], v[104:107], v[120:123], v[164:167]
    v_add_f32 v16, v16, v147
    v_mfma_f32_16x16x32_bf16 v[168:171], v[104:107], v[136:139], v[168:171]
    ds_read_b128 v[96:99], v2 offset:60416
    v_cvt_pk_bf16_f32 v193, v146, v147
    v_cvt_pk_bf16_f32 v4, v236, v237
    v_lshlrev_b32 v236, 16, v4
    v_and_b32 v237, 0xffff0000, v4
    v_cvt_pk_bf16_f32 v4, v238, v239
    v_lshlrev_b32 v238, 16, v4
    v_and_b32 v239, 0xffff0000, v4
    v_cvt_pk_bf16_f32 v4, v240, v241
    s_waitcnt lgkmcnt(3)
    v_mfma_f32_16x16x32_bf16 v[20:23], v[84:87], v[196:199], v[20:23]
    v_exp_f32 v148, v148
    v_exp_f32 v149, v149
    v_mfma_f32_16x16x32_bf16 v[24:27], v[84:87], v[200:203], v[24:27]
    ds_read_b128 v[100:103], v2 offset:61440
    v_add_f32 v15, v15, v148
    v_lshlrev_b32 v240, 16, v4
    v_and_b32 v241, 0xffff0000, v4
    v_cvt_pk_bf16_f32 v4, v242, v243
    v_lshlrev_b32 v242, 16, v4
    v_and_b32 v243, 0xffff0000, v4
    s_waitcnt vmcnt(8)
    v_lshlrev_b32 v4, 16, v204
    v_and_b32 v10, 0xffff0000, v204
    s_waitcnt lgkmcnt(3)
    v_mfma_f32_16x16x32_bf16 v[28:31], v[88:91], v[196:199], v[28:31]
    v_add_f32 v15, v15, v149
    v_mfma_f32_16x16x32_bf16 v[32:35], v[88:91], v[200:203], v[32:35]
    ds_read_b128 v[104:107], v2 offset:62464
    v_cvt_pk_bf16_f32 v190, v148, v149
    v_lshlrev_b32 v5, 16, v205
    v_and_b32 v12, 0xffff0000, v205
    v_mul_f32 v244, v236, v4
    v_mul_f32 v245, v236, v10
    v_mul_f32 v246, v236, v5
    v_mul_f32 v247, v236, v12
    v_lshlrev_b32 v4, 16, v206
    s_mov_b64 s[20:21], s[40:41]
    s_mov_b32 s22, 0x800000
    s_mov_b32 s23, 0x20000
    s_mov_b32 s26, 0x1000
    buffer_load_dword v18, v17, s[20:23], s26 offen
    s_waitcnt lgkmcnt(3)
    v_mfma_f32_16x16x32_bf16 v[36:39], v[92:95], v[196:199], v[36:39]
    v_exp_f32 v150, v150
    v_exp_f32 v151, v151
    v_mfma_f32_16x16x32_bf16 v[40:43], v[92:95], v[200:203], v[40:43]
    ds_read_b128 v[84:87], v2 offset:63488
    v_add_f32 v15, v15, v150
    v_and_b32 v10, 0xffff0000, v206
    v_lshlrev_b32 v5, 16, v207
    v_and_b32 v12, 0xffff0000, v207
    v_mul_f32 v248, v236, v4
    v_mul_f32 v249, v236, v10
    v_mul_f32 v250, v236, v5
    v_mul_f32 v251, v236, v12
    s_waitcnt lgkmcnt(3)
    v_mfma_f32_16x16x32_bf16 v[44:47], v[96:99], v[196:199], v[44:47]
    v_add_f32 v15, v15, v151
    v_mfma_f32_16x16x32_bf16 v[48:51], v[96:99], v[200:203], v[48:51]
    ds_read_b128 v[88:91], v2 offset:64512
    v_cvt_pk_bf16_f32 v191, v150, v151
    s_waitcnt vmcnt(8)
    v_lshlrev_b32 v4, 16, v208
    v_and_b32 v10, 0xffff0000, v208
    v_lshlrev_b32 v5, 16, v209
    v_and_b32 v12, 0xffff0000, v209
    v_fmac_f32 v244, v237, v4
    v_fmac_f32 v245, v237, v10
    v_fmac_f32 v246, v237, v5
    s_waitcnt lgkmcnt(3)
    v_mfma_f32_16x16x32_bf16 v[52:55], v[100:103], v[196:199], v[52:55]
    v_exp_f32 v152, v152
    v_exp_f32 v153, v153
    v_mfma_f32_16x16x32_bf16 v[56:59], v[100:103], v[200:203], v[56:59]
    s_barrier
    ds_read_b128 v[92:95], v2 offset:0
    v_add_f32 v16, v16, v152
    v_fmac_f32 v247, v237, v12
    v_lshlrev_b32 v4, 16, v210
    v_and_b32 v10, 0xffff0000, v210
    v_lshlrev_b32 v5, 16, v211
    v_and_b32 v12, 0xffff0000, v211
    v_fmac_f32 v248, v237, v4
    s_mov_b64 s[20:21], s[40:41]
    s_mov_b32 s22, 0x800000
    s_mov_b32 s23, 0x20000
    s_mov_b32 s26, 0x2000
    buffer_load_dword v18, v17, s[20:23], s26 offen
    s_waitcnt lgkmcnt(3)
    v_mfma_f32_16x16x32_bf16 v[60:63], v[104:107], v[196:199], v[60:63]
    v_add_f32 v16, v16, v153
    v_mfma_f32_16x16x32_bf16 v[64:67], v[104:107], v[200:203], v[64:67]
    ds_read_b128 v[96:99], v2 offset:1024
    v_cvt_pk_bf16_f32 v194, v152, v153
    v_fmac_f32 v249, v237, v10
    v_fmac_f32 v250, v237, v5
    v_fmac_f32 v251, v237, v12
    s_waitcnt vmcnt(8)
    v_lshlrev_b32 v4, 16, v212
    v_and_b32 v10, 0xffff0000, v212
    v_lshlrev_b32 v5, 16, v213
    v_and_b32 v12, 0xffff0000, v213
    s_waitcnt lgkmcnt(3)
    v_mfma_f32_16x16x32_bf16 v[68:71], v[84:87], v[196:199], v[68:71]
    v_exp_f32 v154, v154
    v_exp_f32 v155, v155
    v_mfma_f32_16x16x32_bf16 v[72:75], v[84:87], v[200:203], v[72:75]
    ds_read_b128 v[100:103], v2 offset:2048
    v_add_f32 v16, v16, v154
    v_fmac_f32 v244, v238, v4
    v_fmac_f32 v245, v238, v10
    v_fmac_f32 v246, v238, v5
    v_fmac_f32 v247, v238, v12
    v_lshlrev_b32 v4, 16, v214
    v_and_b32 v10, 0xffff0000, v214
    v_lshlrev_b32 v5, 16, v215
    s_waitcnt lgkmcnt(3)
    v_mfma_f32_16x16x32_bf16 v[76:79], v[88:91], v[196:199], v[76:79]
    v_add_f32 v16, v16, v155
    v_mfma_f32_16x16x32_bf16 v[80:83], v[88:91], v[200:203], v[80:83]
    ds_read_b128 v[104:107], v2 offset:3072
    v_cvt_pk_bf16_f32 v195, v154, v155
    v_and_b32 v12, 0xffff0000, v215
    v_fmac_f32 v248, v238, v4
    v_fmac_f32 v249, v238, v10
    v_fmac_f32 v250, v238, v5
    v_fmac_f32 v251, v238, v12
    s_waitcnt vmcnt(7)
    v_lshlrev_b32 v4, 16, v216
    v_and_b32 v10, 0xffff0000, v216
    s_waitcnt lgkmcnt(3)
    v_mfma_f32_16x16x32_bf16 v[140:143], v[92:95], v[108:111], v[172:175]
    v_exp_f32 v156, v156
    v_exp_f32 v157, v157
    v_mfma_f32_16x16x32_bf16 v[144:147], v[92:95], v[124:127], v[176:179]
    ds_read_b128 v[84:87], v2 offset:4096
    v_add_f32 v15, v15, v156
    v_lshlrev_b32 v5, 16, v217
    v_and_b32 v12, 0xffff0000, v217
    v_fmac_f32 v244, v239, v4
    v_fmac_f32 v245, v239, v10
    v_fmac_f32 v246, v239, v5
    v_fmac_f32 v247, v239, v12
    v_lshlrev_b32 v4, 16, v218
    s_mov_b64 s[20:21], s[40:41]
    s_mov_b32 s22, 0x800000
    s_mov_b32 s23, 0x20000
    s_mov_b32 s26, 0x3000
    buffer_load_dword v18, v17, s[20:23], s26 offen
    s_waitcnt lgkmcnt(3)
    v_mfma_f32_16x16x32_bf16 v[148:151], v[96:99], v[108:111], v[172:175]
    v_add_f32 v15, v15, v157
    v_mfma_f32_16x16x32_bf16 v[152:155], v[96:99], v[124:127], v[176:179]
    ds_read_b128 v[88:91], v2 offset:5120
    v_cvt_pk_bf16_f32 v196, v156, v157
    v_and_b32 v10, 0xffff0000, v218
    v_lshlrev_b32 v5, 16, v219
    v_and_b32 v12, 0xffff0000, v219
    v_fmac_f32 v248, v239, v4
    v_fmac_f32 v249, v239, v10
    v_fmac_f32 v250, v239, v5
    v_fmac_f32 v251, v239, v12
    s_waitcnt lgkmcnt(3)
    v_mfma_f32_16x16x32_bf16 v[140:143], v[100:103], v[112:115], v[140:143]
    v_exp_f32 v158, v158
    v_exp_f32 v159, v159
    v_mfma_f32_16x16x32_bf16 v[144:147], v[100:103], v[128:131], v[144:147]
    ds_read_b128 v[92:95], v2 offset:6144
    v_add_f32 v15, v15, v158
    s_waitcnt vmcnt(7)
    v_lshlrev_b32 v4, 16, v220
    v_and_b32 v10, 0xffff0000, v220
    v_lshlrev_b32 v5, 16, v221
    v_and_b32 v12, 0xffff0000, v221
    v_fmac_f32 v244, v240, v4
    v_fmac_f32 v245, v240, v10
    s_waitcnt lgkmcnt(3)
    v_mfma_f32_16x16x32_bf16 v[148:151], v[104:107], v[112:115], v[148:151]
    v_add_f32 v15, v15, v159
    v_mfma_f32_16x16x32_bf16 v[152:155], v[104:107], v[128:131], v[152:155]
    ds_read_b128 v[96:99], v2 offset:7168
    v_cvt_pk_bf16_f32 v197, v158, v159
    v_fmac_f32 v246, v240, v5
    v_fmac_f32 v247, v240, v12
    v_lshlrev_b32 v4, 16, v222
    v_and_b32 v10, 0xffff0000, v222
    v_lshlrev_b32 v5, 16, v223
    v_and_b32 v12, 0xffff0000, v223
    v_fmac_f32 v248, v240, v4
    s_mov_b64 s[20:21], s[40:41]
    s_mov_b32 s22, 0x800000
    s_mov_b32 s23, 0x20000
    s_mov_b32 s26, 0x4000
    buffer_load_dword v18, v17, s[20:23], s26 offen
    s_waitcnt lgkmcnt(3)
    v_mfma_f32_16x16x32_bf16 v[140:143], v[84:87], v[116:119], v[140:143]
    v_exp_f32 v160, v160
    v_exp_f32 v161, v161
    v_mfma_f32_16x16x32_bf16 v[144:147], v[84:87], v[132:135], v[144:147]
    ds_read_b128 v[100:103], v3 offset:8192
    v_add_f32 v16, v16, v160
    v_fmac_f32 v249, v240, v10
    v_fmac_f32 v250, v240, v5
    v_fmac_f32 v251, v240, v12
    s_waitcnt vmcnt(7)
    v_lshlrev_b32 v4, 16, v224
    v_and_b32 v10, 0xffff0000, v224
    v_lshlrev_b32 v5, 16, v225
    v_and_b32 v12, 0xffff0000, v225
    s_waitcnt lgkmcnt(3)
    v_mfma_f32_16x16x32_bf16 v[148:151], v[88:91], v[116:119], v[148:151]
    v_add_f32 v16, v16, v161
    v_mfma_f32_16x16x32_bf16 v[152:155], v[88:91], v[132:135], v[152:155]
    ds_read_b128 v[104:107], v3 offset:9216
    v_cvt_pk_bf16_f32 v200, v160, v161
    v_fmac_f32 v244, v241, v4
    v_fmac_f32 v245, v241, v10
    v_fmac_f32 v246, v241, v5
    v_fmac_f32 v247, v241, v12
    v_lshlrev_b32 v4, 16, v226
    v_and_b32 v10, 0xffff0000, v226
    v_lshlrev_b32 v5, 16, v227
    s_waitcnt lgkmcnt(3)
    v_mfma_f32_16x16x32_bf16 v[140:143], v[92:95], v[120:123], v[140:143]
    v_exp_f32 v162, v162
    v_exp_f32 v163, v163
    v_mfma_f32_16x16x32_bf16 v[144:147], v[92:95], v[136:139], v[144:147]
    ds_read_b128 v[84:87], v3 offset:10240
    v_add_f32 v16, v16, v162
    v_and_b32 v12, 0xffff0000, v227
    v_fmac_f32 v248, v241, v4
    v_fmac_f32 v249, v241, v10
    v_fmac_f32 v250, v241, v5
    v_fmac_f32 v251, v241, v12
    s_waitcnt vmcnt(6)
    v_lshlrev_b32 v4, 16, v228
    v_and_b32 v10, 0xffff0000, v228
    s_waitcnt lgkmcnt(3)
    v_mfma_f32_16x16x32_bf16 v[148:151], v[96:99], v[120:123], v[148:151]
    v_add_f32 v16, v16, v163
    v_mfma_f32_16x16x32_bf16 v[152:155], v[96:99], v[136:139], v[152:155]
    ds_read_b128 v[88:91], v3 offset:11264
    v_cvt_pk_bf16_f32 v201, v162, v163
    v_lshlrev_b32 v5, 16, v229
    v_and_b32 v12, 0xffff0000, v229
    v_fmac_f32 v244, v242, v4
    v_fmac_f32 v245, v242, v10
    v_fmac_f32 v246, v242, v5
    v_fmac_f32 v247, v242, v12
    v_lshlrev_b32 v4, 16, v230
    s_mov_b64 s[20:21], s[40:41]
    s_mov_b32 s22, 0x800000
    s_mov_b32 s23, 0x20000
    s_mov_b32 s26, 0x5000
    buffer_load_dword v18, v17, s[20:23], s26 offen
    s_waitcnt lgkmcnt(3)
    v_mfma_f32_16x16x32_bf16 v[20:23], v[100:103], v[188:191], v[20:23]
    v_exp_f32 v164, v164
    v_exp_f32 v165, v165
    v_mfma_f32_16x16x32_bf16 v[24:27], v[100:103], v[192:195], v[24:27]
    ds_read_b128 v[92:95], v3 offset:12288
    v_add_f32 v15, v15, v164
    v_and_b32 v10, 0xffff0000, v230
    v_lshlrev_b32 v5, 16, v231
    v_and_b32 v12, 0xffff0000, v231
    v_fmac_f32 v248, v242, v4
    v_fmac_f32 v249, v242, v10
    v_fmac_f32 v250, v242, v5
    s_waitcnt lgkmcnt(3)
    v_mfma_f32_16x16x32_bf16 v[28:31], v[104:107], v[188:191], v[28:31]
    v_add_f32 v15, v15, v165
    v_mfma_f32_16x16x32_bf16 v[32:35], v[104:107], v[192:195], v[32:35]
    ds_read_b128 v[96:99], v3 offset:13312
    v_cvt_pk_bf16_f32 v198, v164, v165
    v_fmac_f32 v251, v242, v12
    s_waitcnt vmcnt(6)
    v_lshlrev_b32 v4, 16, v232
    v_and_b32 v10, 0xffff0000, v232
    v_lshlrev_b32 v5, 16, v233
    v_and_b32 v12, 0xffff0000, v233
    v_fmac_f32 v244, v243, v4
    v_fmac_f32 v245, v243, v10
    s_waitcnt lgkmcnt(3)
    v_mfma_f32_16x16x32_bf16 v[36:39], v[84:87], v[188:191], v[36:39]
    v_exp_f32 v166, v166
    v_exp_f32 v167, v167
    v_mfma_f32_16x16x32_bf16 v[40:43], v[84:87], v[192:195], v[40:43]
    ds_read_b128 v[100:103], v3 offset:14336
    v_add_f32 v15, v15, v166
    v_fmac_f32 v246, v243, v5
    v_fmac_f32 v247, v243, v12
    v_lshlrev_b32 v4, 16, v234
    v_and_b32 v10, 0xffff0000, v234
    v_lshlrev_b32 v5, 16, v235
    v_and_b32 v12, 0xffff0000, v235
    v_fmac_f32 v248, v243, v4
    s_mov_b64 s[20:21], s[40:41]
    s_mov_b32 s22, 0x800000
    s_mov_b32 s23, 0x20000
    s_mov_b32 s26, 0x6000
    buffer_load_dword v18, v17, s[20:23], s26 offen
    s_waitcnt lgkmcnt(3)
    v_mfma_f32_16x16x32_bf16 v[44:47], v[88:91], v[188:191], v[44:47]
    v_add_f32 v15, v15, v167
    v_mfma_f32_16x16x32_bf16 v[48:51], v[88:91], v[192:195], v[48:51]
    ds_read_b128 v[104:107], v3 offset:15360
    v_cvt_pk_bf16_f32 v199, v166, v167
    v_fmac_f32 v249, v243, v10
    v_fmac_f32 v250, v243, v5
    v_fmac_f32 v251, v243, v12
    v_permlane32_swap_b32 v244, v248
    v_permlane32_swap_b32 v245, v249
    v_permlane32_swap_b32 v246, v250
    v_permlane32_swap_b32 v247, v251
    s_waitcnt lgkmcnt(3)
    v_mfma_f32_16x16x32_bf16 v[52:55], v[92:95], v[188:191], v[52:55]
    v_exp_f32 v168, v168
    v_exp_f32 v169, v169
    v_mfma_f32_16x16x32_bf16 v[56:59], v[92:95], v[192:195], v[56:59]
    s_barrier
    ds_read_b128 v[84:87], v2 offset:16384
    v_add_f32 v16, v16, v168
    v_add_f32 v244, v244, v248
    v_add_f32 v245, v245, v249
    v_add_f32 v246, v246, v250
    v_add_f32 v247, v247, v251
    s_nop 0
    v_permlane16_swap_b32 v244, v246
    v_permlane16_swap_b32 v245, v247
    v_add_f32 v244, v244, v246
    s_waitcnt lgkmcnt(3)
    v_mfma_f32_16x16x32_bf16 v[60:63], v[96:99], v[188:191], v[60:63]
    v_add_f32 v16, v16, v169
    v_mfma_f32_16x16x32_bf16 v[64:67], v[96:99], v[192:195], v[64:67]
    ds_read_b128 v[88:91], v2 offset:17408
    v_cvt_pk_bf16_f32 v202, v168, v169
    v_add_f32 v245, v245, v247
    v_add_f32_dpp v244, v244, v244 row_ror:8 row_mask:0xf bank_mask:0xf
    s_nop 0
    v_add_f32_dpp v245, v245, v245 row_ror:8 row_mask:0xf bank_mask:0xf
    v_add_f32_dpp v244, v244, v244 row_ror:4 row_mask:0xf bank_mask:0xf
    s_nop 0
    v_add_f32_dpp v245, v245, v245 row_ror:4 row_mask:0xf bank_mask:0xf
    v_add_f32_dpp v244, v244, v244 row_ror:2 row_mask:0xf bank_mask:0xf
    s_nop 0
    v_add_f32_dpp v245, v245, v245 row_ror:2 row_mask:0xf bank_mask:0xf
    s_waitcnt lgkmcnt(3)
    v_mfma_f32_16x16x32_bf16 v[68:71], v[100:103], v[188:191], v[68:71]
    v_exp_f32 v170, v170
    v_exp_f32 v171, v171
    v_mfma_f32_16x16x32_bf16 v[72:75], v[100:103], v[192:195], v[72:75]
    ds_read_b128 v[92:95], v2 offset:18432
    v_add_f32 v16, v16, v170
    v_lshrrev_b32 v13, 6, v8
    v_lshlrev_b32 v13, 6, v13
    v_lshl_add_u32 v13, v14, 5, v13
    v_bfe_u32 v14, v8, 4, 2
    v_lshl_add_u32 v13, v14, 3, v13
    ds_write_b64 v13, v[244:245] offset:49152
    s_mov_b64 s[20:21], s[40:41]
    s_mov_b32 s22, 0x800000
    s_mov_b32 s23, 0x20000
    s_mov_b32 s26, 0x7000
    buffer_load_dword v18, v17, s[20:23], s26 offen
    s_waitcnt lgkmcnt(4)
    v_mfma_f32_16x16x32_bf16 v[76:79], v[104:107], v[188:191], v[76:79]
    v_add_f32 v16, v16, v171
    v_mfma_f32_16x16x32_bf16 v[80:83], v[104:107], v[192:195], v[80:83]
    ds_read_b128 v[96:99], v2 offset:19456
    v_cvt_pk_bf16_f32 v203, v170, v171
    s_waitcnt lgkmcnt(4)
    v_mfma_f32_16x16x32_bf16 v[156:159], v[84:87], v[108:111], v[172:175]
    v_exp_f32 v140, v140
    v_exp_f32 v141, v141
    v_mfma_f32_16x16x32_bf16 v[160:163], v[84:87], v[124:127], v[176:179]
    ds_read_b128 v[100:103], v2 offset:20480
    v_add_f32 v15, v15, v140
    s_waitcnt lgkmcnt(4)
    v_mfma_f32_16x16x32_bf16 v[164:167], v[88:91], v[108:111], v[172:175]
    v_add_f32 v15, v15, v141
    v_mfma_f32_16x16x32_bf16 v[168:171], v[88:91], v[124:127], v[176:179]
    ds_read_b128 v[104:107], v2 offset:21504
    v_cvt_pk_bf16_f32 v188, v140, v141
    s_mov_b64 s[20:21], s[40:41]
    s_mov_b32 s22, 0x800000
    s_mov_b32 s23, 0x20000
    s_mov_b32 s26, 0x8000
    buffer_load_dword v18, v17, s[20:23], s26 offen
    s_waitcnt lgkmcnt(4)
    v_mfma_f32_16x16x32_bf16 v[156:159], v[92:95], v[112:115], v[156:159]
    v_exp_f32 v142, v142
    v_exp_f32 v143, v143
    v_mfma_f32_16x16x32_bf16 v[160:163], v[92:95], v[128:131], v[160:163]
    ds_read_b128 v[84:87], v2 offset:22528
    v_add_f32 v15, v15, v142
    s_waitcnt lgkmcnt(3)
    v_mfma_f32_16x16x32_bf16 v[164:167], v[96:99], v[112:115], v[164:167]
    v_add_f32 v15, v15, v143
    v_mfma_f32_16x16x32_bf16 v[168:171], v[96:99], v[128:131], v[168:171]
    ds_read_b128 v[88:91], v2 offset:23552
    v_cvt_pk_bf16_f32 v189, v142, v143
    s_waitcnt lgkmcnt(0)
    v_mfma_f32_16x16x32_bf16 v[156:159], v[100:103], v[116:119], v[156:159]
    v_exp_f32 v144, v144
    v_exp_f32 v145, v145
    v_mfma_f32_16x16x32_bf16 v[160:163], v[100:103], v[132:135], v[160:163]
    ds_read_b128 v[92:95], v3 offset:24576
    v_add_f32 v16, v16, v144
    s_mov_b64 s[20:21], s[40:41]
    s_mov_b32 s22, 0x800000
    s_mov_b32 s23, 0x20000
    s_mov_b32 s26, 0x9000
    buffer_load_dword v18, v17, s[20:23], s26 offen
    v_mfma_f32_16x16x32_bf16 v[164:167], v[104:107], v[116:119], v[164:167]
    v_add_f32 v16, v16, v145
    v_mfma_f32_16x16x32_bf16 v[168:171], v[104:107], v[132:135], v[168:171]
    ds_read_b128 v[96:99], v3 offset:25600
    v_cvt_pk_bf16_f32 v192, v144, v145
    v_mfma_f32_16x16x32_bf16 v[156:159], v[84:87], v[120:123], v[156:159]
    v_exp_f32 v146, v146
    v_exp_f32 v147, v147
    v_mfma_f32_16x16x32_bf16 v[160:163], v[84:87], v[136:139], v[160:163]
    ds_read_b128 v[100:103], v3 offset:26624
    v_add_f32 v16, v16, v146
    v_mfma_f32_16x16x32_bf16 v[164:167], v[88:91], v[120:123], v[164:167]
    v_add_f32 v16, v16, v147
    v_mfma_f32_16x16x32_bf16 v[168:171], v[88:91], v[136:139], v[168:171]
    ds_read_b128 v[104:107], v3 offset:27648
    v_cvt_pk_bf16_f32 v193, v146, v147
    s_waitcnt lgkmcnt(3)
    v_mfma_f32_16x16x32_bf16 v[20:23], v[92:95], v[196:199], v[20:23]
    v_exp_f32 v148, v148
    v_exp_f32 v149, v149
    v_mfma_f32_16x16x32_bf16 v[24:27], v[92:95], v[200:203], v[24:27]
    ds_read_b128 v[84:87], v3 offset:28672
    v_add_f32 v15, v15, v148
    s_mov_b64 s[20:21], s[40:41]
    s_mov_b32 s22, 0x800000
    s_mov_b32 s23, 0x20000
    s_mov_b32 s26, 0xa000
    buffer_load_dword v18, v17, s[20:23], s26 offen
    s_waitcnt lgkmcnt(3)
    v_mfma_f32_16x16x32_bf16 v[28:31], v[96:99], v[196:199], v[28:31]
    v_add_f32 v15, v15, v149
    v_mfma_f32_16x16x32_bf16 v[32:35], v[96:99], v[200:203], v[32:35]
    ds_read_b128 v[88:91], v3 offset:29696
    v_cvt_pk_bf16_f32 v190, v148, v149
    s_waitcnt lgkmcnt(3)
    v_mfma_f32_16x16x32_bf16 v[36:39], v[100:103], v[196:199], v[36:39]
    v_exp_f32 v150, v150
    v_exp_f32 v151, v151
    v_mfma_f32_16x16x32_bf16 v[40:43], v[100:103], v[200:203], v[40:43]
    ds_read_b128 v[92:95], v3 offset:30720
    v_add_f32 v15, v15, v150
    s_waitcnt lgkmcnt(3)
    v_mfma_f32_16x16x32_bf16 v[44:47], v[104:107], v[196:199], v[44:47]
    v_add_f32 v15, v15, v151
    v_mfma_f32_16x16x32_bf16 v[48:51], v[104:107], v[200:203], v[48:51]
    ds_read_b128 v[96:99], v3 offset:31744
    v_cvt_pk_bf16_f32 v191, v150, v151
    s_mov_b64 s[20:21], s[40:41]
    s_mov_b32 s22, 0x800000
    s_mov_b32 s23, 0x20000
    s_mov_b32 s26, 0xb000
    buffer_load_dword v18, v17, s[20:23], s26 offen
    s_waitcnt lgkmcnt(3)
    v_mfma_f32_16x16x32_bf16 v[52:55], v[84:87], v[196:199], v[52:55]
    v_exp_f32 v152, v152
    v_exp_f32 v153, v153
    v_mfma_f32_16x16x32_bf16 v[56:59], v[84:87], v[200:203], v[56:59]
    s_barrier
    ds_read_b128 v[100:103], v2 offset:32768
    v_add_f32 v16, v16, v152
    s_waitcnt lgkmcnt(3)
    v_mfma_f32_16x16x32_bf16 v[60:63], v[88:91], v[196:199], v[60:63]
    v_add_f32 v16, v16, v153
    v_mfma_f32_16x16x32_bf16 v[64:67], v[88:91], v[200:203], v[64:67]
    ds_read_b128 v[104:107], v2 offset:33792
    v_cvt_pk_bf16_f32 v194, v152, v153
    s_waitcnt lgkmcnt(3)
    v_mfma_f32_16x16x32_bf16 v[68:71], v[92:95], v[196:199], v[68:71]
    v_exp_f32 v154, v154
    v_exp_f32 v155, v155
    v_mfma_f32_16x16x32_bf16 v[72:75], v[92:95], v[200:203], v[72:75]
    ds_read_b128 v[84:87], v2 offset:34816
    v_add_f32 v16, v16, v154
    s_waitcnt lgkmcnt(3)
    v_mfma_f32_16x16x32_bf16 v[76:79], v[96:99], v[196:199], v[76:79]
    v_add_f32 v16, v16, v155
    v_mfma_f32_16x16x32_bf16 v[80:83], v[96:99], v[200:203], v[80:83]
    ds_read_b128 v[88:91], v2 offset:35840
    v_cvt_pk_bf16_f32 v195, v154, v155
    s_mov_b64 s[20:21], s[40:41]
    s_mov_b32 s22, 0x800000
    s_mov_b32 s23, 0x20000
    s_mov_b32 s26, 0xc000
    buffer_load_dword v18, v17, s[20:23], s26 offen
    s_waitcnt lgkmcnt(3)
    v_mfma_f32_16x16x32_bf16 v[140:143], v[100:103], v[108:111], v[172:175]
    v_exp_f32 v156, v156
    v_exp_f32 v157, v157
    v_mfma_f32_16x16x32_bf16 v[144:147], v[100:103], v[124:127], v[176:179]
    ds_read_b128 v[92:95], v2 offset:36864
    v_add_f32 v15, v15, v156
    s_waitcnt lgkmcnt(3)
    v_mfma_f32_16x16x32_bf16 v[148:151], v[104:107], v[108:111], v[172:175]
    v_add_f32 v15, v15, v157
    v_mfma_f32_16x16x32_bf16 v[152:155], v[104:107], v[124:127], v[176:179]
    ds_read_b128 v[96:99], v2 offset:37888
    v_cvt_pk_bf16_f32 v196, v156, v157
    s_waitcnt lgkmcnt(3)
    v_mfma_f32_16x16x32_bf16 v[140:143], v[84:87], v[112:115], v[140:143]
    v_exp_f32 v158, v158
    v_exp_f32 v159, v159
    v_mfma_f32_16x16x32_bf16 v[144:147], v[84:87], v[128:131], v[144:147]
    ds_read_b128 v[100:103], v2 offset:38912
    v_add_f32 v15, v15, v158
    v_and_b32 v13, 15, v0
    v_lshlrev_b32 v13, 2, v13
    ds_read_b32 v244, v13 offset:49152
    ds_read_b32 v245, v13 offset:49216
    ds_read_b32 v246, v13 offset:49280
    ds_read_b32 v247, v13 offset:49344
    s_mov_b64 s[20:21], s[40:41]
    s_mov_b32 s22, 0x800000
    s_mov_b32 s23, 0x20000
    s_mov_b32 s26, 0xd000
    buffer_load_dword v18, v17, s[20:23], s26 offen
    s_waitcnt lgkmcnt(7)
    v_mfma_f32_16x16x32_bf16 v[148:151], v[88:91], v[112:115], v[148:151]
    v_add_f32 v15, v15, v159
    v_mfma_f32_16x16x32_bf16 v[152:155], v[88:91], v[128:131], v[152:155]
    ds_read_b128 v[104:107], v2 offset:39936
    v_cvt_pk_bf16_f32 v197, v158, v159
    s_waitcnt lgkmcnt(7)
    v_mfma_f32_16x16x32_bf16 v[140:143], v[92:95], v[116:119], v[140:143]
    v_exp_f32 v160, v160
    v_exp_f32 v161, v161
    v_mfma_f32_16x16x32_bf16 v[144:147], v[92:95], v[132:135], v[144:147]
    ds_read_b128 v[84:87], v2 offset:8192
    v_add_f32 v16, v16, v160
    s_waitcnt lgkmcnt(7)
    v_mfma_f32_16x16x32_bf16 v[148:151], v[96:99], v[116:119], v[148:151]
    v_add_f32 v16, v16, v161
    v_mfma_f32_16x16x32_bf16 v[152:155], v[96:99], v[132:135], v[152:155]
    ds_read_b128 v[88:91], v2 offset:9216
    v_cvt_pk_bf16_f32 v200, v160, v161
    s_waitcnt lgkmcnt(7)
    v_mfma_f32_16x16x32_bf16 v[140:143], v[100:103], v[120:123], v[140:143]
    v_exp_f32 v162, v162
    v_exp_f32 v163, v163
    v_mfma_f32_16x16x32_bf16 v[144:147], v[100:103], v[136:139], v[144:147]
    ds_read_b128 v[92:95], v2 offset:10240
    v_add_f32 v16, v16, v162
    s_mov_b64 s[20:21], s[40:41]
    s_mov_b32 s22, 0x800000
    s_mov_b32 s23, 0x20000
    s_mov_b32 s26, 0xe000
    buffer_load_dword v18, v17, s[20:23], s26 offen
    s_waitcnt lgkmcnt(3)
    v_mfma_f32_16x16x32_bf16 v[148:151], v[104:107], v[120:123], v[148:151]
    v_add_f32 v16, v16, v163
    v_mfma_f32_16x16x32_bf16 v[152:155], v[104:107], v[136:139], v[152:155]
    ds_read_b128 v[96:99], v2 offset:11264
    v_cvt_pk_bf16_f32 v201, v162, v163
    s_waitcnt lgkmcnt(3)
    v_mfma_f32_16x16x32_bf16 v[20:23], v[84:87], v[188:191], v[20:23]
    v_exp_f32 v164, v164
    v_exp_f32 v165, v165
    v_mfma_f32_16x16x32_bf16 v[24:27], v[84:87], v[192:195], v[24:27]
    ds_read_b128 v[100:103], v2 offset:12288
    v_add_f32 v15, v15, v164
    v_add_f32 v244, v244, v246
    v_add_f32 v245, v245, v247
    v_add_f32 v244, v244, v245
    v_cvt_pk_bf16_f32 v244, v244, v244
    v_lshlrev_b32 v244, 16, v244
    s_lshr_b32 s26, s100, 6
    s_cmp_eq_u32 s26, 2
    s_cselect_b32 s26, 1.0, 0
    v_add_f32 v244, s26, v244
    v_cvt_pk_bf16_f32 v244, v244, v244
    v_lshlrev_b32 v244, 16, v244
    v_or_b32 v244, 1, v244
    s_lshl_b32 s26, s100, 6
    s_add_u32 s26, s26, 0xa20000
    s_cmp_eq_u32 s3, 4
    s_cselect_b32 s26, s26, 0x7ffffff0
    s_mov_b64 exec, 0xffff
    buffer_store_dword v244, v13, s[8:11], s26 offen sc1
    s_mov_b64 exec, -1
    s_nop 3
    s_waitcnt lgkmcnt(3)
    v_mfma_f32_16x16x32_bf16 v[28:31], v[88:91], v[188:191], v[28:31]
    v_add_f32 v15, v15, v165
    v_mfma_f32_16x16x32_bf16 v[32:35], v[88:91], v[192:195], v[32:35]
    ds_read_b128 v[104:107], v2 offset:13312
    v_cvt_pk_bf16_f32 v198, v164, v165
    s_mov_b64 s[20:21], s[40:41]
    s_mov_b32 s22, 0x800000
    s_mov_b32 s23, 0x20000
    s_mov_b32 s26, 0xf000
    buffer_load_dword v18, v17, s[20:23], s26 offen
    s_waitcnt lgkmcnt(3)
    v_mfma_f32_16x16x32_bf16 v[36:39], v[92:95], v[188:191], v[36:39]
    v_exp_f32 v166, v166
    v_exp_f32 v167, v167
    v_mfma_f32_16x16x32_bf16 v[40:43], v[92:95], v[192:195], v[40:43]
    ds_read_b128 v[84:87], v2 offset:14336
    v_add_f32 v15, v15, v166
    s_waitcnt lgkmcnt(3)
    v_mfma_f32_16x16x32_bf16 v[44:47], v[96:99], v[188:191], v[44:47]
    v_add_f32 v15, v15, v167
    v_mfma_f32_16x16x32_bf16 v[48:51], v[96:99], v[192:195], v[48:51]
    ds_read_b128 v[88:91], v2 offset:15360
    v_cvt_pk_bf16_f32 v199, v166, v167
    v_lshrrev_b32 v6, 3, v8
    v_and_b32 v7, 7, v8
    s_bfe_u32 s25, s2, 0x10002
    s_mul_i32 s25, s25, 28
    s_lshr_b32 s26, s2, 3
    s_add_u32 s25, s25, s26
    s_lshl_b32 s25, s25, 7
    s_bfe_u32 s24, s2, 0x10001
    s_mul_i32 s24, s24, 3670016
    s_add_u32 s24, s24, s25
    s_mov_b32 s26, 114688
    v_mul_lo_u32 v19, s26, v6
    v_lshl_add_u32 v19, v7, 4, v19
    s_bitcmp0_b32 s2, 0
    s_cselect_b32 s64, s46, s48
    s_cselect_b32 s65, s47, s49
    s_cmp_lt_u32 s2, 224
    s_cselect_b32 s66, 0x700000, 0
    s_mov_b32 s67, 0x20000
    s_waitcnt lgkmcnt(3)
    v_mfma_f32_16x16x32_bf16 v[52:55], v[100:103], v[188:191], v[52:55]
    v_exp_f32 v168, v168
    v_exp_f32 v169, v169
    v_mfma_f32_16x16x32_bf16 v[56:59], v[100:103], v[192:195], v[56:59]
    s_barrier
    ds_read_b128 v[92:95], v2 offset:49152
    v_add_f32 v16, v16, v168
    s_add_u32 s25, s24, 0
    buffer_load_dwordx4 v[204:207], v19, s[64:67], s25 offen
    s_waitcnt lgkmcnt(3)
    v_mfma_f32_16x16x32_bf16 v[60:63], v[104:107], v[188:191], v[60:63]
    v_add_f32 v16, v16, v169
    v_mfma_f32_16x16x32_bf16 v[64:67], v[104:107], v[192:195], v[64:67]
    ds_read_b128 v[96:99], v2 offset:50176
    v_cvt_pk_bf16_f32 v202, v168, v169
    s_waitcnt lgkmcnt(3)
    v_mfma_f32_16x16x32_bf16 v[68:71], v[84:87], v[188:191], v[68:71]
    v_exp_f32 v170, v170
    v_exp_f32 v171, v171
    v_mfma_f32_16x16x32_bf16 v[72:75], v[84:87], v[192:195], v[72:75]
    ds_read_b128 v[100:103], v2 offset:51200
    v_add_f32 v16, v16, v170
    s_waitcnt lgkmcnt(3)
    v_mfma_f32_16x16x32_bf16 v[76:79], v[88:91], v[188:191], v[76:79]
    v_add_f32 v16, v16, v171
    v_mfma_f32_16x16x32_bf16 v[80:83], v[88:91], v[192:195], v[80:83]
    ds_read_b128 v[104:107], v2 offset:52224
    v_cvt_pk_bf16_f32 v203, v170, v171
    s_waitcnt lgkmcnt(3)
    v_mfma_f32_16x16x32_bf16 v[156:159], v[92:95], v[108:111], v[172:175]
    v_exp_f32 v140, v140
    v_exp_f32 v141, v141
    v_mfma_f32_16x16x32_bf16 v[160:163], v[92:95], v[124:127], v[176:179]
    ds_read_b128 v[84:87], v2 offset:53248
    v_add_f32 v15, v15, v140
    s_add_u32 s25, s24, 7168
    buffer_load_dwordx4 v[208:211], v19, s[64:67], s25 offen
    s_waitcnt lgkmcnt(3)
    v_mfma_f32_16x16x32_bf16 v[164:167], v[96:99], v[108:111], v[172:175]
    v_add_f32 v15, v15, v141
    v_mfma_f32_16x16x32_bf16 v[168:171], v[96:99], v[124:127], v[176:179]
    ds_read_b128 v[88:91], v2 offset:54272
    v_cvt_pk_bf16_f32 v188, v140, v141
    s_waitcnt lgkmcnt(3)
    v_mfma_f32_16x16x32_bf16 v[156:159], v[100:103], v[112:115], v[156:159]
    v_exp_f32 v142, v142
    v_exp_f32 v143, v143
    v_mfma_f32_16x16x32_bf16 v[160:163], v[100:103], v[128:131], v[160:163]
    ds_read_b128 v[92:95], v2 offset:55296
    v_add_f32 v15, v15, v142
    s_waitcnt lgkmcnt(3)
    v_mfma_f32_16x16x32_bf16 v[164:167], v[104:107], v[112:115], v[164:167]
    v_add_f32 v15, v15, v143
    v_mfma_f32_16x16x32_bf16 v[168:171], v[104:107], v[128:131], v[168:171]
    ds_read_b128 v[96:99], v2 offset:56320
    v_cvt_pk_bf16_f32 v189, v142, v143
    s_waitcnt lgkmcnt(3)
    v_mfma_f32_16x16x32_bf16 v[156:159], v[84:87], v[116:119], v[156:159]
    v_exp_f32 v144, v144
    v_exp_f32 v145, v145
    v_mfma_f32_16x16x32_bf16 v[160:163], v[84:87], v[132:135], v[160:163]
    ds_read_b128 v[100:103], v2 offset:24576
    v_add_f32 v16, v16, v144
    s_add_u32 s25, s24, 14336
    buffer_load_dwordx4 v[212:215], v19, s[64:67], s25 offen
    s_waitcnt lgkmcnt(3)
    v_mfma_f32_16x16x32_bf16 v[164:167], v[88:91], v[116:119], v[164:167]
    v_add_f32 v16, v16, v145
    v_mfma_f32_16x16x32_bf16 v[168:171], v[88:91], v[132:135], v[168:171]
    ds_read_b128 v[104:107], v2 offset:25600
    v_cvt_pk_bf16_f32 v192, v144, v145
    s_waitcnt lgkmcnt(3)
    v_mfma_f32_16x16x32_bf16 v[156:159], v[92:95], v[120:123], v[156:159]
    v_exp_f32 v146, v146
    v_exp_f32 v147, v147
    v_mfma_f32_16x16x32_bf16 v[160:163], v[92:95], v[136:139], v[160:163]
    ds_read_b128 v[84:87], v2 offset:26624
    v_add_f32 v16, v16, v146
    s_waitcnt lgkmcnt(3)
    v_mfma_f32_16x16x32_bf16 v[164:167], v[96:99], v[120:123], v[164:167]
    v_add_f32 v16, v16, v147
    v_mfma_f32_16x16x32_bf16 v[168:171], v[96:99], v[136:139], v[168:171]
    ds_read_b128 v[88:91], v2 offset:27648
    v_cvt_pk_bf16_f32 v193, v146, v147
    s_waitcnt lgkmcnt(3)
    v_mfma_f32_16x16x32_bf16 v[20:23], v[100:103], v[196:199], v[20:23]
    v_exp_f32 v148, v148
    v_exp_f32 v149, v149
    v_mfma_f32_16x16x32_bf16 v[24:27], v[100:103], v[200:203], v[24:27]
    ds_read_b128 v[92:95], v2 offset:28672
    v_add_f32 v15, v15, v148
    s_waitcnt lgkmcnt(3)
    v_mfma_f32_16x16x32_bf16 v[28:31], v[104:107], v[196:199], v[28:31]
    v_add_f32 v15, v15, v149
    v_mfma_f32_16x16x32_bf16 v[32:35], v[104:107], v[200:203], v[32:35]
    ds_read_b128 v[96:99], v2 offset:29696
    v_cvt_pk_bf16_f32 v190, v148, v149
    s_add_u32 s25, s24, 21504
    buffer_load_dwordx4 v[216:219], v19, s[64:67], s25 offen
    s_waitcnt lgkmcnt(3)
    v_mfma_f32_16x16x32_bf16 v[36:39], v[84:87], v[196:199], v[36:39]
    v_exp_f32 v150, v150
    v_exp_f32 v151, v151
    v_mfma_f32_16x16x32_bf16 v[40:43], v[84:87], v[200:203], v[40:43]
    ds_read_b128 v[100:103], v2 offset:30720
    v_add_f32 v15, v15, v150
    s_waitcnt lgkmcnt(3)
    v_mfma_f32_16x16x32_bf16 v[44:47], v[88:91], v[196:199], v[44:47]
    v_add_f32 v15, v15, v151
    v_mfma_f32_16x16x32_bf16 v[48:51], v[88:91], v[200:203], v[48:51]
    ds_read_b128 v[104:107], v2 offset:31744
    v_cvt_pk_bf16_f32 v191, v150, v151
    s_waitcnt lgkmcnt(3)
    v_mfma_f32_16x16x32_bf16 v[52:55], v[92:95], v[196:199], v[52:55]
    v_exp_f32 v152, v152
    v_exp_f32 v153, v153
    v_mfma_f32_16x16x32_bf16 v[56:59], v[92:95], v[200:203], v[56:59]
    s_barrier
    ds_read_b128 v[84:87], v3 offset:0
    v_add_f32 v16, v16, v152
    s_waitcnt lgkmcnt(3)
    v_mfma_f32_16x16x32_bf16 v[60:63], v[96:99], v[196:199], v[60:63]
    v_add_f32 v16, v16, v153
    v_mfma_f32_16x16x32_bf16 v[64:67], v[96:99], v[200:203], v[64:67]
    ds_read_b128 v[88:91], v3 offset:1024
    v_cvt_pk_bf16_f32 v194, v152, v153
    s_add_u32 s25, s24, 28672
    buffer_load_dwordx4 v[220:223], v19, s[64:67], s25 offen
    s_waitcnt lgkmcnt(3)
    v_mfma_f32_16x16x32_bf16 v[68:71], v[100:103], v[196:199], v[68:71]
    v_exp_f32 v154, v154
    v_exp_f32 v155, v155
    v_mfma_f32_16x16x32_bf16 v[72:75], v[100:103], v[200:203], v[72:75]
    ds_read_b128 v[92:95], v3 offset:2048
    v_add_f32 v16, v16, v154
    s_waitcnt lgkmcnt(3)
    v_mfma_f32_16x16x32_bf16 v[76:79], v[104:107], v[196:199], v[76:79]
    v_add_f32 v16, v16, v155
    v_mfma_f32_16x16x32_bf16 v[80:83], v[104:107], v[200:203], v[80:83]
    ds_read_b128 v[96:99], v3 offset:3072
    v_cvt_pk_bf16_f32 v195, v154, v155
    s_waitcnt lgkmcnt(3)
    v_mfma_f32_16x16x32_bf16 v[140:143], v[84:87], v[108:111], v[172:175]
    v_exp_f32 v156, v156
    v_exp_f32 v157, v157
    v_mfma_f32_16x16x32_bf16 v[144:147], v[84:87], v[124:127], v[176:179]
    ds_read_b128 v[100:103], v3 offset:4096
    v_add_f32 v15, v15, v156
    s_waitcnt lgkmcnt(3)
    v_mfma_f32_16x16x32_bf16 v[148:151], v[88:91], v[108:111], v[172:175]
    v_add_f32 v15, v15, v157
    v_mfma_f32_16x16x32_bf16 v[152:155], v[88:91], v[124:127], v[176:179]
    ds_read_b128 v[104:107], v3 offset:5120
    v_cvt_pk_bf16_f32 v196, v156, v157
    s_waitcnt lgkmcnt(3)
    v_mfma_f32_16x16x32_bf16 v[140:143], v[92:95], v[112:115], v[140:143]
    v_exp_f32 v158, v158
    v_exp_f32 v159, v159
    v_mfma_f32_16x16x32_bf16 v[144:147], v[92:95], v[128:131], v[144:147]
    ds_read_b128 v[84:87], v3 offset:6144
    v_add_f32 v15, v15, v158
    s_add_u32 s25, s24, 35840
    buffer_load_dwordx4 v[224:227], v19, s[64:67], s25 offen
    s_waitcnt lgkmcnt(3)
    v_mfma_f32_16x16x32_bf16 v[148:151], v[96:99], v[112:115], v[148:151]
    v_add_f32 v15, v15, v159
    v_mfma_f32_16x16x32_bf16 v[152:155], v[96:99], v[128:131], v[152:155]
    ds_read_b128 v[88:91], v3 offset:7168
    v_cvt_pk_bf16_f32 v197, v158, v159
    s_waitcnt lgkmcnt(3)
    v_mfma_f32_16x16x32_bf16 v[140:143], v[100:103], v[116:119], v[140:143]
    v_exp_f32 v160, v160
    v_exp_f32 v161, v161
    v_mfma_f32_16x16x32_bf16 v[144:147], v[100:103], v[132:135], v[144:147]
    ds_read_b128 v[92:95], v2 offset:40960
    v_add_f32 v16, v16, v160
    s_waitcnt lgkmcnt(3)
    v_mfma_f32_16x16x32_bf16 v[148:151], v[104:107], v[116:119], v[148:151]
    v_add_f32 v16, v16, v161
    v_mfma_f32_16x16x32_bf16 v[152:155], v[104:107], v[132:135], v[152:155]
    ds_read_b128 v[96:99], v2 offset:41984
    v_cvt_pk_bf16_f32 v200, v160, v161
    s_waitcnt lgkmcnt(3)
    v_mfma_f32_16x16x32_bf16 v[140:143], v[84:87], v[120:123], v[140:143]
    v_exp_f32 v162, v162
    v_exp_f32 v163, v163
    v_mfma_f32_16x16x32_bf16 v[144:147], v[84:87], v[136:139], v[144:147]
    ds_read_b128 v[100:103], v2 offset:43008
    v_add_f32 v16, v16, v162
    s_add_u32 s25, s24, 43008
    buffer_load_dwordx4 v[228:231], v19, s[64:67], s25 offen
    s_waitcnt lgkmcnt(3)
    v_mfma_f32_16x16x32_bf16 v[148:151], v[88:91], v[120:123], v[148:151]
    v_add_f32 v16, v16, v163
    v_mfma_f32_16x16x32_bf16 v[152:155], v[88:91], v[136:139], v[152:155]
    ds_read_b128 v[104:107], v2 offset:44032
    v_cvt_pk_bf16_f32 v201, v162, v163
    s_waitcnt lgkmcnt(3)
    v_mfma_f32_16x16x32_bf16 v[20:23], v[92:95], v[188:191], v[20:23]
    v_exp_f32 v164, v164
    v_exp_f32 v165, v165
    v_mfma_f32_16x16x32_bf16 v[24:27], v[92:95], v[192:195], v[24:27]
    ds_read_b128 v[84:87], v2 offset:45056
    v_add_f32 v15, v15, v164
    s_waitcnt lgkmcnt(3)
    v_mfma_f32_16x16x32_bf16 v[28:31], v[96:99], v[188:191], v[28:31]
    v_add_f32 v15, v15, v165
    v_mfma_f32_16x16x32_bf16 v[32:35], v[96:99], v[192:195], v[32:35]
    ds_read_b128 v[88:91], v2 offset:46080
    v_cvt_pk_bf16_f32 v198, v164, v165
    s_waitcnt lgkmcnt(3)
    v_mfma_f32_16x16x32_bf16 v[36:39], v[100:103], v[188:191], v[36:39]
    v_exp_f32 v166, v166
    v_exp_f32 v167, v167
    v_mfma_f32_16x16x32_bf16 v[40:43], v[100:103], v[192:195], v[40:43]
    ds_read_b128 v[92:95], v2 offset:47104
    v_add_f32 v15, v15, v166
    s_add_u32 s25, s24, 50176
    buffer_load_dwordx4 v[232:235], v19, s[64:67], s25 offen
    s_waitcnt lgkmcnt(3)
    v_mfma_f32_16x16x32_bf16 v[44:47], v[104:107], v[188:191], v[44:47]
    v_add_f32 v15, v15, v167
    v_mfma_f32_16x16x32_bf16 v[48:51], v[104:107], v[192:195], v[48:51]
    ds_read_b128 v[96:99], v2 offset:48128
    v_cvt_pk_bf16_f32 v199, v166, v167
    s_waitcnt lgkmcnt(3)
    v_mfma_f32_16x16x32_bf16 v[52:55], v[84:87], v[188:191], v[52:55]
    v_exp_f32 v168, v168
    v_exp_f32 v169, v169
    v_mfma_f32_16x16x32_bf16 v[56:59], v[84:87], v[192:195], v[56:59]
    s_barrier
    ds_read_b128 v[100:103], v3 offset:16384
    v_add_f32 v16, v16, v168
    s_waitcnt lgkmcnt(3)
    v_mfma_f32_16x16x32_bf16 v[60:63], v[88:91], v[188:191], v[60:63]
    v_add_f32 v16, v16, v169
    v_mfma_f32_16x16x32_bf16 v[64:67], v[88:91], v[192:195], v[64:67]
    ds_read_b128 v[104:107], v3 offset:17408
    v_cvt_pk_bf16_f32 v202, v168, v169
    s_waitcnt lgkmcnt(3)
    v_mfma_f32_16x16x32_bf16 v[68:71], v[92:95], v[188:191], v[68:71]
    v_exp_f32 v170, v170
    v_exp_f32 v171, v171
    v_mfma_f32_16x16x32_bf16 v[72:75], v[92:95], v[192:195], v[72:75]
    ds_read_b128 v[84:87], v3 offset:18432
    v_add_f32 v16, v16, v170
    s_waitcnt lgkmcnt(3)
    v_mfma_f32_16x16x32_bf16 v[76:79], v[96:99], v[188:191], v[76:79]
    v_add_f32 v16, v16, v171
    v_mfma_f32_16x16x32_bf16 v[80:83], v[96:99], v[192:195], v[80:83]
    ds_read_b128 v[88:91], v3 offset:19456
    v_cvt_pk_bf16_f32 v203, v170, v171
    s_add_u32 s25, s24, 57344
    buffer_load_dwordx4 v[236:239], v19, s[64:67], s25 offen
    s_waitcnt lgkmcnt(3)
    v_mfma_f32_16x16x32_bf16 v[156:159], v[100:103], v[108:111], v[172:175]
    v_exp_f32 v140, v140
    v_exp_f32 v141, v141
    v_mfma_f32_16x16x32_bf16 v[160:163], v[100:103], v[124:127], v[176:179]
    ds_read_b128 v[92:95], v3 offset:20480
    v_add_f32 v15, v15, v140
    s_waitcnt lgkmcnt(3)
    v_mfma_f32_16x16x32_bf16 v[164:167], v[104:107], v[108:111], v[172:175]
    v_add_f32 v15, v15, v141
    v_mfma_f32_16x16x32_bf16 v[168:171], v[104:107], v[124:127], v[176:179]
    ds_read_b128 v[96:99], v3 offset:21504
    v_cvt_pk_bf16_f32 v188, v140, v141
    s_waitcnt lgkmcnt(3)
    v_mfma_f32_16x16x32_bf16 v[156:159], v[84:87], v[112:115], v[156:159]
    v_exp_f32 v142, v142
    v_exp_f32 v143, v143
    v_mfma_f32_16x16x32_bf16 v[160:163], v[84:87], v[128:131], v[160:163]
    ds_read_b128 v[100:103], v3 offset:22528
    v_add_f32 v15, v15, v142
    s_waitcnt lgkmcnt(3)
    v_mfma_f32_16x16x32_bf16 v[164:167], v[88:91], v[112:115], v[164:167]
    v_add_f32 v15, v15, v143
    v_mfma_f32_16x16x32_bf16 v[168:171], v[88:91], v[128:131], v[168:171]
    ds_read_b128 v[104:107], v3 offset:23552
    v_cvt_pk_bf16_f32 v189, v142, v143
    s_add_u32 s25, s24, 64512
    buffer_load_dwordx4 v[240:243], v19, s[64:67], s25 offen
    s_waitcnt lgkmcnt(3)
    v_mfma_f32_16x16x32_bf16 v[156:159], v[92:95], v[116:119], v[156:159]
    v_exp_f32 v144, v144
    v_exp_f32 v145, v145
    v_mfma_f32_16x16x32_bf16 v[160:163], v[92:95], v[132:135], v[160:163]
    ds_read_b128 v[84:87], v2 offset:57344
    v_add_f32 v16, v16, v144
    s_waitcnt lgkmcnt(3)
    v_mfma_f32_16x16x32_bf16 v[164:167], v[96:99], v[116:119], v[164:167]
    v_add_f32 v16, v16, v145
    v_mfma_f32_16x16x32_bf16 v[168:171], v[96:99], v[132:135], v[168:171]
    ds_read_b128 v[88:91], v2 offset:58368
    v_cvt_pk_bf16_f32 v192, v144, v145
    s_waitcnt lgkmcnt(3)
    v_mfma_f32_16x16x32_bf16 v[156:159], v[100:103], v[120:123], v[156:159]
    v_exp_f32 v146, v146
    v_exp_f32 v147, v147
    v_mfma_f32_16x16x32_bf16 v[160:163], v[100:103], v[136:139], v[160:163]
    ds_read_b128 v[92:95], v2 offset:59392
    v_add_f32 v16, v16, v146
    s_waitcnt lgkmcnt(3)
    v_mfma_f32_16x16x32_bf16 v[164:167], v[104:107], v[120:123], v[164:167]
    v_add_f32 v16, v16, v147
    v_mfma_f32_16x16x32_bf16 v[168:171], v[104:107], v[136:139], v[168:171]
    ds_read_b128 v[96:99], v2 offset:60416
    v_cvt_pk_bf16_f32 v193, v146, v147
    s_waitcnt lgkmcnt(3)
    v_mfma_f32_16x16x32_bf16 v[20:23], v[84:87], v[196:199], v[20:23]
    v_exp_f32 v148, v148
    v_exp_f32 v149, v149
    v_mfma_f32_16x16x32_bf16 v[24:27], v[84:87], v[200:203], v[24:27]
    ds_read_b128 v[100:103], v2 offset:61440
    v_add_f32 v15, v15, v148
    s_add_u32 s25, s24, 71680
    buffer_load_dwordx4 v[244:247], v19, s[64:67], s25 offen
    s_waitcnt lgkmcnt(3)
    v_mfma_f32_16x16x32_bf16 v[28:31], v[88:91], v[196:199], v[28:31]
    v_add_f32 v15, v15, v149
    v_mfma_f32_16x16x32_bf16 v[32:35], v[88:91], v[200:203], v[32:35]
    ds_read_b128 v[104:107], v2 offset:62464
    v_cvt_pk_bf16_f32 v190, v148, v149
    s_waitcnt lgkmcnt(3)
    v_mfma_f32_16x16x32_bf16 v[36:39], v[92:95], v[196:199], v[36:39]
    v_exp_f32 v150, v150
    v_exp_f32 v151, v151
    v_mfma_f32_16x16x32_bf16 v[40:43], v[92:95], v[200:203], v[40:43]
    ds_read_b128 v[84:87], v2 offset:63488
    v_add_f32 v15, v15, v150
    s_waitcnt lgkmcnt(3)
    v_mfma_f32_16x16x32_bf16 v[44:47], v[96:99], v[196:199], v[44:47]
    v_add_f32 v15, v15, v151
    v_mfma_f32_16x16x32_bf16 v[48:51], v[96:99], v[200:203], v[48:51]
    ds_read_b128 v[88:91], v2 offset:64512
    v_cvt_pk_bf16_f32 v191, v150, v151
    s_waitcnt lgkmcnt(3)
    v_mfma_f32_16x16x32_bf16 v[52:55], v[100:103], v[196:199], v[52:55]
    v_exp_f32 v152, v152
    v_exp_f32 v153, v153
    v_mfma_f32_16x16x32_bf16 v[56:59], v[100:103], v[200:203], v[56:59]
    s_barrier
    ds_read_b128 v[92:95], v2 offset:0
    v_add_f32 v16, v16, v152
    s_add_u32 s25, s24, 78848
    buffer_load_dwordx4 v[248:251], v19, s[64:67], s25 offen
    s_waitcnt lgkmcnt(3)
    v_mfma_f32_16x16x32_bf16 v[60:63], v[104:107], v[196:199], v[60:63]
    v_add_f32 v16, v16, v153
    v_mfma_f32_16x16x32_bf16 v[64:67], v[104:107], v[200:203], v[64:67]
    ds_read_b128 v[96:99], v2 offset:1024
    v_cvt_pk_bf16_f32 v194, v152, v153
    s_waitcnt lgkmcnt(3)
    v_mfma_f32_16x16x32_bf16 v[68:71], v[84:87], v[196:199], v[68:71]
    v_exp_f32 v154, v154
    v_exp_f32 v155, v155
    v_mfma_f32_16x16x32_bf16 v[72:75], v[84:87], v[200:203], v[72:75]
    ds_read_b128 v[100:103], v2 offset:2048
    v_add_f32 v16, v16, v154
    s_waitcnt lgkmcnt(3)
    v_mfma_f32_16x16x32_bf16 v[76:79], v[88:91], v[196:199], v[76:79]
    v_add_f32 v16, v16, v155
    v_mfma_f32_16x16x32_bf16 v[80:83], v[88:91], v[200:203], v[80:83]
    ds_read_b128 v[104:107], v2 offset:3072
    v_cvt_pk_bf16_f32 v195, v154, v155
    s_waitcnt lgkmcnt(3)
    v_mfma_f32_16x16x32_bf16 v[140:143], v[92:95], v[108:111], v[172:175]
    v_exp_f32 v156, v156
    v_exp_f32 v157, v157
    v_mfma_f32_16x16x32_bf16 v[144:147], v[92:95], v[124:127], v[176:179]
    ds_read_b128 v[84:87], v2 offset:4096
    v_add_f32 v15, v15, v156
    s_add_u32 s25, s24, 86016
    buffer_load_dwordx4 v[252:255], v19, s[64:67], s25 offen
    s_waitcnt lgkmcnt(3)
    v_mfma_f32_16x16x32_bf16 v[148:151], v[96:99], v[108:111], v[172:175]
    v_add_f32 v15, v15, v157
    v_mfma_f32_16x16x32_bf16 v[152:155], v[96:99], v[124:127], v[176:179]
    ds_read_b128 v[88:91], v2 offset:5120
    v_cvt_pk_bf16_f32 v196, v156, v157
    s_waitcnt lgkmcnt(3)
    v_mfma_f32_16x16x32_bf16 v[140:143], v[100:103], v[112:115], v[140:143]
    v_exp_f32 v158, v158
    v_exp_f32 v159, v159
    v_mfma_f32_16x16x32_bf16 v[144:147], v[100:103], v[128:131], v[144:147]
    ds_read_b128 v[92:95], v2 offset:6144
    v_add_f32 v15, v15, v158
    s_waitcnt lgkmcnt(3)
    v_mfma_f32_16x16x32_bf16 v[148:151], v[104:107], v[112:115], v[148:151]
    v_add_f32 v15, v15, v159
    v_mfma_f32_16x16x32_bf16 v[152:155], v[104:107], v[128:131], v[152:155]
    ds_read_b128 v[96:99], v2 offset:7168
    v_cvt_pk_bf16_f32 v197, v158, v159
    s_waitcnt lgkmcnt(3)
    v_mfma_f32_16x16x32_bf16 v[140:143], v[84:87], v[116:119], v[140:143]
    v_exp_f32 v160, v160
    v_exp_f32 v161, v161
    v_mfma_f32_16x16x32_bf16 v[144:147], v[84:87], v[132:135], v[144:147]
    ds_read_b128 v[100:103], v3 offset:8192
    v_add_f32 v16, v16, v160
    s_waitcnt lgkmcnt(3)
    v_mfma_f32_16x16x32_bf16 v[148:151], v[88:91], v[116:119], v[148:151]
    v_add_f32 v16, v16, v161
    v_mfma_f32_16x16x32_bf16 v[152:155], v[88:91], v[132:135], v[152:155]
    ds_read_b128 v[104:107], v3 offset:9216
    v_cvt_pk_bf16_f32 v200, v160, v161
    s_add_u32 s25, s24, 93184
    buffer_load_dwordx4 v[180:183], v19, s[64:67], s25 offen
    s_waitcnt lgkmcnt(3)
    v_mfma_f32_16x16x32_bf16 v[140:143], v[92:95], v[120:123], v[140:143]
    v_exp_f32 v162, v162
    v_exp_f32 v163, v163
    v_mfma_f32_16x16x32_bf16 v[144:147], v[92:95], v[136:139], v[144:147]
    ds_read_b128 v[84:87], v3 offset:10240
    v_add_f32 v16, v16, v162
    s_waitcnt lgkmcnt(3)
    v_mfma_f32_16x16x32_bf16 v[148:151], v[96:99], v[120:123], v[148:151]
    v_add_f32 v16, v16, v163
    v_mfma_f32_16x16x32_bf16 v[152:155], v[96:99], v[136:139], v[152:155]
    ds_read_b128 v[88:91], v3 offset:11264
    v_cvt_pk_bf16_f32 v201, v162, v163
    s_waitcnt lgkmcnt(3)
    v_mfma_f32_16x16x32_bf16 v[20:23], v[100:103], v[188:191], v[20:23]
    v_exp_f32 v164, v164
    v_exp_f32 v165, v165
    v_mfma_f32_16x16x32_bf16 v[24:27], v[100:103], v[192:195], v[24:27]
    ds_read_b128 v[92:95], v3 offset:12288
    v_add_f32 v15, v15, v164
    s_waitcnt lgkmcnt(3)
    v_mfma_f32_16x16x32_bf16 v[28:31], v[104:107], v[188:191], v[28:31]
    v_add_f32 v15, v15, v165
    v_mfma_f32_16x16x32_bf16 v[32:35], v[104:107], v[192:195], v[32:35]
    ds_read_b128 v[96:99], v3 offset:13312
    v_cvt_pk_bf16_f32 v198, v164, v165
    s_add_u32 s25, s24, 100352
    buffer_load_dwordx4 v[184:187], v19, s[64:67], s25 offen
    s_waitcnt lgkmcnt(3)
    v_mfma_f32_16x16x32_bf16 v[36:39], v[84:87], v[188:191], v[36:39]
    v_exp_f32 v166, v166
    v_exp_f32 v167, v167
    v_mfma_f32_16x16x32_bf16 v[40:43], v[84:87], v[192:195], v[40:43]
    ds_read_b128 v[100:103], v3 offset:14336
    v_add_f32 v15, v15, v166
    s_waitcnt lgkmcnt(3)
    v_mfma_f32_16x16x32_bf16 v[44:47], v[88:91], v[188:191], v[44:47]
    v_add_f32 v15, v15, v167
    v_mfma_f32_16x16x32_bf16 v[48:51], v[88:91], v[192:195], v[48:51]
    ds_read_b128 v[104:107], v3 offset:15360
    v_cvt_pk_bf16_f32 v199, v166, v167
    s_waitcnt lgkmcnt(3)
    v_mfma_f32_16x16x32_bf16 v[52:55], v[92:95], v[188:191], v[52:55]
    v_exp_f32 v168, v168
    v_exp_f32 v169, v169
    v_mfma_f32_16x16x32_bf16 v[56:59], v[92:95], v[192:195], v[56:59]
    s_barrier
    ds_read_b128 v[84:87], v2 offset:16384
    v_add_f32 v16, v16, v168
    s_waitcnt lgkmcnt(3)
    v_mfma_f32_16x16x32_bf16 v[60:63], v[96:99], v[188:191], v[60:63]
    v_add_f32 v16, v16, v169
    v_mfma_f32_16x16x32_bf16 v[64:67], v[96:99], v[192:195], v[64:67]
    ds_read_b128 v[88:91], v2 offset:17408
    v_cvt_pk_bf16_f32 v202, v168, v169
    s_waitcnt lgkmcnt(3)
    v_mfma_f32_16x16x32_bf16 v[68:71], v[100:103], v[188:191], v[68:71]
    v_exp_f32 v170, v170
    v_exp_f32 v171, v171
    v_mfma_f32_16x16x32_bf16 v[72:75], v[100:103], v[192:195], v[72:75]
    ds_read_b128 v[92:95], v2 offset:18432
    v_add_f32 v16, v16, v170
    s_waitcnt lgkmcnt(3)
    v_mfma_f32_16x16x32_bf16 v[76:79], v[104:107], v[188:191], v[76:79]
    v_add_f32 v16, v16, v171
    v_mfma_f32_16x16x32_bf16 v[80:83], v[104:107], v[192:195], v[80:83]
    ds_read_b128 v[96:99], v2 offset:19456
    v_cvt_pk_bf16_f32 v203, v170, v171
    s_waitcnt lgkmcnt(3)
    v_mfma_f32_16x16x32_bf16 v[156:159], v[84:87], v[108:111], v[172:175]
    v_exp_f32 v140, v140
    v_exp_f32 v141, v141
    v_mfma_f32_16x16x32_bf16 v[160:163], v[84:87], v[124:127], v[176:179]
    ds_read_b128 v[100:103], v2 offset:20480
    v_add_f32 v15, v15, v140
    s_waitcnt lgkmcnt(3)
    v_mfma_f32_16x16x32_bf16 v[164:167], v[88:91], v[108:111], v[172:175]
    v_add_f32 v15, v15, v141
    v_mfma_f32_16x16x32_bf16 v[168:171], v[88:91], v[124:127], v[176:179]
    ds_read_b128 v[104:107], v2 offset:21504
    v_cvt_pk_bf16_f32 v188, v140, v141
    s_waitcnt lgkmcnt(3)
    v_mfma_f32_16x16x32_bf16 v[156:159], v[92:95], v[112:115], v[156:159]
    v_exp_f32 v142, v142
    v_exp_f32 v143, v143
    v_mfma_f32_16x16x32_bf16 v[160:163], v[92:95], v[128:131], v[160:163]
    ds_read_b128 v[84:87], v2 offset:22528
    v_add_f32 v15, v15, v142
    s_waitcnt lgkmcnt(3)
    v_mfma_f32_16x16x32_bf16 v[164:167], v[96:99], v[112:115], v[164:167]
    v_add_f32 v15, v15, v143
    v_mfma_f32_16x16x32_bf16 v[168:171], v[96:99], v[128:131], v[168:171]
    ds_read_b128 v[88:91], v2 offset:23552
    v_cvt_pk_bf16_f32 v189, v142, v143
    s_waitcnt lgkmcnt(3)
    v_mfma_f32_16x16x32_bf16 v[156:159], v[100:103], v[116:119], v[156:159]
    v_exp_f32 v144, v144
    v_exp_f32 v145, v145
    v_mfma_f32_16x16x32_bf16 v[160:163], v[100:103], v[132:135], v[160:163]
    ds_read_b128 v[92:95], v3 offset:24576
    v_add_f32 v16, v16, v144
    s_waitcnt lgkmcnt(3)
    v_mfma_f32_16x16x32_bf16 v[164:167], v[104:107], v[116:119], v[164:167]
    v_add_f32 v16, v16, v145
    v_mfma_f32_16x16x32_bf16 v[168:171], v[104:107], v[132:135], v[168:171]
    ds_read_b128 v[96:99], v3 offset:25600
    v_cvt_pk_bf16_f32 v192, v144, v145
    s_waitcnt lgkmcnt(3)
    v_mfma_f32_16x16x32_bf16 v[156:159], v[84:87], v[120:123], v[156:159]
    v_exp_f32 v146, v146
    v_exp_f32 v147, v147
    v_mfma_f32_16x16x32_bf16 v[160:163], v[84:87], v[136:139], v[160:163]
    ds_read_b128 v[100:103], v3 offset:26624
    v_add_f32 v16, v16, v146
    s_waitcnt lgkmcnt(3)
    v_mfma_f32_16x16x32_bf16 v[164:167], v[88:91], v[120:123], v[164:167]
    v_add_f32 v16, v16, v147
    v_mfma_f32_16x16x32_bf16 v[168:171], v[88:91], v[136:139], v[168:171]
    ds_read_b128 v[104:107], v3 offset:27648
    v_cvt_pk_bf16_f32 v193, v146, v147
    s_waitcnt lgkmcnt(3)
    v_mfma_f32_16x16x32_bf16 v[20:23], v[92:95], v[196:199], v[20:23]
    v_exp_f32 v148, v148
    v_exp_f32 v149, v149
    v_mfma_f32_16x16x32_bf16 v[24:27], v[92:95], v[200:203], v[24:27]
    ds_read_b128 v[84:87], v3 offset:28672
    v_add_f32 v15, v15, v148
    s_waitcnt lgkmcnt(3)
    v_mfma_f32_16x16x32_bf16 v[28:31], v[96:99], v[196:199], v[28:31]
    v_add_f32 v15, v15, v149
    v_mfma_f32_16x16x32_bf16 v[32:35], v[96:99], v[200:203], v[32:35]
    ds_read_b128 v[88:91], v3 offset:29696
    v_cvt_pk_bf16_f32 v190, v148, v149
    s_waitcnt lgkmcnt(3)
    v_mfma_f32_16x16x32_bf16 v[36:39], v[100:103], v[196:199], v[36:39]
    v_exp_f32 v150, v150
    v_exp_f32 v151, v151
    v_mfma_f32_16x16x32_bf16 v[40:43], v[100:103], v[200:203], v[40:43]
    ds_read_b128 v[92:95], v3 offset:30720
    v_add_f32 v15, v15, v150
    s_waitcnt lgkmcnt(3)
    v_mfma_f32_16x16x32_bf16 v[44:47], v[104:107], v[196:199], v[44:47]
    v_add_f32 v15, v15, v151
    v_mfma_f32_16x16x32_bf16 v[48:51], v[104:107], v[200:203], v[48:51]
    ds_read_b128 v[96:99], v3 offset:31744
    v_cvt_pk_bf16_f32 v191, v150, v151
    s_waitcnt lgkmcnt(3)
    v_mfma_f32_16x16x32_bf16 v[52:55], v[84:87], v[196:199], v[52:55]
    v_exp_f32 v152, v152
    v_exp_f32 v153, v153
    v_mfma_f32_16x16x32_bf16 v[56:59], v[84:87], v[200:203], v[56:59]
    s_barrier
    ds_read_b128 v[100:103], v2 offset:32768
    v_add_f32 v16, v16, v152
    s_waitcnt lgkmcnt(3)
    v_mfma_f32_16x16x32_bf16 v[60:63], v[88:91], v[196:199], v[60:63]
    v_add_f32 v16, v16, v153
    v_mfma_f32_16x16x32_bf16 v[64:67], v[88:91], v[200:203], v[64:67]
    ds_read_b128 v[104:107], v2 offset:33792
    v_cvt_pk_bf16_f32 v194, v152, v153
    s_waitcnt lgkmcnt(3)
    v_mfma_f32_16x16x32_bf16 v[68:71], v[92:95], v[196:199], v[68:71]
    v_exp_f32 v154, v154
    v_exp_f32 v155, v155
    v_mfma_f32_16x16x32_bf16 v[72:75], v[92:95], v[200:203], v[72:75]
    ds_read_b128 v[84:87], v2 offset:34816
    v_add_f32 v16, v16, v154
    s_waitcnt lgkmcnt(3)
    v_mfma_f32_16x16x32_bf16 v[76:79], v[96:99], v[196:199], v[76:79]
    v_add_f32 v16, v16, v155
    v_mfma_f32_16x16x32_bf16 v[80:83], v[96:99], v[200:203], v[80:83]
    ds_read_b128 v[88:91], v2 offset:35840
    v_cvt_pk_bf16_f32 v195, v154, v155
    s_waitcnt lgkmcnt(3)
    v_mfma_f32_16x16x32_bf16 v[140:143], v[100:103], v[108:111], v[172:175]
    v_exp_f32 v156, v156
    v_exp_f32 v157, v157
    v_mfma_f32_16x16x32_bf16 v[144:147], v[100:103], v[124:127], v[176:179]
    ds_read_b128 v[92:95], v2 offset:36864
    v_add_f32 v15, v15, v156
    s_waitcnt lgkmcnt(3)
    v_mfma_f32_16x16x32_bf16 v[148:151], v[104:107], v[108:111], v[172:175]
    v_add_f32 v15, v15, v157
    v_mfma_f32_16x16x32_bf16 v[152:155], v[104:107], v[124:127], v[176:179]
    ds_read_b128 v[96:99], v2 offset:37888
    v_cvt_pk_bf16_f32 v196, v156, v157
    s_waitcnt lgkmcnt(3)
    v_mfma_f32_16x16x32_bf16 v[140:143], v[84:87], v[112:115], v[140:143]
    v_exp_f32 v158, v158
    v_exp_f32 v159, v159
    v_mfma_f32_16x16x32_bf16 v[144:147], v[84:87], v[128:131], v[144:147]
    ds_read_b128 v[100:103], v2 offset:38912
    v_add_f32 v15, v15, v158
    s_waitcnt lgkmcnt(3)
    v_mfma_f32_16x16x32_bf16 v[148:151], v[88:91], v[112:115], v[148:151]
    v_add_f32 v15, v15, v159
    v_mfma_f32_16x16x32_bf16 v[152:155], v[88:91], v[128:131], v[152:155]
    ds_read_b128 v[104:107], v2 offset:39936
    v_cvt_pk_bf16_f32 v197, v158, v159
    s_waitcnt lgkmcnt(3)
    v_mfma_f32_16x16x32_bf16 v[140:143], v[92:95], v[116:119], v[140:143]
    v_exp_f32 v160, v160
    v_exp_f32 v161, v161
    v_mfma_f32_16x16x32_bf16 v[144:147], v[92:95], v[132:135], v[144:147]
    ds_read_b128 v[84:87], v2 offset:8192
    v_add_f32 v16, v16, v160
    s_waitcnt lgkmcnt(3)
    v_mfma_f32_16x16x32_bf16 v[148:151], v[96:99], v[116:119], v[148:151]
    v_add_f32 v16, v16, v161
    v_mfma_f32_16x16x32_bf16 v[152:155], v[96:99], v[132:135], v[152:155]
    ds_read_b128 v[88:91], v2 offset:9216
    v_cvt_pk_bf16_f32 v200, v160, v161
    s_waitcnt lgkmcnt(3)
    v_mfma_f32_16x16x32_bf16 v[140:143], v[100:103], v[120:123], v[140:143]
    v_exp_f32 v162, v162
    v_exp_f32 v163, v163
    v_mfma_f32_16x16x32_bf16 v[144:147], v[100:103], v[136:139], v[144:147]
    ds_read_b128 v[92:95], v2 offset:10240
    v_add_f32 v16, v16, v162
    s_waitcnt lgkmcnt(3)
    v_mfma_f32_16x16x32_bf16 v[148:151], v[104:107], v[120:123], v[148:151]
    v_add_f32 v16, v16, v163
    v_mfma_f32_16x16x32_bf16 v[152:155], v[104:107], v[136:139], v[152:155]
    ds_read_b128 v[96:99], v2 offset:11264
    v_cvt_pk_bf16_f32 v201, v162, v163
    s_waitcnt lgkmcnt(3)
    v_mfma_f32_16x16x32_bf16 v[20:23], v[84:87], v[188:191], v[20:23]
    v_exp_f32 v164, v164
    v_exp_f32 v165, v165
    v_mfma_f32_16x16x32_bf16 v[24:27], v[84:87], v[192:195], v[24:27]
    ds_read_b128 v[100:103], v2 offset:12288
    v_add_f32 v15, v15, v164
    s_waitcnt lgkmcnt(3)
    v_mfma_f32_16x16x32_bf16 v[28:31], v[88:91], v[188:191], v[28:31]
    v_add_f32 v15, v15, v165
    v_mfma_f32_16x16x32_bf16 v[32:35], v[88:91], v[192:195], v[32:35]
    ds_read_b128 v[104:107], v2 offset:13312
    v_cvt_pk_bf16_f32 v198, v164, v165
    s_waitcnt lgkmcnt(3)
    v_mfma_f32_16x16x32_bf16 v[36:39], v[92:95], v[188:191], v[36:39]
    v_exp_f32 v166, v166
    v_exp_f32 v167, v167
    v_mfma_f32_16x16x32_bf16 v[40:43], v[92:95], v[192:195], v[40:43]
    ds_read_b128 v[84:87], v2 offset:14336
    v_add_f32 v15, v15, v166
    s_waitcnt lgkmcnt(3)
    v_mfma_f32_16x16x32_bf16 v[44:47], v[96:99], v[188:191], v[44:47]
    v_add_f32 v15, v15, v167
    v_mfma_f32_16x16x32_bf16 v[48:51], v[96:99], v[192:195], v[48:51]
    ds_read_b128 v[88:91], v2 offset:15360
    v_cvt_pk_bf16_f32 v199, v166, v167
    s_waitcnt lgkmcnt(3)
    v_mfma_f32_16x16x32_bf16 v[52:55], v[100:103], v[188:191], v[52:55]
    v_exp_f32 v168, v168
    v_exp_f32 v169, v169
    v_mfma_f32_16x16x32_bf16 v[56:59], v[100:103], v[192:195], v[56:59]
    s_barrier
    ds_read_b128 v[92:95], v2 offset:49152
    v_add_f32 v16, v16, v168
    s_waitcnt lgkmcnt(3)
    v_mfma_f32_16x16x32_bf16 v[60:63], v[104:107], v[188:191], v[60:63]
    v_add_f32 v16, v16, v169
    v_mfma_f32_16x16x32_bf16 v[64:67], v[104:107], v[192:195], v[64:67]
    ds_read_b128 v[96:99], v2 offset:50176
    v_cvt_pk_bf16_f32 v202, v168, v169
    s_waitcnt lgkmcnt(3)
    v_mfma_f32_16x16x32_bf16 v[68:71], v[84:87], v[188:191], v[68:71]
    v_exp_f32 v170, v170
    v_exp_f32 v171, v171
    v_mfma_f32_16x16x32_bf16 v[72:75], v[84:87], v[192:195], v[72:75]
    ds_read_b128 v[100:103], v2 offset:51200
    v_add_f32 v16, v16, v170
    s_waitcnt lgkmcnt(3)
    v_mfma_f32_16x16x32_bf16 v[76:79], v[88:91], v[188:191], v[76:79]
    v_add_f32 v16, v16, v171
    v_mfma_f32_16x16x32_bf16 v[80:83], v[88:91], v[192:195], v[80:83]
    ds_read_b128 v[104:107], v2 offset:52224
    v_cvt_pk_bf16_f32 v203, v170, v171
    s_waitcnt lgkmcnt(3)
    v_mfma_f32_16x16x32_bf16 v[156:159], v[92:95], v[108:111], v[172:175]
    v_exp_f32 v140, v140
    v_exp_f32 v141, v141
    v_mfma_f32_16x16x32_bf16 v[160:163], v[92:95], v[124:127], v[176:179]
    ds_read_b128 v[84:87], v2 offset:53248
    v_add_f32 v15, v15, v140
    s_waitcnt lgkmcnt(3)
    v_mfma_f32_16x16x32_bf16 v[164:167], v[96:99], v[108:111], v[172:175]
    v_add_f32 v15, v15, v141
    v_mfma_f32_16x16x32_bf16 v[168:171], v[96:99], v[124:127], v[176:179]
    ds_read_b128 v[88:91], v2 offset:54272
    v_cvt_pk_bf16_f32 v188, v140, v141
    s_waitcnt lgkmcnt(3)
    v_mfma_f32_16x16x32_bf16 v[156:159], v[100:103], v[112:115], v[156:159]
    v_exp_f32 v142, v142
    v_exp_f32 v143, v143
    v_mfma_f32_16x16x32_bf16 v[160:163], v[100:103], v[128:131], v[160:163]
    ds_read_b128 v[92:95], v2 offset:55296
    v_add_f32 v15, v15, v142
    s_waitcnt lgkmcnt(3)
    v_mfma_f32_16x16x32_bf16 v[164:167], v[104:107], v[112:115], v[164:167]
    v_add_f32 v15, v15, v143
    v_mfma_f32_16x16x32_bf16 v[168:171], v[104:107], v[128:131], v[168:171]
    ds_read_b128 v[96:99], v2 offset:56320
    v_cvt_pk_bf16_f32 v189, v142, v143
    s_waitcnt lgkmcnt(3)
    v_mfma_f32_16x16x32_bf16 v[156:159], v[84:87], v[116:119], v[156:159]
    v_exp_f32 v144, v144
    v_exp_f32 v145, v145
    v_mfma_f32_16x16x32_bf16 v[160:163], v[84:87], v[132:135], v[160:163]
    ds_read_b128 v[100:103], v2 offset:24576
    v_add_f32 v16, v16, v144
    s_waitcnt lgkmcnt(3)
    v_mfma_f32_16x16x32_bf16 v[164:167], v[88:91], v[116:119], v[164:167]
    v_add_f32 v16, v16, v145
    v_mfma_f32_16x16x32_bf16 v[168:171], v[88:91], v[132:135], v[168:171]
    ds_read_b128 v[104:107], v2 offset:25600
    v_cvt_pk_bf16_f32 v192, v144, v145
    s_waitcnt lgkmcnt(3)
    v_mfma_f32_16x16x32_bf16 v[156:159], v[92:95], v[120:123], v[156:159]
    v_exp_f32 v146, v146
    v_exp_f32 v147, v147
    v_mfma_f32_16x16x32_bf16 v[160:163], v[92:95], v[136:139], v[160:163]
    ds_read_b128 v[84:87], v2 offset:26624
    v_add_f32 v16, v16, v146
    s_waitcnt lgkmcnt(3)
    v_mfma_f32_16x16x32_bf16 v[164:167], v[96:99], v[120:123], v[164:167]
    v_add_f32 v16, v16, v147
    v_mfma_f32_16x16x32_bf16 v[168:171], v[96:99], v[136:139], v[168:171]
    ds_read_b128 v[88:91], v2 offset:27648
    v_cvt_pk_bf16_f32 v193, v146, v147
    s_waitcnt lgkmcnt(3)
    v_mfma_f32_16x16x32_bf16 v[20:23], v[100:103], v[196:199], v[20:23]
    v_exp_f32 v148, v148
    v_exp_f32 v149, v149
    v_mfma_f32_16x16x32_bf16 v[24:27], v[100:103], v[200:203], v[24:27]
    ds_read_b128 v[92:95], v2 offset:28672
    v_add_f32 v15, v15, v148
    s_waitcnt lgkmcnt(3)
    v_mfma_f32_16x16x32_bf16 v[28:31], v[104:107], v[196:199], v[28:31]
    v_add_f32 v15, v15, v149
    v_mfma_f32_16x16x32_bf16 v[32:35], v[104:107], v[200:203], v[32:35]
    ds_read_b128 v[96:99], v2 offset:29696
    v_cvt_pk_bf16_f32 v190, v148, v149
    s_waitcnt lgkmcnt(3)
    v_mfma_f32_16x16x32_bf16 v[36:39], v[84:87], v[196:199], v[36:39]
    v_exp_f32 v150, v150
    v_exp_f32 v151, v151
    v_mfma_f32_16x16x32_bf16 v[40:43], v[84:87], v[200:203], v[40:43]
    ds_read_b128 v[100:103], v2 offset:30720
    v_add_f32 v15, v15, v150
    s_waitcnt lgkmcnt(3)
    v_mfma_f32_16x16x32_bf16 v[44:47], v[88:91], v[196:199], v[44:47]
    v_add_f32 v15, v15, v151
    v_mfma_f32_16x16x32_bf16 v[48:51], v[88:91], v[200:203], v[48:51]
    ds_read_b128 v[104:107], v2 offset:31744
    v_cvt_pk_bf16_f32 v191, v150, v151
    s_waitcnt lgkmcnt(3)
    v_mfma_f32_16x16x32_bf16 v[52:55], v[92:95], v[196:199], v[52:55]
    v_exp_f32 v152, v152
    v_exp_f32 v153, v153
    v_mfma_f32_16x16x32_bf16 v[56:59], v[92:95], v[200:203], v[56:59]
    ds_read_b128 v[84:87], v2 offset:40960
    v_add_f32 v16, v16, v152
    s_waitcnt lgkmcnt(3)
    v_mfma_f32_16x16x32_bf16 v[60:63], v[96:99], v[196:199], v[60:63]
    v_add_f32 v16, v16, v153
    v_mfma_f32_16x16x32_bf16 v[64:67], v[96:99], v[200:203], v[64:67]
    ds_read_b128 v[88:91], v2 offset:41984
    v_cvt_pk_bf16_f32 v194, v152, v153
    s_waitcnt lgkmcnt(3)
    v_mfma_f32_16x16x32_bf16 v[68:71], v[100:103], v[196:199], v[68:71]
    v_exp_f32 v154, v154
    v_exp_f32 v155, v155
    v_mfma_f32_16x16x32_bf16 v[72:75], v[100:103], v[200:203], v[72:75]
    ds_read_b128 v[92:95], v2 offset:43008
    v_add_f32 v16, v16, v154
    s_waitcnt lgkmcnt(3)
    v_mfma_f32_16x16x32_bf16 v[76:79], v[104:107], v[196:199], v[76:79]
    v_add_f32 v16, v16, v155
    v_mfma_f32_16x16x32_bf16 v[80:83], v[104:107], v[200:203], v[80:83]
    ds_read_b128 v[96:99], v2 offset:44032
    v_cvt_pk_bf16_f32 v195, v154, v155
    s_waitcnt lgkmcnt(3)
    v_mfma_f32_16x16x32_bf16 v[20:23], v[84:87], v[188:191], v[20:23]
    v_exp_f32 v156, v156
    v_exp_f32 v157, v157
    v_add_f32 v15, v15, v156
    v_mfma_f32_16x16x32_bf16 v[24:27], v[84:87], v[192:195], v[24:27]
    ds_read_b128 v[100:103], v2 offset:45056
    v_add_f32 v15, v15, v157
    v_cvt_pk_bf16_f32 v196, v156, v157
    s_waitcnt lgkmcnt(3)
    v_mfma_f32_16x16x32_bf16 v[28:31], v[88:91], v[188:191], v[28:31]
    v_exp_f32 v158, v158
    v_exp_f32 v159, v159
    v_add_f32 v15, v15, v158
    v_mfma_f32_16x16x32_bf16 v[32:35], v[88:91], v[192:195], v[32:35]
    ds_read_b128 v[104:107], v2 offset:46080
    v_add_f32 v15, v15, v159
    v_cvt_pk_bf16_f32 v197, v158, v159
    s_waitcnt lgkmcnt(3)
    v_mfma_f32_16x16x32_bf16 v[36:39], v[92:95], v[188:191], v[36:39]
    v_exp_f32 v160, v160
    v_exp_f32 v161, v161
    v_add_f32 v16, v16, v160
    v_mfma_f32_16x16x32_bf16 v[40:43], v[92:95], v[192:195], v[40:43]
    ds_read_b128 v[84:87], v2 offset:47104
    v_add_f32 v16, v16, v161
    v_cvt_pk_bf16_f32 v200, v160, v161
    s_waitcnt lgkmcnt(3)
    v_mfma_f32_16x16x32_bf16 v[44:47], v[96:99], v[188:191], v[44:47]
    v_exp_f32 v162, v162
    v_exp_f32 v163, v163
    v_add_f32 v16, v16, v162
    v_mfma_f32_16x16x32_bf16 v[48:51], v[96:99], v[192:195], v[48:51]
    ds_read_b128 v[88:91], v2 offset:48128
    v_add_f32 v16, v16, v163
    v_cvt_pk_bf16_f32 v201, v162, v163
    s_waitcnt lgkmcnt(3)
    v_mfma_f32_16x16x32_bf16 v[52:55], v[100:103], v[188:191], v[52:55]
    v_exp_f32 v164, v164
    v_exp_f32 v165, v165
    v_add_f32 v15, v15, v164
    v_mfma_f32_16x16x32_bf16 v[56:59], v[100:103], v[192:195], v[56:59]
    ds_read_b128 v[92:95], v2 offset:57344
    v_add_f32 v15, v15, v165
    v_cvt_pk_bf16_f32 v198, v164, v165
    s_waitcnt lgkmcnt(3)
    v_mfma_f32_16x16x32_bf16 v[60:63], v[104:107], v[188:191], v[60:63]
    v_exp_f32 v166, v166
    v_exp_f32 v167, v167
    v_add_f32 v15, v15, v166
    v_mfma_f32_16x16x32_bf16 v[64:67], v[104:107], v[192:195], v[64:67]
    ds_read_b128 v[96:99], v2 offset:58368
    v_add_f32 v15, v15, v167
    v_cvt_pk_bf16_f32 v199, v166, v167
    s_waitcnt lgkmcnt(3)
    v_mfma_f32_16x16x32_bf16 v[68:71], v[84:87], v[188:191], v[68:71]
    v_exp_f32 v168, v168
    v_exp_f32 v169, v169
    v_add_f32 v16, v16, v168
    v_mfma_f32_16x16x32_bf16 v[72:75], v[84:87], v[192:195], v[72:75]
    ds_read_b128 v[100:103], v2 offset:59392
    v_add_f32 v16, v16, v169
    v_cvt_pk_bf16_f32 v202, v168, v169
    s_waitcnt lgkmcnt(3)
    v_mfma_f32_16x16x32_bf16 v[76:79], v[88:91], v[188:191], v[76:79]
    v_exp_f32 v170, v170
    v_exp_f32 v171, v171
    v_add_f32 v16, v16, v170
    v_mfma_f32_16x16x32_bf16 v[80:83], v[88:91], v[192:195], v[80:83]
    ds_read_b128 v[104:107], v2 offset:60416
    v_add_f32 v16, v16, v171
    v_cvt_pk_bf16_f32 v203, v170, v171
    s_waitcnt lgkmcnt(3)
    v_mfma_f32_16x16x32_bf16 v[20:23], v[92:95], v[196:199], v[20:23]
    v_mfma_f32_16x16x32_bf16 v[24:27], v[92:95], v[200:203], v[24:27]
    ds_read_b128 v[84:87], v2 offset:61440
    s_waitcnt lgkmcnt(3)
    v_mfma_f32_16x16x32_bf16 v[28:31], v[96:99], v[196:199], v[28:31]
    v_mfma_f32_16x16x32_bf16 v[32:35], v[96:99], v[200:203], v[32:35]
    ds_read_b128 v[88:91], v2 offset:62464
    s_waitcnt lgkmcnt(3)
    v_mfma_f32_16x16x32_bf16 v[36:39], v[100:103], v[196:199], v[36:39]
    v_mfma_f32_16x16x32_bf16 v[40:43], v[100:103], v[200:203], v[40:43]
    ds_read_b128 v[92:95], v2 offset:63488
    s_waitcnt lgkmcnt(3)
    v_mfma_f32_16x16x32_bf16 v[44:47], v[104:107], v[196:199], v[44:47]
    v_mfma_f32_16x16x32_bf16 v[48:51], v[104:107], v[200:203], v[48:51]
    ds_read_b128 v[96:99], v2 offset:64512
    s_waitcnt lgkmcnt(3)
    v_mfma_f32_16x16x32_bf16 v[52:55], v[84:87], v[196:199], v[52:55]
    v_mfma_f32_16x16x32_bf16 v[56:59], v[84:87], v[200:203], v[56:59]
    s_waitcnt lgkmcnt(2)
    v_mfma_f32_16x16x32_bf16 v[60:63], v[88:91], v[196:199], v[60:63]
    v_mfma_f32_16x16x32_bf16 v[64:67], v[88:91], v[200:203], v[64:67]
    s_waitcnt lgkmcnt(1)
    v_mfma_f32_16x16x32_bf16 v[68:71], v[92:95], v[196:199], v[68:71]
    v_mfma_f32_16x16x32_bf16 v[72:75], v[92:95], v[200:203], v[72:75]
    s_waitcnt lgkmcnt(0)
    v_mfma_f32_16x16x32_bf16 v[76:79], v[96:99], v[196:199], v[76:79]
    v_mfma_f32_16x16x32_bf16 v[80:83], v[96:99], v[200:203], v[80:83]
fz_chk:
    s_setprio 0
    v_mov_b32 v9, v15
    v_mov_b32 v11, v16
    s_nop 0
    v_permlane16_swap_b32 v15, v9
    v_permlane16_swap_b32 v16, v11
    v_add_f32 v15, v15, v9
    v_add_f32 v16, v16, v11
    v_mov_b32 v9, v15
    v_mov_b32 v11, v16
    s_nop 0
    v_permlane32_swap_b32 v15, v9
    v_permlane32_swap_b32 v16, v11
    v_add_f32 v15, v15, v9
    v_add_f32 v16, v16, v11
    v_max3_f32 v10, |v20|, |v21|, v15
    v_max3_f32 v12, |v22|, |v23|, v16
    v_max3_f32 v10, |v24|, |v25|, v10
    v_max3_f32 v12, |v26|, |v27|, v12
    v_max3_f32 v10, |v28|, |v29|, v10
    v_max3_f32 v12, |v30|, |v31|, v12
    v_max3_f32 v10, |v32|, |v33|, v10
    v_max3_f32 v12, |v34|, |v35|, v12
    v_max3_f32 v10, |v36|, |v37|, v10
    v_max3_f32 v12, |v38|, |v39|, v12
    v_max3_f32 v10, |v40|, |v41|, v10
    v_max3_f32 v12, |v42|, |v43|, v12
    v_max3_f32 v10, |v44|, |v45|, v10
    v_max3_f32 v12, |v46|, |v47|, v12
    v_max3_f32 v10, |v48|, |v49|, v10
    v_max3_f32 v12, |v50|, |v51|, v12
    v_max3_f32 v10, |v52|, |v53|, v10
    v_max3_f32 v12, |v54|, |v55|, v12
    v_max3_f32 v10, |v56|, |v57|, v10
    v_max3_f32 v12, |v58|, |v59|, v12
    v_max3_f32 v10, |v60|, |v61|, v10
    v_max3_f32 v12, |v62|, |v63|, v12
    v_max3_f32 v10, |v64|, |v65|, v10
    v_max3_f32 v12, |v66|, |v67|, v12
    v_max3_f32 v10, |v68|, |v69|, v10
    v_max3_f32 v12, |v70|, |v71|, v12
    v_max3_f32 v10, |v72|, |v73|, v10
    v_max3_f32 v12, |v74|, |v75|, v12
    v_max3_f32 v10, |v76|, |v77|, v10
    v_max3_f32 v12, |v78|, |v79|, v12
    v_max3_f32 v10, |v80|, |v81|, v10
    v_max3_f32 v12, |v82|, |v83|, v12
    v_max_f32 v10, v10, v12
    s_mov_b32 s26, 0x7b800000
    v_cmp_ngt_f32 vcc, s26, v10
    v_cmp_u_f32 s[26:27], v15, v16
    s_or_b64 vcc, vcc, s[26:27]
    s_cbranch_vccnz fz_slow
fz_epi:
    s_cmp_lt_u32 s3, 4
    s_cbranch_scc1 fz_nw15
    s_add_u32 s25, s24, 107520
    buffer_load_dwordx4 v[172:175], v19, s[64:67], s25 offen
fz_nw15:
    v_rcp_f32 v9, v15
    v_rcp_f32 v11, v16
    s_lshl_b32 s19, s13, 3
    s_add_u32 s19, s19, s3
    s_mul_i32 s20, s19, 262144
    s_lshl_b32 s25, s12, 12
    s_add_u32 s20, s20, s25
    s_add_u32 s20, s20, 0x1000000
    s_add_u32 s25, s20, 131072
    v_mul_f32 v148, v20, v9
    v_mul_f32 v149, v21, v9
    v_mul_f32 v150, v22, v9
    v_mul_f32 v151, v23, v9
    v_mul_f32 v152, v28, v9
    v_mul_f32 v153, v29, v9
    v_mul_f32 v154, v30, v9
    v_mul_f32 v155, v31, v9
    v_cvt_pk_bf16_f32 v108, v148, v149
    v_cvt_pk_bf16_f32 v109, v150, v151
    v_cvt_pk_bf16_f32 v110, v152, v153
    v_cvt_pk_bf16_f32 v111, v154, v155
    buffer_store_dwordx4 v[108:111], v1, s[8:11], s20 offen offset:0 sc1
    v_mul_f32 v164, v24, v11
    v_mul_f32 v165, v25, v11
    v_mul_f32 v166, v26, v11
    v_mul_f32 v167, v27, v11
    v_mul_f32 v168, v32, v11
    v_mul_f32 v169, v33, v11
    v_mul_f32 v170, v34, v11
    v_mul_f32 v171, v35, v11
    v_cvt_pk_bf16_f32 v124, v164, v165
    v_cvt_pk_bf16_f32 v125, v166, v167
    v_cvt_pk_bf16_f32 v126, v168, v169
    v_cvt_pk_bf16_f32 v127, v170, v171
    buffer_store_dwordx4 v[124:127], v1, s[8:11], s25 offen offset:0 sc1
    v_mul_f32 v148, v36, v9
    v_mul_f32 v149, v37, v9
    v_mul_f32 v150, v38, v9
    v_mul_f32 v151, v39, v9
    v_mul_f32 v152, v44, v9
    v_mul_f32 v153, v45, v9
    v_mul_f32 v154, v46, v9
    v_mul_f32 v155, v47, v9
    v_cvt_pk_bf16_f32 v112, v148, v149
    v_cvt_pk_bf16_f32 v113, v150, v151
    v_cvt_pk_bf16_f32 v114, v152, v153
    v_cvt_pk_bf16_f32 v115, v154, v155
    buffer_store_dwordx4 v[112:115], v1, s[8:11], s20 offen offset:1024 sc1
    v_mul_f32 v164, v40, v11
    v_mul_f32 v165, v41, v11
    v_mul_f32 v166, v42, v11
    v_mul_f32 v167, v43, v11
    v_mul_f32 v168, v48, v11
    v_mul_f32 v169, v49, v11
    v_mul_f32 v170, v50, v11
    v_mul_f32 v171, v51, v11
    v_cvt_pk_bf16_f32 v128, v164, v165
    v_cvt_pk_bf16_f32 v129, v166, v167
    v_cvt_pk_bf16_f32 v130, v168, v169
    v_cvt_pk_bf16_f32 v131, v170, v171
    buffer_store_dwordx4 v[128:131], v1, s[8:11], s25 offen offset:1024 sc1
    v_mul_f32 v148, v52, v9
    v_mul_f32 v149, v53, v9
    v_mul_f32 v150, v54, v9
    v_mul_f32 v151, v55, v9
    v_mul_f32 v152, v60, v9
    v_mul_f32 v153, v61, v9
    v_mul_f32 v154, v62, v9
    v_mul_f32 v155, v63, v9
    v_cvt_pk_bf16_f32 v116, v148, v149
    v_cvt_pk_bf16_f32 v117, v150, v151
    v_cvt_pk_bf16_f32 v118, v152, v153
    v_cvt_pk_bf16_f32 v119, v154, v155
    buffer_store_dwordx4 v[116:119], v1, s[8:11], s20 offen offset:2048 sc1
    v_mul_f32 v164, v56, v11
    v_mul_f32 v165, v57, v11
    v_mul_f32 v166, v58, v11
    v_mul_f32 v167, v59, v11
    v_mul_f32 v168, v64, v11
    v_mul_f32 v169, v65, v11
    v_mul_f32 v170, v66, v11
    v_mul_f32 v171, v67, v11
    v_cvt_pk_bf16_f32 v132, v164, v165
    v_cvt_pk_bf16_f32 v133, v166, v167
    v_cvt_pk_bf16_f32 v134, v168, v169
    v_cvt_pk_bf16_f32 v135, v170, v171
    buffer_store_dwordx4 v[132:135], v1, s[8:11], s25 offen offset:2048 sc1
    v_mul_f32 v148, v68, v9
    v_mul_f32 v149, v69, v9
    v_mul_f32 v150, v70, v9
    v_mul_f32 v151, v71, v9
    v_mul_f32 v152, v76, v9
    v_mul_f32 v153, v77, v9
    v_mul_f32 v154, v78, v9
    v_mul_f32 v155, v79, v9
    v_cvt_pk_bf16_f32 v120, v148, v149
    v_cvt_pk_bf16_f32 v121, v150, v151
    v_cvt_pk_bf16_f32 v122, v152, v153
    v_cvt_pk_bf16_f32 v123, v154, v155
    buffer_store_dwordx4 v[120:123], v1, s[8:11], s20 offen offset:3072 sc1
    v_mul_f32 v164, v72, v11
    v_mul_f32 v165, v73, v11
    v_mul_f32 v166, v74, v11
    v_mul_f32 v167, v75, v11
    v_mul_f32 v168, v80, v11
    v_mul_f32 v169, v81, v11
    v_mul_f32 v170, v82, v11
    v_mul_f32 v171, v83, v11
    v_cvt_pk_bf16_f32 v136, v164, v165
    v_cvt_pk_bf16_f32 v137, v166, v167
    v_cvt_pk_bf16_f32 v138, v168, v169
    v_cvt_pk_bf16_f32 v139, v170, v171
    buffer_store_dwordx4 v[136:139], v1, s[8:11], s25 offen offset:3072 sc1
    s_cmp_ge_u32 s3, 4
    s_cbranch_scc1 fz_p3B
    v_bfe_u32 v9, v0, 2, 2
    v_lshrrev_b32 v10, 4, v0
    v_and_b32 v11, 3, v0
    v_lshlrev_b32 v3, 10, v10
    v_lshl_add_u32 v3, v9, 6, v3
    v_lshl_add_u32 v3, v11, 3, v3
    v_bfe_u32 v12, v0, 4, 1
    v_lshlrev_b32 v12, 5, v12
    v_sub_u32 v2, v3, v12
    v_add_u32 v3, v3, v12
    s_lshl_b32 s19, s13, 3
    s_add_u32 s19, s19, s3
    s_mul_i32 s19, s19, 262144
    v_add_u32 v4, s19, v1
    s_and_b32 s62, s12, 24
    s_and_b32 s19, s12, 7
    s_lshl_b32 s20, s19, 2
    s_lshr_b32 s20, 0x54732160, s20
    s_and_b32 s20, s20, 7
    s_lshl_b32 s20, s20, 2
    s_bfm_b32 s21, s20, 0
    s_and_b32 s22, s21, 0x51764320
    s_lshl_b32 s22, s22, 4
    s_lshl_b32 s21, s21, 4
    s_or_b32 s21, s21, 15
    s_andn2_b32 s21, 0x51764320, s21
    s_or_b32 s42, s21, s22
    s_or_b32 s42, s42, s19
    s_bfe_u32 s96, s2, 0x10002
    s_mul_i32 s96, s96, 28
    s_lshr_b32 s26, s2, 3
    s_add_u32 s96, s96, s26
    s_and_b32 s97, s2, 1
    s_bfe_u32 s98, s2, 0x10001
    s_bfe_u32 s99, s2, 0x40003
    s_and_b32 s100, s2, 7
    s_lshl_b32 s100, s100, 1
    s_lshr_b32 s26, s2, 7
    s_add_u32 s100, s100, s26
    v_lshrrev_b32 v9, 4, v0
    v_lshlrev_b32 v13, 4, v9
    s_add_u32 s19, s12, 1
    s_and_b32 s19, s19, 7
    s_lshl_b32 s26, s19, 9
    s_add_u32 s26, s26, 0x22000
    v_add_u32 v13, s26, v13
    v_and_b32 v14, 15, v0
    v_lshlrev_b32 v14, 6, v14
    v_lshl_add_u32 v14, v9, 4, v14
    s_lshr_b32 s18, s12, 3
    s_lshl_b32 s18, s18, 22
    s_lshl_b32 s26, s13, 3
    s_add_u32 s26, s26, s3
    s_lshl_b32 s26, s26, 16
    s_add_u32 s18, s18, s26
    s_lshl_b32 s19, s19, 12
    s_add_u32 s18, s18, s19
    s_add_u32 s18, s18, 0x2000000
    s_add_u32 s19, s18, 0x8000
    v_add_u32 v15, 0x10000, v3
    v_add_u32 v16, 0x10000, v2
    s_lshl_b32 s26, s13, 3
    s_add_u32 s26, s26, s3
    s_lshl_b32 s26, s26, 2
    s_lshr_b32 s27, s12, 3
    s_add_u32 s26, s26, s27
    s_lshl_b32 s26, s26, 7
    s_add_u32 s20, s26, 0x540000
    s_and_b32 s27, s12, 7
    s_lshl_b32 s27, s27, 2
    s_add_u32 s26, s20, s27
    v_mov_b32 v9, s14
    v_mov_b32 v10, 0
    s_waitcnt vmcnt(0)
    s_mov_b64 exec, 1
    buffer_store_dword v9, v10, s[8:11], s26 offen sc1
    s_mov_b64 exec, -1
    s_waitcnt lgkmcnt(0)
    s_barrier
    ds_read_b64_tr_b16 v[84:85], v3 offset:0
    ds_read_b64_tr_b16 v[86:87], v3 offset:4096
    ds_read_b64_tr_b16 v[88:89], v2 offset:32
    ds_read_b64_tr_b16 v[90:91], v2 offset:4128
    ds_read_b64_tr_b16 v[92:93], v3 offset:256
    ds_read_b64_tr_b16 v[94:95], v3 offset:4352
    ds_read_b64_tr_b16 v[96:97], v2 offset:288
    ds_read_b64_tr_b16 v[98:99], v2 offset:4384
    s_waitcnt lgkmcnt(6)
    v_mfma_f32_16x16x32_bf16 v[20:23], v[84:87], v[108:111], 0
    ds_read_b64_tr_b16 v[100:101], v3 offset:512
    v_mfma_f32_16x16x32_bf16 v[24:27], v[84:87], v[124:127], 0
    s_bfe_u32 s22, s42, 0x30004
    s_or_b32 s22, s22, s62
    s_lshl_b32 s22, s22, 18
    s_add_u32 s22, s22, s16
    s_add_u32 s22, s22, 0x20000
    s_add_u32 m0, s17, 0xc000
    s_nop 0
    buffer_load_dwordx4 v17, s[4:7], s22 offen lds
    ds_read_b64_tr_b16 v[102:103], v3 offset:4608
    s_waitcnt lgkmcnt(6)
    v_mfma_f32_16x16x32_bf16 v[28:31], v[88:91], v[108:111], 0
    ds_read_b64_tr_b16 v[104:105], v2 offset:544
    v_mfma_f32_16x16x32_bf16 v[32:35], v[88:91], v[124:127], 0
    ds_read_b64_tr_b16 v[106:107], v2 offset:4640
    s_waitcnt lgkmcnt(6)
    v_mfma_f32_16x16x32_bf16 v[36:39], v[92:95], v[108:111], 0
    s_bfe_u32 s22, s42, 0x30004
    s_or_b32 s22, s22, s62
    s_lshl_b32 s22, s22, 18
    s_add_u32 s22, s22, s16
    s_add_u32 s22, s22, 0x22000
    s_add_u32 m0, s17, 0xc400
    s_nop 0
    buffer_load_dwordx4 v18, s[4:7], s22 offen lds
    ds_read_b64_tr_b16 v[84:85], v3 offset:768
    v_mfma_f32_16x16x32_bf16 v[40:43], v[92:95], v[124:127], 0
    ds_read_b64_tr_b16 v[86:87], v3 offset:4864
    s_waitcnt lgkmcnt(6)
    v_mfma_f32_16x16x32_bf16 v[44:47], v[96:99], v[108:111], 0
    ds_read_b64_tr_b16 v[88:89], v2 offset:800
    v_mfma_f32_16x16x32_bf16 v[48:51], v[96:99], v[124:127], 0
    s_bfe_u32 s22, s42, 0x30004
    s_or_b32 s22, s22, s62
    s_lshl_b32 s22, s22, 18
    s_add_u32 s22, s22, s16
    s_add_u32 s22, s22, 0x24000
    s_add_u32 m0, s17, 0xc800
    s_nop 0
    buffer_load_dwordx4 v17, s[4:7], s22 offen lds
    ds_read_b64_tr_b16 v[90:91], v2 offset:4896
    s_waitcnt lgkmcnt(6)
    v_mfma_f32_16x16x32_bf16 v[52:55], v[100:103], v[108:111], 0
    ds_read_b64_tr_b16 v[92:93], v3 offset:8192
    v_mfma_f32_16x16x32_bf16 v[56:59], v[100:103], v[124:127], 0
    ds_read_b64_tr_b16 v[94:95], v3 offset:12288
    s_waitcnt lgkmcnt(6)
    v_mfma_f32_16x16x32_bf16 v[60:63], v[104:107], v[108:111], 0
    s_bfe_u32 s22, s42, 0x30004
    s_or_b32 s22, s22, s62
    s_lshl_b32 s22, s22, 18
    s_add_u32 s22, s22, s16
    s_add_u32 s22, s22, 0x26000
    s_add_u32 m0, s17, 0xcc00
    s_nop 0
    buffer_load_dwordx4 v18, s[4:7], s22 offen lds
    ds_read_b64_tr_b16 v[96:97], v2 offset:8224
    v_mfma_f32_16x16x32_bf16 v[64:67], v[104:107], v[124:127], 0
    ds_read_b64_tr_b16 v[98:99], v2 offset:12320
    s_waitcnt lgkmcnt(6)
    v_mfma_f32_16x16x32_bf16 v[68:71], v[84:87], v[108:111], 0
    ds_read_b64_tr_b16 v[100:101], v3 offset:8448
    v_mfma_f32_16x16x32_bf16 v[72:75], v[84:87], v[124:127], 0
    s_bfe_u32 s22, s42, 0x30008
    s_or_b32 s22, s22, s62
    s_lshl_b32 s22, s22, 18
    s_add_u32 s22, s22, s16
    s_add_u32 s22, s22, 0x0
    s_add_u32 m0, s17, 0x10000
    s_nop 0
    buffer_load_dwordx4 v17, s[4:7], s22 offen lds
    ds_read_b64_tr_b16 v[102:103], v3 offset:12544
    s_waitcnt lgkmcnt(6)
    v_mfma_f32_16x16x32_bf16 v[76:79], v[88:91], v[108:111], 0
    ds_read_b64_tr_b16 v[104:105], v2 offset:8480
    v_mfma_f32_16x16x32_bf16 v[80:83], v[88:91], v[124:127], 0
    ds_read_b64_tr_b16 v[106:107], v2 offset:12576
    s_waitcnt lgkmcnt(6)
    v_mfma_f32_16x16x32_bf16 v[20:23], v[92:95], v[112:115], v[20:23]
    s_bfe_u32 s22, s42, 0x30008
    s_or_b32 s22, s22, s62
    s_lshl_b32 s22, s22, 18
    s_add_u32 s22, s22, s16
    s_add_u32 s22, s22, 0x2000
    s_add_u32 m0, s17, 0x10400
    s_nop 0
    buffer_load_dwordx4 v18, s[4:7], s22 offen lds
    ds_read_b64_tr_b16 v[84:85], v3 offset:8704
    v_mfma_f32_16x16x32_bf16 v[24:27], v[92:95], v[128:131], v[24:27]
    ds_read_b64_tr_b16 v[86:87], v3 offset:12800
    s_waitcnt lgkmcnt(6)
    v_mfma_f32_16x16x32_bf16 v[28:31], v[96:99], v[112:115], v[28:31]
    ds_read_b64_tr_b16 v[88:89], v2 offset:8736
    v_mfma_f32_16x16x32_bf16 v[32:35], v[96:99], v[128:131], v[32:35]
    s_bfe_u32 s22, s42, 0x30008
    s_or_b32 s22, s22, s62
    s_lshl_b32 s22, s22, 18
    s_add_u32 s22, s22, s16
    s_add_u32 s22, s22, 0x4000
    s_add_u32 m0, s17, 0x10800
    s_nop 0
    buffer_load_dwordx4 v17, s[4:7], s22 offen lds
    ds_read_b64_tr_b16 v[90:91], v2 offset:12832
    s_waitcnt lgkmcnt(6)
    v_mfma_f32_16x16x32_bf16 v[36:39], v[100:103], v[112:115], v[36:39]
    ds_read_b64_tr_b16 v[92:93], v3 offset:8960
    v_mfma_f32_16x16x32_bf16 v[40:43], v[100:103], v[128:131], v[40:43]
    ds_read_b64_tr_b16 v[94:95], v3 offset:13056
    s_waitcnt lgkmcnt(6)
    v_mfma_f32_16x16x32_bf16 v[44:47], v[104:107], v[112:115], v[44:47]
    s_bfe_u32 s22, s42, 0x30008
    s_or_b32 s22, s22, s62
    s_lshl_b32 s22, s22, 18
    s_add_u32 s22, s22, s16
    s_add_u32 s22, s22, 0x6000
    s_add_u32 m0, s17, 0x10c00
    s_nop 0
    buffer_load_dwordx4 v18, s[4:7], s22 offen lds
    ds_read_b64_tr_b16 v[96:97], v2 offset:8992
    v_mfma_f32_16x16x32_bf16 v[48:51], v[104:107], v[128:131], v[48:51]
    ds_read_b64_tr_b16 v[98:99], v2 offset:13088
    s_waitcnt lgkmcnt(6)
    v_mfma_f32_16x16x32_bf16 v[52:55], v[84:87], v[112:115], v[52:55]
    v_mfma_f32_16x16x32_bf16 v[56:59], v[84:87], v[128:131], v[56:59]
    s_bfe_u32 s22, s42, 0x30008
    s_or_b32 s22, s22, s62
    s_lshl_b32 s22, s22, 18
    s_add_u32 s22, s22, s16
    s_add_u32 s22, s22, 0x20000
    s_add_u32 m0, s17, 0x14000
    s_nop 0
    buffer_load_dwordx4 v17, s[4:7], s22 offen lds
    s_barrier
    ds_read_b64_tr_b16 v[100:101], v3 offset:16384
    ds_read_b64_tr_b16 v[102:103], v3 offset:20480
    s_waitcnt lgkmcnt(6)
    v_mfma_f32_16x16x32_bf16 v[60:63], v[88:91], v[112:115], v[60:63]
    ds_read_b64_tr_b16 v[104:105], v2 offset:16416
    v_mfma_f32_16x16x32_bf16 v[64:67], v[88:91], v[128:131], v[64:67]
    s_bfe_u32 s22, s42, 0x3000c
    s_or_b32 s22, s22, s62
    s_lshl_b32 s22, s22, 18
    s_add_u32 s22, s22, s16
    s_add_u32 s22, s22, 0x0
    s_add_u32 m0, s17, 0x18000
    s_nop 0
    buffer_load_dwordx4 v17, s[4:7], s22 offen lds
    ds_read_b64_tr_b16 v[106:107], v2 offset:20512
    s_waitcnt lgkmcnt(6)
    v_mfma_f32_16x16x32_bf16 v[68:71], v[92:95], v[112:115], v[68:71]
    s_bfe_u32 s22, s42, 0x30008
    s_or_b32 s22, s22, s62
    s_lshl_b32 s22, s22, 18
    s_add_u32 s22, s22, s16
    s_add_u32 s22, s22, 0x22000
    s_add_u32 m0, s17, 0x14400
    s_nop 0
    buffer_load_dwordx4 v18, s[4:7], s22 offen lds
    ds_read_b64_tr_b16 v[84:85], v3 offset:16640
    v_mfma_f32_16x16x32_bf16 v[72:75], v[92:95], v[128:131], v[72:75]
    ds_read_b64_tr_b16 v[86:87], v3 offset:20736
    s_waitcnt lgkmcnt(6)
    v_mfma_f32_16x16x32_bf16 v[76:79], v[96:99], v[112:115], v[76:79]
    ds_read_b64_tr_b16 v[88:89], v2 offset:16672
    v_mfma_f32_16x16x32_bf16 v[80:83], v[96:99], v[128:131], v[80:83]
    s_bfe_u32 s22, s42, 0x30008
    s_or_b32 s22, s22, s62
    s_lshl_b32 s22, s22, 18
    s_add_u32 s22, s22, s16
    s_add_u32 s22, s22, 0x24000
    s_add_u32 m0, s17, 0x14800
    s_nop 0
    buffer_load_dwordx4 v17, s[4:7], s22 offen lds
    ds_read_b64_tr_b16 v[90:91], v2 offset:20768
    s_waitcnt lgkmcnt(6)
    v_mfma_f32_16x16x32_bf16 v[20:23], v[100:103], v[116:119], v[20:23]
    ds_read_b64_tr_b16 v[92:93], v3 offset:16896
    v_mfma_f32_16x16x32_bf16 v[24:27], v[100:103], v[132:135], v[24:27]
    ds_read_b64_tr_b16 v[94:95], v3 offset:20992
    s_waitcnt lgkmcnt(6)
    v_mfma_f32_16x16x32_bf16 v[28:31], v[104:107], v[116:119], v[28:31]
    s_bfe_u32 s22, s42, 0x30008
    s_or_b32 s22, s22, s62
    s_lshl_b32 s22, s22, 18
    s_add_u32 s22, s22, s16
    s_add_u32 s22, s22, 0x26000
    s_add_u32 m0, s17, 0x14c00
    s_nop 0
    buffer_load_dwordx4 v18, s[4:7], s22 offen lds
    ds_read_b64_tr_b16 v[96:97], v2 offset:16928
    v_mfma_f32_16x16x32_bf16 v[32:35], v[104:107], v[132:135], v[32:35]
    s_bfe_u32 s22, s42, 0x3000c
    s_or_b32 s22, s22, s62
    s_lshl_b32 s22, s22, 18
    s_add_u32 s22, s22, s16
    s_add_u32 s22, s22, 0x2000
    s_add_u32 m0, s17, 0x18400
    s_nop 0
    buffer_load_dwordx4 v18, s[4:7], s22 offen lds
    ds_read_b64_tr_b16 v[98:99], v2 offset:21024
    s_waitcnt lgkmcnt(6)
    v_mfma_f32_16x16x32_bf16 v[36:39], v[84:87], v[116:119], v[36:39]
    ds_read_b64_tr_b16 v[100:101], v3 offset:17152
    v_mfma_f32_16x16x32_bf16 v[40:43], v[84:87], v[132:135], v[40:43]
    ds_read_b64_tr_b16 v[102:103], v3 offset:21248
    s_waitcnt lgkmcnt(6)
    v_mfma_f32_16x16x32_bf16 v[44:47], v[88:91], v[116:119], v[44:47]
    ds_read_b64_tr_b16 v[104:105], v2 offset:17184
    v_mfma_f32_16x16x32_bf16 v[48:51], v[88:91], v[132:135], v[48:51]
    ds_read_b64_tr_b16 v[106:107], v2 offset:21280
    s_waitcnt lgkmcnt(6)
    v_mfma_f32_16x16x32_bf16 v[52:55], v[92:95], v[116:119], v[52:55]
    ds_read_b64_tr_b16 v[84:85], v3 offset:24576
    v_mfma_f32_16x16x32_bf16 v[56:59], v[92:95], v[132:135], v[56:59]
    ds_read_b64_tr_b16 v[86:87], v3 offset:28672
    s_waitcnt lgkmcnt(6)
    v_mfma_f32_16x16x32_bf16 v[60:63], v[96:99], v[116:119], v[60:63]
    ds_read_b64_tr_b16 v[88:89], v2 offset:24608
    v_mfma_f32_16x16x32_bf16 v[64:67], v[96:99], v[132:135], v[64:67]
    s_bfe_u32 s22, s42, 0x3000c
    s_or_b32 s22, s22, s62
    s_lshl_b32 s22, s22, 18
    s_add_u32 s22, s22, s16
    s_add_u32 s22, s22, 0x4000
    s_add_u32 m0, s17, 0x18800
    s_nop 0
    buffer_load_dwordx4 v17, s[4:7], s22 offen lds
    ds_read_b64_tr_b16 v[90:91], v2 offset:28704
    s_waitcnt lgkmcnt(6)
    v_mfma_f32_16x16x32_bf16 v[68:71], v[100:103], v[116:119], v[68:71]
    ds_read_b64_tr_b16 v[92:93], v3 offset:24832
    v_mfma_f32_16x16x32_bf16 v[72:75], v[100:103], v[132:135], v[72:75]
    ds_read_b64_tr_b16 v[94:95], v3 offset:28928
    s_waitcnt lgkmcnt(6)
    v_mfma_f32_16x16x32_bf16 v[76:79], v[104:107], v[116:119], v[76:79]
    ds_read_b64_tr_b16 v[96:97], v2 offset:24864
    v_mfma_f32_16x16x32_bf16 v[80:83], v[104:107], v[132:135], v[80:83]
    ds_read_b64_tr_b16 v[98:99], v2 offset:28960
    s_waitcnt lgkmcnt(6)
    v_mfma_f32_16x16x32_bf16 v[20:23], v[84:87], v[120:123], v[20:23]
    ds_read_b64_tr_b16 v[100:101], v3 offset:25088
    v_mfma_f32_16x16x32_bf16 v[24:27], v[84:87], v[136:139], v[24:27]
    ds_read_b64_tr_b16 v[102:103], v3 offset:29184
    s_waitcnt lgkmcnt(6)
    v_mfma_f32_16x16x32_bf16 v[28:31], v[88:91], v[120:123], v[28:31]
    ds_read_b64_tr_b16 v[104:105], v2 offset:25120
    v_mfma_f32_16x16x32_bf16 v[32:35], v[88:91], v[136:139], v[32:35]
    s_bfe_u32 s22, s42, 0x3000c
    s_or_b32 s22, s22, s62
    s_lshl_b32 s22, s22, 18
    s_add_u32 s22, s22, s16
    s_add_u32 s22, s22, 0x6000
    s_add_u32 m0, s17, 0x18c00
    s_nop 0
    buffer_load_dwordx4 v18, s[4:7], s22 offen lds
    ds_read_b64_tr_b16 v[106:107], v2 offset:29216
    s_waitcnt lgkmcnt(6)
    v_mfma_f32_16x16x32_bf16 v[36:39], v[92:95], v[120:123], v[36:39]
    ds_read_b64_tr_b16 v[84:85], v3 offset:25344
    v_mfma_f32_16x16x32_bf16 v[40:43], v[92:95], v[136:139], v[40:43]
    ds_read_b64_tr_b16 v[86:87], v3 offset:29440
    s_waitcnt lgkmcnt(6)
    v_mfma_f32_16x16x32_bf16 v[44:47], v[96:99], v[120:123], v[44:47]
    ds_read_b64_tr_b16 v[88:89], v2 offset:25376
    v_mfma_f32_16x16x32_bf16 v[48:51], v[96:99], v[136:139], v[48:51]
    ds_read_b64_tr_b16 v[90:91], v2 offset:29472
    s_waitcnt lgkmcnt(6)
    v_mfma_f32_16x16x32_bf16 v[52:55], v[100:103], v[120:123], v[52:55]
    v_mfma_f32_16x16x32_bf16 v[56:59], v[100:103], v[136:139], v[56:59]
    s_barrier
    ds_read_b64_tr_b16 v[92:93], v3 offset:32768
    ds_read_b64_tr_b16 v[94:95], v3 offset:36864
    s_waitcnt lgkmcnt(6)
    v_mfma_f32_16x16x32_bf16 v[60:63], v[104:107], v[120:123], v[60:63]
    ds_read_b64_tr_b16 v[96:97], v2 offset:32800
    v_mfma_f32_16x16x32_bf16 v[64:67], v[104:107], v[136:139], v[64:67]
    s_bfe_u32 s22, s42, 0x3000c
    s_or_b32 s22, s22, s62
    s_lshl_b32 s22, s22, 18
    s_add_u32 s22, s22, s16
    s_add_u32 s22, s22, 0x20000
    s_add_u32 m0, s17, 0x1c000
    s_nop 0
    buffer_load_dwordx4 v17, s[4:7], s22 offen lds
    ds_read_b64_tr_b16 v[98:99], v2 offset:36896
    s_waitcnt lgkmcnt(6)
    v_mfma_f32_16x16x32_bf16 v[68:71], v[84:87], v[120:123], v[68:71]
    ds_read_b64_tr_b16 v[100:101], v3 offset:33024
    v_mfma_f32_16x16x32_bf16 v[72:75], v[84:87], v[136:139], v[72:75]
    ds_read_b64_tr_b16 v[102:103], v3 offset:37120
    s_waitcnt lgkmcnt(6)
    v_mfma_f32_16x16x32_bf16 v[76:79], v[88:91], v[120:123], v[76:79]
    ds_read_b64_tr_b16 v[104:105], v2 offset:33056
    v_mfma_f32_16x16x32_bf16 v[80:83], v[88:91], v[136:139], v[80:83]
    ds_read_b64_tr_b16 v[106:107], v2 offset:37152
    v_and_b32 v9, 7, v0
    v_lshlrev_b32 v9, 2, v9
    s_mov_b32 s27, 0
fz_oAp:
    buffer_load_dword v10, v9, s[8:11], s20 offen sc1
    s_waitcnt vmcnt(0)
    v_cmp_ne_u32 vcc, s14, v10
    s_and_b32 vcc_lo, vcc_lo, 0xdd
    s_mov_b32 vcc_hi, 0
    s_add_u32 s27, s27, 1
    s_cmp_ge_u32 s27, 65536
    s_cbranch_scc1 fz_oAg
    s_cbranch_vccz fz_oAg
    s_sleep 1
    s_branch fz_oAp
fz_oAg:
    s_bfe_u32 s21, s42, 0x30004
    s_or_b32 s21, s21, s62
    s_lshl_b32 s21, s21, 12
    s_add_u32 s23, s21, 0x1000000
    buffer_load_dwordx4 v[140:143], v4, s[8:11], s23 offen offset:0 sc1
    s_add_u32 s23, s21, 0x1020000
    buffer_load_dwordx4 v[144:147], v4, s[8:11], s23 offen offset:0 sc1
    s_add_u32 s23, s21, 0x1000000
    buffer_load_dwordx4 v[148:151], v4, s[8:11], s23 offen offset:1024 sc1
    s_add_u32 s23, s21, 0x1020000
    buffer_load_dwordx4 v[152:155], v4, s[8:11], s23 offen offset:1024 sc1
    s_add_u32 s23, s21, 0x1000800
    buffer_load_dwordx4 v[156:159], v4, s[8:11], s23 offen offset:0 sc1
    s_add_u32 s23, s21, 0x1020800
    buffer_load_dwordx4 v[160:163], v4, s[8:11], s23 offen offset:0 sc1
    s_add_u32 s23, s21, 0x1000800
    buffer_load_dwordx4 v[164:167], v4, s[8:11], s23 offen offset:1024 sc1
    s_add_u32 s23, s21, 0x1020800
    buffer_load_dwordx4 v[168:171], v4, s[8:11], s23 offen offset:1024 sc1
    s_bfe_u32 s21, s42, 0x30008
    s_or_b32 s21, s21, s62
    s_lshl_b32 s21, s21, 12
    s_add_u32 s23, s21, 0x1000000
    buffer_load_dwordx4 v[188:191], v4, s[8:11], s23 offen offset:0 sc1
    s_add_u32 s23, s21, 0x1020000
    buffer_load_dwordx4 v[192:195], v4, s[8:11], s23 offen offset:0 sc1
    s_add_u32 s23, s21, 0x1000000
    buffer_load_dwordx4 v[196:199], v4, s[8:11], s23 offen offset:1024 sc1
    s_add_u32 s23, s21, 0x1020000
    buffer_load_dwordx4 v[200:203], v4, s[8:11], s23 offen offset:1024 sc1
    s_waitcnt vmcnt(11) lgkmcnt(6)
    v_mfma_f32_16x16x32_bf16 v[20:23], v[92:95], v[140:143], v[20:23]
    ds_read_b64_tr_b16 v[84:85], v3 offset:33280
    s_waitcnt vmcnt(10)
    v_mfma_f32_16x16x32_bf16 v[24:27], v[92:95], v[144:147], v[24:27]
    ds_read_b64_tr_b16 v[86:87], v3 offset:37376
    s_waitcnt lgkmcnt(6)
    v_mfma_f32_16x16x32_bf16 v[28:31], v[96:99], v[140:143], v[28:31]
    ds_read_b64_tr_b16 v[88:89], v2 offset:33312
    v_mfma_f32_16x16x32_bf16 v[32:35], v[96:99], v[144:147], v[32:35]
    s_bfe_u32 s22, s42, 0x3000c
    s_or_b32 s22, s22, s62
    s_lshl_b32 s22, s22, 18
    s_add_u32 s22, s22, s16
    s_add_u32 s22, s22, 0x22000
    s_add_u32 m0, s17, 0x1c400
    s_nop 0
    buffer_load_dwordx4 v18, s[4:7], s22 offen lds
    ds_read_b64_tr_b16 v[90:91], v2 offset:37408
    s_waitcnt lgkmcnt(6)
    v_mfma_f32_16x16x32_bf16 v[36:39], v[100:103], v[140:143], v[36:39]
    ds_read_b64_tr_b16 v[92:93], v3 offset:33536
    v_mfma_f32_16x16x32_bf16 v[40:43], v[100:103], v[144:147], v[40:43]
    ds_read_b64_tr_b16 v[94:95], v3 offset:37632
    s_waitcnt lgkmcnt(6)
    v_mfma_f32_16x16x32_bf16 v[44:47], v[104:107], v[140:143], v[44:47]
    ds_read_b64_tr_b16 v[96:97], v2 offset:33568
    v_mfma_f32_16x16x32_bf16 v[48:51], v[104:107], v[144:147], v[48:51]
    ds_read_b64_tr_b16 v[98:99], v2 offset:37664
    s_add_u32 s23, s21, 0x1000800
    buffer_load_dwordx4 v[108:111], v4, s[8:11], s23 offen offset:0 sc1
    s_waitcnt lgkmcnt(6)
    v_mfma_f32_16x16x32_bf16 v[52:55], v[84:87], v[140:143], v[52:55]
    ds_read_b64_tr_b16 v[100:101], v3 offset:40960
    v_mfma_f32_16x16x32_bf16 v[56:59], v[84:87], v[144:147], v[56:59]
    ds_read_b64_tr_b16 v[102:103], v3 offset:45056
    s_waitcnt lgkmcnt(6)
    v_mfma_f32_16x16x32_bf16 v[60:63], v[88:91], v[140:143], v[60:63]
    ds_read_b64_tr_b16 v[104:105], v2 offset:40992
    v_mfma_f32_16x16x32_bf16 v[64:67], v[88:91], v[144:147], v[64:67]
    s_bfe_u32 s22, s42, 0x3000c
    s_or_b32 s22, s22, s62
    s_lshl_b32 s22, s22, 18
    s_add_u32 s22, s22, s16
    s_add_u32 s22, s22, 0x24000
    s_add_u32 m0, s17, 0x1c800
    s_nop 0
    buffer_load_dwordx4 v17, s[4:7], s22 offen lds
    ds_read_b64_tr_b16 v[106:107], v2 offset:45088
    s_waitcnt lgkmcnt(6)
    v_mfma_f32_16x16x32_bf16 v[68:71], v[92:95], v[140:143], v[68:71]
    ds_read_b64_tr_b16 v[84:85], v3 offset:41216
    v_mfma_f32_16x16x32_bf16 v[72:75], v[92:95], v[144:147], v[72:75]
    ds_read_b64_tr_b16 v[86:87], v3 offset:45312
    s_waitcnt lgkmcnt(6)
    v_mfma_f32_16x16x32_bf16 v[76:79], v[96:99], v[140:143], v[76:79]
    ds_read_b64_tr_b16 v[88:89], v2 offset:41248
    v_mfma_f32_16x16x32_bf16 v[80:83], v[96:99], v[144:147], v[80:83]
    ds_read_b64_tr_b16 v[90:91], v2 offset:45344
    s_add_u32 s23, s21, 0x1020800
    buffer_load_dwordx4 v[112:115], v4, s[8:11], s23 offen offset:0 sc1
    s_waitcnt vmcnt(13) lgkmcnt(6)
    v_mfma_f32_16x16x32_bf16 v[20:23], v[100:103], v[148:151], v[20:23]
    ds_read_b64_tr_b16 v[92:93], v3 offset:41472
    s_waitcnt vmcnt(12)
    v_mfma_f32_16x16x32_bf16 v[24:27], v[100:103], v[152:155], v[24:27]
    ds_read_b64_tr_b16 v[94:95], v3 offset:45568
    s_waitcnt lgkmcnt(6)
    v_mfma_f32_16x16x32_bf16 v[28:31], v[104:107], v[148:151], v[28:31]
    ds_read_b64_tr_b16 v[96:97], v2 offset:41504
    v_mfma_f32_16x16x32_bf16 v[32:35], v[104:107], v[152:155], v[32:35]
    s_bfe_u32 s22, s42, 0x3000c
    s_or_b32 s22, s22, s62
    s_lshl_b32 s22, s22, 18
    s_add_u32 s22, s22, s16
    s_add_u32 s22, s22, 0x26000
    s_add_u32 m0, s17, 0x1cc00
    s_nop 0
    buffer_load_dwordx4 v18, s[4:7], s22 offen lds
    ds_read_b64_tr_b16 v[98:99], v2 offset:45600
    s_waitcnt lgkmcnt(6)
    v_mfma_f32_16x16x32_bf16 v[36:39], v[84:87], v[148:151], v[36:39]
    ds_read_b64_tr_b16 v[100:101], v3 offset:41728
    v_mfma_f32_16x16x32_bf16 v[40:43], v[84:87], v[152:155], v[40:43]
    ds_read_b64_tr_b16 v[102:103], v3 offset:45824
    s_waitcnt lgkmcnt(6)
    v_mfma_f32_16x16x32_bf16 v[44:47], v[88:91], v[148:151], v[44:47]
    ds_read_b64_tr_b16 v[104:105], v2 offset:41760
    v_mfma_f32_16x16x32_bf16 v[48:51], v[88:91], v[152:155], v[48:51]
    ds_read_b64_tr_b16 v[106:107], v2 offset:45856
    s_add_u32 s23, s21, 0x1000800
    buffer_load_dwordx4 v[116:119], v4, s[8:11], s23 offen offset:1024 sc1
    s_waitcnt lgkmcnt(6)
    v_mfma_f32_16x16x32_bf16 v[52:55], v[92:95], v[148:151], v[52:55]
    v_mfma_f32_16x16x32_bf16 v[56:59], v[92:95], v[152:155], v[56:59]
    s_barrier
    ds_read_b64_tr_b16 v[84:85], v3 offset:49152
    ds_read_b64_tr_b16 v[86:87], v3 offset:53248
    s_waitcnt lgkmcnt(6)
    v_mfma_f32_16x16x32_bf16 v[60:63], v[96:99], v[148:151], v[60:63]
    ds_read_b64_tr_b16 v[88:89], v2 offset:49184
    v_mfma_f32_16x16x32_bf16 v[64:67], v[96:99], v[152:155], v[64:67]
    s_bfe_u32 s22, s42, 0x30010
    s_or_b32 s22, s22, s62
    s_lshl_b32 s22, s22, 18
    s_add_u32 s22, s22, s16
    s_add_u32 s22, s22, 0x0
    s_add_u32 m0, s17, 0x0
    s_nop 0
    buffer_load_dwordx4 v17, s[4:7], s22 offen lds
    ds_read_b64_tr_b16 v[90:91], v2 offset:53280
    s_waitcnt lgkmcnt(6)
    v_mfma_f32_16x16x32_bf16 v[68:71], v[100:103], v[148:151], v[68:71]
    ds_read_b64_tr_b16 v[92:93], v3 offset:49408
    v_mfma_f32_16x16x32_bf16 v[72:75], v[100:103], v[152:155], v[72:75]
    ds_read_b64_tr_b16 v[94:95], v3 offset:53504
    s_waitcnt lgkmcnt(6)
    v_mfma_f32_16x16x32_bf16 v[76:79], v[104:107], v[148:151], v[76:79]
    ds_read_b64_tr_b16 v[96:97], v2 offset:49440
    v_mfma_f32_16x16x32_bf16 v[80:83], v[104:107], v[152:155], v[80:83]
    ds_read_b64_tr_b16 v[98:99], v2 offset:53536
    s_add_u32 s23, s21, 0x1020800
    buffer_load_dwordx4 v[120:123], v4, s[8:11], s23 offen offset:1024 sc1
    s_waitcnt vmcnt(15) lgkmcnt(6)
    v_mfma_f32_16x16x32_bf16 v[20:23], v[84:87], v[156:159], v[20:23]
    ds_read_b64_tr_b16 v[100:101], v3 offset:49664
    s_waitcnt vmcnt(14)
    v_mfma_f32_16x16x32_bf16 v[24:27], v[84:87], v[160:163], v[24:27]
    ds_read_b64_tr_b16 v[102:103], v3 offset:53760
    s_waitcnt lgkmcnt(6)
    v_mfma_f32_16x16x32_bf16 v[28:31], v[88:91], v[156:159], v[28:31]
    ds_read_b64_tr_b16 v[104:105], v2 offset:49696
    v_mfma_f32_16x16x32_bf16 v[32:35], v[88:91], v[160:163], v[32:35]
    s_bfe_u32 s22, s42, 0x30010
    s_or_b32 s22, s22, s62
    s_lshl_b32 s22, s22, 18
    s_add_u32 s22, s22, s16
    s_add_u32 s22, s22, 0x2000
    s_add_u32 m0, s17, 0x400
    s_nop 0
    buffer_load_dwordx4 v18, s[4:7], s22 offen lds
    ds_read_b64_tr_b16 v[106:107], v2 offset:53792
    s_waitcnt lgkmcnt(6)
    v_mfma_f32_16x16x32_bf16 v[36:39], v[92:95], v[156:159], v[36:39]
    ds_read_b64_tr_b16 v[84:85], v3 offset:49920
    v_mfma_f32_16x16x32_bf16 v[40:43], v[92:95], v[160:163], v[40:43]
    ds_read_b64_tr_b16 v[86:87], v3 offset:54016
    s_waitcnt lgkmcnt(6)
    v_mfma_f32_16x16x32_bf16 v[44:47], v[96:99], v[156:159], v[44:47]
    ds_read_b64_tr_b16 v[88:89], v2 offset:49952
    v_mfma_f32_16x16x32_bf16 v[48:51], v[96:99], v[160:163], v[48:51]
    ds_read_b64_tr_b16 v[90:91], v2 offset:54048
    s_bfe_u32 s21, s42, 0x3000c
    s_or_b32 s21, s21, s62
    s_lshl_b32 s21, s21, 12
    s_add_u32 s23, s21, 0x1000000
    buffer_load_dwordx4 v[140:143], v4, s[8:11], s23 offen offset:0 sc1
    s_waitcnt lgkmcnt(6)
    v_mfma_f32_16x16x32_bf16 v[52:55], v[100:103], v[156:159], v[52:55]
    ds_read_b64_tr_b16 v[92:93], v3 offset:57344
    v_mfma_f32_16x16x32_bf16 v[56:59], v[100:103], v[160:163], v[56:59]
    ds_read_b64_tr_b16 v[94:95], v3 offset:61440
    s_waitcnt lgkmcnt(6)
    v_mfma_f32_16x16x32_bf16 v[60:63], v[104:107], v[156:159], v[60:63]
    ds_read_b64_tr_b16 v[96:97], v2 offset:57376
    v_mfma_f32_16x16x32_bf16 v[64:67], v[104:107], v[160:163], v[64:67]
    s_bfe_u32 s22, s42, 0x30010
    s_or_b32 s22, s22, s62
    s_lshl_b32 s22, s22, 18
    s_add_u32 s22, s22, s16
    s_add_u32 s22, s22, 0x4000
    s_add_u32 m0, s17, 0x800
    s_nop 0
    buffer_load_dwordx4 v17, s[4:7], s22 offen lds
    ds_read_b64_tr_b16 v[98:99], v2 offset:61472
    s_waitcnt lgkmcnt(6)
    v_mfma_f32_16x16x32_bf16 v[68:71], v[84:87], v[156:159], v[68:71]
    ds_read_b64_tr_b16 v[100:101], v3 offset:57600
    v_mfma_f32_16x16x32_bf16 v[72:75], v[84:87], v[160:163], v[72:75]
    ds_read_b64_tr_b16 v[102:103], v3 offset:61696
    s_waitcnt lgkmcnt(6)
    v_mfma_f32_16x16x32_bf16 v[76:79], v[88:91], v[156:159], v[76:79]
    ds_read_b64_tr_b16 v[104:105], v2 offset:57632
    v_mfma_f32_16x16x32_bf16 v[80:83], v[88:91], v[160:163], v[80:83]
    ds_read_b64_tr_b16 v[106:107], v2 offset:61728
    s_add_u32 s23, s21, 0x1020000
    buffer_load_dwordx4 v[144:147], v4, s[8:11], s23 offen offset:0 sc1
    s_waitcnt vmcnt(17) lgkmcnt(6)
    v_mfma_f32_16x16x32_bf16 v[20:23], v[92:95], v[164:167], v[20:23]
    ds_read_b64_tr_b16 v[84:85], v3 offset:57856
    s_waitcnt vmcnt(16)
    v_mfma_f32_16x16x32_bf16 v[24:27], v[92:95], v[168:171], v[24:27]
    ds_read_b64_tr_b16 v[86:87], v3 offset:61952
    s_waitcnt lgkmcnt(6)
    v_mfma_f32_16x16x32_bf16 v[28:31], v[96:99], v[164:167], v[28:31]
    ds_read_b64_tr_b16 v[88:89], v2 offset:57888
    v_mfma_f32_16x16x32_bf16 v[32:35], v[96:99], v[168:171], v[32:35]
    s_bfe_u32 s22, s42, 0x30010
    s_or_b32 s22, s22, s62
    s_lshl_b32 s22, s22, 18
    s_add_u32 s22, s22, s16
    s_add_u32 s22, s22, 0x6000
    s_add_u32 m0, s17, 0xc00
    s_nop 0
    buffer_load_dwordx4 v18, s[4:7], s22 offen lds
    ds_read_b64_tr_b16 v[90:91], v2 offset:61984
    s_waitcnt lgkmcnt(6)
    v_mfma_f32_16x16x32_bf16 v[36:39], v[100:103], v[164:167], v[36:39]
    ds_read_b64_tr_b16 v[92:93], v3 offset:58112
    v_mfma_f32_16x16x32_bf16 v[40:43], v[100:103], v[168:171], v[40:43]
    ds_read_b64_tr_b16 v[94:95], v3 offset:62208
    s_waitcnt lgkmcnt(6)
    v_mfma_f32_16x16x32_bf16 v[44:47], v[104:107], v[164:167], v[44:47]
    ds_read_b64_tr_b16 v[96:97], v2 offset:58144
    v_mfma_f32_16x16x32_bf16 v[48:51], v[104:107], v[168:171], v[48:51]
    ds_read_b64_tr_b16 v[98:99], v2 offset:62240
    s_add_u32 s23, s21, 0x1000000
    buffer_load_dwordx4 v[148:151], v4, s[8:11], s23 offen offset:1024 sc1
    s_waitcnt lgkmcnt(6)
    v_mfma_f32_16x16x32_bf16 v[52:55], v[84:87], v[164:167], v[52:55]
    v_mfma_f32_16x16x32_bf16 v[56:59], v[84:87], v[168:171], v[56:59]
    s_barrier
    ds_read_b64_tr_b16 v[100:101], v15 offset:0
    ds_read_b64_tr_b16 v[102:103], v15 offset:4096
    s_waitcnt lgkmcnt(6)
    v_mfma_f32_16x16x32_bf16 v[60:63], v[88:91], v[164:167], v[60:63]
    ds_read_b64_tr_b16 v[104:105], v16 offset:32
    v_mfma_f32_16x16x32_bf16 v[64:67], v[88:91], v[168:171], v[64:67]
    s_bfe_u32 s22, s42, 0x30010
    s_or_b32 s22, s22, s62
    s_lshl_b32 s22, s22, 18
    s_add_u32 s22, s22, s16
    s_add_u32 s22, s22, 0x20000
    s_add_u32 m0, s17, 0x4000
    s_nop 0
    buffer_load_dwordx4 v17, s[4:7], s22 offen lds
    ds_read_b64_tr_b16 v[106:107], v16 offset:4128
    s_waitcnt lgkmcnt(6)
    v_mfma_f32_16x16x32_bf16 v[68:71], v[92:95], v[164:167], v[68:71]
    ds_read_b64_tr_b16 v[84:85], v15 offset:256
    v_mfma_f32_16x16x32_bf16 v[72:75], v[92:95], v[168:171], v[72:75]
    ds_read_b64_tr_b16 v[86:87], v15 offset:4352
    s_waitcnt lgkmcnt(6)
    v_mfma_f32_16x16x32_bf16 v[76:79], v[96:99], v[164:167], v[76:79]
    ds_read_b64_tr_b16 v[88:89], v16 offset:288
    v_mfma_f32_16x16x32_bf16 v[80:83], v[96:99], v[168:171], v[80:83]
    ds_read_b64_tr_b16 v[90:91], v16 offset:4384
    s_add_u32 s23, s21, 0x1020000
    buffer_load_dwordx4 v[152:155], v4, s[8:11], s23 offen offset:1024 sc1
    s_waitcnt vmcnt(19) lgkmcnt(6)
    v_mfma_f32_16x16x32_bf16 v[20:23], v[100:103], v[188:191], v[20:23]
    ds_read_b64_tr_b16 v[92:93], v15 offset:512
    s_waitcnt vmcnt(18)
    v_mfma_f32_16x16x32_bf16 v[24:27], v[100:103], v[192:195], v[24:27]
    ds_read_b64_tr_b16 v[94:95], v15 offset:4608
    s_waitcnt lgkmcnt(6)
    v_mfma_f32_16x16x32_bf16 v[28:31], v[104:107], v[188:191], v[28:31]
    ds_read_b64_tr_b16 v[96:97], v16 offset:544
    v_mfma_f32_16x16x32_bf16 v[32:35], v[104:107], v[192:195], v[32:35]
    s_bfe_u32 s22, s42, 0x30010
    s_or_b32 s22, s22, s62
    s_lshl_b32 s22, s22, 18
    s_add_u32 s22, s22, s16
    s_add_u32 s22, s22, 0x22000
    s_add_u32 m0, s17, 0x4400
    s_nop 0
    buffer_load_dwordx4 v18, s[4:7], s22 offen lds
    ds_read_b64_tr_b16 v[98:99], v16 offset:4640
    s_waitcnt lgkmcnt(6)
    v_mfma_f32_16x16x32_bf16 v[36:39], v[84:87], v[188:191], v[36:39]
    ds_read_b64_tr_b16 v[100:101], v15 offset:768
    v_mfma_f32_16x16x32_bf16 v[40:43], v[84:87], v[192:195], v[40:43]
    ds_read_b64_tr_b16 v[102:103], v15 offset:4864
    s_waitcnt lgkmcnt(6)
    v_mfma_f32_16x16x32_bf16 v[44:47], v[88:91], v[188:191], v[44:47]
    ds_read_b64_tr_b16 v[104:105], v16 offset:800
    v_mfma_f32_16x16x32_bf16 v[48:51], v[88:91], v[192:195], v[48:51]
    ds_read_b64_tr_b16 v[106:107], v16 offset:4896
    s_add_u32 s23, s21, 0x1000800
    buffer_load_dwordx4 v[156:159], v4, s[8:11], s23 offen offset:0 sc1
    s_waitcnt lgkmcnt(6)
    v_mfma_f32_16x16x32_bf16 v[52:55], v[92:95], v[188:191], v[52:55]
    ds_read_b64_tr_b16 v[84:85], v15 offset:8192
    v_mfma_f32_16x16x32_bf16 v[56:59], v[92:95], v[192:195], v[56:59]
    ds_read_b64_tr_b16 v[86:87], v15 offset:12288
    s_waitcnt lgkmcnt(6)
    v_mfma_f32_16x16x32_bf16 v[60:63], v[96:99], v[188:191], v[60:63]
    ds_read_b64_tr_b16 v[88:89], v16 offset:8224
    v_mfma_f32_16x16x32_bf16 v[64:67], v[96:99], v[192:195], v[64:67]
    s_bfe_u32 s22, s42, 0x30010
    s_or_b32 s22, s22, s62
    s_lshl_b32 s22, s22, 18
    s_add_u32 s22, s22, s16
    s_add_u32 s22, s22, 0x24000
    s_add_u32 m0, s17, 0x4800
    s_nop 0
    buffer_load_dwordx4 v17, s[4:7], s22 offen lds
    ds_read_b64_tr_b16 v[90:91], v16 offset:12320
    s_waitcnt lgkmcnt(6)
    v_mfma_f32_16x16x32_bf16 v[68:71], v[100:103], v[188:191], v[68:71]
    ds_read_b64_tr_b16 v[92:93], v15 offset:8448
    v_mfma_f32_16x16x32_bf16 v[72:75], v[100:103], v[192:195], v[72:75]
    ds_read_b64_tr_b16 v[94:95], v15 offset:12544
    s_waitcnt lgkmcnt(6)
    v_mfma_f32_16x16x32_bf16 v[76:79], v[104:107], v[188:191], v[76:79]
    ds_read_b64_tr_b16 v[96:97], v16 offset:8480
    v_mfma_f32_16x16x32_bf16 v[80:83], v[104:107], v[192:195], v[80:83]
    ds_read_b64_tr_b16 v[98:99], v16 offset:12576
    s_add_u32 s23, s21, 0x1020800
    buffer_load_dwordx4 v[160:163], v4, s[8:11], s23 offen offset:0 sc1
    s_waitcnt vmcnt(21) lgkmcnt(6)
    v_mfma_f32_16x16x32_bf16 v[20:23], v[84:87], v[196:199], v[20:23]
    ds_read_b64_tr_b16 v[100:101], v15 offset:8704
    s_waitcnt vmcnt(20)
    v_mfma_f32_16x16x32_bf16 v[24:27], v[84:87], v[200:203], v[24:27]
    ds_read_b64_tr_b16 v[102:103], v15 offset:12800
    s_waitcnt lgkmcnt(6)
    v_mfma_f32_16x16x32_bf16 v[28:31], v[88:91], v[196:199], v[28:31]
    ds_read_b64_tr_b16 v[104:105], v16 offset:8736
    v_mfma_f32_16x16x32_bf16 v[32:35], v[88:91], v[200:203], v[32:35]
    s_bfe_u32 s22, s42, 0x30010
    s_or_b32 s22, s22, s62
    s_lshl_b32 s22, s22, 18
    s_add_u32 s22, s22, s16
    s_add_u32 s22, s22, 0x26000
    s_add_u32 m0, s17, 0x4c00
    s_nop 0
    buffer_load_dwordx4 v18, s[4:7], s22 offen lds
    ds_read_b64_tr_b16 v[106:107], v16 offset:12832
    s_waitcnt lgkmcnt(6)
    v_mfma_f32_16x16x32_bf16 v[36:39], v[92:95], v[196:199], v[36:39]
    ds_read_b64_tr_b16 v[84:85], v15 offset:8960
    v_mfma_f32_16x16x32_bf16 v[40:43], v[92:95], v[200:203], v[40:43]
    ds_read_b64_tr_b16 v[86:87], v15 offset:13056
    s_waitcnt lgkmcnt(6)
    v_mfma_f32_16x16x32_bf16 v[44:47], v[96:99], v[196:199], v[44:47]
    ds_read_b64_tr_b16 v[88:89], v16 offset:8992
    v_mfma_f32_16x16x32_bf16 v[48:51], v[96:99], v[200:203], v[48:51]
    ds_read_b64_tr_b16 v[90:91], v16 offset:13088
    s_add_u32 s23, s21, 0x1000800
    buffer_load_dwordx4 v[164:167], v4, s[8:11], s23 offen offset:1024 sc1
    s_waitcnt lgkmcnt(6)
    v_mfma_f32_16x16x32_bf16 v[52:55], v[100:103], v[196:199], v[52:55]
    v_mfma_f32_16x16x32_bf16 v[56:59], v[100:103], v[200:203], v[56:59]
    s_barrier
    ds_read_b64_tr_b16 v[92:93], v15 offset:16384
    ds_read_b64_tr_b16 v[94:95], v15 offset:20480
    s_waitcnt lgkmcnt(6)
    v_mfma_f32_16x16x32_bf16 v[60:63], v[104:107], v[196:199], v[60:63]
    ds_read_b64_tr_b16 v[96:97], v16 offset:16416
    v_mfma_f32_16x16x32_bf16 v[64:67], v[104:107], v[200:203], v[64:67]
    s_bfe_u32 s22, s42, 0x30014
    s_or_b32 s22, s22, s62
    s_lshl_b32 s22, s22, 18
    s_add_u32 s22, s22, s16
    s_add_u32 s22, s22, 0x0
    s_add_u32 m0, s17, 0x8000
    s_nop 0
    buffer_load_dwordx4 v17, s[4:7], s22 offen lds
    ds_read_b64_tr_b16 v[98:99], v16 offset:20512
    s_waitcnt lgkmcnt(6)
    v_mfma_f32_16x16x32_bf16 v[68:71], v[84:87], v[196:199], v[68:71]
    ds_read_b64_tr_b16 v[100:101], v15 offset:16640
    v_mfma_f32_16x16x32_bf16 v[72:75], v[84:87], v[200:203], v[72:75]
    ds_read_b64_tr_b16 v[102:103], v15 offset:20736
    s_waitcnt lgkmcnt(6)
    v_mfma_f32_16x16x32_bf16 v[76:79], v[88:91], v[196:199], v[76:79]
    ds_read_b64_tr_b16 v[104:105], v16 offset:16672
    v_mfma_f32_16x16x32_bf16 v[80:83], v[88:91], v[200:203], v[80:83]
    ds_read_b64_tr_b16 v[106:107], v16 offset:20768
    s_add_u32 s23, s21, 0x1020800
    buffer_load_dwordx4 v[168:171], v4, s[8:11], s23 offen offset:1024 sc1
    s_waitcnt vmcnt(22) lgkmcnt(6)
    v_mfma_f32_16x16x32_bf16 v[20:23], v[92:95], v[108:111], v[20:23]
    ds_read_b64_tr_b16 v[84:85], v15 offset:16896
    s_waitcnt vmcnt(20)
    v_mfma_f32_16x16x32_bf16 v[24:27], v[92:95], v[112:115], v[24:27]
    ds_read_b64_tr_b16 v[86:87], v15 offset:20992
    s_waitcnt lgkmcnt(6)
    v_mfma_f32_16x16x32_bf16 v[28:31], v[96:99], v[108:111], v[28:31]
    ds_read_b64_tr_b16 v[88:89], v16 offset:16928
    v_mfma_f32_16x16x32_bf16 v[32:35], v[96:99], v[112:115], v[32:35]
    s_bfe_u32 s22, s42, 0x30014
    s_or_b32 s22, s22, s62
    s_lshl_b32 s22, s22, 18
    s_add_u32 s22, s22, s16
    s_add_u32 s22, s22, 0x2000
    s_add_u32 m0, s17, 0x8400
    s_nop 0
    buffer_load_dwordx4 v18, s[4:7], s22 offen lds
    ds_read_b64_tr_b16 v[90:91], v16 offset:21024
    s_waitcnt lgkmcnt(6)
    v_mfma_f32_16x16x32_bf16 v[36:39], v[100:103], v[108:111], v[36:39]
    ds_read_b64_tr_b16 v[92:93], v15 offset:17152
    v_mfma_f32_16x16x32_bf16 v[40:43], v[100:103], v[112:115], v[40:43]
    ds_read_b64_tr_b16 v[94:95], v15 offset:21248
    s_waitcnt lgkmcnt(6)
    v_mfma_f32_16x16x32_bf16 v[44:47], v[104:107], v[108:111], v[44:47]
    ds_read_b64_tr_b16 v[96:97], v16 offset:17184
    v_mfma_f32_16x16x32_bf16 v[48:51], v[104:107], v[112:115], v[48:51]
    ds_read_b64_tr_b16 v[98:99], v16 offset:21280
    s_bfe_u32 s21, s42, 0x30010
    s_or_b32 s21, s21, s62
    s_lshl_b32 s21, s21, 12
    s_add_u32 s23, s21, 0x1000000
    buffer_load_dwordx4 v[188:191], v4, s[8:11], s23 offen offset:0 sc1
    s_waitcnt lgkmcnt(6)
    v_mfma_f32_16x16x32_bf16 v[52:55], v[84:87], v[108:111], v[52:55]
    ds_read_b64_tr_b16 v[100:101], v15 offset:24576
    v_mfma_f32_16x16x32_bf16 v[56:59], v[84:87], v[112:115], v[56:59]
    ds_read_b64_tr_b16 v[102:103], v15 offset:28672
    s_waitcnt lgkmcnt(6)
    v_mfma_f32_16x16x32_bf16 v[60:63], v[88:91], v[108:111], v[60:63]
    ds_read_b64_tr_b16 v[104:105], v16 offset:24608
    v_mfma_f32_16x16x32_bf16 v[64:67], v[88:91], v[112:115], v[64:67]
    s_bfe_u32 s22, s42, 0x30014
    s_or_b32 s22, s22, s62
    s_lshl_b32 s22, s22, 18
    s_add_u32 s22, s22, s16
    s_add_u32 s22, s22, 0x4000
    s_add_u32 m0, s17, 0x8800
    s_nop 0
    buffer_load_dwordx4 v17, s[4:7], s22 offen lds
    ds_read_b64_tr_b16 v[106:107], v16 offset:28704
    s_waitcnt lgkmcnt(6)
    v_mfma_f32_16x16x32_bf16 v[68:71], v[92:95], v[108:111], v[68:71]
    ds_read_b64_tr_b16 v[84:85], v15 offset:24832
    v_mfma_f32_16x16x32_bf16 v[72:75], v[92:95], v[112:115], v[72:75]
    ds_read_b64_tr_b16 v[86:87], v15 offset:28928
    s_waitcnt lgkmcnt(6)
    v_mfma_f32_16x16x32_bf16 v[76:79], v[96:99], v[108:111], v[76:79]
    ds_read_b64_tr_b16 v[88:89], v16 offset:24864
    v_mfma_f32_16x16x32_bf16 v[80:83], v[96:99], v[112:115], v[80:83]
    ds_read_b64_tr_b16 v[90:91], v16 offset:28960
    s_add_u32 s23, s21, 0x1020000
    buffer_load_dwordx4 v[192:195], v4, s[8:11], s23 offen offset:0 sc1
    s_waitcnt vmcnt(22) lgkmcnt(6)
    v_mfma_f32_16x16x32_bf16 v[20:23], v[100:103], v[116:119], v[20:23]
    ds_read_b64_tr_b16 v[92:93], v15 offset:25088
    s_waitcnt vmcnt(20)
    v_mfma_f32_16x16x32_bf16 v[24:27], v[100:103], v[120:123], v[24:27]
    ds_read_b64_tr_b16 v[94:95], v15 offset:29184
    s_waitcnt lgkmcnt(6)
    v_mfma_f32_16x16x32_bf16 v[28:31], v[104:107], v[116:119], v[28:31]
    ds_read_b64_tr_b16 v[96:97], v16 offset:25120
    v_mfma_f32_16x16x32_bf16 v[32:35], v[104:107], v[120:123], v[32:35]
    s_bfe_u32 s22, s42, 0x30014
    s_or_b32 s22, s22, s62
    s_lshl_b32 s22, s22, 18
    s_add_u32 s22, s22, s16
    s_add_u32 s22, s22, 0x6000
    s_add_u32 m0, s17, 0x8c00
    s_nop 0
    buffer_load_dwordx4 v18, s[4:7], s22 offen lds
    ds_read_b64_tr_b16 v[98:99], v16 offset:29216
    s_waitcnt lgkmcnt(6)
    v_mfma_f32_16x16x32_bf16 v[36:39], v[84:87], v[116:119], v[36:39]
    ds_read_b64_tr_b16 v[100:101], v15 offset:25344
    v_mfma_f32_16x16x32_bf16 v[40:43], v[84:87], v[120:123], v[40:43]
    ds_read_b64_tr_b16 v[102:103], v15 offset:29440
    s_waitcnt lgkmcnt(6)
    v_mfma_f32_16x16x32_bf16 v[44:47], v[88:91], v[116:119], v[44:47]
    ds_read_b64_tr_b16 v[104:105], v16 offset:25376
    v_mfma_f32_16x16x32_bf16 v[48:51], v[88:91], v[120:123], v[48:51]
    ds_read_b64_tr_b16 v[106:107], v16 offset:29472
    s_add_u32 s23, s21, 0x1000000
    buffer_load_dwordx4 v[196:199], v4, s[8:11], s23 offen offset:1024 sc1
    s_waitcnt lgkmcnt(6)
    v_mfma_f32_16x16x32_bf16 v[52:55], v[92:95], v[116:119], v[52:55]
    v_mfma_f32_16x16x32_bf16 v[56:59], v[92:95], v[120:123], v[56:59]
    s_barrier
    ds_read_b64_tr_b16 v[84:85], v15 offset:32768
    ds_read_b64_tr_b16 v[86:87], v15 offset:36864
    s_waitcnt lgkmcnt(6)
    v_mfma_f32_16x16x32_bf16 v[60:63], v[96:99], v[116:119], v[60:63]
    ds_read_b64_tr_b16 v[88:89], v16 offset:32800
    v_mfma_f32_16x16x32_bf16 v[64:67], v[96:99], v[120:123], v[64:67]
    s_bfe_u32 s22, s42, 0x30014
    s_or_b32 s22, s22, s62
    s_lshl_b32 s22, s22, 18
    s_add_u32 s22, s22, s16
    s_add_u32 s22, s22, 0x20000
    s_add_u32 m0, s17, 0xc000
    s_nop 0
    buffer_load_dwordx4 v17, s[4:7], s22 offen lds
    ds_read_b64_tr_b16 v[90:91], v16 offset:36896
    s_waitcnt lgkmcnt(6)
    v_mfma_f32_16x16x32_bf16 v[68:71], v[100:103], v[116:119], v[68:71]
    ds_read_b64_tr_b16 v[92:93], v15 offset:33024
    v_mfma_f32_16x16x32_bf16 v[72:75], v[100:103], v[120:123], v[72:75]
    ds_read_b64_tr_b16 v[94:95], v15 offset:37120
    s_waitcnt lgkmcnt(6)
    v_mfma_f32_16x16x32_bf16 v[76:79], v[104:107], v[116:119], v[76:79]
    ds_read_b64_tr_b16 v[96:97], v16 offset:33056
    v_mfma_f32_16x16x32_bf16 v[80:83], v[104:107], v[120:123], v[80:83]
    ds_read_b64_tr_b16 v[98:99], v16 offset:37152
    s_add_u32 s23, s21, 0x1020000
    buffer_load_dwordx4 v[200:203], v4, s[8:11], s23 offen offset:1024 sc1
    s_waitcnt vmcnt(22) lgkmcnt(6)
    v_mfma_f32_16x16x32_bf16 v[20:23], v[84:87], v[140:143], v[20:23]
    ds_read_b64_tr_b16 v[100:101], v15 offset:33280
    s_waitcnt vmcnt(20)
    v_mfma_f32_16x16x32_bf16 v[24:27], v[84:87], v[144:147], v[24:27]
    ds_read_b64_tr_b16 v[102:103], v15 offset:37376
    s_waitcnt lgkmcnt(6)
    v_mfma_f32_16x16x32_bf16 v[28:31], v[88:91], v[140:143], v[28:31]
    ds_read_b64_tr_b16 v[104:105], v16 offset:33312
    v_mfma_f32_16x16x32_bf16 v[32:35], v[88:91], v[144:147], v[32:35]
    s_bfe_u32 s22, s42, 0x30014
    s_or_b32 s22, s22, s62
    s_lshl_b32 s22, s22, 18
    s_add_u32 s22, s22, s16
    s_add_u32 s22, s22, 0x22000
    s_add_u32 m0, s17, 0xc400
    s_nop 0
    buffer_load_dwordx4 v18, s[4:7], s22 offen lds
    ds_read_b64_tr_b16 v[106:107], v16 offset:37408
    s_waitcnt lgkmcnt(6)
    v_mfma_f32_16x16x32_bf16 v[36:39], v[92:95], v[140:143], v[36:39]
    ds_read_b64_tr_b16 v[84:85], v15 offset:33536
    v_mfma_f32_16x16x32_bf16 v[40:43], v[92:95], v[144:147], v[40:43]
    ds_read_b64_tr_b16 v[86:87], v15 offset:37632
    s_waitcnt lgkmcnt(6)
    v_mfma_f32_16x16x32_bf16 v[44:47], v[96:99], v[140:143], v[44:47]
    ds_read_b64_tr_b16 v[88:89], v16 offset:33568
    v_mfma_f32_16x16x32_bf16 v[48:51], v[96:99], v[144:147], v[48:51]
    ds_read_b64_tr_b16 v[90:91], v16 offset:37664
    s_add_u32 s23, s21, 0x1000800
    buffer_load_dwordx4 v[108:111], v4, s[8:11], s23 offen offset:0 sc1
    s_waitcnt lgkmcnt(6)
    v_mfma_f32_16x16x32_bf16 v[52:55], v[100:103], v[140:143], v[52:55]
    ds_read_b64_tr_b16 v[92:93], v15 offset:40960
    v_mfma_f32_16x16x32_bf16 v[56:59], v[100:103], v[144:147], v[56:59]
    ds_read_b64_tr_b16 v[94:95], v15 offset:45056
    s_waitcnt lgkmcnt(6)
    v_mfma_f32_16x16x32_bf16 v[60:63], v[104:107], v[140:143], v[60:63]
    ds_read_b64_tr_b16 v[96:97], v16 offset:40992
    v_mfma_f32_16x16x32_bf16 v[64:67], v[104:107], v[144:147], v[64:67]
    s_bfe_u32 s22, s42, 0x30014
    s_or_b32 s22, s22, s62
    s_lshl_b32 s22, s22, 18
    s_add_u32 s22, s22, s16
    s_add_u32 s22, s22, 0x24000
    s_add_u32 m0, s17, 0xc800
    s_nop 0
    buffer_load_dwordx4 v17, s[4:7], s22 offen lds
    ds_read_b64_tr_b16 v[98:99], v16 offset:45088
    s_waitcnt lgkmcnt(6)
    v_mfma_f32_16x16x32_bf16 v[68:71], v[84:87], v[140:143], v[68:71]
    ds_read_b64_tr_b16 v[100:101], v15 offset:41216
    v_mfma_f32_16x16x32_bf16 v[72:75], v[84:87], v[144:147], v[72:75]
    ds_read_b64_tr_b16 v[102:103], v15 offset:45312
    s_waitcnt lgkmcnt(6)
    v_mfma_f32_16x16x32_bf16 v[76:79], v[88:91], v[140:143], v[76:79]
    ds_read_b64_tr_b16 v[104:105], v16 offset:41248
    v_mfma_f32_16x16x32_bf16 v[80:83], v[88:91], v[144:147], v[80:83]
    ds_read_b64_tr_b16 v[106:107], v16 offset:45344
    s_add_u32 s23, s21, 0x1020800
    buffer_load_dwordx4 v[112:115], v4, s[8:11], s23 offen offset:0 sc1
    s_waitcnt vmcnt(22) lgkmcnt(6)
    v_mfma_f32_16x16x32_bf16 v[20:23], v[92:95], v[148:151], v[20:23]
    ds_read_b64_tr_b16 v[84:85], v15 offset:41472
    s_waitcnt vmcnt(20)
    v_mfma_f32_16x16x32_bf16 v[24:27], v[92:95], v[152:155], v[24:27]
    ds_read_b64_tr_b16 v[86:87], v15 offset:45568
    s_waitcnt lgkmcnt(6)
    v_mfma_f32_16x16x32_bf16 v[28:31], v[96:99], v[148:151], v[28:31]
    ds_read_b64_tr_b16 v[88:89], v16 offset:41504
    v_mfma_f32_16x16x32_bf16 v[32:35], v[96:99], v[152:155], v[32:35]
    s_bfe_u32 s22, s42, 0x30014
    s_or_b32 s22, s22, s62
    s_lshl_b32 s22, s22, 18
    s_add_u32 s22, s22, s16
    s_add_u32 s22, s22, 0x26000
    s_add_u32 m0, s17, 0xcc00
    s_nop 0
    buffer_load_dwordx4 v18, s[4:7], s22 offen lds
    ds_read_b64_tr_b16 v[90:91], v16 offset:45600
    s_waitcnt lgkmcnt(6)
    v_mfma_f32_16x16x32_bf16 v[36:39], v[100:103], v[148:151], v[36:39]
    ds_read_b64_tr_b16 v[92:93], v15 offset:41728
    v_mfma_f32_16x16x32_bf16 v[40:43], v[100:103], v[152:155], v[40:43]
    ds_read_b64_tr_b16 v[94:95], v15 offset:45824
    s_waitcnt lgkmcnt(6)
    v_mfma_f32_16x16x32_bf16 v[44:47], v[104:107], v[148:151], v[44:47]
    ds_read_b64_tr_b16 v[96:97], v16 offset:41760
    v_mfma_f32_16x16x32_bf16 v[48:51], v[104:107], v[152:155], v[48:51]
    ds_read_b64_tr_b16 v[98:99], v16 offset:45856
    s_add_u32 s23, s21, 0x1000800
    buffer_load_dwordx4 v[116:119], v4, s[8:11], s23 offen offset:1024 sc1
    s_waitcnt lgkmcnt(6)
    v_mfma_f32_16x16x32_bf16 v[52:55], v[84:87], v[148:151], v[52:55]
    v_mfma_f32_16x16x32_bf16 v[56:59], v[84:87], v[152:155], v[56:59]
    s_barrier
    ds_read_b64_tr_b16 v[100:101], v15 offset:49152
    ds_read_b64_tr_b16 v[102:103], v15 offset:53248
    s_waitcnt lgkmcnt(6)
    v_mfma_f32_16x16x32_bf16 v[60:63], v[88:91], v[148:151], v[60:63]
    ds_read_b64_tr_b16 v[104:105], v16 offset:49184
    v_mfma_f32_16x16x32_bf16 v[64:67], v[88:91], v[152:155], v[64:67]
    s_bfe_u32 s22, s42, 0x30018
    s_or_b32 s22, s22, s62
    s_lshl_b32 s22, s22, 18
    s_add_u32 s22, s22, s16
    s_add_u32 s22, s22, 0x0
    s_add_u32 m0, s17, 0x10000
    s_nop 0
    buffer_load_dwordx4 v17, s[4:7], s22 offen lds
    ds_read_b64_tr_b16 v[106:107], v16 offset:53280
    s_waitcnt lgkmcnt(6)
    v_mfma_f32_16x16x32_bf16 v[68:71], v[92:95], v[148:151], v[68:71]
    ds_read_b64_tr_b16 v[84:85], v15 offset:49408
    v_mfma_f32_16x16x32_bf16 v[72:75], v[92:95], v[152:155], v[72:75]
    ds_read_b64_tr_b16 v[86:87], v15 offset:53504
    s_waitcnt lgkmcnt(6)
    v_mfma_f32_16x16x32_bf16 v[76:79], v[96:99], v[148:151], v[76:79]
    ds_read_b64_tr_b16 v[88:89], v16 offset:49440
    v_mfma_f32_16x16x32_bf16 v[80:83], v[96:99], v[152:155], v[80:83]
    ds_read_b64_tr_b16 v[90:91], v16 offset:53536
    s_add_u32 s23, s21, 0x1020800
    buffer_load_dwordx4 v[120:123], v4, s[8:11], s23 offen offset:1024 sc1
    s_waitcnt vmcnt(22) lgkmcnt(6)
    v_mfma_f32_16x16x32_bf16 v[20:23], v[100:103], v[156:159], v[20:23]
    ds_read_b64_tr_b16 v[92:93], v15 offset:49664
    s_waitcnt vmcnt(20)
    v_mfma_f32_16x16x32_bf16 v[24:27], v[100:103], v[160:163], v[24:27]
    ds_read_b64_tr_b16 v[94:95], v15 offset:53760
    s_waitcnt lgkmcnt(6)
    v_mfma_f32_16x16x32_bf16 v[28:31], v[104:107], v[156:159], v[28:31]
    ds_read_b64_tr_b16 v[96:97], v16 offset:49696
    v_mfma_f32_16x16x32_bf16 v[32:35], v[104:107], v[160:163], v[32:35]
    s_bfe_u32 s22, s42, 0x30018
    s_or_b32 s22, s22, s62
    s_lshl_b32 s22, s22, 18
    s_add_u32 s22, s22, s16
    s_add_u32 s22, s22, 0x2000
    s_add_u32 m0, s17, 0x10400
    s_nop 0
    buffer_load_dwordx4 v18, s[4:7], s22 offen lds
    ds_read_b64_tr_b16 v[98:99], v16 offset:53792
    s_waitcnt lgkmcnt(6)
    v_mfma_f32_16x16x32_bf16 v[36:39], v[84:87], v[156:159], v[36:39]
    ds_read_b64_tr_b16 v[100:101], v15 offset:49920
    v_mfma_f32_16x16x32_bf16 v[40:43], v[84:87], v[160:163], v[40:43]
    ds_read_b64_tr_b16 v[102:103], v15 offset:54016
    buffer_load_dword v10, v9, s[8:11], s20 offen sc1
    s_waitcnt lgkmcnt(6)
    v_mfma_f32_16x16x32_bf16 v[44:47], v[88:91], v[156:159], v[44:47]
    ds_read_b64_tr_b16 v[104:105], v16 offset:49952
    v_mfma_f32_16x16x32_bf16 v[48:51], v[88:91], v[160:163], v[48:51]
    ds_read_b64_tr_b16 v[106:107], v16 offset:54048
    s_bfe_u32 s21, s42, 0x30014
    s_or_b32 s21, s21, s62
    s_lshl_b32 s21, s21, 12
    s_add_u32 s23, s21, 0x1000000
    buffer_load_dwordx4 v[140:143], v4, s[8:11], s23 offen offset:0 sc1
    s_waitcnt lgkmcnt(6)
    v_mfma_f32_16x16x32_bf16 v[52:55], v[92:95], v[156:159], v[52:55]
    ds_read_b64_tr_b16 v[84:85], v15 offset:57344
    v_mfma_f32_16x16x32_bf16 v[56:59], v[92:95], v[160:163], v[56:59]
    ds_read_b64_tr_b16 v[86:87], v15 offset:61440
    s_waitcnt lgkmcnt(6)
    v_mfma_f32_16x16x32_bf16 v[60:63], v[96:99], v[156:159], v[60:63]
    ds_read_b64_tr_b16 v[88:89], v16 offset:57376
    v_mfma_f32_16x16x32_bf16 v[64:67], v[96:99], v[160:163], v[64:67]
    s_bfe_u32 s22, s42, 0x30018
    s_or_b32 s22, s22, s62
    s_lshl_b32 s22, s22, 18
    s_add_u32 s22, s22, s16
    s_add_u32 s22, s22, 0x4000
    s_add_u32 m0, s17, 0x10800
    s_nop 0
    buffer_load_dwordx4 v17, s[4:7], s22 offen lds
    ds_read_b64_tr_b16 v[90:91], v16 offset:61472
    s_waitcnt lgkmcnt(6)
    v_mfma_f32_16x16x32_bf16 v[68:71], v[100:103], v[156:159], v[68:71]
    ds_read_b64_tr_b16 v[92:93], v15 offset:57600
    v_mfma_f32_16x16x32_bf16 v[72:75], v[100:103], v[160:163], v[72:75]
    ds_read_b64_tr_b16 v[94:95], v15 offset:61696
    s_waitcnt lgkmcnt(6)
    v_mfma_f32_16x16x32_bf16 v[76:79], v[104:107], v[156:159], v[76:79]
    ds_read_b64_tr_b16 v[96:97], v16 offset:57632
    v_mfma_f32_16x16x32_bf16 v[80:83], v[104:107], v[160:163], v[80:83]
    ds_read_b64_tr_b16 v[98:99], v16 offset:61728
    s_add_u32 s23, s21, 0x1020000
    buffer_load_dwordx4 v[144:147], v4, s[8:11], s23 offen offset:0 sc1
    s_waitcnt vmcnt(23) lgkmcnt(6)
    v_mfma_f32_16x16x32_bf16 v[20:23], v[84:87], v[164:167], v[20:23]
    ds_read_b64_tr_b16 v[100:101], v15 offset:57856
    s_waitcnt vmcnt(21)
    v_mfma_f32_16x16x32_bf16 v[24:27], v[84:87], v[168:171], v[24:27]
    ds_read_b64_tr_b16 v[102:103], v15 offset:61952
    s_waitcnt lgkmcnt(6)
    v_mfma_f32_16x16x32_bf16 v[28:31], v[88:91], v[164:167], v[28:31]
    ds_read_b64_tr_b16 v[104:105], v16 offset:57888
    v_mfma_f32_16x16x32_bf16 v[32:35], v[88:91], v[168:171], v[32:35]
    s_bfe_u32 s22, s42, 0x30018
    s_or_b32 s22, s22, s62
    s_lshl_b32 s22, s22, 18
    s_add_u32 s22, s22, s16
    s_add_u32 s22, s22, 0x6000
    s_add_u32 m0, s17, 0x10c00
    s_nop 0
    buffer_load_dwordx4 v18, s[4:7], s22 offen lds
    ds_read_b64_tr_b16 v[106:107], v16 offset:61984
    s_waitcnt lgkmcnt(6)
    v_mfma_f32_16x16x32_bf16 v[36:39], v[92:95], v[164:167], v[36:39]
    ds_read_b64_tr_b16 v[84:85], v15 offset:58112
    v_mfma_f32_16x16x32_bf16 v[40:43], v[92:95], v[168:171], v[40:43]
    ds_read_b64_tr_b16 v[86:87], v15 offset:62208
    s_waitcnt lgkmcnt(6)
    v_mfma_f32_16x16x32_bf16 v[44:47], v[96:99], v[164:167], v[44:47]
    ds_read_b64_tr_b16 v[88:89], v16 offset:58144
    v_mfma_f32_16x16x32_bf16 v[48:51], v[96:99], v[168:171], v[48:51]
    ds_read_b64_tr_b16 v[90:91], v16 offset:62240
    s_add_u32 s23, s21, 0x1000000
    buffer_load_dwordx4 v[148:151], v4, s[8:11], s23 offen offset:1024 sc1
    s_waitcnt lgkmcnt(6)
    v_mfma_f32_16x16x32_bf16 v[52:55], v[100:103], v[164:167], v[52:55]
    v_mfma_f32_16x16x32_bf16 v[56:59], v[100:103], v[168:171], v[56:59]
    s_barrier
    ds_read_b64_tr_b16 v[92:93], v3 offset:0
    ds_read_b64_tr_b16 v[94:95], v3 offset:4096
    s_waitcnt lgkmcnt(6)
    v_mfma_f32_16x16x32_bf16 v[60:63], v[104:107], v[164:167], v[60:63]
    ds_read_b64_tr_b16 v[96:97], v2 offset:32
    v_mfma_f32_16x16x32_bf16 v[64:67], v[104:107], v[168:171], v[64:67]
    s_bfe_u32 s22, s42, 0x30018
    s_or_b32 s22, s22, s62
    s_lshl_b32 s22, s22, 18
    s_add_u32 s22, s22, s16
    s_add_u32 s22, s22, 0x20000
    s_add_u32 m0, s17, 0x14000
    s_nop 0
    buffer_load_dwordx4 v17, s[4:7], s22 offen lds
    ds_read_b64_tr_b16 v[98:99], v2 offset:4128
    s_waitcnt lgkmcnt(6)
    v_mfma_f32_16x16x32_bf16 v[68:71], v[84:87], v[164:167], v[68:71]
    ds_read_b64_tr_b16 v[100:101], v3 offset:256
    v_mfma_f32_16x16x32_bf16 v[72:75], v[84:87], v[168:171], v[72:75]
    ds_read_b64_tr_b16 v[102:103], v3 offset:4352
    s_waitcnt lgkmcnt(6)
    v_mfma_f32_16x16x32_bf16 v[76:79], v[88:91], v[164:167], v[76:79]
    ds_read_b64_tr_b16 v[104:105], v2 offset:288
    v_mfma_f32_16x16x32_bf16 v[80:83], v[88:91], v[168:171], v[80:83]
    ds_read_b64_tr_b16 v[106:107], v2 offset:4384
    s_add_u32 s23, s21, 0x1020000
    buffer_load_dwordx4 v[152:155], v4, s[8:11], s23 offen offset:1024 sc1
    s_waitcnt vmcnt(23) lgkmcnt(6)
    v_mfma_f32_16x16x32_bf16 v[20:23], v[92:95], v[188:191], v[20:23]
    ds_read_b64_tr_b16 v[84:85], v3 offset:512
    s_waitcnt vmcnt(21)
    v_mfma_f32_16x16x32_bf16 v[24:27], v[92:95], v[192:195], v[24:27]
    ds_read_b64_tr_b16 v[86:87], v3 offset:4608
    s_waitcnt lgkmcnt(6)
    v_mfma_f32_16x16x32_bf16 v[28:31], v[96:99], v[188:191], v[28:31]
    ds_read_b64_tr_b16 v[88:89], v2 offset:544
    v_mfma_f32_16x16x32_bf16 v[32:35], v[96:99], v[192:195], v[32:35]
    s_bfe_u32 s22, s42, 0x30018
    s_or_b32 s22, s22, s62
    s_lshl_b32 s22, s22, 18
    s_add_u32 s22, s22, s16
    s_add_u32 s22, s22, 0x22000
    s_add_u32 m0, s17, 0x14400
    s_nop 0
    buffer_load_dwordx4 v18, s[4:7], s22 offen lds
    ds_read_b64_tr_b16 v[90:91], v2 offset:4640
    s_waitcnt lgkmcnt(6)
    v_mfma_f32_16x16x32_bf16 v[36:39], v[100:103], v[188:191], v[36:39]
    ds_read_b64_tr_b16 v[92:93], v3 offset:768
    v_mfma_f32_16x16x32_bf16 v[40:43], v[100:103], v[192:195], v[40:43]
    ds_read_b64_tr_b16 v[94:95], v3 offset:4864
    s_waitcnt lgkmcnt(6)
    v_mfma_f32_16x16x32_bf16 v[44:47], v[104:107], v[188:191], v[44:47]
    ds_read_b64_tr_b16 v[96:97], v2 offset:800
    v_mfma_f32_16x16x32_bf16 v[48:51], v[104:107], v[192:195], v[48:51]
    ds_read_b64_tr_b16 v[98:99], v2 offset:4896
    s_add_u32 s23, s21, 0x1000800
    buffer_load_dwordx4 v[156:159], v4, s[8:11], s23 offen offset:0 sc1
    s_waitcnt lgkmcnt(6)
    v_mfma_f32_16x16x32_bf16 v[52:55], v[84:87], v[188:191], v[52:55]
    ds_read_b64_tr_b16 v[100:101], v3 offset:8192
    v_mfma_f32_16x16x32_bf16 v[56:59], v[84:87], v[192:195], v[56:59]
    ds_read_b64_tr_b16 v[102:103], v3 offset:12288
    s_waitcnt lgkmcnt(6)
    v_mfma_f32_16x16x32_bf16 v[60:63], v[88:91], v[188:191], v[60:63]
    ds_read_b64_tr_b16 v[104:105], v2 offset:8224
    v_mfma_f32_16x16x32_bf16 v[64:67], v[88:91], v[192:195], v[64:67]
    s_bfe_u32 s22, s42, 0x30018
    s_or_b32 s22, s22, s62
    s_lshl_b32 s22, s22, 18
    s_add_u32 s22, s22, s16
    s_add_u32 s22, s22, 0x24000
    s_add_u32 m0, s17, 0x14800
    s_nop 0
    buffer_load_dwordx4 v17, s[4:7], s22 offen lds
    ds_read_b64_tr_b16 v[106:107], v2 offset:12320
    s_waitcnt lgkmcnt(6)
    v_mfma_f32_16x16x32_bf16 v[68:71], v[92:95], v[188:191], v[68:71]
    ds_read_b64_tr_b16 v[84:85], v3 offset:8448
    v_mfma_f32_16x16x32_bf16 v[72:75], v[92:95], v[192:195], v[72:75]
    ds_read_b64_tr_b16 v[86:87], v3 offset:12544
    s_waitcnt lgkmcnt(6)
    v_mfma_f32_16x16x32_bf16 v[76:79], v[96:99], v[188:191], v[76:79]
    ds_read_b64_tr_b16 v[88:89], v2 offset:8480
    v_mfma_f32_16x16x32_bf16 v[80:83], v[96:99], v[192:195], v[80:83]
    ds_read_b64_tr_b16 v[90:91], v2 offset:12576
    s_add_u32 s23, s21, 0x1020800
    buffer_load_dwordx4 v[160:163], v4, s[8:11], s23 offen offset:0 sc1
    s_waitcnt vmcnt(23) lgkmcnt(6)
    v_mfma_f32_16x16x32_bf16 v[20:23], v[100:103], v[196:199], v[20:23]
    ds_read_b64_tr_b16 v[92:93], v3 offset:8704
    s_waitcnt vmcnt(21)
    v_mfma_f32_16x16x32_bf16 v[24:27], v[100:103], v[200:203], v[24:27]
    ds_read_b64_tr_b16 v[94:95], v3 offset:12800
    s_waitcnt lgkmcnt(6)
    v_mfma_f32_16x16x32_bf16 v[28:31], v[104:107], v[196:199], v[28:31]
    ds_read_b64_tr_b16 v[96:97], v2 offset:8736
    v_mfma_f32_16x16x32_bf16 v[32:35], v[104:107], v[200:203], v[32:35]
    s_bfe_u32 s22, s42, 0x30018
    s_or_b32 s22, s22, s62
    s_lshl_b32 s22, s22, 18
    s_add_u32 s22, s22, s16
    s_add_u32 s22, s22, 0x26000
    s_add_u32 m0, s17, 0x14c00
    s_nop 0
    buffer_load_dwordx4 v18, s[4:7], s22 offen lds
    ds_read_b64_tr_b16 v[98:99], v2 offset:12832
    s_waitcnt lgkmcnt(6)
    v_mfma_f32_16x16x32_bf16 v[36:39], v[84:87], v[196:199], v[36:39]
    ds_read_b64_tr_b16 v[100:101], v3 offset:8960
    v_mfma_f32_16x16x32_bf16 v[40:43], v[84:87], v[200:203], v[40:43]
    ds_read_b64_tr_b16 v[102:103], v3 offset:13056
    s_waitcnt lgkmcnt(6)
    v_mfma_f32_16x16x32_bf16 v[44:47], v[88:91], v[196:199], v[44:47]
    ds_read_b64_tr_b16 v[104:105], v2 offset:8992
    v_mfma_f32_16x16x32_bf16 v[48:51], v[88:91], v[200:203], v[48:51]
    ds_read_b64_tr_b16 v[106:107], v2 offset:13088
    s_add_u32 s23, s21, 0x1000800
    buffer_load_dwordx4 v[164:167], v4, s[8:11], s23 offen offset:1024 sc1
    s_waitcnt lgkmcnt(6)
    v_mfma_f32_16x16x32_bf16 v[52:55], v[92:95], v[196:199], v[52:55]
    v_mfma_f32_16x16x32_bf16 v[56:59], v[92:95], v[200:203], v[56:59]
    s_barrier
    ds_read_b64_tr_b16 v[84:85], v3 offset:16384
    ds_read_b64_tr_b16 v[86:87], v3 offset:20480
    s_waitcnt lgkmcnt(6)
    v_mfma_f32_16x16x32_bf16 v[60:63], v[96:99], v[196:199], v[60:63]
    ds_read_b64_tr_b16 v[88:89], v2 offset:16416
    v_mfma_f32_16x16x32_bf16 v[64:67], v[96:99], v[200:203], v[64:67]
    s_bfe_u32 s22, s42, 0x3001c
    s_or_b32 s22, s22, s62
    s_lshl_b32 s22, s22, 18
    s_add_u32 s22, s22, s16
    s_add_u32 s22, s22, 0x0
    s_add_u32 m0, s17, 0x18000
    s_nop 0
    buffer_load_dwordx4 v17, s[4:7], s22 offen lds
    ds_read_b64_tr_b16 v[90:91], v2 offset:20512
    s_waitcnt lgkmcnt(6)
    v_mfma_f32_16x16x32_bf16 v[68:71], v[100:103], v[196:199], v[68:71]
    ds_read_b64_tr_b16 v[92:93], v3 offset:16640
    v_mfma_f32_16x16x32_bf16 v[72:75], v[100:103], v[200:203], v[72:75]
    ds_read_b64_tr_b16 v[94:95], v3 offset:20736
    s_waitcnt lgkmcnt(6)
    v_mfma_f32_16x16x32_bf16 v[76:79], v[104:107], v[196:199], v[76:79]
    ds_read_b64_tr_b16 v[96:97], v2 offset:16672
    v_mfma_f32_16x16x32_bf16 v[80:83], v[104:107], v[200:203], v[80:83]
    ds_read_b64_tr_b16 v[98:99], v2 offset:20768
    s_add_u32 s23, s21, 0x1020800
    buffer_load_dwordx4 v[168:171], v4, s[8:11], s23 offen offset:1024 sc1
    s_waitcnt vmcnt(15)
    v_cmp_ne_u32 vcc, s14, v10
    s_cbranch_vccz fz_o2gA
    s_mov_b32 s27, 0
fz_o2pA:
    buffer_load_dword v10, v9, s[8:11], s20 offen sc1
    s_waitcnt vmcnt(0)
    v_cmp_ne_u32 vcc, s14, v10
    s_add_u32 s27, s27, 1
    s_cmp_ge_u32 s27, 65536
    s_nop 4
    s_cbranch_scc1 fz_o2gA
    s_cbranch_vccnz fz_o2pA
fz_o2gA:
    s_waitcnt lgkmcnt(6)
    v_mfma_f32_16x16x32_bf16 v[20:23], v[84:87], v[108:111], v[20:23]
    ds_read_b64_tr_b16 v[100:101], v3 offset:16896
    v_mfma_f32_16x16x32_bf16 v[24:27], v[84:87], v[112:115], v[24:27]
    ds_read_b64_tr_b16 v[102:103], v3 offset:20992
    s_waitcnt lgkmcnt(6)
    v_mfma_f32_16x16x32_bf16 v[28:31], v[88:91], v[108:111], v[28:31]
    ds_read_b64_tr_b16 v[104:105], v2 offset:16928
    v_mfma_f32_16x16x32_bf16 v[32:35], v[88:91], v[112:115], v[32:35]
    s_bfe_u32 s22, s42, 0x3001c
    s_or_b32 s22, s22, s62
    s_lshl_b32 s22, s22, 18
    s_add_u32 s22, s22, s16
    s_add_u32 s22, s22, 0x2000
    s_add_u32 m0, s17, 0x18400
    s_nop 0
    buffer_load_dwordx4 v18, s[4:7], s22 offen lds
    ds_read_b64_tr_b16 v[106:107], v2 offset:21024
    s_waitcnt lgkmcnt(6)
    v_mfma_f32_16x16x32_bf16 v[36:39], v[92:95], v[108:111], v[36:39]
    ds_read_b64_tr_b16 v[84:85], v3 offset:17152
    v_mfma_f32_16x16x32_bf16 v[40:43], v[92:95], v[112:115], v[40:43]
    ds_read_b64_tr_b16 v[86:87], v3 offset:21248
    s_waitcnt lgkmcnt(6)
    v_mfma_f32_16x16x32_bf16 v[44:47], v[96:99], v[108:111], v[44:47]
    ds_read_b64_tr_b16 v[88:89], v2 offset:17184
    v_mfma_f32_16x16x32_bf16 v[48:51], v[96:99], v[112:115], v[48:51]
    ds_read_b64_tr_b16 v[90:91], v2 offset:21280
    s_bfe_u32 s21, s42, 0x30018
    s_or_b32 s21, s21, s62
    s_lshl_b32 s21, s21, 12
    s_add_u32 s23, s21, 0x1000000
    buffer_load_dwordx4 v[188:191], v4, s[8:11], s23 offen offset:0 sc1
    s_waitcnt lgkmcnt(6)
    v_mfma_f32_16x16x32_bf16 v[52:55], v[100:103], v[108:111], v[52:55]
    ds_read_b64_tr_b16 v[92:93], v3 offset:24576
    v_mfma_f32_16x16x32_bf16 v[56:59], v[100:103], v[112:115], v[56:59]
    ds_read_b64_tr_b16 v[94:95], v3 offset:28672
    s_waitcnt lgkmcnt(6)
    v_mfma_f32_16x16x32_bf16 v[60:63], v[104:107], v[108:111], v[60:63]
    ds_read_b64_tr_b16 v[96:97], v2 offset:24608
    v_mfma_f32_16x16x32_bf16 v[64:67], v[104:107], v[112:115], v[64:67]
    s_bfe_u32 s22, s42, 0x3001c
    s_or_b32 s22, s22, s62
    s_lshl_b32 s22, s22, 18
    s_add_u32 s22, s22, s16
    s_add_u32 s22, s22, 0x4000
    s_add_u32 m0, s17, 0x18800
    s_nop 0
    buffer_load_dwordx4 v17, s[4:7], s22 offen lds
    ds_read_b64_tr_b16 v[98:99], v2 offset:28704
    s_waitcnt lgkmcnt(6)
    v_mfma_f32_16x16x32_bf16 v[68:71], v[84:87], v[108:111], v[68:71]
    ds_read_b64_tr_b16 v[100:101], v3 offset:24832
    v_mfma_f32_16x16x32_bf16 v[72:75], v[84:87], v[112:115], v[72:75]
    ds_read_b64_tr_b16 v[102:103], v3 offset:28928
    s_waitcnt lgkmcnt(6)
    v_mfma_f32_16x16x32_bf16 v[76:79], v[88:91], v[108:111], v[76:79]
    ds_read_b64_tr_b16 v[104:105], v2 offset:24864
    v_mfma_f32_16x16x32_bf16 v[80:83], v[88:91], v[112:115], v[80:83]
    ds_read_b64_tr_b16 v[106:107], v2 offset:28960
    s_add_u32 s23, s21, 0x1020000
    buffer_load_dwordx4 v[192:195], v4, s[8:11], s23 offen offset:0 sc1
    s_waitcnt lgkmcnt(6)
    v_mfma_f32_16x16x32_bf16 v[20:23], v[92:95], v[116:119], v[20:23]
    ds_read_b64_tr_b16 v[84:85], v3 offset:25088
    v_mfma_f32_16x16x32_bf16 v[24:27], v[92:95], v[120:123], v[24:27]
    ds_read_b64_tr_b16 v[86:87], v3 offset:29184
    s_waitcnt lgkmcnt(6)
    v_mfma_f32_16x16x32_bf16 v[28:31], v[96:99], v[116:119], v[28:31]
    ds_read_b64_tr_b16 v[88:89], v2 offset:25120
    v_mfma_f32_16x16x32_bf16 v[32:35], v[96:99], v[120:123], v[32:35]
    s_bfe_u32 s22, s42, 0x3001c
    s_or_b32 s22, s22, s62
    s_lshl_b32 s22, s22, 18
    s_add_u32 s22, s22, s16
    s_add_u32 s22, s22, 0x6000
    s_add_u32 m0, s17, 0x18c00
    s_nop 0
    buffer_load_dwordx4 v18, s[4:7], s22 offen lds
    ds_read_b64_tr_b16 v[90:91], v2 offset:29216
    s_waitcnt lgkmcnt(6)
    v_mfma_f32_16x16x32_bf16 v[36:39], v[100:103], v[116:119], v[36:39]
    ds_read_b64_tr_b16 v[92:93], v3 offset:25344
    v_mfma_f32_16x16x32_bf16 v[40:43], v[100:103], v[120:123], v[40:43]
    ds_read_b64_tr_b16 v[94:95], v3 offset:29440
    s_waitcnt lgkmcnt(6)
    v_mfma_f32_16x16x32_bf16 v[44:47], v[104:107], v[116:119], v[44:47]
    ds_read_b64_tr_b16 v[96:97], v2 offset:25376
    v_mfma_f32_16x16x32_bf16 v[48:51], v[104:107], v[120:123], v[48:51]
    ds_read_b64_tr_b16 v[98:99], v2 offset:29472
    s_add_u32 s23, s21, 0x1000000
    buffer_load_dwordx4 v[196:199], v4, s[8:11], s23 offen offset:1024 sc1
    s_waitcnt lgkmcnt(6)
    v_mfma_f32_16x16x32_bf16 v[52:55], v[84:87], v[116:119], v[52:55]
    v_mfma_f32_16x16x32_bf16 v[56:59], v[84:87], v[120:123], v[56:59]
    s_barrier
    ds_read_b64_tr_b16 v[100:101], v3 offset:32768
    ds_read_b64_tr_b16 v[102:103], v3 offset:36864
    s_waitcnt lgkmcnt(6)
    v_mfma_f32_16x16x32_bf16 v[60:63], v[88:91], v[116:119], v[60:63]
    ds_read_b64_tr_b16 v[104:105], v2 offset:32800
    v_mfma_f32_16x16x32_bf16 v[64:67], v[88:91], v[120:123], v[64:67]
    s_bfe_u32 s22, s42, 0x3001c
    s_or_b32 s22, s22, s62
    s_lshl_b32 s22, s22, 18
    s_add_u32 s22, s22, s16
    s_add_u32 s22, s22, 0x20000
    s_add_u32 m0, s17, 0x1c000
    s_nop 0
    buffer_load_dwordx4 v17, s[4:7], s22 offen lds
    ds_read_b64_tr_b16 v[106:107], v2 offset:36896
    s_waitcnt lgkmcnt(6)
    v_mfma_f32_16x16x32_bf16 v[68:71], v[92:95], v[116:119], v[68:71]
    ds_read_b64_tr_b16 v[84:85], v3 offset:33024
    v_mfma_f32_16x16x32_bf16 v[72:75], v[92:95], v[120:123], v[72:75]
    ds_read_b64_tr_b16 v[86:87], v3 offset:37120
    s_waitcnt lgkmcnt(6)
    v_mfma_f32_16x16x32_bf16 v[76:79], v[96:99], v[116:119], v[76:79]
    ds_read_b64_tr_b16 v[88:89], v2 offset:33056
    v_mfma_f32_16x16x32_bf16 v[80:83], v[96:99], v[120:123], v[80:83]
    ds_read_b64_tr_b16 v[90:91], v2 offset:37152
    s_add_u32 s23, s21, 0x1020000
    buffer_load_dwordx4 v[200:203], v4, s[8:11], s23 offen offset:1024 sc1
    s_waitcnt vmcnt(22) lgkmcnt(6)
    v_mfma_f32_16x16x32_bf16 v[20:23], v[100:103], v[140:143], v[20:23]
    ds_read_b64_tr_b16 v[92:93], v3 offset:33280
    s_waitcnt vmcnt(20)
    v_mfma_f32_16x16x32_bf16 v[24:27], v[100:103], v[144:147], v[24:27]
    ds_read_b64_tr_b16 v[94:95], v3 offset:37376
    s_waitcnt lgkmcnt(6)
    v_mfma_f32_16x16x32_bf16 v[28:31], v[104:107], v[140:143], v[28:31]
    ds_read_b64_tr_b16 v[96:97], v2 offset:33312
    v_mfma_f32_16x16x32_bf16 v[32:35], v[104:107], v[144:147], v[32:35]
    s_bfe_u32 s22, s42, 0x3001c
    s_or_b32 s22, s22, s62
    s_lshl_b32 s22, s22, 18
    s_add_u32 s22, s22, s16
    s_add_u32 s22, s22, 0x22000
    s_add_u32 m0, s17, 0x1c400
    s_nop 0
    buffer_load_dwordx4 v18, s[4:7], s22 offen lds
    ds_read_b64_tr_b16 v[98:99], v2 offset:37408
    s_waitcnt lgkmcnt(6)
    v_mfma_f32_16x16x32_bf16 v[36:39], v[84:87], v[140:143], v[36:39]
    ds_read_b64_tr_b16 v[100:101], v3 offset:33536
    v_mfma_f32_16x16x32_bf16 v[40:43], v[84:87], v[144:147], v[40:43]
    ds_read_b64_tr_b16 v[102:103], v3 offset:37632
    s_waitcnt lgkmcnt(6)
    v_mfma_f32_16x16x32_bf16 v[44:47], v[88:91], v[140:143], v[44:47]
    ds_read_b64_tr_b16 v[104:105], v2 offset:33568
    v_mfma_f32_16x16x32_bf16 v[48:51], v[88:91], v[144:147], v[48:51]
    ds_read_b64_tr_b16 v[106:107], v2 offset:37664
    s_add_u32 s23, s21, 0x1000800
    buffer_load_dwordx4 v[108:111], v4, s[8:11], s23 offen offset:0 sc1
    s_waitcnt lgkmcnt(6)
    v_mfma_f32_16x16x32_bf16 v[52:55], v[92:95], v[140:143], v[52:55]
    ds_read_b64_tr_b16 v[84:85], v3 offset:40960
    v_mfma_f32_16x16x32_bf16 v[56:59], v[92:95], v[144:147], v[56:59]
    ds_read_b64_tr_b16 v[86:87], v3 offset:45056
    s_waitcnt lgkmcnt(6)
    v_mfma_f32_16x16x32_bf16 v[60:63], v[96:99], v[140:143], v[60:63]
    ds_read_b64_tr_b16 v[88:89], v2 offset:40992
    v_mfma_f32_16x16x32_bf16 v[64:67], v[96:99], v[144:147], v[64:67]
    s_bfe_u32 s22, s42, 0x3001c
    s_or_b32 s22, s22, s62
    s_lshl_b32 s22, s22, 18
    s_add_u32 s22, s22, s16
    s_add_u32 s22, s22, 0x24000
    s_add_u32 m0, s17, 0x1c800
    s_nop 0
    buffer_load_dwordx4 v17, s[4:7], s22 offen lds
    ds_read_b64_tr_b16 v[90:91], v2 offset:45088
    s_waitcnt lgkmcnt(6)
    v_mfma_f32_16x16x32_bf16 v[68:71], v[100:103], v[140:143], v[68:71]
    ds_read_b64_tr_b16 v[92:93], v3 offset:41216
    v_mfma_f32_16x16x32_bf16 v[72:75], v[100:103], v[144:147], v[72:75]
    ds_read_b64_tr_b16 v[94:95], v3 offset:45312
    s_waitcnt lgkmcnt(6)
    v_mfma_f32_16x16x32_bf16 v[76:79], v[104:107], v[140:143], v[76:79]
    ds_read_b64_tr_b16 v[96:97], v2 offset:41248
    v_mfma_f32_16x16x32_bf16 v[80:83], v[104:107], v[144:147], v[80:83]
    ds_read_b64_tr_b16 v[98:99], v2 offset:45344
    s_add_u32 s23, s21, 0x1020800
    buffer_load_dwordx4 v[112:115], v4, s[8:11], s23 offen offset:0 sc1
    s_waitcnt vmcnt(22) lgkmcnt(6)
    v_mfma_f32_16x16x32_bf16 v[20:23], v[84:87], v[148:151], v[20:23]
    ds_read_b64_tr_b16 v[100:101], v3 offset:41472
    s_waitcnt vmcnt(20)
    v_mfma_f32_16x16x32_bf16 v[24:27], v[84:87], v[152:155], v[24:27]
    ds_read_b64_tr_b16 v[102:103], v3 offset:45568
    s_waitcnt lgkmcnt(6)
    v_mfma_f32_16x16x32_bf16 v[28:31], v[88:91], v[148:151], v[28:31]
    ds_read_b64_tr_b16 v[104:105], v2 offset:41504
    v_mfma_f32_16x16x32_bf16 v[32:35], v[88:91], v[152:155], v[32:35]
    s_bfe_u32 s22, s42, 0x3001c
    s_or_b32 s22, s22, s62
    s_lshl_b32 s22, s22, 18
    s_add_u32 s22, s22, s16
    s_add_u32 s22, s22, 0x26000
    s_add_u32 m0, s17, 0x1cc00
    s_nop 0
    buffer_load_dwordx4 v18, s[4:7], s22 offen lds
    ds_read_b64_tr_b16 v[106:107], v2 offset:45600
    s_waitcnt lgkmcnt(6)
    v_mfma_f32_16x16x32_bf16 v[36:39], v[92:95], v[148:151], v[36:39]
    ds_read_b64_tr_b16 v[84:85], v3 offset:41728
    v_mfma_f32_16x16x32_bf16 v[40:43], v[92:95], v[152:155], v[40:43]
    ds_read_b64_tr_b16 v[86:87], v3 offset:45824
    s_waitcnt lgkmcnt(6)
    v_mfma_f32_16x16x32_bf16 v[44:47], v[96:99], v[148:151], v[44:47]
    ds_read_b64_tr_b16 v[88:89], v2 offset:41760
    v_mfma_f32_16x16x32_bf16 v[48:51], v[96:99], v[152:155], v[48:51]
    ds_read_b64_tr_b16 v[90:91], v2 offset:45856
    s_add_u32 s23, s21, 0x1000800
    buffer_load_dwordx4 v[116:119], v4, s[8:11], s23 offen offset:1024 sc1
    s_waitcnt lgkmcnt(6)
    v_mfma_f32_16x16x32_bf16 v[52:55], v[100:103], v[148:151], v[52:55]
    v_mfma_f32_16x16x32_bf16 v[56:59], v[100:103], v[152:155], v[56:59]
    s_barrier
    ds_read_b64_tr_b16 v[92:93], v3 offset:49152
    ds_read_b64_tr_b16 v[94:95], v3 offset:53248
    s_waitcnt lgkmcnt(6)
    v_mfma_f32_16x16x32_bf16 v[60:63], v[104:107], v[148:151], v[60:63]
    ds_read_b64_tr_b16 v[96:97], v2 offset:49184
    v_mfma_f32_16x16x32_bf16 v[64:67], v[104:107], v[152:155], v[64:67]
    ds_read_b64_tr_b16 v[98:99], v2 offset:53280
    s_waitcnt lgkmcnt(6)
    v_mfma_f32_16x16x32_bf16 v[68:71], v[84:87], v[148:151], v[68:71]
    ds_read_b64_tr_b16 v[100:101], v3 offset:49408
    v_mfma_f32_16x16x32_bf16 v[72:75], v[84:87], v[152:155], v[72:75]
    ds_read_b64_tr_b16 v[102:103], v3 offset:53504
    s_waitcnt lgkmcnt(6)
    v_mfma_f32_16x16x32_bf16 v[76:79], v[88:91], v[148:151], v[76:79]
    ds_read_b64_tr_b16 v[104:105], v2 offset:49440
    v_mfma_f32_16x16x32_bf16 v[80:83], v[88:91], v[152:155], v[80:83]
    ds_read_b64_tr_b16 v[106:107], v2 offset:53536
    s_add_u32 s23, s21, 0x1020800
    buffer_load_dwordx4 v[120:123], v4, s[8:11], s23 offen offset:1024 sc1
    s_waitcnt vmcnt(21) lgkmcnt(6)
    v_mfma_f32_16x16x32_bf16 v[20:23], v[92:95], v[156:159], v[20:23]
    ds_read_b64_tr_b16 v[84:85], v3 offset:49664
    s_waitcnt vmcnt(19)
    v_mfma_f32_16x16x32_bf16 v[24:27], v[92:95], v[160:163], v[24:27]
    ds_read_b64_tr_b16 v[86:87], v3 offset:53760
    s_waitcnt lgkmcnt(6)
    v_mfma_f32_16x16x32_bf16 v[28:31], v[96:99], v[156:159], v[28:31]
    ds_read_b64_tr_b16 v[88:89], v2 offset:49696
    v_mfma_f32_16x16x32_bf16 v[32:35], v[96:99], v[160:163], v[32:35]
    ds_read_b64_tr_b16 v[90:91], v2 offset:53792
    s_waitcnt lgkmcnt(6)
    v_mfma_f32_16x16x32_bf16 v[36:39], v[100:103], v[156:159], v[36:39]
    ds_read_b64_tr_b16 v[92:93], v3 offset:49920
    v_mfma_f32_16x16x32_bf16 v[40:43], v[100:103], v[160:163], v[40:43]
    ds_read_b64_tr_b16 v[94:95], v3 offset:54016
    s_waitcnt lgkmcnt(6)
    v_mfma_f32_16x16x32_bf16 v[44:47], v[104:107], v[156:159], v[44:47]
    ds_read_b64_tr_b16 v[96:97], v2 offset:49952
    v_mfma_f32_16x16x32_bf16 v[48:51], v[104:107], v[160:163], v[48:51]
    ds_read_b64_tr_b16 v[98:99], v2 offset:54048
    s_bfe_u32 s21, s42, 0x3001c
    s_or_b32 s21, s21, s62
    s_lshl_b32 s21, s21, 12
    s_add_u32 s23, s21, 0x1000000
    buffer_load_dwordx4 v[140:143], v4, s[8:11], s23 offen offset:0 sc1
    s_waitcnt lgkmcnt(6)
    v_mfma_f32_16x16x32_bf16 v[52:55], v[84:87], v[156:159], v[52:55]
    ds_read_b64_tr_b16 v[100:101], v3 offset:57344
    v_mfma_f32_16x16x32_bf16 v[56:59], v[84:87], v[160:163], v[56:59]
    ds_read_b64_tr_b16 v[102:103], v3 offset:61440
    s_waitcnt lgkmcnt(6)
    v_mfma_f32_16x16x32_bf16 v[60:63], v[88:91], v[156:159], v[60:63]
    ds_read_b64_tr_b16 v[104:105], v2 offset:57376
    v_mfma_f32_16x16x32_bf16 v[64:67], v[88:91], v[160:163], v[64:67]
    ds_read_b64_tr_b16 v[106:107], v2 offset:61472
    s_waitcnt lgkmcnt(6)
    v_mfma_f32_16x16x32_bf16 v[68:71], v[92:95], v[156:159], v[68:71]
    ds_read_b64_tr_b16 v[84:85], v3 offset:57600
    v_mfma_f32_16x16x32_bf16 v[72:75], v[92:95], v[160:163], v[72:75]
    ds_read_b64_tr_b16 v[86:87], v3 offset:61696
    s_waitcnt lgkmcnt(6)
    v_mfma_f32_16x16x32_bf16 v[76:79], v[96:99], v[156:159], v[76:79]
    ds_read_b64_tr_b16 v[88:89], v2 offset:57632
    v_mfma_f32_16x16x32_bf16 v[80:83], v[96:99], v[160:163], v[80:83]
    ds_read_b64_tr_b16 v[90:91], v2 offset:61728
    s_add_u32 s23, s21, 0x1020000
    buffer_load_dwordx4 v[144:147], v4, s[8:11], s23 offen offset:0 sc1
    s_waitcnt vmcnt(19) lgkmcnt(6)
    v_mfma_f32_16x16x32_bf16 v[20:23], v[100:103], v[164:167], v[20:23]
    ds_read_b64_tr_b16 v[92:93], v3 offset:57856
    s_waitcnt vmcnt(17)
    v_mfma_f32_16x16x32_bf16 v[24:27], v[100:103], v[168:171], v[24:27]
    ds_read_b64_tr_b16 v[94:95], v3 offset:61952
    s_waitcnt lgkmcnt(6)
    v_mfma_f32_16x16x32_bf16 v[28:31], v[104:107], v[164:167], v[28:31]
    ds_read_b64_tr_b16 v[96:97], v2 offset:57888
    v_mfma_f32_16x16x32_bf16 v[32:35], v[104:107], v[168:171], v[32:35]
    ds_read_b64_tr_b16 v[98:99], v2 offset:61984
    s_waitcnt lgkmcnt(6)
    v_mfma_f32_16x16x32_bf16 v[36:39], v[84:87], v[164:167], v[36:39]
    ds_read_b64_tr_b16 v[100:101], v3 offset:58112
    v_mfma_f32_16x16x32_bf16 v[40:43], v[84:87], v[168:171], v[40:43]
    ds_read_b64_tr_b16 v[102:103], v3 offset:62208
    s_waitcnt lgkmcnt(6)
    v_mfma_f32_16x16x32_bf16 v[44:47], v[88:91], v[164:167], v[44:47]
    ds_read_b64_tr_b16 v[104:105], v2 offset:58144
    v_mfma_f32_16x16x32_bf16 v[48:51], v[88:91], v[168:171], v[48:51]
    ds_read_b64_tr_b16 v[106:107], v2 offset:62240
    s_add_u32 s23, s21, 0x1000000
    buffer_load_dwordx4 v[148:151], v4, s[8:11], s23 offen offset:1024 sc1
    s_waitcnt lgkmcnt(6)
    v_mfma_f32_16x16x32_bf16 v[52:55], v[92:95], v[164:167], v[52:55]
    v_mfma_f32_16x16x32_bf16 v[56:59], v[92:95], v[168:171], v[56:59]
    s_waitcnt vmcnt(5)
    s_barrier
    ds_read_b64_tr_b16 v[84:85], v15 offset:0
    ds_read_b64_tr_b16 v[86:87], v15 offset:4096
    s_waitcnt lgkmcnt(6)
    v_mfma_f32_16x16x32_bf16 v[60:63], v[96:99], v[164:167], v[60:63]
    ds_read_b64_tr_b16 v[88:89], v16 offset:32
    v_mfma_f32_16x16x32_bf16 v[64:67], v[96:99], v[168:171], v[64:67]
    ds_read_b64_tr_b16 v[90:91], v16 offset:4128
    s_waitcnt lgkmcnt(6)
    v_mfma_f32_16x16x32_bf16 v[68:71], v[100:103], v[164:167], v[68:71]
    ds_read_b64_tr_b16 v[92:93], v15 offset:256
    v_mfma_f32_16x16x32_bf16 v[72:75], v[100:103], v[168:171], v[72:75]
    ds_read_b64_tr_b16 v[94:95], v15 offset:4352
    s_waitcnt lgkmcnt(6)
    v_mfma_f32_16x16x32_bf16 v[76:79], v[104:107], v[164:167], v[76:79]
    ds_read_b64_tr_b16 v[96:97], v16 offset:288
    v_mfma_f32_16x16x32_bf16 v[80:83], v[104:107], v[168:171], v[80:83]
    ds_read_b64_tr_b16 v[98:99], v16 offset:4384
    s_add_u32 s23, s21, 0x1020000
    buffer_load_dwordx4 v[152:155], v4, s[8:11], s23 offen offset:1024 sc1
    s_waitcnt lgkmcnt(6)
    v_mfma_f32_16x16x32_bf16 v[20:23], v[84:87], v[188:191], v[20:23]
    ds_read_b64_tr_b16 v[100:101], v15 offset:512
    v_mfma_f32_16x16x32_bf16 v[24:27], v[84:87], v[192:195], v[24:27]
    ds_read_b64_tr_b16 v[102:103], v15 offset:4608
    s_waitcnt lgkmcnt(6)
    v_mfma_f32_16x16x32_bf16 v[28:31], v[88:91], v[188:191], v[28:31]
    ds_read_b64_tr_b16 v[104:105], v16 offset:544
    v_mfma_f32_16x16x32_bf16 v[32:35], v[88:91], v[192:195], v[32:35]
    ds_read_b64_tr_b16 v[106:107], v16 offset:4640
    s_waitcnt lgkmcnt(6)
    v_mfma_f32_16x16x32_bf16 v[36:39], v[92:95], v[188:191], v[36:39]
    ds_read_b64_tr_b16 v[84:85], v15 offset:768
    v_mfma_f32_16x16x32_bf16 v[40:43], v[92:95], v[192:195], v[40:43]
    ds_read_b64_tr_b16 v[86:87], v15 offset:4864
    s_waitcnt lgkmcnt(6)
    v_mfma_f32_16x16x32_bf16 v[44:47], v[96:99], v[188:191], v[44:47]
    ds_read_b64_tr_b16 v[88:89], v16 offset:800
    v_mfma_f32_16x16x32_bf16 v[48:51], v[96:99], v[192:195], v[48:51]
    ds_read_b64_tr_b16 v[90:91], v16 offset:4896
    s_add_u32 s23, s21, 0x1000800
    buffer_load_dwordx4 v[156:159], v4, s[8:11], s23 offen offset:0 sc1
    s_waitcnt lgkmcnt(6)
    v_mfma_f32_16x16x32_bf16 v[52:55], v[100:103], v[188:191], v[52:55]
    ds_read_b64_tr_b16 v[92:93], v15 offset:8192
    v_mfma_f32_16x16x32_bf16 v[56:59], v[100:103], v[192:195], v[56:59]
    ds_read_b64_tr_b16 v[94:95], v15 offset:12288
    s_waitcnt lgkmcnt(6)
    v_mfma_f32_16x16x32_bf16 v[60:63], v[104:107], v[188:191], v[60:63]
    ds_read_b64_tr_b16 v[96:97], v16 offset:8224
    v_mfma_f32_16x16x32_bf16 v[64:67], v[104:107], v[192:195], v[64:67]
    ds_read_b64_tr_b16 v[98:99], v16 offset:12320
    s_waitcnt lgkmcnt(6)
    v_mfma_f32_16x16x32_bf16 v[68:71], v[84:87], v[188:191], v[68:71]
    ds_read_b64_tr_b16 v[100:101], v15 offset:8448
    v_mfma_f32_16x16x32_bf16 v[72:75], v[84:87], v[192:195], v[72:75]
    ds_read_b64_tr_b16 v[102:103], v15 offset:12544
    s_waitcnt lgkmcnt(6)
    v_mfma_f32_16x16x32_bf16 v[76:79], v[88:91], v[188:191], v[76:79]
    ds_read_b64_tr_b16 v[104:105], v16 offset:8480
    v_mfma_f32_16x16x32_bf16 v[80:83], v[88:91], v[192:195], v[80:83]
    ds_read_b64_tr_b16 v[106:107], v16 offset:12576
    s_add_u32 s23, s21, 0x1020800
    buffer_load_dwordx4 v[160:163], v4, s[8:11], s23 offen offset:0 sc1
    s_waitcnt lgkmcnt(6)
    v_mfma_f32_16x16x32_bf16 v[20:23], v[92:95], v[196:199], v[20:23]
    ds_read_b64_tr_b16 v[84:85], v15 offset:8704
    v_mfma_f32_16x16x32_bf16 v[24:27], v[92:95], v[200:203], v[24:27]
    ds_read_b64_tr_b16 v[86:87], v15 offset:12800
    s_waitcnt lgkmcnt(6)
    v_mfma_f32_16x16x32_bf16 v[28:31], v[96:99], v[196:199], v[28:31]
    ds_read_b64_tr_b16 v[88:89], v16 offset:8736
    v_mfma_f32_16x16x32_bf16 v[32:35], v[96:99], v[200:203], v[32:35]
    ds_read_b64_tr_b16 v[90:91], v16 offset:12832
    s_waitcnt lgkmcnt(6)
    v_mfma_f32_16x16x32_bf16 v[36:39], v[100:103], v[196:199], v[36:39]
    ds_read_b64_tr_b16 v[92:93], v15 offset:8960
    v_mfma_f32_16x16x32_bf16 v[40:43], v[100:103], v[200:203], v[40:43]
    ds_read_b64_tr_b16 v[94:95], v15 offset:13056
    s_waitcnt lgkmcnt(6)
    v_mfma_f32_16x16x32_bf16 v[44:47], v[104:107], v[196:199], v[44:47]
    ds_read_b64_tr_b16 v[96:97], v16 offset:8992
    v_mfma_f32_16x16x32_bf16 v[48:51], v[104:107], v[200:203], v[48:51]
    ds_read_b64_tr_b16 v[98:99], v16 offset:13088
    s_add_u32 s23, s21, 0x1000800
    buffer_load_dwordx4 v[164:167], v4, s[8:11], s23 offen offset:1024 sc1
    s_waitcnt lgkmcnt(6)
    v_mfma_f32_16x16x32_bf16 v[52:55], v[84:87], v[196:199], v[52:55]
    ds_read_b64_tr_b16 v[100:101], v15 offset:16384
    v_mfma_f32_16x16x32_bf16 v[56:59], v[84:87], v[200:203], v[56:59]
    ds_read_b64_tr_b16 v[102:103], v15 offset:20480
    s_waitcnt lgkmcnt(6)
    v_mfma_f32_16x16x32_bf16 v[60:63], v[88:91], v[196:199], v[60:63]
    ds_read_b64_tr_b16 v[104:105], v16 offset:16416
    v_mfma_f32_16x16x32_bf16 v[64:67], v[88:91], v[200:203], v[64:67]
    ds_read_b64_tr_b16 v[106:107], v16 offset:20512
    s_waitcnt lgkmcnt(6)
    v_mfma_f32_16x16x32_bf16 v[68:71], v[92:95], v[196:199], v[68:71]
    ds_read_b64_tr_b16 v[84:85], v15 offset:24576
    v_mfma_f32_16x16x32_bf16 v[72:75], v[92:95], v[200:203], v[72:75]
    ds_read_b64_tr_b16 v[86:87], v15 offset:28672
    s_waitcnt lgkmcnt(6)
    v_mfma_f32_16x16x32_bf16 v[76:79], v[96:99], v[196:199], v[76:79]
    ds_read_b64_tr_b16 v[88:89], v16 offset:24608
    v_mfma_f32_16x16x32_bf16 v[80:83], v[96:99], v[200:203], v[80:83]
    ds_read_b64_tr_b16 v[90:91], v16 offset:28704
    s_add_u32 s23, s21, 0x1020800
    buffer_load_dwordx4 v[168:171], v4, s[8:11], s23 offen offset:1024 sc1
    s_waitcnt lgkmcnt(6)
    v_mfma_f32_16x16x32_bf16 v[20:23], v[100:103], v[108:111], v[20:23]
    ds_read_b64_tr_b16 v[92:93], v15 offset:32768
    v_mfma_f32_16x16x32_bf16 v[24:27], v[100:103], v[112:115], v[24:27]
    ds_read_b64_tr_b16 v[94:95], v15 offset:36864
    s_waitcnt lgkmcnt(6)
    v_mfma_f32_16x16x32_bf16 v[28:31], v[104:107], v[108:111], v[28:31]
    ds_read_b64_tr_b16 v[96:97], v16 offset:32800
    v_mfma_f32_16x16x32_bf16 v[32:35], v[104:107], v[112:115], v[32:35]
    ds_read_b64_tr_b16 v[98:99], v16 offset:36896
    s_waitcnt vmcnt(9) lgkmcnt(6)
    v_mfma_f32_16x16x32_bf16 v[20:23], v[84:87], v[116:119], v[20:23]
    ds_read_b64_tr_b16 v[100:101], v15 offset:40960
    s_waitcnt vmcnt(8)
    v_mfma_f32_16x16x32_bf16 v[24:27], v[84:87], v[120:123], v[24:27]
    ds_read_b64_tr_b16 v[102:103], v15 offset:45056
    s_waitcnt lgkmcnt(6)
    v_mfma_f32_16x16x32_bf16 v[28:31], v[88:91], v[116:119], v[28:31]
    ds_read_b64_tr_b16 v[104:105], v16 offset:40992
    v_mfma_f32_16x16x32_bf16 v[32:35], v[88:91], v[120:123], v[32:35]
    ds_read_b64_tr_b16 v[106:107], v16 offset:45088
    s_waitcnt vmcnt(7) lgkmcnt(6)
    v_mfma_f32_16x16x32_bf16 v[20:23], v[92:95], v[140:143], v[20:23]
    ds_read_b64_tr_b16 v[84:85], v15 offset:49152
    s_waitcnt vmcnt(6)
    v_mfma_f32_16x16x32_bf16 v[24:27], v[92:95], v[144:147], v[24:27]
    ds_read_b64_tr_b16 v[86:87], v15 offset:53248
    s_waitcnt lgkmcnt(6)
    v_mfma_f32_16x16x32_bf16 v[28:31], v[96:99], v[140:143], v[28:31]
    ds_read_b64_tr_b16 v[88:89], v16 offset:49184
    v_mfma_f32_16x16x32_bf16 v[32:35], v[96:99], v[144:147], v[32:35]
    ds_read_b64_tr_b16 v[90:91], v16 offset:53280
    s_waitcnt vmcnt(5) lgkmcnt(6)
    v_mfma_f32_16x16x32_bf16 v[20:23], v[100:103], v[148:151], v[20:23]
    ds_read_b64_tr_b16 v[92:93], v15 offset:57344
    s_waitcnt vmcnt(4)
    v_mfma_f32_16x16x32_bf16 v[24:27], v[100:103], v[152:155], v[24:27]
    ds_read_b64_tr_b16 v[94:95], v15 offset:61440
    s_waitcnt lgkmcnt(6)
    v_mfma_f32_16x16x32_bf16 v[28:31], v[104:107], v[148:151], v[28:31]
    ds_read_b64_tr_b16 v[96:97], v16 offset:57376
    v_mfma_f32_16x16x32_bf16 v[32:35], v[104:107], v[152:155], v[32:35]
    ds_read_b64_tr_b16 v[98:99], v16 offset:61472
    s_waitcnt vmcnt(3) lgkmcnt(6)
    v_mfma_f32_16x16x32_bf16 v[20:23], v[84:87], v[156:159], v[20:23]
    ds_read_b64_tr_b16 v[100:101], v15 offset:16640
    s_waitcnt vmcnt(2)
    v_mfma_f32_16x16x32_bf16 v[24:27], v[84:87], v[160:163], v[24:27]
    ds_read_b64_tr_b16 v[102:103], v15 offset:20736
    s_waitcnt lgkmcnt(6)
    v_mfma_f32_16x16x32_bf16 v[28:31], v[88:91], v[156:159], v[28:31]
    ds_read_b64_tr_b16 v[104:105], v16 offset:16672
    v_mfma_f32_16x16x32_bf16 v[32:35], v[88:91], v[160:163], v[32:35]
    ds_read_b64_tr_b16 v[106:107], v16 offset:20768
    s_waitcnt vmcnt(1) lgkmcnt(6)
    v_mfma_f32_16x16x32_bf16 v[20:23], v[92:95], v[164:167], v[20:23]
    ds_read_b64_tr_b16 v[84:85], v15 offset:24832
    s_waitcnt vmcnt(0)
    v_mfma_f32_16x16x32_bf16 v[24:27], v[92:95], v[168:171], v[24:27]
    ds_read_b64_tr_b16 v[86:87], v15 offset:28928
    s_waitcnt lgkmcnt(6)
    v_mfma_f32_16x16x32_bf16 v[28:31], v[96:99], v[164:167], v[28:31]
    ds_read_b64_tr_b16 v[88:89], v16 offset:24864
    v_mfma_f32_16x16x32_bf16 v[32:35], v[96:99], v[168:171], v[32:35]
    ds_read_b64_tr_b16 v[90:91], v16 offset:28960
    ds_read_b128 v[124:127], v13 offset:0
    ds_read_b128 v[128:131], v13 offset:64
    s_waitcnt lgkmcnt(8)
    v_mfma_f32_16x16x32_bf16 v[36:39], v[100:103], v[108:111], v[36:39]
    ds_read_b64_tr_b16 v[92:93], v15 offset:33024
    v_mfma_f32_16x16x32_bf16 v[40:43], v[100:103], v[112:115], v[40:43]
    ds_read_b64_tr_b16 v[94:95], v15 offset:37120
    s_waitcnt lgkmcnt(8)
    v_mfma_f32_16x16x32_bf16 v[44:47], v[104:107], v[108:111], v[44:47]
    ds_read_b64_tr_b16 v[96:97], v16 offset:33056
    v_mfma_f32_16x16x32_bf16 v[48:51], v[104:107], v[112:115], v[48:51]
    ds_read_b64_tr_b16 v[98:99], v16 offset:37152
    s_waitcnt lgkmcnt(8)
    v_mfma_f32_16x16x32_bf16 v[36:39], v[84:87], v[116:119], v[36:39]
    s_waitcnt lgkmcnt(5)
    v_pk_mul_f32 v[132:133], v[20:21], v[124:125]
    v_pk_mul_f32 v[134:135], v[22:23], v[126:127]
    ds_read_b64_tr_b16 v[100:101], v15 offset:41216
    v_mfma_f32_16x16x32_bf16 v[40:43], v[84:87], v[120:123], v[40:43]
    s_waitcnt lgkmcnt(5)
    v_pk_mul_f32 v[136:137], v[28:29], v[128:129]
    ds_read_b64_tr_b16 v[102:103], v15 offset:45312
    v_mfma_f32_16x16x32_bf16 v[44:47], v[88:91], v[116:119], v[44:47]
    v_pk_mul_f32 v[138:139], v[30:31], v[130:131]
    v_cvt_pk_bf16_f32 v132, v132, v133
    ds_read_b64_tr_b16 v[104:105], v16 offset:41248
    v_mfma_f32_16x16x32_bf16 v[48:51], v[88:91], v[120:123], v[48:51]
    v_cvt_pk_bf16_f32 v133, v134, v135
    ds_read_b64_tr_b16 v[106:107], v16 offset:45344
    s_waitcnt lgkmcnt(6)
    v_mfma_f32_16x16x32_bf16 v[36:39], v[92:95], v[140:143], v[36:39]
    v_cvt_pk_bf16_f32 v134, v136, v137
    v_cvt_pk_bf16_f32 v135, v138, v139
    ds_read_b64_tr_b16 v[84:85], v15 offset:49408
    v_mfma_f32_16x16x32_bf16 v[40:43], v[92:95], v[144:147], v[40:43]
    v_permlane32_swap_b32 v132, v134
    ds_read_b64_tr_b16 v[86:87], v15 offset:53504
    s_waitcnt lgkmcnt(6)
    v_mfma_f32_16x16x32_bf16 v[44:47], v[96:99], v[140:143], v[44:47]
    v_permlane32_swap_b32 v133, v135
    v_permlane16_swap_b32 v132, v134
    ds_read_b64_tr_b16 v[88:89], v16 offset:49440
    v_mfma_f32_16x16x32_bf16 v[48:51], v[96:99], v[144:147], v[48:51]
    v_permlane16_swap_b32 v133, v135
    ds_read_b64_tr_b16 v[90:91], v16 offset:53536
    s_waitcnt lgkmcnt(6)
    v_mfma_f32_16x16x32_bf16 v[36:39], v[100:103], v[148:151], v[36:39]
    buffer_store_dwordx4 v[132:135], v14, s[8:11], s18 offen offset:0 sc1
    ds_read_b64_tr_b16 v[92:93], v15 offset:57600
    v_mfma_f32_16x16x32_bf16 v[40:43], v[100:103], v[152:155], v[40:43]
    v_pk_mul_f32 v[132:133], v[24:25], v[124:125]
    v_pk_mul_f32 v[134:135], v[26:27], v[126:127]
    ds_read_b64_tr_b16 v[94:95], v15 offset:61696
    s_waitcnt lgkmcnt(6)
    v_mfma_f32_16x16x32_bf16 v[44:47], v[104:107], v[148:151], v[44:47]
    v_pk_mul_f32 v[136:137], v[32:33], v[128:129]
    ds_read_b64_tr_b16 v[96:97], v16 offset:57632
    v_mfma_f32_16x16x32_bf16 v[48:51], v[104:107], v[152:155], v[48:51]
    v_pk_mul_f32 v[138:139], v[34:35], v[130:131]
    v_cvt_pk_bf16_f32 v132, v132, v133
    ds_read_b64_tr_b16 v[98:99], v16 offset:61728
    s_waitcnt lgkmcnt(6)
    v_mfma_f32_16x16x32_bf16 v[36:39], v[84:87], v[156:159], v[36:39]
    v_cvt_pk_bf16_f32 v133, v134, v135
    ds_read_b64_tr_b16 v[100:101], v15 offset:16896
    v_mfma_f32_16x16x32_bf16 v[40:43], v[84:87], v[160:163], v[40:43]
    v_cvt_pk_bf16_f32 v134, v136, v137
    v_cvt_pk_bf16_f32 v135, v138, v139
    ds_read_b64_tr_b16 v[102:103], v15 offset:20992
    s_waitcnt lgkmcnt(6)
    v_mfma_f32_16x16x32_bf16 v[44:47], v[88:91], v[156:159], v[44:47]
    v_permlane32_swap_b32 v132, v134
    ds_read_b64_tr_b16 v[104:105], v16 offset:16928
    v_mfma_f32_16x16x32_bf16 v[48:51], v[88:91], v[160:163], v[48:51]
    v_permlane32_swap_b32 v133, v135
    v_permlane16_swap_b32 v132, v134
    ds_read_b64_tr_b16 v[106:107], v16 offset:21024
    s_waitcnt lgkmcnt(6)
    v_mfma_f32_16x16x32_bf16 v[36:39], v[92:95], v[164:167], v[36:39]
    v_permlane16_swap_b32 v133, v135
    ds_read_b64_tr_b16 v[84:85], v15 offset:25088
    v_mfma_f32_16x16x32_bf16 v[40:43], v[92:95], v[168:171], v[40:43]
    buffer_store_dwordx4 v[132:135], v14, s[8:11], s19 offen offset:0 sc1
    ds_read_b64_tr_b16 v[86:87], v15 offset:29184
    s_waitcnt lgkmcnt(6)
    v_mfma_f32_16x16x32_bf16 v[44:47], v[96:99], v[164:167], v[44:47]
    ds_read_b64_tr_b16 v[88:89], v16 offset:25120
    v_mfma_f32_16x16x32_bf16 v[48:51], v[96:99], v[168:171], v[48:51]
    ds_read_b64_tr_b16 v[90:91], v16 offset:29216
    ds_read_b128 v[124:127], v13 offset:128
    ds_read_b128 v[128:131], v13 offset:192
    s_waitcnt lgkmcnt(8)
    v_mfma_f32_16x16x32_bf16 v[52:55], v[100:103], v[108:111], v[52:55]
    ds_read_b64_tr_b16 v[92:93], v15 offset:33280
    v_mfma_f32_16x16x32_bf16 v[56:59], v[100:103], v[112:115], v[56:59]
    ds_read_b64_tr_b16 v[94:95], v15 offset:37376
    s_waitcnt lgkmcnt(8)
    v_mfma_f32_16x16x32_bf16 v[60:63], v[104:107], v[108:111], v[60:63]
    ds_read_b64_tr_b16 v[96:97], v16 offset:33312
    v_mfma_f32_16x16x32_bf16 v[64:67], v[104:107], v[112:115], v[64:67]
    ds_read_b64_tr_b16 v[98:99], v16 offset:37408
    s_waitcnt lgkmcnt(8)
    v_mfma_f32_16x16x32_bf16 v[52:55], v[84:87], v[116:119], v[52:55]
    s_waitcnt lgkmcnt(5)
    v_pk_mul_f32 v[132:133], v[36:37], v[124:125]
    v_pk_mul_f32 v[134:135], v[38:39], v[126:127]
    ds_read_b64_tr_b16 v[100:101], v15 offset:41472
    v_mfma_f32_16x16x32_bf16 v[56:59], v[84:87], v[120:123], v[56:59]
    s_waitcnt lgkmcnt(5)
    v_pk_mul_f32 v[136:137], v[44:45], v[128:129]
    ds_read_b64_tr_b16 v[102:103], v15 offset:45568
    v_mfma_f32_16x16x32_bf16 v[60:63], v[88:91], v[116:119], v[60:63]
    v_pk_mul_f32 v[138:139], v[46:47], v[130:131]
    v_cvt_pk_bf16_f32 v132, v132, v133
    ds_read_b64_tr_b16 v[104:105], v16 offset:41504
    v_mfma_f32_16x16x32_bf16 v[64:67], v[88:91], v[120:123], v[64:67]
    v_cvt_pk_bf16_f32 v133, v134, v135
    ds_read_b64_tr_b16 v[106:107], v16 offset:45600
    s_waitcnt lgkmcnt(6)
    v_mfma_f32_16x16x32_bf16 v[52:55], v[92:95], v[140:143], v[52:55]
    v_cvt_pk_bf16_f32 v134, v136, v137
    v_cvt_pk_bf16_f32 v135, v138, v139
    ds_read_b64_tr_b16 v[84:85], v15 offset:49664
    v_mfma_f32_16x16x32_bf16 v[56:59], v[92:95], v[144:147], v[56:59]
    v_permlane32_swap_b32 v132, v134
    ds_read_b64_tr_b16 v[86:87], v15 offset:53760
    s_waitcnt lgkmcnt(6)
    v_mfma_f32_16x16x32_bf16 v[60:63], v[96:99], v[140:143], v[60:63]
    v_permlane32_swap_b32 v133, v135
    v_permlane16_swap_b32 v132, v134
    ds_read_b64_tr_b16 v[88:89], v16 offset:49696
    v_mfma_f32_16x16x32_bf16 v[64:67], v[96:99], v[144:147], v[64:67]
    v_permlane16_swap_b32 v133, v135
    ds_read_b64_tr_b16 v[90:91], v16 offset:53792
    s_waitcnt lgkmcnt(6)
    v_mfma_f32_16x16x32_bf16 v[52:55], v[100:103], v[148:151], v[52:55]
    buffer_store_dwordx4 v[132:135], v14, s[8:11], s18 offen offset:1024 sc1
    ds_read_b64_tr_b16 v[92:93], v15 offset:57856
    v_mfma_f32_16x16x32_bf16 v[56:59], v[100:103], v[152:155], v[56:59]
    v_pk_mul_f32 v[132:133], v[40:41], v[124:125]
    v_pk_mul_f32 v[134:135], v[42:43], v[126:127]
    ds_read_b64_tr_b16 v[94:95], v15 offset:61952
    s_waitcnt lgkmcnt(6)
    v_mfma_f32_16x16x32_bf16 v[60:63], v[104:107], v[148:151], v[60:63]
    v_pk_mul_f32 v[136:137], v[48:49], v[128:129]
    ds_read_b64_tr_b16 v[96:97], v16 offset:57888
    v_mfma_f32_16x16x32_bf16 v[64:67], v[104:107], v[152:155], v[64:67]
    v_pk_mul_f32 v[138:139], v[50:51], v[130:131]
    v_cvt_pk_bf16_f32 v132, v132, v133
    ds_read_b64_tr_b16 v[98:99], v16 offset:61984
    s_waitcnt lgkmcnt(6)
    v_mfma_f32_16x16x32_bf16 v[52:55], v[84:87], v[156:159], v[52:55]
    v_cvt_pk_bf16_f32 v133, v134, v135
    ds_read_b64_tr_b16 v[100:101], v15 offset:17152
    v_mfma_f32_16x16x32_bf16 v[56:59], v[84:87], v[160:163], v[56:59]
    v_cvt_pk_bf16_f32 v134, v136, v137
    v_cvt_pk_bf16_f32 v135, v138, v139
    ds_read_b64_tr_b16 v[102:103], v15 offset:21248
    s_waitcnt lgkmcnt(6)
    v_mfma_f32_16x16x32_bf16 v[60:63], v[88:91], v[156:159], v[60:63]
    v_permlane32_swap_b32 v132, v134
    ds_read_b64_tr_b16 v[104:105], v16 offset:17184
    v_mfma_f32_16x16x32_bf16 v[64:67], v[88:91], v[160:163], v[64:67]
    v_permlane32_swap_b32 v133, v135
    v_permlane16_swap_b32 v132, v134
    ds_read_b64_tr_b16 v[106:107], v16 offset:21280
    s_waitcnt lgkmcnt(6)
    v_mfma_f32_16x16x32_bf16 v[52:55], v[92:95], v[164:167], v[52:55]
    v_permlane16_swap_b32 v133, v135
    ds_read_b64_tr_b16 v[84:85], v15 offset:25344
    v_mfma_f32_16x16x32_bf16 v[56:59], v[92:95], v[168:171], v[56:59]
    buffer_store_dwordx4 v[132:135], v14, s[8:11], s19 offen offset:1024 sc1
    ds_read_b64_tr_b16 v[86:87], v15 offset:29440
    s_waitcnt lgkmcnt(6)
    v_mfma_f32_16x16x32_bf16 v[60:63], v[96:99], v[164:167], v[60:63]
    ds_read_b64_tr_b16 v[88:89], v16 offset:25376
    v_mfma_f32_16x16x32_bf16 v[64:67], v[96:99], v[168:171], v[64:67]
    ds_read_b64_tr_b16 v[90:91], v16 offset:29472
    ds_read_b128 v[124:127], v13 offset:256
    ds_read_b128 v[128:131], v13 offset:320
    s_waitcnt lgkmcnt(8)
    v_mfma_f32_16x16x32_bf16 v[68:71], v[100:103], v[108:111], v[68:71]
    ds_read_b64_tr_b16 v[92:93], v15 offset:33536
    v_mfma_f32_16x16x32_bf16 v[72:75], v[100:103], v[112:115], v[72:75]
    ds_read_b64_tr_b16 v[94:95], v15 offset:37632
    s_waitcnt lgkmcnt(8)
    v_mfma_f32_16x16x32_bf16 v[76:79], v[104:107], v[108:111], v[76:79]
    ds_read_b64_tr_b16 v[96:97], v16 offset:33568
    v_mfma_f32_16x16x32_bf16 v[80:83], v[104:107], v[112:115], v[80:83]
    ds_read_b64_tr_b16 v[98:99], v16 offset:37664
    s_waitcnt lgkmcnt(8)
    v_mfma_f32_16x16x32_bf16 v[68:71], v[84:87], v[116:119], v[68:71]
    s_waitcnt lgkmcnt(5)
    v_pk_mul_f32 v[132:133], v[52:53], v[124:125]
    v_pk_mul_f32 v[134:135], v[54:55], v[126:127]
    ds_read_b64_tr_b16 v[100:101], v15 offset:41728
    v_mfma_f32_16x16x32_bf16 v[72:75], v[84:87], v[120:123], v[72:75]
    s_waitcnt lgkmcnt(5)
    v_pk_mul_f32 v[136:137], v[60:61], v[128:129]
    ds_read_b64_tr_b16 v[102:103], v15 offset:45824
    v_mfma_f32_16x16x32_bf16 v[76:79], v[88:91], v[116:119], v[76:79]
    v_pk_mul_f32 v[138:139], v[62:63], v[130:131]
    v_cvt_pk_bf16_f32 v132, v132, v133
    ds_read_b64_tr_b16 v[104:105], v16 offset:41760
    v_mfma_f32_16x16x32_bf16 v[80:83], v[88:91], v[120:123], v[80:83]
    v_cvt_pk_bf16_f32 v133, v134, v135
    ds_read_b64_tr_b16 v[106:107], v16 offset:45856
    s_waitcnt lgkmcnt(6)
    v_mfma_f32_16x16x32_bf16 v[68:71], v[92:95], v[140:143], v[68:71]
    v_cvt_pk_bf16_f32 v134, v136, v137
    v_cvt_pk_bf16_f32 v135, v138, v139
    ds_read_b64_tr_b16 v[84:85], v15 offset:49920
    v_mfma_f32_16x16x32_bf16 v[72:75], v[92:95], v[144:147], v[72:75]
    v_permlane32_swap_b32 v132, v134
    ds_read_b64_tr_b16 v[86:87], v15 offset:54016
    s_waitcnt lgkmcnt(6)
    v_mfma_f32_16x16x32_bf16 v[76:79], v[96:99], v[140:143], v[76:79]
    v_permlane32_swap_b32 v133, v135
    v_permlane16_swap_b32 v132, v134
    ds_read_b64_tr_b16 v[88:89], v16 offset:49952
    v_mfma_f32_16x16x32_bf16 v[80:83], v[96:99], v[144:147], v[80:83]
    v_permlane16_swap_b32 v133, v135
    ds_read_b64_tr_b16 v[90:91], v16 offset:54048
    s_waitcnt lgkmcnt(6)
    v_mfma_f32_16x16x32_bf16 v[68:71], v[100:103], v[148:151], v[68:71]
    buffer_store_dwordx4 v[132:135], v14, s[8:11], s18 offen offset:2048 sc1
    ds_read_b64_tr_b16 v[92:93], v15 offset:58112
    v_mfma_f32_16x16x32_bf16 v[72:75], v[100:103], v[152:155], v[72:75]
    v_pk_mul_f32 v[132:133], v[56:57], v[124:125]
    v_pk_mul_f32 v[134:135], v[58:59], v[126:127]
    ds_read_b64_tr_b16 v[94:95], v15 offset:62208
    s_waitcnt lgkmcnt(6)
    v_mfma_f32_16x16x32_bf16 v[76:79], v[104:107], v[148:151], v[76:79]
    v_pk_mul_f32 v[136:137], v[64:65], v[128:129]
    ds_read_b64_tr_b16 v[96:97], v16 offset:58144
    v_mfma_f32_16x16x32_bf16 v[80:83], v[104:107], v[152:155], v[80:83]
    v_pk_mul_f32 v[138:139], v[66:67], v[130:131]
    v_cvt_pk_bf16_f32 v132, v132, v133
    ds_read_b64_tr_b16 v[98:99], v16 offset:62240
    s_waitcnt lgkmcnt(6)
    v_mfma_f32_16x16x32_bf16 v[68:71], v[84:87], v[156:159], v[68:71]
    v_cvt_pk_bf16_f32 v133, v134, v135
    v_mfma_f32_16x16x32_bf16 v[72:75], v[84:87], v[160:163], v[72:75]
    v_cvt_pk_bf16_f32 v134, v136, v137
    v_cvt_pk_bf16_f32 v135, v138, v139
    s_waitcnt lgkmcnt(4)
    v_mfma_f32_16x16x32_bf16 v[76:79], v[88:91], v[156:159], v[76:79]
    v_permlane32_swap_b32 v132, v134
    v_mfma_f32_16x16x32_bf16 v[80:83], v[88:91], v[160:163], v[80:83]
    v_permlane32_swap_b32 v133, v135
    v_permlane16_swap_b32 v132, v134
    s_waitcnt lgkmcnt(2)
    v_mfma_f32_16x16x32_bf16 v[68:71], v[92:95], v[164:167], v[68:71]
    v_permlane16_swap_b32 v133, v135
    v_mfma_f32_16x16x32_bf16 v[72:75], v[92:95], v[168:171], v[72:75]
    buffer_store_dwordx4 v[132:135], v14, s[8:11], s19 offen offset:2048 sc1
    s_waitcnt lgkmcnt(0)
    v_mfma_f32_16x16x32_bf16 v[76:79], v[96:99], v[164:167], v[76:79]
    v_mfma_f32_16x16x32_bf16 v[80:83], v[96:99], v[168:171], v[80:83]
    ds_read_b128 v[124:127], v13 offset:384
    ds_read_b128 v[128:131], v13 offset:448
    s_waitcnt lgkmcnt(1)
    v_pk_mul_f32 v[132:133], v[68:69], v[124:125]
    v_pk_mul_f32 v[134:135], v[70:71], v[126:127]
    s_waitcnt lgkmcnt(0)
    s_nop 0
    v_pk_mul_f32 v[136:137], v[76:77], v[128:129]
    v_pk_mul_f32 v[138:139], v[78:79], v[130:131]
    v_cvt_pk_bf16_f32 v132, v132, v133
    v_cvt_pk_bf16_f32 v133, v134, v135
    v_cvt_pk_bf16_f32 v134, v136, v137
    v_cvt_pk_bf16_f32 v135, v138, v139
    s_nop 0
    v_permlane32_swap_b32 v132, v134
    v_permlane32_swap_b32 v133, v135
    s_nop 0
    v_permlane16_swap_b32 v132, v134
    v_permlane16_swap_b32 v133, v135
    buffer_store_dwordx4 v[132:135], v14, s[8:11], s18 offen offset:3072 sc1
    s_nop 1
    v_pk_mul_f32 v[132:133], v[72:73], v[124:125]
    v_pk_mul_f32 v[134:135], v[74:75], v[126:127]
    v_pk_mul_f32 v[136:137], v[80:81], v[128:129]
    v_pk_mul_f32 v[138:139], v[82:83], v[130:131]
    v_cvt_pk_bf16_f32 v132, v132, v133
    v_cvt_pk_bf16_f32 v133, v134, v135
    v_cvt_pk_bf16_f32 v134, v136, v137
    v_cvt_pk_bf16_f32 v135, v138, v139
    s_nop 0
    v_permlane32_swap_b32 v132, v134
    v_permlane32_swap_b32 v133, v135
    s_nop 0
    v_permlane16_swap_b32 v132, v134
    v_permlane16_swap_b32 v133, v135
    buffer_store_dwordx4 v[132:135], v14, s[8:11], s19 offen offset:3072 sc1
    s_branch fz_p3e
fz_p3B:
    v_bfe_u32 v9, v0, 2, 2
    v_lshrrev_b32 v10, 4, v0
    v_and_b32 v11, 3, v0
    v_lshlrev_b32 v3, 10, v10
    v_lshl_add_u32 v3, v9, 6, v3
    v_lshl_add_u32 v3, v11, 3, v3
    v_bfe_u32 v12, v0, 4, 1
    v_lshlrev_b32 v12, 5, v12
    v_sub_u32 v2, v3, v12
    v_add_u32 v3, v3, v12
    s_lshl_b32 s19, s13, 3
    s_add_u32 s19, s19, s3
    s_mul_i32 s19, s19, 262144
    v_add_u32 v4, s19, v1
    s_and_b32 s62, s12, 24
    s_and_b32 s19, s12, 7
    s_lshl_b32 s20, s19, 2
    s_lshr_b32 s20, 0x54732160, s20
    s_and_b32 s20, s20, 7
    s_lshl_b32 s20, s20, 2
    s_bfm_b32 s21, s20, 0
    s_and_b32 s22, s21, 0x51764320
    s_lshl_b32 s22, s22, 4
    s_lshl_b32 s21, s21, 4
    s_or_b32 s21, s21, 15
    s_andn2_b32 s21, 0x51764320, s21
    s_or_b32 s42, s21, s22
    s_or_b32 s42, s42, s19
    s_bfe_u32 s96, s2, 0x10002
    s_mul_i32 s96, s96, 28
    s_lshr_b32 s26, s2, 3
    s_add_u32 s96, s96, s26
    s_and_b32 s97, s2, 1
    s_bfe_u32 s98, s2, 0x10001
    s_bfe_u32 s99, s2, 0x40003
    s_and_b32 s100, s2, 7
    s_lshl_b32 s100, s100, 1
    s_lshr_b32 s26, s2, 7
    s_add_u32 s100, s100, s26
    v_lshrrev_b32 v9, 4, v0
    v_lshlrev_b32 v13, 4, v9
    s_add_u32 s19, s12, 1
    s_and_b32 s19, s19, 7
    s_lshl_b32 s26, s19, 9
    s_add_u32 s26, s26, 0x22000
    v_add_u32 v13, s26, v13
    v_and_b32 v14, 15, v0
    v_lshlrev_b32 v14, 6, v14
    v_lshl_add_u32 v14, v9, 4, v14
    s_lshr_b32 s18, s12, 3
    s_lshl_b32 s18, s18, 22
    s_lshl_b32 s26, s13, 3
    s_add_u32 s26, s26, s3
    s_lshl_b32 s26, s26, 16
    s_add_u32 s18, s18, s26
    s_lshl_b32 s19, s19, 12
    s_add_u32 s18, s18, s19
    s_add_u32 s18, s18, 0x2000000
    s_add_u32 s19, s18, 0x8000
    v_add_u32 v15, 0x10000, v3
    v_add_u32 v16, 0x10000, v2
    s_lshl_b32 s26, s13, 3
    s_add_u32 s26, s26, s3
    s_lshl_b32 s26, s26, 2
    s_lshr_b32 s27, s12, 3
    s_add_u32 s26, s26, s27
    s_lshl_b32 s26, s26, 7
    s_add_u32 s20, s26, 0x540000
    s_and_b32 s27, s12, 7
    s_lshl_b32 s27, s27, 2
    s_add_u32 s26, s20, s27
    v_mov_b32 v9, s14
    v_mov_b32 v10, 0
    s_waitcnt vmcnt(0)
    s_mov_b64 exec, 1
    buffer_store_dword v9, v10, s[8:11], s26 offen sc1
    s_mov_b64 exec, -1
    s_waitcnt lgkmcnt(0)
    s_barrier
    ds_read_b64_tr_b16 v[84:85], v3 offset:0
    ds_read_b64_tr_b16 v[86:87], v3 offset:4096
    ds_read_b64_tr_b16 v[88:89], v2 offset:32
    ds_read_b64_tr_b16 v[90:91], v2 offset:4128
    ds_read_b64_tr_b16 v[92:93], v3 offset:256
    ds_read_b64_tr_b16 v[94:95], v3 offset:4352
    ds_read_b64_tr_b16 v[96:97], v2 offset:288
    ds_read_b64_tr_b16 v[98:99], v2 offset:4384
    s_waitcnt lgkmcnt(6)
    v_mfma_f32_16x16x32_bf16 v[20:23], v[84:87], v[108:111], 0
    ds_read_b64_tr_b16 v[100:101], v3 offset:512
    v_mfma_f32_16x16x32_bf16 v[24:27], v[84:87], v[124:127], 0
    ds_read_b64_tr_b16 v[102:103], v3 offset:4608
    s_waitcnt lgkmcnt(6)
    v_mfma_f32_16x16x32_bf16 v[28:31], v[88:91], v[108:111], 0
    ds_read_b64_tr_b16 v[104:105], v2 offset:544
    v_mfma_f32_16x16x32_bf16 v[32:35], v[88:91], v[124:127], 0
    ds_read_b64_tr_b16 v[106:107], v2 offset:4640
    s_waitcnt lgkmcnt(6)
    v_mfma_f32_16x16x32_bf16 v[36:39], v[92:95], v[108:111], 0
    ds_read_b64_tr_b16 v[84:85], v3 offset:768
    v_mfma_f32_16x16x32_bf16 v[40:43], v[92:95], v[124:127], 0
    ds_read_b64_tr_b16 v[86:87], v3 offset:4864
    s_waitcnt lgkmcnt(6)
    v_mfma_f32_16x16x32_bf16 v[44:47], v[96:99], v[108:111], 0
    ds_read_b64_tr_b16 v[88:89], v2 offset:800
    v_mfma_f32_16x16x32_bf16 v[48:51], v[96:99], v[124:127], 0
    ds_read_b64_tr_b16 v[90:91], v2 offset:4896
    s_waitcnt lgkmcnt(6)
    v_mfma_f32_16x16x32_bf16 v[52:55], v[100:103], v[108:111], 0
    ds_read_b64_tr_b16 v[92:93], v3 offset:8192
    v_mfma_f32_16x16x32_bf16 v[56:59], v[100:103], v[124:127], 0
    ds_read_b64_tr_b16 v[94:95], v3 offset:12288
    s_waitcnt lgkmcnt(6)
    v_mfma_f32_16x16x32_bf16 v[60:63], v[104:107], v[108:111], 0
    ds_read_b64_tr_b16 v[96:97], v2 offset:8224
    v_mfma_f32_16x16x32_bf16 v[64:67], v[104:107], v[124:127], 0
    ds_read_b64_tr_b16 v[98:99], v2 offset:12320
    s_waitcnt lgkmcnt(6)
    v_mfma_f32_16x16x32_bf16 v[68:71], v[84:87], v[108:111], 0
    ds_read_b64_tr_b16 v[100:101], v3 offset:8448
    v_mfma_f32_16x16x32_bf16 v[72:75], v[84:87], v[124:127], 0
    ds_read_b64_tr_b16 v[102:103], v3 offset:12544
    s_waitcnt lgkmcnt(6)
    v_mfma_f32_16x16x32_bf16 v[76:79], v[88:91], v[108:111], 0
    ds_read_b64_tr_b16 v[104:105], v2 offset:8480
    v_mfma_f32_16x16x32_bf16 v[80:83], v[88:91], v[124:127], 0
    ds_read_b64_tr_b16 v[106:107], v2 offset:12576
    s_waitcnt lgkmcnt(6)
    v_mfma_f32_16x16x32_bf16 v[20:23], v[92:95], v[112:115], v[20:23]
    ds_read_b64_tr_b16 v[84:85], v3 offset:8704
    v_mfma_f32_16x16x32_bf16 v[24:27], v[92:95], v[128:131], v[24:27]
    ds_read_b64_tr_b16 v[86:87], v3 offset:12800
    s_waitcnt lgkmcnt(6)
    v_mfma_f32_16x16x32_bf16 v[28:31], v[96:99], v[112:115], v[28:31]
    ds_read_b64_tr_b16 v[88:89], v2 offset:8736
    v_mfma_f32_16x16x32_bf16 v[32:35], v[96:99], v[128:131], v[32:35]
    ds_read_b64_tr_b16 v[90:91], v2 offset:12832
    s_waitcnt lgkmcnt(6)
    v_mfma_f32_16x16x32_bf16 v[36:39], v[100:103], v[112:115], v[36:39]
    ds_read_b64_tr_b16 v[92:93], v3 offset:8960
    v_mfma_f32_16x16x32_bf16 v[40:43], v[100:103], v[128:131], v[40:43]
    ds_read_b64_tr_b16 v[94:95], v3 offset:13056
    s_waitcnt lgkmcnt(6)
    v_mfma_f32_16x16x32_bf16 v[44:47], v[104:107], v[112:115], v[44:47]
    ds_read_b64_tr_b16 v[96:97], v2 offset:8992
    v_mfma_f32_16x16x32_bf16 v[48:51], v[104:107], v[128:131], v[48:51]
    ds_read_b64_tr_b16 v[98:99], v2 offset:13088
    s_waitcnt lgkmcnt(6)
    v_mfma_f32_16x16x32_bf16 v[52:55], v[84:87], v[112:115], v[52:55]
    v_mfma_f32_16x16x32_bf16 v[56:59], v[84:87], v[128:131], v[56:59]
    s_barrier
    ds_read_b64_tr_b16 v[100:101], v3 offset:16384
    ds_read_b64_tr_b16 v[102:103], v3 offset:20480
    s_waitcnt lgkmcnt(6)
    v_mfma_f32_16x16x32_bf16 v[60:63], v[88:91], v[112:115], v[60:63]
    ds_read_b64_tr_b16 v[104:105], v2 offset:16416
    v_mfma_f32_16x16x32_bf16 v[64:67], v[88:91], v[128:131], v[64:67]
    ds_read_b64_tr_b16 v[106:107], v2 offset:20512
    s_waitcnt lgkmcnt(6)
    v_mfma_f32_16x16x32_bf16 v[68:71], v[92:95], v[112:115], v[68:71]
    ds_read_b64_tr_b16 v[84:85], v3 offset:16640
    v_mfma_f32_16x16x32_bf16 v[72:75], v[92:95], v[128:131], v[72:75]
    ds_read_b64_tr_b16 v[86:87], v3 offset:20736
    s_waitcnt lgkmcnt(6)
    v_mfma_f32_16x16x32_bf16 v[76:79], v[96:99], v[112:115], v[76:79]
    ds_read_b64_tr_b16 v[88:89], v2 offset:16672
    v_mfma_f32_16x16x32_bf16 v[80:83], v[96:99], v[128:131], v[80:83]
    ds_read_b64_tr_b16 v[90:91], v2 offset:20768
    s_waitcnt lgkmcnt(6)
    v_mfma_f32_16x16x32_bf16 v[20:23], v[100:103], v[116:119], v[20:23]
    ds_read_b64_tr_b16 v[92:93], v3 offset:16896
    v_mfma_f32_16x16x32_bf16 v[24:27], v[100:103], v[132:135], v[24:27]
    ds_read_b64_tr_b16 v[94:95], v3 offset:20992
    s_waitcnt lgkmcnt(6)
    v_mfma_f32_16x16x32_bf16 v[28:31], v[104:107], v[116:119], v[28:31]
    ds_read_b64_tr_b16 v[96:97], v2 offset:16928
    v_mfma_f32_16x16x32_bf16 v[32:35], v[104:107], v[132:135], v[32:35]
    ds_read_b64_tr_b16 v[98:99], v2 offset:21024
    s_waitcnt lgkmcnt(6)
    v_mfma_f32_16x16x32_bf16 v[36:39], v[84:87], v[116:119], v[36:39]
    ds_read_b64_tr_b16 v[100:101], v3 offset:17152
    v_mfma_f32_16x16x32_bf16 v[40:43], v[84:87], v[132:135], v[40:43]
    ds_read_b64_tr_b16 v[102:103], v3 offset:21248
    s_waitcnt lgkmcnt(6)
    v_mfma_f32_16x16x32_bf16 v[44:47], v[88:91], v[116:119], v[44:47]
    ds_read_b64_tr_b16 v[104:105], v2 offset:17184
    v_mfma_f32_16x16x32_bf16 v[48:51], v[88:91], v[132:135], v[48:51]
    ds_read_b64_tr_b16 v[106:107], v2 offset:21280
    s_waitcnt lgkmcnt(6)
    v_mfma_f32_16x16x32_bf16 v[52:55], v[92:95], v[116:119], v[52:55]
    ds_read_b64_tr_b16 v[84:85], v3 offset:24576
    v_mfma_f32_16x16x32_bf16 v[56:59], v[92:95], v[132:135], v[56:59]
    ds_read_b64_tr_b16 v[86:87], v3 offset:28672
    s_waitcnt lgkmcnt(6)
    v_mfma_f32_16x16x32_bf16 v[60:63], v[96:99], v[116:119], v[60:63]
    ds_read_b64_tr_b16 v[88:89], v2 offset:24608
    v_mfma_f32_16x16x32_bf16 v[64:67], v[96:99], v[132:135], v[64:67]
    ds_read_b64_tr_b16 v[90:91], v2 offset:28704
    s_waitcnt lgkmcnt(6)
    v_mfma_f32_16x16x32_bf16 v[68:71], v[100:103], v[116:119], v[68:71]
    ds_read_b64_tr_b16 v[92:93], v3 offset:24832
    v_mfma_f32_16x16x32_bf16 v[72:75], v[100:103], v[132:135], v[72:75]
    ds_read_b64_tr_b16 v[94:95], v3 offset:28928
    s_waitcnt lgkmcnt(6)
    v_mfma_f32_16x16x32_bf16 v[76:79], v[104:107], v[116:119], v[76:79]
    ds_read_b64_tr_b16 v[96:97], v2 offset:24864
    v_mfma_f32_16x16x32_bf16 v[80:83], v[104:107], v[132:135], v[80:83]
    ds_read_b64_tr_b16 v[98:99], v2 offset:28960
    s_waitcnt lgkmcnt(6)
    v_mfma_f32_16x16x32_bf16 v[20:23], v[84:87], v[120:123], v[20:23]
    ds_read_b64_tr_b16 v[100:101], v3 offset:25088
    v_mfma_f32_16x16x32_bf16 v[24:27], v[84:87], v[136:139], v[24:27]
    ds_read_b64_tr_b16 v[102:103], v3 offset:29184
    s_waitcnt lgkmcnt(6)
    v_mfma_f32_16x16x32_bf16 v[28:31], v[88:91], v[120:123], v[28:31]
    ds_read_b64_tr_b16 v[104:105], v2 offset:25120
    v_mfma_f32_16x16x32_bf16 v[32:35], v[88:91], v[136:139], v[32:35]
    ds_read_b64_tr_b16 v[106:107], v2 offset:29216
    s_waitcnt lgkmcnt(6)
    v_mfma_f32_16x16x32_bf16 v[36:39], v[92:95], v[120:123], v[36:39]
    ds_read_b64_tr_b16 v[84:85], v3 offset:25344
    v_mfma_f32_16x16x32_bf16 v[40:43], v[92:95], v[136:139], v[40:43]
    ds_read_b64_tr_b16 v[86:87], v3 offset:29440
    s_waitcnt lgkmcnt(6)
    v_mfma_f32_16x16x32_bf16 v[44:47], v[96:99], v[120:123], v[44:47]
    ds_read_b64_tr_b16 v[88:89], v2 offset:25376
    v_mfma_f32_16x16x32_bf16 v[48:51], v[96:99], v[136:139], v[48:51]
    ds_read_b64_tr_b16 v[90:91], v2 offset:29472
    s_waitcnt lgkmcnt(6)
    v_mfma_f32_16x16x32_bf16 v[52:55], v[100:103], v[120:123], v[52:55]
    v_mfma_f32_16x16x32_bf16 v[56:59], v[100:103], v[136:139], v[56:59]
    s_barrier
    ds_read_b64_tr_b16 v[92:93], v3 offset:32768
    ds_read_b64_tr_b16 v[94:95], v3 offset:36864
    s_waitcnt lgkmcnt(6)
    v_mfma_f32_16x16x32_bf16 v[60:63], v[104:107], v[120:123], v[60:63]
    ds_read_b64_tr_b16 v[96:97], v2 offset:32800
    v_mfma_f32_16x16x32_bf16 v[64:67], v[104:107], v[136:139], v[64:67]
    ds_read_b64_tr_b16 v[98:99], v2 offset:36896
    s_waitcnt lgkmcnt(6)
    v_mfma_f32_16x16x32_bf16 v[68:71], v[84:87], v[120:123], v[68:71]
    ds_read_b64_tr_b16 v[100:101], v3 offset:33024
    v_mfma_f32_16x16x32_bf16 v[72:75], v[84:87], v[136:139], v[72:75]
    ds_read_b64_tr_b16 v[102:103], v3 offset:37120
    s_waitcnt lgkmcnt(6)
    v_mfma_f32_16x16x32_bf16 v[76:79], v[88:91], v[120:123], v[76:79]
    ds_read_b64_tr_b16 v[104:105], v2 offset:33056
    v_mfma_f32_16x16x32_bf16 v[80:83], v[88:91], v[136:139], v[80:83]
    ds_read_b64_tr_b16 v[106:107], v2 offset:37152
    v_and_b32 v9, 7, v0
    v_lshlrev_b32 v9, 2, v9
    s_mov_b32 s27, 0
fz_oBp:
    buffer_load_dword v10, v9, s[8:11], s20 offen sc1
    s_waitcnt vmcnt(0)
    v_cmp_ne_u32 vcc, s14, v10
    s_and_b32 vcc_lo, vcc_lo, 0xdd
    s_mov_b32 vcc_hi, 0
    s_add_u32 s27, s27, 1
    s_cmp_ge_u32 s27, 65536
    s_cbranch_scc1 fz_oBg
    s_cbranch_vccz fz_oBg
    s_sleep 1
    s_branch fz_oBp
fz_oBg:
    s_bfe_u32 s21, s42, 0x30004
    s_or_b32 s21, s21, s62
    s_lshl_b32 s21, s21, 12
    s_add_u32 s23, s21, 0x1000000
    buffer_load_dwordx4 v[140:143], v4, s[8:11], s23 offen offset:0 sc1
    s_add_u32 s23, s21, 0x1020000
    buffer_load_dwordx4 v[144:147], v4, s[8:11], s23 offen offset:0 sc1
    s_add_u32 s23, s21, 0x1000000
    buffer_load_dwordx4 v[148:151], v4, s[8:11], s23 offen offset:1024 sc1
    s_add_u32 s23, s21, 0x1020000
    buffer_load_dwordx4 v[152:155], v4, s[8:11], s23 offen offset:1024 sc1
    s_add_u32 s23, s21, 0x1000800
    buffer_load_dwordx4 v[156:159], v4, s[8:11], s23 offen offset:0 sc1
    s_add_u32 s23, s21, 0x1020800
    buffer_load_dwordx4 v[160:163], v4, s[8:11], s23 offen offset:0 sc1
    s_add_u32 s23, s21, 0x1000800
    buffer_load_dwordx4 v[164:167], v4, s[8:11], s23 offen offset:1024 sc1
    s_add_u32 s23, s21, 0x1020800
    buffer_load_dwordx4 v[168:171], v4, s[8:11], s23 offen offset:1024 sc1
    s_bfe_u32 s21, s42, 0x30008
    s_or_b32 s21, s21, s62
    s_lshl_b32 s21, s21, 12
    s_add_u32 s23, s21, 0x1000000
    buffer_load_dwordx4 v[188:191], v4, s[8:11], s23 offen offset:0 sc1
    s_add_u32 s23, s21, 0x1020000
    buffer_load_dwordx4 v[192:195], v4, s[8:11], s23 offen offset:0 sc1
    s_add_u32 s23, s21, 0x1000000
    buffer_load_dwordx4 v[196:199], v4, s[8:11], s23 offen offset:1024 sc1
    s_add_u32 s23, s21, 0x1020000
    buffer_load_dwordx4 v[200:203], v4, s[8:11], s23 offen offset:1024 sc1
    s_waitcnt vmcnt(11) lgkmcnt(6)
    v_mfma_f32_16x16x32_bf16 v[20:23], v[92:95], v[140:143], v[20:23]
    ds_read_b64_tr_b16 v[84:85], v3 offset:33280
    s_waitcnt vmcnt(10)
    v_mfma_f32_16x16x32_bf16 v[24:27], v[92:95], v[144:147], v[24:27]
    ds_read_b64_tr_b16 v[86:87], v3 offset:37376
    s_waitcnt lgkmcnt(6)
    v_mfma_f32_16x16x32_bf16 v[28:31], v[96:99], v[140:143], v[28:31]
    ds_read_b64_tr_b16 v[88:89], v2 offset:33312
    v_mfma_f32_16x16x32_bf16 v[32:35], v[96:99], v[144:147], v[32:35]
    ds_read_b64_tr_b16 v[90:91], v2 offset:37408
    s_add_u32 s23, s21, 0x1000800
    buffer_load_dwordx4 v[108:111], v4, s[8:11], s23 offen offset:0 sc1
    s_waitcnt lgkmcnt(6)
    v_mfma_f32_16x16x32_bf16 v[36:39], v[100:103], v[140:143], v[36:39]
    ds_read_b64_tr_b16 v[92:93], v3 offset:33536
    v_mfma_f32_16x16x32_bf16 v[40:43], v[100:103], v[144:147], v[40:43]
    ds_read_b64_tr_b16 v[94:95], v3 offset:37632
    s_waitcnt lgkmcnt(6)
    v_mfma_f32_16x16x32_bf16 v[44:47], v[104:107], v[140:143], v[44:47]
    ds_read_b64_tr_b16 v[96:97], v2 offset:33568
    v_mfma_f32_16x16x32_bf16 v[48:51], v[104:107], v[144:147], v[48:51]
    ds_read_b64_tr_b16 v[98:99], v2 offset:37664
    s_waitcnt lgkmcnt(6)
    v_mfma_f32_16x16x32_bf16 v[52:55], v[84:87], v[140:143], v[52:55]
    ds_read_b64_tr_b16 v[100:101], v3 offset:40960
    v_mfma_f32_16x16x32_bf16 v[56:59], v[84:87], v[144:147], v[56:59]
    ds_read_b64_tr_b16 v[102:103], v3 offset:45056
    s_waitcnt lgkmcnt(6)
    v_mfma_f32_16x16x32_bf16 v[60:63], v[88:91], v[140:143], v[60:63]
    ds_read_b64_tr_b16 v[104:105], v2 offset:40992
    v_mfma_f32_16x16x32_bf16 v[64:67], v[88:91], v[144:147], v[64:67]
    ds_read_b64_tr_b16 v[106:107], v2 offset:45088
    s_add_u32 s23, s21, 0x1020800
    buffer_load_dwordx4 v[112:115], v4, s[8:11], s23 offen offset:0 sc1
    s_waitcnt lgkmcnt(6)
    v_mfma_f32_16x16x32_bf16 v[68:71], v[92:95], v[140:143], v[68:71]
    ds_read_b64_tr_b16 v[84:85], v3 offset:41216
    v_mfma_f32_16x16x32_bf16 v[72:75], v[92:95], v[144:147], v[72:75]
    ds_read_b64_tr_b16 v[86:87], v3 offset:45312
    s_waitcnt lgkmcnt(6)
    v_mfma_f32_16x16x32_bf16 v[76:79], v[96:99], v[140:143], v[76:79]
    ds_read_b64_tr_b16 v[88:89], v2 offset:41248
    v_mfma_f32_16x16x32_bf16 v[80:83], v[96:99], v[144:147], v[80:83]
    ds_read_b64_tr_b16 v[90:91], v2 offset:45344
    s_waitcnt vmcnt(11) lgkmcnt(6)
    v_mfma_f32_16x16x32_bf16 v[20:23], v[100:103], v[148:151], v[20:23]
    ds_read_b64_tr_b16 v[92:93], v3 offset:41472
    s_waitcnt vmcnt(10)
    v_mfma_f32_16x16x32_bf16 v[24:27], v[100:103], v[152:155], v[24:27]
    ds_read_b64_tr_b16 v[94:95], v3 offset:45568
    s_waitcnt lgkmcnt(6)
    v_mfma_f32_16x16x32_bf16 v[28:31], v[104:107], v[148:151], v[28:31]
    ds_read_b64_tr_b16 v[96:97], v2 offset:41504
    v_mfma_f32_16x16x32_bf16 v[32:35], v[104:107], v[152:155], v[32:35]
    ds_read_b64_tr_b16 v[98:99], v2 offset:45600
    s_add_u32 s23, s21, 0x1000800
    buffer_load_dwordx4 v[116:119], v4, s[8:11], s23 offen offset:1024 sc1
    s_waitcnt lgkmcnt(6)
    v_mfma_f32_16x16x32_bf16 v[36:39], v[84:87], v[148:151], v[36:39]
    ds_read_b64_tr_b16 v[100:101], v3 offset:41728
    v_mfma_f32_16x16x32_bf16 v[40:43], v[84:87], v[152:155], v[40:43]
    ds_read_b64_tr_b16 v[102:103], v3 offset:45824
    s_waitcnt lgkmcnt(6)
    v_mfma_f32_16x16x32_bf16 v[44:47], v[88:91], v[148:151], v[44:47]
    ds_read_b64_tr_b16 v[104:105], v2 offset:41760
    v_mfma_f32_16x16x32_bf16 v[48:51], v[88:91], v[152:155], v[48:51]
    ds_read_b64_tr_b16 v[106:107], v2 offset:45856
    s_waitcnt lgkmcnt(6)
    v_mfma_f32_16x16x32_bf16 v[52:55], v[92:95], v[148:151], v[52:55]
    v_mfma_f32_16x16x32_bf16 v[56:59], v[92:95], v[152:155], v[56:59]
    s_barrier
    ds_read_b64_tr_b16 v[84:85], v3 offset:49152
    ds_read_b64_tr_b16 v[86:87], v3 offset:53248
    s_waitcnt lgkmcnt(6)
    v_mfma_f32_16x16x32_bf16 v[60:63], v[96:99], v[148:151], v[60:63]
    ds_read_b64_tr_b16 v[88:89], v2 offset:49184
    v_mfma_f32_16x16x32_bf16 v[64:67], v[96:99], v[152:155], v[64:67]
    ds_read_b64_tr_b16 v[90:91], v2 offset:53280
    s_add_u32 s23, s21, 0x1020800
    buffer_load_dwordx4 v[120:123], v4, s[8:11], s23 offen offset:1024 sc1
    s_waitcnt lgkmcnt(6)
    v_mfma_f32_16x16x32_bf16 v[68:71], v[100:103], v[148:151], v[68:71]
    ds_read_b64_tr_b16 v[92:93], v3 offset:49408
    v_mfma_f32_16x16x32_bf16 v[72:75], v[100:103], v[152:155], v[72:75]
    ds_read_b64_tr_b16 v[94:95], v3 offset:53504
    s_waitcnt lgkmcnt(6)
    v_mfma_f32_16x16x32_bf16 v[76:79], v[104:107], v[148:151], v[76:79]
    ds_read_b64_tr_b16 v[96:97], v2 offset:49440
    v_mfma_f32_16x16x32_bf16 v[80:83], v[104:107], v[152:155], v[80:83]
    ds_read_b64_tr_b16 v[98:99], v2 offset:53536
    s_waitcnt vmcnt(11) lgkmcnt(6)
    v_mfma_f32_16x16x32_bf16 v[20:23], v[84:87], v[156:159], v[20:23]
    ds_read_b64_tr_b16 v[100:101], v3 offset:49664
    s_waitcnt vmcnt(10)
    v_mfma_f32_16x16x32_bf16 v[24:27], v[84:87], v[160:163], v[24:27]
    ds_read_b64_tr_b16 v[102:103], v3 offset:53760
    s_waitcnt lgkmcnt(6)
    v_mfma_f32_16x16x32_bf16 v[28:31], v[88:91], v[156:159], v[28:31]
    ds_read_b64_tr_b16 v[104:105], v2 offset:49696
    v_mfma_f32_16x16x32_bf16 v[32:35], v[88:91], v[160:163], v[32:35]
    ds_read_b64_tr_b16 v[106:107], v2 offset:53792
    s_bfe_u32 s21, s42, 0x3000c
    s_or_b32 s21, s21, s62
    s_lshl_b32 s21, s21, 12
    s_add_u32 s23, s21, 0x1000000
    buffer_load_dwordx4 v[140:143], v4, s[8:11], s23 offen offset:0 sc1
    s_waitcnt lgkmcnt(6)
    v_mfma_f32_16x16x32_bf16 v[36:39], v[92:95], v[156:159], v[36:39]
    ds_read_b64_tr_b16 v[84:85], v3 offset:49920
    v_mfma_f32_16x16x32_bf16 v[40:43], v[92:95], v[160:163], v[40:43]
    ds_read_b64_tr_b16 v[86:87], v3 offset:54016
    s_waitcnt lgkmcnt(6)
    v_mfma_f32_16x16x32_bf16 v[44:47], v[96:99], v[156:159], v[44:47]
    ds_read_b64_tr_b16 v[88:89], v2 offset:49952
    v_mfma_f32_16x16x32_bf16 v[48:51], v[96:99], v[160:163], v[48:51]
    ds_read_b64_tr_b16 v[90:91], v2 offset:54048
    s_waitcnt lgkmcnt(6)
    v_mfma_f32_16x16x32_bf16 v[52:55], v[100:103], v[156:159], v[52:55]
    ds_read_b64_tr_b16 v[92:93], v3 offset:57344
    v_mfma_f32_16x16x32_bf16 v[56:59], v[100:103], v[160:163], v[56:59]
    ds_read_b64_tr_b16 v[94:95], v3 offset:61440
    s_waitcnt lgkmcnt(6)
    v_mfma_f32_16x16x32_bf16 v[60:63], v[104:107], v[156:159], v[60:63]
    ds_read_b64_tr_b16 v[96:97], v2 offset:57376
    v_mfma_f32_16x16x32_bf16 v[64:67], v[104:107], v[160:163], v[64:67]
    ds_read_b64_tr_b16 v[98:99], v2 offset:61472
    s_add_u32 s23, s21, 0x1020000
    buffer_load_dwordx4 v[144:147], v4, s[8:11], s23 offen offset:0 sc1
    s_waitcnt lgkmcnt(6)
    v_mfma_f32_16x16x32_bf16 v[68:71], v[84:87], v[156:159], v[68:71]
    ds_read_b64_tr_b16 v[100:101], v3 offset:57600
    v_mfma_f32_16x16x32_bf16 v[72:75], v[84:87], v[160:163], v[72:75]
    ds_read_b64_tr_b16 v[102:103], v3 offset:61696
    s_waitcnt lgkmcnt(6)
    v_mfma_f32_16x16x32_bf16 v[76:79], v[88:91], v[156:159], v[76:79]
    ds_read_b64_tr_b16 v[104:105], v2 offset:57632
    v_mfma_f32_16x16x32_bf16 v[80:83], v[88:91], v[160:163], v[80:83]
    ds_read_b64_tr_b16 v[106:107], v2 offset:61728
    s_waitcnt vmcnt(11) lgkmcnt(6)
    v_mfma_f32_16x16x32_bf16 v[20:23], v[92:95], v[164:167], v[20:23]
    ds_read_b64_tr_b16 v[84:85], v3 offset:57856
    s_waitcnt vmcnt(10)
    v_mfma_f32_16x16x32_bf16 v[24:27], v[92:95], v[168:171], v[24:27]
    ds_read_b64_tr_b16 v[86:87], v3 offset:61952
    s_waitcnt lgkmcnt(6)
    v_mfma_f32_16x16x32_bf16 v[28:31], v[96:99], v[164:167], v[28:31]
    ds_read_b64_tr_b16 v[88:89], v2 offset:57888
    v_mfma_f32_16x16x32_bf16 v[32:35], v[96:99], v[168:171], v[32:35]
    ds_read_b64_tr_b16 v[90:91], v2 offset:61984
    s_add_u32 s23, s21, 0x1000000
    buffer_load_dwordx4 v[148:151], v4, s[8:11], s23 offen offset:1024 sc1
    s_waitcnt lgkmcnt(6)
    v_mfma_f32_16x16x32_bf16 v[36:39], v[100:103], v[164:167], v[36:39]
    ds_read_b64_tr_b16 v[92:93], v3 offset:58112
    v_mfma_f32_16x16x32_bf16 v[40:43], v[100:103], v[168:171], v[40:43]
    ds_read_b64_tr_b16 v[94:95], v3 offset:62208
    s_waitcnt lgkmcnt(6)
    v_mfma_f32_16x16x32_bf16 v[44:47], v[104:107], v[164:167], v[44:47]
    ds_read_b64_tr_b16 v[96:97], v2 offset:58144
    v_mfma_f32_16x16x32_bf16 v[48:51], v[104:107], v[168:171], v[48:51]
    ds_read_b64_tr_b16 v[98:99], v2 offset:62240
    s_waitcnt lgkmcnt(6)
    v_mfma_f32_16x16x32_bf16 v[52:55], v[84:87], v[164:167], v[52:55]
    v_mfma_f32_16x16x32_bf16 v[56:59], v[84:87], v[168:171], v[56:59]
    s_barrier
    ds_read_b64_tr_b16 v[100:101], v15 offset:0
    ds_read_b64_tr_b16 v[102:103], v15 offset:4096
    s_waitcnt lgkmcnt(6)
    v_mfma_f32_16x16x32_bf16 v[60:63], v[88:91], v[164:167], v[60:63]
    ds_read_b64_tr_b16 v[104:105], v16 offset:32
    v_mfma_f32_16x16x32_bf16 v[64:67], v[88:91], v[168:171], v[64:67]
    ds_read_b64_tr_b16 v[106:107], v16 offset:4128
    s_add_u32 s23, s21, 0x1020000
    buffer_load_dwordx4 v[152:155], v4, s[8:11], s23 offen offset:1024 sc1
    s_waitcnt lgkmcnt(6)
    v_mfma_f32_16x16x32_bf16 v[68:71], v[92:95], v[164:167], v[68:71]
    ds_read_b64_tr_b16 v[84:85], v15 offset:256
    v_mfma_f32_16x16x32_bf16 v[72:75], v[92:95], v[168:171], v[72:75]
    ds_read_b64_tr_b16 v[86:87], v15 offset:4352
    s_waitcnt lgkmcnt(6)
    v_mfma_f32_16x16x32_bf16 v[76:79], v[96:99], v[164:167], v[76:79]
    ds_read_b64_tr_b16 v[88:89], v16 offset:288
    v_mfma_f32_16x16x32_bf16 v[80:83], v[96:99], v[168:171], v[80:83]
    ds_read_b64_tr_b16 v[90:91], v16 offset:4384
    s_waitcnt vmcnt(11) lgkmcnt(6)
    v_mfma_f32_16x16x32_bf16 v[20:23], v[100:103], v[188:191], v[20:23]
    ds_read_b64_tr_b16 v[92:93], v15 offset:512
    s_waitcnt vmcnt(10)
    v_mfma_f32_16x16x32_bf16 v[24:27], v[100:103], v[192:195], v[24:27]
    ds_read_b64_tr_b16 v[94:95], v15 offset:4608
    s_waitcnt lgkmcnt(6)
    v_mfma_f32_16x16x32_bf16 v[28:31], v[104:107], v[188:191], v[28:31]
    ds_read_b64_tr_b16 v[96:97], v16 offset:544
    v_mfma_f32_16x16x32_bf16 v[32:35], v[104:107], v[192:195], v[32:35]
    ds_read_b64_tr_b16 v[98:99], v16 offset:4640
    s_add_u32 s23, s21, 0x1000800
    buffer_load_dwordx4 v[156:159], v4, s[8:11], s23 offen offset:0 sc1
    s_waitcnt lgkmcnt(6)
    v_mfma_f32_16x16x32_bf16 v[36:39], v[84:87], v[188:191], v[36:39]
    ds_read_b64_tr_b16 v[100:101], v15 offset:768
    v_mfma_f32_16x16x32_bf16 v[40:43], v[84:87], v[192:195], v[40:43]
    ds_read_b64_tr_b16 v[102:103], v15 offset:4864
    s_waitcnt lgkmcnt(6)
    v_mfma_f32_16x16x32_bf16 v[44:47], v[88:91], v[188:191], v[44:47]
    ds_read_b64_tr_b16 v[104:105], v16 offset:800
    v_mfma_f32_16x16x32_bf16 v[48:51], v[88:91], v[192:195], v[48:51]
    ds_read_b64_tr_b16 v[106:107], v16 offset:4896
    s_waitcnt lgkmcnt(6)
    v_mfma_f32_16x16x32_bf16 v[52:55], v[92:95], v[188:191], v[52:55]
    ds_read_b64_tr_b16 v[84:85], v15 offset:8192
    v_mfma_f32_16x16x32_bf16 v[56:59], v[92:95], v[192:195], v[56:59]
    ds_read_b64_tr_b16 v[86:87], v15 offset:12288
    s_waitcnt lgkmcnt(6)
    v_mfma_f32_16x16x32_bf16 v[60:63], v[96:99], v[188:191], v[60:63]
    ds_read_b64_tr_b16 v[88:89], v16 offset:8224
    v_mfma_f32_16x16x32_bf16 v[64:67], v[96:99], v[192:195], v[64:67]
    ds_read_b64_tr_b16 v[90:91], v16 offset:12320
    s_add_u32 s23, s21, 0x1020800
    buffer_load_dwordx4 v[160:163], v4, s[8:11], s23 offen offset:0 sc1
    s_waitcnt lgkmcnt(6)
    v_mfma_f32_16x16x32_bf16 v[68:71], v[100:103], v[188:191], v[68:71]
    ds_read_b64_tr_b16 v[92:93], v15 offset:8448
    v_mfma_f32_16x16x32_bf16 v[72:75], v[100:103], v[192:195], v[72:75]
    ds_read_b64_tr_b16 v[94:95], v15 offset:12544
    s_waitcnt lgkmcnt(6)
    v_mfma_f32_16x16x32_bf16 v[76:79], v[104:107], v[188:191], v[76:79]
    ds_read_b64_tr_b16 v[96:97], v16 offset:8480
    v_mfma_f32_16x16x32_bf16 v[80:83], v[104:107], v[192:195], v[80:83]
    ds_read_b64_tr_b16 v[98:99], v16 offset:12576
    s_waitcnt vmcnt(11) lgkmcnt(6)
    v_mfma_f32_16x16x32_bf16 v[20:23], v[84:87], v[196:199], v[20:23]
    ds_read_b64_tr_b16 v[100:101], v15 offset:8704
    s_waitcnt vmcnt(10)
    v_mfma_f32_16x16x32_bf16 v[24:27], v[84:87], v[200:203], v[24:27]
    ds_read_b64_tr_b16 v[102:103], v15 offset:12800
    s_waitcnt lgkmcnt(6)
    v_mfma_f32_16x16x32_bf16 v[28:31], v[88:91], v[196:199], v[28:31]
    ds_read_b64_tr_b16 v[104:105], v16 offset:8736
    v_mfma_f32_16x16x32_bf16 v[32:35], v[88:91], v[200:203], v[32:35]
    ds_read_b64_tr_b16 v[106:107], v16 offset:12832
    s_add_u32 s23, s21, 0x1000800
    buffer_load_dwordx4 v[164:167], v4, s[8:11], s23 offen offset:1024 sc1
    s_waitcnt lgkmcnt(6)
    v_mfma_f32_16x16x32_bf16 v[36:39], v[92:95], v[196:199], v[36:39]
    ds_read_b64_tr_b16 v[84:85], v15 offset:8960
    v_mfma_f32_16x16x32_bf16 v[40:43], v[92:95], v[200:203], v[40:43]
    ds_read_b64_tr_b16 v[86:87], v15 offset:13056
    s_waitcnt lgkmcnt(6)
    v_mfma_f32_16x16x32_bf16 v[44:47], v[96:99], v[196:199], v[44:47]
    ds_read_b64_tr_b16 v[88:89], v16 offset:8992
    v_mfma_f32_16x16x32_bf16 v[48:51], v[96:99], v[200:203], v[48:51]
    ds_read_b64_tr_b16 v[90:91], v16 offset:13088
    s_waitcnt lgkmcnt(6)
    v_mfma_f32_16x16x32_bf16 v[52:55], v[100:103], v[196:199], v[52:55]
    v_mfma_f32_16x16x32_bf16 v[56:59], v[100:103], v[200:203], v[56:59]
    s_barrier
    ds_read_b64_tr_b16 v[92:93], v15 offset:16384
    ds_read_b64_tr_b16 v[94:95], v15 offset:20480
    s_waitcnt lgkmcnt(6)
    v_mfma_f32_16x16x32_bf16 v[60:63], v[104:107], v[196:199], v[60:63]
    ds_read_b64_tr_b16 v[96:97], v16 offset:16416
    v_mfma_f32_16x16x32_bf16 v[64:67], v[104:107], v[200:203], v[64:67]
    ds_read_b64_tr_b16 v[98:99], v16 offset:20512
    s_add_u32 s23, s21, 0x1020800
    buffer_load_dwordx4 v[168:171], v4, s[8:11], s23 offen offset:1024 sc1
    s_waitcnt lgkmcnt(6)
    v_mfma_f32_16x16x32_bf16 v[68:71], v[84:87], v[196:199], v[68:71]
    ds_read_b64_tr_b16 v[100:101], v15 offset:16640
    v_mfma_f32_16x16x32_bf16 v[72:75], v[84:87], v[200:203], v[72:75]
    ds_read_b64_tr_b16 v[102:103], v15 offset:20736
    s_waitcnt lgkmcnt(6)
    v_mfma_f32_16x16x32_bf16 v[76:79], v[88:91], v[196:199], v[76:79]
    ds_read_b64_tr_b16 v[104:105], v16 offset:16672
    v_mfma_f32_16x16x32_bf16 v[80:83], v[88:91], v[200:203], v[80:83]
    ds_read_b64_tr_b16 v[106:107], v16 offset:20768
    s_waitcnt vmcnt(11) lgkmcnt(6)
    v_mfma_f32_16x16x32_bf16 v[20:23], v[92:95], v[108:111], v[20:23]
    ds_read_b64_tr_b16 v[84:85], v15 offset:16896
    s_waitcnt vmcnt(10)
    v_mfma_f32_16x16x32_bf16 v[24:27], v[92:95], v[112:115], v[24:27]
    ds_read_b64_tr_b16 v[86:87], v15 offset:20992
    s_waitcnt lgkmcnt(6)
    v_mfma_f32_16x16x32_bf16 v[28:31], v[96:99], v[108:111], v[28:31]
    ds_read_b64_tr_b16 v[88:89], v16 offset:16928
    v_mfma_f32_16x16x32_bf16 v[32:35], v[96:99], v[112:115], v[32:35]
    ds_read_b64_tr_b16 v[90:91], v16 offset:21024
    s_bfe_u32 s21, s42, 0x30010
    s_or_b32 s21, s21, s62
    s_lshl_b32 s21, s21, 12
    s_add_u32 s23, s21, 0x1000000
    buffer_load_dwordx4 v[188:191], v4, s[8:11], s23 offen offset:0 sc1
    s_waitcnt lgkmcnt(6)
    v_mfma_f32_16x16x32_bf16 v[36:39], v[100:103], v[108:111], v[36:39]
    ds_read_b64_tr_b16 v[92:93], v15 offset:17152
    v_mfma_f32_16x16x32_bf16 v[40:43], v[100:103], v[112:115], v[40:43]
    ds_read_b64_tr_b16 v[94:95], v15 offset:21248
    s_waitcnt lgkmcnt(6)
    v_mfma_f32_16x16x32_bf16 v[44:47], v[104:107], v[108:111], v[44:47]
    ds_read_b64_tr_b16 v[96:97], v16 offset:17184
    v_mfma_f32_16x16x32_bf16 v[48:51], v[104:107], v[112:115], v[48:51]
    ds_read_b64_tr_b16 v[98:99], v16 offset:21280
    s_waitcnt lgkmcnt(6)
    v_mfma_f32_16x16x32_bf16 v[52:55], v[84:87], v[108:111], v[52:55]
    ds_read_b64_tr_b16 v[100:101], v15 offset:24576
    v_mfma_f32_16x16x32_bf16 v[56:59], v[84:87], v[112:115], v[56:59]
    ds_read_b64_tr_b16 v[102:103], v15 offset:28672
    s_waitcnt lgkmcnt(6)
    v_mfma_f32_16x16x32_bf16 v[60:63], v[88:91], v[108:111], v[60:63]
    ds_read_b64_tr_b16 v[104:105], v16 offset:24608
    v_mfma_f32_16x16x32_bf16 v[64:67], v[88:91], v[112:115], v[64:67]
    ds_read_b64_tr_b16 v[106:107], v16 offset:28704
    s_add_u32 s23, s21, 0x1020000
    buffer_load_dwordx4 v[192:195], v4, s[8:11], s23 offen offset:0 sc1
    s_waitcnt lgkmcnt(6)
    v_mfma_f32_16x16x32_bf16 v[68:71], v[92:95], v[108:111], v[68:71]
    ds_read_b64_tr_b16 v[84:85], v15 offset:24832
    v_mfma_f32_16x16x32_bf16 v[72:75], v[92:95], v[112:115], v[72:75]
    ds_read_b64_tr_b16 v[86:87], v15 offset:28928
    s_waitcnt lgkmcnt(6)
    v_mfma_f32_16x16x32_bf16 v[76:79], v[96:99], v[108:111], v[76:79]
    ds_read_b64_tr_b16 v[88:89], v16 offset:24864
    v_mfma_f32_16x16x32_bf16 v[80:83], v[96:99], v[112:115], v[80:83]
    ds_read_b64_tr_b16 v[90:91], v16 offset:28960
    s_waitcnt vmcnt(11) lgkmcnt(6)
    v_mfma_f32_16x16x32_bf16 v[20:23], v[100:103], v[116:119], v[20:23]
    ds_read_b64_tr_b16 v[92:93], v15 offset:25088
    s_waitcnt vmcnt(10)
    v_mfma_f32_16x16x32_bf16 v[24:27], v[100:103], v[120:123], v[24:27]
    ds_read_b64_tr_b16 v[94:95], v15 offset:29184
    s_waitcnt lgkmcnt(6)
    v_mfma_f32_16x16x32_bf16 v[28:31], v[104:107], v[116:119], v[28:31]
    ds_read_b64_tr_b16 v[96:97], v16 offset:25120
    v_mfma_f32_16x16x32_bf16 v[32:35], v[104:107], v[120:123], v[32:35]
    ds_read_b64_tr_b16 v[98:99], v16 offset:29216
    s_add_u32 s23, s21, 0x1000000
    buffer_load_dwordx4 v[196:199], v4, s[8:11], s23 offen offset:1024 sc1
    s_waitcnt lgkmcnt(6)
    v_mfma_f32_16x16x32_bf16 v[36:39], v[84:87], v[116:119], v[36:39]
    ds_read_b64_tr_b16 v[100:101], v15 offset:25344
    v_mfma_f32_16x16x32_bf16 v[40:43], v[84:87], v[120:123], v[40:43]
    ds_read_b64_tr_b16 v[102:103], v15 offset:29440
    s_waitcnt lgkmcnt(6)
    v_mfma_f32_16x16x32_bf16 v[44:47], v[88:91], v[116:119], v[44:47]
    ds_read_b64_tr_b16 v[104:105], v16 offset:25376
    v_mfma_f32_16x16x32_bf16 v[48:51], v[88:91], v[120:123], v[48:51]
    ds_read_b64_tr_b16 v[106:107], v16 offset:29472
    s_waitcnt lgkmcnt(6)
    v_mfma_f32_16x16x32_bf16 v[52:55], v[92:95], v[116:119], v[52:55]
    v_mfma_f32_16x16x32_bf16 v[56:59], v[92:95], v[120:123], v[56:59]
    s_barrier
    ds_read_b64_tr_b16 v[84:85], v15 offset:32768
    ds_read_b64_tr_b16 v[86:87], v15 offset:36864
    s_waitcnt lgkmcnt(6)
    v_mfma_f32_16x16x32_bf16 v[60:63], v[96:99], v[116:119], v[60:63]
    ds_read_b64_tr_b16 v[88:89], v16 offset:32800
    v_mfma_f32_16x16x32_bf16 v[64:67], v[96:99], v[120:123], v[64:67]
    ds_read_b64_tr_b16 v[90:91], v16 offset:36896
    s_add_u32 s23, s21, 0x1020000
    buffer_load_dwordx4 v[200:203], v4, s[8:11], s23 offen offset:1024 sc1
    s_waitcnt lgkmcnt(6)
    v_mfma_f32_16x16x32_bf16 v[68:71], v[100:103], v[116:119], v[68:71]
    ds_read_b64_tr_b16 v[92:93], v15 offset:33024
    v_mfma_f32_16x16x32_bf16 v[72:75], v[100:103], v[120:123], v[72:75]
    ds_read_b64_tr_b16 v[94:95], v15 offset:37120
    s_waitcnt lgkmcnt(6)
    v_mfma_f32_16x16x32_bf16 v[76:79], v[104:107], v[116:119], v[76:79]
    ds_read_b64_tr_b16 v[96:97], v16 offset:33056
    v_mfma_f32_16x16x32_bf16 v[80:83], v[104:107], v[120:123], v[80:83]
    ds_read_b64_tr_b16 v[98:99], v16 offset:37152
    s_waitcnt vmcnt(11) lgkmcnt(6)
    v_mfma_f32_16x16x32_bf16 v[20:23], v[84:87], v[140:143], v[20:23]
    ds_read_b64_tr_b16 v[100:101], v15 offset:33280
    s_waitcnt vmcnt(10)
    v_mfma_f32_16x16x32_bf16 v[24:27], v[84:87], v[144:147], v[24:27]
    ds_read_b64_tr_b16 v[102:103], v15 offset:37376
    s_waitcnt lgkmcnt(6)
    v_mfma_f32_16x16x32_bf16 v[28:31], v[88:91], v[140:143], v[28:31]
    ds_read_b64_tr_b16 v[104:105], v16 offset:33312
    v_mfma_f32_16x16x32_bf16 v[32:35], v[88:91], v[144:147], v[32:35]
    ds_read_b64_tr_b16 v[106:107], v16 offset:37408
    s_add_u32 s23, s21, 0x1000800
    buffer_load_dwordx4 v[108:111], v4, s[8:11], s23 offen offset:0 sc1
    s_waitcnt lgkmcnt(6)
    v_mfma_f32_16x16x32_bf16 v[36:39], v[92:95], v[140:143], v[36:39]
    ds_read_b64_tr_b16 v[84:85], v15 offset:33536
    v_mfma_f32_16x16x32_bf16 v[40:43], v[92:95], v[144:147], v[40:43]
    ds_read_b64_tr_b16 v[86:87], v15 offset:37632
    s_waitcnt lgkmcnt(6)
    v_mfma_f32_16x16x32_bf16 v[44:47], v[96:99], v[140:143], v[44:47]
    ds_read_b64_tr_b16 v[88:89], v16 offset:33568
    v_mfma_f32_16x16x32_bf16 v[48:51], v[96:99], v[144:147], v[48:51]
    ds_read_b64_tr_b16 v[90:91], v16 offset:37664
    s_waitcnt lgkmcnt(6)
    v_mfma_f32_16x16x32_bf16 v[52:55], v[100:103], v[140:143], v[52:55]
    ds_read_b64_tr_b16 v[92:93], v15 offset:40960
    v_mfma_f32_16x16x32_bf16 v[56:59], v[100:103], v[144:147], v[56:59]
    ds_read_b64_tr_b16 v[94:95], v15 offset:45056
    s_waitcnt lgkmcnt(6)
    v_mfma_f32_16x16x32_bf16 v[60:63], v[104:107], v[140:143], v[60:63]
    ds_read_b64_tr_b16 v[96:97], v16 offset:40992
    v_mfma_f32_16x16x32_bf16 v[64:67], v[104:107], v[144:147], v[64:67]
    ds_read_b64_tr_b16 v[98:99], v16 offset:45088
    s_add_u32 s23, s21, 0x1020800
    buffer_load_dwordx4 v[112:115], v4, s[8:11], s23 offen offset:0 sc1
    s_waitcnt lgkmcnt(6)
    v_mfma_f32_16x16x32_bf16 v[68:71], v[84:87], v[140:143], v[68:71]
    ds_read_b64_tr_b16 v[100:101], v15 offset:41216
    v_mfma_f32_16x16x32_bf16 v[72:75], v[84:87], v[144:147], v[72:75]
    ds_read_b64_tr_b16 v[102:103], v15 offset:45312
    s_waitcnt lgkmcnt(6)
    v_mfma_f32_16x16x32_bf16 v[76:79], v[88:91], v[140:143], v[76:79]
    ds_read_b64_tr_b16 v[104:105], v16 offset:41248
    v_mfma_f32_16x16x32_bf16 v[80:83], v[88:91], v[144:147], v[80:83]
    ds_read_b64_tr_b16 v[106:107], v16 offset:45344
    s_waitcnt vmcnt(11) lgkmcnt(6)
    v_mfma_f32_16x16x32_bf16 v[20:23], v[92:95], v[148:151], v[20:23]
    ds_read_b64_tr_b16 v[84:85], v15 offset:41472
    s_waitcnt vmcnt(10)
    v_mfma_f32_16x16x32_bf16 v[24:27], v[92:95], v[152:155], v[24:27]
    ds_read_b64_tr_b16 v[86:87], v15 offset:45568
    s_waitcnt lgkmcnt(6)
    v_mfma_f32_16x16x32_bf16 v[28:31], v[96:99], v[148:151], v[28:31]
    ds_read_b64_tr_b16 v[88:89], v16 offset:41504
    v_mfma_f32_16x16x32_bf16 v[32:35], v[96:99], v[152:155], v[32:35]
    ds_read_b64_tr_b16 v[90:91], v16 offset:45600
    s_add_u32 s23, s21, 0x1000800
    buffer_load_dwordx4 v[116:119], v4, s[8:11], s23 offen offset:1024 sc1
    s_waitcnt lgkmcnt(6)
    v_mfma_f32_16x16x32_bf16 v[36:39], v[100:103], v[148:151], v[36:39]
    ds_read_b64_tr_b16 v[92:93], v15 offset:41728
    v_mfma_f32_16x16x32_bf16 v[40:43], v[100:103], v[152:155], v[40:43]
    ds_read_b64_tr_b16 v[94:95], v15 offset:45824
    s_waitcnt lgkmcnt(6)
    v_mfma_f32_16x16x32_bf16 v[44:47], v[104:107], v[148:151], v[44:47]
    ds_read_b64_tr_b16 v[96:97], v16 offset:41760
    v_mfma_f32_16x16x32_bf16 v[48:51], v[104:107], v[152:155], v[48:51]
    ds_read_b64_tr_b16 v[98:99], v16 offset:45856
    s_waitcnt lgkmcnt(6)
    v_mfma_f32_16x16x32_bf16 v[52:55], v[84:87], v[148:151], v[52:55]
    v_mfma_f32_16x16x32_bf16 v[56:59], v[84:87], v[152:155], v[56:59]
    s_barrier
    ds_read_b64_tr_b16 v[100:101], v15 offset:49152
    ds_read_b64_tr_b16 v[102:103], v15 offset:53248
    s_waitcnt lgkmcnt(6)
    v_mfma_f32_16x16x32_bf16 v[60:63], v[88:91], v[148:151], v[60:63]
    ds_read_b64_tr_b16 v[104:105], v16 offset:49184
    v_mfma_f32_16x16x32_bf16 v[64:67], v[88:91], v[152:155], v[64:67]
    ds_read_b64_tr_b16 v[106:107], v16 offset:53280
    s_add_u32 s23, s21, 0x1020800
    buffer_load_dwordx4 v[120:123], v4, s[8:11], s23 offen offset:1024 sc1
    s_waitcnt lgkmcnt(6)
    v_mfma_f32_16x16x32_bf16 v[68:71], v[92:95], v[148:151], v[68:71]
    ds_read_b64_tr_b16 v[84:85], v15 offset:49408
    v_mfma_f32_16x16x32_bf16 v[72:75], v[92:95], v[152:155], v[72:75]
    ds_read_b64_tr_b16 v[86:87], v15 offset:53504
    s_waitcnt lgkmcnt(6)
    v_mfma_f32_16x16x32_bf16 v[76:79], v[96:99], v[148:151], v[76:79]
    ds_read_b64_tr_b16 v[88:89], v16 offset:49440
    v_mfma_f32_16x16x32_bf16 v[80:83], v[96:99], v[152:155], v[80:83]
    ds_read_b64_tr_b16 v[90:91], v16 offset:53536
    s_waitcnt vmcnt(11) lgkmcnt(6)
    v_mfma_f32_16x16x32_bf16 v[20:23], v[100:103], v[156:159], v[20:23]
    ds_read_b64_tr_b16 v[92:93], v15 offset:49664
    s_waitcnt vmcnt(10)
    v_mfma_f32_16x16x32_bf16 v[24:27], v[100:103], v[160:163], v[24:27]
    ds_read_b64_tr_b16 v[94:95], v15 offset:53760
    s_waitcnt lgkmcnt(6)
    v_mfma_f32_16x16x32_bf16 v[28:31], v[104:107], v[156:159], v[28:31]
    ds_read_b64_tr_b16 v[96:97], v16 offset:49696
    v_mfma_f32_16x16x32_bf16 v[32:35], v[104:107], v[160:163], v[32:35]
    ds_read_b64_tr_b16 v[98:99], v16 offset:53792
    s_bfe_u32 s21, s42, 0x30014
    s_or_b32 s21, s21, s62
    s_lshl_b32 s21, s21, 12
    s_add_u32 s23, s21, 0x1000000
    buffer_load_dwordx4 v[140:143], v4, s[8:11], s23 offen offset:0 sc1
    s_waitcnt lgkmcnt(6)
    v_mfma_f32_16x16x32_bf16 v[36:39], v[84:87], v[156:159], v[36:39]
    ds_read_b64_tr_b16 v[100:101], v15 offset:49920
    v_mfma_f32_16x16x32_bf16 v[40:43], v[84:87], v[160:163], v[40:43]
    ds_read_b64_tr_b16 v[102:103], v15 offset:54016
    buffer_load_dword v10, v9, s[8:11], s20 offen sc1
    s_waitcnt lgkmcnt(6)
    v_mfma_f32_16x16x32_bf16 v[44:47], v[88:91], v[156:159], v[44:47]
    ds_read_b64_tr_b16 v[104:105], v16 offset:49952
    v_mfma_f32_16x16x32_bf16 v[48:51], v[88:91], v[160:163], v[48:51]
    ds_read_b64_tr_b16 v[106:107], v16 offset:54048
    s_waitcnt lgkmcnt(6)
    v_mfma_f32_16x16x32_bf16 v[52:55], v[92:95], v[156:159], v[52:55]
    ds_read_b64_tr_b16 v[84:85], v15 offset:57344
    v_mfma_f32_16x16x32_bf16 v[56:59], v[92:95], v[160:163], v[56:59]
    ds_read_b64_tr_b16 v[86:87], v15 offset:61440
    s_waitcnt lgkmcnt(6)
    v_mfma_f32_16x16x32_bf16 v[60:63], v[96:99], v[156:159], v[60:63]
    ds_read_b64_tr_b16 v[88:89], v16 offset:57376
    v_mfma_f32_16x16x32_bf16 v[64:67], v[96:99], v[160:163], v[64:67]
    ds_read_b64_tr_b16 v[90:91], v16 offset:61472
    s_add_u32 s23, s21, 0x1020000
    buffer_load_dwordx4 v[144:147], v4, s[8:11], s23 offen offset:0 sc1
    s_waitcnt lgkmcnt(6)
    v_mfma_f32_16x16x32_bf16 v[68:71], v[100:103], v[156:159], v[68:71]
    ds_read_b64_tr_b16 v[92:93], v15 offset:57600
    v_mfma_f32_16x16x32_bf16 v[72:75], v[100:103], v[160:163], v[72:75]
    ds_read_b64_tr_b16 v[94:95], v15 offset:61696
    s_waitcnt lgkmcnt(6)
    v_mfma_f32_16x16x32_bf16 v[76:79], v[104:107], v[156:159], v[76:79]
    ds_read_b64_tr_b16 v[96:97], v16 offset:57632
    v_mfma_f32_16x16x32_bf16 v[80:83], v[104:107], v[160:163], v[80:83]
    ds_read_b64_tr_b16 v[98:99], v16 offset:61728
    s_waitcnt vmcnt(12) lgkmcnt(6)
    v_mfma_f32_16x16x32_bf16 v[20:23], v[84:87], v[164:167], v[20:23]
    ds_read_b64_tr_b16 v[100:101], v15 offset:57856
    s_waitcnt vmcnt(11)
    v_mfma_f32_16x16x32_bf16 v[24:27], v[84:87], v[168:171], v[24:27]
    ds_read_b64_tr_b16 v[102:103], v15 offset:61952
    s_waitcnt lgkmcnt(6)
    v_mfma_f32_16x16x32_bf16 v[28:31], v[88:91], v[164:167], v[28:31]
    ds_read_b64_tr_b16 v[104:105], v16 offset:57888
    v_mfma_f32_16x16x32_bf16 v[32:35], v[88:91], v[168:171], v[32:35]
    ds_read_b64_tr_b16 v[106:107], v16 offset:61984
    s_add_u32 s23, s21, 0x1000000
    buffer_load_dwordx4 v[148:151], v4, s[8:11], s23 offen offset:1024 sc1
    s_waitcnt lgkmcnt(6)
    v_mfma_f32_16x16x32_bf16 v[36:39], v[92:95], v[164:167], v[36:39]
    ds_read_b64_tr_b16 v[84:85], v15 offset:58112
    v_mfma_f32_16x16x32_bf16 v[40:43], v[92:95], v[168:171], v[40:43]
    ds_read_b64_tr_b16 v[86:87], v15 offset:62208
    s_waitcnt lgkmcnt(6)
    v_mfma_f32_16x16x32_bf16 v[44:47], v[96:99], v[164:167], v[44:47]
    ds_read_b64_tr_b16 v[88:89], v16 offset:58144
    v_mfma_f32_16x16x32_bf16 v[48:51], v[96:99], v[168:171], v[48:51]
    ds_read_b64_tr_b16 v[90:91], v16 offset:62240
    s_waitcnt lgkmcnt(6)
    v_mfma_f32_16x16x32_bf16 v[52:55], v[100:103], v[164:167], v[52:55]
    v_mfma_f32_16x16x32_bf16 v[56:59], v[100:103], v[168:171], v[56:59]
    s_barrier
    ds_read_b64_tr_b16 v[92:93], v3 offset:0
    ds_read_b64_tr_b16 v[94:95], v3 offset:4096
    s_waitcnt lgkmcnt(6)
    v_mfma_f32_16x16x32_bf16 v[60:63], v[104:107], v[164:167], v[60:63]
    ds_read_b64_tr_b16 v[96:97], v2 offset:32
    v_mfma_f32_16x16x32_bf16 v[64:67], v[104:107], v[168:171], v[64:67]
    ds_read_b64_tr_b16 v[98:99], v2 offset:4128
    s_add_u32 s23, s21, 0x1020000
    buffer_load_dwordx4 v[152:155], v4, s[8:11], s23 offen offset:1024 sc1
    s_waitcnt lgkmcnt(6)
    v_mfma_f32_16x16x32_bf16 v[68:71], v[84:87], v[164:167], v[68:71]
    ds_read_b64_tr_b16 v[100:101], v3 offset:256
    v_mfma_f32_16x16x32_bf16 v[72:75], v[84:87], v[168:171], v[72:75]
    ds_read_b64_tr_b16 v[102:103], v3 offset:4352
    s_waitcnt lgkmcnt(6)
    v_mfma_f32_16x16x32_bf16 v[76:79], v[88:91], v[164:167], v[76:79]
    ds_read_b64_tr_b16 v[104:105], v2 offset:288
    v_mfma_f32_16x16x32_bf16 v[80:83], v[88:91], v[168:171], v[80:83]
    ds_read_b64_tr_b16 v[106:107], v2 offset:4384
    s_waitcnt vmcnt(12) lgkmcnt(6)
    v_mfma_f32_16x16x32_bf16 v[20:23], v[92:95], v[188:191], v[20:23]
    ds_read_b64_tr_b16 v[84:85], v3 offset:512
    s_waitcnt vmcnt(11)
    v_mfma_f32_16x16x32_bf16 v[24:27], v[92:95], v[192:195], v[24:27]
    ds_read_b64_tr_b16 v[86:87], v3 offset:4608
    s_waitcnt lgkmcnt(6)
    v_mfma_f32_16x16x32_bf16 v[28:31], v[96:99], v[188:191], v[28:31]
    ds_read_b64_tr_b16 v[88:89], v2 offset:544
    v_mfma_f32_16x16x32_bf16 v[32:35], v[96:99], v[192:195], v[32:35]
    ds_read_b64_tr_b16 v[90:91], v2 offset:4640
    s_add_u32 s23, s21, 0x1000800
    buffer_load_dwordx4 v[156:159], v4, s[8:11], s23 offen offset:0 sc1
    s_waitcnt lgkmcnt(6)
    v_mfma_f32_16x16x32_bf16 v[36:39], v[100:103], v[188:191], v[36:39]
    ds_read_b64_tr_b16 v[92:93], v3 offset:768
    v_mfma_f32_16x16x32_bf16 v[40:43], v[100:103], v[192:195], v[40:43]
    ds_read_b64_tr_b16 v[94:95], v3 offset:4864
    s_waitcnt lgkmcnt(6)
    v_mfma_f32_16x16x32_bf16 v[44:47], v[104:107], v[188:191], v[44:47]
    ds_read_b64_tr_b16 v[96:97], v2 offset:800
    v_mfma_f32_16x16x32_bf16 v[48:51], v[104:107], v[192:195], v[48:51]
    ds_read_b64_tr_b16 v[98:99], v2 offset:4896
    s_waitcnt lgkmcnt(6)
    v_mfma_f32_16x16x32_bf16 v[52:55], v[84:87], v[188:191], v[52:55]
    ds_read_b64_tr_b16 v[100:101], v3 offset:8192
    v_mfma_f32_16x16x32_bf16 v[56:59], v[84:87], v[192:195], v[56:59]
    ds_read_b64_tr_b16 v[102:103], v3 offset:12288
    s_waitcnt lgkmcnt(6)
    v_mfma_f32_16x16x32_bf16 v[60:63], v[88:91], v[188:191], v[60:63]
    ds_read_b64_tr_b16 v[104:105], v2 offset:8224
    v_mfma_f32_16x16x32_bf16 v[64:67], v[88:91], v[192:195], v[64:67]
    ds_read_b64_tr_b16 v[106:107], v2 offset:12320
    s_add_u32 s23, s21, 0x1020800
    buffer_load_dwordx4 v[160:163], v4, s[8:11], s23 offen offset:0 sc1
    s_waitcnt lgkmcnt(6)
    v_mfma_f32_16x16x32_bf16 v[68:71], v[92:95], v[188:191], v[68:71]
    ds_read_b64_tr_b16 v[84:85], v3 offset:8448
    v_mfma_f32_16x16x32_bf16 v[72:75], v[92:95], v[192:195], v[72:75]
    ds_read_b64_tr_b16 v[86:87], v3 offset:12544
    s_waitcnt lgkmcnt(6)
    v_mfma_f32_16x16x32_bf16 v[76:79], v[96:99], v[188:191], v[76:79]
    ds_read_b64_tr_b16 v[88:89], v2 offset:8480
    v_mfma_f32_16x16x32_bf16 v[80:83], v[96:99], v[192:195], v[80:83]
    ds_read_b64_tr_b16 v[90:91], v2 offset:12576
    s_waitcnt vmcnt(12) lgkmcnt(6)
    v_mfma_f32_16x16x32_bf16 v[20:23], v[100:103], v[196:199], v[20:23]
    ds_read_b64_tr_b16 v[92:93], v3 offset:8704
    s_waitcnt vmcnt(11)
    v_mfma_f32_16x16x32_bf16 v[24:27], v[100:103], v[200:203], v[24:27]
    ds_read_b64_tr_b16 v[94:95], v3 offset:12800
    s_waitcnt lgkmcnt(6)
    v_mfma_f32_16x16x32_bf16 v[28:31], v[104:107], v[196:199], v[28:31]
    ds_read_b64_tr_b16 v[96:97], v2 offset:8736
    v_mfma_f32_16x16x32_bf16 v[32:35], v[104:107], v[200:203], v[32:35]
    ds_read_b64_tr_b16 v[98:99], v2 offset:12832
    s_add_u32 s23, s21, 0x1000800
    buffer_load_dwordx4 v[164:167], v4, s[8:11], s23 offen offset:1024 sc1
    s_waitcnt lgkmcnt(6)
    v_mfma_f32_16x16x32_bf16 v[36:39], v[84:87], v[196:199], v[36:39]
    ds_read_b64_tr_b16 v[100:101], v3 offset:8960
    v_mfma_f32_16x16x32_bf16 v[40:43], v[84:87], v[200:203], v[40:43]
    ds_read_b64_tr_b16 v[102:103], v3 offset:13056
    s_waitcnt lgkmcnt(6)
    v_mfma_f32_16x16x32_bf16 v[44:47], v[88:91], v[196:199], v[44:47]
    ds_read_b64_tr_b16 v[104:105], v2 offset:8992
    v_mfma_f32_16x16x32_bf16 v[48:51], v[88:91], v[200:203], v[48:51]
    ds_read_b64_tr_b16 v[106:107], v2 offset:13088
    s_waitcnt lgkmcnt(6)
    v_mfma_f32_16x16x32_bf16 v[52:55], v[92:95], v[196:199], v[52:55]
    v_mfma_f32_16x16x32_bf16 v[56:59], v[92:95], v[200:203], v[56:59]
    s_barrier
    ds_read_b64_tr_b16 v[84:85], v3 offset:16384
    ds_read_b64_tr_b16 v[86:87], v3 offset:20480
    s_waitcnt lgkmcnt(6)
    v_mfma_f32_16x16x32_bf16 v[60:63], v[96:99], v[196:199], v[60:63]
    ds_read_b64_tr_b16 v[88:89], v2 offset:16416
    v_mfma_f32_16x16x32_bf16 v[64:67], v[96:99], v[200:203], v[64:67]
    ds_read_b64_tr_b16 v[90:91], v2 offset:20512
    s_add_u32 s23, s21, 0x1020800
    buffer_load_dwordx4 v[168:171], v4, s[8:11], s23 offen offset:1024 sc1
    s_waitcnt lgkmcnt(6)
    v_mfma_f32_16x16x32_bf16 v[68:71], v[100:103], v[196:199], v[68:71]
    ds_read_b64_tr_b16 v[92:93], v3 offset:16640
    v_mfma_f32_16x16x32_bf16 v[72:75], v[100:103], v[200:203], v[72:75]
    ds_read_b64_tr_b16 v[94:95], v3 offset:20736
    s_waitcnt lgkmcnt(6)
    v_mfma_f32_16x16x32_bf16 v[76:79], v[104:107], v[196:199], v[76:79]
    ds_read_b64_tr_b16 v[96:97], v2 offset:16672
    v_mfma_f32_16x16x32_bf16 v[80:83], v[104:107], v[200:203], v[80:83]
    ds_read_b64_tr_b16 v[98:99], v2 offset:20768
    s_waitcnt vmcnt(7)
    v_cmp_ne_u32 vcc, s14, v10
    s_cbranch_vccz fz_o2gB
    s_mov_b32 s27, 0
fz_o2pB:
    buffer_load_dword v10, v9, s[8:11], s20 offen sc1
    s_waitcnt vmcnt(0)
    v_cmp_ne_u32 vcc, s14, v10
    s_add_u32 s27, s27, 1
    s_cmp_ge_u32 s27, 65536
    s_nop 4
    s_cbranch_scc1 fz_o2gB
    s_cbranch_vccnz fz_o2pB
fz_o2gB:
    s_waitcnt lgkmcnt(6)
    v_mfma_f32_16x16x32_bf16 v[20:23], v[84:87], v[108:111], v[20:23]
    ds_read_b64_tr_b16 v[100:101], v3 offset:16896
    v_mfma_f32_16x16x32_bf16 v[24:27], v[84:87], v[112:115], v[24:27]
    ds_read_b64_tr_b16 v[102:103], v3 offset:20992
    s_waitcnt lgkmcnt(6)
    v_mfma_f32_16x16x32_bf16 v[28:31], v[88:91], v[108:111], v[28:31]
    ds_read_b64_tr_b16 v[104:105], v2 offset:16928
    v_mfma_f32_16x16x32_bf16 v[32:35], v[88:91], v[112:115], v[32:35]
    ds_read_b64_tr_b16 v[106:107], v2 offset:21024
    s_bfe_u32 s21, s42, 0x30018
    s_or_b32 s21, s21, s62
    s_lshl_b32 s21, s21, 12
    s_add_u32 s23, s21, 0x1000000
    buffer_load_dwordx4 v[188:191], v4, s[8:11], s23 offen offset:0 sc1
    s_waitcnt lgkmcnt(6)
    v_mfma_f32_16x16x32_bf16 v[36:39], v[92:95], v[108:111], v[36:39]
    ds_read_b64_tr_b16 v[84:85], v3 offset:17152
    v_mfma_f32_16x16x32_bf16 v[40:43], v[92:95], v[112:115], v[40:43]
    ds_read_b64_tr_b16 v[86:87], v3 offset:21248
    s_waitcnt lgkmcnt(6)
    v_mfma_f32_16x16x32_bf16 v[44:47], v[96:99], v[108:111], v[44:47]
    ds_read_b64_tr_b16 v[88:89], v2 offset:17184
    v_mfma_f32_16x16x32_bf16 v[48:51], v[96:99], v[112:115], v[48:51]
    ds_read_b64_tr_b16 v[90:91], v2 offset:21280
    s_waitcnt lgkmcnt(6)
    v_mfma_f32_16x16x32_bf16 v[52:55], v[100:103], v[108:111], v[52:55]
    ds_read_b64_tr_b16 v[92:93], v3 offset:24576
    v_mfma_f32_16x16x32_bf16 v[56:59], v[100:103], v[112:115], v[56:59]
    ds_read_b64_tr_b16 v[94:95], v3 offset:28672
    s_waitcnt lgkmcnt(6)
    v_mfma_f32_16x16x32_bf16 v[60:63], v[104:107], v[108:111], v[60:63]
    ds_read_b64_tr_b16 v[96:97], v2 offset:24608
    v_mfma_f32_16x16x32_bf16 v[64:67], v[104:107], v[112:115], v[64:67]
    ds_read_b64_tr_b16 v[98:99], v2 offset:28704
    s_add_u32 s23, s21, 0x1020000
    buffer_load_dwordx4 v[192:195], v4, s[8:11], s23 offen offset:0 sc1
    s_waitcnt lgkmcnt(6)
    v_mfma_f32_16x16x32_bf16 v[68:71], v[84:87], v[108:111], v[68:71]
    ds_read_b64_tr_b16 v[100:101], v3 offset:24832
    v_mfma_f32_16x16x32_bf16 v[72:75], v[84:87], v[112:115], v[72:75]
    ds_read_b64_tr_b16 v[102:103], v3 offset:28928
    s_waitcnt lgkmcnt(6)
    v_mfma_f32_16x16x32_bf16 v[76:79], v[88:91], v[108:111], v[76:79]
    ds_read_b64_tr_b16 v[104:105], v2 offset:24864
    v_mfma_f32_16x16x32_bf16 v[80:83], v[88:91], v[112:115], v[80:83]
    ds_read_b64_tr_b16 v[106:107], v2 offset:28960
    s_waitcnt lgkmcnt(6)
    v_mfma_f32_16x16x32_bf16 v[20:23], v[92:95], v[116:119], v[20:23]
    ds_read_b64_tr_b16 v[84:85], v3 offset:25088
    v_mfma_f32_16x16x32_bf16 v[24:27], v[92:95], v[120:123], v[24:27]
    ds_read_b64_tr_b16 v[86:87], v3 offset:29184
    s_waitcnt lgkmcnt(6)
    v_mfma_f32_16x16x32_bf16 v[28:31], v[96:99], v[116:119], v[28:31]
    ds_read_b64_tr_b16 v[88:89], v2 offset:25120
    v_mfma_f32_16x16x32_bf16 v[32:35], v[96:99], v[120:123], v[32:35]
    ds_read_b64_tr_b16 v[90:91], v2 offset:29216
    s_add_u32 s23, s21, 0x1000000
    buffer_load_dwordx4 v[196:199], v4, s[8:11], s23 offen offset:1024 sc1
    s_waitcnt lgkmcnt(6)
    v_mfma_f32_16x16x32_bf16 v[36:39], v[100:103], v[116:119], v[36:39]
    ds_read_b64_tr_b16 v[92:93], v3 offset:25344
    v_mfma_f32_16x16x32_bf16 v[40:43], v[100:103], v[120:123], v[40:43]
    ds_read_b64_tr_b16 v[94:95], v3 offset:29440
    s_waitcnt lgkmcnt(6)
    v_mfma_f32_16x16x32_bf16 v[44:47], v[104:107], v[116:119], v[44:47]
    ds_read_b64_tr_b16 v[96:97], v2 offset:25376
    v_mfma_f32_16x16x32_bf16 v[48:51], v[104:107], v[120:123], v[48:51]
    ds_read_b64_tr_b16 v[98:99], v2 offset:29472
    s_waitcnt lgkmcnt(6)
    v_mfma_f32_16x16x32_bf16 v[52:55], v[84:87], v[116:119], v[52:55]
    v_mfma_f32_16x16x32_bf16 v[56:59], v[84:87], v[120:123], v[56:59]
    s_barrier
    ds_read_b64_tr_b16 v[100:101], v3 offset:32768
    ds_read_b64_tr_b16 v[102:103], v3 offset:36864
    s_waitcnt lgkmcnt(6)
    v_mfma_f32_16x16x32_bf16 v[60:63], v[88:91], v[116:119], v[60:63]
    ds_read_b64_tr_b16 v[104:105], v2 offset:32800
    v_mfma_f32_16x16x32_bf16 v[64:67], v[88:91], v[120:123], v[64:67]
    ds_read_b64_tr_b16 v[106:107], v2 offset:36896
    s_add_u32 s23, s21, 0x1020000
    buffer_load_dwordx4 v[200:203], v4, s[8:11], s23 offen offset:1024 sc1
    s_waitcnt lgkmcnt(6)
    v_mfma_f32_16x16x32_bf16 v[68:71], v[92:95], v[116:119], v[68:71]
    ds_read_b64_tr_b16 v[84:85], v3 offset:33024
    v_mfma_f32_16x16x32_bf16 v[72:75], v[92:95], v[120:123], v[72:75]
    ds_read_b64_tr_b16 v[86:87], v3 offset:37120
    s_waitcnt lgkmcnt(6)
    v_mfma_f32_16x16x32_bf16 v[76:79], v[96:99], v[116:119], v[76:79]
    ds_read_b64_tr_b16 v[88:89], v2 offset:33056
    v_mfma_f32_16x16x32_bf16 v[80:83], v[96:99], v[120:123], v[80:83]
    ds_read_b64_tr_b16 v[90:91], v2 offset:37152
    s_waitcnt lgkmcnt(6)
    v_mfma_f32_16x16x32_bf16 v[20:23], v[100:103], v[140:143], v[20:23]
    ds_read_b64_tr_b16 v[92:93], v3 offset:33280
    s_waitcnt vmcnt(10)
    v_mfma_f32_16x16x32_bf16 v[24:27], v[100:103], v[144:147], v[24:27]
    ds_read_b64_tr_b16 v[94:95], v3 offset:37376
    s_waitcnt lgkmcnt(6)
    v_mfma_f32_16x16x32_bf16 v[28:31], v[104:107], v[140:143], v[28:31]
    ds_read_b64_tr_b16 v[96:97], v2 offset:33312
    v_mfma_f32_16x16x32_bf16 v[32:35], v[104:107], v[144:147], v[32:35]
    ds_read_b64_tr_b16 v[98:99], v2 offset:37408
    s_add_u32 s23, s21, 0x1000800
    buffer_load_dwordx4 v[108:111], v4, s[8:11], s23 offen offset:0 sc1
    s_waitcnt lgkmcnt(6)
    v_mfma_f32_16x16x32_bf16 v[36:39], v[84:87], v[140:143], v[36:39]
    ds_read_b64_tr_b16 v[100:101], v3 offset:33536
    v_mfma_f32_16x16x32_bf16 v[40:43], v[84:87], v[144:147], v[40:43]
    ds_read_b64_tr_b16 v[102:103], v3 offset:37632
    s_waitcnt lgkmcnt(6)
    v_mfma_f32_16x16x32_bf16 v[44:47], v[88:91], v[140:143], v[44:47]
    ds_read_b64_tr_b16 v[104:105], v2 offset:33568
    v_mfma_f32_16x16x32_bf16 v[48:51], v[88:91], v[144:147], v[48:51]
    ds_read_b64_tr_b16 v[106:107], v2 offset:37664
    s_waitcnt lgkmcnt(6)
    v_mfma_f32_16x16x32_bf16 v[52:55], v[92:95], v[140:143], v[52:55]
    ds_read_b64_tr_b16 v[84:85], v3 offset:40960
    v_mfma_f32_16x16x32_bf16 v[56:59], v[92:95], v[144:147], v[56:59]
    ds_read_b64_tr_b16 v[86:87], v3 offset:45056
    s_waitcnt lgkmcnt(6)
    v_mfma_f32_16x16x32_bf16 v[60:63], v[96:99], v[140:143], v[60:63]
    ds_read_b64_tr_b16 v[88:89], v2 offset:40992
    v_mfma_f32_16x16x32_bf16 v[64:67], v[96:99], v[144:147], v[64:67]
    ds_read_b64_tr_b16 v[90:91], v2 offset:45088
    s_add_u32 s23, s21, 0x1020800
    buffer_load_dwordx4 v[112:115], v4, s[8:11], s23 offen offset:0 sc1
    s_waitcnt lgkmcnt(6)
    v_mfma_f32_16x16x32_bf16 v[68:71], v[100:103], v[140:143], v[68:71]
    ds_read_b64_tr_b16 v[92:93], v3 offset:41216
    v_mfma_f32_16x16x32_bf16 v[72:75], v[100:103], v[144:147], v[72:75]
    ds_read_b64_tr_b16 v[94:95], v3 offset:45312
    s_waitcnt lgkmcnt(6)
    v_mfma_f32_16x16x32_bf16 v[76:79], v[104:107], v[140:143], v[76:79]
    ds_read_b64_tr_b16 v[96:97], v2 offset:41248
    v_mfma_f32_16x16x32_bf16 v[80:83], v[104:107], v[144:147], v[80:83]
    ds_read_b64_tr_b16 v[98:99], v2 offset:45344
    s_waitcnt vmcnt(11) lgkmcnt(6)
    v_mfma_f32_16x16x32_bf16 v[20:23], v[84:87], v[148:151], v[20:23]
    ds_read_b64_tr_b16 v[100:101], v3 offset:41472
    s_waitcnt vmcnt(10)
    v_mfma_f32_16x16x32_bf16 v[24:27], v[84:87], v[152:155], v[24:27]
    ds_read_b64_tr_b16 v[102:103], v3 offset:45568
    s_waitcnt lgkmcnt(6)
    v_mfma_f32_16x16x32_bf16 v[28:31], v[88:91], v[148:151], v[28:31]
    ds_read_b64_tr_b16 v[104:105], v2 offset:41504
    v_mfma_f32_16x16x32_bf16 v[32:35], v[88:91], v[152:155], v[32:35]
    ds_read_b64_tr_b16 v[106:107], v2 offset:45600
    s_add_u32 s23, s21, 0x1000800
    buffer_load_dwordx4 v[116:119], v4, s[8:11], s23 offen offset:1024 sc1
    s_waitcnt lgkmcnt(6)
    v_mfma_f32_16x16x32_bf16 v[36:39], v[92:95], v[148:151], v[36:39]
    ds_read_b64_tr_b16 v[84:85], v3 offset:41728
    v_mfma_f32_16x16x32_bf16 v[40:43], v[92:95], v[152:155], v[40:43]
    ds_read_b64_tr_b16 v[86:87], v3 offset:45824
    s_waitcnt lgkmcnt(6)
    v_mfma_f32_16x16x32_bf16 v[44:47], v[96:99], v[148:151], v[44:47]
    ds_read_b64_tr_b16 v[88:89], v2 offset:41760
    v_mfma_f32_16x16x32_bf16 v[48:51], v[96:99], v[152:155], v[48:51]
    ds_read_b64_tr_b16 v[90:91], v2 offset:45856
    s_waitcnt lgkmcnt(6)
    v_mfma_f32_16x16x32_bf16 v[52:55], v[100:103], v[148:151], v[52:55]
    v_mfma_f32_16x16x32_bf16 v[56:59], v[100:103], v[152:155], v[56:59]
    s_barrier
    ds_read_b64_tr_b16 v[92:93], v3 offset:49152
    ds_read_b64_tr_b16 v[94:95], v3 offset:53248
    s_waitcnt lgkmcnt(6)
    v_mfma_f32_16x16x32_bf16 v[60:63], v[104:107], v[148:151], v[60:63]
    ds_read_b64_tr_b16 v[96:97], v2 offset:49184
    v_mfma_f32_16x16x32_bf16 v[64:67], v[104:107], v[152:155], v[64:67]
    ds_read_b64_tr_b16 v[98:99], v2 offset:53280
    s_add_u32 s23, s21, 0x1020800
    buffer_load_dwordx4 v[120:123], v4, s[8:11], s23 offen offset:1024 sc1
    s_waitcnt lgkmcnt(6)
    v_mfma_f32_16x16x32_bf16 v[68:71], v[84:87], v[148:151], v[68:71]
    ds_read_b64_tr_b16 v[100:101], v3 offset:49408
    v_mfma_f32_16x16x32_bf16 v[72:75], v[84:87], v[152:155], v[72:75]
    ds_read_b64_tr_b16 v[102:103], v3 offset:53504
    s_waitcnt lgkmcnt(6)
    v_mfma_f32_16x16x32_bf16 v[76:79], v[88:91], v[148:151], v[76:79]
    ds_read_b64_tr_b16 v[104:105], v2 offset:49440
    v_mfma_f32_16x16x32_bf16 v[80:83], v[88:91], v[152:155], v[80:83]
    ds_read_b64_tr_b16 v[106:107], v2 offset:53536
    s_waitcnt vmcnt(11) lgkmcnt(6)
    v_mfma_f32_16x16x32_bf16 v[20:23], v[92:95], v[156:159], v[20:23]
    ds_read_b64_tr_b16 v[84:85], v3 offset:49664
    s_waitcnt vmcnt(10)
    v_mfma_f32_16x16x32_bf16 v[24:27], v[92:95], v[160:163], v[24:27]
    ds_read_b64_tr_b16 v[86:87], v3 offset:53760
    s_waitcnt lgkmcnt(6)
    v_mfma_f32_16x16x32_bf16 v[28:31], v[96:99], v[156:159], v[28:31]
    ds_read_b64_tr_b16 v[88:89], v2 offset:49696
    v_mfma_f32_16x16x32_bf16 v[32:35], v[96:99], v[160:163], v[32:35]
    ds_read_b64_tr_b16 v[90:91], v2 offset:53792
    s_bfe_u32 s21, s42, 0x3001c
    s_or_b32 s21, s21, s62
    s_lshl_b32 s21, s21, 12
    s_add_u32 s23, s21, 0x1000000
    buffer_load_dwordx4 v[140:143], v4, s[8:11], s23 offen offset:0 sc1
    s_waitcnt lgkmcnt(6)
    v_mfma_f32_16x16x32_bf16 v[36:39], v[100:103], v[156:159], v[36:39]
    ds_read_b64_tr_b16 v[92:93], v3 offset:49920
    v_mfma_f32_16x16x32_bf16 v[40:43], v[100:103], v[160:163], v[40:43]
    ds_read_b64_tr_b16 v[94:95], v3 offset:54016
    s_waitcnt lgkmcnt(6)
    v_mfma_f32_16x16x32_bf16 v[44:47], v[104:107], v[156:159], v[44:47]
    ds_read_b64_tr_b16 v[96:97], v2 offset:49952
    v_mfma_f32_16x16x32_bf16 v[48:51], v[104:107], v[160:163], v[48:51]
    ds_read_b64_tr_b16 v[98:99], v2 offset:54048
    s_waitcnt lgkmcnt(6)
    v_mfma_f32_16x16x32_bf16 v[52:55], v[84:87], v[156:159], v[52:55]
    ds_read_b64_tr_b16 v[100:101], v3 offset:57344
    v_mfma_f32_16x16x32_bf16 v[56:59], v[84:87], v[160:163], v[56:59]
    ds_read_b64_tr_b16 v[102:103], v3 offset:61440
    s_waitcnt lgkmcnt(6)
    v_mfma_f32_16x16x32_bf16 v[60:63], v[88:91], v[156:159], v[60:63]
    ds_read_b64_tr_b16 v[104:105], v2 offset:57376
    v_mfma_f32_16x16x32_bf16 v[64:67], v[88:91], v[160:163], v[64:67]
    ds_read_b64_tr_b16 v[106:107], v2 offset:61472
    s_add_u32 s23, s21, 0x1020000
    buffer_load_dwordx4 v[144:147], v4, s[8:11], s23 offen offset:0 sc1
    s_waitcnt lgkmcnt(6)
    v_mfma_f32_16x16x32_bf16 v[68:71], v[92:95], v[156:159], v[68:71]
    ds_read_b64_tr_b16 v[84:85], v3 offset:57600
    v_mfma_f32_16x16x32_bf16 v[72:75], v[92:95], v[160:163], v[72:75]
    ds_read_b64_tr_b16 v[86:87], v3 offset:61696
    s_waitcnt lgkmcnt(6)
    v_mfma_f32_16x16x32_bf16 v[76:79], v[96:99], v[156:159], v[76:79]
    ds_read_b64_tr_b16 v[88:89], v2 offset:57632
    v_mfma_f32_16x16x32_bf16 v[80:83], v[96:99], v[160:163], v[80:83]
    ds_read_b64_tr_b16 v[90:91], v2 offset:61728
    s_waitcnt vmcnt(11) lgkmcnt(6)
    v_mfma_f32_16x16x32_bf16 v[20:23], v[100:103], v[164:167], v[20:23]
    ds_read_b64_tr_b16 v[92:93], v3 offset:57856
    s_waitcnt vmcnt(10)
    v_mfma_f32_16x16x32_bf16 v[24:27], v[100:103], v[168:171], v[24:27]
    ds_read_b64_tr_b16 v[94:95], v3 offset:61952
    s_waitcnt lgkmcnt(6)
    v_mfma_f32_16x16x32_bf16 v[28:31], v[104:107], v[164:167], v[28:31]
    ds_read_b64_tr_b16 v[96:97], v2 offset:57888
    v_mfma_f32_16x16x32_bf16 v[32:35], v[104:107], v[168:171], v[32:35]
    ds_read_b64_tr_b16 v[98:99], v2 offset:61984
    s_add_u32 s23, s21, 0x1000000
    buffer_load_dwordx4 v[148:151], v4, s[8:11], s23 offen offset:1024 sc1
    s_waitcnt lgkmcnt(6)
    v_mfma_f32_16x16x32_bf16 v[36:39], v[84:87], v[164:167], v[36:39]
    ds_read_b64_tr_b16 v[100:101], v3 offset:58112
    v_mfma_f32_16x16x32_bf16 v[40:43], v[84:87], v[168:171], v[40:43]
    ds_read_b64_tr_b16 v[102:103], v3 offset:62208
    s_waitcnt lgkmcnt(6)
    v_mfma_f32_16x16x32_bf16 v[44:47], v[88:91], v[164:167], v[44:47]
    ds_read_b64_tr_b16 v[104:105], v2 offset:58144
    v_mfma_f32_16x16x32_bf16 v[48:51], v[88:91], v[168:171], v[48:51]
    ds_read_b64_tr_b16 v[106:107], v2 offset:62240
    s_waitcnt lgkmcnt(6)
    v_mfma_f32_16x16x32_bf16 v[52:55], v[92:95], v[164:167], v[52:55]
    v_mfma_f32_16x16x32_bf16 v[56:59], v[92:95], v[168:171], v[56:59]
    s_barrier
    ds_read_b64_tr_b16 v[84:85], v15 offset:0
    ds_read_b64_tr_b16 v[86:87], v15 offset:4096
    s_waitcnt lgkmcnt(6)
    v_mfma_f32_16x16x32_bf16 v[60:63], v[96:99], v[164:167], v[60:63]
    ds_read_b64_tr_b16 v[88:89], v16 offset:32
    v_mfma_f32_16x16x32_bf16 v[64:67], v[96:99], v[168:171], v[64:67]
    ds_read_b64_tr_b16 v[90:91], v16 offset:4128
    s_add_u32 s23, s21, 0x1020000
    buffer_load_dwordx4 v[152:155], v4, s[8:11], s23 offen offset:1024 sc1
    s_waitcnt lgkmcnt(6)
    v_mfma_f32_16x16x32_bf16 v[68:71], v[100:103], v[164:167], v[68:71]
    ds_read_b64_tr_b16 v[92:93], v15 offset:256
    v_mfma_f32_16x16x32_bf16 v[72:75], v[100:103], v[168:171], v[72:75]
    ds_read_b64_tr_b16 v[94:95], v15 offset:4352
    s_waitcnt lgkmcnt(6)
    v_mfma_f32_16x16x32_bf16 v[76:79], v[104:107], v[164:167], v[76:79]
    ds_read_b64_tr_b16 v[96:97], v16 offset:288
    v_mfma_f32_16x16x32_bf16 v[80:83], v[104:107], v[168:171], v[80:83]
    ds_read_b64_tr_b16 v[98:99], v16 offset:4384
    s_waitcnt vmcnt(11) lgkmcnt(6)
    v_mfma_f32_16x16x32_bf16 v[20:23], v[84:87], v[188:191], v[20:23]
    ds_read_b64_tr_b16 v[100:101], v15 offset:512
    s_waitcnt vmcnt(10)
    v_mfma_f32_16x16x32_bf16 v[24:27], v[84:87], v[192:195], v[24:27]
    ds_read_b64_tr_b16 v[102:103], v15 offset:4608
    s_waitcnt lgkmcnt(6)
    v_mfma_f32_16x16x32_bf16 v[28:31], v[88:91], v[188:191], v[28:31]
    ds_read_b64_tr_b16 v[104:105], v16 offset:544
    v_mfma_f32_16x16x32_bf16 v[32:35], v[88:91], v[192:195], v[32:35]
    ds_read_b64_tr_b16 v[106:107], v16 offset:4640
    s_add_u32 s23, s21, 0x1000800
    buffer_load_dwordx4 v[156:159], v4, s[8:11], s23 offen offset:0 sc1
    s_waitcnt lgkmcnt(6)
    v_mfma_f32_16x16x32_bf16 v[36:39], v[92:95], v[188:191], v[36:39]
    ds_read_b64_tr_b16 v[84:85], v15 offset:768
    v_mfma_f32_16x16x32_bf16 v[40:43], v[92:95], v[192:195], v[40:43]
    ds_read_b64_tr_b16 v[86:87], v15 offset:4864
    s_waitcnt lgkmcnt(6)
    v_mfma_f32_16x16x32_bf16 v[44:47], v[96:99], v[188:191], v[44:47]
    ds_read_b64_tr_b16 v[88:89], v16 offset:800
    v_mfma_f32_16x16x32_bf16 v[48:51], v[96:99], v[192:195], v[48:51]
    ds_read_b64_tr_b16 v[90:91], v16 offset:4896
    s_waitcnt lgkmcnt(6)
    v_mfma_f32_16x16x32_bf16 v[52:55], v[100:103], v[188:191], v[52:55]
    ds_read_b64_tr_b16 v[92:93], v15 offset:8192
    v_mfma_f32_16x16x32_bf16 v[56:59], v[100:103], v[192:195], v[56:59]
    ds_read_b64_tr_b16 v[94:95], v15 offset:12288
    s_waitcnt lgkmcnt(6)
    v_mfma_f32_16x16x32_bf16 v[60:63], v[104:107], v[188:191], v[60:63]
    ds_read_b64_tr_b16 v[96:97], v16 offset:8224
    v_mfma_f32_16x16x32_bf16 v[64:67], v[104:107], v[192:195], v[64:67]
    ds_read_b64_tr_b16 v[98:99], v16 offset:12320
    s_add_u32 s23, s21, 0x1020800
    buffer_load_dwordx4 v[160:163], v4, s[8:11], s23 offen offset:0 sc1
    s_waitcnt lgkmcnt(6)
    v_mfma_f32_16x16x32_bf16 v[68:71], v[84:87], v[188:191], v[68:71]
    ds_read_b64_tr_b16 v[100:101], v15 offset:8448
    v_mfma_f32_16x16x32_bf16 v[72:75], v[84:87], v[192:195], v[72:75]
    ds_read_b64_tr_b16 v[102:103], v15 offset:12544
    s_waitcnt lgkmcnt(6)
    v_mfma_f32_16x16x32_bf16 v[76:79], v[88:91], v[188:191], v[76:79]
    ds_read_b64_tr_b16 v[104:105], v16 offset:8480
    v_mfma_f32_16x16x32_bf16 v[80:83], v[88:91], v[192:195], v[80:83]
    ds_read_b64_tr_b16 v[106:107], v16 offset:12576
    s_waitcnt vmcnt(11) lgkmcnt(6)
    v_mfma_f32_16x16x32_bf16 v[20:23], v[92:95], v[196:199], v[20:23]
    ds_read_b64_tr_b16 v[84:85], v15 offset:8704
    s_waitcnt vmcnt(10)
    v_mfma_f32_16x16x32_bf16 v[24:27], v[92:95], v[200:203], v[24:27]
    ds_read_b64_tr_b16 v[86:87], v15 offset:12800
    s_waitcnt lgkmcnt(6)
    v_mfma_f32_16x16x32_bf16 v[28:31], v[96:99], v[196:199], v[28:31]
    ds_read_b64_tr_b16 v[88:89], v16 offset:8736
    v_mfma_f32_16x16x32_bf16 v[32:35], v[96:99], v[200:203], v[32:35]
    ds_read_b64_tr_b16 v[90:91], v16 offset:12832
    s_add_u32 s23, s21, 0x1000800
    buffer_load_dwordx4 v[164:167], v4, s[8:11], s23 offen offset:1024 sc1
    s_waitcnt lgkmcnt(6)
    v_mfma_f32_16x16x32_bf16 v[36:39], v[100:103], v[196:199], v[36:39]
    ds_read_b64_tr_b16 v[92:93], v15 offset:8960
    v_mfma_f32_16x16x32_bf16 v[40:43], v[100:103], v[200:203], v[40:43]
    ds_read_b64_tr_b16 v[94:95], v15 offset:13056
    s_waitcnt lgkmcnt(6)
    v_mfma_f32_16x16x32_bf16 v[44:47], v[104:107], v[196:199], v[44:47]
    ds_read_b64_tr_b16 v[96:97], v16 offset:8992
    v_mfma_f32_16x16x32_bf16 v[48:51], v[104:107], v[200:203], v[48:51]
    ds_read_b64_tr_b16 v[98:99], v16 offset:13088
    s_waitcnt lgkmcnt(6)
    v_mfma_f32_16x16x32_bf16 v[52:55], v[84:87], v[196:199], v[52:55]
    ds_read_b64_tr_b16 v[100:101], v15 offset:16384
    v_mfma_f32_16x16x32_bf16 v[56:59], v[84:87], v[200:203], v[56:59]
    ds_read_b64_tr_b16 v[102:103], v15 offset:20480
    s_waitcnt lgkmcnt(6)
    v_mfma_f32_16x16x32_bf16 v[60:63], v[88:91], v[196:199], v[60:63]
    ds_read_b64_tr_b16 v[104:105], v16 offset:16416
    v_mfma_f32_16x16x32_bf16 v[64:67], v[88:91], v[200:203], v[64:67]
    ds_read_b64_tr_b16 v[106:107], v16 offset:20512
    s_add_u32 s23, s21, 0x1020800
    buffer_load_dwordx4 v[168:171], v4, s[8:11], s23 offen offset:1024 sc1
    s_waitcnt lgkmcnt(6)
    v_mfma_f32_16x16x32_bf16 v[68:71], v[92:95], v[196:199], v[68:71]
    ds_read_b64_tr_b16 v[84:85], v15 offset:24576
    v_mfma_f32_16x16x32_bf16 v[72:75], v[92:95], v[200:203], v[72:75]
    ds_read_b64_tr_b16 v[86:87], v15 offset:28672
    s_waitcnt lgkmcnt(6)
    v_mfma_f32_16x16x32_bf16 v[76:79], v[96:99], v[196:199], v[76:79]
    ds_read_b64_tr_b16 v[88:89], v16 offset:24608
    v_mfma_f32_16x16x32_bf16 v[80:83], v[96:99], v[200:203], v[80:83]
    ds_read_b64_tr_b16 v[90:91], v16 offset:28704
    s_waitcnt vmcnt(11) lgkmcnt(6)
    v_mfma_f32_16x16x32_bf16 v[20:23], v[100:103], v[108:111], v[20:23]
    ds_read_b64_tr_b16 v[92:93], v15 offset:32768
    s_waitcnt vmcnt(10)
    v_mfma_f32_16x16x32_bf16 v[24:27], v[100:103], v[112:115], v[24:27]
    ds_read_b64_tr_b16 v[94:95], v15 offset:36864
    s_waitcnt lgkmcnt(6)
    v_mfma_f32_16x16x32_bf16 v[28:31], v[104:107], v[108:111], v[28:31]
    ds_read_b64_tr_b16 v[96:97], v16 offset:32800
    v_mfma_f32_16x16x32_bf16 v[32:35], v[104:107], v[112:115], v[32:35]
    ds_read_b64_tr_b16 v[98:99], v16 offset:36896
    s_waitcnt vmcnt(9) lgkmcnt(6)
    v_mfma_f32_16x16x32_bf16 v[20:23], v[84:87], v[116:119], v[20:23]
    ds_read_b64_tr_b16 v[100:101], v15 offset:40960
    s_waitcnt vmcnt(8)
    v_mfma_f32_16x16x32_bf16 v[24:27], v[84:87], v[120:123], v[24:27]
    ds_read_b64_tr_b16 v[102:103], v15 offset:45056
    s_waitcnt lgkmcnt(6)
    v_mfma_f32_16x16x32_bf16 v[28:31], v[88:91], v[116:119], v[28:31]
    ds_read_b64_tr_b16 v[104:105], v16 offset:40992
    v_mfma_f32_16x16x32_bf16 v[32:35], v[88:91], v[120:123], v[32:35]
    ds_read_b64_tr_b16 v[106:107], v16 offset:45088
    s_waitcnt vmcnt(7) lgkmcnt(6)
    v_mfma_f32_16x16x32_bf16 v[20:23], v[92:95], v[140:143], v[20:23]
    ds_read_b64_tr_b16 v[84:85], v15 offset:49152
    s_waitcnt vmcnt(6)
    v_mfma_f32_16x16x32_bf16 v[24:27], v[92:95], v[144:147], v[24:27]
    ds_read_b64_tr_b16 v[86:87], v15 offset:53248
    s_waitcnt lgkmcnt(6)
    v_mfma_f32_16x16x32_bf16 v[28:31], v[96:99], v[140:143], v[28:31]
    ds_read_b64_tr_b16 v[88:89], v16 offset:49184
    v_mfma_f32_16x16x32_bf16 v[32:35], v[96:99], v[144:147], v[32:35]
    ds_read_b64_tr_b16 v[90:91], v16 offset:53280
    s_waitcnt vmcnt(5) lgkmcnt(6)
    v_mfma_f32_16x16x32_bf16 v[20:23], v[100:103], v[148:151], v[20:23]
    ds_read_b64_tr_b16 v[92:93], v15 offset:57344
    s_waitcnt vmcnt(4)
    v_mfma_f32_16x16x32_bf16 v[24:27], v[100:103], v[152:155], v[24:27]
    ds_read_b64_tr_b16 v[94:95], v15 offset:61440
    s_waitcnt lgkmcnt(6)
    v_mfma_f32_16x16x32_bf16 v[28:31], v[104:107], v[148:151], v[28:31]
    ds_read_b64_tr_b16 v[96:97], v16 offset:57376
    v_mfma_f32_16x16x32_bf16 v[32:35], v[104:107], v[152:155], v[32:35]
    ds_read_b64_tr_b16 v[98:99], v16 offset:61472
    s_waitcnt vmcnt(3) lgkmcnt(6)
    v_mfma_f32_16x16x32_bf16 v[20:23], v[84:87], v[156:159], v[20:23]
    ds_read_b64_tr_b16 v[100:101], v15 offset:16640
    s_waitcnt vmcnt(2)
    v_mfma_f32_16x16x32_bf16 v[24:27], v[84:87], v[160:163], v[24:27]
    ds_read_b64_tr_b16 v[102:103], v15 offset:20736
    s_waitcnt lgkmcnt(6)
    v_mfma_f32_16x16x32_bf16 v[28:31], v[88:91], v[156:159], v[28:31]
    ds_read_b64_tr_b16 v[104:105], v16 offset:16672
    v_mfma_f32_16x16x32_bf16 v[32:35], v[88:91], v[160:163], v[32:35]
    ds_read_b64_tr_b16 v[106:107], v16 offset:20768
    s_waitcnt vmcnt(1) lgkmcnt(6)
    v_mfma_f32_16x16x32_bf16 v[20:23], v[92:95], v[164:167], v[20:23]
    ds_read_b64_tr_b16 v[84:85], v15 offset:24832
    s_waitcnt vmcnt(0)
    v_mfma_f32_16x16x32_bf16 v[24:27], v[92:95], v[168:171], v[24:27]
    ds_read_b64_tr_b16 v[86:87], v15 offset:28928
    s_waitcnt lgkmcnt(6)
    v_mfma_f32_16x16x32_bf16 v[28:31], v[96:99], v[164:167], v[28:31]
    ds_read_b64_tr_b16 v[88:89], v16 offset:24864
    v_mfma_f32_16x16x32_bf16 v[32:35], v[96:99], v[168:171], v[32:35]
    ds_read_b64_tr_b16 v[90:91], v16 offset:28960
    ds_read_b128 v[124:127], v13 offset:0
    ds_read_b128 v[128:131], v13 offset:64
    s_waitcnt lgkmcnt(8)
    v_mfma_f32_16x16x32_bf16 v[36:39], v[100:103], v[108:111], v[36:39]
    ds_read_b64_tr_b16 v[92:93], v15 offset:33024
    v_mfma_f32_16x16x32_bf16 v[40:43], v[100:103], v[112:115], v[40:43]
    ds_read_b64_tr_b16 v[94:95], v15 offset:37120
    s_waitcnt lgkmcnt(8)
    v_mfma_f32_16x16x32_bf16 v[44:47], v[104:107], v[108:111], v[44:47]
    ds_read_b64_tr_b16 v[96:97], v16 offset:33056
    v_mfma_f32_16x16x32_bf16 v[48:51], v[104:107], v[112:115], v[48:51]
    ds_read_b64_tr_b16 v[98:99], v16 offset:37152
    s_waitcnt lgkmcnt(8)
    v_mfma_f32_16x16x32_bf16 v[36:39], v[84:87], v[116:119], v[36:39]
    s_waitcnt lgkmcnt(5)
    v_pk_mul_f32 v[132:133], v[20:21], v[124:125]
    v_pk_mul_f32 v[134:135], v[22:23], v[126:127]
    ds_read_b64_tr_b16 v[100:101], v15 offset:41216
    v_mfma_f32_16x16x32_bf16 v[40:43], v[84:87], v[120:123], v[40:43]
    s_waitcnt lgkmcnt(5)
    v_pk_mul_f32 v[136:137], v[28:29], v[128:129]
    ds_read_b64_tr_b16 v[102:103], v15 offset:45312
    v_mfma_f32_16x16x32_bf16 v[44:47], v[88:91], v[116:119], v[44:47]
    v_pk_mul_f32 v[138:139], v[30:31], v[130:131]
    v_cvt_pk_bf16_f32 v132, v132, v133
    ds_read_b64_tr_b16 v[104:105], v16 offset:41248
    v_mfma_f32_16x16x32_bf16 v[48:51], v[88:91], v[120:123], v[48:51]
    v_cvt_pk_bf16_f32 v133, v134, v135
    ds_read_b64_tr_b16 v[106:107], v16 offset:45344
    s_waitcnt lgkmcnt(6)
    v_mfma_f32_16x16x32_bf16 v[36:39], v[92:95], v[140:143], v[36:39]
    v_cvt_pk_bf16_f32 v134, v136, v137
    v_cvt_pk_bf16_f32 v135, v138, v139
    ds_read_b64_tr_b16 v[84:85], v15 offset:49408
    v_mfma_f32_16x16x32_bf16 v[40:43], v[92:95], v[144:147], v[40:43]
    v_permlane32_swap_b32 v132, v134
    ds_read_b64_tr_b16 v[86:87], v15 offset:53504
    s_waitcnt lgkmcnt(6)
    v_mfma_f32_16x16x32_bf16 v[44:47], v[96:99], v[140:143], v[44:47]
    v_permlane32_swap_b32 v133, v135
    v_permlane16_swap_b32 v132, v134
    ds_read_b64_tr_b16 v[88:89], v16 offset:49440
    v_mfma_f32_16x16x32_bf16 v[48:51], v[96:99], v[144:147], v[48:51]
    v_permlane16_swap_b32 v133, v135
    ds_read_b64_tr_b16 v[90:91], v16 offset:53536
    s_waitcnt lgkmcnt(6)
    v_mfma_f32_16x16x32_bf16 v[36:39], v[100:103], v[148:151], v[36:39]
    buffer_store_dwordx4 v[132:135], v14, s[8:11], s18 offen offset:0 sc1
    ds_read_b64_tr_b16 v[92:93], v15 offset:57600
    v_mfma_f32_16x16x32_bf16 v[40:43], v[100:103], v[152:155], v[40:43]
    v_pk_mul_f32 v[132:133], v[24:25], v[124:125]
    v_pk_mul_f32 v[134:135], v[26:27], v[126:127]
    ds_read_b64_tr_b16 v[94:95], v15 offset:61696
    s_waitcnt lgkmcnt(6)
    v_mfma_f32_16x16x32_bf16 v[44:47], v[104:107], v[148:151], v[44:47]
    v_pk_mul_f32 v[136:137], v[32:33], v[128:129]
    ds_read_b64_tr_b16 v[96:97], v16 offset:57632
    v_mfma_f32_16x16x32_bf16 v[48:51], v[104:107], v[152:155], v[48:51]
    v_pk_mul_f32 v[138:139], v[34:35], v[130:131]
    v_cvt_pk_bf16_f32 v132, v132, v133
    ds_read_b64_tr_b16 v[98:99], v16 offset:61728
    s_waitcnt lgkmcnt(6)
    v_mfma_f32_16x16x32_bf16 v[36:39], v[84:87], v[156:159], v[36:39]
    v_cvt_pk_bf16_f32 v133, v134, v135
    ds_read_b64_tr_b16 v[100:101], v15 offset:16896
    v_mfma_f32_16x16x32_bf16 v[40:43], v[84:87], v[160:163], v[40:43]
    v_cvt_pk_bf16_f32 v134, v136, v137
    v_cvt_pk_bf16_f32 v135, v138, v139
    ds_read_b64_tr_b16 v[102:103], v15 offset:20992
    s_waitcnt lgkmcnt(6)
    v_mfma_f32_16x16x32_bf16 v[44:47], v[88:91], v[156:159], v[44:47]
    v_permlane32_swap_b32 v132, v134
    ds_read_b64_tr_b16 v[104:105], v16 offset:16928
    v_mfma_f32_16x16x32_bf16 v[48:51], v[88:91], v[160:163], v[48:51]
    v_permlane32_swap_b32 v133, v135
    v_permlane16_swap_b32 v132, v134
    ds_read_b64_tr_b16 v[106:107], v16 offset:21024
    s_waitcnt lgkmcnt(6)
    v_mfma_f32_16x16x32_bf16 v[36:39], v[92:95], v[164:167], v[36:39]
    v_permlane16_swap_b32 v133, v135
    ds_read_b64_tr_b16 v[84:85], v15 offset:25088
    v_mfma_f32_16x16x32_bf16 v[40:43], v[92:95], v[168:171], v[40:43]
    buffer_store_dwordx4 v[132:135], v14, s[8:11], s19 offen offset:0 sc1
    ds_read_b64_tr_b16 v[86:87], v15 offset:29184
    s_waitcnt lgkmcnt(6)
    v_mfma_f32_16x16x32_bf16 v[44:47], v[96:99], v[164:167], v[44:47]
    ds_read_b64_tr_b16 v[88:89], v16 offset:25120
    v_mfma_f32_16x16x32_bf16 v[48:51], v[96:99], v[168:171], v[48:51]
    ds_read_b64_tr_b16 v[90:91], v16 offset:29216
    ds_read_b128 v[124:127], v13 offset:128
    ds_read_b128 v[128:131], v13 offset:192
    s_waitcnt lgkmcnt(8)
    v_mfma_f32_16x16x32_bf16 v[52:55], v[100:103], v[108:111], v[52:55]
    ds_read_b64_tr_b16 v[92:93], v15 offset:33280
    v_mfma_f32_16x16x32_bf16 v[56:59], v[100:103], v[112:115], v[56:59]
    ds_read_b64_tr_b16 v[94:95], v15 offset:37376
    s_waitcnt lgkmcnt(8)
    v_mfma_f32_16x16x32_bf16 v[60:63], v[104:107], v[108:111], v[60:63]
    ds_read_b64_tr_b16 v[96:97], v16 offset:33312
    v_mfma_f32_16x16x32_bf16 v[64:67], v[104:107], v[112:115], v[64:67]
    ds_read_b64_tr_b16 v[98:99], v16 offset:37408
    s_waitcnt lgkmcnt(8)
    v_mfma_f32_16x16x32_bf16 v[52:55], v[84:87], v[116:119], v[52:55]
    s_waitcnt lgkmcnt(5)
    v_pk_mul_f32 v[132:133], v[36:37], v[124:125]
    v_pk_mul_f32 v[134:135], v[38:39], v[126:127]
    ds_read_b64_tr_b16 v[100:101], v15 offset:41472
    v_mfma_f32_16x16x32_bf16 v[56:59], v[84:87], v[120:123], v[56:59]
    s_waitcnt lgkmcnt(5)
    v_pk_mul_f32 v[136:137], v[44:45], v[128:129]
    ds_read_b64_tr_b16 v[102:103], v15 offset:45568
    v_mfma_f32_16x16x32_bf16 v[60:63], v[88:91], v[116:119], v[60:63]
    v_pk_mul_f32 v[138:139], v[46:47], v[130:131]
    v_cvt_pk_bf16_f32 v132, v132, v133
    ds_read_b64_tr_b16 v[104:105], v16 offset:41504
    v_mfma_f32_16x16x32_bf16 v[64:67], v[88:91], v[120:123], v[64:67]
    v_cvt_pk_bf16_f32 v133, v134, v135
    ds_read_b64_tr_b16 v[106:107], v16 offset:45600
    s_waitcnt lgkmcnt(6)
    v_mfma_f32_16x16x32_bf16 v[52:55], v[92:95], v[140:143], v[52:55]
    v_cvt_pk_bf16_f32 v134, v136, v137
    v_cvt_pk_bf16_f32 v135, v138, v139
    ds_read_b64_tr_b16 v[84:85], v15 offset:49664
    v_mfma_f32_16x16x32_bf16 v[56:59], v[92:95], v[144:147], v[56:59]
    v_permlane32_swap_b32 v132, v134
    ds_read_b64_tr_b16 v[86:87], v15 offset:53760
    s_waitcnt lgkmcnt(6)
    v_mfma_f32_16x16x32_bf16 v[60:63], v[96:99], v[140:143], v[60:63]
    v_permlane32_swap_b32 v133, v135
    v_permlane16_swap_b32 v132, v134
    ds_read_b64_tr_b16 v[88:89], v16 offset:49696
    v_mfma_f32_16x16x32_bf16 v[64:67], v[96:99], v[144:147], v[64:67]
    v_permlane16_swap_b32 v133, v135
    ds_read_b64_tr_b16 v[90:91], v16 offset:53792
    s_waitcnt lgkmcnt(6)
    v_mfma_f32_16x16x32_bf16 v[52:55], v[100:103], v[148:151], v[52:55]
    buffer_store_dwordx4 v[132:135], v14, s[8:11], s18 offen offset:1024 sc1
    ds_read_b64_tr_b16 v[92:93], v15 offset:57856
    v_mfma_f32_16x16x32_bf16 v[56:59], v[100:103], v[152:155], v[56:59]
    v_pk_mul_f32 v[132:133], v[40:41], v[124:125]
    v_pk_mul_f32 v[134:135], v[42:43], v[126:127]
    ds_read_b64_tr_b16 v[94:95], v15 offset:61952
    s_waitcnt lgkmcnt(6)
    v_mfma_f32_16x16x32_bf16 v[60:63], v[104:107], v[148:151], v[60:63]
    v_pk_mul_f32 v[136:137], v[48:49], v[128:129]
    ds_read_b64_tr_b16 v[96:97], v16 offset:57888
    v_mfma_f32_16x16x32_bf16 v[64:67], v[104:107], v[152:155], v[64:67]
    v_pk_mul_f32 v[138:139], v[50:51], v[130:131]
    v_cvt_pk_bf16_f32 v132, v132, v133
    ds_read_b64_tr_b16 v[98:99], v16 offset:61984
    s_waitcnt lgkmcnt(6)
    v_mfma_f32_16x16x32_bf16 v[52:55], v[84:87], v[156:159], v[52:55]
    v_cvt_pk_bf16_f32 v133, v134, v135
    ds_read_b64_tr_b16 v[100:101], v15 offset:17152
    v_mfma_f32_16x16x32_bf16 v[56:59], v[84:87], v[160:163], v[56:59]
    v_cvt_pk_bf16_f32 v134, v136, v137
    v_cvt_pk_bf16_f32 v135, v138, v139
    ds_read_b64_tr_b16 v[102:103], v15 offset:21248
    s_waitcnt lgkmcnt(6)
    v_mfma_f32_16x16x32_bf16 v[60:63], v[88:91], v[156:159], v[60:63]
    v_permlane32_swap_b32 v132, v134
    ds_read_b64_tr_b16 v[104:105], v16 offset:17184
    v_mfma_f32_16x16x32_bf16 v[64:67], v[88:91], v[160:163], v[64:67]
    v_permlane32_swap_b32 v133, v135
    v_permlane16_swap_b32 v132, v134
    ds_read_b64_tr_b16 v[106:107], v16 offset:21280
    s_waitcnt lgkmcnt(6)
    v_mfma_f32_16x16x32_bf16 v[52:55], v[92:95], v[164:167], v[52:55]
    v_permlane16_swap_b32 v133, v135
    ds_read_b64_tr_b16 v[84:85], v15 offset:25344
    v_mfma_f32_16x16x32_bf16 v[56:59], v[92:95], v[168:171], v[56:59]
    buffer_store_dwordx4 v[132:135], v14, s[8:11], s19 offen offset:1024 sc1
    ds_read_b64_tr_b16 v[86:87], v15 offset:29440
    s_waitcnt lgkmcnt(6)
    v_mfma_f32_16x16x32_bf16 v[60:63], v[96:99], v[164:167], v[60:63]
    ds_read_b64_tr_b16 v[88:89], v16 offset:25376
    v_mfma_f32_16x16x32_bf16 v[64:67], v[96:99], v[168:171], v[64:67]
    ds_read_b64_tr_b16 v[90:91], v16 offset:29472
    ds_read_b128 v[124:127], v13 offset:256
    ds_read_b128 v[128:131], v13 offset:320
    s_waitcnt lgkmcnt(8)
    v_mfma_f32_16x16x32_bf16 v[68:71], v[100:103], v[108:111], v[68:71]
    ds_read_b64_tr_b16 v[92:93], v15 offset:33536
    v_mfma_f32_16x16x32_bf16 v[72:75], v[100:103], v[112:115], v[72:75]
    ds_read_b64_tr_b16 v[94:95], v15 offset:37632
    s_waitcnt lgkmcnt(8)
    v_mfma_f32_16x16x32_bf16 v[76:79], v[104:107], v[108:111], v[76:79]
    ds_read_b64_tr_b16 v[96:97], v16 offset:33568
    v_mfma_f32_16x16x32_bf16 v[80:83], v[104:107], v[112:115], v[80:83]
    ds_read_b64_tr_b16 v[98:99], v16 offset:37664
    s_waitcnt lgkmcnt(8)
    v_mfma_f32_16x16x32_bf16 v[68:71], v[84:87], v[116:119], v[68:71]
    s_waitcnt lgkmcnt(5)
    v_pk_mul_f32 v[132:133], v[52:53], v[124:125]
    v_pk_mul_f32 v[134:135], v[54:55], v[126:127]
    ds_read_b64_tr_b16 v[100:101], v15 offset:41728
    v_mfma_f32_16x16x32_bf16 v[72:75], v[84:87], v[120:123], v[72:75]
    s_waitcnt lgkmcnt(5)
    v_pk_mul_f32 v[136:137], v[60:61], v[128:129]
    ds_read_b64_tr_b16 v[102:103], v15 offset:45824
    v_mfma_f32_16x16x32_bf16 v[76:79], v[88:91], v[116:119], v[76:79]
    v_pk_mul_f32 v[138:139], v[62:63], v[130:131]
    v_cvt_pk_bf16_f32 v132, v132, v133
    ds_read_b64_tr_b16 v[104:105], v16 offset:41760
    v_mfma_f32_16x16x32_bf16 v[80:83], v[88:91], v[120:123], v[80:83]
    v_cvt_pk_bf16_f32 v133, v134, v135
    ds_read_b64_tr_b16 v[106:107], v16 offset:45856
    s_waitcnt lgkmcnt(6)
    v_mfma_f32_16x16x32_bf16 v[68:71], v[92:95], v[140:143], v[68:71]
    v_cvt_pk_bf16_f32 v134, v136, v137
    v_cvt_pk_bf16_f32 v135, v138, v139
    ds_read_b64_tr_b16 v[84:85], v15 offset:49920
    v_mfma_f32_16x16x32_bf16 v[72:75], v[92:95], v[144:147], v[72:75]
    v_permlane32_swap_b32 v132, v134
    ds_read_b64_tr_b16 v[86:87], v15 offset:54016
    s_waitcnt lgkmcnt(6)
    v_mfma_f32_16x16x32_bf16 v[76:79], v[96:99], v[140:143], v[76:79]
    v_permlane32_swap_b32 v133, v135
    v_permlane16_swap_b32 v132, v134
    ds_read_b64_tr_b16 v[88:89], v16 offset:49952
    v_mfma_f32_16x16x32_bf16 v[80:83], v[96:99], v[144:147], v[80:83]
    v_permlane16_swap_b32 v133, v135
    ds_read_b64_tr_b16 v[90:91], v16 offset:54048
    s_waitcnt lgkmcnt(6)
    v_mfma_f32_16x16x32_bf16 v[68:71], v[100:103], v[148:151], v[68:71]
    buffer_store_dwordx4 v[132:135], v14, s[8:11], s18 offen offset:2048 sc1
    ds_read_b64_tr_b16 v[92:93], v15 offset:58112
    v_mfma_f32_16x16x32_bf16 v[72:75], v[100:103], v[152:155], v[72:75]
    v_pk_mul_f32 v[132:133], v[56:57], v[124:125]
    v_pk_mul_f32 v[134:135], v[58:59], v[126:127]
    ds_read_b64_tr_b16 v[94:95], v15 offset:62208
    s_waitcnt lgkmcnt(6)
    v_mfma_f32_16x16x32_bf16 v[76:79], v[104:107], v[148:151], v[76:79]
    v_pk_mul_f32 v[136:137], v[64:65], v[128:129]
    ds_read_b64_tr_b16 v[96:97], v16 offset:58144
    v_mfma_f32_16x16x32_bf16 v[80:83], v[104:107], v[152:155], v[80:83]
    v_pk_mul_f32 v[138:139], v[66:67], v[130:131]
    v_cvt_pk_bf16_f32 v132, v132, v133
    ds_read_b64_tr_b16 v[98:99], v16 offset:62240
    s_waitcnt lgkmcnt(6)
    v_mfma_f32_16x16x32_bf16 v[68:71], v[84:87], v[156:159], v[68:71]
    v_cvt_pk_bf16_f32 v133, v134, v135
    v_mfma_f32_16x16x32_bf16 v[72:75], v[84:87], v[160:163], v[72:75]
    v_cvt_pk_bf16_f32 v134, v136, v137
    v_cvt_pk_bf16_f32 v135, v138, v139
    s_waitcnt lgkmcnt(4)
    v_mfma_f32_16x16x32_bf16 v[76:79], v[88:91], v[156:159], v[76:79]
    v_permlane32_swap_b32 v132, v134
    v_mfma_f32_16x16x32_bf16 v[80:83], v[88:91], v[160:163], v[80:83]
    v_permlane32_swap_b32 v133, v135
    v_permlane16_swap_b32 v132, v134
    s_waitcnt lgkmcnt(2)
    v_mfma_f32_16x16x32_bf16 v[68:71], v[92:95], v[164:167], v[68:71]
    v_permlane16_swap_b32 v133, v135
    v_mfma_f32_16x16x32_bf16 v[72:75], v[92:95], v[168:171], v[72:75]
    buffer_store_dwordx4 v[132:135], v14, s[8:11], s19 offen offset:2048 sc1
    s_waitcnt lgkmcnt(0)
    v_mfma_f32_16x16x32_bf16 v[76:79], v[96:99], v[164:167], v[76:79]
    v_mfma_f32_16x16x32_bf16 v[80:83], v[96:99], v[168:171], v[80:83]
    ds_read_b128 v[124:127], v13 offset:384
    ds_read_b128 v[128:131], v13 offset:448
    s_waitcnt lgkmcnt(1)
    v_pk_mul_f32 v[132:133], v[68:69], v[124:125]
    v_pk_mul_f32 v[134:135], v[70:71], v[126:127]
    s_waitcnt lgkmcnt(0)
    s_nop 0
    v_pk_mul_f32 v[136:137], v[76:77], v[128:129]
    v_pk_mul_f32 v[138:139], v[78:79], v[130:131]
    v_cvt_pk_bf16_f32 v132, v132, v133
    v_cvt_pk_bf16_f32 v133, v134, v135
    v_cvt_pk_bf16_f32 v134, v136, v137
    v_cvt_pk_bf16_f32 v135, v138, v139
    s_nop 0
    v_permlane32_swap_b32 v132, v134
    v_permlane32_swap_b32 v133, v135
    s_nop 0
    v_permlane16_swap_b32 v132, v134
    v_permlane16_swap_b32 v133, v135
    buffer_store_dwordx4 v[132:135], v14, s[8:11], s18 offen offset:3072 sc1
    s_nop 1
    v_pk_mul_f32 v[132:133], v[72:73], v[124:125]
    v_pk_mul_f32 v[134:135], v[74:75], v[126:127]
    v_pk_mul_f32 v[136:137], v[80:81], v[128:129]
    v_pk_mul_f32 v[138:139], v[82:83], v[130:131]
    v_cvt_pk_bf16_f32 v132, v132, v133
    v_cvt_pk_bf16_f32 v133, v134, v135
    v_cvt_pk_bf16_f32 v134, v136, v137
    v_cvt_pk_bf16_f32 v135, v138, v139
    s_nop 0
    v_permlane32_swap_b32 v132, v134
    v_permlane32_swap_b32 v133, v135
    s_nop 0
    v_permlane16_swap_b32 v132, v134
    v_permlane16_swap_b32 v133, v135
    buffer_store_dwordx4 v[132:135], v14, s[8:11], s19 offen offset:3072 sc1
fz_p3e:
    s_lshl_b32 s26, s13, 3
    s_add_u32 s26, s26, s3
    s_lshl_b32 s26, s26, 7
    s_lshl_b32 s27, s12, 2
    s_add_u32 s26, s26, s27
    s_add_u32 s26, s26, 0x550000
    v_mov_b32 v7, s14
    v_mov_b32 v6, 0
    v_mov_b32 v16, s3
    v_lshl_add_u32 v17, v16, 6, v0
    v_lshlrev_b32 v5, 2, v17
    v_lshrrev_b32 v13, 3, v8
    v_and_b32 v14, 7, v8
    s_lshl_b32 s16, s13, 8
    s_lshl_b32 s27, s12, 3
    s_add_u32 s16, s16, s27
    s_add_u32 s16, s16, s3
    s_lshl_b32 s17, s16, 11
    s_mov_b64 s[28:29], s[32:33]
    s_mov_b32 s30, 0x400000
    s_mov_b32 s31, 0x20000
    s_mov_b64 s[64:65], s[56:57]
    s_mov_b32 s66, 0x400000
    s_mov_b32 s67, 0x20000
    v_add_u32 v15, 0x20000, v1
    ds_read_b128 v[72:75], v15 offset:0
    ds_read_b128 v[76:79], v15 offset:1024
    ds_read_b128 v[80:83], v15 offset:2048
    ds_read_b128 v[84:87], v15 offset:3072
    ds_read_b128 v[88:91], v15 offset:4096
    ds_read_b128 v[92:95], v15 offset:5120
    ds_read_b128 v[96:99], v15 offset:6144
    ds_read_b128 v[100:103], v15 offset:7168
    s_waitcnt vmcnt(0)
    s_mov_b64 exec, 1
    buffer_store_dword v7, v6, s[8:11], s26 offen sc1
    s_mov_b64 exec, -1
    buffer_load_dwordx4 v[128:131], v1, s[28:31], s17 offen offset:0
    buffer_load_dwordx4 v[132:135], v1, s[28:31], s17 offen offset:1024
    v_mov_b32 v190, 0
    v_mov_b32 v196, 0
    s_waitcnt lgkmcnt(5)
    v_lshlrev_b32 v144, 16, v80
    v_and_b32 v145, 0xffff0000, v80
    s_waitcnt lgkmcnt(1)
    v_lshlrev_b32 v146, 16, v96
    v_and_b32 v147, 0xffff0000, v96
    v_pk_mul_f32 v[104:105], v[144:145], v[146:147]
    v_lshlrev_b32 v144, 16, v72
    v_and_b32 v145, 0xffff0000, v72
    v_fmac_f32 v190, v144, v146
    v_fmac_f32 v190, v145, v147
    v_add_f32 v196, v196, v104
    v_add_f32 v196, v196, v105
    v_lshlrev_b32 v144, 16, v81
    v_and_b32 v145, 0xffff0000, v81
    v_lshlrev_b32 v146, 16, v97
    v_and_b32 v147, 0xffff0000, v97
    v_pk_mul_f32 v[106:107], v[144:145], v[146:147]
    v_lshlrev_b32 v144, 16, v73
    v_and_b32 v145, 0xffff0000, v73
    v_fmac_f32 v190, v144, v146
    v_fmac_f32 v190, v145, v147
    v_add_f32 v196, v196, v106
    v_add_f32 v196, v196, v107
    v_lshlrev_b32 v144, 16, v82
    v_and_b32 v145, 0xffff0000, v82
    v_lshlrev_b32 v146, 16, v98
    v_and_b32 v147, 0xffff0000, v98
    v_pk_mul_f32 v[108:109], v[144:145], v[146:147]
    v_lshlrev_b32 v144, 16, v74
    v_and_b32 v145, 0xffff0000, v74
    v_fmac_f32 v190, v144, v146
    v_fmac_f32 v190, v145, v147
    v_add_f32 v196, v196, v108
    v_add_f32 v196, v196, v109
    v_lshlrev_b32 v144, 16, v83
    v_and_b32 v145, 0xffff0000, v83
    v_lshlrev_b32 v146, 16, v99
    v_and_b32 v147, 0xffff0000, v99
    v_pk_mul_f32 v[110:111], v[144:145], v[146:147]
    v_lshlrev_b32 v144, 16, v75
    v_and_b32 v145, 0xffff0000, v75
    v_fmac_f32 v190, v144, v146
    v_fmac_f32 v190, v145, v147
    v_add_f32 v196, v196, v110
    v_add_f32 v196, v196, v111
    v_lshlrev_b32 v144, 16, v84
    v_and_b32 v145, 0xffff0000, v84
    s_waitcnt lgkmcnt(0)
    v_lshlrev_b32 v146, 16, v100
    v_and_b32 v147, 0xffff0000, v100
    v_pk_mul_f32 v[112:113], v[144:145], v[146:147]
    v_lshlrev_b32 v144, 16, v76
    v_and_b32 v145, 0xffff0000, v76
    v_fmac_f32 v190, v144, v146
    v_fmac_f32 v190, v145, v147
    v_add_f32 v196, v196, v112
    v_add_f32 v196, v196, v113
    v_lshlrev_b32 v144, 16, v85
    v_and_b32 v145, 0xffff0000, v85
    v_lshlrev_b32 v146, 16, v101
    v_and_b32 v147, 0xffff0000, v101
    v_pk_mul_f32 v[114:115], v[144:145], v[146:147]
    v_lshlrev_b32 v144, 16, v77
    v_and_b32 v145, 0xffff0000, v77
    v_fmac_f32 v190, v144, v146
    v_fmac_f32 v190, v145, v147
    v_add_f32 v196, v196, v114
    v_add_f32 v196, v196, v115
    v_lshlrev_b32 v144, 16, v86
    v_and_b32 v145, 0xffff0000, v86
    v_lshlrev_b32 v146, 16, v102
    v_and_b32 v147, 0xffff0000, v102
    v_pk_mul_f32 v[116:117], v[144:145], v[146:147]
    v_lshlrev_b32 v144, 16, v78
    v_and_b32 v145, 0xffff0000, v78
    v_fmac_f32 v190, v144, v146
    v_fmac_f32 v190, v145, v147
    v_add_f32 v196, v196, v116
    v_add_f32 v196, v196, v117
    v_lshlrev_b32 v144, 16, v87
    v_and_b32 v145, 0xffff0000, v87
    v_lshlrev_b32 v146, 16, v103
    v_and_b32 v147, 0xffff0000, v103
    v_pk_mul_f32 v[118:119], v[144:145], v[146:147]
    v_lshlrev_b32 v144, 16, v79
    v_and_b32 v145, 0xffff0000, v79
    v_fmac_f32 v190, v144, v146
    v_fmac_f32 v190, v145, v147
    v_add_f32 v196, v196, v118
    v_add_f32 v196, v196, v119
    v_add_f32_dpp v190, v190, v190 row_ror:1 row_mask:0xf bank_mask:0xf
    s_nop 0
    v_add_f32_dpp v196, v196, v196 row_ror:1 row_mask:0xf bank_mask:0xf
    v_add_f32_dpp v190, v190, v190 row_ror:2 row_mask:0xf bank_mask:0xf
    s_nop 0
    v_add_f32_dpp v196, v196, v196 row_ror:2 row_mask:0xf bank_mask:0xf
    v_add_f32_dpp v190, v190, v190 row_ror:4 row_mask:0xf bank_mask:0xf
    s_nop 0
    v_add_f32_dpp v196, v196, v196 row_ror:4 row_mask:0xf bank_mask:0xf
    v_add_f32_dpp v190, v190, v190 row_ror:8 row_mask:0xf bank_mask:0xf
    s_nop 0
    v_add_f32_dpp v196, v196, v196 row_ror:8 row_mask:0xf bank_mask:0xf
    v_mov_b32 v144, v190
    s_nop 1
    v_permlane16_swap_b32 v190, v144
    v_add_f32 v190, v190, v144
    v_mov_b32 v145, v196
    s_nop 1
    v_permlane16_swap_b32 v196, v145
    v_add_f32 v196, v196, v145
    v_mov_b32 v144, v190
    s_nop 1
    v_permlane32_swap_b32 v190, v144
    v_add_f32 v190, v190, v144
    v_mov_b32 v145, v196
    s_nop 1
    v_permlane32_swap_b32 v196, v145
    v_add_f32 v196, v196, v145
    v_lshlrev_b32 v7, 2, v8
    s_lshl_b32 s25, s98, 10
    s_add_u32 s25, s25, 131072
    v_add_u32 v11, s25, v7
    ds_read_b32 v168, v11 offset:2048
    ds_read_b32 v170, v11
    s_lshl_b32 s18, s99, 7
    s_add_u32 s25, s18, 131072
    v_lshl_add_u32 v11, v0, 1, s25
    ds_read_u16 v125, v11 offset:2048
    ds_read_u16 v126, v11 offset:0
    ds_read_u16 v127, v11 offset:4096
    s_waitcnt lgkmcnt(2)
    v_lshlrev_b32 v125, 16, v125
    s_waitcnt lgkmcnt(1)
    v_lshlrev_b32 v126, 16, v126
    s_waitcnt lgkmcnt(0)
    v_lshlrev_b32 v127, 16, v127
    v_and_b32 v169, 0xffff0000, v168
    v_lshlrev_b32 v168, 16, v168
    v_and_b32 v171, 0xffff0000, v170
    v_lshlrev_b32 v170, 16, v170
    s_waitcnt vmcnt(1)
    v_lshlrev_b32 v24, 16, v128
    v_and_b32 v25, 0xffff0000, v128
    v_lshlrev_b32 v26, 16, v129
    v_and_b32 v27, 0xffff0000, v129
    v_lshlrev_b32 v28, 16, v130
    v_and_b32 v29, 0xffff0000, v130
    v_lshlrev_b32 v30, 16, v131
    v_and_b32 v31, 0xffff0000, v131
    s_waitcnt vmcnt(0)
    v_lshlrev_b32 v32, 16, v132
    v_and_b32 v33, 0xffff0000, v132
    v_lshlrev_b32 v34, 16, v133
    v_and_b32 v35, 0xffff0000, v133
    v_lshlrev_b32 v36, 16, v134
    v_and_b32 v37, 0xffff0000, v134
    v_lshlrev_b32 v38, 16, v135
    v_and_b32 v39, 0xffff0000, v135
    s_lshr_b32 s24, s16, 4
    s_lshl_b32 s24, s24, 15
    s_and_b32 s27, s16, 15
    s_lshl_b32 s27, s27, 6
    s_add_u32 s24, s24, s27
    s_add_u32 s24, s24, 0x2000000
    v_lshrrev_b32 v3, 2, v0
    v_lshlrev_b32 v3, 10, v3
    v_and_b32 v2, 3, v0
    v_lshl_add_u32 v3, v2, 4, v3
    v_and_b32 v11, 31, v0
    v_lshlrev_b32 v11, 2, v11
    s_lshl_b32 s22, s13, 3
    s_lshr_b32 s23, s12, 2
    s_add_u32 s22, s22, s23
    s_lshl_b32 s22, s22, 7
    s_add_u32 s22, s22, 0x550000
    s_mov_b32 s27, 0
fz_rp:
    buffer_load_dword v144, v11, s[8:11], s22 offen sc1
    s_waitcnt vmcnt(0)
    v_cmp_ne_u32 vcc, s14, v144
    s_add_u32 s27, s27, 1
    s_cmp_ge_u32 s27, 65536
    s_cbranch_scc1 fz_rg
    s_cbranch_vccz fz_rg
    s_sleep 1
    s_branch fz_rp
fz_rg:
    s_add_u32 s25, s24, 0x0
    buffer_load_dwordx4 v[40:43], v3, s[8:11], s25 offen sc1
    s_add_u32 s25, s24, 0x400000
    buffer_load_dwordx4 v[48:51], v3, s[8:11], s25 offen sc1
    s_add_u32 s25, s24, 0x800000
    buffer_load_dwordx4 v[56:59], v3, s[8:11], s25 offen sc1
    s_add_u32 s25, s24, 0xc00000
    buffer_load_dwordx4 v[64:67], v3, s[8:11], s25 offen sc1
    s_add_u32 s25, s24, 0x4000
    buffer_load_dwordx4 v[44:47], v3, s[8:11], s25 offen sc1
    s_add_u32 s25, s24, 0x404000
    buffer_load_dwordx4 v[52:55], v3, s[8:11], s25 offen sc1
    s_add_u32 s25, s24, 0x804000
    buffer_load_dwordx4 v[60:63], v3, s[8:11], s25 offen sc1
    s_add_u32 s25, s24, 0xc04000
    buffer_load_dwordx4 v[68:71], v3, s[8:11], s25 offen sc1
    s_waitcnt vmcnt(7)
    v_lshlrev_b32 v144, 16, v40
    v_and_b32 v145, 0xffff0000, v40
    s_waitcnt vmcnt(6)
    v_lshlrev_b32 v146, 16, v48
    v_and_b32 v147, 0xffff0000, v48
    v_pk_add_f32 v[144:145], v[144:145], v[146:147]
    s_waitcnt vmcnt(5)
    v_lshlrev_b32 v146, 16, v56
    v_and_b32 v147, 0xffff0000, v56
    v_pk_add_f32 v[144:145], v[144:145], v[146:147]
    s_waitcnt vmcnt(4)
    v_lshlrev_b32 v146, 16, v64
    v_and_b32 v147, 0xffff0000, v64
    v_pk_add_f32 v[144:145], v[144:145], v[146:147]
    v_pk_add_f32 v[24:25], v[24:25], v[144:145]
    v_cvt_pk_bf16_f32 v11, v24, v25
    v_lshlrev_b32 v24, 16, v11
    v_and_b32 v25, 0xffff0000, v11
    v_lshlrev_b32 v148, 16, v41
    v_and_b32 v149, 0xffff0000, v41
    v_lshlrev_b32 v150, 16, v49
    v_and_b32 v151, 0xffff0000, v49
    v_pk_add_f32 v[148:149], v[148:149], v[150:151]
    v_lshlrev_b32 v150, 16, v57
    v_and_b32 v151, 0xffff0000, v57
    v_pk_add_f32 v[148:149], v[148:149], v[150:151]
    v_lshlrev_b32 v150, 16, v65
    v_and_b32 v151, 0xffff0000, v65
    v_pk_add_f32 v[148:149], v[148:149], v[150:151]
    v_pk_add_f32 v[26:27], v[26:27], v[148:149]
    v_cvt_pk_bf16_f32 v12, v26, v27
    v_lshlrev_b32 v26, 16, v12
    v_and_b32 v27, 0xffff0000, v12
    v_lshlrev_b32 v144, 16, v42
    v_and_b32 v145, 0xffff0000, v42
    v_lshlrev_b32 v146, 16, v50
    v_and_b32 v147, 0xffff0000, v50
    v_pk_add_f32 v[144:145], v[144:145], v[146:147]
    v_lshlrev_b32 v146, 16, v58
    v_and_b32 v147, 0xffff0000, v58
    v_pk_add_f32 v[144:145], v[144:145], v[146:147]
    v_lshlrev_b32 v146, 16, v66
    v_and_b32 v147, 0xffff0000, v66
    v_pk_add_f32 v[144:145], v[144:145], v[146:147]
    v_pk_add_f32 v[28:29], v[28:29], v[144:145]
    v_cvt_pk_bf16_f32 v11, v28, v29
    v_lshlrev_b32 v28, 16, v11
    v_and_b32 v29, 0xffff0000, v11
    v_lshlrev_b32 v148, 16, v43
    v_and_b32 v149, 0xffff0000, v43
    v_lshlrev_b32 v150, 16, v51
    v_and_b32 v151, 0xffff0000, v51
    v_pk_add_f32 v[148:149], v[148:149], v[150:151]
    v_lshlrev_b32 v150, 16, v59
    v_and_b32 v151, 0xffff0000, v59
    v_pk_add_f32 v[148:149], v[148:149], v[150:151]
    v_lshlrev_b32 v150, 16, v67
    v_and_b32 v151, 0xffff0000, v67
    v_pk_add_f32 v[148:149], v[148:149], v[150:151]
    v_pk_add_f32 v[30:31], v[30:31], v[148:149]
    v_cvt_pk_bf16_f32 v12, v30, v31
    v_lshlrev_b32 v30, 16, v12
    v_and_b32 v31, 0xffff0000, v12
    s_waitcnt vmcnt(3)
    v_lshlrev_b32 v144, 16, v44
    v_and_b32 v145, 0xffff0000, v44
    s_waitcnt vmcnt(2)
    v_lshlrev_b32 v146, 16, v52
    v_and_b32 v147, 0xffff0000, v52
    v_pk_add_f32 v[144:145], v[144:145], v[146:147]
    s_waitcnt vmcnt(1)
    v_lshlrev_b32 v146, 16, v60
    v_and_b32 v147, 0xffff0000, v60
    v_pk_add_f32 v[144:145], v[144:145], v[146:147]
    s_waitcnt vmcnt(0)
    v_lshlrev_b32 v146, 16, v68
    v_and_b32 v147, 0xffff0000, v68
    v_pk_add_f32 v[144:145], v[144:145], v[146:147]
    v_pk_add_f32 v[32:33], v[32:33], v[144:145]
    v_cvt_pk_bf16_f32 v11, v32, v33
    v_lshlrev_b32 v32, 16, v11
    v_and_b32 v33, 0xffff0000, v11
    v_lshlrev_b32 v148, 16, v45
    v_and_b32 v149, 0xffff0000, v45
    v_lshlrev_b32 v150, 16, v53
    v_and_b32 v151, 0xffff0000, v53
    v_pk_add_f32 v[148:149], v[148:149], v[150:151]
    v_lshlrev_b32 v150, 16, v61
    v_and_b32 v151, 0xffff0000, v61
    v_pk_add_f32 v[148:149], v[148:149], v[150:151]
    v_lshlrev_b32 v150, 16, v69
    v_and_b32 v151, 0xffff0000, v69
    v_pk_add_f32 v[148:149], v[148:149], v[150:151]
    v_pk_add_f32 v[34:35], v[34:35], v[148:149]
    v_cvt_pk_bf16_f32 v12, v34, v35
    v_lshlrev_b32 v34, 16, v12
    v_and_b32 v35, 0xffff0000, v12
    v_lshlrev_b32 v144, 16, v46
    v_and_b32 v145, 0xffff0000, v46
    v_lshlrev_b32 v146, 16, v54
    v_and_b32 v147, 0xffff0000, v54
    v_pk_add_f32 v[144:145], v[144:145], v[146:147]
    v_lshlrev_b32 v146, 16, v62
    v_and_b32 v147, 0xffff0000, v62
    v_pk_add_f32 v[144:145], v[144:145], v[146:147]
    v_lshlrev_b32 v146, 16, v70
    v_and_b32 v147, 0xffff0000, v70
    v_pk_add_f32 v[144:145], v[144:145], v[146:147]
    v_pk_add_f32 v[36:37], v[36:37], v[144:145]
    v_cvt_pk_bf16_f32 v11, v36, v37
    v_lshlrev_b32 v36, 16, v11
    v_and_b32 v37, 0xffff0000, v11
    v_lshlrev_b32 v148, 16, v47
    v_and_b32 v149, 0xffff0000, v47
    v_lshlrev_b32 v150, 16, v55
    v_and_b32 v151, 0xffff0000, v55
    v_pk_add_f32 v[148:149], v[148:149], v[150:151]
    v_lshlrev_b32 v150, 16, v63
    v_and_b32 v151, 0xffff0000, v63
    v_pk_add_f32 v[148:149], v[148:149], v[150:151]
    v_lshlrev_b32 v150, 16, v71
    v_and_b32 v151, 0xffff0000, v71
    v_pk_add_f32 v[148:149], v[148:149], v[150:151]
    v_pk_add_f32 v[38:39], v[38:39], v[148:149]
    v_cvt_pk_bf16_f32 v12, v38, v39
    v_lshlrev_b32 v38, 16, v12
    v_and_b32 v39, 0xffff0000, v12
    v_readfirstlane_b32 s25, v24
    s_nop 1
    v_mov_b32 v188, s25
    v_pk_add_f32 v[40:41], v[24:25], v[188:189] op_sel_hi:[1,0] neg_lo:[0,1] neg_hi:[0,1]
    v_pk_add_f32 v[42:43], v[26:27], v[188:189] op_sel_hi:[1,0] neg_lo:[0,1] neg_hi:[0,1]
    v_pk_add_f32 v[44:45], v[28:29], v[188:189] op_sel_hi:[1,0] neg_lo:[0,1] neg_hi:[0,1]
    v_pk_add_f32 v[46:47], v[30:31], v[188:189] op_sel_hi:[1,0] neg_lo:[0,1] neg_hi:[0,1]
    v_pk_add_f32 v[48:49], v[32:33], v[188:189] op_sel_hi:[1,0] neg_lo:[0,1] neg_hi:[0,1]
    v_pk_add_f32 v[50:51], v[34:35], v[188:189] op_sel_hi:[1,0] neg_lo:[0,1] neg_hi:[0,1]
    v_pk_add_f32 v[52:53], v[36:37], v[188:189] op_sel_hi:[1,0] neg_lo:[0,1] neg_hi:[0,1]
    v_pk_add_f32 v[54:55], v[38:39], v[188:189] op_sel_hi:[1,0] neg_lo:[0,1] neg_hi:[0,1]
    v_pk_add_f32 v[148:149], v[40:41], v[42:43]
    v_pk_mul_f32 v[144:145], v[40:41], v[40:41]
    v_pk_mul_f32 v[146:147], v[40:41], v[104:105]
    v_pk_fma_f32 v[144:145], v[42:43], v[42:43], v[144:145]
    v_pk_fma_f32 v[146:147], v[42:43], v[106:107], v[146:147]
    v_pk_add_f32 v[148:149], v[148:149], v[44:45]
    v_pk_fma_f32 v[144:145], v[44:45], v[44:45], v[144:145]
    v_pk_fma_f32 v[146:147], v[44:45], v[108:109], v[146:147]
    v_pk_add_f32 v[148:149], v[148:149], v[46:47]
    v_pk_fma_f32 v[144:145], v[46:47], v[46:47], v[144:145]
    v_pk_fma_f32 v[146:147], v[46:47], v[110:111], v[146:147]
    v_pk_add_f32 v[148:149], v[148:149], v[48:49]
    v_pk_fma_f32 v[144:145], v[48:49], v[48:49], v[144:145]
    v_pk_fma_f32 v[146:147], v[48:49], v[112:113], v[146:147]
    v_pk_add_f32 v[148:149], v[148:149], v[50:51]
    v_pk_fma_f32 v[144:145], v[50:51], v[50:51], v[144:145]
    v_pk_fma_f32 v[146:147], v[50:51], v[114:115], v[146:147]
    v_pk_add_f32 v[148:149], v[148:149], v[52:53]
    v_pk_fma_f32 v[144:145], v[52:53], v[52:53], v[144:145]
    v_pk_fma_f32 v[146:147], v[52:53], v[116:117], v[146:147]
    v_pk_add_f32 v[148:149], v[148:149], v[54:55]
    v_pk_fma_f32 v[144:145], v[54:55], v[54:55], v[144:145]
    v_pk_fma_f32 v[146:147], v[54:55], v[118:119], v[146:147]
    v_add_f32 v192, v148, v149
    v_add_f32 v193, v144, v145
    v_add_f32 v194, v146, v147
    v_add_f32_dpp v192, v192, v192 row_ror:1 row_mask:0xf bank_mask:0xf
    v_add_f32_dpp v193, v193, v193 row_ror:1 row_mask:0xf bank_mask:0xf
    v_add_f32_dpp v194, v194, v194 row_ror:1 row_mask:0xf bank_mask:0xf
    v_add_f32_dpp v192, v192, v192 row_ror:2 row_mask:0xf bank_mask:0xf
    v_add_f32_dpp v193, v193, v193 row_ror:2 row_mask:0xf bank_mask:0xf
    v_add_f32_dpp v194, v194, v194 row_ror:2 row_mask:0xf bank_mask:0xf
    v_add_f32_dpp v192, v192, v192 row_ror:4 row_mask:0xf bank_mask:0xf
    v_add_f32_dpp v193, v193, v193 row_ror:4 row_mask:0xf bank_mask:0xf
    v_add_f32_dpp v194, v194, v194 row_ror:4 row_mask:0xf bank_mask:0xf
    v_add_f32_dpp v192, v192, v192 row_ror:8 row_mask:0xf bank_mask:0xf
    v_add_f32_dpp v193, v193, v193 row_ror:8 row_mask:0xf bank_mask:0xf
    v_add_f32_dpp v194, v194, v194 row_ror:8 row_mask:0xf bank_mask:0xf
    v_mov_b32 v144, v192
    s_nop 1
    v_permlane16_swap_b32 v192, v144
    v_add_f32 v192, v192, v144
    v_mov_b32 v145, v193
    s_nop 1
    v_permlane16_swap_b32 v193, v145
    v_add_f32 v193, v193, v145
    v_mov_b32 v146, v194
    s_nop 1
    v_permlane16_swap_b32 v194, v146
    v_add_f32 v194, v194, v146
    v_mov_b32 v144, v192
    s_nop 1
    v_permlane32_swap_b32 v192, v144
    v_add_f32 v192, v192, v144
    v_mov_b32 v145, v193
    s_nop 1
    v_permlane32_swap_b32 v193, v145
    v_add_f32 v193, v193, v145
    v_mov_b32 v146, v194
    s_nop 1
    v_permlane32_swap_b32 v194, v146
    v_add_f32 v194, v194, v146
    v_mul_f32 v192, 0x3a800000, v192
    v_mul_f32 v193, 0x3a800000, v193
    v_fma_f32 v193, -v192, v192, v193
    v_max_f32 v193, 0, v193
    v_fma_f32 v194, -v192, v196, v194
    v_add_f32 v192, s25, v192
    v_add_f32 v144, 0x3727c5ac, v193
    v_rsq_f32 v144, v144
    s_nop 0
    v_fma_f32 v23, v194, v144, v190
    v_cvt_pk_bf16_f32 v192, v192, v192
    v_lshlrev_b32 v192, 16, v192
    v_cvt_pk_bf16_f32 v193, v193, v193
    v_lshlrev_b32 v193, 16, v193
    v_add_f32 v193, 0x3727c5ac, v193
    v_cvt_pk_bf16_f32 v193, v193, v193
    v_lshlrev_b32 v193, 16, v193
    v_sqrt_f32 v194, v193
    s_nop 0
    v_cvt_pk_bf16_f32 v194, v194, v194
    v_lshlrev_b32 v194, 16, v194
    v_rcp_f32 v195, v194
    v_mov_b32 v21, v192
    v_mov_b32 v22, v194
    v_ashrrev_i32 v12, 31, v23
    v_or_b32 v12, 0x80000000, v12
    v_xor_b32 v20, v23, v12
    v_and_b32 v20, 0xfffff800, v20
    v_max_u32 v20, 0x800, v20
    s_sub_u32 s24, 2047, s16
    v_or_b32 v20, s24, v20
    v_lshlrev_b32 v11, 4, v16
    ds_write_b128 v11, v[20:23]
    s_waitcnt lgkmcnt(0)
    s_barrier
    s_cmp_lg_u32 s3, 0
    s_cbranch_scc1 fz_nk
    v_and_b32 v11, 7, v0
    v_lshlrev_b32 v11, 4, v11
    ds_read_b32 v144, v11 offset:0
    s_waitcnt lgkmcnt(0)
    v_mov_b32 v145, v144
    s_nop 1
    v_max_u32_dpp v145, v145, v145 row_ror:1 row_mask:0xf bank_mask:0xf
    s_nop 1
    v_max_u32_dpp v145, v145, v145 row_ror:2 row_mask:0xf bank_mask:0xf
    s_nop 1
    v_max_u32_dpp v145, v145, v145 row_ror:4 row_mask:0xf bank_mask:0xf
    v_cmp_eq_u32 vcc, v144, v145
    s_ff1_i32_b64 s26, vcc
    s_lshl_b32 s26, s26, 4
    v_mov_b32 v11, s26
    ds_read_b128 v[20:23], v11 offset:0
    s_lshl_b32 s24, s2, 4
    s_add_u32 s24, s24, 0xa70000
    s_mov_b64 exec, 1
    s_waitcnt lgkmcnt(0)
    buffer_store_dwordx4 v[20:23], v6, s[8:11], s24 offen sc1
    s_mov_b64 exec, -1
fz_nk:
    s_waitcnt lgkmcnt(0)
    v_lshlrev_b32 v2, 5, v14
    v_bfe_u32 v4, v0, 4, 2
    v_lshl_add_u32 v2, v4, 3, v2
    v_bfe_u32 v4, v17, 6, 2
    v_lshl_add_u32 v2, v4, 8, v2
    v_lshlrev_b32 v4, 2, v0
    s_cmp_lt_u32 s3, 4
    s_cbranch_scc1 fz_dn
    v_sub_f32 v40, v24, v192
    v_sub_f32 v41, v25, v192
    v_sub_f32 v42, v26, v192
    v_sub_f32 v43, v27, v192
    v_sub_f32 v44, v28, v192
    v_sub_f32 v45, v29, v192
    v_sub_f32 v46, v30, v192
    v_sub_f32 v47, v31, v192
    v_cvt_pk_bf16_f32 v12, v40, v41
    v_lshlrev_b32 v40, 16, v12
    v_and_b32 v41, 0xffff0000, v12
    v_cvt_pk_bf16_f32 v12, v42, v43
    v_lshlrev_b32 v42, 16, v12
    v_and_b32 v43, 0xffff0000, v12
    v_cvt_pk_bf16_f32 v12, v44, v45
    v_lshlrev_b32 v44, 16, v12
    v_and_b32 v45, 0xffff0000, v12
    v_cvt_pk_bf16_f32 v12, v46, v47
    v_lshlrev_b32 v46, 16, v12
    v_and_b32 v47, 0xffff0000, v12
    v_mul_f32 v40, v40, v195
    v_mul_f32 v41, v41, v195
    v_mul_f32 v42, v42, v195
    v_mul_f32 v43, v43, v195
    v_mul_f32 v44, v44, v195
    v_mul_f32 v45, v45, v195
    v_mul_f32 v46, v46, v195
    v_mul_f32 v47, v47, v195
    v_cvt_pk_bf16_f32 v12, v40, v41
    v_lshlrev_b32 v40, 16, v12
    v_and_b32 v41, 0xffff0000, v12
    v_cvt_pk_bf16_f32 v12, v42, v43
    v_lshlrev_b32 v42, 16, v12
    v_and_b32 v43, 0xffff0000, v12
    v_cvt_pk_bf16_f32 v12, v44, v45
    v_lshlrev_b32 v44, 16, v12
    v_and_b32 v45, 0xffff0000, v12
    v_cvt_pk_bf16_f32 v12, v46, v47
    v_lshlrev_b32 v46, 16, v12
    v_and_b32 v47, 0xffff0000, v12
    v_lshlrev_b32 v48, 16, v80
    v_and_b32 v49, 0xffff0000, v80
    v_lshlrev_b32 v50, 16, v81
    v_and_b32 v51, 0xffff0000, v81
    v_lshlrev_b32 v52, 16, v82
    v_and_b32 v53, 0xffff0000, v82
    v_lshlrev_b32 v54, 16, v83
    v_and_b32 v55, 0xffff0000, v83
    v_pk_mul_f32 v[40:41], v[40:41], v[48:49]
    v_pk_mul_f32 v[42:43], v[42:43], v[50:51]
    v_pk_mul_f32 v[44:45], v[44:45], v[52:53]
    v_pk_mul_f32 v[46:47], v[46:47], v[54:55]
    v_cvt_pk_bf16_f32 v12, v40, v41
    v_lshlrev_b32 v40, 16, v12
    v_and_b32 v41, 0xffff0000, v12
    v_cvt_pk_bf16_f32 v12, v42, v43
    v_lshlrev_b32 v42, 16, v12
    v_and_b32 v43, 0xffff0000, v12
    v_cvt_pk_bf16_f32 v12, v44, v45
    v_lshlrev_b32 v44, 16, v12
    v_and_b32 v45, 0xffff0000, v12
    v_cvt_pk_bf16_f32 v12, v46, v47
    v_lshlrev_b32 v46, 16, v12
    v_and_b32 v47, 0xffff0000, v12
    v_lshlrev_b32 v48, 16, v72
    v_and_b32 v49, 0xffff0000, v72
    v_lshlrev_b32 v50, 16, v73
    v_and_b32 v51, 0xffff0000, v73
    v_lshlrev_b32 v52, 16, v74
    v_and_b32 v53, 0xffff0000, v74
    v_lshlrev_b32 v54, 16, v75
    v_and_b32 v55, 0xffff0000, v75
    v_pk_add_f32 v[40:41], v[40:41], v[48:49]
    v_pk_add_f32 v[42:43], v[42:43], v[50:51]
    v_pk_add_f32 v[44:45], v[44:45], v[52:53]
    v_pk_add_f32 v[46:47], v[46:47], v[54:55]
    v_cvt_pk_bf16_f32 v12, v40, v41
    v_lshlrev_b32 v40, 16, v12
    v_and_b32 v41, 0xffff0000, v12
    v_cvt_pk_bf16_f32 v12, v42, v43
    v_lshlrev_b32 v42, 16, v12
    v_and_b32 v43, 0xffff0000, v12
    v_cvt_pk_bf16_f32 v12, v44, v45
    v_lshlrev_b32 v44, 16, v12
    v_and_b32 v45, 0xffff0000, v12
    v_cvt_pk_bf16_f32 v12, v46, v47
    v_lshlrev_b32 v46, 16, v12
    v_and_b32 v47, 0xffff0000, v12
    v_lshlrev_b32 v48, 16, v88
    v_and_b32 v49, 0xffff0000, v88
    v_lshlrev_b32 v50, 16, v89
    v_and_b32 v51, 0xffff0000, v89
    v_lshlrev_b32 v52, 16, v90
    v_and_b32 v53, 0xffff0000, v90
    v_lshlrev_b32 v54, 16, v91
    v_and_b32 v55, 0xffff0000, v91
    v_pk_mul_f32 v[40:41], v[40:41], v[48:49]
    v_pk_mul_f32 v[42:43], v[42:43], v[50:51]
    v_pk_mul_f32 v[44:45], v[44:45], v[52:53]
    v_pk_mul_f32 v[46:47], v[46:47], v[54:55]
    v_cvt_pk_bf16_f32 v12, v40, v41
    v_lshlrev_b32 v40, 16, v12
    v_and_b32 v41, 0xffff0000, v12
    v_cvt_pk_bf16_f32 v12, v42, v43
    v_lshlrev_b32 v42, 16, v12
    v_and_b32 v43, 0xffff0000, v12
    v_cvt_pk_bf16_f32 v12, v44, v45
    v_lshlrev_b32 v44, 16, v12
    v_and_b32 v45, 0xffff0000, v12
    v_cvt_pk_bf16_f32 v12, v46, v47
    v_lshlrev_b32 v46, 16, v12
    v_and_b32 v47, 0xffff0000, v12
    v_pk_add_f32 v[40:41], v[40:41], v[24:25]
    v_pk_add_f32 v[42:43], v[42:43], v[26:27]
    v_pk_add_f32 v[44:45], v[44:45], v[28:29]
    v_pk_add_f32 v[46:47], v[46:47], v[30:31]
    v_cvt_pk_bf16_f32 v56, v40, v41
    v_cvt_pk_bf16_f32 v57, v42, v43
    v_cvt_pk_bf16_f32 v58, v44, v45
    v_cvt_pk_bf16_f32 v59, v46, v47
    v_sub_f32 v40, v32, v192
    v_sub_f32 v41, v33, v192
    v_sub_f32 v42, v34, v192
    v_sub_f32 v43, v35, v192
    v_sub_f32 v44, v36, v192
    v_sub_f32 v45, v37, v192
    v_sub_f32 v46, v38, v192
    v_sub_f32 v47, v39, v192
    v_cvt_pk_bf16_f32 v12, v40, v41
    v_lshlrev_b32 v40, 16, v12
    v_and_b32 v41, 0xffff0000, v12
    v_cvt_pk_bf16_f32 v12, v42, v43
    v_lshlrev_b32 v42, 16, v12
    v_and_b32 v43, 0xffff0000, v12
    v_cvt_pk_bf16_f32 v12, v44, v45
    v_lshlrev_b32 v44, 16, v12
    v_and_b32 v45, 0xffff0000, v12
    v_cvt_pk_bf16_f32 v12, v46, v47
    v_lshlrev_b32 v46, 16, v12
    v_and_b32 v47, 0xffff0000, v12
    v_mul_f32 v40, v40, v195
    v_mul_f32 v41, v41, v195
    v_mul_f32 v42, v42, v195
    v_mul_f32 v43, v43, v195
    v_mul_f32 v44, v44, v195
    v_mul_f32 v45, v45, v195
    v_mul_f32 v46, v46, v195
    v_mul_f32 v47, v47, v195
    v_cvt_pk_bf16_f32 v12, v40, v41
    v_lshlrev_b32 v40, 16, v12
    v_and_b32 v41, 0xffff0000, v12
    v_cvt_pk_bf16_f32 v12, v42, v43
    v_lshlrev_b32 v42, 16, v12
    v_and_b32 v43, 0xffff0000, v12
    v_cvt_pk_bf16_f32 v12, v44, v45
    v_lshlrev_b32 v44, 16, v12
    v_and_b32 v45, 0xffff0000, v12
    v_cvt_pk_bf16_f32 v12, v46, v47
    v_lshlrev_b32 v46, 16, v12
    v_and_b32 v47, 0xffff0000, v12
    v_lshlrev_b32 v48, 16, v84
    v_and_b32 v49, 0xffff0000, v84
    v_lshlrev_b32 v50, 16, v85
    v_and_b32 v51, 0xffff0000, v85
    v_lshlrev_b32 v52, 16, v86
    v_and_b32 v53, 0xffff0000, v86
    v_lshlrev_b32 v54, 16, v87
    v_and_b32 v55, 0xffff0000, v87
    v_pk_mul_f32 v[40:41], v[40:41], v[48:49]
    v_pk_mul_f32 v[42:43], v[42:43], v[50:51]
    v_pk_mul_f32 v[44:45], v[44:45], v[52:53]
    v_pk_mul_f32 v[46:47], v[46:47], v[54:55]
    v_cvt_pk_bf16_f32 v12, v40, v41
    v_lshlrev_b32 v40, 16, v12
    v_and_b32 v41, 0xffff0000, v12
    v_cvt_pk_bf16_f32 v12, v42, v43
    v_lshlrev_b32 v42, 16, v12
    v_and_b32 v43, 0xffff0000, v12
    v_cvt_pk_bf16_f32 v12, v44, v45
    v_lshlrev_b32 v44, 16, v12
    v_and_b32 v45, 0xffff0000, v12
    v_cvt_pk_bf16_f32 v12, v46, v47
    v_lshlrev_b32 v46, 16, v12
    v_and_b32 v47, 0xffff0000, v12
    v_lshlrev_b32 v48, 16, v76
    v_and_b32 v49, 0xffff0000, v76
    v_lshlrev_b32 v50, 16, v77
    v_and_b32 v51, 0xffff0000, v77
    v_lshlrev_b32 v52, 16, v78
    v_and_b32 v53, 0xffff0000, v78
    v_lshlrev_b32 v54, 16, v79
    v_and_b32 v55, 0xffff0000, v79
    v_pk_add_f32 v[40:41], v[40:41], v[48:49]
    v_pk_add_f32 v[42:43], v[42:43], v[50:51]
    v_pk_add_f32 v[44:45], v[44:45], v[52:53]
    v_pk_add_f32 v[46:47], v[46:47], v[54:55]
    v_cvt_pk_bf16_f32 v12, v40, v41
    v_lshlrev_b32 v40, 16, v12
    v_and_b32 v41, 0xffff0000, v12
    v_cvt_pk_bf16_f32 v12, v42, v43
    v_lshlrev_b32 v42, 16, v12
    v_and_b32 v43, 0xffff0000, v12
    v_cvt_pk_bf16_f32 v12, v44, v45
    v_lshlrev_b32 v44, 16, v12
    v_and_b32 v45, 0xffff0000, v12
    v_cvt_pk_bf16_f32 v12, v46, v47
    v_lshlrev_b32 v46, 16, v12
    v_and_b32 v47, 0xffff0000, v12
    v_lshlrev_b32 v48, 16, v92
    v_and_b32 v49, 0xffff0000, v92
    v_lshlrev_b32 v50, 16, v93
    v_and_b32 v51, 0xffff0000, v93
    v_lshlrev_b32 v52, 16, v94
    v_and_b32 v53, 0xffff0000, v94
    v_lshlrev_b32 v54, 16, v95
    v_and_b32 v55, 0xffff0000, v95
    v_pk_mul_f32 v[40:41], v[40:41], v[48:49]
    v_pk_mul_f32 v[42:43], v[42:43], v[50:51]
    v_pk_mul_f32 v[44:45], v[44:45], v[52:53]
    v_pk_mul_f32 v[46:47], v[46:47], v[54:55]
    v_cvt_pk_bf16_f32 v12, v40, v41
    v_lshlrev_b32 v40, 16, v12
    v_and_b32 v41, 0xffff0000, v12
    v_cvt_pk_bf16_f32 v12, v42, v43
    v_lshlrev_b32 v42, 16, v12
    v_and_b32 v43, 0xffff0000, v12
    v_cvt_pk_bf16_f32 v12, v44, v45
    v_lshlrev_b32 v44, 16, v12
    v_and_b32 v45, 0xffff0000, v12
    v_cvt_pk_bf16_f32 v12, v46, v47
    v_lshlrev_b32 v46, 16, v12
    v_and_b32 v47, 0xffff0000, v12
    v_pk_add_f32 v[40:41], v[40:41], v[32:33]
    v_pk_add_f32 v[42:43], v[42:43], v[34:35]
    v_pk_add_f32 v[44:45], v[44:45], v[36:37]
    v_pk_add_f32 v[46:47], v[46:47], v[38:39]
    v_cvt_pk_bf16_f32 v60, v40, v41
    v_cvt_pk_bf16_f32 v61, v42, v43
    v_cvt_pk_bf16_f32 v62, v44, v45
    v_cvt_pk_bf16_f32 v63, v46, v47
    v_lshrrev_b32 v15, 6, v7
    v_lshlrev_b32 v15, 10, v15
    v_and_b32 v11, 63, v7
    v_add_u32 v15, v15, v11
    v_lshlrev_b32 v11, 2, v7
    s_mov_b32 s26, 0xa70000
    s_mov_b32 s27, 0
fz_wp:
    buffer_load_dwordx4 v[20:23], v11, s[8:11], s26 offen sc1
    s_waitcnt vmcnt(0)
    v_cmp_eq_u32 vcc, 0, v20
    s_add_u32 s27, s27, 1
    s_cmp_ge_u32 s27, 65536
    s_cbranch_scc1 fz_wg
    s_cbranch_vccz fz_wg
    s_sleep 1
    s_branch fz_wp
fz_wg:
    v_mov_b32 v144, v20
    s_nop 1
    v_max_u32_dpp v144, v144, v144 row_ror:1 row_mask:0xf bank_mask:0xf
    s_nop 1
    v_max_u32_dpp v144, v144, v144 row_ror:2 row_mask:0xf bank_mask:0xf
    s_nop 1
    v_max_u32_dpp v144, v144, v144 row_ror:4 row_mask:0xf bank_mask:0xf
    s_nop 1
    v_max_u32_dpp v144, v144, v144 row_ror:8 row_mask:0xf bank_mask:0xf
    v_mov_b32 v145, v144
    s_nop 1
    v_permlane16_swap_b32 v144, v145
    v_max_u32 v144, v144, v145
    v_mov_b32 v145, v144
    s_nop 1
    v_permlane32_swap_b32 v144, v145
    v_max_u32 v144, v144, v145
    v_cmp_eq_u32 vcc, v144, v20
    v_lshlrev_b32 v11, 4, v16
    s_and_saveexec_b64 s[26:27], vcc
    ds_write_b128 v11, v[20:23] offset:192
    s_mov_b64 exec, s[26:27]
    s_waitcnt lgkmcnt(0)
    s_barrier
    v_and_b32 v11, 3, v0
    v_lshlrev_b32 v11, 4, v11
    ds_read_b32 v144, v11 offset:256
    s_waitcnt lgkmcnt(0)
    v_mov_b32 v145, v144
    s_nop 1
    v_max_u32_dpp v145, v145, v145 row_ror:1 row_mask:0xf bank_mask:0xf
    s_nop 1
    v_max_u32_dpp v145, v145, v145 row_ror:2 row_mask:0xf bank_mask:0xf
    v_cmp_eq_u32 vcc, v144, v145
    s_ff1_i32_b64 s26, vcc
    s_lshl_b32 s26, s26, 4
    v_mov_b32 v11, s26
    ds_read_b128 v[20:23], v11 offset:256
    s_waitcnt lgkmcnt(0)
    v_and_b32 v144, 0x7ff, v20
    v_sub_u32 v144, 2047, v144
    s_nop 0
    v_readfirstlane_b32 s101, v144
    s_lshl_b32 s62, s101, 11
    v_rcp_f32 v167, v22
    s_cmp_lg_u32 s101, s16
    s_cselect_b32 s23, s17, 0x7ffffff0
    s_lshl_b32 s24, s98, 10
    s_add_u32 s24, s62, s24
    s_lshr_b32 s25, s101, 4
    s_lshl_b32 s25, s25, 15
    s_and_b32 s27, s101, 15
    s_lshl_b32 s27, s27, 6
    s_add_u32 s25, s25, s27
    s_add_u32 s25, s25, 0x2000000
    s_lshl_b32 s26, s98, 14
    s_add_u32 s25, s25, s26
    s_add_u32 s26, s25, 0x0
    buffer_load_dword v40, v15, s[8:11], s26 offen sc1
    s_add_u32 s26, s25, 0x400000
    buffer_load_dword v41, v15, s[8:11], s26 offen sc1
    s_add_u32 s26, s25, 0x800000
    buffer_load_dword v42, v15, s[8:11], s26 offen sc1
    s_add_u32 s26, s25, 0xc00000
    buffer_load_dword v43, v15, s[8:11], s26 offen sc1
    buffer_load_dword v166, v7, s[28:31], s24 offen
    s_waitcnt vmcnt(4)
    v_lshlrev_b32 v144, 16, v40
    v_and_b32 v145, 0xffff0000, v40
    s_waitcnt vmcnt(3)
    v_lshlrev_b32 v146, 16, v41
    v_and_b32 v147, 0xffff0000, v41
    v_pk_add_f32 v[128:129], v[144:145], v[146:147]
    s_waitcnt vmcnt(2)
    v_lshlrev_b32 v144, 16, v42
    v_and_b32 v145, 0xffff0000, v42
    v_pk_add_f32 v[128:129], v[144:145], v[128:129]
    s_waitcnt vmcnt(1)
    v_lshlrev_b32 v144, 16, v43
    v_and_b32 v145, 0xffff0000, v43
    v_pk_add_f32 v[128:129], v[144:145], v[128:129]
    s_waitcnt vmcnt(0)
    v_lshlrev_b32 v144, 16, v166
    v_and_b32 v145, 0xffff0000, v166
    v_pk_add_f32 v[128:129], v[144:145], v[128:129]
    v_cvt_pk_bf16_f32 v144, v128, v129
    v_lshlrev_b32 v128, 16, v144
    v_and_b32 v129, 0xffff0000, v144
    v_sub_f32 v128, v128, v21
    v_sub_f32 v129, v129, v21
    v_cvt_pk_bf16_f32 v144, v128, v129
    v_lshlrev_b32 v128, 16, v144
    v_and_b32 v129, 0xffff0000, v144
    v_mul_f32 v145, v128, v167
    v_fma_f32 v128, -v145, v22, v128
    v_fma_f32 v128, v128, v167, v145
    v_mul_f32 v145, v129, v167
    v_fma_f32 v129, -v145, v22, v129
    v_fma_f32 v129, v129, v167, v145
    v_cvt_pk_bf16_f32 v144, v128, v129
    v_lshlrev_b32 v128, 16, v144
    v_and_b32 v129, 0xffff0000, v144
    v_mul_f32 v128, v128, v168
    v_mul_f32 v129, v129, v169
    v_cvt_pk_bf16_f32 v144, v128, v129
    v_lshlrev_b32 v128, 16, v144
    v_and_b32 v129, 0xffff0000, v144
    v_add_f32 v128, v128, v170
    v_add_f32 v129, v129, v171
    v_cvt_pk_bf16_f32 v144, v128, v129
    v_lshlrev_b32 v128, 16, v144
    v_and_b32 v129, 0xffff0000, v144
    v_lshlrev_b32 v11, 1, v7
    ds_write_b64 v11, v[128:129] offset:512
    v_lshlrev_b32 v11, 6, v13
    s_waitcnt lgkmcnt(0)
    ds_read_b128 v[128:131], v11 offset:512
    ds_read_b128 v[132:135], v11 offset:528
    ds_read_b128 v[136:139], v11 offset:544
    ds_read_b128 v[140:143], v11 offset:560
    s_lshl_b32 s26, s97, 1
    s_add_u32 s26, s26, s98
    s_mul_i32 s26, s26, 14336
    s_lshl_b32 s25, s96, 8
    s_add_u32 s26, s26, s25
    s_add_u32 s26, s26, 0xa10000
    s_cmp_lt_u32 s2, 224
    s_cselect_b32 s26, s26, 0x7ffffff0
    s_cmp_eq_u32 s3, 4
    s_cselect_b32 s26, s26, 0x7ffffff0
    s_mov_b32 s25, s26
    s_waitcnt lgkmcnt(3)
    v_lshrrev_b32 v144, 16, v128
    v_dot2_f32_bf16 v157, v204, v128, 0
    v_dot2_f32_bf16 v156, v204, v144, 0
    v_dot2_f32_bf16 v159, v205, v128, 0
    v_dot2_f32_bf16 v158, v205, v144, 0
    v_dot2_f32_bf16 v161, v206, v128, 0
    v_dot2_f32_bf16 v160, v206, v144, 0
    v_dot2_f32_bf16 v163, v207, v128, 0
    v_dot2_f32_bf16 v162, v207, v144, 0
    v_lshrrev_b32 v145, 16, v129
    v_dot2c_f32_bf16 v157, v208, v129
    v_dot2c_f32_bf16 v156, v208, v145
    v_dot2c_f32_bf16 v159, v209, v129
    v_dot2c_f32_bf16 v158, v209, v145
    v_dot2c_f32_bf16 v161, v210, v129
    v_dot2c_f32_bf16 v160, v210, v145
    v_dot2c_f32_bf16 v163, v211, v129
    v_dot2c_f32_bf16 v162, v211, v145
    v_lshrrev_b32 v146, 16, v130
    v_dot2c_f32_bf16 v157, v212, v130
    v_dot2c_f32_bf16 v156, v212, v146
    v_dot2c_f32_bf16 v159, v213, v130
    v_dot2c_f32_bf16 v158, v213, v146
    v_dot2c_f32_bf16 v161, v214, v130
    v_dot2c_f32_bf16 v160, v214, v146
    v_dot2c_f32_bf16 v163, v215, v130
    v_dot2c_f32_bf16 v162, v215, v146
    v_lshrrev_b32 v147, 16, v131
    v_dot2c_f32_bf16 v157, v216, v131
    v_dot2c_f32_bf16 v156, v216, v147
    v_dot2c_f32_bf16 v159, v217, v131
    v_dot2c_f32_bf16 v158, v217, v147
    v_dot2c_f32_bf16 v161, v218, v131
    v_dot2c_f32_bf16 v160, v218, v147
    v_dot2c_f32_bf16 v163, v219, v131
    v_dot2c_f32_bf16 v162, v219, v147
    s_waitcnt lgkmcnt(2)
    v_lshrrev_b32 v148, 16, v132
    v_dot2c_f32_bf16 v157, v220, v132
    v_dot2c_f32_bf16 v156, v220, v148
    v_dot2c_f32_bf16 v159, v221, v132
    v_dot2c_f32_bf16 v158, v221, v148
    v_dot2c_f32_bf16 v161, v222, v132
    v_dot2c_f32_bf16 v160, v222, v148
    v_dot2c_f32_bf16 v163, v223, v132
    v_dot2c_f32_bf16 v162, v223, v148
    v_lshrrev_b32 v149, 16, v133
    v_dot2c_f32_bf16 v157, v224, v133
    v_dot2c_f32_bf16 v156, v224, v149
    v_dot2c_f32_bf16 v159, v225, v133
    v_dot2c_f32_bf16 v158, v225, v149
    v_dot2c_f32_bf16 v161, v226, v133
    v_dot2c_f32_bf16 v160, v226, v149
    v_dot2c_f32_bf16 v163, v227, v133
    v_dot2c_f32_bf16 v162, v227, v149
    v_lshrrev_b32 v150, 16, v134
    v_dot2c_f32_bf16 v157, v228, v134
    v_dot2c_f32_bf16 v156, v228, v150
    v_dot2c_f32_bf16 v159, v229, v134
    v_dot2c_f32_bf16 v158, v229, v150
    v_dot2c_f32_bf16 v161, v230, v134
    v_dot2c_f32_bf16 v160, v230, v150
    v_dot2c_f32_bf16 v163, v231, v134
    v_dot2c_f32_bf16 v162, v231, v150
    v_lshrrev_b32 v151, 16, v135
    v_dot2c_f32_bf16 v157, v232, v135
    v_dot2c_f32_bf16 v156, v232, v151
    v_dot2c_f32_bf16 v159, v233, v135
    v_dot2c_f32_bf16 v158, v233, v151
    v_dot2c_f32_bf16 v161, v234, v135
    v_dot2c_f32_bf16 v160, v234, v151
    v_dot2c_f32_bf16 v163, v235, v135
    v_dot2c_f32_bf16 v162, v235, v151
    s_waitcnt lgkmcnt(1)
    v_lshrrev_b32 v144, 16, v136
    v_dot2c_f32_bf16 v157, v236, v136
    v_dot2c_f32_bf16 v156, v236, v144
    v_dot2c_f32_bf16 v159, v237, v136
    v_dot2c_f32_bf16 v158, v237, v144
    v_dot2c_f32_bf16 v161, v238, v136
    v_dot2c_f32_bf16 v160, v238, v144
    v_dot2c_f32_bf16 v163, v239, v136
    v_dot2c_f32_bf16 v162, v239, v144
    v_lshrrev_b32 v145, 16, v137
    v_dot2c_f32_bf16 v157, v240, v137
    v_dot2c_f32_bf16 v156, v240, v145
    v_dot2c_f32_bf16 v159, v241, v137
    v_dot2c_f32_bf16 v158, v241, v145
    v_dot2c_f32_bf16 v161, v242, v137
    v_dot2c_f32_bf16 v160, v242, v145
    v_dot2c_f32_bf16 v163, v243, v137
    v_dot2c_f32_bf16 v162, v243, v145
    v_lshrrev_b32 v146, 16, v138
    v_dot2c_f32_bf16 v157, v244, v138
    v_dot2c_f32_bf16 v156, v244, v146
    v_dot2c_f32_bf16 v159, v245, v138
    v_dot2c_f32_bf16 v158, v245, v146
    v_dot2c_f32_bf16 v161, v246, v138
    v_dot2c_f32_bf16 v160, v246, v146
    v_dot2c_f32_bf16 v163, v247, v138
    v_dot2c_f32_bf16 v162, v247, v146
    v_lshrrev_b32 v147, 16, v139
    v_dot2c_f32_bf16 v157, v248, v139
    v_dot2c_f32_bf16 v156, v248, v147
    v_dot2c_f32_bf16 v159, v249, v139
    v_dot2c_f32_bf16 v158, v249, v147
    v_dot2c_f32_bf16 v161, v250, v139
    v_dot2c_f32_bf16 v160, v250, v147
    v_dot2c_f32_bf16 v163, v251, v139
    v_dot2c_f32_bf16 v162, v251, v147
    s_waitcnt lgkmcnt(0)
    v_lshrrev_b32 v148, 16, v140
    v_dot2c_f32_bf16 v157, v252, v140
    v_dot2c_f32_bf16 v156, v252, v148
    v_dot2c_f32_bf16 v159, v253, v140
    v_dot2c_f32_bf16 v158, v253, v148
    v_dot2c_f32_bf16 v161, v254, v140
    v_dot2c_f32_bf16 v160, v254, v148
    v_dot2c_f32_bf16 v163, v255, v140
    v_dot2c_f32_bf16 v162, v255, v148
    v_lshrrev_b32 v149, 16, v141
    v_dot2c_f32_bf16 v157, v180, v141
    v_dot2c_f32_bf16 v156, v180, v149
    v_dot2c_f32_bf16 v159, v181, v141
    v_dot2c_f32_bf16 v158, v181, v149
    v_dot2c_f32_bf16 v161, v182, v141
    v_dot2c_f32_bf16 v160, v182, v149
    v_dot2c_f32_bf16 v163, v183, v141
    v_dot2c_f32_bf16 v162, v183, v149
    v_lshrrev_b32 v150, 16, v142
    v_dot2c_f32_bf16 v157, v184, v142
    v_dot2c_f32_bf16 v156, v184, v150
    v_dot2c_f32_bf16 v159, v185, v142
    v_dot2c_f32_bf16 v158, v185, v150
    v_dot2c_f32_bf16 v161, v186, v142
    v_dot2c_f32_bf16 v160, v186, v150
    v_dot2c_f32_bf16 v163, v187, v142
    v_dot2c_f32_bf16 v162, v187, v150
    v_lshrrev_b32 v151, 16, v143
    v_dot2c_f32_bf16 v157, v172, v143
    v_dot2c_f32_bf16 v156, v172, v151
    v_dot2c_f32_bf16 v159, v173, v143
    v_dot2c_f32_bf16 v158, v173, v151
    v_dot2c_f32_bf16 v161, v174, v143
    v_dot2c_f32_bf16 v160, v174, v151
    v_dot2c_f32_bf16 v163, v175, v143
    v_dot2c_f32_bf16 v162, v175, v151
    s_nop 0
    v_permlane32_swap_b32 v156, v160
    v_permlane32_swap_b32 v157, v161
    v_permlane32_swap_b32 v158, v162
    v_permlane32_swap_b32 v159, v163
    v_add_f32 v156, v156, v160
    v_add_f32 v157, v157, v161
    v_add_f32 v158, v158, v162
    v_add_f32 v159, v159, v163
    s_nop 0
    v_permlane16_swap_b32 v156, v158
    v_permlane16_swap_b32 v157, v159
    v_add_f32 v156, v156, v158
    v_add_f32 v157, v157, v159
    s_nop 0
    v_add_f32_dpp v156, v156, v156 row_ror:8 row_mask:0xf bank_mask:0xf
    v_add_f32_dpp v157, v157, v157 row_ror:8 row_mask:0xf bank_mask:0xf
    ds_write_b64 v2, v[156:157] offset:4096
    s_waitcnt lgkmcnt(0)
    s_barrier
    ds_read_b32 v156, v4 offset:4096
    ds_read_b32 v157, v4 offset:4352
    ds_read_b32 v158, v4 offset:4608
    ds_read_b32 v159, v4 offset:4864
    s_waitcnt lgkmcnt(1)
    v_add_f32 v156, v156, v158
    s_waitcnt lgkmcnt(0)
    v_add_f32 v157, v157, v159
    v_add_f32 v156, v156, v157
    v_or_b32 v156, 1, v156
    buffer_store_dword v156, v4, s[8:11], s25 offen sc1
    s_cmp_lg_u32 s101, s16
    s_cselect_b32 s23, s17, 0x7ffffff0
    buffer_store_dwordx4 v[56:59], v1, s[64:67], s23 offen offset:0 sc1
    buffer_store_dwordx4 v[60:63], v1, s[64:67], s23 offen offset:1024 sc1
    s_branch fz_end
fz_dn:
    v_sub_f32 v40, v24, v192
    v_sub_f32 v41, v25, v192
    v_sub_f32 v42, v26, v192
    v_sub_f32 v43, v27, v192
    v_sub_f32 v44, v28, v192
    v_sub_f32 v45, v29, v192
    v_sub_f32 v46, v30, v192
    v_sub_f32 v47, v31, v192
    v_cvt_pk_bf16_f32 v12, v40, v41
    v_lshlrev_b32 v40, 16, v12
    v_and_b32 v41, 0xffff0000, v12
    v_cvt_pk_bf16_f32 v12, v42, v43
    v_lshlrev_b32 v42, 16, v12
    v_and_b32 v43, 0xffff0000, v12
    v_cvt_pk_bf16_f32 v12, v44, v45
    v_lshlrev_b32 v44, 16, v12
    v_and_b32 v45, 0xffff0000, v12
    v_cvt_pk_bf16_f32 v12, v46, v47
    v_lshlrev_b32 v46, 16, v12
    v_and_b32 v47, 0xffff0000, v12
    v_mul_f32 v40, v40, v195
    v_mul_f32 v41, v41, v195
    v_mul_f32 v42, v42, v195
    v_mul_f32 v43, v43, v195
    v_mul_f32 v44, v44, v195
    v_mul_f32 v45, v45, v195
    v_mul_f32 v46, v46, v195
    v_mul_f32 v47, v47, v195
    v_cvt_pk_bf16_f32 v12, v40, v41
    v_lshlrev_b32 v40, 16, v12
    v_and_b32 v41, 0xffff0000, v12
    v_cvt_pk_bf16_f32 v12, v42, v43
    v_lshlrev_b32 v42, 16, v12
    v_and_b32 v43, 0xffff0000, v12
    v_cvt_pk_bf16_f32 v12, v44, v45
    v_lshlrev_b32 v44, 16, v12
    v_and_b32 v45, 0xffff0000, v12
    v_cvt_pk_bf16_f32 v12, v46, v47
    v_lshlrev_b32 v46, 16, v12
    v_and_b32 v47, 0xffff0000, v12
    v_lshlrev_b32 v48, 16, v80
    v_and_b32 v49, 0xffff0000, v80
    v_lshlrev_b32 v50, 16, v81
    v_and_b32 v51, 0xffff0000, v81
    v_lshlrev_b32 v52, 16, v82
    v_and_b32 v53, 0xffff0000, v82
    v_lshlrev_b32 v54, 16, v83
    v_and_b32 v55, 0xffff0000, v83
    v_pk_mul_f32 v[40:41], v[40:41], v[48:49]
    v_pk_mul_f32 v[42:43], v[42:43], v[50:51]
    v_pk_mul_f32 v[44:45], v[44:45], v[52:53]
    v_pk_mul_f32 v[46:47], v[46:47], v[54:55]
    v_cvt_pk_bf16_f32 v12, v40, v41
    v_lshlrev_b32 v40, 16, v12
    v_and_b32 v41, 0xffff0000, v12
    v_cvt_pk_bf16_f32 v12, v42, v43
    v_lshlrev_b32 v42, 16, v12
    v_and_b32 v43, 0xffff0000, v12
    v_cvt_pk_bf16_f32 v12, v44, v45
    v_lshlrev_b32 v44, 16, v12
    v_and_b32 v45, 0xffff0000, v12
    v_cvt_pk_bf16_f32 v12, v46, v47
    v_lshlrev_b32 v46, 16, v12
    v_and_b32 v47, 0xffff0000, v12
    v_lshlrev_b32 v48, 16, v72
    v_and_b32 v49, 0xffff0000, v72
    v_lshlrev_b32 v50, 16, v73
    v_and_b32 v51, 0xffff0000, v73
    v_lshlrev_b32 v52, 16, v74
    v_and_b32 v53, 0xffff0000, v74
    v_lshlrev_b32 v54, 16, v75
    v_and_b32 v55, 0xffff0000, v75
    v_pk_add_f32 v[40:41], v[40:41], v[48:49]
    v_pk_add_f32 v[42:43], v[42:43], v[50:51]
    v_pk_add_f32 v[44:45], v[44:45], v[52:53]
    v_pk_add_f32 v[46:47], v[46:47], v[54:55]
    v_cvt_pk_bf16_f32 v12, v40, v41
    v_lshlrev_b32 v40, 16, v12
    v_and_b32 v41, 0xffff0000, v12
    v_cvt_pk_bf16_f32 v12, v42, v43
    v_lshlrev_b32 v42, 16, v12
    v_and_b32 v43, 0xffff0000, v12
    v_cvt_pk_bf16_f32 v12, v44, v45
    v_lshlrev_b32 v44, 16, v12
    v_and_b32 v45, 0xffff0000, v12
    v_cvt_pk_bf16_f32 v12, v46, v47
    v_lshlrev_b32 v46, 16, v12
    v_and_b32 v47, 0xffff0000, v12
    v_lshlrev_b32 v48, 16, v88
    v_and_b32 v49, 0xffff0000, v88
    v_lshlrev_b32 v50, 16, v89
    v_and_b32 v51, 0xffff0000, v89
    v_lshlrev_b32 v52, 16, v90
    v_and_b32 v53, 0xffff0000, v90
    v_lshlrev_b32 v54, 16, v91
    v_and_b32 v55, 0xffff0000, v91
    v_pk_mul_f32 v[40:41], v[40:41], v[48:49]
    v_pk_mul_f32 v[42:43], v[42:43], v[50:51]
    v_pk_mul_f32 v[44:45], v[44:45], v[52:53]
    v_pk_mul_f32 v[46:47], v[46:47], v[54:55]
    v_cvt_pk_bf16_f32 v12, v40, v41
    v_lshlrev_b32 v40, 16, v12
    v_and_b32 v41, 0xffff0000, v12
    v_cvt_pk_bf16_f32 v12, v42, v43
    v_lshlrev_b32 v42, 16, v12
    v_and_b32 v43, 0xffff0000, v12
    v_cvt_pk_bf16_f32 v12, v44, v45
    v_lshlrev_b32 v44, 16, v12
    v_and_b32 v45, 0xffff0000, v12
    v_cvt_pk_bf16_f32 v12, v46, v47
    v_lshlrev_b32 v46, 16, v12
    v_and_b32 v47, 0xffff0000, v12
    v_pk_add_f32 v[40:41], v[40:41], v[24:25]
    v_pk_add_f32 v[42:43], v[42:43], v[26:27]
    v_pk_add_f32 v[44:45], v[44:45], v[28:29]
    v_pk_add_f32 v[46:47], v[46:47], v[30:31]
    v_cvt_pk_bf16_f32 v56, v40, v41
    v_cvt_pk_bf16_f32 v57, v42, v43
    v_cvt_pk_bf16_f32 v58, v44, v45
    v_cvt_pk_bf16_f32 v59, v46, v47
    v_sub_f32 v40, v32, v192
    v_sub_f32 v41, v33, v192
    v_sub_f32 v42, v34, v192
    v_sub_f32 v43, v35, v192
    v_sub_f32 v44, v36, v192
    v_sub_f32 v45, v37, v192
    v_sub_f32 v46, v38, v192
    v_sub_f32 v47, v39, v192
    v_cvt_pk_bf16_f32 v12, v40, v41
    v_lshlrev_b32 v40, 16, v12
    v_and_b32 v41, 0xffff0000, v12
    v_cvt_pk_bf16_f32 v12, v42, v43
    v_lshlrev_b32 v42, 16, v12
    v_and_b32 v43, 0xffff0000, v12
    v_cvt_pk_bf16_f32 v12, v44, v45
    v_lshlrev_b32 v44, 16, v12
    v_and_b32 v45, 0xffff0000, v12
    v_cvt_pk_bf16_f32 v12, v46, v47
    v_lshlrev_b32 v46, 16, v12
    v_and_b32 v47, 0xffff0000, v12
    v_mul_f32 v40, v40, v195
    v_mul_f32 v41, v41, v195
    v_mul_f32 v42, v42, v195
    v_mul_f32 v43, v43, v195
    v_mul_f32 v44, v44, v195
    v_mul_f32 v45, v45, v195
    v_mul_f32 v46, v46, v195
    v_mul_f32 v47, v47, v195
    v_cvt_pk_bf16_f32 v12, v40, v41
    v_lshlrev_b32 v40, 16, v12
    v_and_b32 v41, 0xffff0000, v12
    v_cvt_pk_bf16_f32 v12, v42, v43
    v_lshlrev_b32 v42, 16, v12
    v_and_b32 v43, 0xffff0000, v12
    v_cvt_pk_bf16_f32 v12, v44, v45
    v_lshlrev_b32 v44, 16, v12
    v_and_b32 v45, 0xffff0000, v12
    v_cvt_pk_bf16_f32 v12, v46, v47
    v_lshlrev_b32 v46, 16, v12
    v_and_b32 v47, 0xffff0000, v12
    v_lshlrev_b32 v48, 16, v84
    v_and_b32 v49, 0xffff0000, v84
    v_lshlrev_b32 v50, 16, v85
    v_and_b32 v51, 0xffff0000, v85
    v_lshlrev_b32 v52, 16, v86
    v_and_b32 v53, 0xffff0000, v86
    v_lshlrev_b32 v54, 16, v87
    v_and_b32 v55, 0xffff0000, v87
    v_pk_mul_f32 v[40:41], v[40:41], v[48:49]
    v_pk_mul_f32 v[42:43], v[42:43], v[50:51]
    v_pk_mul_f32 v[44:45], v[44:45], v[52:53]
    v_pk_mul_f32 v[46:47], v[46:47], v[54:55]
    v_cvt_pk_bf16_f32 v12, v40, v41
    v_lshlrev_b32 v40, 16, v12
    v_and_b32 v41, 0xffff0000, v12
    v_cvt_pk_bf16_f32 v12, v42, v43
    v_lshlrev_b32 v42, 16, v12
    v_and_b32 v43, 0xffff0000, v12
    v_cvt_pk_bf16_f32 v12, v44, v45
    v_lshlrev_b32 v44, 16, v12
    v_and_b32 v45, 0xffff0000, v12
    v_cvt_pk_bf16_f32 v12, v46, v47
    v_lshlrev_b32 v46, 16, v12
    v_and_b32 v47, 0xffff0000, v12
    v_lshlrev_b32 v48, 16, v76
    v_and_b32 v49, 0xffff0000, v76
    v_lshlrev_b32 v50, 16, v77
    v_and_b32 v51, 0xffff0000, v77
    v_lshlrev_b32 v52, 16, v78
    v_and_b32 v53, 0xffff0000, v78
    v_lshlrev_b32 v54, 16, v79
    v_and_b32 v55, 0xffff0000, v79
    v_pk_add_f32 v[40:41], v[40:41], v[48:49]
    v_pk_add_f32 v[42:43], v[42:43], v[50:51]
    v_pk_add_f32 v[44:45], v[44:45], v[52:53]
    v_pk_add_f32 v[46:47], v[46:47], v[54:55]
    v_cvt_pk_bf16_f32 v12, v40, v41
    v_lshlrev_b32 v40, 16, v12
    v_and_b32 v41, 0xffff0000, v12
    v_cvt_pk_bf16_f32 v12, v42, v43
    v_lshlrev_b32 v42, 16, v12
    v_and_b32 v43, 0xffff0000, v12
    v_cvt_pk_bf16_f32 v12, v44, v45
    v_lshlrev_b32 v44, 16, v12
    v_and_b32 v45, 0xffff0000, v12
    v_cvt_pk_bf16_f32 v12, v46, v47
    v_lshlrev_b32 v46, 16, v12
    v_and_b32 v47, 0xffff0000, v12
    v_lshlrev_b32 v48, 16, v92
    v_and_b32 v49, 0xffff0000, v92
    v_lshlrev_b32 v50, 16, v93
    v_and_b32 v51, 0xffff0000, v93
    v_lshlrev_b32 v52, 16, v94
    v_and_b32 v53, 0xffff0000, v94
    v_lshlrev_b32 v54, 16, v95
    v_and_b32 v55, 0xffff0000, v95
    v_pk_mul_f32 v[40:41], v[40:41], v[48:49]
    v_pk_mul_f32 v[42:43], v[42:43], v[50:51]
    v_pk_mul_f32 v[44:45], v[44:45], v[52:53]
    v_pk_mul_f32 v[46:47], v[46:47], v[54:55]
    v_cvt_pk_bf16_f32 v12, v40, v41
    v_lshlrev_b32 v40, 16, v12
    v_and_b32 v41, 0xffff0000, v12
    v_cvt_pk_bf16_f32 v12, v42, v43
    v_lshlrev_b32 v42, 16, v12
    v_and_b32 v43, 0xffff0000, v12
    v_cvt_pk_bf16_f32 v12, v44, v45
    v_lshlrev_b32 v44, 16, v12
    v_and_b32 v45, 0xffff0000, v12
    v_cvt_pk_bf16_f32 v12, v46, v47
    v_lshlrev_b32 v46, 16, v12
    v_and_b32 v47, 0xffff0000, v12
    v_pk_add_f32 v[40:41], v[40:41], v[32:33]
    v_pk_add_f32 v[42:43], v[42:43], v[34:35]
    v_pk_add_f32 v[44:45], v[44:45], v[36:37]
    v_pk_add_f32 v[46:47], v[46:47], v[38:39]
    v_cvt_pk_bf16_f32 v60, v40, v41
    v_cvt_pk_bf16_f32 v61, v42, v43
    v_cvt_pk_bf16_f32 v62, v44, v45
    v_cvt_pk_bf16_f32 v63, v46, v47
    s_barrier
    v_and_b32 v11, 3, v0
    v_lshlrev_b32 v11, 4, v11
    ds_read_b32 v144, v11 offset:256
    s_waitcnt lgkmcnt(0)
    v_mov_b32 v145, v144
    s_nop 1
    v_max_u32_dpp v145, v145, v145 row_ror:1 row_mask:0xf bank_mask:0xf
    s_nop 1
    v_max_u32_dpp v145, v145, v145 row_ror:2 row_mask:0xf bank_mask:0xf
    v_cmp_eq_u32 vcc, v144, v145
    s_ff1_i32_b64 s26, vcc
    s_lshl_b32 s26, s26, 4
    v_mov_b32 v11, s26
    ds_read_b128 v[20:23], v11 offset:256
    s_waitcnt lgkmcnt(0)
    v_and_b32 v144, 0x7ff, v20
    v_sub_u32 v144, 2047, v144
    s_nop 0
    v_readfirstlane_b32 s101, v144
    s_lshl_b32 s62, s101, 11
    v_rcp_f32 v167, v22
    s_cmp_lg_u32 s101, s16
    s_cselect_b32 s23, s17, 0x7ffffff0
    s_add_u32 s62, s62, s18
    v_lshlrev_b32 v12, 1, v0
    s_lshr_b32 s25, s101, 4
    s_lshl_b32 s25, s25, 15
    s_and_b32 s27, s101, 15
    s_lshl_b32 s27, s27, 6
    s_add_u32 s25, s25, s27
    s_add_u32 s25, s25, 0x2000000
    s_lshl_b32 s26, s99, 11
    s_add_u32 s25, s25, s26
    v_lshrrev_b32 v15, 5, v0
    v_lshlrev_b32 v15, 10, v15
    v_and_b32 v11, 63, v12
    v_add_u32 v15, v15, v11
    s_add_u32 s26, s25, 0x0
    buffer_load_ushort v40, v15, s[8:11], s26 offen sc1
    s_add_u32 s26, s25, 0x400000
    buffer_load_ushort v41, v15, s[8:11], s26 offen sc1
    s_add_u32 s26, s25, 0x800000
    buffer_load_ushort v42, v15, s[8:11], s26 offen sc1
    s_add_u32 s26, s25, 0xc00000
    buffer_load_ushort v43, v15, s[8:11], s26 offen sc1
    buffer_load_ushort v44, v12, s[28:31], s62 offen
    buffer_store_dwordx4 v[56:59], v1, s[64:67], s23 offen offset:0 sc1
    buffer_store_dwordx4 v[60:63], v1, s[64:67], s23 offen offset:1024 sc1
    v_min_u32 v7, 223, v17
    v_lshlrev_b32 v7, 2, v7
    s_mul_i32 s24, s100, 896
    s_add_u32 s24, s24, 0xa10000
    v_mul_u32_u24 v11, 28, v13
    s_barrier
    s_mov_b32 s27, 0
fz_ap:
    s_add_u32 s25, s24, 0
    buffer_load_dword v120, v7, s[8:11], s25 offen sc1
    s_add_u32 s25, s24, 14336
    buffer_load_dword v121, v7, s[8:11], s25 offen sc1
    s_add_u32 s25, s24, 28672
    buffer_load_dword v122, v7, s[8:11], s25 offen sc1
    s_add_u32 s25, s24, 43008
    buffer_load_dword v123, v7, s[8:11], s25 offen sc1
    s_waitcnt vmcnt(2)
    v_min_u32 v124, v120, v121
    s_waitcnt vmcnt(0)
    v_min3_u32 v124, v124, v122, v123
    v_cmp_eq_u32 vcc, 0, v124
    s_add_u32 s27, s27, 1
    s_cmp_ge_u32 s27, 65536
    s_cbranch_scc1 fz_ag
    s_cbranch_vccz fz_ag
    s_branch fz_ap
fz_ag:
    v_add_f32 v120, v120, v121
    v_add_f32 v122, v122, v123
    v_cvt_pk_bf16_f32 v124, v120, v122
    v_lshlrev_b32 v120, 16, v124
    v_and_b32 v122, 0xffff0000, v124
    v_mul_f32 v124, 0xbfb8aa3b, v120
    v_exp_f32 v124, v124
    s_nop 0
    v_add_f32 v124, 1.0, v124
    v_rcp_f32 v124, v124
    s_nop 0
    v_mul_f32 v120, v120, v124
    v_cvt_pk_bf16_f32 v120, v120, v120
    v_lshlrev_b32 v120, 16, v120
    v_mul_f32 v120, v120, v122
    v_cvt_pk_bf16_f32 v120, v120, v120
    v_lshlrev_b32 v120, 16, v120
    ds_write_b32 v5, v120 offset:8192
    s_waitcnt lgkmcnt(0)
    s_barrier
    ds_read_b32 v128, v11 offset:8192
    ds_read_b32 v129, v11 offset:8196
    ds_read_b32 v130, v11 offset:8200
    ds_read_b32 v131, v11 offset:8204
    ds_read_b32 v132, v11 offset:8208
    ds_read_b32 v133, v11 offset:8212
    ds_read_b32 v134, v11 offset:8216
    s_lshl_b32 s24, s99, 12
    s_add_u32 s24, s24, 0xa00000
    s_lshl_b32 s25, s100, 8
    s_add_u32 s25, s25, s24
    s_waitcnt lgkmcnt(6)
    v_lshrrev_b32 v144, 16, v128
    v_dot2_f32_bf16 v157, v204, v128, 0
    v_dot2_f32_bf16 v156, v204, v144, 0
    v_dot2_f32_bf16 v159, v205, v128, 0
    v_dot2_f32_bf16 v158, v205, v144, 0
    v_dot2_f32_bf16 v161, v206, v128, 0
    v_dot2_f32_bf16 v160, v206, v144, 0
    v_dot2_f32_bf16 v163, v207, v128, 0
    v_dot2_f32_bf16 v162, v207, v144, 0
    s_waitcnt lgkmcnt(5)
    v_lshrrev_b32 v145, 16, v129
    v_dot2c_f32_bf16 v157, v208, v129
    v_dot2c_f32_bf16 v156, v208, v145
    v_dot2c_f32_bf16 v159, v209, v129
    v_dot2c_f32_bf16 v158, v209, v145
    v_dot2c_f32_bf16 v161, v210, v129
    v_dot2c_f32_bf16 v160, v210, v145
    v_dot2c_f32_bf16 v163, v211, v129
    v_dot2c_f32_bf16 v162, v211, v145
    s_waitcnt lgkmcnt(4)
    v_lshrrev_b32 v146, 16, v130
    v_dot2c_f32_bf16 v157, v212, v130
    v_dot2c_f32_bf16 v156, v212, v146
    v_dot2c_f32_bf16 v159, v213, v130
    v_dot2c_f32_bf16 v158, v213, v146
    v_dot2c_f32_bf16 v161, v214, v130
    v_dot2c_f32_bf16 v160, v214, v146
    v_dot2c_f32_bf16 v163, v215, v130
    v_dot2c_f32_bf16 v162, v215, v146
    s_waitcnt lgkmcnt(3)
    v_lshrrev_b32 v147, 16, v131
    v_dot2c_f32_bf16 v157, v216, v131
    v_dot2c_f32_bf16 v156, v216, v147
    v_dot2c_f32_bf16 v159, v217, v131
    v_dot2c_f32_bf16 v158, v217, v147
    v_dot2c_f32_bf16 v161, v218, v131
    v_dot2c_f32_bf16 v160, v218, v147
    v_dot2c_f32_bf16 v163, v219, v131
    v_dot2c_f32_bf16 v162, v219, v147
    s_waitcnt lgkmcnt(2)
    v_lshrrev_b32 v148, 16, v132
    v_dot2c_f32_bf16 v157, v220, v132
    v_dot2c_f32_bf16 v156, v220, v148
    v_dot2c_f32_bf16 v159, v221, v132
    v_dot2c_f32_bf16 v158, v221, v148
    v_dot2c_f32_bf16 v161, v222, v132
    v_dot2c_f32_bf16 v160, v222, v148
    v_dot2c_f32_bf16 v163, v223, v132
    v_dot2c_f32_bf16 v162, v223, v148
    s_waitcnt lgkmcnt(1)
    v_lshrrev_b32 v149, 16, v133
    v_dot2c_f32_bf16 v157, v224, v133
    v_dot2c_f32_bf16 v156, v224, v149
    v_dot2c_f32_bf16 v159, v225, v133
    v_dot2c_f32_bf16 v158, v225, v149
    v_dot2c_f32_bf16 v161, v226, v133
    v_dot2c_f32_bf16 v160, v226, v149
    v_dot2c_f32_bf16 v163, v227, v133
    v_dot2c_f32_bf16 v162, v227, v149
    s_waitcnt lgkmcnt(0)
    v_lshrrev_b32 v150, 16, v134
    v_dot2c_f32_bf16 v157, v228, v134
    v_dot2c_f32_bf16 v156, v228, v150
    v_dot2c_f32_bf16 v159, v229, v134
    v_dot2c_f32_bf16 v158, v229, v150
    v_dot2c_f32_bf16 v161, v230, v134
    v_dot2c_f32_bf16 v160, v230, v150
    v_dot2c_f32_bf16 v163, v231, v134
    v_dot2c_f32_bf16 v162, v231, v150
    s_nop 0
    v_permlane32_swap_b32 v156, v160
    v_permlane32_swap_b32 v157, v161
    v_permlane32_swap_b32 v158, v162
    v_permlane32_swap_b32 v159, v163
    v_add_f32 v156, v156, v160
    v_add_f32 v157, v157, v161
    v_add_f32 v158, v158, v162
    v_add_f32 v159, v159, v163
    s_nop 0
    v_permlane16_swap_b32 v156, v158
    v_permlane16_swap_b32 v157, v159
    v_add_f32 v156, v156, v158
    v_add_f32 v157, v157, v159
    s_nop 0
    v_add_f32_dpp v156, v156, v156 row_ror:8 row_mask:0xf bank_mask:0xf
    v_add_f32_dpp v157, v157, v157 row_ror:8 row_mask:0xf bank_mask:0xf
    ds_write_b64 v2, v[156:157] offset:12288
    s_waitcnt lgkmcnt(0)
    s_barrier
    ds_read_b32 v156, v4 offset:12288
    ds_read_b32 v157, v4 offset:12544
    ds_read_b32 v158, v4 offset:12800
    ds_read_b32 v159, v4 offset:13056
    s_waitcnt lgkmcnt(1)
    v_add_f32 v156, v156, v158
    s_waitcnt lgkmcnt(0)
    v_add_f32 v157, v157, v159
    v_add_f32 v156, v156, v157
    v_or_b32 v156, 1, v156
    s_cmp_lg_u32 s3, 0
    s_cbranch_scc1 fz_end
    buffer_store_dword v156, v4, s[8:11], s25 offen sc1
    s_cmp_lg_u32 s100, 15
    s_cbranch_scc1 fz_end
    v_mov_b32 v190, v23
    v_cvt_pk_bf16_f32 v190, v190, v190
    v_lshlrev_b32 v190, 16, v190
    v_mul_f32 v190, 0xbfb8aa3b, v190
    v_exp_f32 v190, v190
    s_nop 0
    v_add_f32 v190, 1.0, v190
    v_rcp_f32 v190, v190
    s_nop 0
    v_cvt_pk_bf16_f32 v190, v190, v190
    v_lshlrev_b32 v190, 16, v190
    v_lshlrev_b32 v40, 16, v40
    v_lshlrev_b32 v41, 16, v41
    v_lshlrev_b32 v42, 16, v42
    v_lshlrev_b32 v43, 16, v43
    v_lshlrev_b32 v44, 16, v44
    v_add_f32 v188, v40, v41
    v_add_f32 v188, v188, v42
    v_add_f32 v188, v188, v43
    v_add_f32 v188, v44, v188
    v_cvt_pk_bf16_f32 v188, v188, v188
    v_lshlrev_b32 v188, 16, v188
    v_mov_b32 v189, v188
    v_mov_b32 v191, v188
    v_sub_f32 v189, v189, v21
    v_sub_f32 v191, v191, v21
    v_cvt_pk_bf16_f32 v148, v189, v191
    v_lshlrev_b32 v189, 16, v148
    v_and_b32 v191, 0xffff0000, v148
    v_mul_f32 v149, v189, v167
    v_fma_f32 v189, -v149, v22, v189
    v_fma_f32 v189, v189, v167, v149
    v_mul_f32 v149, v191, v167
    v_fma_f32 v191, -v149, v22, v191
    v_fma_f32 v191, v191, v167, v149
    v_cvt_pk_bf16_f32 v148, v189, v191
    v_lshlrev_b32 v189, 16, v148
    v_and_b32 v191, 0xffff0000, v148
    v_mul_f32 v189, v189, v125
    v_mul_f32 v191, v191, v125
    v_cvt_pk_bf16_f32 v148, v189, v191
    v_lshlrev_b32 v189, 16, v148
    v_and_b32 v191, 0xffff0000, v148
    v_add_f32 v189, v189, v126
    v_add_f32 v191, v191, v126
    v_cvt_pk_bf16_f32 v189, v189, v189
    v_lshlrev_b32 v189, 16, v189
    s_mov_b32 s27, 0
fz_yp:
    buffer_load_dword v104, v4, s[8:11], s24 offen offset:0 sc1
    buffer_load_dword v105, v4, s[8:11], s24 offen offset:256 sc1
    buffer_load_dword v106, v4, s[8:11], s24 offen offset:512 sc1
    buffer_load_dword v107, v4, s[8:11], s24 offen offset:768 sc1
    buffer_load_dword v108, v4, s[8:11], s24 offen offset:1024 sc1
    buffer_load_dword v109, v4, s[8:11], s24 offen offset:1280 sc1
    buffer_load_dword v110, v4, s[8:11], s24 offen offset:1536 sc1
    buffer_load_dword v111, v4, s[8:11], s24 offen offset:1792 sc1
    buffer_load_dword v112, v4, s[8:11], s24 offen offset:2048 sc1
    buffer_load_dword v113, v4, s[8:11], s24 offen offset:2304 sc1
    buffer_load_dword v114, v4, s[8:11], s24 offen offset:2560 sc1
    buffer_load_dword v115, v4, s[8:11], s24 offen offset:2816 sc1
    buffer_load_dword v116, v4, s[8:11], s24 offen offset:3072 sc1
    buffer_load_dword v117, v4, s[8:11], s24 offen offset:3328 sc1
    buffer_load_dword v118, v4, s[8:11], s24 offen offset:3584 sc1
    s_waitcnt vmcnt(12)
    v_min3_u32 v7, v104, v105, v106
    s_waitcnt vmcnt(10)
    v_min3_u32 v7, v7, v107, v108
    s_waitcnt vmcnt(8)
    v_min3_u32 v7, v7, v109, v110
    s_waitcnt vmcnt(6)
    v_min3_u32 v7, v7, v111, v112
    s_waitcnt vmcnt(4)
    v_min3_u32 v7, v7, v113, v114
    s_waitcnt vmcnt(2)
    v_min3_u32 v7, v7, v115, v116
    s_waitcnt vmcnt(0)
    v_min3_u32 v7, v7, v117, v118
    v_cmp_eq_u32 vcc, 0, v7
    s_add_u32 s27, s27, 1
    s_cmp_ge_u32 s27, 65536
    s_cbranch_scc1 fz_yg
    s_cbranch_vccz fz_yg
    s_branch fz_yp
fz_yg:
    v_mov_b32 v119, v156
    v_add_f32 v104, v104, v112
    v_add_f32 v105, v105, v113
    v_add_f32 v106, v106, v114
    v_add_f32 v107, v107, v115
    v_add_f32 v108, v108, v116
    v_add_f32 v109, v109, v117
    v_add_f32 v110, v110, v118
    v_add_f32 v111, v111, v119
    v_add_f32 v104, v104, v108
    v_add_f32 v105, v105, v109
    v_add_f32 v106, v106, v110
    v_add_f32 v107, v107, v111
    v_add_f32 v104, v104, v106
    v_add_f32 v105, v105, v107
    v_add_f32 v104, v104, v105
    v_cvt_pk_bf16_f32 v104, v104, v104
    v_lshlrev_b32 v104, 16, v104
    v_mul_f32 v104, v104, v190
    v_cvt_pk_bf16_f32 v104, v104, v104
    v_lshlrev_b32 v104, 16, v104
    v_add_f32 v104, v104, v189
    v_cvt_pk_bf16_f32 v104, v104, v104
    v_lshlrev_b32 v104, 16, v104
    v_mul_f32 v104, v104, v127
    v_cvt_pk_bf16_f32 v104, v104, v104
    v_lshlrev_b32 v104, 16, v104
    v_add_f32 v104, v104, v188
    v_cvt_pk_bf16_f32 v104, v104, v104
    buffer_store_short v104, v12, s[64:67], s62 offen sc1
    s_cmp_lg_u32 s99, 0
    s_cbranch_scc1 fz_end
    s_mov_b32 s26, 0x570000
    v_mov_b32 v7, s14
    s_mov_b64 exec, 1
    buffer_store_dword v7, v6, s[8:11], s26 offen sc1
    s_mov_b64 exec, -1
    s_branch fz_end
fz_slow:
    s_waitcnt vmcnt(0) lgkmcnt(0)
    s_nop 15
    s_nop 3
    s_cmp_eq_u32 s15, 0x7777
    s_cbranch_scc1 fz_epi
    s_mov_b32 s15, 0x7777
    v_add_u32 v5, s18, v1
    v_mov_b32 v9, 0xff7fffff
    v_mov_b32 v10, 0xff7fffff
    s_mov_b32 s22, 0
fz_s1:
    s_add_u32 s23, s22, 4096
    buffer_load_dwordx4 v[84:87], v5, s[8:11], s22 offen offset:0 sc1
    buffer_load_dwordx4 v[88:91], v5, s[8:11], s22 offen offset:1024 sc1
    buffer_load_dwordx4 v[92:95], v5, s[8:11], s22 offen offset:2048 sc1
    buffer_load_dwordx4 v[96:99], v5, s[8:11], s22 offen offset:3072 sc1
    buffer_load_dwordx4 v[100:103], v5, s[8:11], s23 offen offset:0 sc1
    buffer_load_dwordx4 v[104:107], v5, s[8:11], s23 offen offset:1024 sc1
    buffer_load_dwordx4 v[156:159], v5, s[8:11], s23 offen offset:2048 sc1
    buffer_load_dwordx4 v[160:163], v5, s[8:11], s23 offen offset:3072 sc1
    s_waitcnt vmcnt(7)
    v_mfma_f32_16x16x32_bf16 v[140:143], v[84:87], v[108:111], 0
    v_mfma_f32_16x16x32_bf16 v[144:147], v[84:87], v[124:127], 0
    s_waitcnt vmcnt(6)
    v_mfma_f32_16x16x32_bf16 v[148:151], v[88:91], v[108:111], 0
    v_mfma_f32_16x16x32_bf16 v[152:155], v[88:91], v[124:127], 0
    s_waitcnt vmcnt(5)
    v_mfma_f32_16x16x32_bf16 v[140:143], v[92:95], v[112:115], v[140:143]
    v_mfma_f32_16x16x32_bf16 v[144:147], v[92:95], v[128:131], v[144:147]
    s_waitcnt vmcnt(4)
    v_mfma_f32_16x16x32_bf16 v[148:151], v[96:99], v[112:115], v[148:151]
    v_mfma_f32_16x16x32_bf16 v[152:155], v[96:99], v[128:131], v[152:155]
    s_waitcnt vmcnt(3)
    v_mfma_f32_16x16x32_bf16 v[140:143], v[100:103], v[116:119], v[140:143]
    v_mfma_f32_16x16x32_bf16 v[144:147], v[100:103], v[132:135], v[144:147]
    s_waitcnt vmcnt(2)
    v_mfma_f32_16x16x32_bf16 v[148:151], v[104:107], v[116:119], v[148:151]
    v_mfma_f32_16x16x32_bf16 v[152:155], v[104:107], v[132:135], v[152:155]
    s_waitcnt vmcnt(1)
    v_mfma_f32_16x16x32_bf16 v[140:143], v[156:159], v[120:123], v[140:143]
    v_mfma_f32_16x16x32_bf16 v[144:147], v[156:159], v[136:139], v[144:147]
    s_waitcnt vmcnt(0)
    v_mfma_f32_16x16x32_bf16 v[148:151], v[160:163], v[120:123], v[148:151]
    v_mfma_f32_16x16x32_bf16 v[152:155], v[160:163], v[136:139], v[152:155]
    s_nop 3
    v_max3_f32 v9, v9, v140, v141
    v_max3_f32 v9, v9, v142, v143
    v_max3_f32 v10, v10, v144, v145
    v_max3_f32 v10, v10, v146, v147
    v_max3_f32 v9, v9, v148, v149
    v_max3_f32 v9, v9, v150, v151
    v_max3_f32 v10, v10, v152, v153
    v_max3_f32 v10, v10, v154, v155
    s_add_u32 s22, s22, 16384
    s_cmp_lt_u32 s22, 0x40000
    s_cbranch_scc1 fz_s1
    v_mov_b32 v11, v9
    v_mov_b32 v12, v10
    s_nop 0
    v_permlane16_swap_b32 v9, v11
    v_permlane16_swap_b32 v10, v12
    v_max_f32 v9, v9, v11
    v_max_f32 v10, v10, v12
    v_mov_b32 v11, v9
    v_mov_b32 v12, v10
    s_nop 0
    v_permlane32_swap_b32 v9, v11
    v_permlane32_swap_b32 v10, v12
    v_max_f32 v9, v9, v11
    v_max_f32 v10, v10, v12
    v_sub_f32 v172, 0, v9
    v_sub_f32 v173, 0, v9
    v_sub_f32 v174, 0, v9
    v_sub_f32 v175, 0, v9
    v_sub_f32 v176, 0, v10
    v_sub_f32 v177, 0, v10
    v_sub_f32 v178, 0, v10
    v_sub_f32 v179, 0, v10
    v_mov_b32 v20, 0
    v_mov_b32 v21, 0
    v_mov_b32 v22, 0
    v_mov_b32 v23, 0
    v_mov_b32 v24, 0
    v_mov_b32 v25, 0
    v_mov_b32 v26, 0
    v_mov_b32 v27, 0
    v_mov_b32 v28, 0
    v_mov_b32 v29, 0
    v_mov_b32 v30, 0
    v_mov_b32 v31, 0
    v_mov_b32 v32, 0
    v_mov_b32 v33, 0
    v_mov_b32 v34, 0
    v_mov_b32 v35, 0
    v_mov_b32 v36, 0
    v_mov_b32 v37, 0
    v_mov_b32 v38, 0
    v_mov_b32 v39, 0
    v_mov_b32 v40, 0
    v_mov_b32 v41, 0
    v_mov_b32 v42, 0
    v_mov_b32 v43, 0
    v_mov_b32 v44, 0
    v_mov_b32 v45, 0
    v_mov_b32 v46, 0
    v_mov_b32 v47, 0
    v_mov_b32 v48, 0
    v_mov_b32 v49, 0
    v_mov_b32 v50, 0
    v_mov_b32 v51, 0
    v_mov_b32 v52, 0
    v_mov_b32 v53, 0
    v_mov_b32 v54, 0
    v_mov_b32 v55, 0
    v_mov_b32 v56, 0
    v_mov_b32 v57, 0
    v_mov_b32 v58, 0
    v_mov_b32 v59, 0
    v_mov_b32 v60, 0
    v_mov_b32 v61, 0
    v_mov_b32 v62, 0
    v_mov_b32 v63, 0
    v_mov_b32 v64, 0
    v_mov_b32 v65, 0
    v_mov_b32 v66, 0
    v_mov_b32 v67, 0
    v_mov_b32 v68, 0
    v_mov_b32 v69, 0
    v_mov_b32 v70, 0
    v_mov_b32 v71, 0
    v_mov_b32 v72, 0
    v_mov_b32 v73, 0
    v_mov_b32 v74, 0
    v_mov_b32 v75, 0
    v_mov_b32 v76, 0
    v_mov_b32 v77, 0
    v_mov_b32 v78, 0
    v_mov_b32 v79, 0
    v_mov_b32 v80, 0
    v_mov_b32 v81, 0
    v_mov_b32 v82, 0
    v_mov_b32 v83, 0
    v_mov_b32 v15, 0
    v_mov_b32 v16, 0
    s_mov_b32 s22, 0
fz_s2:
    s_add_u32 s23, s22, 4096
    buffer_load_dwordx4 v[84:87], v5, s[8:11], s22 offen offset:0 sc1
    buffer_load_dwordx4 v[88:91], v5, s[8:11], s22 offen offset:1024 sc1
    buffer_load_dwordx4 v[92:95], v5, s[8:11], s22 offen offset:2048 sc1
    buffer_load_dwordx4 v[96:99], v5, s[8:11], s22 offen offset:3072 sc1
    buffer_load_dwordx4 v[100:103], v5, s[8:11], s23 offen offset:0 sc1
    buffer_load_dwordx4 v[104:107], v5, s[8:11], s23 offen offset:1024 sc1
    buffer_load_dwordx4 v[156:159], v5, s[8:11], s23 offen offset:2048 sc1
    buffer_load_dwordx4 v[160:163], v5, s[8:11], s23 offen offset:3072 sc1
    s_waitcnt vmcnt(7)
    v_mfma_f32_16x16x32_bf16 v[140:143], v[84:87], v[108:111], v[172:175]
    v_mfma_f32_16x16x32_bf16 v[144:147], v[84:87], v[124:127], v[176:179]
    s_waitcnt vmcnt(6)
    v_mfma_f32_16x16x32_bf16 v[148:151], v[88:91], v[108:111], v[172:175]
    v_mfma_f32_16x16x32_bf16 v[152:155], v[88:91], v[124:127], v[176:179]
    s_waitcnt vmcnt(5)
    v_mfma_f32_16x16x32_bf16 v[140:143], v[92:95], v[112:115], v[140:143]
    v_mfma_f32_16x16x32_bf16 v[144:147], v[92:95], v[128:131], v[144:147]
    s_waitcnt vmcnt(4)
    v_mfma_f32_16x16x32_bf16 v[148:151], v[96:99], v[112:115], v[148:151]
    v_mfma_f32_16x16x32_bf16 v[152:155], v[96:99], v[128:131], v[152:155]
    s_waitcnt vmcnt(3)
    v_mfma_f32_16x16x32_bf16 v[140:143], v[100:103], v[116:119], v[140:143]
    v_mfma_f32_16x16x32_bf16 v[144:147], v[100:103], v[132:135], v[144:147]
    s_waitcnt vmcnt(2)
    v_mfma_f32_16x16x32_bf16 v[148:151], v[104:107], v[116:119], v[148:151]
    v_mfma_f32_16x16x32_bf16 v[152:155], v[104:107], v[132:135], v[152:155]
    s_waitcnt vmcnt(1)
    v_mfma_f32_16x16x32_bf16 v[140:143], v[156:159], v[120:123], v[140:143]
    v_mfma_f32_16x16x32_bf16 v[144:147], v[156:159], v[136:139], v[144:147]
    s_waitcnt vmcnt(0)
    v_mfma_f32_16x16x32_bf16 v[148:151], v[160:163], v[120:123], v[148:151]
    v_mfma_f32_16x16x32_bf16 v[152:155], v[160:163], v[136:139], v[152:155]
    s_add_u32 s26, s22, 8192
    s_add_u32 s23, s22, 12288
    buffer_load_dwordx4 v[84:87], v5, s[8:11], s26 offen offset:0 sc1
    buffer_load_dwordx4 v[88:91], v5, s[8:11], s26 offen offset:1024 sc1
    buffer_load_dwordx4 v[92:95], v5, s[8:11], s26 offen offset:2048 sc1
    buffer_load_dwordx4 v[96:99], v5, s[8:11], s26 offen offset:3072 sc1
    buffer_load_dwordx4 v[100:103], v5, s[8:11], s23 offen offset:0 sc1
    buffer_load_dwordx4 v[104:107], v5, s[8:11], s23 offen offset:1024 sc1
    buffer_load_dwordx4 v[156:159], v5, s[8:11], s23 offen offset:2048 sc1
    buffer_load_dwordx4 v[160:163], v5, s[8:11], s23 offen offset:3072 sc1
    v_exp_f32 v140, v140
    v_exp_f32 v141, v141
    v_add_f32 v15, v15, v140
    v_add_f32 v15, v15, v141
    v_cvt_pk_bf16_f32 v188, v140, v141
    v_exp_f32 v142, v142
    v_exp_f32 v143, v143
    v_add_f32 v15, v15, v142
    v_add_f32 v15, v15, v143
    v_cvt_pk_bf16_f32 v189, v142, v143
    v_exp_f32 v144, v144
    v_exp_f32 v145, v145
    v_add_f32 v16, v16, v144
    v_add_f32 v16, v16, v145
    v_cvt_pk_bf16_f32 v192, v144, v145
    v_exp_f32 v146, v146
    v_exp_f32 v147, v147
    v_add_f32 v16, v16, v146
    v_add_f32 v16, v16, v147
    v_cvt_pk_bf16_f32 v193, v146, v147
    v_exp_f32 v148, v148
    v_exp_f32 v149, v149
    v_add_f32 v15, v15, v148
    v_add_f32 v15, v15, v149
    v_cvt_pk_bf16_f32 v190, v148, v149
    v_exp_f32 v150, v150
    v_exp_f32 v151, v151
    v_add_f32 v15, v15, v150
    v_add_f32 v15, v15, v151
    v_cvt_pk_bf16_f32 v191, v150, v151
    v_exp_f32 v152, v152
    v_exp_f32 v153, v153
    v_add_f32 v16, v16, v152
    v_add_f32 v16, v16, v153
    v_cvt_pk_bf16_f32 v194, v152, v153
    v_exp_f32 v154, v154
    v_exp_f32 v155, v155
    v_add_f32 v16, v16, v154
    v_add_f32 v16, v16, v155
    v_cvt_pk_bf16_f32 v195, v154, v155
    s_waitcnt vmcnt(7)
    v_mfma_f32_16x16x32_bf16 v[20:23], v[84:87], v[188:191], v[20:23]
    v_mfma_f32_16x16x32_bf16 v[24:27], v[84:87], v[192:195], v[24:27]
    s_waitcnt vmcnt(6)
    v_mfma_f32_16x16x32_bf16 v[28:31], v[88:91], v[188:191], v[28:31]
    v_mfma_f32_16x16x32_bf16 v[32:35], v[88:91], v[192:195], v[32:35]
    s_waitcnt vmcnt(5)
    v_mfma_f32_16x16x32_bf16 v[36:39], v[92:95], v[188:191], v[36:39]
    v_mfma_f32_16x16x32_bf16 v[40:43], v[92:95], v[192:195], v[40:43]
    s_waitcnt vmcnt(4)
    v_mfma_f32_16x16x32_bf16 v[44:47], v[96:99], v[188:191], v[44:47]
    v_mfma_f32_16x16x32_bf16 v[48:51], v[96:99], v[192:195], v[48:51]
    s_waitcnt vmcnt(3)
    v_mfma_f32_16x16x32_bf16 v[52:55], v[100:103], v[188:191], v[52:55]
    v_mfma_f32_16x16x32_bf16 v[56:59], v[100:103], v[192:195], v[56:59]
    s_waitcnt vmcnt(2)
    v_mfma_f32_16x16x32_bf16 v[60:63], v[104:107], v[188:191], v[60:63]
    v_mfma_f32_16x16x32_bf16 v[64:67], v[104:107], v[192:195], v[64:67]
    s_waitcnt vmcnt(1)
    v_mfma_f32_16x16x32_bf16 v[68:71], v[156:159], v[188:191], v[68:71]
    v_mfma_f32_16x16x32_bf16 v[72:75], v[156:159], v[192:195], v[72:75]
    s_waitcnt vmcnt(0)
    v_mfma_f32_16x16x32_bf16 v[76:79], v[160:163], v[188:191], v[76:79]
    v_mfma_f32_16x16x32_bf16 v[80:83], v[160:163], v[192:195], v[80:83]
    s_add_u32 s22, s22, 16384
    s_cmp_lt_u32 s22, 0x40000
    s_cbranch_scc1 fz_s2
    s_waitcnt vmcnt(0) lgkmcnt(0)
    s_nop 15
    s_nop 3
    s_branch fz_chk
fz_end:
    s_endpgm
.section .rodata,"a"
.p2align 6
.amdhsa_kernel adaLN_cond__sliding_block_cached__moe_arch_mod__prompt_kernel
  .amdhsa_next_free_vgpr 256
  .amdhsa_next_free_sgpr 102
  .amdhsa_accum_offset 256
  .amdhsa_group_segment_fixed_size 0
  .amdhsa_kernarg_size 120
  .amdhsa_user_sgpr_count 2
  .amdhsa_user_sgpr_kernarg_segment_ptr 1
  .amdhsa_system_sgpr_workgroup_id_x 1
  .amdhsa_float_denorm_mode_32 3
.end_amdhsa_kernel
```

```asm
; @launch grid=(256,1,1) block=(512,1,1) lds=163840
.amdgcn_target "amdgcn-amd-amdhsa--gfx950"
.text
.globl adaLN_cond__sliding_block_cached__moe_arch_mod__prompt_kernel
.p2align 8
.type adaLN_cond__sliding_block_cached__moe_arch_mod__prompt_kernel,@function
adaLN_cond__sliding_block_cached__moe_arch_mod__prompt_kernel:
fz_start:
    s_cmp_ge_u32 s2, 256
    s_cbranch_scc1 fz_end
    s_load_dwordx16 s[32:47], s[0:1], 0
    s_load_dwordx8 s[48:55], s[0:1], 64
    s_load_dwordx4 s[56:59], s[0:1], 96
    s_load_dwordx2 s[60:61], s[0:1], 112
    s_and_b32 s12, s2, 3
    s_lshl_b32 s12, s12, 3
    s_bfe_u32 s13, s2, 0x30003
    s_add_u32 s12, s12, s13
    s_bfe_u32 s13, s2, 0x10002
    s_lshl_b32 s13, s13, 2
    s_lshr_b32 s19, s2, 6
    s_add_u32 s13, s13, s19
    s_mov_b32 s15, 0
    v_and_b32 v8, 255, v0
    v_lshrrev_b32 v9, 6, v0
    v_and_b32 v0, 63, v0
    v_readfirstlane_b32 s3, v9
    v_lshlrev_b32 v1, 4, v0
    s_mov_b32 s10, 0x3400000
    s_mov_b32 s11, 0x20000
    s_lshl_b32 s19, s13, 3
    s_add_u32 s19, s19, s3
    s_lshl_b32 s20, s19, 16
    v_add_u32 v4, s20, v1
    v_bfe_u32 v9, v0, 2, 2
    v_lshrrev_b32 v10, 4, v0
    v_and_b32 v11, 3, v0
    v_bfe_u32 v13, v0, 4, 1
    v_lshlrev_b32 v3, 11, v10
    v_lshl_add_u32 v3, v9, 6, v3
    v_lshl_add_u32 v3, v11, 3, v3
    v_lshlrev_b32 v16, 5, v13
    v_sub_u32 v15, v3, v16
    v_add_u32 v3, v3, v16
    v_lshlrev_b32 v2, 6, v10
    v_lshl_add_u32 v2, v11, 4, v2
    v_lshl_add_u32 v2, v9, 13, v2
    v_xor_b32 v16, 32, v2
    s_lshr_b32 s18, s12, 3
    s_lshl_b32 s18, s18, 18
    s_add_u32 s18, s18, 0x400000
    v_add_u32 v5, s18, v1
    v_mov_b32 v17, 0
    v_mov_b32 v18, 0
    v_mov_b32 v19, 0
    s_lshl_b32 s16, s3, 17
    s_lshl_b32 s17, s3, 12
    s_cmp_ge_u32 s3, 4
    s_cbranch_scc1 fz_roleB
    v_and_b32 v20, 7, v8
    v_bfe_u32 v26, v8, 3, 3
    v_lshlrev_b32 v22, 4, v26
    s_lshl_b32 s19, s3, 9
    v_add_u32 v22, s19, v22
    v_lshl_add_u32 v21, v20, 11, v22
    v_mov_b32 v25, 0
    s_lshl_b32 s25, s2, 14
    s_waitcnt lgkmcnt(0)
    s_mov_b64 s[8:9], s[60:61]
    s_mov_b64 s[28:29], s[32:33]
    s_mov_b32 s30, 0x400000
    s_mov_b32 s31, 0x20000
    s_barrier
    buffer_load_dwordx4 v[36:39], v21, s[28:31], s25 offen offset:0
    buffer_load_dwordx4 v[40:43], v21, s[28:31], s25 offen offset:128
    buffer_load_dwordx4 v[44:47], v21, s[28:31], s25 offen offset:256
    buffer_load_dwordx4 v[48:51], v21, s[28:31], s25 offen offset:384
    s_mov_b32 s27, 0x570000
    buffer_load_dword v24, v25, s[8:11], s27 offen sc1
    s_lshl_b32 s19, s12, 8
    s_add_u32 s4, s38, s19
    s_addc_u32 s5, s39, 0
    s_sub_u32 s6, 0x800000, s19
    s_mov_b32 s7, 0x20000
    s_waitcnt vmcnt(4)
    v_lshlrev_b32 v52, 16, v36
    v_and_b32 v53, 0xffff0000, v36
    v_lshlrev_b32 v54, 16, v37
    v_and_b32 v55, 0xffff0000, v37
    v_lshlrev_b32 v56, 16, v38
    v_and_b32 v57, 0xffff0000, v38
    v_lshlrev_b32 v58, 16, v39
    v_and_b32 v59, 0xffff0000, v39
    s_waitcnt vmcnt(3)
    v_lshlrev_b32 v60, 16, v40
    v_and_b32 v61, 0xffff0000, v40
    v_lshlrev_b32 v62, 16, v41
    v_and_b32 v63, 0xffff0000, v41
    v_lshlrev_b32 v64, 16, v42
    v_and_b32 v65, 0xffff0000, v42
    v_lshlrev_b32 v66, 16, v43
    v_and_b32 v67, 0xffff0000, v43
    s_waitcnt vmcnt(2)
    v_lshlrev_b32 v68, 16, v44
    v_and_b32 v69, 0xffff0000, v44
    v_lshlrev_b32 v70, 16, v45
    v_and_b32 v71, 0xffff0000, v45
    v_lshlrev_b32 v72, 16, v46
    v_and_b32 v73, 0xffff0000, v46
    v_lshlrev_b32 v74, 16, v47
    v_and_b32 v75, 0xffff0000, v47
    s_waitcnt vmcnt(1)
    v_lshlrev_b32 v76, 16, v48
    v_and_b32 v77, 0xffff0000, v48
    v_lshlrev_b32 v78, 16, v49
    v_and_b32 v79, 0xffff0000, v49
    v_lshlrev_b32 v80, 16, v50
    v_and_b32 v81, 0xffff0000, v50
    v_lshlrev_b32 v82, 16, v51
    v_and_b32 v83, 0xffff0000, v51
    s_waitcnt vmcnt(0)
    v_readfirstlane_b32 s14, v24
    s_add_u32 s14, s14, 1
    v_lshlrev_b32 v30, 5, v20
    s_lshl_b32 s19, s3, 3
    v_add_u32 v23, s19, v30
    v_add_f32 v31, v52, v53
    v_add_f32 v32, v54, v55
    v_add_f32 v31, v31, v56
    v_add_f32 v32, v32, v57
    v_add_f32 v31, v31, v58
    v_add_f32 v32, v32, v59
    v_add_f32 v31, v31, v60
    v_add_f32 v32, v32, v61
    v_add_f32 v31, v31, v62
    v_add_f32 v32, v32, v63
    v_add_f32 v31, v31, v64
    v_add_f32 v32, v32, v65
    v_add_f32 v31, v31, v66
    v_add_f32 v32, v32, v67
    v_add_f32 v31, v31, v68
    v_add_f32 v32, v32, v69
    v_add_f32 v31, v31, v70
    v_add_f32 v32, v32, v71
    v_add_f32 v31, v31, v72
    v_add_f32 v32, v32, v73
    v_add_f32 v31, v31, v74
    v_add_f32 v32, v32, v75
    v_add_f32 v31, v31, v76
    v_add_f32 v32, v32, v77
    v_add_f32 v31, v31, v78
    v_add_f32 v32, v32, v79
    v_add_f32 v31, v31, v80
    v_add_f32 v32, v32, v81
    v_add_f32 v31, v31, v82
    v_add_f32 v32, v32, v83
    v_add_f32 v26, v31, v32
    s_nop 1
    v_add_f32_dpp v26, v26, v26 row_ror:8 row_mask:0xf bank_mask:0xf
    v_mov_b32 v148, v26
    s_nop 1
    v_permlane16_swap_b32 v26, v148
    v_add_f32 v26, v26, v148
    v_mov_b32 v148, v26
    s_nop 1
    v_permlane32_swap_b32 v26, v148
    v_add_f32 v26, v26, v148
    v_mul_f32 v26, 0x3b800000, v26
    v_sub_f32 v28, v52, v26
    v_mul_f32 v31, v28, v28
    v_sub_f32 v29, v53, v26
    v_mul_f32 v32, v29, v29
    v_sub_f32 v28, v54, v26
    v_sub_f32 v29, v55, v26
    v_fmac_f32 v31, v28, v28
    v_fmac_f32 v32, v29, v29
    v_sub_f32 v28, v56, v26
    v_sub_f32 v29, v57, v26
    v_fmac_f32 v31, v28, v28
    v_fmac_f32 v32, v29, v29
    v_sub_f32 v28, v58, v26
    v_sub_f32 v29, v59, v26
    v_fmac_f32 v31, v28, v28
    v_fmac_f32 v32, v29, v29
    v_sub_f32 v28, v60, v26
    v_sub_f32 v29, v61, v26
    v_fmac_f32 v31, v28, v28
    v_fmac_f32 v32, v29, v29
    v_sub_f32 v28, v62, v26
    v_sub_f32 v29, v63, v26
    v_fmac_f32 v31, v28, v28
    v_fmac_f32 v32, v29, v29
    v_sub_f32 v28, v64, v26
    v_sub_f32 v29, v65, v26
    v_fmac_f32 v31, v28, v28
    v_fmac_f32 v32, v29, v29
    v_sub_f32 v28, v66, v26
    v_sub_f32 v29, v67, v26
    v_fmac_f32 v31, v28, v28
    v_fmac_f32 v32, v29, v29
    v_sub_f32 v28, v68, v26
    v_sub_f32 v29, v69, v26
    v_fmac_f32 v31, v28, v28
    v_fmac_f32 v32, v29, v29
    v_sub_f32 v28, v70, v26
    v_sub_f32 v29, v71, v26
    v_fmac_f32 v31, v28, v28
    v_fmac_f32 v32, v29, v29
    v_sub_f32 v28, v72, v26
    v_sub_f32 v29, v73, v26
    v_fmac_f32 v31, v28, v28
    v_fmac_f32 v32, v29, v29
    v_sub_f32 v28, v74, v26
    v_sub_f32 v29, v75, v26
    v_fmac_f32 v31, v28, v28
    v_fmac_f32 v32, v29, v29
    v_sub_f32 v28, v76, v26
    v_sub_f32 v29, v77, v26
    v_fmac_f32 v31, v28, v28
    v_fmac_f32 v32, v29, v29
    v_sub_f32 v28, v78, v26
    v_sub_f32 v29, v79, v26
    v_fmac_f32 v31, v28, v28
    v_fmac_f32 v32, v29, v29
    v_sub_f32 v28, v80, v26
    v_sub_f32 v29, v81, v26
    v_fmac_f32 v31, v28, v28
    v_fmac_f32 v32, v29, v29
    v_sub_f32 v28, v82, v26
    v_sub_f32 v29, v83, v26
    v_fmac_f32 v31, v28, v28
    v_fmac_f32 v32, v29, v29
    v_add_f32 v27, v31, v32
    s_nop 1
    v_add_f32_dpp v27, v27, v27 row_ror:8 row_mask:0xf bank_mask:0xf
    v_mov_b32 v148, v27
    s_nop 1
    v_permlane16_swap_b32 v27, v148
    v_add_f32 v27, v27, v148
    v_mov_b32 v148, v27
    s_nop 1
    v_permlane32_swap_b32 v27, v148
    v_add_f32 v27, v27, v148
    v_add_u32 v23, 0x20400, v23
    ds_write_b64 v23, v[26:27]
    v_add_u32 v30, 0x20400, v30
    s_waitcnt lgkmcnt(0)
    s_barrier
    ds_read_b128 v[148:151], v30
    ds_read_b128 v[152:155], v30 offset:16
    s_waitcnt lgkmcnt(1)
    v_add_f32 v31, v148, v150
    s_waitcnt lgkmcnt(0)
    v_add_f32 v32, v152, v154
    v_add_f32 v26, v31, v32
    v_mul_f32 v26, 0x3e800000, v26
    v_add_f32 v31, v149, v151
    v_add_f32 v32, v153, v155
    v_add_f32 v27, v31, v32
    v_sub_f32 v148, v148, v26
    v_sub_f32 v150, v150, v26
    v_sub_f32 v152, v152, v26
    v_sub_f32 v154, v154, v26
    v_mul_f32 v31, v148, v148
    v_fmac_f32 v31, v150, v150
    v_fmac_f32 v31, v152, v152
    v_fmac_f32 v31, v154, v154
    v_fmamk_f32 v27, v31, 0x43800000, v27
    v_mul_f32 v27, 0x3a800000, v27
    v_cvt_pk_bf16_f32 v26, v26, v26
    v_lshlrev_b32 v26, 16, v26
    v_cvt_pk_bf16_f32 v27, v27, v27
    v_lshlrev_b32 v27, 16, v27
    v_add_f32 v27, 0x3727c5ac, v27
    v_cvt_pk_bf16_f32 v27, v27, v27
    v_lshlrev_b32 v27, 16, v27
    v_sqrt_f32 v28, v27
    s_nop 0
    v_cvt_pk_bf16_f32 v28, v28, v28
    v_lshlrev_b32 v28, 16, v28
    v_rcp_f32 v29, v28
    s_nop 0
    v_mov_b32 v28, v29
    v_pk_add_f32 v[52:53], v[52:53], v[26:27] op_sel_hi:[1,0] neg_lo:[0,1] neg_hi:[0,1]
    v_pk_add_f32 v[54:55], v[54:55], v[26:27] op_sel_hi:[1,0] neg_lo:[0,1] neg_hi:[0,1]
    v_pk_add_f32 v[56:57], v[56:57], v[26:27] op_sel_hi:[1,0] neg_lo:[0,1] neg_hi:[0,1]
    v_pk_add_f32 v[58:59], v[58:59], v[26:27] op_sel_hi:[1,0] neg_lo:[0,1] neg_hi:[0,1]
    v_pk_add_f32 v[60:61], v[60:61], v[26:27] op_sel_hi:[1,0] neg_lo:[0,1] neg_hi:[0,1]
    v_pk_add_f32 v[62:63], v[62:63], v[26:27] op_sel_hi:[1,0] neg_lo:[0,1] neg_hi:[0,1]
    v_pk_add_f32 v[64:65], v[64:65], v[26:27] op_sel_hi:[1,0] neg_lo:[0,1] neg_hi:[0,1]
    v_pk_add_f32 v[66:67], v[66:67], v[26:27] op_sel_hi:[1,0] neg_lo:[0,1] neg_hi:[0,1]
    v_pk_add_f32 v[68:69], v[68:69], v[26:27] op_sel_hi:[1,0] neg_lo:[0,1] neg_hi:[0,1]
    v_pk_add_f32 v[70:71], v[70:71], v[26:27] op_sel_hi:[1,0] neg_lo:[0,1] neg_hi:[0,1]
    v_pk_add_f32 v[72:73], v[72:73], v[26:27] op_sel_hi:[1,0] neg_lo:[0,1] neg_hi:[0,1]
    v_pk_add_f32 v[74:75], v[74:75], v[26:27] op_sel_hi:[1,0] neg_lo:[0,1] neg_hi:[0,1]
    v_pk_add_f32 v[76:77], v[76:77], v[26:27] op_sel_hi:[1,0] neg_lo:[0,1] neg_hi:[0,1]
    v_pk_add_f32 v[78:79], v[78:79], v[26:27] op_sel_hi:[1,0] neg_lo:[0,1] neg_hi:[0,1]
    v_pk_add_f32 v[80:81], v[80:81], v[26:27] op_sel_hi:[1,0] neg_lo:[0,1] neg_hi:[0,1]
    v_pk_add_f32 v[82:83], v[82:83], v[26:27] op_sel_hi:[1,0] neg_lo:[0,1] neg_hi:[0,1]
    v_cvt_pk_bf16_f32 v31, v52, v53
    v_lshlrev_b32 v52, 16, v31
    v_and_b32 v53, 0xffff0000, v31
    v_cvt_pk_bf16_f32 v31, v54, v55
    v_lshlrev_b32 v54, 16, v31
    v_and_b32 v55, 0xffff0000, v31
    v_cvt_pk_bf16_f32 v31, v56, v57
    v_lshlrev_b32 v56, 16, v31
    v_and_b32 v57, 0xffff0000, v31
    v_cvt_pk_bf16_f32 v31, v58, v59
    v_lshlrev_b32 v58, 16, v31
    v_and_b32 v59, 0xffff0000, v31
    v_cvt_pk_bf16_f32 v31, v60, v61
    v_lshlrev_b32 v60, 16, v31
    v_and_b32 v61, 0xffff0000, v31
    v_cvt_pk_bf16_f32 v31, v62, v63
    v_lshlrev_b32 v62, 16, v31
    v_and_b32 v63, 0xffff0000, v31
    v_cvt_pk_bf16_f32 v31, v64, v65
    v_lshlrev_b32 v64, 16, v31
    v_and_b32 v65, 0xffff0000, v31
    v_cvt_pk_bf16_f32 v31, v66, v67
    v_lshlrev_b32 v66, 16, v31
    v_and_b32 v67, 0xffff0000, v31
    v_cvt_pk_bf16_f32 v31, v68, v69
    v_lshlrev_b32 v68, 16, v31
    v_and_b32 v69, 0xffff0000, v31
    v_cvt_pk_bf16_f32 v31, v70, v71
    v_lshlrev_b32 v70, 16, v31
    v_and_b32 v71, 0xffff0000, v31
    v_cvt_pk_bf16_f32 v31, v72, v73
    v_lshlrev_b32 v72, 16, v31
    v_and_b32 v73, 0xffff0000, v31
    v_cvt_pk_bf16_f32 v31, v74, v75
    v_lshlrev_b32 v74, 16, v31
    v_and_b32 v75, 0xffff0000, v31
    v_cvt_pk_bf16_f32 v31, v76, v77
    v_lshlrev_b32 v76, 16, v31
    v_and_b32 v77, 0xffff0000, v31
    v_cvt_pk_bf16_f32 v31, v78, v79
    v_lshlrev_b32 v78, 16, v31
    v_and_b32 v79, 0xffff0000, v31
    v_cvt_pk_bf16_f32 v31, v80, v81
    v_lshlrev_b32 v80, 16, v31
    v_and_b32 v81, 0xffff0000, v31
    v_cvt_pk_bf16_f32 v31, v82, v83
    v_lshlrev_b32 v82, 16, v31
    v_and_b32 v83, 0xffff0000, v31
    v_pk_mul_f32 v[52:53], v[52:53], v[28:29] op_sel_hi:[1,0]
    v_pk_mul_f32 v[54:55], v[54:55], v[28:29] op_sel_hi:[1,0]
    v_pk_mul_f32 v[56:57], v[56:57], v[28:29] op_sel_hi:[1,0]
    v_pk_mul_f32 v[58:59], v[58:59], v[28:29] op_sel_hi:[1,0]
    v_pk_mul_f32 v[60:61], v[60:61], v[28:29] op_sel_hi:[1,0]
    v_pk_mul_f32 v[62:63], v[62:63], v[28:29] op_sel_hi:[1,0]
    v_pk_mul_f32 v[64:65], v[64:65], v[28:29] op_sel_hi:[1,0]
    v_pk_mul_f32 v[66:67], v[66:67], v[28:29] op_sel_hi:[1,0]
    v_pk_mul_f32 v[68:69], v[68:69], v[28:29] op_sel_hi:[1,0]
    v_pk_mul_f32 v[70:71], v[70:71], v[28:29] op_sel_hi:[1,0]
    v_pk_mul_f32 v[72:73], v[72:73], v[28:29] op_sel_hi:[1,0]
    v_pk_mul_f32 v[74:75], v[74:75], v[28:29] op_sel_hi:[1,0]
    v_pk_mul_f32 v[76:77], v[76:77], v[28:29] op_sel_hi:[1,0]
    v_pk_mul_f32 v[78:79], v[78:79], v[28:29] op_sel_hi:[1,0]
    v_pk_mul_f32 v[80:81], v[80:81], v[28:29] op_sel_hi:[1,0]
    v_pk_mul_f32 v[82:83], v[82:83], v[28:29] op_sel_hi:[1,0]
    v_cvt_pk_bf16_f32 v31, v52, v53
    v_lshlrev_b32 v52, 16, v31
    v_and_b32 v53, 0xffff0000, v31
    v_cvt_pk_bf16_f32 v31, v54, v55
    v_lshlrev_b32 v54, 16, v31
    v_and_b32 v55, 0xffff0000, v31
    v_cvt_pk_bf16_f32 v31, v56, v57
    v_lshlrev_b32 v56, 16, v31
    v_and_b32 v57, 0xffff0000, v31
    v_cvt_pk_bf16_f32 v31, v58, v59
    v_lshlrev_b32 v58, 16, v31
    v_and_b32 v59, 0xffff0000, v31
    v_cvt_pk_bf16_f32 v31, v60, v61
    v_lshlrev_b32 v60, 16, v31
    v_and_b32 v61, 0xffff0000, v31
    v_cvt_pk_bf16_f32 v31, v62, v63
    v_lshlrev_b32 v62, 16, v31
    v_and_b32 v63, 0xffff0000, v31
    v_cvt_pk_bf16_f32 v31, v64, v65
    v_lshlrev_b32 v64, 16, v31
    v_and_b32 v65, 0xffff0000, v31
    v_cvt_pk_bf16_f32 v31, v66, v67
    v_lshlrev_b32 v66, 16, v31
    v_and_b32 v67, 0xffff0000, v31
    v_cvt_pk_bf16_f32 v31, v68, v69
    v_lshlrev_b32 v68, 16, v31
    v_and_b32 v69, 0xffff0000, v31
    v_cvt_pk_bf16_f32 v31, v70, v71
    v_lshlrev_b32 v70, 16, v31
    v_and_b32 v71, 0xffff0000, v31
    v_cvt_pk_bf16_f32 v31, v72, v73
    v_lshlrev_b32 v72, 16, v31
    v_and_b32 v73, 0xffff0000, v31
    v_cvt_pk_bf16_f32 v31, v74, v75
    v_lshlrev_b32 v74, 16, v31
    v_and_b32 v75, 0xffff0000, v31
    v_cvt_pk_bf16_f32 v31, v76, v77
    v_lshlrev_b32 v76, 16, v31
    v_and_b32 v77, 0xffff0000, v31
    v_cvt_pk_bf16_f32 v31, v78, v79
    v_lshlrev_b32 v78, 16, v31
    v_and_b32 v79, 0xffff0000, v31
    v_cvt_pk_bf16_f32 v31, v80, v81
    v_lshlrev_b32 v80, 16, v31
    v_and_b32 v81, 0xffff0000, v31
    v_cvt_pk_bf16_f32 v31, v82, v83
    v_lshlrev_b32 v82, 16, v31
    v_and_b32 v83, 0xffff0000, v31
    v_lshlrev_b32 v33, 1, v22
    v_add_u32 v33, 0x21000, v33
    v_lshlrev_b32 v23, 4, v22
    v_lshl_add_u32 v23, v20, 4, v23
    s_lshr_b32 s23, s2, 1
    s_lshl_b32 s23, s23, 15
    s_and_b32 s24, s2, 1
    s_lshl_b32 s24, s24, 7
    s_add_u32 s23, s23, s24
    s_barrier
    ds_read_b128 v[84:87], v33 offset:4096
    ds_read_b128 v[116:119], v33 offset:0
    ds_read_b128 v[88:91], v33 offset:4112
    ds_read_b128 v[120:123], v33 offset:16
    ds_read_b128 v[92:95], v33 offset:4352
    ds_read_b128 v[124:127], v33 offset:256
    ds_read_b128 v[96:99], v33 offset:4368
    ds_read_b128 v[128:131], v33 offset:272
    ds_read_b128 v[100:103], v33 offset:4608
    ds_read_b128 v[132:135], v33 offset:512
    ds_read_b128 v[104:107], v33 offset:4624
    ds_read_b128 v[136:139], v33 offset:528
    ds_read_b128 v[108:111], v33 offset:4864
    ds_read_b128 v[140:143], v33 offset:768
    ds_read_b128 v[112:115], v33 offset:4880
    ds_read_b128 v[144:147], v33 offset:784
    s_waitcnt lgkmcnt(15)
    v_pk_mul_f32 v[52:53], v[52:53], v[84:85]
    v_pk_mul_f32 v[54:55], v[54:55], v[86:87]
    s_waitcnt lgkmcnt(13)
    v_pk_mul_f32 v[56:57], v[56:57], v[88:89]
    v_pk_mul_f32 v[58:59], v[58:59], v[90:91]
    v_cvt_pk_bf16_f32 v31, v52, v53
    v_lshlrev_b32 v52, 16, v31
    v_and_b32 v53, 0xffff0000, v31
    v_cvt_pk_bf16_f32 v31, v54, v55
    v_lshlrev_b32 v54, 16, v31
    v_and_b32 v55, 0xffff0000, v31
    v_cvt_pk_bf16_f32 v31, v56, v57
    v_lshlrev_b32 v56, 16, v31
    v_and_b32 v57, 0xffff0000, v31
    v_cvt_pk_bf16_f32 v31, v58, v59
    v_lshlrev_b32 v58, 16, v31
    v_and_b32 v59, 0xffff0000, v31
    v_pk_add_f32 v[52:53], v[52:53], v[116:117]
    v_pk_add_f32 v[54:55], v[54:55], v[118:119]
    s_waitcnt lgkmcnt(12)
    v_pk_add_f32 v[56:57], v[56:57], v[120:121]
    v_pk_add_f32 v[58:59], v[58:59], v[122:123]
    v_cvt_pk_bf16_f32 v36, v52, v53
    v_cvt_pk_bf16_f32 v37, v54, v55
    v_cvt_pk_bf16_f32 v38, v56, v57
    v_cvt_pk_bf16_f32 v39, v58, v59
    s_add_u32 s24, s23, 0
    buffer_store_dwordx4 v[36:39], v23, s[8:11], s24 offen sc1
    s_waitcnt lgkmcnt(11)
    v_pk_mul_f32 v[60:61], v[60:61], v[92:93]
    v_pk_mul_f32 v[62:63], v[62:63], v[94:95]
    s_waitcnt lgkmcnt(9)
    v_pk_mul_f32 v[64:65], v[64:65], v[96:97]
    v_pk_mul_f32 v[66:67], v[66:67], v[98:99]
    v_cvt_pk_bf16_f32 v31, v60, v61
    v_lshlrev_b32 v60, 16, v31
    v_and_b32 v61, 0xffff0000, v31
    v_cvt_pk_bf16_f32 v31, v62, v63
    v_lshlrev_b32 v62, 16, v31
    v_and_b32 v63, 0xffff0000, v31
    v_cvt_pk_bf16_f32 v31, v64, v65
    v_lshlrev_b32 v64, 16, v31
    v_and_b32 v65, 0xffff0000, v31
    v_cvt_pk_bf16_f32 v31, v66, v67
    v_lshlrev_b32 v66, 16, v31
    v_and_b32 v67, 0xffff0000, v31
    v_pk_add_f32 v[60:61], v[60:61], v[124:125]
    v_pk_add_f32 v[62:63], v[62:63], v[126:127]
    s_waitcnt lgkmcnt(8)
    v_pk_add_f32 v[64:65], v[64:65], v[128:129]
    v_pk_add_f32 v[66:67], v[66:67], v[130:131]
    v_cvt_pk_bf16_f32 v40, v60, v61
    v_cvt_pk_bf16_f32 v41, v62, v63
    v_cvt_pk_bf16_f32 v42, v64, v65
    v_cvt_pk_bf16_f32 v43, v66, v67
    s_add_u32 s24, s23, 2048
    buffer_store_dwordx4 v[40:43], v23, s[8:11], s24 offen sc1
    s_waitcnt lgkmcnt(7)
    v_pk_mul_f32 v[68:69], v[68:69], v[100:101]
    v_pk_mul_f32 v[70:71], v[70:71], v[102:103]
    s_waitcnt lgkmcnt(5)
    v_pk_mul_f32 v[72:73], v[72:73], v[104:105]
    v_pk_mul_f32 v[74:75], v[74:75], v[106:107]
    v_cvt_pk_bf16_f32 v31, v68, v69
    v_lshlrev_b32 v68, 16, v31
    v_and_b32 v69, 0xffff0000, v31
    v_cvt_pk_bf16_f32 v31, v70, v71
    v_lshlrev_b32 v70, 16, v31
    v_and_b32 v71, 0xffff0000, v31
    v_cvt_pk_bf16_f32 v31, v72, v73
    v_lshlrev_b32 v72, 16, v31
    v_and_b32 v73, 0xffff0000, v31
    v_cvt_pk_bf16_f32 v31, v74, v75
    v_lshlrev_b32 v74, 16, v31
    v_and_b32 v75, 0xffff0000, v31
    v_pk_add_f32 v[68:69], v[68:69], v[132:133]
    v_pk_add_f32 v[70:71], v[70:71], v[134:135]
    s_waitcnt lgkmcnt(4)
    v_pk_add_f32 v[72:73], v[72:73], v[136:137]
    v_pk_add_f32 v[74:75], v[74:75], v[138:139]
    v_cvt_pk_bf16_f32 v44, v68, v69
    v_cvt_pk_bf16_f32 v45, v70, v71
    v_cvt_pk_bf16_f32 v46, v72, v73
    v_cvt_pk_bf16_f32 v47, v74, v75
    s_add_u32 s24, s23, 4096
    buffer_store_dwordx4 v[44:47], v23, s[8:11], s24 offen sc1
    s_waitcnt lgkmcnt(3)
    v_pk_mul_f32 v[76:77], v[76:77], v[108:109]
    v_pk_mul_f32 v[78:79], v[78:79], v[110:111]
    s_waitcnt lgkmcnt(1)
    v_pk_mul_f32 v[80:81], v[80:81], v[112:113]
    v_pk_mul_f32 v[82:83], v[82:83], v[114:115]
    v_cvt_pk_bf16_f32 v31, v76, v77
    v_lshlrev_b32 v76, 16, v31
    v_and_b32 v77, 0xffff0000, v31
    v_cvt_pk_bf16_f32 v31, v78, v79
    v_lshlrev_b32 v78, 16, v31
    v_and_b32 v79, 0xffff0000, v31
    v_cvt_pk_bf16_f32 v31, v80, v81
    v_lshlrev_b32 v80, 16, v31
    v_and_b32 v81, 0xffff0000, v31
    v_cvt_pk_bf16_f32 v31, v82, v83
    v_lshlrev_b32 v82, 16, v31
    v_and_b32 v83, 0xffff0000, v31
    v_pk_add_f32 v[76:77], v[76:77], v[140:141]
    v_pk_add_f32 v[78:79], v[78:79], v[142:143]
    s_waitcnt lgkmcnt(0)
    v_pk_add_f32 v[80:81], v[80:81], v[144:145]
    v_pk_add_f32 v[82:83], v[82:83], v[146:147]
    v_cvt_pk_bf16_f32 v48, v76, v77
    v_cvt_pk_bf16_f32 v49, v78, v79
    v_cvt_pk_bf16_f32 v50, v80, v81
    v_cvt_pk_bf16_f32 v51, v82, v83
    s_add_u32 s24, s23, 6144
    buffer_store_dwordx4 v[48:51], v23, s[8:11], s24 offen sc1
    s_lshl_b32 s26, s2, 7
    s_lshl_b32 s27, s3, 2
    s_add_u32 s26, s26, s27
    s_add_u32 s26, s26, 0x510000
    v_mov_b32 v24, s14
    s_waitcnt vmcnt(0)
    s_mov_b64 exec, 1
    buffer_store_dword v24, v25, s[8:11], s26 offen sc1
    s_mov_b64 exec, -1
    s_add_u32 s22, s16, 0x0
    s_add_u32 m0, s17, 0x0
    s_nop 0
    buffer_load_dwordx4 v2, s[4:7], s22 offen lds
    s_add_u32 s22, s16, 0x8000
    s_add_u32 m0, s17, 0x400
    s_nop 0
    buffer_load_dwordx4 v2, s[4:7], s22 offen lds
    s_add_u32 s22, s16, 0x10000
    s_add_u32 m0, s17, 0x800
    s_nop 0
    buffer_load_dwordx4 v16, s[4:7], s22 offen lds
    s_add_u32 s22, s16, 0x18000
    s_add_u32 m0, s17, 0xc00
    s_nop 0
    buffer_load_dwordx4 v16, s[4:7], s22 offen lds
    s_add_u32 s22, s16, 0x80000
    s_add_u32 m0, s17, 0x4000
    s_nop 0
    buffer_load_dwordx4 v2, s[4:7], s22 offen lds
    s_add_u32 s22, s16, 0x88000
    s_add_u32 m0, s17, 0x4400
    s_nop 0
    buffer_load_dwordx4 v2, s[4:7], s22 offen lds
    s_add_u32 s22, s16, 0x90000
    s_add_u32 m0, s17, 0x4800
    s_nop 0
    buffer_load_dwordx4 v16, s[4:7], s22 offen lds
    s_add_u32 s22, s16, 0x98000
    s_add_u32 m0, s17, 0x4c00
    s_nop 0
    buffer_load_dwordx4 v16, s[4:7], s22 offen lds
    s_add_u32 s22, s16, 0x100000
    s_add_u32 m0, s17, 0x8000
    s_nop 0
    buffer_load_dwordx4 v2, s[4:7], s22 offen lds
    s_add_u32 s22, s16, 0x108000
    s_add_u32 m0, s17, 0x8400
    s_nop 0
    buffer_load_dwordx4 v2, s[4:7], s22 offen lds
    s_add_u32 s22, s16, 0x110000
    s_add_u32 m0, s17, 0x8800
    s_nop 0
    buffer_load_dwordx4 v16, s[4:7], s22 offen lds
    s_add_u32 s22, s16, 0x118000
    s_add_u32 m0, s17, 0x8c00
    s_nop 0
    buffer_load_dwordx4 v16, s[4:7], s22 offen lds
    s_barrier
    s_lshl_b32 s26, s13, 5
    s_lshl_b32 s25, s3, 2
    s_add_u32 s26, s26, s25
    v_bfe_u32 v9, v0, 2, 2
    v_lshlrev_b32 v9, 7, v9
    v_and_b32 v10, 3, v0
    v_lshl_add_u32 v9, v10, 2, v9
    s_lshl_b32 s26, s26, 7
    s_add_u32 s26, s26, 0x510000
    s_mov_b32 s27, 0
fz_hAp:
    buffer_load_dword v10, v9, s[8:11], s26 offen sc1
    s_waitcnt vmcnt(0)
    v_cmp_ne_u32 vcc, s14, v10
    s_add_u32 s27, s27, 1
    s_cmp_ge_u32 s27, 65536
    s_cbranch_scc1 fz_hAg
    s_cbranch_vccz fz_hAg
    s_sleep 4
    s_branch fz_hAp
fz_hAg:
    s_mov_b32 s23, 0x0
    buffer_load_dwordx4 v[204:207], v4, s[8:11], s23 offen offset:0 sc1
    s_mov_b32 s23, 0x8000
    buffer_load_dwordx4 v[208:211], v4, s[8:11], s23 offen offset:0 sc1
    s_mov_b32 s23, 0x0
    buffer_load_dwordx4 v[212:215], v4, s[8:11], s23 offen offset:1024 sc1
    s_mov_b32 s23, 0x8000
    buffer_load_dwordx4 v[216:219], v4, s[8:11], s23 offen offset:1024 sc1
    s_barrier
    ds_read_b64_tr_b16 v[84:85], v3 offset:0
    ds_read_b64_tr_b16 v[86:87], v3 offset:1024
    ds_read_b64_tr_b16 v[88:89], v15 offset:32
    ds_read_b64_tr_b16 v[90:91], v15 offset:1056
    ds_read_b64_tr_b16 v[92:93], v3 offset:256
    ds_read_b64_tr_b16 v[94:95], v3 offset:1280
    ds_read_b64_tr_b16 v[96:97], v15 offset:288
    ds_read_b64_tr_b16 v[98:99], v15 offset:1312
    s_waitcnt vmcnt(3) lgkmcnt(6)
    v_mfma_f32_16x16x32_bf16 v[20:23], v[84:87], v[204:207], 0
    s_mov_b32 s23, 0x800
    buffer_load_dwordx4 v[220:223], v4, s[8:11], s23 offen offset:0 sc1
    ds_read_b64_tr_b16 v[100:101], v3 offset:512
    s_waitcnt vmcnt(3)
    v_mfma_f32_16x16x32_bf16 v[24:27], v[84:87], v[208:211], 0
    ds_read_b64_tr_b16 v[102:103], v3 offset:1536
    s_waitcnt lgkmcnt(6)
    v_mfma_f32_16x16x32_bf16 v[28:31], v[88:91], v[204:207], 0
    s_mov_b32 s23, 0x8800
    buffer_load_dwordx4 v[224:227], v4, s[8:11], s23 offen offset:0 sc1
    ds_read_b64_tr_b16 v[104:105], v15 offset:544
    v_mfma_f32_16x16x32_bf16 v[32:35], v[88:91], v[208:211], 0
    ds_read_b64_tr_b16 v[106:107], v15 offset:1568
    s_waitcnt lgkmcnt(6)
    v_mfma_f32_16x16x32_bf16 v[36:39], v[92:95], v[204:207], 0
    s_mov_b32 s23, 0x800
    buffer_load_dwordx4 v[228:231], v4, s[8:11], s23 offen offset:1024 sc1
    ds_read_b64_tr_b16 v[84:85], v3 offset:768
    v_mfma_f32_16x16x32_bf16 v[40:43], v[92:95], v[208:211], 0
    ds_read_b64_tr_b16 v[86:87], v3 offset:1792
    s_waitcnt lgkmcnt(6)
    v_mfma_f32_16x16x32_bf16 v[44:47], v[96:99], v[204:207], 0
    s_mov_b32 s23, 0x8800
    buffer_load_dwordx4 v[232:235], v4, s[8:11], s23 offen offset:1024 sc1
    ds_read_b64_tr_b16 v[88:89], v15 offset:800
    v_mfma_f32_16x16x32_bf16 v[48:51], v[96:99], v[208:211], 0
    ds_read_b64_tr_b16 v[90:91], v15 offset:1824
    s_mov_b32 s23, 0x1000
    buffer_load_dwordx4 v[140:143], v4, s[8:11], s23 offen offset:0 sc1
    s_waitcnt lgkmcnt(6)
    v_mfma_f32_16x16x32_bf16 v[52:55], v[100:103], v[204:207], 0
    ds_read_b64_tr_b16 v[92:93], v3 offset:8192
    v_mfma_f32_16x16x32_bf16 v[56:59], v[100:103], v[208:211], 0
    ds_read_b64_tr_b16 v[94:95], v3 offset:9216
    s_waitcnt lgkmcnt(6)
    v_mfma_f32_16x16x32_bf16 v[60:63], v[104:107], v[204:207], 0
    ds_read_b64_tr_b16 v[96:97], v15 offset:8224
    v_mfma_f32_16x16x32_bf16 v[64:67], v[104:107], v[208:211], 0
    ds_read_b64_tr_b16 v[98:99], v15 offset:9248
    s_waitcnt lgkmcnt(6)
    v_mfma_f32_16x16x32_bf16 v[68:71], v[84:87], v[204:207], 0
    ds_read_b64_tr_b16 v[100:101], v3 offset:8448
    v_mfma_f32_16x16x32_bf16 v[72:75], v[84:87], v[208:211], 0
    ds_read_b64_tr_b16 v[102:103], v3 offset:9472
    s_waitcnt lgkmcnt(6)
    v_mfma_f32_16x16x32_bf16 v[76:79], v[88:91], v[204:207], 0
    ds_read_b64_tr_b16 v[104:105], v15 offset:8480
    v_mfma_f32_16x16x32_bf16 v[80:83], v[88:91], v[208:211], 0
    ds_read_b64_tr_b16 v[106:107], v15 offset:9504
    s_mov_b32 s23, 0x9000
    buffer_load_dwordx4 v[144:147], v4, s[8:11], s23 offen offset:0 sc1
    s_waitcnt vmcnt(7) lgkmcnt(6)
    v_mfma_f32_16x16x32_bf16 v[20:23], v[92:95], v[212:215], v[20:23]
    ds_read_b64_tr_b16 v[84:85], v3 offset:8704
    s_waitcnt vmcnt(6)
    v_mfma_f32_16x16x32_bf16 v[24:27], v[92:95], v[216:219], v[24:27]
    ds_read_b64_tr_b16 v[86:87], v3 offset:9728
    s_waitcnt lgkmcnt(6)
    v_mfma_f32_16x16x32_bf16 v[28:31], v[96:99], v[212:215], v[28:31]
    ds_read_b64_tr_b16 v[88:89], v15 offset:8736
    v_mfma_f32_16x16x32_bf16 v[32:35], v[96:99], v[216:219], v[32:35]
    ds_read_b64_tr_b16 v[90:91], v15 offset:9760
    s_waitcnt lgkmcnt(6)
    v_mfma_f32_16x16x32_bf16 v[36:39], v[100:103], v[212:215], v[36:39]
    ds_read_b64_tr_b16 v[92:93], v3 offset:8960
    v_mfma_f32_16x16x32_bf16 v[40:43], v[100:103], v[216:219], v[40:43]
    ds_read_b64_tr_b16 v[94:95], v3 offset:9984
    s_waitcnt lgkmcnt(6)
    v_mfma_f32_16x16x32_bf16 v[44:47], v[104:107], v[212:215], v[44:47]
    ds_read_b64_tr_b16 v[96:97], v15 offset:8992
    v_mfma_f32_16x16x32_bf16 v[48:51], v[104:107], v[216:219], v[48:51]
    ds_read_b64_tr_b16 v[98:99], v15 offset:10016
    s_mov_b32 s23, 0x1000
    buffer_load_dwordx4 v[148:151], v4, s[8:11], s23 offen offset:1024 sc1
    s_waitcnt lgkmcnt(6)
    v_mfma_f32_16x16x32_bf16 v[52:55], v[84:87], v[212:215], v[52:55]
    v_mfma_f32_16x16x32_bf16 v[56:59], v[84:87], v[216:219], v[56:59]
    s_barrier
    ds_read_b64_tr_b16 v[100:101], v3 offset:16384
    ds_read_b64_tr_b16 v[102:103], v3 offset:17408
    s_waitcnt lgkmcnt(6)
    v_mfma_f32_16x16x32_bf16 v[60:63], v[88:91], v[212:215], v[60:63]
    ds_read_b64_tr_b16 v[104:105], v15 offset:16416
    v_mfma_f32_16x16x32_bf16 v[64:67], v[88:91], v[216:219], v[64:67]
    s_add_u32 s22, s16, 0x180000
    s_add_u32 m0, s17, 0xc000
    s_nop 0
    buffer_load_dwordx4 v2, s[4:7], s22 offen lds
    ds_read_b64_tr_b16 v[106:107], v15 offset:17440
    s_waitcnt lgkmcnt(6)
    v_mfma_f32_16x16x32_bf16 v[68:71], v[92:95], v[212:215], v[68:71]
    ds_read_b64_tr_b16 v[84:85], v3 offset:16640
    v_mfma_f32_16x16x32_bf16 v[72:75], v[92:95], v[216:219], v[72:75]
    ds_read_b64_tr_b16 v[86:87], v3 offset:17664
    s_waitcnt lgkmcnt(6)
    v_mfma_f32_16x16x32_bf16 v[76:79], v[96:99], v[212:215], v[76:79]
    ds_read_b64_tr_b16 v[88:89], v15 offset:16672
    v_mfma_f32_16x16x32_bf16 v[80:83], v[96:99], v[216:219], v[80:83]
    ds_read_b64_tr_b16 v[90:91], v15 offset:17696
    s_mov_b32 s23, 0x9000
    buffer_load_dwordx4 v[152:155], v4, s[8:11], s23 offen offset:1024 sc1
    s_waitcnt vmcnt(8) lgkmcnt(6)
    v_mfma_f32_16x16x32_bf16 v[20:23], v[100:103], v[220:223], v[20:23]
    ds_read_b64_tr_b16 v[92:93], v3 offset:16896
    s_waitcnt vmcnt(7)
    v_mfma_f32_16x16x32_bf16 v[24:27], v[100:103], v[224:227], v[24:27]
    ds_read_b64_tr_b16 v[94:95], v3 offset:17920
    s_waitcnt lgkmcnt(6)
    v_mfma_f32_16x16x32_bf16 v[28:31], v[104:107], v[220:223], v[28:31]
    ds_read_b64_tr_b16 v[96:97], v15 offset:16928
    v_mfma_f32_16x16x32_bf16 v[32:35], v[104:107], v[224:227], v[32:35]
    s_add_u32 s22, s16, 0x188000
    s_add_u32 m0, s17, 0xc400
    s_nop 0
    buffer_load_dwordx4 v2, s[4:7], s22 offen lds
    ds_read_b64_tr_b16 v[98:99], v15 offset:17952
    s_waitcnt lgkmcnt(6)
    v_mfma_f32_16x16x32_bf16 v[36:39], v[84:87], v[220:223], v[36:39]
    ds_read_b64_tr_b16 v[100:101], v3 offset:17152
    v_mfma_f32_16x16x32_bf16 v[40:43], v[84:87], v[224:227], v[40:43]
    ds_read_b64_tr_b16 v[102:103], v3 offset:18176
    s_waitcnt lgkmcnt(6)
    v_mfma_f32_16x16x32_bf16 v[44:47], v[88:91], v[220:223], v[44:47]
    ds_read_b64_tr_b16 v[104:105], v15 offset:17184
    v_mfma_f32_16x16x32_bf16 v[48:51], v[88:91], v[224:227], v[48:51]
    ds_read_b64_tr_b16 v[106:107], v15 offset:18208
    s_mov_b32 s23, 0x1800
    buffer_load_dwordx4 v[204:207], v4, s[8:11], s23 offen offset:0 sc1
    s_waitcnt lgkmcnt(6)
    v_mfma_f32_16x16x32_bf16 v[52:55], v[92:95], v[220:223], v[52:55]
    ds_read_b64_tr_b16 v[84:85], v3 offset:24576
    v_mfma_f32_16x16x32_bf16 v[56:59], v[92:95], v[224:227], v[56:59]
    ds_read_b64_tr_b16 v[86:87], v3 offset:25600
    s_waitcnt lgkmcnt(6)
    v_mfma_f32_16x16x32_bf16 v[60:63], v[96:99], v[220:223], v[60:63]
    ds_read_b64_tr_b16 v[88:89], v15 offset:24608
    v_mfma_f32_16x16x32_bf16 v[64:67], v[96:99], v[224:227], v[64:67]
    s_add_u32 s22, s16, 0x190000
    s_add_u32 m0, s17, 0xc800
    s_nop 0
    buffer_load_dwordx4 v16, s[4:7], s22 offen lds
    ds_read_b64_tr_b16 v[90:91], v15 offset:25632
    s_waitcnt lgkmcnt(6)
    v_mfma_f32_16x16x32_bf16 v[68:71], v[100:103], v[220:223], v[68:71]
    ds_read_b64_tr_b16 v[92:93], v3 offset:24832
    v_mfma_f32_16x16x32_bf16 v[72:75], v[100:103], v[224:227], v[72:75]
    ds_read_b64_tr_b16 v[94:95], v3 offset:25856
    s_waitcnt lgkmcnt(6)
    v_mfma_f32_16x16x32_bf16 v[76:79], v[104:107], v[220:223], v[76:79]
    ds_read_b64_tr_b16 v[96:97], v15 offset:24864
    v_mfma_f32_16x16x32_bf16 v[80:83], v[104:107], v[224:227], v[80:83]
    ds_read_b64_tr_b16 v[98:99], v15 offset:25888
    s_mov_b32 s23, 0x9800
    buffer_load_dwordx4 v[208:211], v4, s[8:11], s23 offen offset:0 sc1
    s_waitcnt vmcnt(10) lgkmcnt(6)
    v_mfma_f32_16x16x32_bf16 v[20:23], v[84:87], v[228:231], v[20:23]
    ds_read_b64_tr_b16 v[100:101], v3 offset:25088
    s_waitcnt vmcnt(9)
    v_mfma_f32_16x16x32_bf16 v[24:27], v[84:87], v[232:235], v[24:27]
    ds_read_b64_tr_b16 v[102:103], v3 offset:26112
    s_waitcnt lgkmcnt(6)
    v_mfma_f32_16x16x32_bf16 v[28:31], v[88:91], v[228:231], v[28:31]
    ds_read_b64_tr_b16 v[104:105], v15 offset:25120
    v_mfma_f32_16x16x32_bf16 v[32:35], v[88:91], v[232:235], v[32:35]
    s_add_u32 s22, s16, 0x198000
    s_add_u32 m0, s17, 0xcc00
    s_nop 0
    buffer_load_dwordx4 v16, s[4:7], s22 offen lds
    ds_read_b64_tr_b16 v[106:107], v15 offset:26144
    s_waitcnt lgkmcnt(6)
    v_mfma_f32_16x16x32_bf16 v[36:39], v[92:95], v[228:231], v[36:39]
    ds_read_b64_tr_b16 v[84:85], v3 offset:25344
    v_mfma_f32_16x16x32_bf16 v[40:43], v[92:95], v[232:235], v[40:43]
    ds_read_b64_tr_b16 v[86:87], v3 offset:26368
    s_waitcnt lgkmcnt(6)
    v_mfma_f32_16x16x32_bf16 v[44:47], v[96:99], v[228:231], v[44:47]
    ds_read_b64_tr_b16 v[88:89], v15 offset:25376
    v_mfma_f32_16x16x32_bf16 v[48:51], v[96:99], v[232:235], v[48:51]
    ds_read_b64_tr_b16 v[90:91], v15 offset:26400
    s_mov_b32 s23, 0x1800
    buffer_load_dwordx4 v[212:215], v4, s[8:11], s23 offen offset:1024 sc1
    s_waitcnt lgkmcnt(6)
    v_mfma_f32_16x16x32_bf16 v[52:55], v[100:103], v[228:231], v[52:55]
    v_mfma_f32_16x16x32_bf16 v[56:59], v[100:103], v[232:235], v[56:59]
    s_barrier
    ds_read_b64_tr_b16 v[92:93], v3 offset:32768
    ds_read_b64_tr_b16 v[94:95], v3 offset:33792
    s_waitcnt lgkmcnt(6)
    v_mfma_f32_16x16x32_bf16 v[60:63], v[104:107], v[228:231], v[60:63]
    ds_read_b64_tr_b16 v[96:97], v15 offset:32800
    v_mfma_f32_16x16x32_bf16 v[64:67], v[104:107], v[232:235], v[64:67]
    s_add_u32 s22, s16, 0x200000
    s_add_u32 m0, s17, 0x0
    s_nop 0
    buffer_load_dwordx4 v2, s[4:7], s22 offen lds
    ds_read_b64_tr_b16 v[98:99], v15 offset:33824
    s_waitcnt lgkmcnt(6)
    v_mfma_f32_16x16x32_bf16 v[68:71], v[84:87], v[228:231], v[68:71]
    ds_read_b64_tr_b16 v[100:101], v3 offset:33024
    v_mfma_f32_16x16x32_bf16 v[72:75], v[84:87], v[232:235], v[72:75]
    ds_read_b64_tr_b16 v[102:103], v3 offset:34048
    s_waitcnt lgkmcnt(6)
    v_mfma_f32_16x16x32_bf16 v[76:79], v[88:91], v[228:231], v[76:79]
    ds_read_b64_tr_b16 v[104:105], v15 offset:33056
    v_mfma_f32_16x16x32_bf16 v[80:83], v[88:91], v[232:235], v[80:83]
    ds_read_b64_tr_b16 v[106:107], v15 offset:34080
    s_mov_b32 s23, 0x9800
    buffer_load_dwordx4 v[216:219], v4, s[8:11], s23 offen offset:1024 sc1
    s_waitcnt vmcnt(12) lgkmcnt(6)
    v_mfma_f32_16x16x32_bf16 v[20:23], v[92:95], v[140:143], v[20:23]
    ds_read_b64_tr_b16 v[84:85], v3 offset:33280
    s_waitcnt vmcnt(11)
    v_mfma_f32_16x16x32_bf16 v[24:27], v[92:95], v[144:147], v[24:27]
    ds_read_b64_tr_b16 v[86:87], v3 offset:34304
    s_waitcnt lgkmcnt(6)
    v_mfma_f32_16x16x32_bf16 v[28:31], v[96:99], v[140:143], v[28:31]
    ds_read_b64_tr_b16 v[88:89], v15 offset:33312
    v_mfma_f32_16x16x32_bf16 v[32:35], v[96:99], v[144:147], v[32:35]
    s_add_u32 s22, s16, 0x208000
    s_add_u32 m0, s17, 0x400
    s_nop 0
    buffer_load_dwordx4 v2, s[4:7], s22 offen lds
    ds_read_b64_tr_b16 v[90:91], v15 offset:34336
    s_waitcnt lgkmcnt(6)
    v_mfma_f32_16x16x32_bf16 v[36:39], v[100:103], v[140:143], v[36:39]
    ds_read_b64_tr_b16 v[92:93], v3 offset:33536
    v_mfma_f32_16x16x32_bf16 v[40:43], v[100:103], v[144:147], v[40:43]
    ds_read_b64_tr_b16 v[94:95], v3 offset:34560
    s_waitcnt lgkmcnt(6)
    v_mfma_f32_16x16x32_bf16 v[44:47], v[104:107], v[140:143], v[44:47]
    ds_read_b64_tr_b16 v[96:97], v15 offset:33568
    v_mfma_f32_16x16x32_bf16 v[48:51], v[104:107], v[144:147], v[48:51]
    ds_read_b64_tr_b16 v[98:99], v15 offset:34592
    s_mov_b32 s23, 0x2000
    buffer_load_dwordx4 v[220:223], v4, s[8:11], s23 offen offset:0 sc1
    s_waitcnt lgkmcnt(6)
    v_mfma_f32_16x16x32_bf16 v[52:55], v[84:87], v[140:143], v[52:55]
    ds_read_b64_tr_b16 v[100:101], v3 offset:40960
    v_mfma_f32_16x16x32_bf16 v[56:59], v[84:87], v[144:147], v[56:59]
    ds_read_b64_tr_b16 v[102:103], v3 offset:41984
    s_waitcnt lgkmcnt(6)
    v_mfma_f32_16x16x32_bf16 v[60:63], v[88:91], v[140:143], v[60:63]
    ds_read_b64_tr_b16 v[104:105], v15 offset:40992
    v_mfma_f32_16x16x32_bf16 v[64:67], v[88:91], v[144:147], v[64:67]
    s_add_u32 s22, s16, 0x210000
    s_add_u32 m0, s17, 0x800
    s_nop 0
    buffer_load_dwordx4 v16, s[4:7], s22 offen lds
    ds_read_b64_tr_b16 v[106:107], v15 offset:42016
    s_waitcnt lgkmcnt(6)
    v_mfma_f32_16x16x32_bf16 v[68:71], v[92:95], v[140:143], v[68:71]
    ds_read_b64_tr_b16 v[84:85], v3 offset:41216
    v_mfma_f32_16x16x32_bf16 v[72:75], v[92:95], v[144:147], v[72:75]
    ds_read_b64_tr_b16 v[86:87], v3 offset:42240
    s_waitcnt lgkmcnt(6)
    v_mfma_f32_16x16x32_bf16 v[76:79], v[96:99], v[140:143], v[76:79]
    ds_read_b64_tr_b16 v[88:89], v15 offset:41248
    v_mfma_f32_16x16x32_bf16 v[80:83], v[96:99], v[144:147], v[80:83]
    ds_read_b64_tr_b16 v[90:91], v15 offset:42272
    s_mov_b32 s23, 0xa000
    buffer_load_dwordx4 v[224:227], v4, s[8:11], s23 offen offset:0 sc1
    s_waitcnt vmcnt(14) lgkmcnt(6)
    v_mfma_f32_16x16x32_bf16 v[20:23], v[100:103], v[148:151], v[20:23]
    ds_read_b64_tr_b16 v[92:93], v3 offset:41472
    s_waitcnt vmcnt(12)
    v_mfma_f32_16x16x32_bf16 v[24:27], v[100:103], v[152:155], v[24:27]
    ds_read_b64_tr_b16 v[94:95], v3 offset:42496
    s_waitcnt lgkmcnt(6)
    v_mfma_f32_16x16x32_bf16 v[28:31], v[104:107], v[148:151], v[28:31]
    ds_read_b64_tr_b16 v[96:97], v15 offset:41504
    v_mfma_f32_16x16x32_bf16 v[32:35], v[104:107], v[152:155], v[32:35]
    s_add_u32 s22, s16, 0x218000
    s_add_u32 m0, s17, 0xc00
    s_nop 0
    buffer_load_dwordx4 v16, s[4:7], s22 offen lds
    ds_read_b64_tr_b16 v[98:99], v15 offset:42528
    s_waitcnt lgkmcnt(6)
    v_mfma_f32_16x16x32_bf16 v[36:39], v[84:87], v[148:151], v[36:39]
    ds_read_b64_tr_b16 v[100:101], v3 offset:41728
    v_mfma_f32_16x16x32_bf16 v[40:43], v[84:87], v[152:155], v[40:43]
    ds_read_b64_tr_b16 v[102:103], v3 offset:42752
    s_waitcnt lgkmcnt(6)
    v_mfma_f32_16x16x32_bf16 v[44:47], v[88:91], v[148:151], v[44:47]
    ds_read_b64_tr_b16 v[104:105], v15 offset:41760
    v_mfma_f32_16x16x32_bf16 v[48:51], v[88:91], v[152:155], v[48:51]
    ds_read_b64_tr_b16 v[106:107], v15 offset:42784
    s_mov_b32 s23, 0x2000
    buffer_load_dwordx4 v[228:231], v4, s[8:11], s23 offen offset:1024 sc1
    s_waitcnt lgkmcnt(6)
    v_mfma_f32_16x16x32_bf16 v[52:55], v[92:95], v[148:151], v[52:55]
    v_mfma_f32_16x16x32_bf16 v[56:59], v[92:95], v[152:155], v[56:59]
    s_waitcnt vmcnt(9)
    s_barrier
    ds_read_b64_tr_b16 v[84:85], v3 offset:49152
    ds_read_b64_tr_b16 v[86:87], v3 offset:50176
    s_waitcnt lgkmcnt(6)
    v_mfma_f32_16x16x32_bf16 v[60:63], v[96:99], v[148:151], v[60:63]
    ds_read_b64_tr_b16 v[88:89], v15 offset:49184
    v_mfma_f32_16x16x32_bf16 v[64:67], v[96:99], v[152:155], v[64:67]
    s_add_u32 s22, s16, 0x280000
    s_add_u32 m0, s17, 0x4000
    s_nop 0
    buffer_load_dwordx4 v2, s[4:7], s22 offen lds
    ds_read_b64_tr_b16 v[90:91], v15 offset:50208
    s_waitcnt lgkmcnt(6)
    v_mfma_f32_16x16x32_bf16 v[68:71], v[100:103], v[148:151], v[68:71]
    ds_read_b64_tr_b16 v[92:93], v3 offset:49408
    v_mfma_f32_16x16x32_bf16 v[72:75], v[100:103], v[152:155], v[72:75]
    ds_read_b64_tr_b16 v[94:95], v3 offset:50432
    s_waitcnt lgkmcnt(6)
    v_mfma_f32_16x16x32_bf16 v[76:79], v[104:107], v[148:151], v[76:79]
    ds_read_b64_tr_b16 v[96:97], v15 offset:49440
    v_mfma_f32_16x16x32_bf16 v[80:83], v[104:107], v[152:155], v[80:83]
    ds_read_b64_tr_b16 v[98:99], v15 offset:50464
    s_mov_b32 s23, 0xa000
    buffer_load_dwordx4 v[232:235], v4, s[8:11], s23 offen offset:1024 sc1
    s_waitcnt lgkmcnt(6)
    v_mfma_f32_16x16x32_bf16 v[20:23], v[84:87], v[204:207], v[20:23]
    ds_read_b64_tr_b16 v[100:101], v3 offset:49664
    v_mfma_f32_16x16x32_bf16 v[24:27], v[84:87], v[208:211], v[24:27]
    ds_read_b64_tr_b16 v[102:103], v3 offset:50688
    s_waitcnt lgkmcnt(6)
    v_mfma_f32_16x16x32_bf16 v[28:31], v[88:91], v[204:207], v[28:31]
    ds_read_b64_tr_b16 v[104:105], v15 offset:49696
    v_mfma_f32_16x16x32_bf16 v[32:35], v[88:91], v[208:211], v[32:35]
    s_add_u32 s22, s16, 0x288000
    s_add_u32 m0, s17, 0x4400
    s_nop 0
    buffer_load_dwordx4 v2, s[4:7], s22 offen lds
    ds_read_b64_tr_b16 v[106:107], v15 offset:50720
    s_waitcnt lgkmcnt(6)
    v_mfma_f32_16x16x32_bf16 v[36:39], v[92:95], v[204:207], v[36:39]
    ds_read_b64_tr_b16 v[84:85], v3 offset:49920
    v_mfma_f32_16x16x32_bf16 v[40:43], v[92:95], v[208:211], v[40:43]
    ds_read_b64_tr_b16 v[86:87], v3 offset:50944
    s_waitcnt lgkmcnt(6)
    v_mfma_f32_16x16x32_bf16 v[44:47], v[96:99], v[204:207], v[44:47]
    ds_read_b64_tr_b16 v[88:89], v15 offset:49952
    v_mfma_f32_16x16x32_bf16 v[48:51], v[96:99], v[208:211], v[48:51]
    ds_read_b64_tr_b16 v[90:91], v15 offset:50976
    s_mov_b32 s23, 0x2800
    buffer_load_dwordx4 v[140:143], v4, s[8:11], s23 offen offset:0 sc1
    s_waitcnt lgkmcnt(6)
    v_mfma_f32_16x16x32_bf16 v[52:55], v[100:103], v[204:207], v[52:55]
    ds_read_b64_tr_b16 v[92:93], v3 offset:57344
    v_mfma_f32_16x16x32_bf16 v[56:59], v[100:103], v[208:211], v[56:59]
    ds_read_b64_tr_b16 v[94:95], v3 offset:58368
    s_waitcnt lgkmcnt(6)
    v_mfma_f32_16x16x32_bf16 v[60:63], v[104:107], v[204:207], v[60:63]
    ds_read_b64_tr_b16 v[96:97], v15 offset:57376
    v_mfma_f32_16x16x32_bf16 v[64:67], v[104:107], v[208:211], v[64:67]
    s_add_u32 s22, s16, 0x290000
    s_add_u32 m0, s17, 0x4800
    s_nop 0
    buffer_load_dwordx4 v16, s[4:7], s22 offen lds
    ds_read_b64_tr_b16 v[98:99], v15 offset:58400
    s_waitcnt lgkmcnt(6)
    v_mfma_f32_16x16x32_bf16 v[68:71], v[84:87], v[204:207], v[68:71]
    ds_read_b64_tr_b16 v[100:101], v3 offset:57600
    v_mfma_f32_16x16x32_bf16 v[72:75], v[84:87], v[208:211], v[72:75]
    ds_read_b64_tr_b16 v[102:103], v3 offset:58624
    s_waitcnt lgkmcnt(6)
    v_mfma_f32_16x16x32_bf16 v[76:79], v[88:91], v[204:207], v[76:79]
    ds_read_b64_tr_b16 v[104:105], v15 offset:57632
    v_mfma_f32_16x16x32_bf16 v[80:83], v[88:91], v[208:211], v[80:83]
    ds_read_b64_tr_b16 v[106:107], v15 offset:58656
    s_mov_b32 s23, 0xa800
    buffer_load_dwordx4 v[144:147], v4, s[8:11], s23 offen offset:0 sc1
    s_waitcnt vmcnt(14) lgkmcnt(6)
    v_mfma_f32_16x16x32_bf16 v[20:23], v[92:95], v[212:215], v[20:23]
    ds_read_b64_tr_b16 v[84:85], v3 offset:57856
    s_waitcnt vmcnt(12)
    v_mfma_f32_16x16x32_bf16 v[24:27], v[92:95], v[216:219], v[24:27]
    ds_read_b64_tr_b16 v[86:87], v3 offset:58880
    s_waitcnt lgkmcnt(6)
    v_mfma_f32_16x16x32_bf16 v[28:31], v[96:99], v[212:215], v[28:31]
    ds_read_b64_tr_b16 v[88:89], v15 offset:57888
    v_mfma_f32_16x16x32_bf16 v[32:35], v[96:99], v[216:219], v[32:35]
    s_add_u32 s22, s16, 0x298000
    s_add_u32 m0, s17, 0x4c00
    s_nop 0
    buffer_load_dwordx4 v16, s[4:7], s22 offen lds
    ds_read_b64_tr_b16 v[90:91], v15 offset:58912
    s_waitcnt lgkmcnt(6)
    v_mfma_f32_16x16x32_bf16 v[36:39], v[100:103], v[212:215], v[36:39]
    ds_read_b64_tr_b16 v[92:93], v3 offset:58112
    v_mfma_f32_16x16x32_bf16 v[40:43], v[100:103], v[216:219], v[40:43]
    ds_read_b64_tr_b16 v[94:95], v3 offset:59136
    s_waitcnt lgkmcnt(6)
    v_mfma_f32_16x16x32_bf16 v[44:47], v[104:107], v[212:215], v[44:47]
    ds_read_b64_tr_b16 v[96:97], v15 offset:58144
    v_mfma_f32_16x16x32_bf16 v[48:51], v[104:107], v[216:219], v[48:51]
    ds_read_b64_tr_b16 v[98:99], v15 offset:59168
    s_mov_b32 s23, 0x2800
    buffer_load_dwordx4 v[148:151], v4, s[8:11], s23 offen offset:1024 sc1
    s_waitcnt lgkmcnt(6)
    v_mfma_f32_16x16x32_bf16 v[52:55], v[84:87], v[212:215], v[52:55]
    v_mfma_f32_16x16x32_bf16 v[56:59], v[84:87], v[216:219], v[56:59]
    s_waitcnt vmcnt(9)
    s_barrier
    ds_read_b64_tr_b16 v[100:101], v3 offset:0
    ds_read_b64_tr_b16 v[102:103], v3 offset:1024
    s_waitcnt lgkmcnt(6)
    v_mfma_f32_16x16x32_bf16 v[60:63], v[88:91], v[212:215], v[60:63]
    ds_read_b64_tr_b16 v[104:105], v15 offset:32
    v_mfma_f32_16x16x32_bf16 v[64:67], v[88:91], v[216:219], v[64:67]
    s_add_u32 s22, s16, 0x300000
    s_add_u32 m0, s17, 0x8000
    s_nop 0
    buffer_load_dwordx4 v2, s[4:7], s22 offen lds
    ds_read_b64_tr_b16 v[106:107], v15 offset:1056
    s_waitcnt lgkmcnt(6)
    v_mfma_f32_16x16x32_bf16 v[68:71], v[92:95], v[212:215], v[68:71]
    ds_read_b64_tr_b16 v[84:85], v3 offset:256
    v_mfma_f32_16x16x32_bf16 v[72:75], v[92:95], v[216:219], v[72:75]
    ds_read_b64_tr_b16 v[86:87], v3 offset:1280
    s_waitcnt lgkmcnt(6)
    v_mfma_f32_16x16x32_bf16 v[76:79], v[96:99], v[212:215], v[76:79]
    ds_read_b64_tr_b16 v[88:89], v15 offset:288
    v_mfma_f32_16x16x32_bf16 v[80:83], v[96:99], v[216:219], v[80:83]
    ds_read_b64_tr_b16 v[90:91], v15 offset:1312
    s_mov_b32 s23, 0xa800
    buffer_load_dwordx4 v[152:155], v4, s[8:11], s23 offen offset:1024 sc1
    s_waitcnt lgkmcnt(6)
    v_mfma_f32_16x16x32_bf16 v[20:23], v[100:103], v[220:223], v[20:23]
    ds_read_b64_tr_b16 v[92:93], v3 offset:512
    v_mfma_f32_16x16x32_bf16 v[24:27], v[100:103], v[224:227], v[24:27]
    ds_read_b64_tr_b16 v[94:95], v3 offset:1536
    s_waitcnt lgkmcnt(6)
    v_mfma_f32_16x16x32_bf16 v[28:31], v[104:107], v[220:223], v[28:31]
    ds_read_b64_tr_b16 v[96:97], v15 offset:544
    v_mfma_f32_16x16x32_bf16 v[32:35], v[104:107], v[224:227], v[32:35]
    s_add_u32 s22, s16, 0x308000
    s_add_u32 m0, s17, 0x8400
    s_nop 0
    buffer_load_dwordx4 v2, s[4:7], s22 offen lds
    ds_read_b64_tr_b16 v[98:99], v15 offset:1568
    s_waitcnt lgkmcnt(6)
    v_mfma_f32_16x16x32_bf16 v[36:39], v[84:87], v[220:223], v[36:39]
    ds_read_b64_tr_b16 v[100:101], v3 offset:768
    v_mfma_f32_16x16x32_bf16 v[40:43], v[84:87], v[224:227], v[40:43]
    ds_read_b64_tr_b16 v[102:103], v3 offset:1792
    s_waitcnt lgkmcnt(6)
    v_mfma_f32_16x16x32_bf16 v[44:47], v[88:91], v[220:223], v[44:47]
    ds_read_b64_tr_b16 v[104:105], v15 offset:800
    v_mfma_f32_16x16x32_bf16 v[48:51], v[88:91], v[224:227], v[48:51]
    ds_read_b64_tr_b16 v[106:107], v15 offset:1824
    s_mov_b32 s23, 0x3000
    buffer_load_dwordx4 v[204:207], v4, s[8:11], s23 offen offset:0 sc1
    s_waitcnt lgkmcnt(6)
    v_mfma_f32_16x16x32_bf16 v[52:55], v[92:95], v[220:223], v[52:55]
    ds_read_b64_tr_b16 v[84:85], v3 offset:8192
    v_mfma_f32_16x16x32_bf16 v[56:59], v[92:95], v[224:227], v[56:59]
    ds_read_b64_tr_b16 v[86:87], v3 offset:9216
    s_waitcnt lgkmcnt(6)
    v_mfma_f32_16x16x32_bf16 v[60:63], v[96:99], v[220:223], v[60:63]
    ds_read_b64_tr_b16 v[88:89], v15 offset:8224
    v_mfma_f32_16x16x32_bf16 v[64:67], v[96:99], v[224:227], v[64:67]
    s_add_u32 s22, s16, 0x310000
    s_add_u32 m0, s17, 0x8800
    s_nop 0
    buffer_load_dwordx4 v16, s[4:7], s22 offen lds
    ds_read_b64_tr_b16 v[90:91], v15 offset:9248
    s_waitcnt lgkmcnt(6)
    v_mfma_f32_16x16x32_bf16 v[68:71], v[100:103], v[220:223], v[68:71]
    ds_read_b64_tr_b16 v[92:93], v3 offset:8448
    v_mfma_f32_16x16x32_bf16 v[72:75], v[100:103], v[224:227], v[72:75]
    ds_read_b64_tr_b16 v[94:95], v3 offset:9472
    s_waitcnt lgkmcnt(6)
    v_mfma_f32_16x16x32_bf16 v[76:79], v[104:107], v[220:223], v[76:79]
    ds_read_b64_tr_b16 v[96:97], v15 offset:8480
    v_mfma_f32_16x16x32_bf16 v[80:83], v[104:107], v[224:227], v[80:83]
    ds_read_b64_tr_b16 v[98:99], v15 offset:9504
    s_mov_b32 s23, 0xb000
    buffer_load_dwordx4 v[208:211], v4, s[8:11], s23 offen offset:0 sc1
    s_waitcnt vmcnt(14) lgkmcnt(6)
    v_mfma_f32_16x16x32_bf16 v[20:23], v[84:87], v[228:231], v[20:23]
    ds_read_b64_tr_b16 v[100:101], v3 offset:8704
    s_waitcnt vmcnt(12)
    v_mfma_f32_16x16x32_bf16 v[24:27], v[84:87], v[232:235], v[24:27]
    ds_read_b64_tr_b16 v[102:103], v3 offset:9728
    s_waitcnt lgkmcnt(6)
    v_mfma_f32_16x16x32_bf16 v[28:31], v[88:91], v[228:231], v[28:31]
    ds_read_b64_tr_b16 v[104:105], v15 offset:8736
    v_mfma_f32_16x16x32_bf16 v[32:35], v[88:91], v[232:235], v[32:35]
    s_add_u32 s22, s16, 0x318000
    s_add_u32 m0, s17, 0x8c00
    s_nop 0
    buffer_load_dwordx4 v16, s[4:7], s22 offen lds
    ds_read_b64_tr_b16 v[106:107], v15 offset:9760
    s_waitcnt lgkmcnt(6)
    v_mfma_f32_16x16x32_bf16 v[36:39], v[92:95], v[228:231], v[36:39]
    ds_read_b64_tr_b16 v[84:85], v3 offset:8960
    v_mfma_f32_16x16x32_bf16 v[40:43], v[92:95], v[232:235], v[40:43]
    ds_read_b64_tr_b16 v[86:87], v3 offset:9984
    s_waitcnt lgkmcnt(6)
    v_mfma_f32_16x16x32_bf16 v[44:47], v[96:99], v[228:231], v[44:47]
    ds_read_b64_tr_b16 v[88:89], v15 offset:8992
    v_mfma_f32_16x16x32_bf16 v[48:51], v[96:99], v[232:235], v[48:51]
    ds_read_b64_tr_b16 v[90:91], v15 offset:10016
    s_mov_b32 s23, 0x3000
    buffer_load_dwordx4 v[212:215], v4, s[8:11], s23 offen offset:1024 sc1
    s_waitcnt lgkmcnt(6)
    v_mfma_f32_16x16x32_bf16 v[52:55], v[100:103], v[228:231], v[52:55]
    v_mfma_f32_16x16x32_bf16 v[56:59], v[100:103], v[232:235], v[56:59]
    s_waitcnt vmcnt(9)
    s_barrier
    ds_read_b64_tr_b16 v[92:93], v3 offset:16384
    ds_read_b64_tr_b16 v[94:95], v3 offset:17408
    s_waitcnt lgkmcnt(6)
    v_mfma_f32_16x16x32_bf16 v[60:63], v[104:107], v[228:231], v[60:63]
    ds_read_b64_tr_b16 v[96:97], v15 offset:16416
    v_mfma_f32_16x16x32_bf16 v[64:67], v[104:107], v[232:235], v[64:67]
    s_add_u32 s22, s16, 0x380000
    s_add_u32 m0, s17, 0xc000
    s_nop 0
    buffer_load_dwordx4 v2, s[4:7], s22 offen lds
    ds_read_b64_tr_b16 v[98:99], v15 offset:17440
    s_waitcnt lgkmcnt(6)
    v_mfma_f32_16x16x32_bf16 v[68:71], v[84:87], v[228:231], v[68:71]
    ds_read_b64_tr_b16 v[100:101], v3 offset:16640
    v_mfma_f32_16x16x32_bf16 v[72:75], v[84:87], v[232:235], v[72:75]
    ds_read_b64_tr_b16 v[102:103], v3 offset:17664
    s_waitcnt lgkmcnt(6)
    v_mfma_f32_16x16x32_bf16 v[76:79], v[88:91], v[228:231], v[76:79]
    ds_read_b64_tr_b16 v[104:105], v15 offset:16672
    v_mfma_f32_16x16x32_bf16 v[80:83], v[88:91], v[232:235], v[80:83]
    ds_read_b64_tr_b16 v[106:107], v15 offset:17696
    s_mov_b32 s23, 0xb000
    buffer_load_dwordx4 v[216:219], v4, s[8:11], s23 offen offset:1024 sc1
    s_waitcnt lgkmcnt(6)
    v_mfma_f32_16x16x32_bf16 v[20:23], v[92:95], v[140:143], v[20:23]
    ds_read_b64_tr_b16 v[84:85], v3 offset:16896
    v_mfma_f32_16x16x32_bf16 v[24:27], v[92:95], v[144:147], v[24:27]
    ds_read_b64_tr_b16 v[86:87], v3 offset:17920
    s_waitcnt lgkmcnt(6)
    v_mfma_f32_16x16x32_bf16 v[28:31], v[96:99], v[140:143], v[28:31]
    ds_read_b64_tr_b16 v[88:89], v15 offset:16928
    v_mfma_f32_16x16x32_bf16 v[32:35], v[96:99], v[144:147], v[32:35]
    s_add_u32 s22, s16, 0x388000
    s_add_u32 m0, s17, 0xc400
    s_nop 0
    buffer_load_dwordx4 v2, s[4:7], s22 offen lds
    ds_read_b64_tr_b16 v[90:91], v15 offset:17952
    s_waitcnt lgkmcnt(6)
    v_mfma_f32_16x16x32_bf16 v[36:39], v[100:103], v[140:143], v[36:39]
    ds_read_b64_tr_b16 v[92:93], v3 offset:17152
    v_mfma_f32_16x16x32_bf16 v[40:43], v[100:103], v[144:147], v[40:43]
    ds_read_b64_tr_b16 v[94:95], v3 offset:18176
    s_waitcnt lgkmcnt(6)
    v_mfma_f32_16x16x32_bf16 v[44:47], v[104:107], v[140:143], v[44:47]
    ds_read_b64_tr_b16 v[96:97], v15 offset:17184
    v_mfma_f32_16x16x32_bf16 v[48:51], v[104:107], v[144:147], v[48:51]
    ds_read_b64_tr_b16 v[98:99], v15 offset:18208
    s_mov_b32 s23, 0x3800
    buffer_load_dwordx4 v[220:223], v4, s[8:11], s23 offen offset:0 sc1
    s_waitcnt lgkmcnt(6)
    v_mfma_f32_16x16x32_bf16 v[52:55], v[84:87], v[140:143], v[52:55]
    ds_read_b64_tr_b16 v[100:101], v3 offset:24576
    v_mfma_f32_16x16x32_bf16 v[56:59], v[84:87], v[144:147], v[56:59]
    ds_read_b64_tr_b16 v[102:103], v3 offset:25600
    s_waitcnt lgkmcnt(6)
    v_mfma_f32_16x16x32_bf16 v[60:63], v[88:91], v[140:143], v[60:63]
    ds_read_b64_tr_b16 v[104:105], v15 offset:24608
    v_mfma_f32_16x16x32_bf16 v[64:67], v[88:91], v[144:147], v[64:67]
    s_add_u32 s22, s16, 0x390000
    s_add_u32 m0, s17, 0xc800
    s_nop 0
    buffer_load_dwordx4 v16, s[4:7], s22 offen lds
    ds_read_b64_tr_b16 v[106:107], v15 offset:25632
    s_waitcnt lgkmcnt(6)
    v_mfma_f32_16x16x32_bf16 v[68:71], v[92:95], v[140:143], v[68:71]
    ds_read_b64_tr_b16 v[84:85], v3 offset:24832
    v_mfma_f32_16x16x32_bf16 v[72:75], v[92:95], v[144:147], v[72:75]
    ds_read_b64_tr_b16 v[86:87], v3 offset:25856
    s_waitcnt lgkmcnt(6)
    v_mfma_f32_16x16x32_bf16 v[76:79], v[96:99], v[140:143], v[76:79]
    ds_read_b64_tr_b16 v[88:89], v15 offset:24864
    v_mfma_f32_16x16x32_bf16 v[80:83], v[96:99], v[144:147], v[80:83]
    ds_read_b64_tr_b16 v[90:91], v15 offset:25888
    s_mov_b32 s23, 0xb800
    buffer_load_dwordx4 v[224:227], v4, s[8:11], s23 offen offset:0 sc1
    s_waitcnt vmcnt(14) lgkmcnt(6)
    v_mfma_f32_16x16x32_bf16 v[20:23], v[100:103], v[148:151], v[20:23]
    ds_read_b64_tr_b16 v[92:93], v3 offset:25088
    s_waitcnt vmcnt(12)
    v_mfma_f32_16x16x32_bf16 v[24:27], v[100:103], v[152:155], v[24:27]
    ds_read_b64_tr_b16 v[94:95], v3 offset:26112
    s_waitcnt lgkmcnt(6)
    v_mfma_f32_16x16x32_bf16 v[28:31], v[104:107], v[148:151], v[28:31]
    ds_read_b64_tr_b16 v[96:97], v15 offset:25120
    v_mfma_f32_16x16x32_bf16 v[32:35], v[104:107], v[152:155], v[32:35]
    s_add_u32 s22, s16, 0x398000
    s_add_u32 m0, s17, 0xcc00
    s_nop 0
    buffer_load_dwordx4 v16, s[4:7], s22 offen lds
    ds_read_b64_tr_b16 v[98:99], v15 offset:26144
    s_waitcnt lgkmcnt(6)
    v_mfma_f32_16x16x32_bf16 v[36:39], v[84:87], v[148:151], v[36:39]
    ds_read_b64_tr_b16 v[100:101], v3 offset:25344
    v_mfma_f32_16x16x32_bf16 v[40:43], v[84:87], v[152:155], v[40:43]
    ds_read_b64_tr_b16 v[102:103], v3 offset:26368
    s_waitcnt lgkmcnt(6)
    v_mfma_f32_16x16x32_bf16 v[44:47], v[88:91], v[148:151], v[44:47]
    ds_read_b64_tr_b16 v[104:105], v15 offset:25376
    v_mfma_f32_16x16x32_bf16 v[48:51], v[88:91], v[152:155], v[48:51]
    ds_read_b64_tr_b16 v[106:107], v15 offset:26400
    s_mov_b32 s23, 0x3800
    buffer_load_dwordx4 v[228:231], v4, s[8:11], s23 offen offset:1024 sc1
    s_waitcnt lgkmcnt(6)
    v_mfma_f32_16x16x32_bf16 v[52:55], v[92:95], v[148:151], v[52:55]
    v_mfma_f32_16x16x32_bf16 v[56:59], v[92:95], v[152:155], v[56:59]
    s_waitcnt vmcnt(9)
    s_barrier
    ds_read_b64_tr_b16 v[84:85], v3 offset:32768
    ds_read_b64_tr_b16 v[86:87], v3 offset:33792
    s_waitcnt lgkmcnt(6)
    v_mfma_f32_16x16x32_bf16 v[60:63], v[96:99], v[148:151], v[60:63]
    ds_read_b64_tr_b16 v[88:89], v15 offset:32800
    v_mfma_f32_16x16x32_bf16 v[64:67], v[96:99], v[152:155], v[64:67]
    s_add_u32 s22, s16, 0x400000
    s_add_u32 m0, s17, 0x0
    s_nop 0
    buffer_load_dwordx4 v2, s[4:7], s22 offen lds
    ds_read_b64_tr_b16 v[90:91], v15 offset:33824
    s_waitcnt lgkmcnt(6)
    v_mfma_f32_16x16x32_bf16 v[68:71], v[100:103], v[148:151], v[68:71]
    ds_read_b64_tr_b16 v[92:93], v3 offset:33024
    v_mfma_f32_16x16x32_bf16 v[72:75], v[100:103], v[152:155], v[72:75]
    ds_read_b64_tr_b16 v[94:95], v3 offset:34048
    s_waitcnt lgkmcnt(6)
    v_mfma_f32_16x16x32_bf16 v[76:79], v[104:107], v[148:151], v[76:79]
    ds_read_b64_tr_b16 v[96:97], v15 offset:33056
    v_mfma_f32_16x16x32_bf16 v[80:83], v[104:107], v[152:155], v[80:83]
    ds_read_b64_tr_b16 v[98:99], v15 offset:34080
    s_mov_b32 s23, 0xb800
    buffer_load_dwordx4 v[232:235], v4, s[8:11], s23 offen offset:1024 sc1
    s_waitcnt lgkmcnt(6)
    v_mfma_f32_16x16x32_bf16 v[20:23], v[84:87], v[204:207], v[20:23]
    ds_read_b64_tr_b16 v[100:101], v3 offset:33280
    v_mfma_f32_16x16x32_bf16 v[24:27], v[84:87], v[208:211], v[24:27]
    ds_read_b64_tr_b16 v[102:103], v3 offset:34304
    s_waitcnt lgkmcnt(6)
    v_mfma_f32_16x16x32_bf16 v[28:31], v[88:91], v[204:207], v[28:31]
    ds_read_b64_tr_b16 v[104:105], v15 offset:33312
    v_mfma_f32_16x16x32_bf16 v[32:35], v[88:91], v[208:211], v[32:35]
    s_add_u32 s22, s16, 0x408000
    s_add_u32 m0, s17, 0x400
    s_nop 0
    buffer_load_dwordx4 v2, s[4:7], s22 offen lds
    ds_read_b64_tr_b16 v[106:107], v15 offset:34336
    s_waitcnt lgkmcnt(6)
    v_mfma_f32_16x16x32_bf16 v[36:39], v[92:95], v[204:207], v[36:39]
    ds_read_b64_tr_b16 v[84:85], v3 offset:33536
    v_mfma_f32_16x16x32_bf16 v[40:43], v[92:95], v[208:211], v[40:43]
    ds_read_b64_tr_b16 v[86:87], v3 offset:34560
    s_waitcnt lgkmcnt(6)
    v_mfma_f32_16x16x32_bf16 v[44:47], v[96:99], v[204:207], v[44:47]
    ds_read_b64_tr_b16 v[88:89], v15 offset:33568
    v_mfma_f32_16x16x32_bf16 v[48:51], v[96:99], v[208:211], v[48:51]
    ds_read_b64_tr_b16 v[90:91], v15 offset:34592
    s_mov_b32 s23, 0x4000
    buffer_load_dwordx4 v[140:143], v4, s[8:11], s23 offen offset:0 sc1
    s_waitcnt lgkmcnt(6)
    v_mfma_f32_16x16x32_bf16 v[52:55], v[100:103], v[204:207], v[52:55]
    ds_read_b64_tr_b16 v[92:93], v3 offset:40960
    v_mfma_f32_16x16x32_bf16 v[56:59], v[100:103], v[208:211], v[56:59]
    ds_read_b64_tr_b16 v[94:95], v3 offset:41984
    s_waitcnt lgkmcnt(6)
    v_mfma_f32_16x16x32_bf16 v[60:63], v[104:107], v[204:207], v[60:63]
    ds_read_b64_tr_b16 v[96:97], v15 offset:40992
    v_mfma_f32_16x16x32_bf16 v[64:67], v[104:107], v[208:211], v[64:67]
    s_add_u32 s22, s16, 0x410000
    s_add_u32 m0, s17, 0x800
    s_nop 0
    buffer_load_dwordx4 v16, s[4:7], s22 offen lds
    ds_read_b64_tr_b16 v[98:99], v15 offset:42016
    s_waitcnt lgkmcnt(6)
    v_mfma_f32_16x16x32_bf16 v[68:71], v[84:87], v[204:207], v[68:71]
    ds_read_b64_tr_b16 v[100:101], v3 offset:41216
    v_mfma_f32_16x16x32_bf16 v[72:75], v[84:87], v[208:211], v[72:75]
    ds_read_b64_tr_b16 v[102:103], v3 offset:42240
    s_waitcnt lgkmcnt(6)
    v_mfma_f32_16x16x32_bf16 v[76:79], v[88:91], v[204:207], v[76:79]
    ds_read_b64_tr_b16 v[104:105], v15 offset:41248
    v_mfma_f32_16x16x32_bf16 v[80:83], v[88:91], v[208:211], v[80:83]
    ds_read_b64_tr_b16 v[106:107], v15 offset:42272
    s_mov_b32 s23, 0xc000
    buffer_load_dwordx4 v[144:147], v4, s[8:11], s23 offen offset:0 sc1
    s_waitcnt vmcnt(14) lgkmcnt(6)
    v_mfma_f32_16x16x32_bf16 v[20:23], v[92:95], v[212:215], v[20:23]
    ds_read_b64_tr_b16 v[84:85], v3 offset:41472
    s_waitcnt vmcnt(12)
    v_mfma_f32_16x16x32_bf16 v[24:27], v[92:95], v[216:219], v[24:27]
    ds_read_b64_tr_b16 v[86:87], v3 offset:42496
    s_waitcnt lgkmcnt(6)
    v_mfma_f32_16x16x32_bf16 v[28:31], v[96:99], v[212:215], v[28:31]
    ds_read_b64_tr_b16 v[88:89], v15 offset:41504
    v_mfma_f32_16x16x32_bf16 v[32:35], v[96:99], v[216:219], v[32:35]
    s_add_u32 s22, s16, 0x418000
    s_add_u32 m0, s17, 0xc00
    s_nop 0
    buffer_load_dwordx4 v16, s[4:7], s22 offen lds
    ds_read_b64_tr_b16 v[90:91], v15 offset:42528
    s_waitcnt lgkmcnt(6)
    v_mfma_f32_16x16x32_bf16 v[36:39], v[100:103], v[212:215], v[36:39]
    ds_read_b64_tr_b16 v[92:93], v3 offset:41728
    v_mfma_f32_16x16x32_bf16 v[40:43], v[100:103], v[216:219], v[40:43]
    ds_read_b64_tr_b16 v[94:95], v3 offset:42752
    s_waitcnt lgkmcnt(6)
    v_mfma_f32_16x16x32_bf16 v[44:47], v[104:107], v[212:215], v[44:47]
    ds_read_b64_tr_b16 v[96:97], v15 offset:41760
    v_mfma_f32_16x16x32_bf16 v[48:51], v[104:107], v[216:219], v[48:51]
    ds_read_b64_tr_b16 v[98:99], v15 offset:42784
    s_mov_b32 s23, 0x4000
    buffer_load_dwordx4 v[148:151], v4, s[8:11], s23 offen offset:1024 sc1
    s_waitcnt lgkmcnt(6)
    v_mfma_f32_16x16x32_bf16 v[52:55], v[84:87], v[212:215], v[52:55]
    v_mfma_f32_16x16x32_bf16 v[56:59], v[84:87], v[216:219], v[56:59]
    s_waitcnt vmcnt(9)
    s_barrier
    ds_read_b64_tr_b16 v[100:101], v3 offset:49152
    ds_read_b64_tr_b16 v[102:103], v3 offset:50176
    s_waitcnt lgkmcnt(6)
    v_mfma_f32_16x16x32_bf16 v[60:63], v[88:91], v[212:215], v[60:63]
    ds_read_b64_tr_b16 v[104:105], v15 offset:49184
    v_mfma_f32_16x16x32_bf16 v[64:67], v[88:91], v[216:219], v[64:67]
    s_add_u32 s22, s16, 0x480000
    s_add_u32 m0, s17, 0x4000
    s_nop 0
    buffer_load_dwordx4 v2, s[4:7], s22 offen lds
    ds_read_b64_tr_b16 v[106:107], v15 offset:50208
    s_waitcnt lgkmcnt(6)
    v_mfma_f32_16x16x32_bf16 v[68:71], v[92:95], v[212:215], v[68:71]
    ds_read_b64_tr_b16 v[84:85], v3 offset:49408
    v_mfma_f32_16x16x32_bf16 v[72:75], v[92:95], v[216:219], v[72:75]
    ds_read_b64_tr_b16 v[86:87], v3 offset:50432
    s_waitcnt lgkmcnt(6)
    v_mfma_f32_16x16x32_bf16 v[76:79], v[96:99], v[212:215], v[76:79]
    ds_read_b64_tr_b16 v[88:89], v15 offset:49440
    v_mfma_f32_16x16x32_bf16 v[80:83], v[96:99], v[216:219], v[80:83]
    ds_read_b64_tr_b16 v[90:91], v15 offset:50464
    s_mov_b32 s23, 0xc000
    buffer_load_dwordx4 v[152:155], v4, s[8:11], s23 offen offset:1024 sc1
    s_waitcnt lgkmcnt(6)
    v_mfma_f32_16x16x32_bf16 v[20:23], v[100:103], v[220:223], v[20:23]
    ds_read_b64_tr_b16 v[92:93], v3 offset:49664
    v_mfma_f32_16x16x32_bf16 v[24:27], v[100:103], v[224:227], v[24:27]
    ds_read_b64_tr_b16 v[94:95], v3 offset:50688
    s_waitcnt lgkmcnt(6)
    v_mfma_f32_16x16x32_bf16 v[28:31], v[104:107], v[220:223], v[28:31]
    ds_read_b64_tr_b16 v[96:97], v15 offset:49696
    v_mfma_f32_16x16x32_bf16 v[32:35], v[104:107], v[224:227], v[32:35]
    s_add_u32 s22, s16, 0x488000
    s_add_u32 m0, s17, 0x4400
    s_nop 0
    buffer_load_dwordx4 v2, s[4:7], s22 offen lds
    ds_read_b64_tr_b16 v[98:99], v15 offset:50720
    s_waitcnt lgkmcnt(6)
    v_mfma_f32_16x16x32_bf16 v[36:39], v[84:87], v[220:223], v[36:39]
    ds_read_b64_tr_b16 v[100:101], v3 offset:49920
    v_mfma_f32_16x16x32_bf16 v[40:43], v[84:87], v[224:227], v[40:43]
    ds_read_b64_tr_b16 v[102:103], v3 offset:50944
    s_waitcnt lgkmcnt(6)
    v_mfma_f32_16x16x32_bf16 v[44:47], v[88:91], v[220:223], v[44:47]
    ds_read_b64_tr_b16 v[104:105], v15 offset:49952
    v_mfma_f32_16x16x32_bf16 v[48:51], v[88:91], v[224:227], v[48:51]
    ds_read_b64_tr_b16 v[106:107], v15 offset:50976
    s_mov_b32 s23, 0x4800
    buffer_load_dwordx4 v[204:207], v4, s[8:11], s23 offen offset:0 sc1
    s_waitcnt lgkmcnt(6)
    v_mfma_f32_16x16x32_bf16 v[52:55], v[92:95], v[220:223], v[52:55]
    ds_read_b64_tr_b16 v[84:85], v3 offset:57344
    v_mfma_f32_16x16x32_bf16 v[56:59], v[92:95], v[224:227], v[56:59]
    ds_read_b64_tr_b16 v[86:87], v3 offset:58368
    s_waitcnt lgkmcnt(6)
    v_mfma_f32_16x16x32_bf16 v[60:63], v[96:99], v[220:223], v[60:63]
    ds_read_b64_tr_b16 v[88:89], v15 offset:57376
    v_mfma_f32_16x16x32_bf16 v[64:67], v[96:99], v[224:227], v[64:67]
    s_add_u32 s22, s16, 0x490000
    s_add_u32 m0, s17, 0x4800
    s_nop 0
    buffer_load_dwordx4 v16, s[4:7], s22 offen lds
    ds_read_b64_tr_b16 v[90:91], v15 offset:58400
    s_waitcnt lgkmcnt(6)
    v_mfma_f32_16x16x32_bf16 v[68:71], v[100:103], v[220:223], v[68:71]
    ds_read_b64_tr_b16 v[92:93], v3 offset:57600
    v_mfma_f32_16x16x32_bf16 v[72:75], v[100:103], v[224:227], v[72:75]
    ds_read_b64_tr_b16 v[94:95], v3 offset:58624
    s_waitcnt lgkmcnt(6)
    v_mfma_f32_16x16x32_bf16 v[76:79], v[104:107], v[220:223], v[76:79]
    ds_read_b64_tr_b16 v[96:97], v15 offset:57632
    v_mfma_f32_16x16x32_bf16 v[80:83], v[104:107], v[224:227], v[80:83]
    ds_read_b64_tr_b16 v[98:99], v15 offset:58656
    s_mov_b32 s23, 0xc800
    buffer_load_dwordx4 v[208:211], v4, s[8:11], s23 offen offset:0 sc1
    s_waitcnt vmcnt(14) lgkmcnt(6)
    v_mfma_f32_16x16x32_bf16 v[20:23], v[84:87], v[228:231], v[20:23]
    ds_read_b64_tr_b16 v[100:101], v3 offset:57856
    s_waitcnt vmcnt(12)
    v_mfma_f32_16x16x32_bf16 v[24:27], v[84:87], v[232:235], v[24:27]
    ds_read_b64_tr_b16 v[102:103], v3 offset:58880
    s_waitcnt lgkmcnt(6)
    v_mfma_f32_16x16x32_bf16 v[28:31], v[88:91], v[228:231], v[28:31]
    ds_read_b64_tr_b16 v[104:105], v15 offset:57888
    v_mfma_f32_16x16x32_bf16 v[32:35], v[88:91], v[232:235], v[32:35]
    s_add_u32 s22, s16, 0x498000
    s_add_u32 m0, s17, 0x4c00
    s_nop 0
    buffer_load_dwordx4 v16, s[4:7], s22 offen lds
    ds_read_b64_tr_b16 v[106:107], v15 offset:58912
    s_waitcnt lgkmcnt(6)
    v_mfma_f32_16x16x32_bf16 v[36:39], v[92:95], v[228:231], v[36:39]
    ds_read_b64_tr_b16 v[84:85], v3 offset:58112
    v_mfma_f32_16x16x32_bf16 v[40:43], v[92:95], v[232:235], v[40:43]
    ds_read_b64_tr_b16 v[86:87], v3 offset:59136
    s_waitcnt lgkmcnt(6)
    v_mfma_f32_16x16x32_bf16 v[44:47], v[96:99], v[228:231], v[44:47]
    ds_read_b64_tr_b16 v[88:89], v15 offset:58144
    v_mfma_f32_16x16x32_bf16 v[48:51], v[96:99], v[232:235], v[48:51]
    ds_read_b64_tr_b16 v[90:91], v15 offset:59168
    s_mov_b32 s23, 0x4800
    buffer_load_dwordx4 v[212:215], v4, s[8:11], s23 offen offset:1024 sc1
    s_waitcnt lgkmcnt(6)
    v_mfma_f32_16x16x32_bf16 v[52:55], v[100:103], v[228:231], v[52:55]
    v_mfma_f32_16x16x32_bf16 v[56:59], v[100:103], v[232:235], v[56:59]
    s_waitcnt vmcnt(9)
    s_barrier
    ds_read_b64_tr_b16 v[92:93], v3 offset:0
    ds_read_b64_tr_b16 v[94:95], v3 offset:1024
    s_waitcnt lgkmcnt(6)
    v_mfma_f32_16x16x32_bf16 v[60:63], v[104:107], v[228:231], v[60:63]
    ds_read_b64_tr_b16 v[96:97], v15 offset:32
    v_mfma_f32_16x16x32_bf16 v[64:67], v[104:107], v[232:235], v[64:67]
    s_add_u32 s22, s16, 0x500000
    s_add_u32 m0, s17, 0x8000
    s_nop 0
    buffer_load_dwordx4 v2, s[4:7], s22 offen lds
    ds_read_b64_tr_b16 v[98:99], v15 offset:1056
    s_waitcnt lgkmcnt(6)
    v_mfma_f32_16x16x32_bf16 v[68:71], v[84:87], v[228:231], v[68:71]
    ds_read_b64_tr_b16 v[100:101], v3 offset:256
    v_mfma_f32_16x16x32_bf16 v[72:75], v[84:87], v[232:235], v[72:75]
    ds_read_b64_tr_b16 v[102:103], v3 offset:1280
    s_waitcnt lgkmcnt(6)
    v_mfma_f32_16x16x32_bf16 v[76:79], v[88:91], v[228:231], v[76:79]
    ds_read_b64_tr_b16 v[104:105], v15 offset:288
    v_mfma_f32_16x16x32_bf16 v[80:83], v[88:91], v[232:235], v[80:83]
    ds_read_b64_tr_b16 v[106:107], v15 offset:1312
    s_mov_b32 s23, 0xc800
    buffer_load_dwordx4 v[216:219], v4, s[8:11], s23 offen offset:1024 sc1
    s_waitcnt lgkmcnt(6)
    v_mfma_f32_16x16x32_bf16 v[20:23], v[92:95], v[140:143], v[20:23]
    ds_read_b64_tr_b16 v[84:85], v3 offset:512
    v_mfma_f32_16x16x32_bf16 v[24:27], v[92:95], v[144:147], v[24:27]
    ds_read_b64_tr_b16 v[86:87], v3 offset:1536
    s_waitcnt lgkmcnt(6)
    v_mfma_f32_16x16x32_bf16 v[28:31], v[96:99], v[140:143], v[28:31]
    ds_read_b64_tr_b16 v[88:89], v15 offset:544
    v_mfma_f32_16x16x32_bf16 v[32:35], v[96:99], v[144:147], v[32:35]
    s_add_u32 s22, s16, 0x508000
    s_add_u32 m0, s17, 0x8400
    s_nop 0
    buffer_load_dwordx4 v2, s[4:7], s22 offen lds
    ds_read_b64_tr_b16 v[90:91], v15 offset:1568
    s_waitcnt lgkmcnt(6)
    v_mfma_f32_16x16x32_bf16 v[36:39], v[100:103], v[140:143], v[36:39]
    ds_read_b64_tr_b16 v[92:93], v3 offset:768
    v_mfma_f32_16x16x32_bf16 v[40:43], v[100:103], v[144:147], v[40:43]
    ds_read_b64_tr_b16 v[94:95], v3 offset:1792
    s_waitcnt lgkmcnt(6)
    v_mfma_f32_16x16x32_bf16 v[44:47], v[104:107], v[140:143], v[44:47]
    ds_read_b64_tr_b16 v[96:97], v15 offset:800
    v_mfma_f32_16x16x32_bf16 v[48:51], v[104:107], v[144:147], v[48:51]
    ds_read_b64_tr_b16 v[98:99], v15 offset:1824
    s_mov_b32 s23, 0x5000
    buffer_load_dwordx4 v[220:223], v4, s[8:11], s23 offen offset:0 sc1
    s_waitcnt lgkmcnt(6)
    v_mfma_f32_16x16x32_bf16 v[52:55], v[84:87], v[140:143], v[52:55]
    ds_read_b64_tr_b16 v[100:101], v3 offset:8192
    v_mfma_f32_16x16x32_bf16 v[56:59], v[84:87], v[144:147], v[56:59]
    ds_read_b64_tr_b16 v[102:103], v3 offset:9216
    s_waitcnt lgkmcnt(6)
    v_mfma_f32_16x16x32_bf16 v[60:63], v[88:91], v[140:143], v[60:63]
    ds_read_b64_tr_b16 v[104:105], v15 offset:8224
    v_mfma_f32_16x16x32_bf16 v[64:67], v[88:91], v[144:147], v[64:67]
    s_add_u32 s22, s16, 0x510000
    s_add_u32 m0, s17, 0x8800
    s_nop 0
    buffer_load_dwordx4 v16, s[4:7], s22 offen lds
    ds_read_b64_tr_b16 v[106:107], v15 offset:9248
    s_waitcnt lgkmcnt(6)
    v_mfma_f32_16x16x32_bf16 v[68:71], v[92:95], v[140:143], v[68:71]
    ds_read_b64_tr_b16 v[84:85], v3 offset:8448
    v_mfma_f32_16x16x32_bf16 v[72:75], v[92:95], v[144:147], v[72:75]
    ds_read_b64_tr_b16 v[86:87], v3 offset:9472
    s_waitcnt lgkmcnt(6)
    v_mfma_f32_16x16x32_bf16 v[76:79], v[96:99], v[140:143], v[76:79]
    ds_read_b64_tr_b16 v[88:89], v15 offset:8480
    v_mfma_f32_16x16x32_bf16 v[80:83], v[96:99], v[144:147], v[80:83]
    ds_read_b64_tr_b16 v[90:91], v15 offset:9504
    s_mov_b32 s23, 0xd000
    buffer_load_dwordx4 v[224:227], v4, s[8:11], s23 offen offset:0 sc1
    s_waitcnt vmcnt(14) lgkmcnt(6)
    v_mfma_f32_16x16x32_bf16 v[20:23], v[100:103], v[148:151], v[20:23]
    ds_read_b64_tr_b16 v[92:93], v3 offset:8704
    s_waitcnt vmcnt(12)
    v_mfma_f32_16x16x32_bf16 v[24:27], v[100:103], v[152:155], v[24:27]
    ds_read_b64_tr_b16 v[94:95], v3 offset:9728
    s_waitcnt lgkmcnt(6)
    v_mfma_f32_16x16x32_bf16 v[28:31], v[104:107], v[148:151], v[28:31]
    ds_read_b64_tr_b16 v[96:97], v15 offset:8736
    v_mfma_f32_16x16x32_bf16 v[32:35], v[104:107], v[152:155], v[32:35]
    s_add_u32 s22, s16, 0x518000
    s_add_u32 m0, s17, 0x8c00
    s_nop 0
    buffer_load_dwordx4 v16, s[4:7], s22 offen lds
    ds_read_b64_tr_b16 v[98:99], v15 offset:9760
    s_waitcnt lgkmcnt(6)
    v_mfma_f32_16x16x32_bf16 v[36:39], v[84:87], v[148:151], v[36:39]
    ds_read_b64_tr_b16 v[100:101], v3 offset:8960
    v_mfma_f32_16x16x32_bf16 v[40:43], v[84:87], v[152:155], v[40:43]
    ds_read_b64_tr_b16 v[102:103], v3 offset:9984
    s_waitcnt lgkmcnt(6)
    v_mfma_f32_16x16x32_bf16 v[44:47], v[88:91], v[148:151], v[44:47]
    ds_read_b64_tr_b16 v[104:105], v15 offset:8992
    v_mfma_f32_16x16x32_bf16 v[48:51], v[88:91], v[152:155], v[48:51]
    ds_read_b64_tr_b16 v[106:107], v15 offset:10016
    s_mov_b32 s23, 0x5000
    buffer_load_dwordx4 v[228:231], v4, s[8:11], s23 offen offset:1024 sc1
    s_waitcnt lgkmcnt(6)
    v_mfma_f32_16x16x32_bf16 v[52:55], v[92:95], v[148:151], v[52:55]
    v_mfma_f32_16x16x32_bf16 v[56:59], v[92:95], v[152:155], v[56:59]
    s_waitcnt vmcnt(9)
    s_barrier
    ds_read_b64_tr_b16 v[84:85], v3 offset:16384
    ds_read_b64_tr_b16 v[86:87], v3 offset:17408
    s_waitcnt lgkmcnt(6)
    v_mfma_f32_16x16x32_bf16 v[60:63], v[96:99], v[148:151], v[60:63]
    ds_read_b64_tr_b16 v[88:89], v15 offset:16416
    v_mfma_f32_16x16x32_bf16 v[64:67], v[96:99], v[152:155], v[64:67]
    s_add_u32 s22, s16, 0x580000
    s_add_u32 m0, s17, 0xc000
    s_nop 0
    buffer_load_dwordx4 v2, s[4:7], s22 offen lds
    ds_read_b64_tr_b16 v[90:91], v15 offset:17440
    s_waitcnt lgkmcnt(6)
    v_mfma_f32_16x16x32_bf16 v[68:71], v[100:103], v[148:151], v[68:71]
    ds_read_b64_tr_b16 v[92:93], v3 offset:16640
    v_mfma_f32_16x16x32_bf16 v[72:75], v[100:103], v[152:155], v[72:75]
    ds_read_b64_tr_b16 v[94:95], v3 offset:17664
    s_waitcnt lgkmcnt(6)
    v_mfma_f32_16x16x32_bf16 v[76:79], v[104:107], v[148:151], v[76:79]
    ds_read_b64_tr_b16 v[96:97], v15 offset:16672
    v_mfma_f32_16x16x32_bf16 v[80:83], v[104:107], v[152:155], v[80:83]
    ds_read_b64_tr_b16 v[98:99], v15 offset:17696
    s_mov_b32 s23, 0xd000
    buffer_load_dwordx4 v[232:235], v4, s[8:11], s23 offen offset:1024 sc1
    s_waitcnt lgkmcnt(6)
    v_mfma_f32_16x16x32_bf16 v[20:23], v[84:87], v[204:207], v[20:23]
    ds_read_b64_tr_b16 v[100:101], v3 offset:16896
    v_mfma_f32_16x16x32_bf16 v[24:27], v[84:87], v[208:211], v[24:27]
    ds_read_b64_tr_b16 v[102:103], v3 offset:17920
    s_waitcnt lgkmcnt(6)
    v_mfma_f32_16x16x32_bf16 v[28:31], v[88:91], v[204:207], v[28:31]
    ds_read_b64_tr_b16 v[104:105], v15 offset:16928
    v_mfma_f32_16x16x32_bf16 v[32:35], v[88:91], v[208:211], v[32:35]
    s_add_u32 s22, s16, 0x588000
    s_add_u32 m0, s17, 0xc400
    s_nop 0
    buffer_load_dwordx4 v2, s[4:7], s22 offen lds
    ds_read_b64_tr_b16 v[106:107], v15 offset:17952
    s_waitcnt lgkmcnt(6)
    v_mfma_f32_16x16x32_bf16 v[36:39], v[92:95], v[204:207], v[36:39]
    ds_read_b64_tr_b16 v[84:85], v3 offset:17152
    v_mfma_f32_16x16x32_bf16 v[40:43], v[92:95], v[208:211], v[40:43]
    ds_read_b64_tr_b16 v[86:87], v3 offset:18176
    s_waitcnt lgkmcnt(6)
    v_mfma_f32_16x16x32_bf16 v[44:47], v[96:99], v[204:207], v[44:47]
    ds_read_b64_tr_b16 v[88:89], v15 offset:17184
    v_mfma_f32_16x16x32_bf16 v[48:51], v[96:99], v[208:211], v[48:51]
    ds_read_b64_tr_b16 v[90:91], v15 offset:18208
    s_mov_b32 s23, 0x5800
    buffer_load_dwordx4 v[140:143], v4, s[8:11], s23 offen offset:0 sc1
    s_waitcnt lgkmcnt(6)
    v_mfma_f32_16x16x32_bf16 v[52:55], v[100:103], v[204:207], v[52:55]
    ds_read_b64_tr_b16 v[92:93], v3 offset:24576
    v_mfma_f32_16x16x32_bf16 v[56:59], v[100:103], v[208:211], v[56:59]
    ds_read_b64_tr_b16 v[94:95], v3 offset:25600
    s_waitcnt lgkmcnt(6)
    v_mfma_f32_16x16x32_bf16 v[60:63], v[104:107], v[204:207], v[60:63]
    ds_read_b64_tr_b16 v[96:97], v15 offset:24608
    v_mfma_f32_16x16x32_bf16 v[64:67], v[104:107], v[208:211], v[64:67]
    s_add_u32 s22, s16, 0x590000
    s_add_u32 m0, s17, 0xc800
    s_nop 0
    buffer_load_dwordx4 v16, s[4:7], s22 offen lds
    ds_read_b64_tr_b16 v[98:99], v15 offset:25632
    s_waitcnt lgkmcnt(6)
    v_mfma_f32_16x16x32_bf16 v[68:71], v[84:87], v[204:207], v[68:71]
    ds_read_b64_tr_b16 v[100:101], v3 offset:24832
    v_mfma_f32_16x16x32_bf16 v[72:75], v[84:87], v[208:211], v[72:75]
    ds_read_b64_tr_b16 v[102:103], v3 offset:25856
    s_waitcnt lgkmcnt(6)
    v_mfma_f32_16x16x32_bf16 v[76:79], v[88:91], v[204:207], v[76:79]
    ds_read_b64_tr_b16 v[104:105], v15 offset:24864
    v_mfma_f32_16x16x32_bf16 v[80:83], v[88:91], v[208:211], v[80:83]
    ds_read_b64_tr_b16 v[106:107], v15 offset:25888
    s_mov_b32 s23, 0xd800
    buffer_load_dwordx4 v[144:147], v4, s[8:11], s23 offen offset:0 sc1
    s_waitcnt vmcnt(14) lgkmcnt(6)
    v_mfma_f32_16x16x32_bf16 v[20:23], v[92:95], v[212:215], v[20:23]
    ds_read_b64_tr_b16 v[84:85], v3 offset:25088
    s_waitcnt vmcnt(12)
    v_mfma_f32_16x16x32_bf16 v[24:27], v[92:95], v[216:219], v[24:27]
    ds_read_b64_tr_b16 v[86:87], v3 offset:26112
    s_waitcnt lgkmcnt(6)
    v_mfma_f32_16x16x32_bf16 v[28:31], v[96:99], v[212:215], v[28:31]
    ds_read_b64_tr_b16 v[88:89], v15 offset:25120
    v_mfma_f32_16x16x32_bf16 v[32:35], v[96:99], v[216:219], v[32:35]
    s_add_u32 s22, s16, 0x598000
    s_add_u32 m0, s17, 0xcc00
    s_nop 0
    buffer_load_dwordx4 v16, s[4:7], s22 offen lds
    ds_read_b64_tr_b16 v[90:91], v15 offset:26144
    s_waitcnt lgkmcnt(6)
    v_mfma_f32_16x16x32_bf16 v[36:39], v[100:103], v[212:215], v[36:39]
    ds_read_b64_tr_b16 v[92:93], v3 offset:25344
    v_mfma_f32_16x16x32_bf16 v[40:43], v[100:103], v[216:219], v[40:43]
    ds_read_b64_tr_b16 v[94:95], v3 offset:26368
    s_waitcnt lgkmcnt(6)
    v_mfma_f32_16x16x32_bf16 v[44:47], v[104:107], v[212:215], v[44:47]
    ds_read_b64_tr_b16 v[96:97], v15 offset:25376
    v_mfma_f32_16x16x32_bf16 v[48:51], v[104:107], v[216:219], v[48:51]
    ds_read_b64_tr_b16 v[98:99], v15 offset:26400
    s_mov_b32 s23, 0x5800
    buffer_load_dwordx4 v[148:151], v4, s[8:11], s23 offen offset:1024 sc1
    s_waitcnt lgkmcnt(6)
    v_mfma_f32_16x16x32_bf16 v[52:55], v[84:87], v[212:215], v[52:55]
    v_mfma_f32_16x16x32_bf16 v[56:59], v[84:87], v[216:219], v[56:59]
    s_waitcnt vmcnt(9)
    s_barrier
    ds_read_b64_tr_b16 v[100:101], v3 offset:32768
    ds_read_b64_tr_b16 v[102:103], v3 offset:33792
    s_waitcnt lgkmcnt(6)
    v_mfma_f32_16x16x32_bf16 v[60:63], v[88:91], v[212:215], v[60:63]
    ds_read_b64_tr_b16 v[104:105], v15 offset:32800
    v_mfma_f32_16x16x32_bf16 v[64:67], v[88:91], v[216:219], v[64:67]
    s_add_u32 s22, s16, 0x600000
    s_add_u32 m0, s17, 0x0
    s_nop 0
    buffer_load_dwordx4 v2, s[4:7], s22 offen lds
    ds_read_b64_tr_b16 v[106:107], v15 offset:33824
    s_waitcnt lgkmcnt(6)
    v_mfma_f32_16x16x32_bf16 v[68:71], v[92:95], v[212:215], v[68:71]
    ds_read_b64_tr_b16 v[84:85], v3 offset:33024
    v_mfma_f32_16x16x32_bf16 v[72:75], v[92:95], v[216:219], v[72:75]
    ds_read_b64_tr_b16 v[86:87], v3 offset:34048
    s_waitcnt lgkmcnt(6)
    v_mfma_f32_16x16x32_bf16 v[76:79], v[96:99], v[212:215], v[76:79]
    ds_read_b64_tr_b16 v[88:89], v15 offset:33056
    v_mfma_f32_16x16x32_bf16 v[80:83], v[96:99], v[216:219], v[80:83]
    ds_read_b64_tr_b16 v[90:91], v15 offset:34080
    s_mov_b32 s23, 0xd800
    buffer_load_dwordx4 v[152:155], v4, s[8:11], s23 offen offset:1024 sc1
    s_waitcnt lgkmcnt(6)
    v_mfma_f32_16x16x32_bf16 v[20:23], v[100:103], v[220:223], v[20:23]
    ds_read_b64_tr_b16 v[92:93], v3 offset:33280
    v_mfma_f32_16x16x32_bf16 v[24:27], v[100:103], v[224:227], v[24:27]
    ds_read_b64_tr_b16 v[94:95], v3 offset:34304
    s_waitcnt lgkmcnt(6)
    v_mfma_f32_16x16x32_bf16 v[28:31], v[104:107], v[220:223], v[28:31]
    ds_read_b64_tr_b16 v[96:97], v15 offset:33312
    v_mfma_f32_16x16x32_bf16 v[32:35], v[104:107], v[224:227], v[32:35]
    s_add_u32 s22, s16, 0x608000
    s_add_u32 m0, s17, 0x400
    s_nop 0
    buffer_load_dwordx4 v2, s[4:7], s22 offen lds
    ds_read_b64_tr_b16 v[98:99], v15 offset:34336
    s_waitcnt lgkmcnt(6)
    v_mfma_f32_16x16x32_bf16 v[36:39], v[84:87], v[220:223], v[36:39]
    ds_read_b64_tr_b16 v[100:101], v3 offset:33536
    v_mfma_f32_16x16x32_bf16 v[40:43], v[84:87], v[224:227], v[40:43]
    ds_read_b64_tr_b16 v[102:103], v3 offset:34560
    s_waitcnt lgkmcnt(6)
    v_mfma_f32_16x16x32_bf16 v[44:47], v[88:91], v[220:223], v[44:47]
    ds_read_b64_tr_b16 v[104:105], v15 offset:33568
    v_mfma_f32_16x16x32_bf16 v[48:51], v[88:91], v[224:227], v[48:51]
    ds_read_b64_tr_b16 v[106:107], v15 offset:34592
    s_mov_b32 s23, 0x6000
    buffer_load_dwordx4 v[204:207], v4, s[8:11], s23 offen offset:0 sc1
    s_waitcnt lgkmcnt(6)
    v_mfma_f32_16x16x32_bf16 v[52:55], v[92:95], v[220:223], v[52:55]
    ds_read_b64_tr_b16 v[84:85], v3 offset:40960
    v_mfma_f32_16x16x32_bf16 v[56:59], v[92:95], v[224:227], v[56:59]
    ds_read_b64_tr_b16 v[86:87], v3 offset:41984
    s_waitcnt lgkmcnt(6)
    v_mfma_f32_16x16x32_bf16 v[60:63], v[96:99], v[220:223], v[60:63]
    ds_read_b64_tr_b16 v[88:89], v15 offset:40992
    v_mfma_f32_16x16x32_bf16 v[64:67], v[96:99], v[224:227], v[64:67]
    s_add_u32 s22, s16, 0x610000
    s_add_u32 m0, s17, 0x800
    s_nop 0
    buffer_load_dwordx4 v16, s[4:7], s22 offen lds
    ds_read_b64_tr_b16 v[90:91], v15 offset:42016
    s_waitcnt lgkmcnt(6)
    v_mfma_f32_16x16x32_bf16 v[68:71], v[100:103], v[220:223], v[68:71]
    ds_read_b64_tr_b16 v[92:93], v3 offset:41216
    v_mfma_f32_16x16x32_bf16 v[72:75], v[100:103], v[224:227], v[72:75]
    ds_read_b64_tr_b16 v[94:95], v3 offset:42240
    s_waitcnt lgkmcnt(6)
    v_mfma_f32_16x16x32_bf16 v[76:79], v[104:107], v[220:223], v[76:79]
    ds_read_b64_tr_b16 v[96:97], v15 offset:41248
    v_mfma_f32_16x16x32_bf16 v[80:83], v[104:107], v[224:227], v[80:83]
    ds_read_b64_tr_b16 v[98:99], v15 offset:42272
    s_mov_b32 s23, 0xe000
    buffer_load_dwordx4 v[208:211], v4, s[8:11], s23 offen offset:0 sc1
    s_waitcnt vmcnt(14) lgkmcnt(6)
    v_mfma_f32_16x16x32_bf16 v[20:23], v[84:87], v[228:231], v[20:23]
    ds_read_b64_tr_b16 v[100:101], v3 offset:41472
    s_waitcnt vmcnt(12)
    v_mfma_f32_16x16x32_bf16 v[24:27], v[84:87], v[232:235], v[24:27]
    ds_read_b64_tr_b16 v[102:103], v3 offset:42496
    s_waitcnt lgkmcnt(6)
    v_mfma_f32_16x16x32_bf16 v[28:31], v[88:91], v[228:231], v[28:31]
    ds_read_b64_tr_b16 v[104:105], v15 offset:41504
    v_mfma_f32_16x16x32_bf16 v[32:35], v[88:91], v[232:235], v[32:35]
    s_add_u32 s22, s16, 0x618000
    s_add_u32 m0, s17, 0xc00
    s_nop 0
    buffer_load_dwordx4 v16, s[4:7], s22 offen lds
    ds_read_b64_tr_b16 v[106:107], v15 offset:42528
    s_waitcnt lgkmcnt(6)
    v_mfma_f32_16x16x32_bf16 v[36:39], v[92:95], v[228:231], v[36:39]
    ds_read_b64_tr_b16 v[84:85], v3 offset:41728
    v_mfma_f32_16x16x32_bf16 v[40:43], v[92:95], v[232:235], v[40:43]
    ds_read_b64_tr_b16 v[86:87], v3 offset:42752
    s_waitcnt lgkmcnt(6)
    v_mfma_f32_16x16x32_bf16 v[44:47], v[96:99], v[228:231], v[44:47]
    ds_read_b64_tr_b16 v[88:89], v15 offset:41760
    v_mfma_f32_16x16x32_bf16 v[48:51], v[96:99], v[232:235], v[48:51]
    ds_read_b64_tr_b16 v[90:91], v15 offset:42784
    s_mov_b32 s23, 0x6000
    buffer_load_dwordx4 v[212:215], v4, s[8:11], s23 offen offset:1024 sc1
    s_waitcnt lgkmcnt(6)
    v_mfma_f32_16x16x32_bf16 v[52:55], v[100:103], v[228:231], v[52:55]
    v_mfma_f32_16x16x32_bf16 v[56:59], v[100:103], v[232:235], v[56:59]
    s_waitcnt vmcnt(9)
    s_barrier
    ds_read_b64_tr_b16 v[92:93], v3 offset:49152
    ds_read_b64_tr_b16 v[94:95], v3 offset:50176
    s_waitcnt lgkmcnt(6)
    v_mfma_f32_16x16x32_bf16 v[60:63], v[104:107], v[228:231], v[60:63]
    s_lshr_b32 s26, s12, 3
    s_lshl_b32 s26, s26, 10
    s_add_u32 s62, s26, 0x530000
    buffer_load_dword v17, v1, s[8:11], s62 offen offset:0 sc1
    buffer_load_dword v18, v1, s[8:11], s62 offen offset:4 sc1
    buffer_load_dword v19, v1, s[8:11], s62 offen offset:8 sc1
    buffer_load_dword v6, v1, s[8:11], s62 offen offset:12 sc1
    ds_read_b64_tr_b16 v[96:97], v15 offset:49184
    v_mfma_f32_16x16x32_bf16 v[64:67], v[104:107], v[232:235], v[64:67]
    s_add_u32 s22, s16, 0x680000
    s_add_u32 m0, s17, 0x4000
    s_nop 0
    buffer_load_dwordx4 v2, s[4:7], s22 offen lds
    ds_read_b64_tr_b16 v[98:99], v15 offset:50208
    s_waitcnt lgkmcnt(6)
    v_mfma_f32_16x16x32_bf16 v[68:71], v[84:87], v[228:231], v[68:71]
    ds_read_b64_tr_b16 v[100:101], v3 offset:49408
    v_mfma_f32_16x16x32_bf16 v[72:75], v[84:87], v[232:235], v[72:75]
    ds_read_b64_tr_b16 v[102:103], v3 offset:50432
    s_waitcnt lgkmcnt(6)
    v_mfma_f32_16x16x32_bf16 v[76:79], v[88:91], v[228:231], v[76:79]
    ds_read_b64_tr_b16 v[104:105], v15 offset:49440
    v_mfma_f32_16x16x32_bf16 v[80:83], v[88:91], v[232:235], v[80:83]
    ds_read_b64_tr_b16 v[106:107], v15 offset:50464
    s_mov_b32 s23, 0xe000
    buffer_load_dwordx4 v[216:219], v4, s[8:11], s23 offen offset:1024 sc1
    s_waitcnt lgkmcnt(6)
    v_mfma_f32_16x16x32_bf16 v[20:23], v[92:95], v[140:143], v[20:23]
    ds_read_b64_tr_b16 v[84:85], v3 offset:49664
    v_mfma_f32_16x16x32_bf16 v[24:27], v[92:95], v[144:147], v[24:27]
    ds_read_b64_tr_b16 v[86:87], v3 offset:50688
    s_waitcnt lgkmcnt(6)
    v_mfma_f32_16x16x32_bf16 v[28:31], v[96:99], v[140:143], v[28:31]
    ds_read_b64_tr_b16 v[88:89], v15 offset:49696
    v_mfma_f32_16x16x32_bf16 v[32:35], v[96:99], v[144:147], v[32:35]
    s_add_u32 s22, s16, 0x688000
    s_add_u32 m0, s17, 0x4400
    s_nop 0
    buffer_load_dwordx4 v2, s[4:7], s22 offen lds
    ds_read_b64_tr_b16 v[90:91], v15 offset:50720
    s_waitcnt lgkmcnt(6)
    v_mfma_f32_16x16x32_bf16 v[36:39], v[100:103], v[140:143], v[36:39]
    ds_read_b64_tr_b16 v[92:93], v3 offset:49920
    v_mfma_f32_16x16x32_bf16 v[40:43], v[100:103], v[144:147], v[40:43]
    ds_read_b64_tr_b16 v[94:95], v3 offset:50944
    s_waitcnt lgkmcnt(6)
    v_mfma_f32_16x16x32_bf16 v[44:47], v[104:107], v[140:143], v[44:47]
    ds_read_b64_tr_b16 v[96:97], v15 offset:49952
    v_mfma_f32_16x16x32_bf16 v[48:51], v[104:107], v[144:147], v[48:51]
    ds_read_b64_tr_b16 v[98:99], v15 offset:50976
    s_mov_b32 s23, 0x6800
    buffer_load_dwordx4 v[220:223], v4, s[8:11], s23 offen offset:0 sc1
    s_waitcnt lgkmcnt(6)
    v_mfma_f32_16x16x32_bf16 v[52:55], v[84:87], v[140:143], v[52:55]
    ds_read_b64_tr_b16 v[100:101], v3 offset:57344
    v_mfma_f32_16x16x32_bf16 v[56:59], v[84:87], v[144:147], v[56:59]
    ds_read_b64_tr_b16 v[102:103], v3 offset:58368
    s_waitcnt lgkmcnt(6)
    v_mfma_f32_16x16x32_bf16 v[60:63], v[88:91], v[140:143], v[60:63]
    ds_read_b64_tr_b16 v[104:105], v15 offset:57376
    v_mfma_f32_16x16x32_bf16 v[64:67], v[88:91], v[144:147], v[64:67]
    s_add_u32 s22, s16, 0x690000
    s_add_u32 m0, s17, 0x4800
    s_nop 0
    buffer_load_dwordx4 v16, s[4:7], s22 offen lds
    ds_read_b64_tr_b16 v[106:107], v15 offset:58400
    s_waitcnt lgkmcnt(6)
    v_mfma_f32_16x16x32_bf16 v[68:71], v[92:95], v[140:143], v[68:71]
    ds_read_b64_tr_b16 v[84:85], v3 offset:57600
    v_mfma_f32_16x16x32_bf16 v[72:75], v[92:95], v[144:147], v[72:75]
    ds_read_b64_tr_b16 v[86:87], v3 offset:58624
    s_waitcnt lgkmcnt(6)
    v_mfma_f32_16x16x32_bf16 v[76:79], v[96:99], v[140:143], v[76:79]
    ds_read_b64_tr_b16 v[88:89], v15 offset:57632
    v_mfma_f32_16x16x32_bf16 v[80:83], v[96:99], v[144:147], v[80:83]
    ds_read_b64_tr_b16 v[90:91], v15 offset:58656
    s_mov_b32 s23, 0xe800
    buffer_load_dwordx4 v[224:227], v4, s[8:11], s23 offen offset:0 sc1
    s_waitcnt vmcnt(18) lgkmcnt(6)
    v_mfma_f32_16x16x32_bf16 v[20:23], v[100:103], v[148:151], v[20:23]
    ds_read_b64_tr_b16 v[92:93], v3 offset:57856
    s_waitcnt vmcnt(16)
    v_mfma_f32_16x16x32_bf16 v[24:27], v[100:103], v[152:155], v[24:27]
    ds_read_b64_tr_b16 v[94:95], v3 offset:58880
    s_waitcnt lgkmcnt(6)
    v_mfma_f32_16x16x32_bf16 v[28:31], v[104:107], v[148:151], v[28:31]
    ds_read_b64_tr_b16 v[96:97], v15 offset:57888
    v_mfma_f32_16x16x32_bf16 v[32:35], v[104:107], v[152:155], v[32:35]
    s_add_u32 s22, s16, 0x698000
    s_add_u32 m0, s17, 0x4c00
    s_nop 0
    buffer_load_dwordx4 v16, s[4:7], s22 offen lds
    ds_read_b64_tr_b16 v[98:99], v15 offset:58912
    s_waitcnt lgkmcnt(6)
    v_mfma_f32_16x16x32_bf16 v[36:39], v[84:87], v[148:151], v[36:39]
    ds_read_b64_tr_b16 v[100:101], v3 offset:58112
    v_mfma_f32_16x16x32_bf16 v[40:43], v[84:87], v[152:155], v[40:43]
    ds_read_b64_tr_b16 v[102:103], v3 offset:59136
    s_waitcnt lgkmcnt(6)
    v_mfma_f32_16x16x32_bf16 v[44:47], v[88:91], v[148:151], v[44:47]
    ds_read_b64_tr_b16 v[104:105], v15 offset:58144
    v_mfma_f32_16x16x32_bf16 v[48:51], v[88:91], v[152:155], v[48:51]
    ds_read_b64_tr_b16 v[106:107], v15 offset:59168
    s_mov_b32 s23, 0x6800
    buffer_load_dwordx4 v[228:231], v4, s[8:11], s23 offen offset:1024 sc1
    s_waitcnt lgkmcnt(6)
    v_mfma_f32_16x16x32_bf16 v[52:55], v[92:95], v[148:151], v[52:55]
    v_mfma_f32_16x16x32_bf16 v[56:59], v[92:95], v[152:155], v[56:59]
    s_waitcnt vmcnt(13)
    s_barrier
    ds_read_b64_tr_b16 v[84:85], v3 offset:0
    ds_read_b64_tr_b16 v[86:87], v3 offset:1024
    s_waitcnt lgkmcnt(6)
    v_mfma_f32_16x16x32_bf16 v[60:63], v[96:99], v[148:151], v[60:63]
    ds_read_b64_tr_b16 v[88:89], v15 offset:32
    v_mfma_f32_16x16x32_bf16 v[64:67], v[96:99], v[152:155], v[64:67]
    s_add_u32 s22, s16, 0x700000
    s_add_u32 m0, s17, 0x8000
    s_nop 0
    buffer_load_dwordx4 v2, s[4:7], s22 offen lds
    ds_read_b64_tr_b16 v[90:91], v15 offset:1056
    s_waitcnt lgkmcnt(6)
    v_mfma_f32_16x16x32_bf16 v[68:71], v[100:103], v[148:151], v[68:71]
    ds_read_b64_tr_b16 v[92:93], v3 offset:256
    v_mfma_f32_16x16x32_bf16 v[72:75], v[100:103], v[152:155], v[72:75]
    ds_read_b64_tr_b16 v[94:95], v3 offset:1280
    s_waitcnt lgkmcnt(6)
    v_mfma_f32_16x16x32_bf16 v[76:79], v[104:107], v[148:151], v[76:79]
    ds_read_b64_tr_b16 v[96:97], v15 offset:288
    v_mfma_f32_16x16x32_bf16 v[80:83], v[104:107], v[152:155], v[80:83]
    ds_read_b64_tr_b16 v[98:99], v15 offset:1312
    s_mov_b32 s23, 0xe800
    buffer_load_dwordx4 v[232:235], v4, s[8:11], s23 offen offset:1024 sc1
    s_waitcnt lgkmcnt(6)
    v_mfma_f32_16x16x32_bf16 v[20:23], v[84:87], v[204:207], v[20:23]
    ds_read_b64_tr_b16 v[100:101], v3 offset:512
    v_mfma_f32_16x16x32_bf16 v[24:27], v[84:87], v[208:211], v[24:27]
    ds_read_b64_tr_b16 v[102:103], v3 offset:1536
    s_waitcnt lgkmcnt(6)
    v_mfma_f32_16x16x32_bf16 v[28:31], v[88:91], v[204:207], v[28:31]
    ds_read_b64_tr_b16 v[104:105], v15 offset:544
    v_mfma_f32_16x16x32_bf16 v[32:35], v[88:91], v[208:211], v[32:35]
    s_add_u32 s22, s16, 0x708000
    s_add_u32 m0, s17, 0x8400
    s_nop 0
    buffer_load_dwordx4 v2, s[4:7], s22 offen lds
    ds_read_b64_tr_b16 v[106:107], v15 offset:1568
    s_waitcnt lgkmcnt(6)
    v_mfma_f32_16x16x32_bf16 v[36:39], v[92:95], v[204:207], v[36:39]
    ds_read_b64_tr_b16 v[84:85], v3 offset:768
    v_mfma_f32_16x16x32_bf16 v[40:43], v[92:95], v[208:211], v[40:43]
    ds_read_b64_tr_b16 v[86:87], v3 offset:1792
    s_waitcnt lgkmcnt(6)
    v_mfma_f32_16x16x32_bf16 v[44:47], v[96:99], v[204:207], v[44:47]
    ds_read_b64_tr_b16 v[88:89], v15 offset:800
    v_mfma_f32_16x16x32_bf16 v[48:51], v[96:99], v[208:211], v[48:51]
    ds_read_b64_tr_b16 v[90:91], v15 offset:1824
    s_mov_b32 s23, 0x7000
    buffer_load_dwordx4 v[140:143], v4, s[8:11], s23 offen offset:0 sc1
    s_waitcnt lgkmcnt(6)
    v_mfma_f32_16x16x32_bf16 v[52:55], v[100:103], v[204:207], v[52:55]
    ds_read_b64_tr_b16 v[92:93], v3 offset:8192
    v_mfma_f32_16x16x32_bf16 v[56:59], v[100:103], v[208:211], v[56:59]
    ds_read_b64_tr_b16 v[94:95], v3 offset:9216
    s_waitcnt lgkmcnt(6)
    v_mfma_f32_16x16x32_bf16 v[60:63], v[104:107], v[204:207], v[60:63]
    ds_read_b64_tr_b16 v[96:97], v15 offset:8224
    v_mfma_f32_16x16x32_bf16 v[64:67], v[104:107], v[208:211], v[64:67]
    s_add_u32 s22, s16, 0x710000
    s_add_u32 m0, s17, 0x8800
    s_nop 0
    buffer_load_dwordx4 v16, s[4:7], s22 offen lds
    ds_read_b64_tr_b16 v[98:99], v15 offset:9248
    s_waitcnt lgkmcnt(6)
    v_mfma_f32_16x16x32_bf16 v[68:71], v[84:87], v[204:207], v[68:71]
    ds_read_b64_tr_b16 v[100:101], v3 offset:8448
    v_mfma_f32_16x16x32_bf16 v[72:75], v[84:87], v[208:211], v[72:75]
    ds_read_b64_tr_b16 v[102:103], v3 offset:9472
    s_waitcnt lgkmcnt(6)
    v_mfma_f32_16x16x32_bf16 v[76:79], v[88:91], v[204:207], v[76:79]
    ds_read_b64_tr_b16 v[104:105], v15 offset:8480
    v_mfma_f32_16x16x32_bf16 v[80:83], v[88:91], v[208:211], v[80:83]
    ds_read_b64_tr_b16 v[106:107], v15 offset:9504
    s_mov_b32 s23, 0xf000
    buffer_load_dwordx4 v[144:147], v4, s[8:11], s23 offen offset:0 sc1
    s_waitcnt vmcnt(18) lgkmcnt(6)
    v_mfma_f32_16x16x32_bf16 v[20:23], v[92:95], v[212:215], v[20:23]
    ds_read_b64_tr_b16 v[84:85], v3 offset:8704
    s_waitcnt vmcnt(12)
    v_mfma_f32_16x16x32_bf16 v[24:27], v[92:95], v[216:219], v[24:27]
    ds_read_b64_tr_b16 v[86:87], v3 offset:9728
    s_waitcnt lgkmcnt(6)
    v_mfma_f32_16x16x32_bf16 v[28:31], v[96:99], v[212:215], v[28:31]
    ds_read_b64_tr_b16 v[88:89], v15 offset:8736
    v_mfma_f32_16x16x32_bf16 v[32:35], v[96:99], v[216:219], v[32:35]
    s_add_u32 s22, s16, 0x718000
    s_add_u32 m0, s17, 0x8c00
    s_nop 0
    buffer_load_dwordx4 v16, s[4:7], s22 offen lds
    ds_read_b64_tr_b16 v[90:91], v15 offset:9760
    s_waitcnt lgkmcnt(6)
    v_mfma_f32_16x16x32_bf16 v[36:39], v[100:103], v[212:215], v[36:39]
    ds_read_b64_tr_b16 v[92:93], v3 offset:8960
    v_mfma_f32_16x16x32_bf16 v[40:43], v[100:103], v[216:219], v[40:43]
    ds_read_b64_tr_b16 v[94:95], v3 offset:9984
    s_waitcnt lgkmcnt(6)
    v_mfma_f32_16x16x32_bf16 v[44:47], v[104:107], v[212:215], v[44:47]
    ds_read_b64_tr_b16 v[96:97], v15 offset:8992
    v_mfma_f32_16x16x32_bf16 v[48:51], v[104:107], v[216:219], v[48:51]
    ds_read_b64_tr_b16 v[98:99], v15 offset:10016
    s_mov_b32 s23, 0x7000
    buffer_load_dwordx4 v[148:151], v4, s[8:11], s23 offen offset:1024 sc1
    s_waitcnt lgkmcnt(6)
    v_mfma_f32_16x16x32_bf16 v[52:55], v[84:87], v[212:215], v[52:55]
    v_mfma_f32_16x16x32_bf16 v[56:59], v[84:87], v[216:219], v[56:59]
    s_waitcnt vmcnt(9)
    s_barrier
    ds_read_b64_tr_b16 v[100:101], v3 offset:16384
    ds_read_b64_tr_b16 v[102:103], v3 offset:17408
    s_waitcnt lgkmcnt(6)
    v_mfma_f32_16x16x32_bf16 v[60:63], v[88:91], v[212:215], v[60:63]
    ds_read_b64_tr_b16 v[104:105], v15 offset:16416
    v_mfma_f32_16x16x32_bf16 v[64:67], v[88:91], v[216:219], v[64:67]
    s_add_u32 s22, s16, 0x780000
    s_add_u32 m0, s17, 0xc000
    s_nop 0
    buffer_load_dwordx4 v2, s[4:7], s22 offen lds
    ds_read_b64_tr_b16 v[106:107], v15 offset:17440
    s_waitcnt lgkmcnt(6)
    v_mfma_f32_16x16x32_bf16 v[68:71], v[92:95], v[212:215], v[68:71]
    ds_read_b64_tr_b16 v[84:85], v3 offset:16640
    v_mfma_f32_16x16x32_bf16 v[72:75], v[92:95], v[216:219], v[72:75]
    ds_read_b64_tr_b16 v[86:87], v3 offset:17664
    s_waitcnt lgkmcnt(6)
    v_mfma_f32_16x16x32_bf16 v[76:79], v[96:99], v[212:215], v[76:79]
    ds_read_b64_tr_b16 v[88:89], v15 offset:16672
    v_mfma_f32_16x16x32_bf16 v[80:83], v[96:99], v[216:219], v[80:83]
    ds_read_b64_tr_b16 v[90:91], v15 offset:17696
    s_mov_b32 s23, 0xf000
    buffer_load_dwordx4 v[152:155], v4, s[8:11], s23 offen offset:1024 sc1
    s_waitcnt lgkmcnt(6)
    v_mfma_f32_16x16x32_bf16 v[20:23], v[100:103], v[220:223], v[20:23]
    ds_read_b64_tr_b16 v[92:93], v3 offset:16896
    v_mfma_f32_16x16x32_bf16 v[24:27], v[100:103], v[224:227], v[24:27]
    ds_read_b64_tr_b16 v[94:95], v3 offset:17920
    s_waitcnt lgkmcnt(6)
    v_mfma_f32_16x16x32_bf16 v[28:31], v[104:107], v[220:223], v[28:31]
    ds_read_b64_tr_b16 v[96:97], v15 offset:16928
    v_mfma_f32_16x16x32_bf16 v[32:35], v[104:107], v[224:227], v[32:35]
    s_add_u32 s22, s16, 0x788000
    s_add_u32 m0, s17, 0xc400
    s_nop 0
    buffer_load_dwordx4 v2, s[4:7], s22 offen lds
    ds_read_b64_tr_b16 v[98:99], v15 offset:17952
    s_waitcnt lgkmcnt(6)
    v_mfma_f32_16x16x32_bf16 v[36:39], v[84:87], v[220:223], v[36:39]
    ds_read_b64_tr_b16 v[100:101], v3 offset:17152
    v_mfma_f32_16x16x32_bf16 v[40:43], v[84:87], v[224:227], v[40:43]
    ds_read_b64_tr_b16 v[102:103], v3 offset:18176
    s_waitcnt lgkmcnt(6)
    v_mfma_f32_16x16x32_bf16 v[44:47], v[88:91], v[220:223], v[44:47]
    ds_read_b64_tr_b16 v[104:105], v15 offset:17184
    v_mfma_f32_16x16x32_bf16 v[48:51], v[88:91], v[224:227], v[48:51]
    ds_read_b64_tr_b16 v[106:107], v15 offset:18208
    s_mov_b32 s23, 0x7800
    buffer_load_dwordx4 v[204:207], v4, s[8:11], s23 offen offset:0 sc1
    s_waitcnt lgkmcnt(6)
    v_mfma_f32_16x16x32_bf16 v[52:55], v[92:95], v[220:223], v[52:55]
    ds_read_b64_tr_b16 v[84:85], v3 offset:24576
    v_mfma_f32_16x16x32_bf16 v[56:59], v[92:95], v[224:227], v[56:59]
    ds_read_b64_tr_b16 v[86:87], v3 offset:25600
    s_waitcnt lgkmcnt(6)
    v_mfma_f32_16x16x32_bf16 v[60:63], v[96:99], v[220:223], v[60:63]
    ds_read_b64_tr_b16 v[88:89], v15 offset:24608
    v_mfma_f32_16x16x32_bf16 v[64:67], v[96:99], v[224:227], v[64:67]
    s_add_u32 s22, s16, 0x790000
    s_add_u32 m0, s17, 0xc800
    s_nop 0
    buffer_load_dwordx4 v16, s[4:7], s22 offen lds
    ds_read_b64_tr_b16 v[90:91], v15 offset:25632
    s_waitcnt lgkmcnt(6)
    v_mfma_f32_16x16x32_bf16 v[68:71], v[100:103], v[220:223], v[68:71]
    ds_read_b64_tr_b16 v[92:93], v3 offset:24832
    v_mfma_f32_16x16x32_bf16 v[72:75], v[100:103], v[224:227], v[72:75]
    ds_read_b64_tr_b16 v[94:95], v3 offset:25856
    s_waitcnt lgkmcnt(6)
    v_mfma_f32_16x16x32_bf16 v[76:79], v[104:107], v[220:223], v[76:79]
    ds_read_b64_tr_b16 v[96:97], v15 offset:24864
    v_mfma_f32_16x16x32_bf16 v[80:83], v[104:107], v[224:227], v[80:83]
    ds_read_b64_tr_b16 v[98:99], v15 offset:25888
    s_mov_b32 s23, 0xf800
    buffer_load_dwordx4 v[208:211], v4, s[8:11], s23 offen offset:0 sc1
    s_waitcnt vmcnt(14) lgkmcnt(6)
    v_mfma_f32_16x16x32_bf16 v[20:23], v[84:87], v[228:231], v[20:23]
    ds_read_b64_tr_b16 v[100:101], v3 offset:25088
    s_waitcnt vmcnt(12)
    v_mfma_f32_16x16x32_bf16 v[24:27], v[84:87], v[232:235], v[24:27]
    ds_read_b64_tr_b16 v[102:103], v3 offset:26112
    s_waitcnt lgkmcnt(6)
    v_mfma_f32_16x16x32_bf16 v[28:31], v[88:91], v[228:231], v[28:31]
    ds_read_b64_tr_b16 v[104:105], v15 offset:25120
    v_mfma_f32_16x16x32_bf16 v[32:35], v[88:91], v[232:235], v[32:35]
    s_add_u32 s22, s16, 0x798000
    s_add_u32 m0, s17, 0xcc00
    s_nop 0
    buffer_load_dwordx4 v16, s[4:7], s22 offen lds
    ds_read_b64_tr_b16 v[106:107], v15 offset:26144
    s_waitcnt lgkmcnt(6)
    v_mfma_f32_16x16x32_bf16 v[36:39], v[92:95], v[228:231], v[36:39]
    ds_read_b64_tr_b16 v[84:85], v3 offset:25344
    v_mfma_f32_16x16x32_bf16 v[40:43], v[92:95], v[232:235], v[40:43]
    ds_read_b64_tr_b16 v[86:87], v3 offset:26368
    s_waitcnt lgkmcnt(6)
    v_mfma_f32_16x16x32_bf16 v[44:47], v[96:99], v[228:231], v[44:47]
    ds_read_b64_tr_b16 v[88:89], v15 offset:25376
    v_mfma_f32_16x16x32_bf16 v[48:51], v[96:99], v[232:235], v[48:51]
    ds_read_b64_tr_b16 v[90:91], v15 offset:26400
    s_mov_b32 s23, 0x7800
    buffer_load_dwordx4 v[212:215], v4, s[8:11], s23 offen offset:1024 sc1
    s_waitcnt lgkmcnt(6)
    v_mfma_f32_16x16x32_bf16 v[52:55], v[100:103], v[228:231], v[52:55]
    v_mfma_f32_16x16x32_bf16 v[56:59], v[100:103], v[232:235], v[56:59]
    s_waitcnt vmcnt(9)
    s_barrier
    v_xor_b32 v17, s14, v17
    v_xor_b32 v18, s14, v18
    v_xor_b32 v19, s14, v19
    v_xor_b32 v6, s14, v6
    v_or3_b32 v17, v17, v18, v19
    v_or_b32 v17, v17, v6
    v_cmp_ne_u32 vcc, 0, v17
    s_cbranch_vccz fz_kvg
    s_mov_b32 s27, 0
fz_kvp:
    buffer_load_dword v17, v1, s[8:11], s62 offen offset:0 sc1
    buffer_load_dword v18, v1, s[8:11], s62 offen offset:4 sc1
    buffer_load_dword v19, v1, s[8:11], s62 offen offset:8 sc1
    buffer_load_dword v6, v1, s[8:11], s62 offen offset:12 sc1
    s_waitcnt vmcnt(0)
    v_xor_b32 v17, s14, v17
    v_xor_b32 v18, s14, v18
    v_xor_b32 v19, s14, v19
    v_xor_b32 v6, s14, v6
    v_or3_b32 v17, v17, v18, v19
    v_or_b32 v17, v17, v6
    v_cmp_ne_u32 vcc, 0, v17
    s_add_u32 s27, s27, 1
    s_cmp_ge_u32 s27, 65536
    s_nop 4
    s_cbranch_scc1 fz_kvg
    s_cbranch_vccnz fz_kvp
fz_kvg:
    ds_read_b64_tr_b16 v[92:93], v3 offset:32768
    ds_read_b64_tr_b16 v[94:95], v3 offset:33792
    s_waitcnt lgkmcnt(6)
    v_mfma_f32_16x16x32_bf16 v[60:63], v[104:107], v[228:231], v[60:63]
    ds_read_b64_tr_b16 v[96:97], v15 offset:32800
    v_mfma_f32_16x16x32_bf16 v[64:67], v[104:107], v[232:235], v[64:67]
    s_add_u32 s22, s17, 0x0
    s_add_u32 m0, s17, 0x10000
    s_nop 0
    buffer_load_dwordx4 v5, s[8:11], s22 offen sc1 lds
    ds_read_b64_tr_b16 v[98:99], v15 offset:33824
    s_waitcnt lgkmcnt(6)
    v_mfma_f32_16x16x32_bf16 v[68:71], v[84:87], v[228:231], v[68:71]
    ds_read_b64_tr_b16 v[100:101], v3 offset:33024
    v_mfma_f32_16x16x32_bf16 v[72:75], v[84:87], v[232:235], v[72:75]
    ds_read_b64_tr_b16 v[102:103], v3 offset:34048
    s_waitcnt lgkmcnt(6)
    v_mfma_f32_16x16x32_bf16 v[76:79], v[88:91], v[228:231], v[76:79]
    ds_read_b64_tr_b16 v[104:105], v15 offset:33056
    v_mfma_f32_16x16x32_bf16 v[80:83], v[88:91], v[232:235], v[80:83]
    ds_read_b64_tr_b16 v[106:107], v15 offset:34080
    s_mov_b32 s23, 0xf800
    buffer_load_dwordx4 v[216:219], v4, s[8:11], s23 offen offset:1024 sc1
    s_waitcnt lgkmcnt(6)
    v_mfma_f32_16x16x32_bf16 v[20:23], v[92:95], v[140:143], v[20:23]
    ds_read_b64_tr_b16 v[84:85], v3 offset:33280
    v_mfma_f32_16x16x32_bf16 v[24:27], v[92:95], v[144:147], v[24:27]
    ds_read_b64_tr_b16 v[86:87], v3 offset:34304
    s_waitcnt lgkmcnt(6)
    v_mfma_f32_16x16x32_bf16 v[28:31], v[96:99], v[140:143], v[28:31]
    ds_read_b64_tr_b16 v[88:89], v15 offset:33312
    v_mfma_f32_16x16x32_bf16 v[32:35], v[96:99], v[144:147], v[32:35]
    s_add_u32 s22, s17, 0x400
    s_add_u32 m0, s17, 0x10400
    s_nop 0
    buffer_load_dwordx4 v5, s[8:11], s22 offen sc1 lds
    ds_read_b64_tr_b16 v[90:91], v15 offset:34336
    s_waitcnt lgkmcnt(6)
    v_mfma_f32_16x16x32_bf16 v[36:39], v[100:103], v[140:143], v[36:39]
    ds_read_b64_tr_b16 v[92:93], v3 offset:33536
    v_mfma_f32_16x16x32_bf16 v[40:43], v[100:103], v[144:147], v[40:43]
    ds_read_b64_tr_b16 v[94:95], v3 offset:34560
    s_waitcnt lgkmcnt(6)
    v_mfma_f32_16x16x32_bf16 v[44:47], v[104:107], v[140:143], v[44:47]
    ds_read_b64_tr_b16 v[96:97], v15 offset:33568
    v_mfma_f32_16x16x32_bf16 v[48:51], v[104:107], v[144:147], v[48:51]
    ds_read_b64_tr_b16 v[98:99], v15 offset:34592
    s_waitcnt lgkmcnt(6)
    v_mfma_f32_16x16x32_bf16 v[52:55], v[84:87], v[140:143], v[52:55]
    ds_read_b64_tr_b16 v[100:101], v3 offset:40960
    v_mfma_f32_16x16x32_bf16 v[56:59], v[84:87], v[144:147], v[56:59]
    ds_read_b64_tr_b16 v[102:103], v3 offset:41984
    s_waitcnt lgkmcnt(6)
    v_mfma_f32_16x16x32_bf16 v[60:63], v[88:91], v[140:143], v[60:63]
    ds_read_b64_tr_b16 v[104:105], v15 offset:40992
    v_mfma_f32_16x16x32_bf16 v[64:67], v[88:91], v[144:147], v[64:67]
    s_add_u32 s22, s17, 0x800
    s_add_u32 m0, s17, 0x10800
    s_nop 0
    buffer_load_dwordx4 v5, s[8:11], s22 offen sc1 lds
    ds_read_b64_tr_b16 v[106:107], v15 offset:42016
    s_waitcnt lgkmcnt(6)
    v_mfma_f32_16x16x32_bf16 v[68:71], v[92:95], v[140:143], v[68:71]
    ds_read_b64_tr_b16 v[84:85], v3 offset:41216
    v_mfma_f32_16x16x32_bf16 v[72:75], v[92:95], v[144:147], v[72:75]
    ds_read_b64_tr_b16 v[86:87], v3 offset:42240
    s_waitcnt lgkmcnt(6)
    v_mfma_f32_16x16x32_bf16 v[76:79], v[96:99], v[140:143], v[76:79]
    ds_read_b64_tr_b16 v[88:89], v15 offset:41248
    v_mfma_f32_16x16x32_bf16 v[80:83], v[96:99], v[144:147], v[80:83]
    ds_read_b64_tr_b16 v[90:91], v15 offset:42272
    s_waitcnt vmcnt(12) lgkmcnt(6)
    v_mfma_f32_16x16x32_bf16 v[20:23], v[100:103], v[148:151], v[20:23]
    ds_read_b64_tr_b16 v[92:93], v3 offset:41472
    s_waitcnt vmcnt(10)
    v_mfma_f32_16x16x32_bf16 v[24:27], v[100:103], v[152:155], v[24:27]
    ds_read_b64_tr_b16 v[94:95], v3 offset:42496
    s_add_u32 s22, s17, 0x8000
    s_add_u32 m0, s17, 0x18000
    s_nop 0
    buffer_load_dwordx4 v5, s[8:11], s22 offen sc1 lds
    s_waitcnt lgkmcnt(6)
    v_mfma_f32_16x16x32_bf16 v[28:31], v[104:107], v[148:151], v[28:31]
    ds_read_b64_tr_b16 v[96:97], v15 offset:41504
    v_mfma_f32_16x16x32_bf16 v[32:35], v[104:107], v[152:155], v[32:35]
    s_add_u32 s22, s17, 0xc00
    s_add_u32 m0, s17, 0x10c00
    s_nop 0
    buffer_load_dwordx4 v5, s[8:11], s22 offen sc1 lds
    ds_read_b64_tr_b16 v[98:99], v15 offset:42528
    s_add_u32 s22, s17, 0x8400
    s_add_u32 m0, s17, 0x18400
    s_nop 0
    buffer_load_dwordx4 v5, s[8:11], s22 offen sc1 lds
    s_waitcnt lgkmcnt(6)
    v_mfma_f32_16x16x32_bf16 v[36:39], v[84:87], v[148:151], v[36:39]
    ds_read_b64_tr_b16 v[100:101], v3 offset:41728
    v_mfma_f32_16x16x32_bf16 v[40:43], v[84:87], v[152:155], v[40:43]
    ds_read_b64_tr_b16 v[102:103], v3 offset:42752
    s_add_u32 s22, s17, 0x8800
    s_add_u32 m0, s17, 0x18800
    s_nop 0
    buffer_load_dwordx4 v5, s[8:11], s22 offen sc1 lds
    s_waitcnt lgkmcnt(6)
    v_mfma_f32_16x16x32_bf16 v[44:47], v[88:91], v[148:151], v[44:47]
    ds_read_b64_tr_b16 v[104:105], v15 offset:41760
    v_mfma_f32_16x16x32_bf16 v[48:51], v[88:91], v[152:155], v[48:51]
    ds_read_b64_tr_b16 v[106:107], v15 offset:42784
    s_add_u32 s22, s17, 0x8c00
    s_add_u32 m0, s17, 0x18c00
    s_nop 0
    buffer_load_dwordx4 v5, s[8:11], s22 offen sc1 lds
    s_waitcnt lgkmcnt(6)
    v_mfma_f32_16x16x32_bf16 v[52:55], v[92:95], v[148:151], v[52:55]
    v_mfma_f32_16x16x32_bf16 v[56:59], v[92:95], v[152:155], v[56:59]
    s_waitcnt vmcnt(10)
    s_barrier
    ds_read_b64_tr_b16 v[84:85], v3 offset:49152
    ds_read_b64_tr_b16 v[86:87], v3 offset:50176
    s_add_u32 s22, s17, 0xc000
    s_add_u32 m0, s17, 0x1c000
    s_nop 0
    buffer_load_dwordx4 v5, s[8:11], s22 offen sc1 lds
    s_waitcnt lgkmcnt(6)
    v_mfma_f32_16x16x32_bf16 v[60:63], v[96:99], v[148:151], v[60:63]
    ds_read_b64_tr_b16 v[88:89], v15 offset:49184
    v_mfma_f32_16x16x32_bf16 v[64:67], v[96:99], v[152:155], v[64:67]
    s_add_u32 s22, s17, 0x4000
    s_add_u32 m0, s17, 0x14000
    s_nop 0
    buffer_load_dwordx4 v5, s[8:11], s22 offen sc1 lds
    ds_read_b64_tr_b16 v[90:91], v15 offset:50208
    s_add_u32 s22, s17, 0xc400
    s_add_u32 m0, s17, 0x1c400
    s_nop 0
    buffer_load_dwordx4 v5, s[8:11], s22 offen sc1 lds
    s_waitcnt lgkmcnt(6)
    v_mfma_f32_16x16x32_bf16 v[68:71], v[100:103], v[148:151], v[68:71]
    ds_read_b64_tr_b16 v[92:93], v3 offset:49408
    v_mfma_f32_16x16x32_bf16 v[72:75], v[100:103], v[152:155], v[72:75]
    ds_read_b64_tr_b16 v[94:95], v3 offset:50432
    s_add_u32 s22, s17, 0xc800
    s_add_u32 m0, s17, 0x1c800
    s_nop 0
    buffer_load_dwordx4 v5, s[8:11], s22 offen sc1 lds
    s_waitcnt lgkmcnt(6)
    v_mfma_f32_16x16x32_bf16 v[76:79], v[104:107], v[148:151], v[76:79]
    ds_read_b64_tr_b16 v[96:97], v15 offset:49440
    v_mfma_f32_16x16x32_bf16 v[80:83], v[104:107], v[152:155], v[80:83]
    ds_read_b64_tr_b16 v[98:99], v15 offset:50464
    s_add_u32 s22, s17, 0xcc00
    s_add_u32 m0, s17, 0x1cc00
    s_nop 0
    buffer_load_dwordx4 v5, s[8:11], s22 offen sc1 lds
    s_waitcnt lgkmcnt(6)
    v_mfma_f32_16x16x32_bf16 v[20:23], v[84:87], v[204:207], v[20:23]
    ds_read_b64_tr_b16 v[100:101], v3 offset:49664
    v_mfma_f32_16x16x32_bf16 v[24:27], v[84:87], v[208:211], v[24:27]
    ds_read_b64_tr_b16 v[102:103], v3 offset:50688
    s_waitcnt lgkmcnt(6)
    v_mfma_f32_16x16x32_bf16 v[28:31], v[88:91], v[204:207], v[28:31]
    ds_read_b64_tr_b16 v[104:105], v15 offset:49696
    v_mfma_f32_16x16x32_bf16 v[32:35], v[88:91], v[208:211], v[32:35]
    s_add_u32 s22, s17, 0x4400
    s_add_u32 m0, s17, 0x14400
    s_nop 0
    buffer_load_dwordx4 v5, s[8:11], s22 offen sc1 lds
    ds_read_b64_tr_b16 v[106:107], v15 offset:50720
    s_waitcnt lgkmcnt(6)
    v_mfma_f32_16x16x32_bf16 v[36:39], v[92:95], v[204:207], v[36:39]
    ds_read_b64_tr_b16 v[84:85], v3 offset:49920
    v_mfma_f32_16x16x32_bf16 v[40:43], v[92:95], v[208:211], v[40:43]
    ds_read_b64_tr_b16 v[86:87], v3 offset:50944
    s_waitcnt lgkmcnt(6)
    v_mfma_f32_16x16x32_bf16 v[44:47], v[96:99], v[204:207], v[44:47]
    ds_read_b64_tr_b16 v[88:89], v15 offset:49952
    v_mfma_f32_16x16x32_bf16 v[48:51], v[96:99], v[208:211], v[48:51]
    ds_read_b64_tr_b16 v[90:91], v15 offset:50976
    s_waitcnt lgkmcnt(6)
    v_mfma_f32_16x16x32_bf16 v[52:55], v[100:103], v[204:207], v[52:55]
    ds_read_b64_tr_b16 v[92:93], v3 offset:57344
    v_mfma_f32_16x16x32_bf16 v[56:59], v[100:103], v[208:211], v[56:59]
    ds_read_b64_tr_b16 v[94:95], v3 offset:58368
    s_waitcnt lgkmcnt(6)
    v_mfma_f32_16x16x32_bf16 v[60:63], v[104:107], v[204:207], v[60:63]
    ds_read_b64_tr_b16 v[96:97], v15 offset:57376
    v_mfma_f32_16x16x32_bf16 v[64:67], v[104:107], v[208:211], v[64:67]
    s_add_u32 s22, s17, 0x4800
    s_add_u32 m0, s17, 0x14800
    s_nop 0
    buffer_load_dwordx4 v5, s[8:11], s22 offen sc1 lds
    ds_read_b64_tr_b16 v[98:99], v15 offset:58400
    s_waitcnt lgkmcnt(6)
    v_mfma_f32_16x16x32_bf16 v[68:71], v[84:87], v[204:207], v[68:71]
    ds_read_b64_tr_b16 v[100:101], v3 offset:57600
    v_mfma_f32_16x16x32_bf16 v[72:75], v[84:87], v[208:211], v[72:75]
    ds_read_b64_tr_b16 v[102:103], v3 offset:58624
    s_waitcnt lgkmcnt(6)
    v_mfma_f32_16x16x32_bf16 v[76:79], v[88:91], v[204:207], v[76:79]
    ds_read_b64_tr_b16 v[104:105], v15 offset:57632
    v_mfma_f32_16x16x32_bf16 v[80:83], v[88:91], v[208:211], v[80:83]
    ds_read_b64_tr_b16 v[106:107], v15 offset:58656
    s_waitcnt vmcnt(16) lgkmcnt(6)
    v_mfma_f32_16x16x32_bf16 v[20:23], v[92:95], v[212:215], v[20:23]
    ds_read_b64_tr_b16 v[84:85], v3 offset:57856
    s_waitcnt vmcnt(14)
    v_mfma_f32_16x16x32_bf16 v[24:27], v[92:95], v[216:219], v[24:27]
    ds_read_b64_tr_b16 v[86:87], v3 offset:58880
    s_add_u32 s22, s17, 0x10000
    s_add_u32 m0, s17, 0x20000
    s_nop 0
    buffer_load_dwordx4 v5, s[8:11], s22 offen sc1 lds
    s_waitcnt lgkmcnt(6)
    v_mfma_f32_16x16x32_bf16 v[28:31], v[96:99], v[212:215], v[28:31]
    ds_read_b64_tr_b16 v[88:89], v15 offset:57888
    v_mfma_f32_16x16x32_bf16 v[32:35], v[96:99], v[216:219], v[32:35]
    s_add_u32 s22, s17, 0x4c00
    s_add_u32 m0, s17, 0x14c00
    s_nop 0
    buffer_load_dwordx4 v5, s[8:11], s22 offen sc1 lds
    ds_read_b64_tr_b16 v[90:91], v15 offset:58912
    s_add_u32 s22, s17, 0x10400
    s_add_u32 m0, s17, 0x20400
    s_nop 0
    buffer_load_dwordx4 v5, s[8:11], s22 offen sc1 lds
    s_waitcnt lgkmcnt(6)
    v_mfma_f32_16x16x32_bf16 v[36:39], v[100:103], v[212:215], v[36:39]
    ds_read_b64_tr_b16 v[92:93], v3 offset:58112
    v_mfma_f32_16x16x32_bf16 v[40:43], v[100:103], v[216:219], v[40:43]
    ds_read_b64_tr_b16 v[94:95], v3 offset:59136
    s_add_u32 s22, s17, 0x10800
    s_add_u32 m0, s17, 0x20800
    s_nop 0
    buffer_load_dwordx4 v5, s[8:11], s22 offen sc1 lds
    s_waitcnt lgkmcnt(6)
    v_mfma_f32_16x16x32_bf16 v[44:47], v[104:107], v[212:215], v[44:47]
    ds_read_b64_tr_b16 v[96:97], v15 offset:58144
    v_mfma_f32_16x16x32_bf16 v[48:51], v[104:107], v[216:219], v[48:51]
    ds_read_b64_tr_b16 v[98:99], v15 offset:59168
    s_add_u32 s22, s17, 0x10c00
    s_add_u32 m0, s17, 0x20c00
    s_nop 0
    buffer_load_dwordx4 v5, s[8:11], s22 offen sc1 lds
    s_waitcnt lgkmcnt(6)
    v_mfma_f32_16x16x32_bf16 v[52:55], v[84:87], v[212:215], v[52:55]
    v_mfma_f32_16x16x32_bf16 v[56:59], v[84:87], v[216:219], v[56:59]
    s_add_u32 s22, s17, 0x14000
    s_add_u32 m0, s17, 0x24000
    s_nop 0
    buffer_load_dwordx4 v5, s[8:11], s22 offen sc1 lds
    s_waitcnt lgkmcnt(4)
    v_mfma_f32_16x16x32_bf16 v[60:63], v[88:91], v[212:215], v[60:63]
    v_mfma_f32_16x16x32_bf16 v[64:67], v[88:91], v[216:219], v[64:67]
    s_add_u32 s22, s17, 0x14400
    s_add_u32 m0, s17, 0x24400
    s_nop 0
    buffer_load_dwordx4 v5, s[8:11], s22 offen sc1 lds
    s_waitcnt lgkmcnt(2)
    v_mfma_f32_16x16x32_bf16 v[68:71], v[92:95], v[212:215], v[68:71]
    v_mfma_f32_16x16x32_bf16 v[72:75], v[92:95], v[216:219], v[72:75]
    s_add_u32 s22, s17, 0x14800
    s_add_u32 m0, s17, 0x24800
    s_nop 0
    buffer_load_dwordx4 v5, s[8:11], s22 offen sc1 lds
    s_waitcnt lgkmcnt(0)
    v_mfma_f32_16x16x32_bf16 v[76:79], v[96:99], v[212:215], v[76:79]
    v_mfma_f32_16x16x32_bf16 v[80:83], v[96:99], v[216:219], v[80:83]
    s_add_u32 s22, s17, 0x14c00
    s_add_u32 m0, s17, 0x24c00
    s_nop 0
    buffer_load_dwordx4 v5, s[8:11], s22 offen sc1 lds
    s_mov_b32 s24, 0x3e0293ee
    v_cvt_pk_bf16_f32 v108, v20, v21
    v_cvt_pk_bf16_f32 v109, v22, v23
    v_cvt_pk_bf16_f32 v124, v24, v25
    v_cvt_pk_bf16_f32 v125, v26, v27
    v_cvt_pk_bf16_f32 v110, v28, v29
    v_cvt_pk_bf16_f32 v111, v30, v31
    v_cvt_pk_bf16_f32 v126, v32, v33
    v_cvt_pk_bf16_f32 v127, v34, v35
    v_cvt_pk_bf16_f32 v112, v36, v37
    v_cvt_pk_bf16_f32 v113, v38, v39
    v_cvt_pk_bf16_f32 v128, v40, v41
    v_cvt_pk_bf16_f32 v129, v42, v43
    v_cvt_pk_bf16_f32 v114, v44, v45
    v_cvt_pk_bf16_f32 v115, v46, v47
    v_cvt_pk_bf16_f32 v130, v48, v49
    v_cvt_pk_bf16_f32 v131, v50, v51
    v_cvt_pk_bf16_f32 v116, v52, v53
    v_cvt_pk_bf16_f32 v117, v54, v55
    v_cvt_pk_bf16_f32 v132, v56, v57
    v_cvt_pk_bf16_f32 v133, v58, v59
    v_cvt_pk_bf16_f32 v118, v60, v61
    v_cvt_pk_bf16_f32 v119, v62, v63
    v_cvt_pk_bf16_f32 v134, v64, v65
    v_cvt_pk_bf16_f32 v135, v66, v67
    v_cvt_pk_bf16_f32 v120, v68, v69
    v_cvt_pk_bf16_f32 v121, v70, v71
    v_cvt_pk_bf16_f32 v136, v72, v73
    v_cvt_pk_bf16_f32 v137, v74, v75
    v_cvt_pk_bf16_f32 v122, v76, v77
    v_cvt_pk_bf16_f32 v123, v78, v79
    v_cvt_pk_bf16_f32 v138, v80, v81
    v_cvt_pk_bf16_f32 v139, v82, v83
    v_add_u32 v2, 0x10000, v1
    v_add_u32 v3, 0x20000, v1
    s_and_b32 s62, s12, 24
    s_and_b32 s19, s12, 7
    s_lshl_b32 s20, s19, 2
    s_lshr_b32 s20, 0x54732160, s20
    s_and_b32 s20, s20, 7
    s_lshl_b32 s20, s20, 2
    s_bfm_b32 s21, s20, 0
    s_and_b32 s22, s21, 0x51764320
    s_lshl_b32 s22, s22, 4
    s_lshl_b32 s21, s21, 4
    s_or_b32 s21, s21, 15
    s_andn2_b32 s21, 0x51764320, s21
    s_or_b32 s42, s21, s22
    s_or_b32 s42, s42, s19
    s_add_u32 s19, s12, 1
    s_and_b32 s19, s19, 7
    s_lshl_b32 s19, s19, 8
    s_add_u32 s4, s40, s19
    s_addc_u32 s5, s41, 0
    s_sub_u32 s6, 0x800000, s19
    s_mov_b32 s7, 0x20000
    s_lshl_b32 s16, s3, 15
    v_bfe_u32 v9, v0, 2, 2
    v_lshrrev_b32 v10, 4, v0
    v_and_b32 v11, 3, v0
    v_lshlrev_b32 v17, 6, v10
    v_lshl_add_u32 v17, v11, 4, v17
    v_lshl_add_u32 v17, v9, 11, v17
    v_xor_b32 v18, 32, v17
    s_waitcnt vmcnt(19)
    s_barrier
    ds_read_b128 v[84:87], v2 offset:0
    ds_read_b128 v[88:91], v2 offset:1024
    ds_read_b128 v[92:95], v2 offset:2048
    ds_read_b128 v[96:99], v2 offset:3072
    s_waitcnt lgkmcnt(3)
    v_mfma_f32_16x16x32_bf16 v[140:143], v[84:87], v[108:111], 0
    v_mfma_f32_16x16x32_bf16 v[144:147], v[84:87], v[124:127], 0
    ds_read_b128 v[100:103], v2 offset:4096
    s_waitcnt lgkmcnt(3)
    v_mfma_f32_16x16x32_bf16 v[148:151], v[88:91], v[108:111], 0
    v_mfma_f32_16x16x32_bf16 v[152:155], v[88:91], v[124:127], 0
    ds_read_b128 v[104:107], v2 offset:5120
    s_waitcnt lgkmcnt(3)
    v_mfma_f32_16x16x32_bf16 v[140:143], v[92:95], v[112:115], v[140:143]
    v_mfma_f32_16x16x32_bf16 v[144:147], v[92:95], v[128:131], v[144:147]
    ds_read_b128 v[84:87], v2 offset:6144
    s_waitcnt lgkmcnt(3)
    v_mfma_f32_16x16x32_bf16 v[148:151], v[96:99], v[112:115], v[148:151]
    v_mfma_f32_16x16x32_bf16 v[152:155], v[96:99], v[128:131], v[152:155]
    ds_read_b128 v[88:91], v2 offset:7168
    s_waitcnt lgkmcnt(3)
    v_mfma_f32_16x16x32_bf16 v[140:143], v[100:103], v[116:119], v[140:143]
    v_mfma_f32_16x16x32_bf16 v[144:147], v[100:103], v[132:135], v[144:147]
    s_waitcnt vmcnt(7)
    s_barrier
    ds_read_b128 v[92:95], v2 offset:16384
    s_waitcnt lgkmcnt(3)
    v_mfma_f32_16x16x32_bf16 v[148:151], v[104:107], v[116:119], v[148:151]
    v_mfma_f32_16x16x32_bf16 v[152:155], v[104:107], v[132:135], v[152:155]
    ds_read_b128 v[96:99], v2 offset:17408
    s_waitcnt lgkmcnt(3)
    v_mfma_f32_16x16x32_bf16 v[140:143], v[84:87], v[120:123], v[140:143]
    v_mfma_f32_16x16x32_bf16 v[144:147], v[84:87], v[136:139], v[144:147]
    ds_read_b128 v[100:103], v2 offset:18432
    s_waitcnt lgkmcnt(3)
    v_mfma_f32_16x16x32_bf16 v[148:151], v[88:91], v[120:123], v[148:151]
    v_mfma_f32_16x16x32_bf16 v[152:155], v[88:91], v[136:139], v[152:155]
    ds_read_b128 v[104:107], v2 offset:19456
    s_waitcnt lgkmcnt(3)
    v_mfma_f32_16x16x32_bf16 v[156:159], v[92:95], v[108:111], 0
    v_mfma_f32_16x16x32_bf16 v[160:163], v[92:95], v[124:127], 0
    ds_read_b128 v[84:87], v2 offset:20480
    s_waitcnt lgkmcnt(3)
    v_mfma_f32_16x16x32_bf16 v[164:167], v[96:99], v[108:111], 0
    v_mfma_f32_16x16x32_bf16 v[168:171], v[96:99], v[124:127], 0
    ds_read_b128 v[88:91], v2 offset:21504
    s_waitcnt lgkmcnt(3)
    v_mfma_f32_16x16x32_bf16 v[156:159], v[100:103], v[112:115], v[156:159]
    v_mfma_f32_16x16x32_bf16 v[160:163], v[100:103], v[128:131], v[160:163]
    ds_read_b128 v[92:95], v2 offset:22528
    s_waitcnt lgkmcnt(3)
    v_mfma_f32_16x16x32_bf16 v[164:167], v[104:107], v[112:115], v[164:167]
    v_max3_f32 v9, v140, v141, v142
    v_mfma_f32_16x16x32_bf16 v[168:171], v[104:107], v[128:131], v[168:171]
    ds_read_b128 v[96:99], v2 offset:23552
    v_max3_f32 v9, v9, v143, v148
    s_waitcnt lgkmcnt(3)
    v_mfma_f32_16x16x32_bf16 v[156:159], v[84:87], v[116:119], v[156:159]
    v_max3_f32 v9, v9, v149, v150
    v_mfma_f32_16x16x32_bf16 v[160:163], v[84:87], v[132:135], v[160:163]
    s_barrier
    s_setprio 3
    ds_read_b128 v[100:103], v2 offset:32768
    v_max_f32 v9, v9, v151
    s_waitcnt lgkmcnt(3)
    v_mfma_f32_16x16x32_bf16 v[164:167], v[88:91], v[116:119], v[164:167]
    v_max3_f32 v10, v144, v145, v146
    v_mfma_f32_16x16x32_bf16 v[168:171], v[88:91], v[132:135], v[168:171]
    ds_read_b128 v[104:107], v2 offset:33792
    v_max3_f32 v10, v10, v147, v152
    s_waitcnt lgkmcnt(3)
    v_mfma_f32_16x16x32_bf16 v[156:159], v[92:95], v[120:123], v[156:159]
    v_max3_f32 v10, v10, v153, v154
    v_mfma_f32_16x16x32_bf16 v[160:163], v[92:95], v[136:139], v[160:163]
    ds_read_b128 v[84:87], v2 offset:34816
    v_max_f32 v10, v10, v155
    s_waitcnt lgkmcnt(3)
    v_mfma_f32_16x16x32_bf16 v[164:167], v[96:99], v[120:123], v[164:167]
    v_mfma_f32_16x16x32_bf16 v[168:171], v[96:99], v[136:139], v[168:171]
    ds_read_b128 v[88:91], v2 offset:35840
    v_max3_f32 v9, v9, v156, v157
    v_max3_f32 v9, v9, v158, v159
    s_nop 3
    v_max3_f32 v9, v9, v164, v165
    v_max3_f32 v9, v9, v166, v167
    v_max3_f32 v10, v10, v160, v161
    v_max3_f32 v10, v10, v162, v163
    v_max3_f32 v10, v10, v168, v169
    v_max3_f32 v10, v10, v170, v171
    v_mov_b32 v11, v9
    v_mov_b32 v12, v10
    s_nop 0
    v_permlane16_swap_b32 v9, v11
    v_permlane16_swap_b32 v10, v12
    v_max_f32 v9, v9, v11
    v_max_f32 v10, v10, v12
    v_mov_b32 v11, v9
    v_mov_b32 v12, v10
    s_nop 0
    v_permlane32_swap_b32 v9, v11
    v_permlane32_swap_b32 v10, v12
    v_max_f32 v9, v9, v11
    v_max_f32 v10, v10, v12
    v_sub_f32 v172, 0, v9
    v_sub_f32 v173, 0, v9
    v_sub_f32 v174, 0, v9
    v_sub_f32 v175, 0, v9
    v_sub_f32 v176, 0, v10
    v_sub_f32 v177, 0, v10
    v_sub_f32 v178, 0, v10
    v_sub_f32 v179, 0, v10
    v_add_f32 v140, v140, v172
    v_add_f32 v141, v141, v172
    v_exp_f32 v140, v140
    v_exp_f32 v141, v141
    s_nop 0
    v_add_f32 v15, v140, v141
    v_cvt_pk_bf16_f32 v188, v140, v141
    v_add_f32 v142, v142, v172
    v_add_f32 v143, v143, v172
    v_exp_f32 v142, v142
    v_exp_f32 v143, v143
    v_add_f32 v15, v15, v142
    v_add_f32 v15, v15, v143
    v_cvt_pk_bf16_f32 v189, v142, v143
    v_add_f32 v144, v144, v176
    v_add_f32 v145, v145, v176
    v_exp_f32 v144, v144
    v_exp_f32 v145, v145
    s_nop 0
    v_add_f32 v16, v144, v145
    v_cvt_pk_bf16_f32 v192, v144, v145
    v_add_f32 v146, v146, v176
    v_add_f32 v147, v147, v176
    v_exp_f32 v146, v146
    v_exp_f32 v147, v147
    v_add_f32 v16, v16, v146
    v_add_f32 v16, v16, v147
    v_cvt_pk_bf16_f32 v193, v146, v147
    v_add_f32 v148, v148, v172
    v_add_f32 v149, v149, v172
    v_exp_f32 v148, v148
    v_exp_f32 v149, v149
    v_add_f32 v15, v15, v148
    v_add_f32 v15, v15, v149
    v_cvt_pk_bf16_f32 v190, v148, v149
    v_add_f32 v150, v150, v172
    v_add_f32 v151, v151, v172
    v_exp_f32 v150, v150
    v_exp_f32 v151, v151
    v_add_f32 v15, v15, v150
    v_add_f32 v15, v15, v151
    v_cvt_pk_bf16_f32 v191, v150, v151
    v_add_f32 v152, v152, v176
    v_add_f32 v153, v153, v176
    v_exp_f32 v152, v152
    v_exp_f32 v153, v153
    v_add_f32 v16, v16, v152
    v_add_f32 v16, v16, v153
    v_cvt_pk_bf16_f32 v194, v152, v153
    v_add_f32 v154, v154, v176
    v_add_f32 v155, v155, v176
    v_exp_f32 v154, v154
    v_exp_f32 v155, v155
    v_add_f32 v16, v16, v154
    v_add_f32 v16, v16, v155
    v_cvt_pk_bf16_f32 v195, v154, v155
    s_waitcnt lgkmcnt(3)
    v_mfma_f32_16x16x32_bf16 v[140:143], v[100:103], v[108:111], v[172:175]
    v_add_f32 v156, v156, v172
    v_add_f32 v157, v157, v172
    v_mfma_f32_16x16x32_bf16 v[144:147], v[100:103], v[124:127], v[176:179]
    ds_read_b128 v[92:95], v2 offset:36864
    v_exp_f32 v156, v156
    v_exp_f32 v157, v157
    s_waitcnt lgkmcnt(3)
    v_mfma_f32_16x16x32_bf16 v[148:151], v[104:107], v[108:111], v[172:175]
    v_add_f32 v15, v15, v156
    v_add_f32 v15, v15, v157
    v_mfma_f32_16x16x32_bf16 v[152:155], v[104:107], v[124:127], v[176:179]
    ds_read_b128 v[96:99], v2 offset:37888
    v_cvt_pk_bf16_f32 v196, v156, v157
    s_waitcnt lgkmcnt(3)
    v_mfma_f32_16x16x32_bf16 v[140:143], v[84:87], v[112:115], v[140:143]
    v_add_f32 v158, v158, v172
    v_add_f32 v159, v159, v172
    v_mfma_f32_16x16x32_bf16 v[144:147], v[84:87], v[128:131], v[144:147]
    ds_read_b128 v[100:103], v2 offset:38912
    v_exp_f32 v158, v158
    v_exp_f32 v159, v159
    s_waitcnt lgkmcnt(3)
    v_mfma_f32_16x16x32_bf16 v[148:151], v[88:91], v[112:115], v[148:151]
    v_add_f32 v15, v15, v158
    v_add_f32 v15, v15, v159
    v_mfma_f32_16x16x32_bf16 v[152:155], v[88:91], v[128:131], v[152:155]
    ds_read_b128 v[104:107], v2 offset:39936
    v_cvt_pk_bf16_f32 v197, v158, v159
    s_waitcnt lgkmcnt(3)
    v_mfma_f32_16x16x32_bf16 v[140:143], v[92:95], v[116:119], v[140:143]
    v_add_f32 v160, v160, v176
    v_add_f32 v161, v161, v176
    v_mfma_f32_16x16x32_bf16 v[144:147], v[92:95], v[132:135], v[144:147]
    ds_read_b128 v[84:87], v2 offset:8192
    v_exp_f32 v160, v160
    v_exp_f32 v161, v161
    s_waitcnt lgkmcnt(3)
    v_mfma_f32_16x16x32_bf16 v[148:151], v[96:99], v[116:119], v[148:151]
    v_add_f32 v16, v16, v160
    v_add_f32 v16, v16, v161
    v_mfma_f32_16x16x32_bf16 v[152:155], v[96:99], v[132:135], v[152:155]
    ds_read_b128 v[88:91], v2 offset:9216
    v_cvt_pk_bf16_f32 v200, v160, v161
    s_waitcnt lgkmcnt(3)
    v_mfma_f32_16x16x32_bf16 v[140:143], v[100:103], v[120:123], v[140:143]
    v_add_f32 v162, v162, v176
    v_add_f32 v163, v163, v176
    v_mfma_f32_16x16x32_bf16 v[144:147], v[100:103], v[136:139], v[144:147]
    ds_read_b128 v[92:95], v2 offset:10240
    v_exp_f32 v162, v162
    v_exp_f32 v163, v163
    s_waitcnt lgkmcnt(3)
    v_mfma_f32_16x16x32_bf16 v[148:151], v[104:107], v[120:123], v[148:151]
    v_add_f32 v16, v16, v162
    v_add_f32 v16, v16, v163
    v_mfma_f32_16x16x32_bf16 v[152:155], v[104:107], v[136:139], v[152:155]
    ds_read_b128 v[96:99], v2 offset:11264
    v_cvt_pk_bf16_f32 v201, v162, v163
    s_waitcnt lgkmcnt(3)
    v_mfma_f32_16x16x32_bf16 v[20:23], v[84:87], v[188:191], 0
    v_add_f32 v164, v164, v172
    v_add_f32 v165, v165, v172
    v_mfma_f32_16x16x32_bf16 v[24:27], v[84:87], v[192:195], 0
    ds_read_b128 v[100:103], v2 offset:12288
    v_exp_f32 v164, v164
    v_exp_f32 v165, v165
    s_waitcnt lgkmcnt(3)
    v_mfma_f32_16x16x32_bf16 v[28:31], v[88:91], v[188:191], 0
    v_add_f32 v15, v15, v164
    v_add_f32 v15, v15, v165
    v_mfma_f32_16x16x32_bf16 v[32:35], v[88:91], v[192:195], 0
    ds_read_b128 v[104:107], v2 offset:13312
    v_cvt_pk_bf16_f32 v198, v164, v165
    s_waitcnt lgkmcnt(3)
    v_mfma_f32_16x16x32_bf16 v[36:39], v[92:95], v[188:191], 0
    v_add_f32 v166, v166, v172
    v_add_f32 v167, v167, v172
    v_mfma_f32_16x16x32_bf16 v[40:43], v[92:95], v[192:195], 0
    ds_read_b128 v[84:87], v2 offset:14336
    v_exp_f32 v166, v166
    v_exp_f32 v167, v167
    s_waitcnt lgkmcnt(3)
    v_mfma_f32_16x16x32_bf16 v[44:47], v[96:99], v[188:191], 0
    v_add_f32 v15, v15, v166
    v_add_f32 v15, v15, v167
    v_mfma_f32_16x16x32_bf16 v[48:51], v[96:99], v[192:195], 0
    ds_read_b128 v[88:91], v2 offset:15360
    v_cvt_pk_bf16_f32 v199, v166, v167
    s_waitcnt lgkmcnt(3)
    v_mfma_f32_16x16x32_bf16 v[52:55], v[100:103], v[188:191], 0
    v_add_f32 v168, v168, v176
    v_add_f32 v169, v169, v176
    v_mfma_f32_16x16x32_bf16 v[56:59], v[100:103], v[192:195], 0
    s_barrier
    ds_read_b128 v[92:95], v2 offset:49152
    v_exp_f32 v168, v168
    v_exp_f32 v169, v169
    s_waitcnt lgkmcnt(3)
    v_mfma_f32_16x16x32_bf16 v[60:63], v[104:107], v[188:191], 0
    v_add_f32 v16, v16, v168
    v_add_f32 v16, v16, v169
    v_mfma_f32_16x16x32_bf16 v[64:67], v[104:107], v[192:195], 0
    ds_read_b128 v[96:99], v2 offset:50176
    v_cvt_pk_bf16_f32 v202, v168, v169
    s_waitcnt lgkmcnt(3)
    v_mfma_f32_16x16x32_bf16 v[68:71], v[84:87], v[188:191], 0
    v_add_f32 v170, v170, v176
    v_add_f32 v171, v171, v176
    v_mfma_f32_16x16x32_bf16 v[72:75], v[84:87], v[192:195], 0
    ds_read_b128 v[100:103], v2 offset:51200
    v_exp_f32 v170, v170
    v_exp_f32 v171, v171
    s_waitcnt lgkmcnt(3)
    v_mfma_f32_16x16x32_bf16 v[76:79], v[88:91], v[188:191], 0
    v_add_f32 v16, v16, v170
    v_add_f32 v16, v16, v171
    v_mfma_f32_16x16x32_bf16 v[80:83], v[88:91], v[192:195], 0
    ds_read_b128 v[104:107], v2 offset:52224
    v_cvt_pk_bf16_f32 v203, v170, v171
    s_waitcnt lgkmcnt(3)
    v_mfma_f32_16x16x32_bf16 v[156:159], v[92:95], v[108:111], v[172:175]
    v_exp_f32 v140, v140
    v_exp_f32 v141, v141
    v_mfma_f32_16x16x32_bf16 v[160:163], v[92:95], v[124:127], v[176:179]
    ds_read_b128 v[84:87], v2 offset:53248
    v_add_f32 v15, v15, v140
    s_waitcnt lgkmcnt(3)
    v_mfma_f32_16x16x32_bf16 v[164:167], v[96:99], v[108:111], v[172:175]
    v_add_f32 v15, v15, v141
    v_mfma_f32_16x16x32_bf16 v[168:171], v[96:99], v[124:127], v[176:179]
    ds_read_b128 v[88:91], v2 offset:54272
    v_cvt_pk_bf16_f32 v188, v140, v141
    s_waitcnt lgkmcnt(3)
    v_mfma_f32_16x16x32_bf16 v[156:159], v[100:103], v[112:115], v[156:159]
    v_exp_f32 v142, v142
    v_exp_f32 v143, v143
    v_mfma_f32_16x16x32_bf16 v[160:163], v[100:103], v[128:131], v[160:163]
    ds_read_b128 v[92:95], v2 offset:55296
    v_add_f32 v15, v15, v142
    s_waitcnt lgkmcnt(3)
    v_mfma_f32_16x16x32_bf16 v[164:167], v[104:107], v[112:115], v[164:167]
    v_add_f32 v15, v15, v143
    v_mfma_f32_16x16x32_bf16 v[168:171], v[104:107], v[128:131], v[168:171]
    ds_read_b128 v[96:99], v2 offset:56320
    v_cvt_pk_bf16_f32 v189, v142, v143
    s_waitcnt lgkmcnt(3)
    v_mfma_f32_16x16x32_bf16 v[156:159], v[84:87], v[116:119], v[156:159]
    v_exp_f32 v144, v144
    v_exp_f32 v145, v145
    v_mfma_f32_16x16x32_bf16 v[160:163], v[84:87], v[132:135], v[160:163]
    ds_read_b128 v[100:103], v2 offset:24576
    v_add_f32 v16, v16, v144
    s_waitcnt lgkmcnt(3)
    v_mfma_f32_16x16x32_bf16 v[164:167], v[88:91], v[116:119], v[164:167]
    v_add_f32 v16, v16, v145
    v_mfma_f32_16x16x32_bf16 v[168:171], v[88:91], v[132:135], v[168:171]
    ds_read_b128 v[104:107], v2 offset:25600
    v_cvt_pk_bf16_f32 v192, v144, v145
    s_waitcnt lgkmcnt(3)
    v_mfma_f32_16x16x32_bf16 v[156:159], v[92:95], v[120:123], v[156:159]
    v_exp_f32 v146, v146
    v_exp_f32 v147, v147
    v_mfma_f32_16x16x32_bf16 v[160:163], v[92:95], v[136:139], v[160:163]
    ds_read_b128 v[84:87], v2 offset:26624
    v_add_f32 v16, v16, v146
    s_waitcnt lgkmcnt(3)
    v_mfma_f32_16x16x32_bf16 v[164:167], v[96:99], v[120:123], v[164:167]
    v_add_f32 v16, v16, v147
    v_mfma_f32_16x16x32_bf16 v[168:171], v[96:99], v[136:139], v[168:171]
    ds_read_b128 v[88:91], v2 offset:27648
    v_cvt_pk_bf16_f32 v193, v146, v147
    s_waitcnt lgkmcnt(3)
    v_mfma_f32_16x16x32_bf16 v[20:23], v[100:103], v[196:199], v[20:23]
    v_exp_f32 v148, v148
    v_exp_f32 v149, v149
    v_mfma_f32_16x16x32_bf16 v[24:27], v[100:103], v[200:203], v[24:27]
    ds_read_b128 v[92:95], v2 offset:28672
    v_add_f32 v15, v15, v148
    s_waitcnt lgkmcnt(3)
    v_mfma_f32_16x16x32_bf16 v[28:31], v[104:107], v[196:199], v[28:31]
    v_add_f32 v15, v15, v149
    v_mfma_f32_16x16x32_bf16 v[32:35], v[104:107], v[200:203], v[32:35]
    ds_read_b128 v[96:99], v2 offset:29696
    v_cvt_pk_bf16_f32 v190, v148, v149
    s_waitcnt lgkmcnt(3)
    v_mfma_f32_16x16x32_bf16 v[36:39], v[84:87], v[196:199], v[36:39]
    v_exp_f32 v150, v150
    v_exp_f32 v151, v151
    v_mfma_f32_16x16x32_bf16 v[40:43], v[84:87], v[200:203], v[40:43]
    ds_read_b128 v[100:103], v2 offset:30720
    v_add_f32 v15, v15, v150
    s_waitcnt lgkmcnt(3)
    v_mfma_f32_16x16x32_bf16 v[44:47], v[88:91], v[196:199], v[44:47]
    v_add_f32 v15, v15, v151
    v_mfma_f32_16x16x32_bf16 v[48:51], v[88:91], v[200:203], v[48:51]
    ds_read_b128 v[104:107], v2 offset:31744
    v_cvt_pk_bf16_f32 v191, v150, v151
    s_waitcnt lgkmcnt(3)
    v_mfma_f32_16x16x32_bf16 v[52:55], v[92:95], v[196:199], v[52:55]
    v_exp_f32 v152, v152
    v_exp_f32 v153, v153
    v_mfma_f32_16x16x32_bf16 v[56:59], v[92:95], v[200:203], v[56:59]
    s_waitcnt vmcnt(4)
    s_barrier
    ds_read_b128 v[84:87], v3 offset:0
    v_add_f32 v16, v16, v152
    s_waitcnt lgkmcnt(3)
    v_mfma_f32_16x16x32_bf16 v[60:63], v[96:99], v[196:199], v[60:63]
    v_add_f32 v16, v16, v153
    v_mfma_f32_16x16x32_bf16 v[64:67], v[96:99], v[200:203], v[64:67]
    s_add_u32 s22, s17, 0x18000
    s_add_u32 m0, s17, 0x10000
    s_nop 0
    buffer_load_dwordx4 v5, s[8:11], s22 offen sc1 lds
    ds_read_b128 v[88:91], v3 offset:1024
    v_cvt_pk_bf16_f32 v194, v152, v153
    s_waitcnt lgkmcnt(3)
    v_mfma_f32_16x16x32_bf16 v[68:71], v[100:103], v[196:199], v[68:71]
    v_exp_f32 v154, v154
    v_exp_f32 v155, v155
    v_mfma_f32_16x16x32_bf16 v[72:75], v[100:103], v[200:203], v[72:75]
    ds_read_b128 v[92:95], v3 offset:2048
    v_add_f32 v16, v16, v154
    s_waitcnt lgkmcnt(3)
    v_mfma_f32_16x16x32_bf16 v[76:79], v[104:107], v[196:199], v[76:79]
    v_add_f32 v16, v16, v155
    v_mfma_f32_16x16x32_bf16 v[80:83], v[104:107], v[200:203], v[80:83]
    s_add_u32 s22, s17, 0x18400
    s_add_u32 m0, s17, 0x10400
    s_nop 0
    buffer_load_dwordx4 v5, s[8:11], s22 offen sc1 lds
    ds_read_b128 v[96:99], v3 offset:3072
    v_cvt_pk_bf16_f32 v195, v154, v155
    s_waitcnt lgkmcnt(3)
    v_mfma_f32_16x16x32_bf16 v[140:143], v[84:87], v[108:111], v[172:175]
    v_exp_f32 v156, v156
    v_exp_f32 v157, v157
    v_mfma_f32_16x16x32_bf16 v[144:147], v[84:87], v[124:127], v[176:179]
    ds_read_b128 v[100:103], v3 offset:4096
    v_add_f32 v15, v15, v156
    s_waitcnt lgkmcnt(3)
    v_mfma_f32_16x16x32_bf16 v[148:151], v[88:91], v[108:111], v[172:175]
    v_add_f32 v15, v15, v157
    v_mfma_f32_16x16x32_bf16 v[152:155], v[88:91], v[124:127], v[176:179]
    s_add_u32 s22, s17, 0x18800
    s_add_u32 m0, s17, 0x10800
    s_nop 0
    buffer_load_dwordx4 v5, s[8:11], s22 offen sc1 lds
    ds_read_b128 v[104:107], v3 offset:5120
    v_cvt_pk_bf16_f32 v196, v156, v157
    s_waitcnt lgkmcnt(3)
    v_mfma_f32_16x16x32_bf16 v[140:143], v[92:95], v[112:115], v[140:143]
    v_exp_f32 v158, v158
    v_exp_f32 v159, v159
    v_mfma_f32_16x16x32_bf16 v[144:147], v[92:95], v[128:131], v[144:147]
    ds_read_b128 v[84:87], v3 offset:6144
    v_add_f32 v15, v15, v158
    s_waitcnt lgkmcnt(3)
    v_mfma_f32_16x16x32_bf16 v[148:151], v[96:99], v[112:115], v[148:151]
    v_add_f32 v15, v15, v159
    v_mfma_f32_16x16x32_bf16 v[152:155], v[96:99], v[128:131], v[152:155]
    s_add_u32 s22, s17, 0x18c00
    s_add_u32 m0, s17, 0x10c00
    s_nop 0
    buffer_load_dwordx4 v5, s[8:11], s22 offen sc1 lds
    ds_read_b128 v[88:91], v3 offset:7168
    v_cvt_pk_bf16_f32 v197, v158, v159
    s_waitcnt lgkmcnt(3)
    v_mfma_f32_16x16x32_bf16 v[140:143], v[100:103], v[116:119], v[140:143]
    v_exp_f32 v160, v160
    v_exp_f32 v161, v161
    v_mfma_f32_16x16x32_bf16 v[144:147], v[100:103], v[132:135], v[144:147]
    ds_read_b128 v[92:95], v2 offset:40960
    v_add_f32 v16, v16, v160
    s_waitcnt lgkmcnt(3)
    v_mfma_f32_16x16x32_bf16 v[148:151], v[104:107], v[116:119], v[148:151]
    v_add_f32 v16, v16, v161
    v_mfma_f32_16x16x32_bf16 v[152:155], v[104:107], v[132:135], v[152:155]
    ds_read_b128 v[96:99], v2 offset:41984
    v_cvt_pk_bf16_f32 v200, v160, v161
    s_waitcnt lgkmcnt(3)
    v_mfma_f32_16x16x32_bf16 v[140:143], v[84:87], v[120:123], v[140:143]
    v_exp_f32 v162, v162
    v_exp_f32 v163, v163
    v_mfma_f32_16x16x32_bf16 v[144:147], v[84:87], v[136:139], v[144:147]
    ds_read_b128 v[100:103], v2 offset:43008
    v_add_f32 v16, v16, v162
    s_waitcnt lgkmcnt(3)
    v_mfma_f32_16x16x32_bf16 v[148:151], v[88:91], v[120:123], v[148:151]
    v_add_f32 v16, v16, v163
    v_mfma_f32_16x16x32_bf16 v[152:155], v[88:91], v[136:139], v[152:155]
    ds_read_b128 v[104:107], v2 offset:44032
    v_cvt_pk_bf16_f32 v201, v162, v163
    s_waitcnt lgkmcnt(3)
    v_mfma_f32_16x16x32_bf16 v[20:23], v[92:95], v[188:191], v[20:23]
    v_exp_f32 v164, v164
    v_exp_f32 v165, v165
    v_mfma_f32_16x16x32_bf16 v[24:27], v[92:95], v[192:195], v[24:27]
    ds_read_b128 v[84:87], v2 offset:45056
    v_add_f32 v15, v15, v164
    s_waitcnt lgkmcnt(3)
    v_mfma_f32_16x16x32_bf16 v[28:31], v[96:99], v[188:191], v[28:31]
    v_add_f32 v15, v15, v165
    v_mfma_f32_16x16x32_bf16 v[32:35], v[96:99], v[192:195], v[32:35]
    ds_read_b128 v[88:91], v2 offset:46080
    v_cvt_pk_bf16_f32 v198, v164, v165
    s_waitcnt lgkmcnt(3)
    v_mfma_f32_16x16x32_bf16 v[36:39], v[100:103], v[188:191], v[36:39]
    v_exp_f32 v166, v166
    v_exp_f32 v167, v167
    v_mfma_f32_16x16x32_bf16 v[40:43], v[100:103], v[192:195], v[40:43]
    ds_read_b128 v[92:95], v2 offset:47104
    v_add_f32 v15, v15, v166
    s_waitcnt lgkmcnt(3)
    v_mfma_f32_16x16x32_bf16 v[44:47], v[104:107], v[188:191], v[44:47]
    v_add_f32 v15, v15, v167
    v_mfma_f32_16x16x32_bf16 v[48:51], v[104:107], v[192:195], v[48:51]
    ds_read_b128 v[96:99], v2 offset:48128
    v_cvt_pk_bf16_f32 v199, v166, v167
    v_lshrrev_b32 v6, 3, v8
    v_and_b32 v7, 7, v8
    s_mov_b64 s[64:65], s[50:51]
    s_mov_b32 s66, 0x700000
    s_mov_b32 s67, 0x20000
    v_mul_u32_u24 v19, 14336, v6
    v_lshl_add_u32 v19, v7, 4, v19
    s_and_b32 s24, s2, 7
    s_lshl_b32 s24, s24, 1
    s_lshr_b32 s26, s2, 7
    s_add_u32 s24, s24, s26
    s_mul_i32 s24, s24, 458752
    s_bfe_u32 s25, s2, 0x40003
    s_lshl_b32 s25, s25, 7
    s_add_u32 s24, s24, s25
    s_waitcnt lgkmcnt(3)
    v_mfma_f32_16x16x32_bf16 v[52:55], v[84:87], v[188:191], v[52:55]
    v_exp_f32 v168, v168
    v_exp_f32 v169, v169
    v_mfma_f32_16x16x32_bf16 v[56:59], v[84:87], v[192:195], v[56:59]
    s_waitcnt vmcnt(4)
    s_barrier
    ds_read_b128 v[100:103], v3 offset:16384
    v_add_f32 v16, v16, v168
    s_add_u32 s25, s24, 0
    buffer_load_dwordx4 v[204:207], v19, s[64:67], s25 offen
    s_waitcnt lgkmcnt(3)
    v_mfma_f32_16x16x32_bf16 v[60:63], v[88:91], v[188:191], v[60:63]
    v_add_f32 v16, v16, v169
    v_mfma_f32_16x16x32_bf16 v[64:67], v[88:91], v[192:195], v[64:67]
    s_add_u32 s22, s17, 0x1c000
    s_add_u32 m0, s17, 0x14000
    s_nop 0
    buffer_load_dwordx4 v5, s[8:11], s22 offen sc1 lds
    ds_read_b128 v[104:107], v3 offset:17408
    v_cvt_pk_bf16_f32 v202, v168, v169
    s_waitcnt lgkmcnt(3)
    v_mfma_f32_16x16x32_bf16 v[68:71], v[92:95], v[188:191], v[68:71]
    v_exp_f32 v170, v170
    v_exp_f32 v171, v171
    v_mfma_f32_16x16x32_bf16 v[72:75], v[92:95], v[192:195], v[72:75]
    ds_read_b128 v[84:87], v3 offset:18432
    v_add_f32 v16, v16, v170
    s_waitcnt lgkmcnt(3)
    v_mfma_f32_16x16x32_bf16 v[76:79], v[96:99], v[188:191], v[76:79]
    v_add_f32 v16, v16, v171
    v_mfma_f32_16x16x32_bf16 v[80:83], v[96:99], v[192:195], v[80:83]
    s_add_u32 s22, s17, 0x1c400
    s_add_u32 m0, s17, 0x14400
    s_nop 0
    buffer_load_dwordx4 v5, s[8:11], s22 offen sc1 lds
    ds_read_b128 v[88:91], v3 offset:19456
    v_cvt_pk_bf16_f32 v203, v170, v171
    s_waitcnt lgkmcnt(3)
    v_mfma_f32_16x16x32_bf16 v[156:159], v[100:103], v[108:111], v[172:175]
    v_exp_f32 v140, v140
    v_exp_f32 v141, v141
    v_mfma_f32_16x16x32_bf16 v[160:163], v[100:103], v[124:127], v[176:179]
    ds_read_b128 v[92:95], v3 offset:20480
    v_add_f32 v15, v15, v140
    s_waitcnt lgkmcnt(3)
    v_mfma_f32_16x16x32_bf16 v[164:167], v[104:107], v[108:111], v[172:175]
    v_add_f32 v15, v15, v141
    v_mfma_f32_16x16x32_bf16 v[168:171], v[104:107], v[124:127], v[176:179]
    s_add_u32 s22, s17, 0x1c800
    s_add_u32 m0, s17, 0x14800
    s_nop 0
    buffer_load_dwordx4 v5, s[8:11], s22 offen sc1 lds
    ds_read_b128 v[96:99], v3 offset:21504
    v_cvt_pk_bf16_f32 v188, v140, v141
    s_add_u32 s25, s24, 2048
    buffer_load_dwordx4 v[208:211], v19, s[64:67], s25 offen
    s_waitcnt lgkmcnt(3)
    v_mfma_f32_16x16x32_bf16 v[156:159], v[84:87], v[112:115], v[156:159]
    v_exp_f32 v142, v142
    v_exp_f32 v143, v143
    v_mfma_f32_16x16x32_bf16 v[160:163], v[84:87], v[128:131], v[160:163]
    ds_read_b128 v[100:103], v3 offset:22528
    v_add_f32 v15, v15, v142
    s_waitcnt lgkmcnt(3)
    v_mfma_f32_16x16x32_bf16 v[164:167], v[88:91], v[112:115], v[164:167]
    v_add_f32 v15, v15, v143
    v_mfma_f32_16x16x32_bf16 v[168:171], v[88:91], v[128:131], v[168:171]
    s_add_u32 s22, s17, 0x1cc00
    s_add_u32 m0, s17, 0x14c00
    s_nop 0
    buffer_load_dwordx4 v5, s[8:11], s22 offen sc1 lds
    ds_read_b128 v[104:107], v3 offset:23552
    v_cvt_pk_bf16_f32 v189, v142, v143
    s_waitcnt lgkmcnt(3)
    v_mfma_f32_16x16x32_bf16 v[156:159], v[92:95], v[116:119], v[156:159]
    v_exp_f32 v144, v144
    v_exp_f32 v145, v145
    v_mfma_f32_16x16x32_bf16 v[160:163], v[92:95], v[132:135], v[160:163]
    ds_read_b128 v[84:87], v2 offset:57344
    v_add_f32 v16, v16, v144
    s_waitcnt lgkmcnt(3)
    v_mfma_f32_16x16x32_bf16 v[164:167], v[96:99], v[116:119], v[164:167]
    v_add_f32 v16, v16, v145
    v_mfma_f32_16x16x32_bf16 v[168:171], v[96:99], v[132:135], v[168:171]
    ds_read_b128 v[88:91], v2 offset:58368
    v_cvt_pk_bf16_f32 v192, v144, v145
    s_waitcnt lgkmcnt(3)
    v_mfma_f32_16x16x32_bf16 v[156:159], v[100:103], v[120:123], v[156:159]
    v_exp_f32 v146, v146
    v_exp_f32 v147, v147
    v_mfma_f32_16x16x32_bf16 v[160:163], v[100:103], v[136:139], v[160:163]
    ds_read_b128 v[92:95], v2 offset:59392
    v_add_f32 v16, v16, v146
    s_waitcnt lgkmcnt(3)
    v_mfma_f32_16x16x32_bf16 v[164:167], v[104:107], v[120:123], v[164:167]
    v_add_f32 v16, v16, v147
    v_mfma_f32_16x16x32_bf16 v[168:171], v[104:107], v[136:139], v[168:171]
    ds_read_b128 v[96:99], v2 offset:60416
    v_cvt_pk_bf16_f32 v193, v146, v147
    s_add_u32 s25, s24, 4096
    buffer_load_dwordx4 v[212:215], v19, s[64:67], s25 offen
    s_waitcnt lgkmcnt(3)
    v_mfma_f32_16x16x32_bf16 v[20:23], v[84:87], v[196:199], v[20:23]
    v_exp_f32 v148, v148
    v_exp_f32 v149, v149
    v_mfma_f32_16x16x32_bf16 v[24:27], v[84:87], v[200:203], v[24:27]
    ds_read_b128 v[100:103], v2 offset:61440
    v_add_f32 v15, v15, v148
    s_waitcnt lgkmcnt(3)
    v_mfma_f32_16x16x32_bf16 v[28:31], v[88:91], v[196:199], v[28:31]
    v_add_f32 v15, v15, v149
    v_mfma_f32_16x16x32_bf16 v[32:35], v[88:91], v[200:203], v[32:35]
    ds_read_b128 v[104:107], v2 offset:62464
    v_cvt_pk_bf16_f32 v190, v148, v149
    s_waitcnt lgkmcnt(3)
    v_mfma_f32_16x16x32_bf16 v[36:39], v[92:95], v[196:199], v[36:39]
    v_exp_f32 v150, v150
    v_exp_f32 v151, v151
    v_mfma_f32_16x16x32_bf16 v[40:43], v[92:95], v[200:203], v[40:43]
    ds_read_b128 v[84:87], v2 offset:63488
    v_add_f32 v15, v15, v150
    s_waitcnt lgkmcnt(3)
    v_mfma_f32_16x16x32_bf16 v[44:47], v[96:99], v[196:199], v[44:47]
    v_add_f32 v15, v15, v151
    v_mfma_f32_16x16x32_bf16 v[48:51], v[96:99], v[200:203], v[48:51]
    ds_read_b128 v[88:91], v2 offset:64512
    v_cvt_pk_bf16_f32 v191, v150, v151
    s_waitcnt lgkmcnt(3)
    v_mfma_f32_16x16x32_bf16 v[52:55], v[100:103], v[196:199], v[52:55]
    v_exp_f32 v152, v152
    v_exp_f32 v153, v153
    v_mfma_f32_16x16x32_bf16 v[56:59], v[100:103], v[200:203], v[56:59]
    s_waitcnt vmcnt(7)
    s_barrier
    ds_read_b128 v[92:95], v2 offset:0
    v_add_f32 v16, v16, v152
    s_waitcnt lgkmcnt(3)
    v_mfma_f32_16x16x32_bf16 v[60:63], v[104:107], v[196:199], v[60:63]
    v_add_f32 v16, v16, v153
    v_mfma_f32_16x16x32_bf16 v[64:67], v[104:107], v[200:203], v[64:67]
    s_add_u32 s22, s17, 0x20000
    s_add_u32 m0, s17, 0x18000
    s_nop 0
    buffer_load_dwordx4 v5, s[8:11], s22 offen sc1 lds
    ds_read_b128 v[96:99], v2 offset:1024
    v_cvt_pk_bf16_f32 v194, v152, v153
    s_add_u32 s25, s24, 6144
    buffer_load_dwordx4 v[216:219], v19, s[64:67], s25 offen
    s_waitcnt lgkmcnt(3)
    v_mfma_f32_16x16x32_bf16 v[68:71], v[84:87], v[196:199], v[68:71]
    v_exp_f32 v154, v154
    v_exp_f32 v155, v155
    v_mfma_f32_16x16x32_bf16 v[72:75], v[84:87], v[200:203], v[72:75]
    ds_read_b128 v[100:103], v2 offset:2048
    v_add_f32 v16, v16, v154
    s_waitcnt lgkmcnt(3)
    v_mfma_f32_16x16x32_bf16 v[76:79], v[88:91], v[196:199], v[76:79]
    v_add_f32 v16, v16, v155
    v_mfma_f32_16x16x32_bf16 v[80:83], v[88:91], v[200:203], v[80:83]
    s_add_u32 s22, s17, 0x20400
    s_add_u32 m0, s17, 0x18400
    s_nop 0
    buffer_load_dwordx4 v5, s[8:11], s22 offen sc1 lds
    ds_read_b128 v[104:107], v2 offset:3072
    v_cvt_pk_bf16_f32 v195, v154, v155
    s_waitcnt lgkmcnt(3)
    v_mfma_f32_16x16x32_bf16 v[140:143], v[92:95], v[108:111], v[172:175]
    v_exp_f32 v156, v156
    v_exp_f32 v157, v157
    v_mfma_f32_16x16x32_bf16 v[144:147], v[92:95], v[124:127], v[176:179]
    ds_read_b128 v[84:87], v2 offset:4096
    v_add_f32 v15, v15, v156
    s_waitcnt lgkmcnt(3)
    v_mfma_f32_16x16x32_bf16 v[148:151], v[96:99], v[108:111], v[172:175]
    v_add_f32 v15, v15, v157
    v_mfma_f32_16x16x32_bf16 v[152:155], v[96:99], v[124:127], v[176:179]
    s_add_u32 s22, s17, 0x20800
    s_add_u32 m0, s17, 0x18800
    s_nop 0
    buffer_load_dwordx4 v5, s[8:11], s22 offen sc1 lds
    ds_read_b128 v[88:91], v2 offset:5120
    v_cvt_pk_bf16_f32 v196, v156, v157
    s_waitcnt lgkmcnt(3)
    v_mfma_f32_16x16x32_bf16 v[140:143], v[100:103], v[112:115], v[140:143]
    v_exp_f32 v158, v158
    v_exp_f32 v159, v159
    v_mfma_f32_16x16x32_bf16 v[144:147], v[100:103], v[128:131], v[144:147]
    ds_read_b128 v[92:95], v2 offset:6144
    v_add_f32 v15, v15, v158
    s_add_u32 s25, s24, 8192
    buffer_load_dwordx4 v[220:223], v19, s[64:67], s25 offen
    s_waitcnt lgkmcnt(3)
    v_mfma_f32_16x16x32_bf16 v[148:151], v[104:107], v[112:115], v[148:151]
    v_add_f32 v15, v15, v159
    v_mfma_f32_16x16x32_bf16 v[152:155], v[104:107], v[128:131], v[152:155]
    s_add_u32 s22, s17, 0x20c00
    s_add_u32 m0, s17, 0x18c00
    s_nop 0
    buffer_load_dwordx4 v5, s[8:11], s22 offen sc1 lds
    ds_read_b128 v[96:99], v2 offset:7168
    v_cvt_pk_bf16_f32 v197, v158, v159
    s_waitcnt lgkmcnt(3)
    v_mfma_f32_16x16x32_bf16 v[140:143], v[84:87], v[116:119], v[140:143]
    v_exp_f32 v160, v160
    v_exp_f32 v161, v161
    v_mfma_f32_16x16x32_bf16 v[144:147], v[84:87], v[132:135], v[144:147]
    ds_read_b128 v[100:103], v3 offset:8192
    v_add_f32 v16, v16, v160
    s_waitcnt lgkmcnt(3)
    v_mfma_f32_16x16x32_bf16 v[148:151], v[88:91], v[116:119], v[148:151]
    v_add_f32 v16, v16, v161
    v_mfma_f32_16x16x32_bf16 v[152:155], v[88:91], v[132:135], v[152:155]
    ds_read_b128 v[104:107], v3 offset:9216
    v_cvt_pk_bf16_f32 v200, v160, v161
    s_waitcnt lgkmcnt(3)
    v_mfma_f32_16x16x32_bf16 v[140:143], v[92:95], v[120:123], v[140:143]
    v_exp_f32 v162, v162
    v_exp_f32 v163, v163
    v_mfma_f32_16x16x32_bf16 v[144:147], v[92:95], v[136:139], v[144:147]
    ds_read_b128 v[84:87], v3 offset:10240
    v_add_f32 v16, v16, v162
    s_waitcnt lgkmcnt(3)
    v_mfma_f32_16x16x32_bf16 v[148:151], v[96:99], v[120:123], v[148:151]
    v_add_f32 v16, v16, v163
    v_mfma_f32_16x16x32_bf16 v[152:155], v[96:99], v[136:139], v[152:155]
    ds_read_b128 v[88:91], v3 offset:11264
    v_cvt_pk_bf16_f32 v201, v162, v163
    s_waitcnt lgkmcnt(3)
    v_mfma_f32_16x16x32_bf16 v[20:23], v[100:103], v[188:191], v[20:23]
    v_exp_f32 v164, v164
    v_exp_f32 v165, v165
    v_mfma_f32_16x16x32_bf16 v[24:27], v[100:103], v[192:195], v[24:27]
    ds_read_b128 v[92:95], v3 offset:12288
    v_add_f32 v15, v15, v164
    s_add_u32 s25, s24, 10240
    buffer_load_dwordx4 v[224:227], v19, s[64:67], s25 offen
    s_waitcnt lgkmcnt(3)
    v_mfma_f32_16x16x32_bf16 v[28:31], v[104:107], v[188:191], v[28:31]
    v_add_f32 v15, v15, v165
    v_mfma_f32_16x16x32_bf16 v[32:35], v[104:107], v[192:195], v[32:35]
    ds_read_b128 v[96:99], v3 offset:13312
    v_cvt_pk_bf16_f32 v198, v164, v165
    s_waitcnt lgkmcnt(3)
    v_mfma_f32_16x16x32_bf16 v[36:39], v[84:87], v[188:191], v[36:39]
    v_exp_f32 v166, v166
    v_exp_f32 v167, v167
    v_mfma_f32_16x16x32_bf16 v[40:43], v[84:87], v[192:195], v[40:43]
    ds_read_b128 v[100:103], v3 offset:14336
    v_add_f32 v15, v15, v166
    s_waitcnt lgkmcnt(3)
    v_mfma_f32_16x16x32_bf16 v[44:47], v[88:91], v[188:191], v[44:47]
    v_add_f32 v15, v15, v167
    v_mfma_f32_16x16x32_bf16 v[48:51], v[88:91], v[192:195], v[48:51]
    ds_read_b128 v[104:107], v3 offset:15360
    v_cvt_pk_bf16_f32 v199, v166, v167
    s_waitcnt lgkmcnt(3)
    v_mfma_f32_16x16x32_bf16 v[52:55], v[92:95], v[188:191], v[52:55]
    v_exp_f32 v168, v168
    v_exp_f32 v169, v169
    v_mfma_f32_16x16x32_bf16 v[56:59], v[92:95], v[192:195], v[56:59]
    s_waitcnt vmcnt(8)
    s_barrier
    ds_read_b128 v[84:87], v2 offset:16384
    v_add_f32 v16, v16, v168
    s_waitcnt lgkmcnt(3)
    v_mfma_f32_16x16x32_bf16 v[60:63], v[96:99], v[188:191], v[60:63]
    v_add_f32 v16, v16, v169
    v_mfma_f32_16x16x32_bf16 v[64:67], v[96:99], v[192:195], v[64:67]
    s_add_u32 s22, s17, 0x24000
    s_add_u32 m0, s17, 0x1c000
    s_nop 0
    buffer_load_dwordx4 v5, s[8:11], s22 offen sc1 lds
    ds_read_b128 v[88:91], v2 offset:17408
    v_cvt_pk_bf16_f32 v202, v168, v169
    s_waitcnt lgkmcnt(3)
    v_mfma_f32_16x16x32_bf16 v[68:71], v[100:103], v[188:191], v[68:71]
    v_exp_f32 v170, v170
    v_exp_f32 v171, v171
    v_mfma_f32_16x16x32_bf16 v[72:75], v[100:103], v[192:195], v[72:75]
    ds_read_b128 v[92:95], v2 offset:18432
    v_add_f32 v16, v16, v170
    s_add_u32 s25, s24, 12288
    buffer_load_dwordx4 v[228:231], v19, s[64:67], s25 offen
    s_waitcnt lgkmcnt(3)
    v_mfma_f32_16x16x32_bf16 v[76:79], v[104:107], v[188:191], v[76:79]
    v_add_f32 v16, v16, v171
    v_mfma_f32_16x16x32_bf16 v[80:83], v[104:107], v[192:195], v[80:83]
    s_add_u32 s22, s17, 0x24400
    s_add_u32 m0, s17, 0x1c400
    s_nop 0
    buffer_load_dwordx4 v5, s[8:11], s22 offen sc1 lds
    ds_read_b128 v[96:99], v2 offset:19456
    v_cvt_pk_bf16_f32 v203, v170, v171
    s_waitcnt lgkmcnt(3)
    v_mfma_f32_16x16x32_bf16 v[156:159], v[84:87], v[108:111], v[172:175]
    v_exp_f32 v140, v140
    v_exp_f32 v141, v141
    v_mfma_f32_16x16x32_bf16 v[160:163], v[84:87], v[124:127], v[176:179]
    ds_read_b128 v[100:103], v2 offset:20480
    v_add_f32 v15, v15, v140
    s_waitcnt lgkmcnt(3)
    v_mfma_f32_16x16x32_bf16 v[164:167], v[88:91], v[108:111], v[172:175]
    v_add_f32 v15, v15, v141
    v_mfma_f32_16x16x32_bf16 v[168:171], v[88:91], v[124:127], v[176:179]
    s_add_u32 s22, s17, 0x24800
    s_add_u32 m0, s17, 0x1c800
    s_nop 0
    buffer_load_dwordx4 v5, s[8:11], s22 offen sc1 lds
    ds_read_b128 v[104:107], v2 offset:21504
    v_cvt_pk_bf16_f32 v188, v140, v141
    s_waitcnt lgkmcnt(3)
    v_mfma_f32_16x16x32_bf16 v[156:159], v[92:95], v[112:115], v[156:159]
    v_exp_f32 v142, v142
    v_exp_f32 v143, v143
    v_mfma_f32_16x16x32_bf16 v[160:163], v[92:95], v[128:131], v[160:163]
    ds_read_b128 v[84:87], v2 offset:22528
    v_add_f32 v15, v15, v142
    s_waitcnt lgkmcnt(3)
    v_mfma_f32_16x16x32_bf16 v[164:167], v[96:99], v[112:115], v[164:167]
    v_add_f32 v15, v15, v143
    v_mfma_f32_16x16x32_bf16 v[168:171], v[96:99], v[128:131], v[168:171]
    s_add_u32 s22, s17, 0x24c00
    s_add_u32 m0, s17, 0x1cc00
    s_nop 0
    buffer_load_dwordx4 v5, s[8:11], s22 offen sc1 lds
    ds_read_b128 v[88:91], v2 offset:23552
    v_cvt_pk_bf16_f32 v189, v142, v143
    s_waitcnt lgkmcnt(3)
    v_mfma_f32_16x16x32_bf16 v[156:159], v[100:103], v[116:119], v[156:159]
    v_exp_f32 v144, v144
    v_exp_f32 v145, v145
    v_mfma_f32_16x16x32_bf16 v[160:163], v[100:103], v[132:135], v[160:163]
    ds_read_b128 v[92:95], v3 offset:24576
    v_add_f32 v16, v16, v144
    s_waitcnt lgkmcnt(3)
    v_mfma_f32_16x16x32_bf16 v[164:167], v[104:107], v[116:119], v[164:167]
    v_add_f32 v16, v16, v145
    v_mfma_f32_16x16x32_bf16 v[168:171], v[104:107], v[132:135], v[168:171]
    ds_read_b128 v[96:99], v3 offset:25600
    v_cvt_pk_bf16_f32 v192, v144, v145
    s_waitcnt lgkmcnt(3)
    v_mfma_f32_16x16x32_bf16 v[156:159], v[84:87], v[120:123], v[156:159]
    v_exp_f32 v146, v146
    v_exp_f32 v147, v147
    v_mfma_f32_16x16x32_bf16 v[160:163], v[84:87], v[136:139], v[160:163]
    ds_read_b128 v[100:103], v3 offset:26624
    v_add_f32 v16, v16, v146
    s_waitcnt lgkmcnt(3)
    v_mfma_f32_16x16x32_bf16 v[164:167], v[88:91], v[120:123], v[164:167]
    v_add_f32 v16, v16, v147
    v_mfma_f32_16x16x32_bf16 v[168:171], v[88:91], v[136:139], v[168:171]
    ds_read_b128 v[104:107], v3 offset:27648
    v_cvt_pk_bf16_f32 v193, v146, v147
    s_waitcnt lgkmcnt(3)
    v_mfma_f32_16x16x32_bf16 v[20:23], v[92:95], v[196:199], v[20:23]
    v_exp_f32 v148, v148
    v_exp_f32 v149, v149
    v_mfma_f32_16x16x32_bf16 v[24:27], v[92:95], v[200:203], v[24:27]
    ds_read_b128 v[84:87], v3 offset:28672
    v_add_f32 v15, v15, v148
    s_waitcnt lgkmcnt(3)
    v_mfma_f32_16x16x32_bf16 v[28:31], v[96:99], v[196:199], v[28:31]
    v_add_f32 v15, v15, v149
    v_mfma_f32_16x16x32_bf16 v[32:35], v[96:99], v[200:203], v[32:35]
    ds_read_b128 v[88:91], v3 offset:29696
    v_cvt_pk_bf16_f32 v190, v148, v149
    s_waitcnt lgkmcnt(3)
    v_mfma_f32_16x16x32_bf16 v[36:39], v[100:103], v[196:199], v[36:39]
    v_exp_f32 v150, v150
    v_exp_f32 v151, v151
    v_mfma_f32_16x16x32_bf16 v[40:43], v[100:103], v[200:203], v[40:43]
    ds_read_b128 v[92:95], v3 offset:30720
    v_add_f32 v15, v15, v150
    s_waitcnt lgkmcnt(3)
    v_mfma_f32_16x16x32_bf16 v[44:47], v[104:107], v[196:199], v[44:47]
    v_add_f32 v15, v15, v151
    v_mfma_f32_16x16x32_bf16 v[48:51], v[104:107], v[200:203], v[48:51]
    ds_read_b128 v[96:99], v3 offset:31744
    v_cvt_pk_bf16_f32 v191, v150, v151
    s_waitcnt lgkmcnt(3)
    v_mfma_f32_16x16x32_bf16 v[52:55], v[84:87], v[196:199], v[52:55]
    v_exp_f32 v152, v152
    v_exp_f32 v153, v153
    v_mfma_f32_16x16x32_bf16 v[56:59], v[84:87], v[200:203], v[56:59]
    s_waitcnt vmcnt(6)
    s_barrier
    ds_read_b128 v[100:103], v2 offset:32768
    v_add_f32 v16, v16, v152
    s_waitcnt lgkmcnt(3)
    v_mfma_f32_16x16x32_bf16 v[60:63], v[88:91], v[196:199], v[60:63]
    v_add_f32 v16, v16, v153
    v_mfma_f32_16x16x32_bf16 v[64:67], v[88:91], v[200:203], v[64:67]
    s_add_u32 s22, s17, 0x28000
    s_add_u32 m0, s17, 0x20000
    s_nop 0
    buffer_load_dwordx4 v5, s[8:11], s22 offen sc1 lds
    ds_read_b128 v[104:107], v2 offset:33792
    v_cvt_pk_bf16_f32 v194, v152, v153
    s_waitcnt lgkmcnt(3)
    v_mfma_f32_16x16x32_bf16 v[68:71], v[92:95], v[196:199], v[68:71]
    v_exp_f32 v154, v154
    v_exp_f32 v155, v155
    v_mfma_f32_16x16x32_bf16 v[72:75], v[92:95], v[200:203], v[72:75]
    ds_read_b128 v[84:87], v2 offset:34816
    v_add_f32 v16, v16, v154
    s_waitcnt lgkmcnt(3)
    v_mfma_f32_16x16x32_bf16 v[76:79], v[96:99], v[196:199], v[76:79]
    v_add_f32 v16, v16, v155
    v_mfma_f32_16x16x32_bf16 v[80:83], v[96:99], v[200:203], v[80:83]
    s_add_u32 s22, s17, 0x28400
    s_add_u32 m0, s17, 0x20400
    s_nop 0
    buffer_load_dwordx4 v5, s[8:11], s22 offen sc1 lds
    ds_read_b128 v[88:91], v2 offset:35840
    v_cvt_pk_bf16_f32 v195, v154, v155
    s_waitcnt lgkmcnt(3)
    v_mfma_f32_16x16x32_bf16 v[140:143], v[100:103], v[108:111], v[172:175]
    v_exp_f32 v156, v156
    v_exp_f32 v157, v157
    v_mfma_f32_16x16x32_bf16 v[144:147], v[100:103], v[124:127], v[176:179]
    ds_read_b128 v[92:95], v2 offset:36864
    v_add_f32 v15, v15, v156
    s_waitcnt lgkmcnt(3)
    v_mfma_f32_16x16x32_bf16 v[148:151], v[104:107], v[108:111], v[172:175]
    v_add_f32 v15, v15, v157
    v_mfma_f32_16x16x32_bf16 v[152:155], v[104:107], v[124:127], v[176:179]
    s_add_u32 s22, s17, 0x28800
    s_add_u32 m0, s17, 0x20800
    s_nop 0
    buffer_load_dwordx4 v5, s[8:11], s22 offen sc1 lds
    ds_read_b128 v[96:99], v2 offset:37888
    v_cvt_pk_bf16_f32 v196, v156, v157
    s_waitcnt lgkmcnt(3)
    v_mfma_f32_16x16x32_bf16 v[140:143], v[84:87], v[112:115], v[140:143]
    v_exp_f32 v158, v158
    v_exp_f32 v159, v159
    v_mfma_f32_16x16x32_bf16 v[144:147], v[84:87], v[128:131], v[144:147]
    ds_read_b128 v[100:103], v2 offset:38912
    v_add_f32 v15, v15, v158
    s_waitcnt lgkmcnt(3)
    v_mfma_f32_16x16x32_bf16 v[148:151], v[88:91], v[112:115], v[148:151]
    v_add_f32 v15, v15, v159
    v_mfma_f32_16x16x32_bf16 v[152:155], v[88:91], v[128:131], v[152:155]
    s_add_u32 s22, s17, 0x28c00
    s_add_u32 m0, s17, 0x20c00
    s_nop 0
    buffer_load_dwordx4 v5, s[8:11], s22 offen sc1 lds
    ds_read_b128 v[104:107], v2 offset:39936
    v_cvt_pk_bf16_f32 v197, v158, v159
    s_waitcnt lgkmcnt(3)
    v_mfma_f32_16x16x32_bf16 v[140:143], v[92:95], v[116:119], v[140:143]
    v_exp_f32 v160, v160
    v_exp_f32 v161, v161
    v_mfma_f32_16x16x32_bf16 v[144:147], v[92:95], v[132:135], v[144:147]
    ds_read_b128 v[84:87], v2 offset:8192
    v_add_f32 v16, v16, v160
    s_waitcnt lgkmcnt(3)
    v_mfma_f32_16x16x32_bf16 v[148:151], v[96:99], v[116:119], v[148:151]
    v_add_f32 v16, v16, v161
    v_mfma_f32_16x16x32_bf16 v[152:155], v[96:99], v[132:135], v[152:155]
    ds_read_b128 v[88:91], v2 offset:9216
    v_cvt_pk_bf16_f32 v200, v160, v161
    s_waitcnt lgkmcnt(3)
    v_mfma_f32_16x16x32_bf16 v[140:143], v[100:103], v[120:123], v[140:143]
    v_exp_f32 v162, v162
    v_exp_f32 v163, v163
    v_mfma_f32_16x16x32_bf16 v[144:147], v[100:103], v[136:139], v[144:147]
    ds_read_b128 v[92:95], v2 offset:10240
    v_add_f32 v16, v16, v162
    s_waitcnt lgkmcnt(3)
    v_mfma_f32_16x16x32_bf16 v[148:151], v[104:107], v[120:123], v[148:151]
    v_add_f32 v16, v16, v163
    v_mfma_f32_16x16x32_bf16 v[152:155], v[104:107], v[136:139], v[152:155]
    ds_read_b128 v[96:99], v2 offset:11264
    v_cvt_pk_bf16_f32 v201, v162, v163
    s_waitcnt lgkmcnt(3)
    v_mfma_f32_16x16x32_bf16 v[20:23], v[84:87], v[188:191], v[20:23]
    v_exp_f32 v164, v164
    v_exp_f32 v165, v165
    v_mfma_f32_16x16x32_bf16 v[24:27], v[84:87], v[192:195], v[24:27]
    ds_read_b128 v[100:103], v2 offset:12288
    v_add_f32 v15, v15, v164
    s_waitcnt lgkmcnt(3)
    v_mfma_f32_16x16x32_bf16 v[28:31], v[88:91], v[188:191], v[28:31]
    v_add_f32 v15, v15, v165
    v_mfma_f32_16x16x32_bf16 v[32:35], v[88:91], v[192:195], v[32:35]
    ds_read_b128 v[104:107], v2 offset:13312
    v_cvt_pk_bf16_f32 v198, v164, v165
    s_waitcnt lgkmcnt(3)
    v_mfma_f32_16x16x32_bf16 v[36:39], v[92:95], v[188:191], v[36:39]
    v_exp_f32 v166, v166
    v_exp_f32 v167, v167
    v_mfma_f32_16x16x32_bf16 v[40:43], v[92:95], v[192:195], v[40:43]
    ds_read_b128 v[84:87], v2 offset:14336
    v_add_f32 v15, v15, v166
    s_waitcnt lgkmcnt(3)
    v_mfma_f32_16x16x32_bf16 v[44:47], v[96:99], v[188:191], v[44:47]
    v_add_f32 v15, v15, v167
    v_mfma_f32_16x16x32_bf16 v[48:51], v[96:99], v[192:195], v[48:51]
    ds_read_b128 v[88:91], v2 offset:15360
    v_cvt_pk_bf16_f32 v199, v166, v167
    s_waitcnt lgkmcnt(3)
    v_mfma_f32_16x16x32_bf16 v[52:55], v[100:103], v[188:191], v[52:55]
    v_exp_f32 v168, v168
    v_exp_f32 v169, v169
    v_mfma_f32_16x16x32_bf16 v[56:59], v[100:103], v[192:195], v[56:59]
    s_waitcnt vmcnt(4)
    s_barrier
    ds_read_b128 v[92:95], v2 offset:49152
    v_add_f32 v16, v16, v168
    s_waitcnt lgkmcnt(3)
    v_mfma_f32_16x16x32_bf16 v[60:63], v[104:107], v[188:191], v[60:63]
    v_add_f32 v16, v16, v169
    v_mfma_f32_16x16x32_bf16 v[64:67], v[104:107], v[192:195], v[64:67]
    s_add_u32 s22, s17, 0x2c000
    s_add_u32 m0, s17, 0x24000
    s_nop 0
    buffer_load_dwordx4 v5, s[8:11], s22 offen sc1 lds
    ds_read_b128 v[96:99], v2 offset:50176
    v_cvt_pk_bf16_f32 v202, v168, v169
    s_waitcnt lgkmcnt(3)
    v_mfma_f32_16x16x32_bf16 v[68:71], v[84:87], v[188:191], v[68:71]
    v_exp_f32 v170, v170
    v_exp_f32 v171, v171
    v_mfma_f32_16x16x32_bf16 v[72:75], v[84:87], v[192:195], v[72:75]
    ds_read_b128 v[100:103], v2 offset:51200
    v_add_f32 v16, v16, v170
    s_waitcnt lgkmcnt(3)
    v_mfma_f32_16x16x32_bf16 v[76:79], v[88:91], v[188:191], v[76:79]
    v_add_f32 v16, v16, v171
    v_mfma_f32_16x16x32_bf16 v[80:83], v[88:91], v[192:195], v[80:83]
    s_add_u32 s22, s17, 0x2c400
    s_add_u32 m0, s17, 0x24400
    s_nop 0
    buffer_load_dwordx4 v5, s[8:11], s22 offen sc1 lds
    ds_read_b128 v[104:107], v2 offset:52224
    v_cvt_pk_bf16_f32 v203, v170, v171
    s_waitcnt lgkmcnt(3)
    v_mfma_f32_16x16x32_bf16 v[156:159], v[92:95], v[108:111], v[172:175]
    v_exp_f32 v140, v140
    v_exp_f32 v141, v141
    v_mfma_f32_16x16x32_bf16 v[160:163], v[92:95], v[124:127], v[176:179]
    ds_read_b128 v[84:87], v2 offset:53248
    v_add_f32 v15, v15, v140
    s_waitcnt lgkmcnt(3)
    v_mfma_f32_16x16x32_bf16 v[164:167], v[96:99], v[108:111], v[172:175]
    v_add_f32 v15, v15, v141
    v_mfma_f32_16x16x32_bf16 v[168:171], v[96:99], v[124:127], v[176:179]
    s_add_u32 s22, s17, 0x2c800
    s_add_u32 m0, s17, 0x24800
    s_nop 0
    buffer_load_dwordx4 v5, s[8:11], s22 offen sc1 lds
    ds_read_b128 v[88:91], v2 offset:54272
    v_cvt_pk_bf16_f32 v188, v140, v141
    s_waitcnt lgkmcnt(3)
    v_mfma_f32_16x16x32_bf16 v[156:159], v[100:103], v[112:115], v[156:159]
    v_exp_f32 v142, v142
    v_exp_f32 v143, v143
    v_mfma_f32_16x16x32_bf16 v[160:163], v[100:103], v[128:131], v[160:163]
    ds_read_b128 v[92:95], v2 offset:55296
    v_add_f32 v15, v15, v142
    s_waitcnt lgkmcnt(3)
    v_mfma_f32_16x16x32_bf16 v[164:167], v[104:107], v[112:115], v[164:167]
    v_add_f32 v15, v15, v143
    v_mfma_f32_16x16x32_bf16 v[168:171], v[104:107], v[128:131], v[168:171]
    s_add_u32 s22, s17, 0x2cc00
    s_add_u32 m0, s17, 0x24c00
    s_nop 0
    buffer_load_dwordx4 v5, s[8:11], s22 offen sc1 lds
    ds_read_b128 v[96:99], v2 offset:56320
    v_cvt_pk_bf16_f32 v189, v142, v143
    s_waitcnt lgkmcnt(3)
    v_mfma_f32_16x16x32_bf16 v[156:159], v[84:87], v[116:119], v[156:159]
    v_exp_f32 v144, v144
    v_exp_f32 v145, v145
    v_mfma_f32_16x16x32_bf16 v[160:163], v[84:87], v[132:135], v[160:163]
    ds_read_b128 v[100:103], v2 offset:24576
    v_add_f32 v16, v16, v144
    s_waitcnt lgkmcnt(3)
    v_mfma_f32_16x16x32_bf16 v[164:167], v[88:91], v[116:119], v[164:167]
    v_add_f32 v16, v16, v145
    v_mfma_f32_16x16x32_bf16 v[168:171], v[88:91], v[132:135], v[168:171]
    ds_read_b128 v[104:107], v2 offset:25600
    v_cvt_pk_bf16_f32 v192, v144, v145
    s_waitcnt lgkmcnt(3)
    v_mfma_f32_16x16x32_bf16 v[156:159], v[92:95], v[120:123], v[156:159]
    v_exp_f32 v146, v146
    v_exp_f32 v147, v147
    v_mfma_f32_16x16x32_bf16 v[160:163], v[92:95], v[136:139], v[160:163]
    ds_read_b128 v[84:87], v2 offset:26624
    v_add_f32 v16, v16, v146
    s_waitcnt lgkmcnt(3)
    v_mfma_f32_16x16x32_bf16 v[164:167], v[96:99], v[120:123], v[164:167]
    v_add_f32 v16, v16, v147
    v_mfma_f32_16x16x32_bf16 v[168:171], v[96:99], v[136:139], v[168:171]
    ds_read_b128 v[88:91], v2 offset:27648
    v_cvt_pk_bf16_f32 v193, v146, v147
    s_waitcnt lgkmcnt(3)
    v_mfma_f32_16x16x32_bf16 v[20:23], v[100:103], v[196:199], v[20:23]
    v_exp_f32 v148, v148
    v_exp_f32 v149, v149
    v_mfma_f32_16x16x32_bf16 v[24:27], v[100:103], v[200:203], v[24:27]
    ds_read_b128 v[92:95], v2 offset:28672
    v_add_f32 v15, v15, v148
    s_waitcnt lgkmcnt(3)
    v_mfma_f32_16x16x32_bf16 v[28:31], v[104:107], v[196:199], v[28:31]
    v_add_f32 v15, v15, v149
    v_mfma_f32_16x16x32_bf16 v[32:35], v[104:107], v[200:203], v[32:35]
    ds_read_b128 v[96:99], v2 offset:29696
    v_cvt_pk_bf16_f32 v190, v148, v149
    s_waitcnt lgkmcnt(3)
    v_mfma_f32_16x16x32_bf16 v[36:39], v[84:87], v[196:199], v[36:39]
    v_exp_f32 v150, v150
    v_exp_f32 v151, v151
    v_mfma_f32_16x16x32_bf16 v[40:43], v[84:87], v[200:203], v[40:43]
    ds_read_b128 v[100:103], v2 offset:30720
    v_add_f32 v15, v15, v150
    s_waitcnt lgkmcnt(3)
    v_mfma_f32_16x16x32_bf16 v[44:47], v[88:91], v[196:199], v[44:47]
    v_add_f32 v15, v15, v151
    v_mfma_f32_16x16x32_bf16 v[48:51], v[88:91], v[200:203], v[48:51]
    ds_read_b128 v[104:107], v2 offset:31744
    v_cvt_pk_bf16_f32 v191, v150, v151
    s_waitcnt lgkmcnt(3)
    v_mfma_f32_16x16x32_bf16 v[52:55], v[92:95], v[196:199], v[52:55]
    v_exp_f32 v152, v152
    v_exp_f32 v153, v153
    v_mfma_f32_16x16x32_bf16 v[56:59], v[92:95], v[200:203], v[56:59]
    s_waitcnt vmcnt(4)
    s_barrier
    ds_read_b128 v[84:87], v3 offset:0
    v_add_f32 v16, v16, v152
    s_waitcnt lgkmcnt(3)
    v_mfma_f32_16x16x32_bf16 v[60:63], v[96:99], v[196:199], v[60:63]
    v_add_f32 v16, v16, v153
    v_mfma_f32_16x16x32_bf16 v[64:67], v[96:99], v[200:203], v[64:67]
    s_add_u32 s22, s17, 0x30000
    s_add_u32 m0, s17, 0x10000
    s_nop 0
    buffer_load_dwordx4 v5, s[8:11], s22 offen sc1 lds
    ds_read_b128 v[88:91], v3 offset:1024
    v_cvt_pk_bf16_f32 v194, v152, v153
    s_waitcnt lgkmcnt(3)
    v_mfma_f32_16x16x32_bf16 v[68:71], v[100:103], v[196:199], v[68:71]
    v_exp_f32 v154, v154
    v_exp_f32 v155, v155
    v_mfma_f32_16x16x32_bf16 v[72:75], v[100:103], v[200:203], v[72:75]
    ds_read_b128 v[92:95], v3 offset:2048
    v_add_f32 v16, v16, v154
    s_waitcnt lgkmcnt(3)
    v_mfma_f32_16x16x32_bf16 v[76:79], v[104:107], v[196:199], v[76:79]
    v_add_f32 v16, v16, v155
    v_mfma_f32_16x16x32_bf16 v[80:83], v[104:107], v[200:203], v[80:83]
    s_add_u32 s22, s17, 0x30400
    s_add_u32 m0, s17, 0x10400
    s_nop 0
    buffer_load_dwordx4 v5, s[8:11], s22 offen sc1 lds
    ds_read_b128 v[96:99], v3 offset:3072
    v_cvt_pk_bf16_f32 v195, v154, v155
    s_waitcnt lgkmcnt(3)
    v_mfma_f32_16x16x32_bf16 v[140:143], v[84:87], v[108:111], v[172:175]
    v_exp_f32 v156, v156
    v_exp_f32 v157, v157
    v_mfma_f32_16x16x32_bf16 v[144:147], v[84:87], v[124:127], v[176:179]
    ds_read_b128 v[100:103], v3 offset:4096
    v_add_f32 v15, v15, v156
    s_waitcnt lgkmcnt(3)
    v_mfma_f32_16x16x32_bf16 v[148:151], v[88:91], v[108:111], v[172:175]
    v_add_f32 v15, v15, v157
    v_mfma_f32_16x16x32_bf16 v[152:155], v[88:91], v[124:127], v[176:179]
    s_add_u32 s22, s17, 0x30800
    s_add_u32 m0, s17, 0x10800
    s_nop 0
    buffer_load_dwordx4 v5, s[8:11], s22 offen sc1 lds
    ds_read_b128 v[104:107], v3 offset:5120
    v_cvt_pk_bf16_f32 v196, v156, v157
    s_waitcnt lgkmcnt(3)
    v_mfma_f32_16x16x32_bf16 v[140:143], v[92:95], v[112:115], v[140:143]
    v_exp_f32 v158, v158
    v_exp_f32 v159, v159
    v_mfma_f32_16x16x32_bf16 v[144:147], v[92:95], v[128:131], v[144:147]
    ds_read_b128 v[84:87], v3 offset:6144
    v_add_f32 v15, v15, v158
    s_waitcnt lgkmcnt(3)
    v_mfma_f32_16x16x32_bf16 v[148:151], v[96:99], v[112:115], v[148:151]
    v_add_f32 v15, v15, v159
    v_mfma_f32_16x16x32_bf16 v[152:155], v[96:99], v[128:131], v[152:155]
    s_add_u32 s22, s17, 0x30c00
    s_add_u32 m0, s17, 0x10c00
    s_nop 0
    buffer_load_dwordx4 v5, s[8:11], s22 offen sc1 lds
    ds_read_b128 v[88:91], v3 offset:7168
    v_cvt_pk_bf16_f32 v197, v158, v159
    s_waitcnt lgkmcnt(3)
    v_mfma_f32_16x16x32_bf16 v[140:143], v[100:103], v[116:119], v[140:143]
    v_exp_f32 v160, v160
    v_exp_f32 v161, v161
    v_mfma_f32_16x16x32_bf16 v[144:147], v[100:103], v[132:135], v[144:147]
    ds_read_b128 v[92:95], v2 offset:40960
    v_add_f32 v16, v16, v160
    s_waitcnt lgkmcnt(3)
    v_mfma_f32_16x16x32_bf16 v[148:151], v[104:107], v[116:119], v[148:151]
    v_add_f32 v16, v16, v161
    v_mfma_f32_16x16x32_bf16 v[152:155], v[104:107], v[132:135], v[152:155]
    ds_read_b128 v[96:99], v2 offset:41984
    v_cvt_pk_bf16_f32 v200, v160, v161
    s_waitcnt lgkmcnt(3)
    v_mfma_f32_16x16x32_bf16 v[140:143], v[84:87], v[120:123], v[140:143]
    v_exp_f32 v162, v162
    v_exp_f32 v163, v163
    v_mfma_f32_16x16x32_bf16 v[144:147], v[84:87], v[136:139], v[144:147]
    ds_read_b128 v[100:103], v2 offset:43008
    v_add_f32 v16, v16, v162
    s_waitcnt lgkmcnt(3)
    v_mfma_f32_16x16x32_bf16 v[148:151], v[88:91], v[120:123], v[148:151]
    v_add_f32 v16, v16, v163
    v_mfma_f32_16x16x32_bf16 v[152:155], v[88:91], v[136:139], v[152:155]
    ds_read_b128 v[104:107], v2 offset:44032
    v_cvt_pk_bf16_f32 v201, v162, v163
    s_waitcnt lgkmcnt(3)
    v_mfma_f32_16x16x32_bf16 v[20:23], v[92:95], v[188:191], v[20:23]
    v_exp_f32 v164, v164
    v_exp_f32 v165, v165
    v_mfma_f32_16x16x32_bf16 v[24:27], v[92:95], v[192:195], v[24:27]
    ds_read_b128 v[84:87], v2 offset:45056
    v_add_f32 v15, v15, v164
    s_waitcnt lgkmcnt(3)
    v_mfma_f32_16x16x32_bf16 v[28:31], v[96:99], v[188:191], v[28:31]
    v_add_f32 v15, v15, v165
    v_mfma_f32_16x16x32_bf16 v[32:35], v[96:99], v[192:195], v[32:35]
    ds_read_b128 v[88:91], v2 offset:46080
    v_cvt_pk_bf16_f32 v198, v164, v165
    s_waitcnt lgkmcnt(3)
    v_mfma_f32_16x16x32_bf16 v[36:39], v[100:103], v[188:191], v[36:39]
    v_exp_f32 v166, v166
    v_exp_f32 v167, v167
    v_mfma_f32_16x16x32_bf16 v[40:43], v[100:103], v[192:195], v[40:43]
    ds_read_b128 v[92:95], v2 offset:47104
    v_add_f32 v15, v15, v166
    s_waitcnt lgkmcnt(3)
    v_mfma_f32_16x16x32_bf16 v[44:47], v[104:107], v[188:191], v[44:47]
    v_add_f32 v15, v15, v167
    v_mfma_f32_16x16x32_bf16 v[48:51], v[104:107], v[192:195], v[48:51]
    ds_read_b128 v[96:99], v2 offset:48128
    v_cvt_pk_bf16_f32 v199, v166, v167
    s_waitcnt lgkmcnt(3)
    v_mfma_f32_16x16x32_bf16 v[52:55], v[84:87], v[188:191], v[52:55]
    v_exp_f32 v168, v168
    v_exp_f32 v169, v169
    v_mfma_f32_16x16x32_bf16 v[56:59], v[84:87], v[192:195], v[56:59]
    s_waitcnt vmcnt(4)
    s_barrier
    ds_read_b128 v[100:103], v3 offset:16384
    v_add_f32 v16, v16, v168
    s_waitcnt lgkmcnt(3)
    v_mfma_f32_16x16x32_bf16 v[60:63], v[88:91], v[188:191], v[60:63]
    v_add_f32 v16, v16, v169
    v_mfma_f32_16x16x32_bf16 v[64:67], v[88:91], v[192:195], v[64:67]
    s_add_u32 s22, s17, 0x34000
    s_add_u32 m0, s17, 0x14000
    s_nop 0
    buffer_load_dwordx4 v5, s[8:11], s22 offen sc1 lds
    ds_read_b128 v[104:107], v3 offset:17408
    v_cvt_pk_bf16_f32 v202, v168, v169
    s_waitcnt lgkmcnt(3)
    v_mfma_f32_16x16x32_bf16 v[68:71], v[92:95], v[188:191], v[68:71]
    v_exp_f32 v170, v170
    v_exp_f32 v171, v171
    v_mfma_f32_16x16x32_bf16 v[72:75], v[92:95], v[192:195], v[72:75]
    ds_read_b128 v[84:87], v3 offset:18432
    v_add_f32 v16, v16, v170
    s_waitcnt lgkmcnt(3)
    v_mfma_f32_16x16x32_bf16 v[76:79], v[96:99], v[188:191], v[76:79]
    v_add_f32 v16, v16, v171
    v_mfma_f32_16x16x32_bf16 v[80:83], v[96:99], v[192:195], v[80:83]
    s_add_u32 s22, s17, 0x34400
    s_add_u32 m0, s17, 0x14400
    s_nop 0
    buffer_load_dwordx4 v5, s[8:11], s22 offen sc1 lds
    ds_read_b128 v[88:91], v3 offset:19456
    v_cvt_pk_bf16_f32 v203, v170, v171
    s_waitcnt lgkmcnt(3)
    v_mfma_f32_16x16x32_bf16 v[156:159], v[100:103], v[108:111], v[172:175]
    v_exp_f32 v140, v140
    v_exp_f32 v141, v141
    v_mfma_f32_16x16x32_bf16 v[160:163], v[100:103], v[124:127], v[176:179]
    ds_read_b128 v[92:95], v3 offset:20480
    v_add_f32 v15, v15, v140
    s_waitcnt lgkmcnt(3)
    v_mfma_f32_16x16x32_bf16 v[164:167], v[104:107], v[108:111], v[172:175]
    v_add_f32 v15, v15, v141
    v_mfma_f32_16x16x32_bf16 v[168:171], v[104:107], v[124:127], v[176:179]
    s_add_u32 s22, s17, 0x34800
    s_add_u32 m0, s17, 0x14800
    s_nop 0
    buffer_load_dwordx4 v5, s[8:11], s22 offen sc1 lds
    ds_read_b128 v[96:99], v3 offset:21504
    v_cvt_pk_bf16_f32 v188, v140, v141
    s_waitcnt lgkmcnt(3)
    v_mfma_f32_16x16x32_bf16 v[156:159], v[84:87], v[112:115], v[156:159]
    v_exp_f32 v142, v142
    v_exp_f32 v143, v143
    v_mfma_f32_16x16x32_bf16 v[160:163], v[84:87], v[128:131], v[160:163]
    ds_read_b128 v[100:103], v3 offset:22528
    v_add_f32 v15, v15, v142
    s_waitcnt lgkmcnt(3)
    v_mfma_f32_16x16x32_bf16 v[164:167], v[88:91], v[112:115], v[164:167]
    v_add_f32 v15, v15, v143
    v_mfma_f32_16x16x32_bf16 v[168:171], v[88:91], v[128:131], v[168:171]
    s_add_u32 s22, s17, 0x34c00
    s_add_u32 m0, s17, 0x14c00
    s_nop 0
    buffer_load_dwordx4 v5, s[8:11], s22 offen sc1 lds
    ds_read_b128 v[104:107], v3 offset:23552
    v_cvt_pk_bf16_f32 v189, v142, v143
    s_waitcnt lgkmcnt(3)
    v_mfma_f32_16x16x32_bf16 v[156:159], v[92:95], v[116:119], v[156:159]
    v_exp_f32 v144, v144
    v_exp_f32 v145, v145
    v_mfma_f32_16x16x32_bf16 v[160:163], v[92:95], v[132:135], v[160:163]
    ds_read_b128 v[84:87], v2 offset:57344
    v_add_f32 v16, v16, v144
    s_waitcnt lgkmcnt(3)
    v_mfma_f32_16x16x32_bf16 v[164:167], v[96:99], v[116:119], v[164:167]
    v_add_f32 v16, v16, v145
    v_mfma_f32_16x16x32_bf16 v[168:171], v[96:99], v[132:135], v[168:171]
    ds_read_b128 v[88:91], v2 offset:58368
    v_cvt_pk_bf16_f32 v192, v144, v145
    s_waitcnt lgkmcnt(3)
    v_mfma_f32_16x16x32_bf16 v[156:159], v[100:103], v[120:123], v[156:159]
    v_exp_f32 v146, v146
    v_exp_f32 v147, v147
    v_mfma_f32_16x16x32_bf16 v[160:163], v[100:103], v[136:139], v[160:163]
    ds_read_b128 v[92:95], v2 offset:59392
    v_add_f32 v16, v16, v146
    s_waitcnt lgkmcnt(3)
    v_mfma_f32_16x16x32_bf16 v[164:167], v[104:107], v[120:123], v[164:167]
    v_add_f32 v16, v16, v147
    v_mfma_f32_16x16x32_bf16 v[168:171], v[104:107], v[136:139], v[168:171]
    ds_read_b128 v[96:99], v2 offset:60416
    v_cvt_pk_bf16_f32 v193, v146, v147
    s_waitcnt lgkmcnt(3)
    v_mfma_f32_16x16x32_bf16 v[20:23], v[84:87], v[196:199], v[20:23]
    v_exp_f32 v148, v148
    v_exp_f32 v149, v149
    v_mfma_f32_16x16x32_bf16 v[24:27], v[84:87], v[200:203], v[24:27]
    ds_read_b128 v[100:103], v2 offset:61440
    v_add_f32 v15, v15, v148
    s_waitcnt lgkmcnt(3)
    v_mfma_f32_16x16x32_bf16 v[28:31], v[88:91], v[196:199], v[28:31]
    v_add_f32 v15, v15, v149
    v_mfma_f32_16x16x32_bf16 v[32:35], v[88:91], v[200:203], v[32:35]
    ds_read_b128 v[104:107], v2 offset:62464
    v_cvt_pk_bf16_f32 v190, v148, v149
    s_waitcnt lgkmcnt(3)
    v_mfma_f32_16x16x32_bf16 v[36:39], v[92:95], v[196:199], v[36:39]
    v_exp_f32 v150, v150
    v_exp_f32 v151, v151
    v_mfma_f32_16x16x32_bf16 v[40:43], v[92:95], v[200:203], v[40:43]
    ds_read_b128 v[84:87], v2 offset:63488
    v_add_f32 v15, v15, v150
    s_waitcnt lgkmcnt(3)
    v_mfma_f32_16x16x32_bf16 v[44:47], v[96:99], v[196:199], v[44:47]
    v_add_f32 v15, v15, v151
    v_mfma_f32_16x16x32_bf16 v[48:51], v[96:99], v[200:203], v[48:51]
    ds_read_b128 v[88:91], v2 offset:64512
    v_cvt_pk_bf16_f32 v191, v150, v151
    s_waitcnt lgkmcnt(3)
    v_mfma_f32_16x16x32_bf16 v[52:55], v[100:103], v[196:199], v[52:55]
    v_exp_f32 v152, v152
    v_exp_f32 v153, v153
    v_mfma_f32_16x16x32_bf16 v[56:59], v[100:103], v[200:203], v[56:59]
    s_waitcnt vmcnt(4)
    s_barrier
    ds_read_b128 v[92:95], v2 offset:0
    v_add_f32 v16, v16, v152
    s_waitcnt lgkmcnt(3)
    v_mfma_f32_16x16x32_bf16 v[60:63], v[104:107], v[196:199], v[60:63]
    v_add_f32 v16, v16, v153
    v_mfma_f32_16x16x32_bf16 v[64:67], v[104:107], v[200:203], v[64:67]
    s_add_u32 s22, s17, 0x38000
    s_add_u32 m0, s17, 0x18000
    s_nop 0
    buffer_load_dwordx4 v5, s[8:11], s22 offen sc1 lds
    ds_read_b128 v[96:99], v2 offset:1024
    v_cvt_pk_bf16_f32 v194, v152, v153
    s_waitcnt lgkmcnt(3)
    v_mfma_f32_16x16x32_bf16 v[68:71], v[84:87], v[196:199], v[68:71]
    v_exp_f32 v154, v154
    v_exp_f32 v155, v155
    v_mfma_f32_16x16x32_bf16 v[72:75], v[84:87], v[200:203], v[72:75]
    ds_read_b128 v[100:103], v2 offset:2048
    v_add_f32 v16, v16, v154
    s_waitcnt lgkmcnt(3)
    v_mfma_f32_16x16x32_bf16 v[76:79], v[88:91], v[196:199], v[76:79]
    v_add_f32 v16, v16, v155
    v_mfma_f32_16x16x32_bf16 v[80:83], v[88:91], v[200:203], v[80:83]
    s_add_u32 s22, s17, 0x38400
    s_add_u32 m0, s17, 0x18400
    s_nop 0
    buffer_load_dwordx4 v5, s[8:11], s22 offen sc1 lds
    ds_read_b128 v[104:107], v2 offset:3072
    v_cvt_pk_bf16_f32 v195, v154, v155
    s_waitcnt lgkmcnt(3)
    v_mfma_f32_16x16x32_bf16 v[140:143], v[92:95], v[108:111], v[172:175]
    v_exp_f32 v156, v156
    v_exp_f32 v157, v157
    v_mfma_f32_16x16x32_bf16 v[144:147], v[92:95], v[124:127], v[176:179]
    ds_read_b128 v[84:87], v2 offset:4096
    v_add_f32 v15, v15, v156
    s_waitcnt lgkmcnt(3)
    v_mfma_f32_16x16x32_bf16 v[148:151], v[96:99], v[108:111], v[172:175]
    v_add_f32 v15, v15, v157
    v_mfma_f32_16x16x32_bf16 v[152:155], v[96:99], v[124:127], v[176:179]
    s_add_u32 s22, s17, 0x38800
    s_add_u32 m0, s17, 0x18800
    s_nop 0
    buffer_load_dwordx4 v5, s[8:11], s22 offen sc1 lds
    ds_read_b128 v[88:91], v2 offset:5120
    v_cvt_pk_bf16_f32 v196, v156, v157
    s_waitcnt lgkmcnt(3)
    v_mfma_f32_16x16x32_bf16 v[140:143], v[100:103], v[112:115], v[140:143]
    v_exp_f32 v158, v158
    v_exp_f32 v159, v159
    v_mfma_f32_16x16x32_bf16 v[144:147], v[100:103], v[128:131], v[144:147]
    ds_read_b128 v[92:95], v2 offset:6144
    v_add_f32 v15, v15, v158
    s_waitcnt lgkmcnt(3)
    v_mfma_f32_16x16x32_bf16 v[148:151], v[104:107], v[112:115], v[148:151]
    v_add_f32 v15, v15, v159
    v_mfma_f32_16x16x32_bf16 v[152:155], v[104:107], v[128:131], v[152:155]
    s_add_u32 s22, s17, 0x38c00
    s_add_u32 m0, s17, 0x18c00
    s_nop 0
    buffer_load_dwordx4 v5, s[8:11], s22 offen sc1 lds
    ds_read_b128 v[96:99], v2 offset:7168
    v_cvt_pk_bf16_f32 v197, v158, v159
    s_waitcnt lgkmcnt(3)
    v_mfma_f32_16x16x32_bf16 v[140:143], v[84:87], v[116:119], v[140:143]
    v_exp_f32 v160, v160
    v_exp_f32 v161, v161
    v_mfma_f32_16x16x32_bf16 v[144:147], v[84:87], v[132:135], v[144:147]
    ds_read_b128 v[100:103], v3 offset:8192
    v_add_f32 v16, v16, v160
    s_waitcnt lgkmcnt(3)
    v_mfma_f32_16x16x32_bf16 v[148:151], v[88:91], v[116:119], v[148:151]
    v_add_f32 v16, v16, v161
    v_mfma_f32_16x16x32_bf16 v[152:155], v[88:91], v[132:135], v[152:155]
    ds_read_b128 v[104:107], v3 offset:9216
    v_cvt_pk_bf16_f32 v200, v160, v161
    s_waitcnt lgkmcnt(3)
    v_mfma_f32_16x16x32_bf16 v[140:143], v[92:95], v[120:123], v[140:143]
    v_exp_f32 v162, v162
    v_exp_f32 v163, v163
    v_mfma_f32_16x16x32_bf16 v[144:147], v[92:95], v[136:139], v[144:147]
    ds_read_b128 v[84:87], v3 offset:10240
    v_add_f32 v16, v16, v162
    s_waitcnt lgkmcnt(3)
    v_mfma_f32_16x16x32_bf16 v[148:151], v[96:99], v[120:123], v[148:151]
    v_add_f32 v16, v16, v163
    v_mfma_f32_16x16x32_bf16 v[152:155], v[96:99], v[136:139], v[152:155]
    ds_read_b128 v[88:91], v3 offset:11264
    v_cvt_pk_bf16_f32 v201, v162, v163
    s_waitcnt lgkmcnt(3)
    v_mfma_f32_16x16x32_bf16 v[20:23], v[100:103], v[188:191], v[20:23]
    v_exp_f32 v164, v164
    v_exp_f32 v165, v165
    v_mfma_f32_16x16x32_bf16 v[24:27], v[100:103], v[192:195], v[24:27]
    ds_read_b128 v[92:95], v3 offset:12288
    v_add_f32 v15, v15, v164
    s_waitcnt lgkmcnt(3)
    v_mfma_f32_16x16x32_bf16 v[28:31], v[104:107], v[188:191], v[28:31]
    v_add_f32 v15, v15, v165
    v_mfma_f32_16x16x32_bf16 v[32:35], v[104:107], v[192:195], v[32:35]
    ds_read_b128 v[96:99], v3 offset:13312
    v_cvt_pk_bf16_f32 v198, v164, v165
    s_waitcnt lgkmcnt(3)
    v_mfma_f32_16x16x32_bf16 v[36:39], v[84:87], v[188:191], v[36:39]
    v_exp_f32 v166, v166
    v_exp_f32 v167, v167
    v_mfma_f32_16x16x32_bf16 v[40:43], v[84:87], v[192:195], v[40:43]
    ds_read_b128 v[100:103], v3 offset:14336
    v_add_f32 v15, v15, v166
    s_waitcnt lgkmcnt(3)
    v_mfma_f32_16x16x32_bf16 v[44:47], v[88:91], v[188:191], v[44:47]
    v_add_f32 v15, v15, v167
    v_mfma_f32_16x16x32_bf16 v[48:51], v[88:91], v[192:195], v[48:51]
    ds_read_b128 v[104:107], v3 offset:15360
    v_cvt_pk_bf16_f32 v199, v166, v167
    s_waitcnt lgkmcnt(3)
    v_mfma_f32_16x16x32_bf16 v[52:55], v[92:95], v[188:191], v[52:55]
    v_exp_f32 v168, v168
    v_exp_f32 v169, v169
    v_mfma_f32_16x16x32_bf16 v[56:59], v[92:95], v[192:195], v[56:59]
    s_waitcnt vmcnt(4)
    s_barrier
    ds_read_b128 v[84:87], v2 offset:16384
    v_add_f32 v16, v16, v168
    s_waitcnt lgkmcnt(3)
    v_mfma_f32_16x16x32_bf16 v[60:63], v[96:99], v[188:191], v[60:63]
    v_add_f32 v16, v16, v169
    v_mfma_f32_16x16x32_bf16 v[64:67], v[96:99], v[192:195], v[64:67]
    s_add_u32 s22, s17, 0x3c000
    s_add_u32 m0, s17, 0x1c000
    s_nop 0
    buffer_load_dwordx4 v5, s[8:11], s22 offen sc1 lds
    ds_read_b128 v[88:91], v2 offset:17408
    v_cvt_pk_bf16_f32 v202, v168, v169
    s_waitcnt lgkmcnt(3)
    v_mfma_f32_16x16x32_bf16 v[68:71], v[100:103], v[188:191], v[68:71]
    v_exp_f32 v170, v170
    v_exp_f32 v171, v171
    v_mfma_f32_16x16x32_bf16 v[72:75], v[100:103], v[192:195], v[72:75]
    ds_read_b128 v[92:95], v2 offset:18432
    v_add_f32 v16, v16, v170
    s_waitcnt lgkmcnt(3)
    v_mfma_f32_16x16x32_bf16 v[76:79], v[104:107], v[188:191], v[76:79]
    v_add_f32 v16, v16, v171
    v_mfma_f32_16x16x32_bf16 v[80:83], v[104:107], v[192:195], v[80:83]
    s_add_u32 s22, s17, 0x3c400
    s_add_u32 m0, s17, 0x1c400
    s_nop 0
    buffer_load_dwordx4 v5, s[8:11], s22 offen sc1 lds
    ds_read_b128 v[96:99], v2 offset:19456
    v_cvt_pk_bf16_f32 v203, v170, v171
    s_waitcnt lgkmcnt(3)
    v_mfma_f32_16x16x32_bf16 v[156:159], v[84:87], v[108:111], v[172:175]
    v_exp_f32 v140, v140
    v_exp_f32 v141, v141
    v_mfma_f32_16x16x32_bf16 v[160:163], v[84:87], v[124:127], v[176:179]
    ds_read_b128 v[100:103], v2 offset:20480
    v_add_f32 v15, v15, v140
    s_waitcnt lgkmcnt(3)
    v_mfma_f32_16x16x32_bf16 v[164:167], v[88:91], v[108:111], v[172:175]
    v_add_f32 v15, v15, v141
    v_mfma_f32_16x16x32_bf16 v[168:171], v[88:91], v[124:127], v[176:179]
    s_add_u32 s22, s17, 0x3c800
    s_add_u32 m0, s17, 0x1c800
    s_nop 0
    buffer_load_dwordx4 v5, s[8:11], s22 offen sc1 lds
    ds_read_b128 v[104:107], v2 offset:21504
    v_cvt_pk_bf16_f32 v188, v140, v141
    s_waitcnt lgkmcnt(3)
    v_mfma_f32_16x16x32_bf16 v[156:159], v[92:95], v[112:115], v[156:159]
    v_exp_f32 v142, v142
    v_exp_f32 v143, v143
    v_mfma_f32_16x16x32_bf16 v[160:163], v[92:95], v[128:131], v[160:163]
    ds_read_b128 v[84:87], v2 offset:22528
    v_add_f32 v15, v15, v142
    s_waitcnt lgkmcnt(3)
    v_mfma_f32_16x16x32_bf16 v[164:167], v[96:99], v[112:115], v[164:167]
    v_add_f32 v15, v15, v143
    v_mfma_f32_16x16x32_bf16 v[168:171], v[96:99], v[128:131], v[168:171]
    s_add_u32 s22, s17, 0x3cc00
    s_add_u32 m0, s17, 0x1cc00
    s_nop 0
    buffer_load_dwordx4 v5, s[8:11], s22 offen sc1 lds
    ds_read_b128 v[88:91], v2 offset:23552
    v_cvt_pk_bf16_f32 v189, v142, v143
    s_waitcnt lgkmcnt(3)
    v_mfma_f32_16x16x32_bf16 v[156:159], v[100:103], v[116:119], v[156:159]
    v_exp_f32 v144, v144
    v_exp_f32 v145, v145
    v_mfma_f32_16x16x32_bf16 v[160:163], v[100:103], v[132:135], v[160:163]
    ds_read_b128 v[92:95], v3 offset:24576
    v_add_f32 v16, v16, v144
    s_waitcnt lgkmcnt(3)
    v_mfma_f32_16x16x32_bf16 v[164:167], v[104:107], v[116:119], v[164:167]
    v_add_f32 v16, v16, v145
    v_mfma_f32_16x16x32_bf16 v[168:171], v[104:107], v[132:135], v[168:171]
    ds_read_b128 v[96:99], v3 offset:25600
    v_cvt_pk_bf16_f32 v192, v144, v145
    s_waitcnt lgkmcnt(3)
    v_mfma_f32_16x16x32_bf16 v[156:159], v[84:87], v[120:123], v[156:159]
    v_exp_f32 v146, v146
    v_exp_f32 v147, v147
    v_mfma_f32_16x16x32_bf16 v[160:163], v[84:87], v[136:139], v[160:163]
    ds_read_b128 v[100:103], v3 offset:26624
    v_add_f32 v16, v16, v146
    s_waitcnt lgkmcnt(3)
    v_mfma_f32_16x16x32_bf16 v[164:167], v[88:91], v[120:123], v[164:167]
    v_add_f32 v16, v16, v147
    v_mfma_f32_16x16x32_bf16 v[168:171], v[88:91], v[136:139], v[168:171]
    ds_read_b128 v[104:107], v3 offset:27648
    v_cvt_pk_bf16_f32 v193, v146, v147
    s_waitcnt lgkmcnt(3)
    v_mfma_f32_16x16x32_bf16 v[20:23], v[92:95], v[196:199], v[20:23]
    v_exp_f32 v148, v148
    v_exp_f32 v149, v149
    v_mfma_f32_16x16x32_bf16 v[24:27], v[92:95], v[200:203], v[24:27]
    ds_read_b128 v[84:87], v3 offset:28672
    v_add_f32 v15, v15, v148
    s_waitcnt lgkmcnt(3)
    v_mfma_f32_16x16x32_bf16 v[28:31], v[96:99], v[196:199], v[28:31]
    v_add_f32 v15, v15, v149
    v_mfma_f32_16x16x32_bf16 v[32:35], v[96:99], v[200:203], v[32:35]
    ds_read_b128 v[88:91], v3 offset:29696
    v_cvt_pk_bf16_f32 v190, v148, v149
    s_waitcnt lgkmcnt(3)
    v_mfma_f32_16x16x32_bf16 v[36:39], v[100:103], v[196:199], v[36:39]
    v_exp_f32 v150, v150
    v_exp_f32 v151, v151
    v_mfma_f32_16x16x32_bf16 v[40:43], v[100:103], v[200:203], v[40:43]
    ds_read_b128 v[92:95], v3 offset:30720
    v_add_f32 v15, v15, v150
    s_waitcnt lgkmcnt(3)
    v_mfma_f32_16x16x32_bf16 v[44:47], v[104:107], v[196:199], v[44:47]
    v_add_f32 v15, v15, v151
    v_mfma_f32_16x16x32_bf16 v[48:51], v[104:107], v[200:203], v[48:51]
    ds_read_b128 v[96:99], v3 offset:31744
    v_cvt_pk_bf16_f32 v191, v150, v151
    s_waitcnt lgkmcnt(3)
    v_mfma_f32_16x16x32_bf16 v[52:55], v[84:87], v[196:199], v[52:55]
    v_exp_f32 v152, v152
    v_exp_f32 v153, v153
    v_mfma_f32_16x16x32_bf16 v[56:59], v[84:87], v[200:203], v[56:59]
    s_waitcnt vmcnt(4)
    s_barrier
    ds_read_b128 v[100:103], v2 offset:32768
    v_add_f32 v16, v16, v152
    s_waitcnt lgkmcnt(3)
    v_mfma_f32_16x16x32_bf16 v[60:63], v[88:91], v[196:199], v[60:63]
    v_add_f32 v16, v16, v153
    v_mfma_f32_16x16x32_bf16 v[64:67], v[88:91], v[200:203], v[64:67]
    ds_read_b128 v[104:107], v2 offset:33792
    v_cvt_pk_bf16_f32 v194, v152, v153
    s_waitcnt lgkmcnt(3)
    v_mfma_f32_16x16x32_bf16 v[68:71], v[92:95], v[196:199], v[68:71]
    v_exp_f32 v154, v154
    v_exp_f32 v155, v155
    v_mfma_f32_16x16x32_bf16 v[72:75], v[92:95], v[200:203], v[72:75]
    ds_read_b128 v[84:87], v2 offset:34816
    v_add_f32 v16, v16, v154
    s_waitcnt lgkmcnt(3)
    v_mfma_f32_16x16x32_bf16 v[76:79], v[96:99], v[196:199], v[76:79]
    v_add_f32 v16, v16, v155
    v_mfma_f32_16x16x32_bf16 v[80:83], v[96:99], v[200:203], v[80:83]
    ds_read_b128 v[88:91], v2 offset:35840
    v_cvt_pk_bf16_f32 v195, v154, v155
    s_waitcnt lgkmcnt(3)
    v_mfma_f32_16x16x32_bf16 v[140:143], v[100:103], v[108:111], v[172:175]
    v_exp_f32 v156, v156
    v_exp_f32 v157, v157
    v_mfma_f32_16x16x32_bf16 v[144:147], v[100:103], v[124:127], v[176:179]
    ds_read_b128 v[92:95], v2 offset:36864
    v_add_f32 v15, v15, v156
    s_waitcnt lgkmcnt(3)
    v_mfma_f32_16x16x32_bf16 v[148:151], v[104:107], v[108:111], v[172:175]
    v_add_f32 v15, v15, v157
    v_mfma_f32_16x16x32_bf16 v[152:155], v[104:107], v[124:127], v[176:179]
    ds_read_b128 v[96:99], v2 offset:37888
    v_cvt_pk_bf16_f32 v196, v156, v157
    s_waitcnt lgkmcnt(3)
    v_mfma_f32_16x16x32_bf16 v[140:143], v[84:87], v[112:115], v[140:143]
    v_exp_f32 v158, v158
    v_exp_f32 v159, v159
    v_mfma_f32_16x16x32_bf16 v[144:147], v[84:87], v[128:131], v[144:147]
    ds_read_b128 v[100:103], v2 offset:38912
    v_add_f32 v15, v15, v158
    s_waitcnt lgkmcnt(3)
    v_mfma_f32_16x16x32_bf16 v[148:151], v[88:91], v[112:115], v[148:151]
    v_add_f32 v15, v15, v159
    v_mfma_f32_16x16x32_bf16 v[152:155], v[88:91], v[128:131], v[152:155]
    ds_read_b128 v[104:107], v2 offset:39936
    v_cvt_pk_bf16_f32 v197, v158, v159
    s_waitcnt lgkmcnt(3)
    v_mfma_f32_16x16x32_bf16 v[140:143], v[92:95], v[116:119], v[140:143]
    v_exp_f32 v160, v160
    v_exp_f32 v161, v161
    v_mfma_f32_16x16x32_bf16 v[144:147], v[92:95], v[132:135], v[144:147]
    ds_read_b128 v[84:87], v2 offset:8192
    v_add_f32 v16, v16, v160
    s_waitcnt lgkmcnt(3)
    v_mfma_f32_16x16x32_bf16 v[148:151], v[96:99], v[116:119], v[148:151]
    v_add_f32 v16, v16, v161
    v_mfma_f32_16x16x32_bf16 v[152:155], v[96:99], v[132:135], v[152:155]
    ds_read_b128 v[88:91], v2 offset:9216
    v_cvt_pk_bf16_f32 v200, v160, v161
    s_bfe_u32 s22, s42, 0x30000
    s_or_b32 s22, s22, s62
    s_lshl_b32 s22, s22, 18
    s_add_u32 s22, s22, s16
    s_add_u32 s22, s22, 0x0
    s_add_u32 m0, s17, 0x0
    s_nop 0
    buffer_load_dwordx4 v17, s[4:7], s22 offen lds
    s_waitcnt lgkmcnt(3)
    v_mfma_f32_16x16x32_bf16 v[140:143], v[100:103], v[120:123], v[140:143]
    v_exp_f32 v162, v162
    v_exp_f32 v163, v163
    v_mfma_f32_16x16x32_bf16 v[144:147], v[100:103], v[136:139], v[144:147]
    ds_read_b128 v[92:95], v2 offset:10240
    v_add_f32 v16, v16, v162
    s_waitcnt lgkmcnt(3)
    v_mfma_f32_16x16x32_bf16 v[148:151], v[104:107], v[120:123], v[148:151]
    v_add_f32 v16, v16, v163
    v_mfma_f32_16x16x32_bf16 v[152:155], v[104:107], v[136:139], v[152:155]
    ds_read_b128 v[96:99], v2 offset:11264
    v_cvt_pk_bf16_f32 v201, v162, v163
    s_bfe_u32 s22, s42, 0x30000
    s_or_b32 s22, s22, s62
    s_lshl_b32 s22, s22, 18
    s_add_u32 s22, s22, s16
    s_add_u32 s22, s22, 0x2000
    s_add_u32 m0, s17, 0x400
    s_nop 0
    buffer_load_dwordx4 v18, s[4:7], s22 offen lds
    s_waitcnt lgkmcnt(3)
    v_mfma_f32_16x16x32_bf16 v[20:23], v[84:87], v[188:191], v[20:23]
    v_exp_f32 v164, v164
    v_exp_f32 v165, v165
    v_mfma_f32_16x16x32_bf16 v[24:27], v[84:87], v[192:195], v[24:27]
    ds_read_b128 v[100:103], v2 offset:12288
    v_add_f32 v15, v15, v164
    s_waitcnt lgkmcnt(3)
    v_mfma_f32_16x16x32_bf16 v[28:31], v[88:91], v[188:191], v[28:31]
    v_add_f32 v15, v15, v165
    v_mfma_f32_16x16x32_bf16 v[32:35], v[88:91], v[192:195], v[32:35]
    ds_read_b128 v[104:107], v2 offset:13312
    v_cvt_pk_bf16_f32 v198, v164, v165
    s_bfe_u32 s22, s42, 0x30000
    s_or_b32 s22, s22, s62
    s_lshl_b32 s22, s22, 18
    s_add_u32 s22, s22, s16
    s_add_u32 s22, s22, 0x4000
    s_add_u32 m0, s17, 0x800
    s_nop 0
    buffer_load_dwordx4 v17, s[4:7], s22 offen lds
    s_waitcnt lgkmcnt(3)
    v_mfma_f32_16x16x32_bf16 v[36:39], v[92:95], v[188:191], v[36:39]
    v_exp_f32 v166, v166
    v_exp_f32 v167, v167
    v_mfma_f32_16x16x32_bf16 v[40:43], v[92:95], v[192:195], v[40:43]
    ds_read_b128 v[84:87], v2 offset:14336
    v_add_f32 v15, v15, v166
    s_waitcnt lgkmcnt(3)
    v_mfma_f32_16x16x32_bf16 v[44:47], v[96:99], v[188:191], v[44:47]
    v_add_f32 v15, v15, v167
    v_mfma_f32_16x16x32_bf16 v[48:51], v[96:99], v[192:195], v[48:51]
    ds_read_b128 v[88:91], v2 offset:15360
    v_cvt_pk_bf16_f32 v199, v166, v167
    s_bfe_u32 s22, s42, 0x30000
    s_or_b32 s22, s22, s62
    s_lshl_b32 s22, s22, 18
    s_add_u32 s22, s22, s16
    s_add_u32 s22, s22, 0x6000
    s_add_u32 m0, s17, 0xc00
    s_nop 0
    buffer_load_dwordx4 v18, s[4:7], s22 offen lds
    s_waitcnt lgkmcnt(3)
    v_mfma_f32_16x16x32_bf16 v[52:55], v[100:103], v[188:191], v[52:55]
    v_exp_f32 v168, v168
    v_exp_f32 v169, v169
    v_mfma_f32_16x16x32_bf16 v[56:59], v[100:103], v[192:195], v[56:59]
    s_waitcnt vmcnt(4)
    s_barrier
    ds_read_b128 v[92:95], v2 offset:49152
    v_add_f32 v16, v16, v168
    s_waitcnt lgkmcnt(3)
    v_mfma_f32_16x16x32_bf16 v[60:63], v[104:107], v[188:191], v[60:63]
    v_add_f32 v16, v16, v169
    v_mfma_f32_16x16x32_bf16 v[64:67], v[104:107], v[192:195], v[64:67]
    ds_read_b128 v[96:99], v2 offset:50176
    v_cvt_pk_bf16_f32 v202, v168, v169
    s_waitcnt lgkmcnt(3)
    v_mfma_f32_16x16x32_bf16 v[68:71], v[84:87], v[188:191], v[68:71]
    v_exp_f32 v170, v170
    v_exp_f32 v171, v171
    v_mfma_f32_16x16x32_bf16 v[72:75], v[84:87], v[192:195], v[72:75]
    ds_read_b128 v[100:103], v2 offset:51200
    v_add_f32 v16, v16, v170
    s_waitcnt lgkmcnt(3)
    v_mfma_f32_16x16x32_bf16 v[76:79], v[88:91], v[188:191], v[76:79]
    v_add_f32 v16, v16, v171
    v_mfma_f32_16x16x32_bf16 v[80:83], v[88:91], v[192:195], v[80:83]
    ds_read_b128 v[104:107], v2 offset:52224
    v_cvt_pk_bf16_f32 v203, v170, v171
    s_waitcnt lgkmcnt(3)
    v_mfma_f32_16x16x32_bf16 v[156:159], v[92:95], v[108:111], v[172:175]
    v_exp_f32 v140, v140
    v_exp_f32 v141, v141
    v_mfma_f32_16x16x32_bf16 v[160:163], v[92:95], v[124:127], v[176:179]
    ds_read_b128 v[84:87], v2 offset:53248
    v_add_f32 v15, v15, v140
    v_lshlrev_b32 v6, 4, v8
    s_mov_b64 s[68:69], s[44:45]
    s_mov_b32 s70, 0x800
    s_mov_b32 s71, 0x20000
    v_lshlrev_b32 v7, 3, v8
    buffer_load_dwordx2 v[186:187], v7, s[68:71], 0 offen
    s_mov_b32 s26, 0xa20000
    buffer_load_dwordx4 v[236:239], v6, s[8:11], s26 offen sc1
    s_mov_b32 s26, 0xa21000
    buffer_load_dwordx4 v[240:243], v6, s[8:11], s26 offen sc1
    s_mov_b32 s26, 0xa22000
    buffer_load_dwordx4 v[244:247], v6, s[8:11], s26 offen sc1
    s_mov_b32 s26, 0xa23000
    buffer_load_dwordx4 v[248:251], v6, s[8:11], s26 offen sc1
    s_waitcnt lgkmcnt(3)
    v_mfma_f32_16x16x32_bf16 v[164:167], v[96:99], v[108:111], v[172:175]
    v_add_f32 v15, v15, v141
    v_mfma_f32_16x16x32_bf16 v[168:171], v[96:99], v[124:127], v[176:179]
    ds_read_b128 v[88:91], v2 offset:54272
    v_cvt_pk_bf16_f32 v188, v140, v141
    s_waitcnt lgkmcnt(3)
    v_mfma_f32_16x16x32_bf16 v[156:159], v[100:103], v[112:115], v[156:159]
    v_exp_f32 v142, v142
    v_exp_f32 v143, v143
    v_mfma_f32_16x16x32_bf16 v[160:163], v[100:103], v[128:131], v[160:163]
    ds_read_b128 v[92:95], v2 offset:55296
    v_add_f32 v15, v15, v142
    s_waitcnt lgkmcnt(3)
    v_mfma_f32_16x16x32_bf16 v[164:167], v[104:107], v[112:115], v[164:167]
    v_add_f32 v15, v15, v143
    v_mfma_f32_16x16x32_bf16 v[168:171], v[104:107], v[128:131], v[168:171]
    ds_read_b128 v[96:99], v2 offset:56320
    v_cvt_pk_bf16_f32 v189, v142, v143
    s_waitcnt lgkmcnt(3)
    v_mfma_f32_16x16x32_bf16 v[156:159], v[84:87], v[116:119], v[156:159]
    v_exp_f32 v144, v144
    v_exp_f32 v145, v145
    v_mfma_f32_16x16x32_bf16 v[160:163], v[84:87], v[132:135], v[160:163]
    ds_read_b128 v[100:103], v2 offset:24576
    v_add_f32 v16, v16, v144
    s_waitcnt lgkmcnt(3)
    v_mfma_f32_16x16x32_bf16 v[164:167], v[88:91], v[116:119], v[164:167]
    v_add_f32 v16, v16, v145
    v_mfma_f32_16x16x32_bf16 v[168:171], v[88:91], v[132:135], v[168:171]
    ds_read_b128 v[104:107], v2 offset:25600
    v_cvt_pk_bf16_f32 v192, v144, v145
    s_bfe_u32 s22, s42, 0x30000
    s_or_b32 s22, s22, s62
    s_lshl_b32 s22, s22, 18
    s_add_u32 s22, s22, s16
    s_add_u32 s22, s22, 0x20000
    s_add_u32 m0, s17, 0x4000
    s_nop 0
    buffer_load_dwordx4 v17, s[4:7], s22 offen lds
    s_waitcnt lgkmcnt(3)
    v_mfma_f32_16x16x32_bf16 v[156:159], v[92:95], v[120:123], v[156:159]
    v_exp_f32 v146, v146
    v_exp_f32 v147, v147
    v_mfma_f32_16x16x32_bf16 v[160:163], v[92:95], v[136:139], v[160:163]
    ds_read_b128 v[84:87], v2 offset:26624
    v_add_f32 v16, v16, v146
    s_waitcnt lgkmcnt(3)
    v_mfma_f32_16x16x32_bf16 v[164:167], v[96:99], v[120:123], v[164:167]
    v_add_f32 v16, v16, v147
    v_mfma_f32_16x16x32_bf16 v[168:171], v[96:99], v[136:139], v[168:171]
    ds_read_b128 v[88:91], v2 offset:27648
    v_cvt_pk_bf16_f32 v193, v146, v147
    s_bfe_u32 s22, s42, 0x30000
    s_or_b32 s22, s22, s62
    s_lshl_b32 s22, s22, 18
    s_add_u32 s22, s22, s16
    s_add_u32 s22, s22, 0x22000
    s_add_u32 m0, s17, 0x4400
    s_nop 0
    buffer_load_dwordx4 v18, s[4:7], s22 offen lds
    s_waitcnt lgkmcnt(3)
    v_mfma_f32_16x16x32_bf16 v[20:23], v[100:103], v[196:199], v[20:23]
    v_exp_f32 v148, v148
    v_exp_f32 v149, v149
    v_mfma_f32_16x16x32_bf16 v[24:27], v[100:103], v[200:203], v[24:27]
    ds_read_b128 v[92:95], v2 offset:28672
    v_add_f32 v15, v15, v148
    s_waitcnt lgkmcnt(3)
    v_mfma_f32_16x16x32_bf16 v[28:31], v[104:107], v[196:199], v[28:31]
    v_add_f32 v15, v15, v149
    v_mfma_f32_16x16x32_bf16 v[32:35], v[104:107], v[200:203], v[32:35]
    ds_read_b128 v[96:99], v2 offset:29696
    v_cvt_pk_bf16_f32 v190, v148, v149
    s_bfe_u32 s22, s42, 0x30000
    s_or_b32 s22, s22, s62
    s_lshl_b32 s22, s22, 18
    s_add_u32 s22, s22, s16
    s_add_u32 s22, s22, 0x24000
    s_add_u32 m0, s17, 0x4800
    s_nop 0
    buffer_load_dwordx4 v17, s[4:7], s22 offen lds
    s_waitcnt lgkmcnt(3)
    v_mfma_f32_16x16x32_bf16 v[36:39], v[84:87], v[196:199], v[36:39]
    v_exp_f32 v150, v150
    v_exp_f32 v151, v151
    v_mfma_f32_16x16x32_bf16 v[40:43], v[84:87], v[200:203], v[40:43]
    ds_read_b128 v[100:103], v2 offset:30720
    v_add_f32 v15, v15, v150
    s_waitcnt lgkmcnt(3)
    v_mfma_f32_16x16x32_bf16 v[44:47], v[88:91], v[196:199], v[44:47]
    v_add_f32 v15, v15, v151
    v_mfma_f32_16x16x32_bf16 v[48:51], v[88:91], v[200:203], v[48:51]
    ds_read_b128 v[104:107], v2 offset:31744
    v_cvt_pk_bf16_f32 v191, v150, v151
    s_bfe_u32 s22, s42, 0x30000
    s_or_b32 s22, s22, s62
    s_lshl_b32 s22, s22, 18
    s_add_u32 s22, s22, s16
    s_add_u32 s22, s22, 0x26000
    s_add_u32 m0, s17, 0x4c00
    s_nop 0
    buffer_load_dwordx4 v18, s[4:7], s22 offen lds
    s_waitcnt lgkmcnt(3)
    v_mfma_f32_16x16x32_bf16 v[52:55], v[92:95], v[196:199], v[52:55]
    v_exp_f32 v152, v152
    v_exp_f32 v153, v153
    v_mfma_f32_16x16x32_bf16 v[56:59], v[92:95], v[200:203], v[56:59]
    ds_read_b128 v[84:87], v2 offset:40960
    v_add_f32 v16, v16, v152
    s_waitcnt lgkmcnt(3)
    v_mfma_f32_16x16x32_bf16 v[60:63], v[96:99], v[196:199], v[60:63]
    v_add_f32 v16, v16, v153
    v_mfma_f32_16x16x32_bf16 v[64:67], v[96:99], v[200:203], v[64:67]
    ds_read_b128 v[88:91], v2 offset:41984
    v_cvt_pk_bf16_f32 v194, v152, v153
    s_waitcnt lgkmcnt(3)
    v_mfma_f32_16x16x32_bf16 v[68:71], v[100:103], v[196:199], v[68:71]
    v_exp_f32 v154, v154
    v_exp_f32 v155, v155
    v_mfma_f32_16x16x32_bf16 v[72:75], v[100:103], v[200:203], v[72:75]
    ds_read_b128 v[92:95], v2 offset:43008
    v_add_f32 v16, v16, v154
    s_waitcnt lgkmcnt(3)
    v_mfma_f32_16x16x32_bf16 v[76:79], v[104:107], v[196:199], v[76:79]
    v_add_f32 v16, v16, v155
    v_mfma_f32_16x16x32_bf16 v[80:83], v[104:107], v[200:203], v[80:83]
    ds_read_b128 v[96:99], v2 offset:44032
    v_cvt_pk_bf16_f32 v195, v154, v155
    s_waitcnt lgkmcnt(3)
    v_mfma_f32_16x16x32_bf16 v[20:23], v[84:87], v[188:191], v[20:23]
    v_exp_f32 v156, v156
    v_exp_f32 v157, v157
    v_add_f32 v15, v15, v156
    v_mfma_f32_16x16x32_bf16 v[24:27], v[84:87], v[192:195], v[24:27]
    ds_read_b128 v[100:103], v2 offset:45056
    v_add_f32 v15, v15, v157
    v_cvt_pk_bf16_f32 v196, v156, v157
    s_waitcnt vmcnt(7)
    v_min3_u32 v13, v236, v237, v238
    s_waitcnt vmcnt(6)
    v_min3_u32 v13, v13, v239, v240
    v_min3_u32 v13, v13, v241, v242
    s_waitcnt vmcnt(5)
    v_min3_u32 v13, v13, v243, v244
    v_min3_u32 v13, v13, v245, v246
    s_waitcnt vmcnt(4)
    v_min3_u32 v13, v13, v247, v248
    v_min3_u32 v13, v13, v249, v250
    v_min_u32 v13, v13, v251
    v_cmp_eq_u32 vcc, 0, v13
    s_cbranch_vccz fz_mfg
    s_mov_b32 s27, 0
fz_mfp:
    s_mov_b32 s26, 0xa20000
    buffer_load_dwordx4 v[236:239], v6, s[8:11], s26 offen sc1
    s_mov_b32 s26, 0xa21000
    buffer_load_dwordx4 v[240:243], v6, s[8:11], s26 offen sc1
    s_mov_b32 s26, 0xa22000
    buffer_load_dwordx4 v[244:247], v6, s[8:11], s26 offen sc1
    s_mov_b32 s26, 0xa23000
    buffer_load_dwordx4 v[248:251], v6, s[8:11], s26 offen sc1
    s_waitcnt vmcnt(0)
    v_min3_u32 v13, v236, v237, v238
    v_min3_u32 v13, v13, v239, v240
    v_min3_u32 v13, v13, v241, v242
    v_min3_u32 v13, v13, v243, v244
    v_min3_u32 v13, v13, v245, v246
    v_min3_u32 v13, v13, v247, v248
    v_min3_u32 v13, v13, v249, v250
    v_min_u32 v13, v13, v251
    v_cmp_eq_u32 vcc, 0, v13
    s_add_u32 s27, s27, 1
    s_cmp_ge_u32 s27, 65536
    s_nop 4
    s_cbranch_scc1 fz_mfg
    s_cbranch_vccnz fz_mfp
fz_mfg:
    s_mov_b32 s26, 0x07060302
    v_perm_b32 v180, v241, v240, s26
    v_perm_b32 v181, v243, v242, s26
    v_perm_b32 v182, v245, v244, s26
    v_perm_b32 v183, v247, v246, s26
    v_perm_b32 v184, v249, v248, s26
    v_perm_b32 v185, v251, v250, s26
    v_add_u32 v7, 0x20000, v7
    ds_write_b64 v7, v[180:181] offset:0
    ds_write_b64 v7, v[182:183] offset:2048
    ds_write_b64 v7, v[184:185] offset:4096
    ds_write_b64 v7, v[186:187] offset:6144
    v_and_b32 v236, 0xffff0000, v236
    v_and_b32 v237, 0xffff0000, v237
    v_and_b32 v238, 0xffff0000, v238
    v_and_b32 v239, 0xffff0000, v239
    v_add_u32 v6, 0x22000, v6
    ds_write_b128 v6, v[236:239]
    s_waitcnt lgkmcnt(0)
    v_mfma_f32_16x16x32_bf16 v[28:31], v[88:91], v[188:191], v[28:31]
    v_exp_f32 v158, v158
    v_exp_f32 v159, v159
    v_add_f32 v15, v15, v158
    v_mfma_f32_16x16x32_bf16 v[32:35], v[88:91], v[192:195], v[32:35]
    ds_read_b128 v[104:107], v2 offset:46080
    v_add_f32 v15, v15, v159
    v_cvt_pk_bf16_f32 v197, v158, v159
    v_mfma_f32_16x16x32_bf16 v[36:39], v[92:95], v[188:191], v[36:39]
    v_exp_f32 v160, v160
    v_exp_f32 v161, v161
    v_add_f32 v16, v16, v160
    v_mfma_f32_16x16x32_bf16 v[40:43], v[92:95], v[192:195], v[40:43]
    ds_read_b128 v[84:87], v2 offset:47104
    v_add_f32 v16, v16, v161
    v_cvt_pk_bf16_f32 v200, v160, v161
    v_mfma_f32_16x16x32_bf16 v[44:47], v[96:99], v[188:191], v[44:47]
    v_exp_f32 v162, v162
    v_exp_f32 v163, v163
    v_add_f32 v16, v16, v162
    v_mfma_f32_16x16x32_bf16 v[48:51], v[96:99], v[192:195], v[48:51]
    ds_read_b128 v[88:91], v2 offset:48128
    v_add_f32 v16, v16, v163
    v_cvt_pk_bf16_f32 v201, v162, v163
    v_mfma_f32_16x16x32_bf16 v[52:55], v[100:103], v[188:191], v[52:55]
    v_exp_f32 v164, v164
    v_exp_f32 v165, v165
    v_add_f32 v15, v15, v164
    v_mfma_f32_16x16x32_bf16 v[56:59], v[100:103], v[192:195], v[56:59]
    ds_read_b128 v[92:95], v2 offset:57344
    v_add_f32 v15, v15, v165
    v_cvt_pk_bf16_f32 v198, v164, v165
    s_waitcnt lgkmcnt(3)
    v_mfma_f32_16x16x32_bf16 v[60:63], v[104:107], v[188:191], v[60:63]
    v_exp_f32 v166, v166
    v_exp_f32 v167, v167
    v_add_f32 v15, v15, v166
    v_mfma_f32_16x16x32_bf16 v[64:67], v[104:107], v[192:195], v[64:67]
    ds_read_b128 v[96:99], v2 offset:58368
    v_add_f32 v15, v15, v167
    v_cvt_pk_bf16_f32 v199, v166, v167
    s_bfe_u32 s22, s42, 0x30004
    s_or_b32 s22, s22, s62
    s_lshl_b32 s22, s22, 18
    s_add_u32 s22, s22, s16
    s_add_u32 s22, s22, 0x0
    s_add_u32 m0, s17, 0x8000
    s_nop 0
    buffer_load_dwordx4 v17, s[4:7], s22 offen lds
    s_waitcnt lgkmcnt(3)
    v_mfma_f32_16x16x32_bf16 v[68:71], v[84:87], v[188:191], v[68:71]
    v_exp_f32 v168, v168
    v_exp_f32 v169, v169
    v_add_f32 v16, v16, v168
    v_mfma_f32_16x16x32_bf16 v[72:75], v[84:87], v[192:195], v[72:75]
    ds_read_b128 v[100:103], v2 offset:59392
    v_add_f32 v16, v16, v169
    v_cvt_pk_bf16_f32 v202, v168, v169
    s_waitcnt lgkmcnt(3)
    v_mfma_f32_16x16x32_bf16 v[76:79], v[88:91], v[188:191], v[76:79]
    v_exp_f32 v170, v170
    v_exp_f32 v171, v171
    v_add_f32 v16, v16, v170
    v_mfma_f32_16x16x32_bf16 v[80:83], v[88:91], v[192:195], v[80:83]
    ds_read_b128 v[104:107], v2 offset:60416
    v_add_f32 v16, v16, v171
    v_cvt_pk_bf16_f32 v203, v170, v171
    s_bfe_u32 s22, s42, 0x30004
    s_or_b32 s22, s22, s62
    s_lshl_b32 s22, s22, 18
    s_add_u32 s22, s22, s16
    s_add_u32 s22, s22, 0x2000
    s_add_u32 m0, s17, 0x8400
    s_nop 0
    buffer_load_dwordx4 v18, s[4:7], s22 offen lds
    s_waitcnt lgkmcnt(3)
    v_mfma_f32_16x16x32_bf16 v[20:23], v[92:95], v[196:199], v[20:23]
    v_mfma_f32_16x16x32_bf16 v[24:27], v[92:95], v[200:203], v[24:27]
    ds_read_b128 v[84:87], v2 offset:61440
    s_waitcnt lgkmcnt(3)
    v_mfma_f32_16x16x32_bf16 v[28:31], v[96:99], v[196:199], v[28:31]
    v_mfma_f32_16x16x32_bf16 v[32:35], v[96:99], v[200:203], v[32:35]
    ds_read_b128 v[88:91], v2 offset:62464
    s_bfe_u32 s22, s42, 0x30004
    s_or_b32 s22, s22, s62
    s_lshl_b32 s22, s22, 18
    s_add_u32 s22, s22, s16
    s_add_u32 s22, s22, 0x4000
    s_add_u32 m0, s17, 0x8800
    s_nop 0
    buffer_load_dwordx4 v17, s[4:7], s22 offen lds
    s_waitcnt lgkmcnt(3)
    v_mfma_f32_16x16x32_bf16 v[36:39], v[100:103], v[196:199], v[36:39]
    v_mfma_f32_16x16x32_bf16 v[40:43], v[100:103], v[200:203], v[40:43]
    ds_read_b128 v[92:95], v2 offset:63488
    s_waitcnt lgkmcnt(3)
    v_mfma_f32_16x16x32_bf16 v[44:47], v[104:107], v[196:199], v[44:47]
    v_mfma_f32_16x16x32_bf16 v[48:51], v[104:107], v[200:203], v[48:51]
    ds_read_b128 v[96:99], v2 offset:64512
    s_bfe_u32 s22, s42, 0x30004
    s_or_b32 s22, s22, s62
    s_lshl_b32 s22, s22, 18
    s_add_u32 s22, s22, s16
    s_add_u32 s22, s22, 0x6000
    s_add_u32 m0, s17, 0x8c00
    s_nop 0
    buffer_load_dwordx4 v18, s[4:7], s22 offen lds
    s_waitcnt lgkmcnt(3)
    v_mfma_f32_16x16x32_bf16 v[52:55], v[84:87], v[196:199], v[52:55]
    v_mfma_f32_16x16x32_bf16 v[56:59], v[84:87], v[200:203], v[56:59]
    s_waitcnt lgkmcnt(2)
    v_mfma_f32_16x16x32_bf16 v[60:63], v[88:91], v[196:199], v[60:63]
    v_mfma_f32_16x16x32_bf16 v[64:67], v[88:91], v[200:203], v[64:67]
    s_waitcnt lgkmcnt(1)
    v_mfma_f32_16x16x32_bf16 v[68:71], v[92:95], v[196:199], v[68:71]
    v_mfma_f32_16x16x32_bf16 v[72:75], v[92:95], v[200:203], v[72:75]
    s_waitcnt lgkmcnt(0)
    v_mfma_f32_16x16x32_bf16 v[76:79], v[96:99], v[196:199], v[76:79]
    v_mfma_f32_16x16x32_bf16 v[80:83], v[96:99], v[200:203], v[80:83]
    s_branch fz_chk
fz_roleB:
    s_and_b32 s20, s2, 7
    s_lshl_b32 s20, s20, 3
    s_bfe_u32 s21, s2, 0x30003
    s_add_u32 s20, s20, s21
    s_lshr_b32 s21, s2, 6
    v_lshrrev_b32 v31, 2, v8
    v_mul_u32_u24 v28, 49152, v31
    v_and_b32 v32, 3, v8
    v_lshl_add_u32 v28, v32, 4, v28
    v_lshlrev_b32 v29, 3, v31
    s_mul_i32 s22, s21, 3145728
    s_lshl_b32 s23, s20, 6
    s_add_u32 s22, s22, s23
    s_lshl_b32 s24, s21, 9
    v_mov_b32 v24, 0
    v_mov_b32 v25, 0
    v_mov_b32 v26, 0
    v_mov_b32 v27, 0
    v_lshlrev_b32 v33, 3, v8
    s_lshl_b32 s26, s2, 11
    s_add_u32 s26, s26, 0xa00000
    s_sub_u32 s19, s3, 4
    v_mov_b32 v39, 0x20200
    ds_write_b32 v39, v24
    s_waitcnt lgkmcnt(0)
    s_mov_b64 s[8:9], s[60:61]
    s_mov_b64 s[64:65], s[52:53]
    s_mov_b32 s66, 0x800
    s_mov_b32 s67, 0x20000
    s_mov_b64 s[68:69], s[54:55]
    s_mov_b32 s70, 0xc00000
    s_mov_b32 s71, 0x20000
    s_mov_b64 s[4:5], s[38:39]
    s_mov_b32 s6, 0x800000
    s_mov_b32 s7, 0x20000
    buffer_store_dwordx2 v[24:25], v33, s[8:11], s26 offen sc1
    buffer_load_dwordx2 v[60:61], v29, s[64:67], s24 offen
    s_add_u32 s25, s22, 0
    buffer_load_dwordx4 v[44:47], v28, s[68:71], s25 offen
    s_add_u32 s25, s22, 12288
    buffer_load_dwordx4 v[48:51], v28, s[68:71], s25 offen
    s_add_u32 s25, s22, 24576
    buffer_load_dwordx4 v[52:55], v28, s[68:71], s25 offen
    s_add_u32 s25, s22, 36864
    buffer_load_dwordx4 v[56:59], v28, s[68:71], s25 offen
    s_mov_b32 s27, 0x570000
    buffer_load_dword v20, v24, s[8:11], s27 offen sc1
    s_cmp_lg_u32 s3, 4
    s_cbranch_scc1 fz_ncp
    s_getpc_b64 s[22:23]
fz_pc:
    s_add_u32 s22, s22, fz_start-fz_pc
    s_addc_u32 s23, s23, -1
    s_lshr_b32 s24, s2, 3
    s_lshl_b32 s24, s24, 12
    v_lshl_add_u32 v35, v0, 7, s24
    v_min_u32 v35, fz_end-fz_start, v35
    s_mov_b64 exec, 0xffffffff
    global_load_dword v7, v35, s[22:23]
    s_mov_b64 exec, -1
fz_ncp:
    s_barrier
    v_lshrrev_b32 v34, 4, v0
    s_waitcnt vmcnt(5)
    v_lshlrev_b32 v62, 16, v61
    v_and_b32 v63, 0xffff0000, v61
    v_and_b32 v61, 0xffff0000, v60
    v_lshlrev_b32 v60, 16, v60
    v_mul_f32 v72, 0xbfb8aa3b, v60
    v_exp_f32 v72, v72
    s_nop 0
    v_add_f32 v72, 1.0, v72
    v_rcp_f32 v72, v72
    s_nop 0
    v_mul_f32 v60, v60, v72
    v_mul_f32 v73, 0xbfb8aa3b, v61
    v_exp_f32 v73, v73
    s_nop 0
    v_add_f32 v73, 1.0, v73
    v_rcp_f32 v73, v73
    s_nop 0
    v_mul_f32 v61, v61, v73
    v_mul_f32 v74, 0xbfb8aa3b, v62
    v_exp_f32 v74, v74
    s_nop 0
    v_add_f32 v74, 1.0, v74
    v_rcp_f32 v74, v74
    s_nop 0
    v_mul_f32 v62, v62, v74
    v_mul_f32 v75, 0xbfb8aa3b, v63
    v_exp_f32 v75, v75
    s_nop 0
    v_add_f32 v75, 1.0, v75
    v_rcp_f32 v75, v75
    s_nop 0
    v_mul_f32 v63, v63, v75
    v_cvt_pk_bf16_f32 v72, v60, v61
    v_lshlrev_b32 v60, 16, v72
    v_and_b32 v61, 0xffff0000, v72
    v_cvt_pk_bf16_f32 v73, v62, v63
    v_lshlrev_b32 v62, 16, v73
    v_and_b32 v63, 0xffff0000, v73
    s_waitcnt vmcnt(4)
    v_lshlrev_b32 v72, 16, v44
    v_and_b32 v73, 0xffff0000, v44
    v_lshlrev_b32 v74, 16, v45
    v_and_b32 v75, 0xffff0000, v45
    v_lshlrev_b32 v76, 16, v46
    v_and_b32 v77, 0xffff0000, v46
    v_lshlrev_b32 v78, 16, v47
    v_and_b32 v79, 0xffff0000, v47
    v_mul_f32 v64, v60, v72
    v_mul_f32 v65, v60, v73
    v_mul_f32 v66, v60, v74
    v_mul_f32 v67, v60, v75
    v_mul_f32 v68, v60, v76
    v_mul_f32 v69, v60, v77
    v_mul_f32 v70, v60, v78
    v_mul_f32 v71, v60, v79
    s_waitcnt vmcnt(3)
    v_lshlrev_b32 v72, 16, v48
    v_and_b32 v73, 0xffff0000, v48
    v_lshlrev_b32 v74, 16, v49
    v_and_b32 v75, 0xffff0000, v49
    v_lshlrev_b32 v76, 16, v50
    v_and_b32 v77, 0xffff0000, v50
    v_lshlrev_b32 v78, 16, v51
    v_and_b32 v79, 0xffff0000, v51
    v_fmac_f32 v64, v61, v72
    v_fmac_f32 v65, v61, v73
    v_fmac_f32 v66, v61, v74
    v_fmac_f32 v67, v61, v75
    v_fmac_f32 v68, v61, v76
    v_fmac_f32 v69, v61, v77
    v_fmac_f32 v70, v61, v78
    v_fmac_f32 v71, v61, v79
    s_waitcnt vmcnt(2)
    v_lshlrev_b32 v72, 16, v52
    v_and_b32 v73, 0xffff0000, v52
    v_lshlrev_b32 v74, 16, v53
    v_and_b32 v75, 0xffff0000, v53
    v_lshlrev_b32 v76, 16, v54
    v_and_b32 v77, 0xffff0000, v54
    v_lshlrev_b32 v78, 16, v55
    v_and_b32 v79, 0xffff0000, v55
    v_fmac_f32 v64, v62, v72
    v_fmac_f32 v65, v62, v73
    v_fmac_f32 v66, v62, v74
    v_fmac_f32 v67, v62, v75
    v_fmac_f32 v68, v62, v76
    v_fmac_f32 v69, v62, v77
    v_fmac_f32 v70, v62, v78
    v_fmac_f32 v71, v62, v79
    s_waitcnt vmcnt(1)
    v_lshlrev_b32 v72, 16, v56
    v_and_b32 v73, 0xffff0000, v56
    v_lshlrev_b32 v74, 16, v57
    v_and_b32 v75, 0xffff0000, v57
    v_lshlrev_b32 v76, 16, v58
    v_and_b32 v77, 0xffff0000, v58
    v_lshlrev_b32 v78, 16, v59
    v_and_b32 v79, 0xffff0000, v59
    v_fmac_f32 v64, v63, v72
    v_fmac_f32 v65, v63, v73
    v_fmac_f32 v66, v63, v74
    v_fmac_f32 v67, v63, v75
    v_fmac_f32 v68, v63, v76
    v_fmac_f32 v69, v63, v77
    v_fmac_f32 v70, v63, v78
    v_fmac_f32 v71, v63, v79
    v_permlane32_swap_b32 v64, v68
    v_permlane32_swap_b32 v65, v69
    v_permlane32_swap_b32 v66, v70
    v_permlane32_swap_b32 v67, v71
    v_add_f32 v64, v64, v68
    v_add_f32 v65, v65, v69
    v_add_f32 v66, v66, v70
    v_add_f32 v67, v67, v71
    s_nop 0
    v_permlane16_swap_b32 v64, v66
    v_permlane16_swap_b32 v65, v67
    v_add_f32 v64, v64, v66
    v_add_f32 v65, v65, v67
    s_nop 0
    v_add_f32_dpp v64, v64, v64 row_ror:8 row_mask:0xf bank_mask:0xf
    v_add_f32_dpp v65, v65, v65 row_ror:8 row_mask:0xf bank_mask:0xf
    s_nop 0
    v_add_f32_dpp v64, v64, v64 row_ror:4 row_mask:0xf bank_mask:0xf
    v_add_f32_dpp v65, v65, v65 row_ror:4 row_mask:0xf bank_mask:0xf
    v_lshlrev_b32 v36, 5, v32
    v_lshl_add_u32 v36, v34, 3, v36
    s_lshl_b32 s26, s19, 7
    s_add_u32 s26, s26, 0x20000
    v_add_u32 v36, s26, v36
    ds_write_b64 v36, v[64:65]
    v_mov_b32 v40, 1
    s_mov_b64 exec, 1
    ds_add_rtn_u32 v40, v39, v40
    s_mov_b64 exec, -1
    s_waitcnt vmcnt(0)
    v_readfirstlane_b32 s14, v20
    s_add_u32 s14, s14, 1
    v_add_u32 v37, 0x20000, v1
    s_waitcnt lgkmcnt(0)
    v_readfirstlane_b32 s26, v40
    s_cmp_lg_u32 s26, 3
    s_cbranch_scc1 fz_np
    ds_read_b128 v[80:83], v37 offset:0
    ds_read_b128 v[84:87], v37 offset:128
    ds_read_b128 v[88:91], v37 offset:256
    ds_read_b128 v[92:95], v37 offset:384
    v_mov_b32 v30, 0xff
    s_lshl_b32 s26, s21, 13
    s_lshl_b32 s27, s20, 7
    s_add_u32 s26, s26, s27
    s_add_u32 s26, s26, 0x500000
    s_waitcnt lgkmcnt(2)
    v_pk_add_f32 v[80:81], v[80:81], v[84:85]
    v_pk_add_f32 v[82:83], v[82:83], v[86:87]
    s_waitcnt lgkmcnt(0)
    v_pk_add_f32 v[88:89], v[88:89], v[92:93]
    v_pk_add_f32 v[90:91], v[90:91], v[94:95]
    v_pk_add_f32 v[80:81], v[80:81], v[88:89]
    v_pk_add_f32 v[82:83], v[82:83], v[90:91]
    v_bfi_b32 v80, v30, s14, v80
    s_lshr_b32 s27, s14, 8
    v_bfi_b32 v81, v30, s27, v81
    s_lshr_b32 s27, s14, 16
    v_bfi_b32 v82, v30, s27, v82
    s_lshr_b32 s27, s14, 24
    v_bfi_b32 v83, v30, s27, v83
    s_mov_b64 exec, 0xff
    buffer_store_dwordx4 v[80:83], v1, s[8:11], s26 offen sc1
    s_mov_b64 exec, -1
    s_waitcnt vmcnt(0)
fz_np:
    s_waitcnt vmcnt(0)
    s_barrier
    v_lshlrev_b32 v38, 4, v8
    s_mov_b32 s24, 0x0c0c0400
    s_mov_b32 s25, 0x04000c0c
    s_mov_b32 s27, 0
fz_gp:
    s_mov_b32 s21, 0x500000
    buffer_load_dwordx4 v[96:99], v38, s[8:11], s21 offen sc1
    s_mov_b32 s21, 0x501000
    buffer_load_dwordx4 v[100:103], v38, s[8:11], s21 offen sc1
    s_mov_b32 s21, 0x502000
    buffer_load_dwordx4 v[104:107], v38, s[8:11], s21 offen sc1
    s_mov_b32 s21, 0x503000
    buffer_load_dwordx4 v[108:111], v38, s[8:11], s21 offen sc1
    s_mov_b32 s21, 0x504000
    buffer_load_dwordx4 v[112:115], v38, s[8:11], s21 offen sc1
    s_mov_b32 s21, 0x505000
    buffer_load_dwordx4 v[116:119], v38, s[8:11], s21 offen sc1
    s_mov_b32 s21, 0x506000
    buffer_load_dwordx4 v[120:123], v38, s[8:11], s21 offen sc1
    s_mov_b32 s21, 0x507000
    buffer_load_dwordx4 v[124:127], v38, s[8:11], s21 offen sc1
    s_waitcnt vmcnt(7)
    v_perm_b32 v36, v97, v96, s24
    v_perm_b32 v37, v99, v98, s25
    v_or_b32 v36, v36, v37
    v_xor_b32 v35, s14, v36
    s_waitcnt vmcnt(6)
    v_perm_b32 v36, v101, v100, s24
    v_perm_b32 v37, v103, v102, s25
    v_or_b32 v36, v36, v37
    v_xor_b32 v36, s14, v36
    v_or_b32 v35, v35, v36
    s_waitcnt vmcnt(5)
    v_perm_b32 v36, v105, v104, s24
    v_perm_b32 v37, v107, v106, s25
    v_or_b32 v36, v36, v37
    v_xor_b32 v36, s14, v36
    v_or_b32 v35, v35, v36
    s_waitcnt vmcnt(4)
    v_perm_b32 v36, v109, v108, s24
    v_perm_b32 v37, v111, v110, s25
    v_or_b32 v36, v36, v37
    v_xor_b32 v36, s14, v36
    v_or_b32 v35, v35, v36
    s_waitcnt vmcnt(3)
    v_perm_b32 v36, v113, v112, s24
    v_perm_b32 v37, v115, v114, s25
    v_or_b32 v36, v36, v37
    v_xor_b32 v36, s14, v36
    v_or_b32 v35, v35, v36
    s_waitcnt vmcnt(2)
    v_perm_b32 v36, v117, v116, s24
    v_perm_b32 v37, v119, v118, s25
    v_or_b32 v36, v36, v37
    v_xor_b32 v36, s14, v36
    v_or_b32 v35, v35, v36
    s_waitcnt vmcnt(1)
    v_perm_b32 v36, v121, v120, s24
    v_perm_b32 v37, v123, v122, s25
    v_or_b32 v36, v36, v37
    v_xor_b32 v36, s14, v36
    v_or_b32 v35, v35, v36
    s_waitcnt vmcnt(0)
    v_perm_b32 v36, v125, v124, s24
    v_perm_b32 v37, v127, v126, s25
    v_or_b32 v36, v36, v37
    v_xor_b32 v36, s14, v36
    v_or_b32 v35, v35, v36
    v_cmp_ne_u32 vcc, 0, v35
    s_add_u32 s27, s27, 1
    s_cmp_ge_u32 s27, 65536
    s_cbranch_scc1 fz_gg
    s_cbranch_vccz fz_gg
    s_sleep 1
    s_branch fz_gp
fz_gg:
    v_and_b32 v96, 0xffffff00, v96
    v_and_b32 v97, 0xffffff00, v97
    v_and_b32 v98, 0xffffff00, v98
    v_and_b32 v99, 0xffffff00, v99
    v_and_b32 v100, 0xffffff00, v100
    v_and_b32 v101, 0xffffff00, v101
    v_and_b32 v102, 0xffffff00, v102
    v_and_b32 v103, 0xffffff00, v103
    v_and_b32 v104, 0xffffff00, v104
    v_and_b32 v105, 0xffffff00, v105
    v_and_b32 v106, 0xffffff00, v106
    v_and_b32 v107, 0xffffff00, v107
    v_and_b32 v108, 0xffffff00, v108
    v_and_b32 v109, 0xffffff00, v109
    v_and_b32 v110, 0xffffff00, v110
    v_and_b32 v111, 0xffffff00, v111
    v_and_b32 v112, 0xffffff00, v112
    v_and_b32 v113, 0xffffff00, v113
    v_and_b32 v114, 0xffffff00, v114
    v_and_b32 v115, 0xffffff00, v115
    v_and_b32 v116, 0xffffff00, v116
    v_and_b32 v117, 0xffffff00, v117
    v_and_b32 v118, 0xffffff00, v118
    v_and_b32 v119, 0xffffff00, v119
    v_and_b32 v120, 0xffffff00, v120
    v_and_b32 v121, 0xffffff00, v121
    v_and_b32 v122, 0xffffff00, v122
    v_and_b32 v123, 0xffffff00, v123
    v_and_b32 v124, 0xffffff00, v124
    v_and_b32 v125, 0xffffff00, v125
    v_and_b32 v126, 0xffffff00, v126
    v_and_b32 v127, 0xffffff00, v127
    v_pk_add_f32 v[96:97], v[96:97], v[112:113]
    v_pk_add_f32 v[98:99], v[98:99], v[114:115]
    v_pk_add_f32 v[100:101], v[100:101], v[116:117]
    v_pk_add_f32 v[102:103], v[102:103], v[118:119]
    v_pk_add_f32 v[104:105], v[104:105], v[120:121]
    v_pk_add_f32 v[106:107], v[106:107], v[122:123]
    v_pk_add_f32 v[108:109], v[108:109], v[124:125]
    v_pk_add_f32 v[110:111], v[110:111], v[126:127]
    v_pk_add_f32 v[96:97], v[96:97], v[104:105]
    v_pk_add_f32 v[98:99], v[98:99], v[106:107]
    v_pk_add_f32 v[100:101], v[100:101], v[108:109]
    v_pk_add_f32 v[102:103], v[102:103], v[110:111]
    v_cvt_pk_bf16_f32 v31, v96, v97
    v_lshlrev_b32 v96, 16, v31
    v_and_b32 v97, 0xffff0000, v31
    v_cvt_pk_bf16_f32 v31, v98, v99
    v_lshlrev_b32 v98, 16, v31
    v_and_b32 v99, 0xffff0000, v31
    v_cvt_pk_bf16_f32 v31, v100, v101
    v_lshlrev_b32 v100, 16, v31
    v_and_b32 v101, 0xffff0000, v31
    v_cvt_pk_bf16_f32 v31, v102, v103
    v_lshlrev_b32 v102, 16, v31
    v_and_b32 v103, 0xffff0000, v31
    v_add_f32 v100, 1.0, v100
    v_add_f32 v101, 1.0, v101
    v_add_f32 v102, 1.0, v102
    v_add_f32 v103, 1.0, v103
    v_cvt_pk_bf16_f32 v31, v100, v101
    v_lshlrev_b32 v100, 16, v31
    v_and_b32 v101, 0xffff0000, v31
    v_cvt_pk_bf16_f32 v31, v102, v103
    v_lshlrev_b32 v102, 16, v31
    v_and_b32 v103, 0xffff0000, v31
    v_add_u32 v38, 0x21000, v38
    ds_write_b128 v38, v[96:99]
    ds_write_b128 v38, v[100:103] offset:4096
    s_waitcnt lgkmcnt(0)
    s_barrier
    s_barrier
    s_lshl_b32 s26, s13, 5
    s_lshl_b32 s25, s3, 2
    s_add_u32 s26, s26, s25
    v_bfe_u32 v9, v0, 2, 2
    v_lshlrev_b32 v9, 7, v9
    v_and_b32 v10, 3, v0
    v_lshl_add_u32 v9, v10, 2, v9
    s_lshl_b32 s26, s26, 7
    s_add_u32 s26, s26, 0x510000
    s_mov_b32 s27, 0
fz_hBp:
    buffer_load_dword v10, v9, s[8:11], s26 offen sc1
    s_waitcnt vmcnt(0)
    v_cmp_ne_u32 vcc, s14, v10
    s_add_u32 s27, s27, 1
    s_cmp_ge_u32 s27, 65536
    s_cbranch_scc1 fz_hBg
    s_cbranch_vccz fz_hBg
    s_sleep 4
    s_branch fz_hBp
fz_hBg:
    s_mov_b32 s23, 0x0
    buffer_load_dwordx4 v[204:207], v4, s[8:11], s23 offen offset:0 sc1
    s_mov_b32 s23, 0x8000
    buffer_load_dwordx4 v[208:211], v4, s[8:11], s23 offen offset:0 sc1
    s_mov_b32 s23, 0x0
    buffer_load_dwordx4 v[212:215], v4, s[8:11], s23 offen offset:1024 sc1
    s_mov_b32 s23, 0x8000
    buffer_load_dwordx4 v[216:219], v4, s[8:11], s23 offen offset:1024 sc1
    s_barrier
    ds_read_b64_tr_b16 v[84:85], v3 offset:0
    ds_read_b64_tr_b16 v[86:87], v3 offset:1024
    ds_read_b64_tr_b16 v[88:89], v15 offset:32
    ds_read_b64_tr_b16 v[90:91], v15 offset:1056
    ds_read_b64_tr_b16 v[92:93], v3 offset:256
    ds_read_b64_tr_b16 v[94:95], v3 offset:1280
    ds_read_b64_tr_b16 v[96:97], v15 offset:288
    ds_read_b64_tr_b16 v[98:99], v15 offset:1312
    s_waitcnt vmcnt(3) lgkmcnt(6)
    v_mfma_f32_16x16x32_bf16 v[20:23], v[84:87], v[204:207], 0
    s_mov_b32 s23, 0x800
    buffer_load_dwordx4 v[220:223], v4, s[8:11], s23 offen offset:0 sc1
    ds_read_b64_tr_b16 v[100:101], v3 offset:512
    s_sub_u32 s26, s3, 4
    s_lshl_b32 s26, s26, 3
    v_add_u32 v17, s26, v0
    v_lshrrev_b32 v18, 4, v17
    v_lshlrev_b32 v18, 13, v18
    v_and_b32 v17, 15, v17
    v_lshl_add_u32 v17, v17, 7, v18
    s_lshr_b32 s26, s2, 3
    s_lshl_b32 s26, s26, 14
    s_and_b32 s27, s2, 3
    s_lshl_b32 s27, s27, 11
    s_add_u32 s26, s26, s27
    v_add_u32 v17, s26, v17
    v_cmp_gt_u32 vcc, 8, v0
    v_bfrev_b32 v18, -2
    s_nop 0
    v_cndmask_b32 v17, v18, v17, vcc
    s_mov_b64 s[68:69], s[38:39]
    s_mov_b32 s70, 0x800000
    s_mov_b32 s71, 0x20000
    s_waitcnt vmcnt(3)
    v_mfma_f32_16x16x32_bf16 v[24:27], v[84:87], v[208:211], 0
    ds_read_b64_tr_b16 v[102:103], v3 offset:1536
    s_mov_b32 s26, 0x180000
    buffer_load_dword v18, v17, s[68:71], s26 offen
    s_waitcnt lgkmcnt(6)
    v_mfma_f32_16x16x32_bf16 v[28:31], v[88:91], v[204:207], 0
    s_mov_b32 s23, 0x8800
    buffer_load_dwordx4 v[224:227], v4, s[8:11], s23 offen offset:0 sc1
    ds_read_b64_tr_b16 v[104:105], v15 offset:544
    v_mfma_f32_16x16x32_bf16 v[32:35], v[88:91], v[208:211], 0
    ds_read_b64_tr_b16 v[106:107], v15 offset:1568
    s_mov_b32 s23, 0x1000
    buffer_load_dwordx4 v[140:143], v4, s[8:11], s23 offen offset:0 sc1
    s_waitcnt lgkmcnt(6)
    v_mfma_f32_16x16x32_bf16 v[36:39], v[92:95], v[204:207], 0
    s_mov_b32 s23, 0x800
    buffer_load_dwordx4 v[228:231], v4, s[8:11], s23 offen offset:1024 sc1
    ds_read_b64_tr_b16 v[84:85], v3 offset:768
    v_mfma_f32_16x16x32_bf16 v[40:43], v[92:95], v[208:211], 0
    ds_read_b64_tr_b16 v[86:87], v3 offset:1792
    s_waitcnt lgkmcnt(6)
    v_mfma_f32_16x16x32_bf16 v[44:47], v[96:99], v[204:207], 0
    s_mov_b32 s23, 0x8800
    buffer_load_dwordx4 v[232:235], v4, s[8:11], s23 offen offset:1024 sc1
    ds_read_b64_tr_b16 v[88:89], v15 offset:800
    v_mfma_f32_16x16x32_bf16 v[48:51], v[96:99], v[208:211], 0
    ds_read_b64_tr_b16 v[90:91], v15 offset:1824
    s_mov_b32 s26, 0x200000
    buffer_load_dword v18, v17, s[68:71], s26 offen
    s_waitcnt lgkmcnt(6)
    v_mfma_f32_16x16x32_bf16 v[52:55], v[100:103], v[204:207], 0
    ds_read_b64_tr_b16 v[92:93], v3 offset:8192
    v_mfma_f32_16x16x32_bf16 v[56:59], v[100:103], v[208:211], 0
    ds_read_b64_tr_b16 v[94:95], v3 offset:9216
    s_waitcnt lgkmcnt(6)
    v_mfma_f32_16x16x32_bf16 v[60:63], v[104:107], v[204:207], 0
    ds_read_b64_tr_b16 v[96:97], v15 offset:8224
    v_mfma_f32_16x16x32_bf16 v[64:67], v[104:107], v[208:211], 0
    ds_read_b64_tr_b16 v[98:99], v15 offset:9248
    s_mov_b32 s23, 0x9000
    buffer_load_dwordx4 v[144:147], v4, s[8:11], s23 offen offset:0 sc1
    s_waitcnt lgkmcnt(6)
    v_mfma_f32_16x16x32_bf16 v[68:71], v[84:87], v[204:207], 0
    ds_read_b64_tr_b16 v[100:101], v3 offset:8448
    v_mfma_f32_16x16x32_bf16 v[72:75], v[84:87], v[208:211], 0
    ds_read_b64_tr_b16 v[102:103], v3 offset:9472
    s_waitcnt lgkmcnt(6)
    v_mfma_f32_16x16x32_bf16 v[76:79], v[88:91], v[204:207], 0
    ds_read_b64_tr_b16 v[104:105], v15 offset:8480
    v_mfma_f32_16x16x32_bf16 v[80:83], v[88:91], v[208:211], 0
    ds_read_b64_tr_b16 v[106:107], v15 offset:9504
    s_waitcnt vmcnt(9) lgkmcnt(6)
    v_mfma_f32_16x16x32_bf16 v[20:23], v[92:95], v[212:215], v[20:23]
    ds_read_b64_tr_b16 v[84:85], v3 offset:8704
    s_waitcnt vmcnt(8)
    v_mfma_f32_16x16x32_bf16 v[24:27], v[92:95], v[216:219], v[24:27]
    ds_read_b64_tr_b16 v[86:87], v3 offset:9728
    s_waitcnt lgkmcnt(6)
    v_mfma_f32_16x16x32_bf16 v[28:31], v[96:99], v[212:215], v[28:31]
    ds_read_b64_tr_b16 v[88:89], v15 offset:8736
    v_mfma_f32_16x16x32_bf16 v[32:35], v[96:99], v[216:219], v[32:35]
    ds_read_b64_tr_b16 v[90:91], v15 offset:9760
    s_mov_b32 s23, 0x1000
    buffer_load_dwordx4 v[148:151], v4, s[8:11], s23 offen offset:1024 sc1
    s_waitcnt lgkmcnt(6)
    v_mfma_f32_16x16x32_bf16 v[36:39], v[100:103], v[212:215], v[36:39]
    ds_read_b64_tr_b16 v[92:93], v3 offset:8960
    v_mfma_f32_16x16x32_bf16 v[40:43], v[100:103], v[216:219], v[40:43]
    ds_read_b64_tr_b16 v[94:95], v3 offset:9984
    s_waitcnt lgkmcnt(6)
    v_mfma_f32_16x16x32_bf16 v[44:47], v[104:107], v[212:215], v[44:47]
    ds_read_b64_tr_b16 v[96:97], v15 offset:8992
    v_mfma_f32_16x16x32_bf16 v[48:51], v[104:107], v[216:219], v[48:51]
    ds_read_b64_tr_b16 v[98:99], v15 offset:10016
    s_waitcnt lgkmcnt(6)
    v_mfma_f32_16x16x32_bf16 v[52:55], v[84:87], v[212:215], v[52:55]
    v_mfma_f32_16x16x32_bf16 v[56:59], v[84:87], v[216:219], v[56:59]
    s_barrier
    ds_read_b64_tr_b16 v[100:101], v3 offset:16384
    ds_read_b64_tr_b16 v[102:103], v3 offset:17408
    s_waitcnt lgkmcnt(6)
    v_mfma_f32_16x16x32_bf16 v[60:63], v[88:91], v[212:215], v[60:63]
    ds_read_b64_tr_b16 v[104:105], v15 offset:16416
    v_mfma_f32_16x16x32_bf16 v[64:67], v[88:91], v[216:219], v[64:67]
    ds_read_b64_tr_b16 v[106:107], v15 offset:17440
    s_mov_b32 s23, 0x9000
    buffer_load_dwordx4 v[152:155], v4, s[8:11], s23 offen offset:1024 sc1
    s_waitcnt lgkmcnt(6)
    v_mfma_f32_16x16x32_bf16 v[68:71], v[92:95], v[212:215], v[68:71]
    ds_read_b64_tr_b16 v[84:85], v3 offset:16640
    v_mfma_f32_16x16x32_bf16 v[72:75], v[92:95], v[216:219], v[72:75]
    ds_read_b64_tr_b16 v[86:87], v3 offset:17664
    s_waitcnt lgkmcnt(6)
    v_mfma_f32_16x16x32_bf16 v[76:79], v[96:99], v[212:215], v[76:79]
    ds_read_b64_tr_b16 v[88:89], v15 offset:16672
    v_mfma_f32_16x16x32_bf16 v[80:83], v[96:99], v[216:219], v[80:83]
    ds_read_b64_tr_b16 v[90:91], v15 offset:17696
    s_waitcnt vmcnt(9) lgkmcnt(6)
    v_mfma_f32_16x16x32_bf16 v[20:23], v[100:103], v[220:223], v[20:23]
    ds_read_b64_tr_b16 v[92:93], v3 offset:16896
    s_waitcnt vmcnt(7)
    v_mfma_f32_16x16x32_bf16 v[24:27], v[100:103], v[224:227], v[24:27]
    ds_read_b64_tr_b16 v[94:95], v3 offset:17920
    s_sub_u32 s19, s3, 4
    s_lshl_b32 s25, s2, 2
    s_add_u32 s63, s25, s19
    s_lshr_b32 s20, s63, 8
    s_bfe_u32 s21, s63, 0x40004
    s_and_b32 s24, s63, 15
    s_lshl_b32 s20, s20, 19
    s_lshl_b32 s21, s21, 13
    s_add_u32 s20, s20, s21
    s_add_u32 s20, s20, 393216
    v_and_b32 v168, 15, v0
    v_lshrrev_b32 v169, 4, v0
    s_mov_b64 s[28:29], s[34:35]
    s_mov_b32 s30, 0x200000
    s_mov_b32 s31, 0x20000
    s_cmp_lt_u32 s24, 8
    s_cselect_b32 s30, s30, 0
    v_lshlrev_b32 v170, 8, v168
    v_lshl_add_u32 v170, v169, 3, v170
    s_and_b32 s26, s24, 1
    s_lshl_b32 s26, s26, 12
    s_add_u32 s21, s20, s26
    s_bfe_u32 s26, s24, 0x20001
    s_lshl_b32 s26, s26, 6
    s_add_u32 s21, s21, s26
    buffer_load_dwordx2 v[156:157], v170, s[28:31], s21 offen
    buffer_load_dwordx2 v[158:159], v170, s[28:31], s21 offen offset:32
    s_mov_b64 s[64:65], s[36:37]
    s_mov_b32 s66, 0x200000
    s_mov_b32 s67, 0x20000
    s_cmp_ge_u32 s24, 8
    s_cselect_b32 s66, s66, 0
    s_and_b32 s26, s24, 7
    s_lshl_b32 s26, s26, 5
    s_add_u32 s20, s20, s26
    s_add_u32 s26, s20, 4096
    v_lshlrev_b32 v171, 10, v169
    v_lshl_add_u32 v171, v168, 1, v171
    buffer_load_ushort v160, v171, s[64:67], s20 offen offset:0
    buffer_load_ushort v161, v171, s[64:67], s20 offen offset:256
    buffer_load_ushort v162, v171, s[64:67], s20 offen offset:512
    buffer_load_ushort v163, v171, s[64:67], s20 offen offset:768
    buffer_load_ushort v164, v171, s[64:67], s26 offen offset:0
    buffer_load_ushort v165, v171, s[64:67], s26 offen offset:256
    buffer_load_ushort v166, v171, s[64:67], s26 offen offset:512
    buffer_load_ushort v167, v171, s[64:67], s26 offen offset:768
    s_waitcnt lgkmcnt(6)
    v_mfma_f32_16x16x32_bf16 v[28:31], v[104:107], v[220:223], v[28:31]
    ds_read_b64_tr_b16 v[96:97], v15 offset:16928
    v_mfma_f32_16x16x32_bf16 v[32:35], v[104:107], v[224:227], v[32:35]
    ds_read_b64_tr_b16 v[98:99], v15 offset:17952
    s_mov_b32 s23, 0x1800
    buffer_load_dwordx4 v[204:207], v4, s[8:11], s23 offen offset:0 sc1
    s_waitcnt lgkmcnt(6)
    v_mfma_f32_16x16x32_bf16 v[36:39], v[84:87], v[220:223], v[36:39]
    ds_read_b64_tr_b16 v[100:101], v3 offset:17152
    v_mfma_f32_16x16x32_bf16 v[40:43], v[84:87], v[224:227], v[40:43]
    ds_read_b64_tr_b16 v[102:103], v3 offset:18176
    s_waitcnt lgkmcnt(6)
    v_mfma_f32_16x16x32_bf16 v[44:47], v[88:91], v[220:223], v[44:47]
    ds_read_b64_tr_b16 v[104:105], v15 offset:17184
    v_mfma_f32_16x16x32_bf16 v[48:51], v[88:91], v[224:227], v[48:51]
    ds_read_b64_tr_b16 v[106:107], v15 offset:18208
    s_mov_b32 s26, 0x280000
    buffer_load_dword v18, v17, s[68:71], s26 offen
    s_waitcnt lgkmcnt(6)
    v_mfma_f32_16x16x32_bf16 v[52:55], v[92:95], v[220:223], v[52:55]
    ds_read_b64_tr_b16 v[84:85], v3 offset:24576
    v_mfma_f32_16x16x32_bf16 v[56:59], v[92:95], v[224:227], v[56:59]
    ds_read_b64_tr_b16 v[86:87], v3 offset:25600
    s_waitcnt lgkmcnt(6)
    v_mfma_f32_16x16x32_bf16 v[60:63], v[96:99], v[220:223], v[60:63]
    ds_read_b64_tr_b16 v[88:89], v15 offset:24608
    v_mfma_f32_16x16x32_bf16 v[64:67], v[96:99], v[224:227], v[64:67]
    ds_read_b64_tr_b16 v[90:91], v15 offset:25632
    s_mov_b32 s23, 0x9800
    buffer_load_dwordx4 v[208:211], v4, s[8:11], s23 offen offset:0 sc1
    s_waitcnt lgkmcnt(6)
    v_mfma_f32_16x16x32_bf16 v[68:71], v[100:103], v[220:223], v[68:71]
    ds_read_b64_tr_b16 v[92:93], v3 offset:24832
    v_mfma_f32_16x16x32_bf16 v[72:75], v[100:103], v[224:227], v[72:75]
    ds_read_b64_tr_b16 v[94:95], v3 offset:25856
    s_waitcnt lgkmcnt(6)
    v_mfma_f32_16x16x32_bf16 v[76:79], v[104:107], v[220:223], v[76:79]
    ds_read_b64_tr_b16 v[96:97], v15 offset:24864
    v_mfma_f32_16x16x32_bf16 v[80:83], v[104:107], v[224:227], v[80:83]
    ds_read_b64_tr_b16 v[98:99], v15 offset:25888
    s_waitcnt vmcnt(18) lgkmcnt(6)
    v_mfma_f32_16x16x32_bf16 v[20:23], v[84:87], v[228:231], v[20:23]
    ds_read_b64_tr_b16 v[100:101], v3 offset:25088
    s_waitcnt vmcnt(17)
    v_mfma_f32_16x16x32_bf16 v[24:27], v[84:87], v[232:235], v[24:27]
    ds_read_b64_tr_b16 v[102:103], v3 offset:26112
    s_waitcnt lgkmcnt(6)
    v_mfma_f32_16x16x32_bf16 v[28:31], v[88:91], v[228:231], v[28:31]
    ds_read_b64_tr_b16 v[104:105], v15 offset:25120
    v_mfma_f32_16x16x32_bf16 v[32:35], v[88:91], v[232:235], v[32:35]
    ds_read_b64_tr_b16 v[106:107], v15 offset:26144
    s_mov_b32 s23, 0x1800
    buffer_load_dwordx4 v[212:215], v4, s[8:11], s23 offen offset:1024 sc1
    s_waitcnt lgkmcnt(6)
    v_mfma_f32_16x16x32_bf16 v[36:39], v[92:95], v[228:231], v[36:39]
    ds_read_b64_tr_b16 v[84:85], v3 offset:25344
    v_mfma_f32_16x16x32_bf16 v[40:43], v[92:95], v[232:235], v[40:43]
    ds_read_b64_tr_b16 v[86:87], v3 offset:26368
    s_waitcnt lgkmcnt(6)
    v_mfma_f32_16x16x32_bf16 v[44:47], v[96:99], v[228:231], v[44:47]
    ds_read_b64_tr_b16 v[88:89], v15 offset:25376
    v_mfma_f32_16x16x32_bf16 v[48:51], v[96:99], v[232:235], v[48:51]
    ds_read_b64_tr_b16 v[90:91], v15 offset:26400
    s_waitcnt lgkmcnt(6)
    v_mfma_f32_16x16x32_bf16 v[52:55], v[100:103], v[228:231], v[52:55]
    v_mfma_f32_16x16x32_bf16 v[56:59], v[100:103], v[232:235], v[56:59]
    s_barrier
    ds_read_b64_tr_b16 v[92:93], v3 offset:32768
    ds_read_b64_tr_b16 v[94:95], v3 offset:33792
    s_waitcnt lgkmcnt(6)
    v_mfma_f32_16x16x32_bf16 v[60:63], v[104:107], v[228:231], v[60:63]
    ds_read_b64_tr_b16 v[96:97], v15 offset:32800
    v_mfma_f32_16x16x32_bf16 v[64:67], v[104:107], v[232:235], v[64:67]
    ds_read_b64_tr_b16 v[98:99], v15 offset:33824
    s_mov_b32 s23, 0x9800
    buffer_load_dwordx4 v[216:219], v4, s[8:11], s23 offen offset:1024 sc1
    s_waitcnt lgkmcnt(6)
    v_mfma_f32_16x16x32_bf16 v[68:71], v[84:87], v[228:231], v[68:71]
    ds_read_b64_tr_b16 v[100:101], v3 offset:33024
    v_mfma_f32_16x16x32_bf16 v[72:75], v[84:87], v[232:235], v[72:75]
    ds_read_b64_tr_b16 v[102:103], v3 offset:34048
    s_waitcnt lgkmcnt(6)
    v_mfma_f32_16x16x32_bf16 v[76:79], v[88:91], v[228:231], v[76:79]
    ds_read_b64_tr_b16 v[104:105], v15 offset:33056
    v_mfma_f32_16x16x32_bf16 v[80:83], v[88:91], v[232:235], v[80:83]
    ds_read_b64_tr_b16 v[106:107], v15 offset:34080
    s_waitcnt lgkmcnt(6)
    v_mfma_f32_16x16x32_bf16 v[20:23], v[92:95], v[140:143], v[20:23]
    ds_read_b64_tr_b16 v[84:85], v3 offset:33280
    s_waitcnt vmcnt(17)
    v_mfma_f32_16x16x32_bf16 v[24:27], v[92:95], v[144:147], v[24:27]
    ds_read_b64_tr_b16 v[86:87], v3 offset:34304
    s_waitcnt lgkmcnt(6)
    v_mfma_f32_16x16x32_bf16 v[28:31], v[96:99], v[140:143], v[28:31]
    ds_read_b64_tr_b16 v[88:89], v15 offset:33312
    v_mfma_f32_16x16x32_bf16 v[32:35], v[96:99], v[144:147], v[32:35]
    ds_read_b64_tr_b16 v[90:91], v15 offset:34336
    s_mov_b32 s23, 0x2000
    buffer_load_dwordx4 v[220:223], v4, s[8:11], s23 offen offset:0 sc1
    s_waitcnt lgkmcnt(6)
    v_mfma_f32_16x16x32_bf16 v[36:39], v[100:103], v[140:143], v[36:39]
    ds_read_b64_tr_b16 v[92:93], v3 offset:33536
    v_mfma_f32_16x16x32_bf16 v[40:43], v[100:103], v[144:147], v[40:43]
    ds_read_b64_tr_b16 v[94:95], v3 offset:34560
    s_waitcnt lgkmcnt(6)
    v_mfma_f32_16x16x32_bf16 v[44:47], v[104:107], v[140:143], v[44:47]
    ds_read_b64_tr_b16 v[96:97], v15 offset:33568
    v_mfma_f32_16x16x32_bf16 v[48:51], v[104:107], v[144:147], v[48:51]
    ds_read_b64_tr_b16 v[98:99], v15 offset:34592
    s_mov_b32 s26, 0x300000
    buffer_load_dword v18, v17, s[68:71], s26 offen
    s_waitcnt lgkmcnt(6)
    v_mfma_f32_16x16x32_bf16 v[52:55], v[84:87], v[140:143], v[52:55]
    ds_read_b64_tr_b16 v[100:101], v3 offset:40960
    v_mfma_f32_16x16x32_bf16 v[56:59], v[84:87], v[144:147], v[56:59]
    ds_read_b64_tr_b16 v[102:103], v3 offset:41984
    s_waitcnt lgkmcnt(6)
    v_mfma_f32_16x16x32_bf16 v[60:63], v[88:91], v[140:143], v[60:63]
    ds_read_b64_tr_b16 v[104:105], v15 offset:40992
    v_mfma_f32_16x16x32_bf16 v[64:67], v[88:91], v[144:147], v[64:67]
    ds_read_b64_tr_b16 v[106:107], v15 offset:42016
    s_mov_b32 s23, 0xa000
    buffer_load_dwordx4 v[224:227], v4, s[8:11], s23 offen offset:0 sc1
    s_waitcnt lgkmcnt(6)
    v_mfma_f32_16x16x32_bf16 v[68:71], v[92:95], v[140:143], v[68:71]
    ds_read_b64_tr_b16 v[84:85], v3 offset:41216
    v_mfma_f32_16x16x32_bf16 v[72:75], v[92:95], v[144:147], v[72:75]
    ds_read_b64_tr_b16 v[86:87], v3 offset:42240
    s_waitcnt lgkmcnt(6)
    v_mfma_f32_16x16x32_bf16 v[76:79], v[96:99], v[140:143], v[76:79]
    ds_read_b64_tr_b16 v[88:89], v15 offset:41248
    v_mfma_f32_16x16x32_bf16 v[80:83], v[96:99], v[144:147], v[80:83]
    ds_read_b64_tr_b16 v[90:91], v15 offset:42272
    s_waitcnt vmcnt(19) lgkmcnt(6)
    v_mfma_f32_16x16x32_bf16 v[20:23], v[100:103], v[148:151], v[20:23]
    ds_read_b64_tr_b16 v[92:93], v3 offset:41472
    s_waitcnt vmcnt(18)
    v_mfma_f32_16x16x32_bf16 v[24:27], v[100:103], v[152:155], v[24:27]
    ds_read_b64_tr_b16 v[94:95], v3 offset:42496
    s_waitcnt lgkmcnt(6)
    v_mfma_f32_16x16x32_bf16 v[28:31], v[104:107], v[148:151], v[28:31]
    ds_read_b64_tr_b16 v[96:97], v15 offset:41504
    v_mfma_f32_16x16x32_bf16 v[32:35], v[104:107], v[152:155], v[32:35]
    ds_read_b64_tr_b16 v[98:99], v15 offset:42528
    s_mov_b32 s23, 0x2000
    buffer_load_dwordx4 v[228:231], v4, s[8:11], s23 offen offset:1024 sc1
    s_waitcnt lgkmcnt(6)
    v_mfma_f32_16x16x32_bf16 v[36:39], v[84:87], v[148:151], v[36:39]
    ds_read_b64_tr_b16 v[100:101], v3 offset:41728
    v_mfma_f32_16x16x32_bf16 v[40:43], v[84:87], v[152:155], v[40:43]
    ds_read_b64_tr_b16 v[102:103], v3 offset:42752
    s_waitcnt lgkmcnt(6)
    v_mfma_f32_16x16x32_bf16 v[44:47], v[88:91], v[148:151], v[44:47]
    ds_read_b64_tr_b16 v[104:105], v15 offset:41760
    v_mfma_f32_16x16x32_bf16 v[48:51], v[88:91], v[152:155], v[48:51]
    ds_read_b64_tr_b16 v[106:107], v15 offset:42784
    s_waitcnt lgkmcnt(6)
    v_mfma_f32_16x16x32_bf16 v[52:55], v[92:95], v[148:151], v[52:55]
    v_mfma_f32_16x16x32_bf16 v[56:59], v[92:95], v[152:155], v[56:59]
    s_barrier
    ds_read_b64_tr_b16 v[84:85], v3 offset:49152
    ds_read_b64_tr_b16 v[86:87], v3 offset:50176
    s_waitcnt lgkmcnt(6)
    v_mfma_f32_16x16x32_bf16 v[60:63], v[96:99], v[148:151], v[60:63]
    ds_read_b64_tr_b16 v[88:89], v15 offset:49184
    v_mfma_f32_16x16x32_bf16 v[64:67], v[96:99], v[152:155], v[64:67]
    ds_read_b64_tr_b16 v[90:91], v15 offset:50208
    s_mov_b32 s23, 0xa000
    buffer_load_dwordx4 v[232:235], v4, s[8:11], s23 offen offset:1024 sc1
    s_waitcnt lgkmcnt(6)
    v_mfma_f32_16x16x32_bf16 v[68:71], v[100:103], v[148:151], v[68:71]
    ds_read_b64_tr_b16 v[92:93], v3 offset:49408
    v_mfma_f32_16x16x32_bf16 v[72:75], v[100:103], v[152:155], v[72:75]
    ds_read_b64_tr_b16 v[94:95], v3 offset:50432
    s_waitcnt lgkmcnt(6)
    v_mfma_f32_16x16x32_bf16 v[76:79], v[104:107], v[148:151], v[76:79]
    ds_read_b64_tr_b16 v[96:97], v15 offset:49440
    v_mfma_f32_16x16x32_bf16 v[80:83], v[104:107], v[152:155], v[80:83]
    ds_read_b64_tr_b16 v[98:99], v15 offset:50464
    s_waitcnt vmcnt(9) lgkmcnt(6)
    v_mfma_f32_16x16x32_bf16 v[20:23], v[84:87], v[204:207], v[20:23]
    ds_read_b64_tr_b16 v[100:101], v3 offset:49664
    s_waitcnt vmcnt(7)
    v_mfma_f32_16x16x32_bf16 v[24:27], v[84:87], v[208:211], v[24:27]
    ds_read_b64_tr_b16 v[102:103], v3 offset:50688
    s_mov_b32 s26, 0x3e0293ee
    v_lshlrev_b32 v168, 16, v156
    v_and_b32 v169, 0xffff0000, v156
    v_mul_f32 v168, s26, v168
    v_mul_f32 v169, s26, v169
    v_cvt_pk_bf16_f32 v156, v168, v169
    v_lshlrev_b32 v170, 16, v157
    v_and_b32 v171, 0xffff0000, v157
    v_mul_f32 v170, s26, v170
    v_mul_f32 v171, s26, v171
    v_cvt_pk_bf16_f32 v157, v170, v171
    v_lshlrev_b32 v168, 16, v158
    v_and_b32 v169, 0xffff0000, v158
    v_mul_f32 v168, s26, v168
    v_mul_f32 v169, s26, v169
    v_cvt_pk_bf16_f32 v158, v168, v169
    v_lshlrev_b32 v170, 16, v159
    v_and_b32 v171, 0xffff0000, v159
    v_mul_f32 v170, s26, v170
    v_mul_f32 v171, s26, v171
    v_cvt_pk_bf16_f32 v159, v170, v171
    v_lshl_or_b32 v160, v161, 16, v160
    v_or_b32 v156, v156, v160
    v_lshl_or_b32 v162, v163, 16, v162
    v_or_b32 v157, v157, v162
    v_lshl_or_b32 v164, v165, 16, v164
    v_or_b32 v158, v158, v164
    v_lshl_or_b32 v166, v167, 16, v166
    v_or_b32 v159, v159, v166
    s_lshl_b32 s27, s63, 10
    s_add_u32 s27, s27, 0x400000
    buffer_store_dwordx4 v[156:159], v1, s[8:11], s27 offen sc1
    s_waitcnt lgkmcnt(6)
    v_mfma_f32_16x16x32_bf16 v[28:31], v[88:91], v[204:207], v[28:31]
    ds_read_b64_tr_b16 v[104:105], v15 offset:49696
    v_mfma_f32_16x16x32_bf16 v[32:35], v[88:91], v[208:211], v[32:35]
    ds_read_b64_tr_b16 v[106:107], v15 offset:50720
    s_mov_b32 s23, 0x2800
    buffer_load_dwordx4 v[140:143], v4, s[8:11], s23 offen offset:0 sc1
    s_waitcnt lgkmcnt(6)
    v_mfma_f32_16x16x32_bf16 v[36:39], v[92:95], v[204:207], v[36:39]
    ds_read_b64_tr_b16 v[84:85], v3 offset:49920
    v_mfma_f32_16x16x32_bf16 v[40:43], v[92:95], v[208:211], v[40:43]
    ds_read_b64_tr_b16 v[86:87], v3 offset:50944
    s_waitcnt lgkmcnt(6)
    v_mfma_f32_16x16x32_bf16 v[44:47], v[96:99], v[204:207], v[44:47]
    ds_read_b64_tr_b16 v[88:89], v15 offset:49952
    v_mfma_f32_16x16x32_bf16 v[48:51], v[96:99], v[208:211], v[48:51]
    ds_read_b64_tr_b16 v[90:91], v15 offset:50976
    s_mov_b32 s26, 0x380000
    buffer_load_dword v18, v17, s[68:71], s26 offen
    s_waitcnt lgkmcnt(6)
    v_mfma_f32_16x16x32_bf16 v[52:55], v[100:103], v[204:207], v[52:55]
    ds_read_b64_tr_b16 v[92:93], v3 offset:57344
    v_mfma_f32_16x16x32_bf16 v[56:59], v[100:103], v[208:211], v[56:59]
    ds_read_b64_tr_b16 v[94:95], v3 offset:58368
    s_waitcnt lgkmcnt(6)
    v_mfma_f32_16x16x32_bf16 v[60:63], v[104:107], v[204:207], v[60:63]
    ds_read_b64_tr_b16 v[96:97], v15 offset:57376
    v_mfma_f32_16x16x32_bf16 v[64:67], v[104:107], v[208:211], v[64:67]
    ds_read_b64_tr_b16 v[98:99], v15 offset:58400
    s_mov_b32 s23, 0xa800
    buffer_load_dwordx4 v[144:147], v4, s[8:11], s23 offen offset:0 sc1
    s_waitcnt lgkmcnt(6)
    v_mfma_f32_16x16x32_bf16 v[68:71], v[84:87], v[204:207], v[68:71]
    ds_read_b64_tr_b16 v[100:101], v3 offset:57600
    v_mfma_f32_16x16x32_bf16 v[72:75], v[84:87], v[208:211], v[72:75]
    ds_read_b64_tr_b16 v[102:103], v3 offset:58624
    s_waitcnt lgkmcnt(6)
    v_mfma_f32_16x16x32_bf16 v[76:79], v[88:91], v[204:207], v[76:79]
    ds_read_b64_tr_b16 v[104:105], v15 offset:57632
    v_mfma_f32_16x16x32_bf16 v[80:83], v[88:91], v[208:211], v[80:83]
    ds_read_b64_tr_b16 v[106:107], v15 offset:58656
    s_waitcnt vmcnt(10) lgkmcnt(6)
    v_mfma_f32_16x16x32_bf16 v[20:23], v[92:95], v[212:215], v[20:23]
    ds_read_b64_tr_b16 v[84:85], v3 offset:57856
    s_waitcnt vmcnt(9)
    v_mfma_f32_16x16x32_bf16 v[24:27], v[92:95], v[216:219], v[24:27]
    ds_read_b64_tr_b16 v[86:87], v3 offset:58880
    s_waitcnt lgkmcnt(6)
    v_mfma_f32_16x16x32_bf16 v[28:31], v[96:99], v[212:215], v[28:31]
    ds_read_b64_tr_b16 v[88:89], v15 offset:57888
    v_mfma_f32_16x16x32_bf16 v[32:35], v[96:99], v[216:219], v[32:35]
    ds_read_b64_tr_b16 v[90:91], v15 offset:58912
    s_mov_b32 s23, 0x2800
    buffer_load_dwordx4 v[148:151], v4, s[8:11], s23 offen offset:1024 sc1
    s_waitcnt lgkmcnt(6)
    v_mfma_f32_16x16x32_bf16 v[36:39], v[100:103], v[212:215], v[36:39]
    ds_read_b64_tr_b16 v[92:93], v3 offset:58112
    v_mfma_f32_16x16x32_bf16 v[40:43], v[100:103], v[216:219], v[40:43]
    ds_read_b64_tr_b16 v[94:95], v3 offset:59136
    s_waitcnt lgkmcnt(6)
    v_mfma_f32_16x16x32_bf16 v[44:47], v[104:107], v[212:215], v[44:47]
    ds_read_b64_tr_b16 v[96:97], v15 offset:58144
    v_mfma_f32_16x16x32_bf16 v[48:51], v[104:107], v[216:219], v[48:51]
    ds_read_b64_tr_b16 v[98:99], v15 offset:59168
    s_waitcnt lgkmcnt(6)
    v_mfma_f32_16x16x32_bf16 v[52:55], v[84:87], v[212:215], v[52:55]
    v_mfma_f32_16x16x32_bf16 v[56:59], v[84:87], v[216:219], v[56:59]
    s_barrier
    ds_read_b64_tr_b16 v[100:101], v3 offset:0
    ds_read_b64_tr_b16 v[102:103], v3 offset:1024
    s_waitcnt lgkmcnt(6)
    v_mfma_f32_16x16x32_bf16 v[60:63], v[88:91], v[212:215], v[60:63]
    ds_read_b64_tr_b16 v[104:105], v15 offset:32
    v_mfma_f32_16x16x32_bf16 v[64:67], v[88:91], v[216:219], v[64:67]
    ds_read_b64_tr_b16 v[106:107], v15 offset:1056
    s_mov_b32 s23, 0xa800
    buffer_load_dwordx4 v[152:155], v4, s[8:11], s23 offen offset:1024 sc1
    s_waitcnt lgkmcnt(6)
    v_mfma_f32_16x16x32_bf16 v[68:71], v[92:95], v[212:215], v[68:71]
    ds_read_b64_tr_b16 v[84:85], v3 offset:256
    v_mfma_f32_16x16x32_bf16 v[72:75], v[92:95], v[216:219], v[72:75]
    ds_read_b64_tr_b16 v[86:87], v3 offset:1280
    s_waitcnt lgkmcnt(6)
    v_mfma_f32_16x16x32_bf16 v[76:79], v[96:99], v[212:215], v[76:79]
    ds_read_b64_tr_b16 v[88:89], v15 offset:288
    v_mfma_f32_16x16x32_bf16 v[80:83], v[96:99], v[216:219], v[80:83]
    ds_read_b64_tr_b16 v[90:91], v15 offset:1312
    s_waitcnt vmcnt(10) lgkmcnt(6)
    v_mfma_f32_16x16x32_bf16 v[20:23], v[100:103], v[220:223], v[20:23]
    ds_read_b64_tr_b16 v[92:93], v3 offset:512
    s_waitcnt vmcnt(8)
    v_mfma_f32_16x16x32_bf16 v[24:27], v[100:103], v[224:227], v[24:27]
    ds_read_b64_tr_b16 v[94:95], v3 offset:1536
    s_waitcnt lgkmcnt(6)
    v_mfma_f32_16x16x32_bf16 v[28:31], v[104:107], v[220:223], v[28:31]
    ds_read_b64_tr_b16 v[96:97], v15 offset:544
    v_mfma_f32_16x16x32_bf16 v[32:35], v[104:107], v[224:227], v[32:35]
    ds_read_b64_tr_b16 v[98:99], v15 offset:1568
    s_mov_b32 s23, 0x3000
    buffer_load_dwordx4 v[204:207], v4, s[8:11], s23 offen offset:0 sc1
    s_waitcnt lgkmcnt(6)
    v_mfma_f32_16x16x32_bf16 v[36:39], v[84:87], v[220:223], v[36:39]
    ds_read_b64_tr_b16 v[100:101], v3 offset:768
    v_mfma_f32_16x16x32_bf16 v[40:43], v[84:87], v[224:227], v[40:43]
    ds_read_b64_tr_b16 v[102:103], v3 offset:1792
    s_waitcnt lgkmcnt(6)
    v_mfma_f32_16x16x32_bf16 v[44:47], v[88:91], v[220:223], v[44:47]
    ds_read_b64_tr_b16 v[104:105], v15 offset:800
    v_mfma_f32_16x16x32_bf16 v[48:51], v[88:91], v[224:227], v[48:51]
    ds_read_b64_tr_b16 v[106:107], v15 offset:1824
    s_mov_b32 s26, 0x400000
    buffer_load_dword v18, v17, s[68:71], s26 offen
    s_waitcnt lgkmcnt(6)
    v_mfma_f32_16x16x32_bf16 v[52:55], v[92:95], v[220:223], v[52:55]
    ds_read_b64_tr_b16 v[84:85], v3 offset:8192
    v_mfma_f32_16x16x32_bf16 v[56:59], v[92:95], v[224:227], v[56:59]
    ds_read_b64_tr_b16 v[86:87], v3 offset:9216
    s_waitcnt lgkmcnt(6)
    v_mfma_f32_16x16x32_bf16 v[60:63], v[96:99], v[220:223], v[60:63]
    ds_read_b64_tr_b16 v[88:89], v15 offset:8224
    v_mfma_f32_16x16x32_bf16 v[64:67], v[96:99], v[224:227], v[64:67]
    ds_read_b64_tr_b16 v[90:91], v15 offset:9248
    s_mov_b32 s23, 0xb000
    buffer_load_dwordx4 v[208:211], v4, s[8:11], s23 offen offset:0 sc1
    s_waitcnt lgkmcnt(6)
    v_mfma_f32_16x16x32_bf16 v[68:71], v[100:103], v[220:223], v[68:71]
    ds_read_b64_tr_b16 v[92:93], v3 offset:8448
    v_mfma_f32_16x16x32_bf16 v[72:75], v[100:103], v[224:227], v[72:75]
    ds_read_b64_tr_b16 v[94:95], v3 offset:9472
    s_waitcnt lgkmcnt(6)
    v_mfma_f32_16x16x32_bf16 v[76:79], v[104:107], v[220:223], v[76:79]
    ds_read_b64_tr_b16 v[96:97], v15 offset:8480
    v_mfma_f32_16x16x32_bf16 v[80:83], v[104:107], v[224:227], v[80:83]
    ds_read_b64_tr_b16 v[98:99], v15 offset:9504
    s_waitcnt vmcnt(10) lgkmcnt(6)
    v_mfma_f32_16x16x32_bf16 v[20:23], v[84:87], v[228:231], v[20:23]
    ds_read_b64_tr_b16 v[100:101], v3 offset:8704
    s_waitcnt vmcnt(9)
    v_mfma_f32_16x16x32_bf16 v[24:27], v[84:87], v[232:235], v[24:27]
    ds_read_b64_tr_b16 v[102:103], v3 offset:9728
    s_waitcnt lgkmcnt(6)
    v_mfma_f32_16x16x32_bf16 v[28:31], v[88:91], v[228:231], v[28:31]
    ds_read_b64_tr_b16 v[104:105], v15 offset:8736
    v_mfma_f32_16x16x32_bf16 v[32:35], v[88:91], v[232:235], v[32:35]
    ds_read_b64_tr_b16 v[106:107], v15 offset:9760
    s_mov_b32 s23, 0x3000
    buffer_load_dwordx4 v[212:215], v4, s[8:11], s23 offen offset:1024 sc1
    s_waitcnt lgkmcnt(6)
    v_mfma_f32_16x16x32_bf16 v[36:39], v[92:95], v[228:231], v[36:39]
    ds_read_b64_tr_b16 v[84:85], v3 offset:8960
    v_mfma_f32_16x16x32_bf16 v[40:43], v[92:95], v[232:235], v[40:43]
    ds_read_b64_tr_b16 v[86:87], v3 offset:9984
    s_waitcnt lgkmcnt(6)
    v_mfma_f32_16x16x32_bf16 v[44:47], v[96:99], v[228:231], v[44:47]
    ds_read_b64_tr_b16 v[88:89], v15 offset:8992
    v_mfma_f32_16x16x32_bf16 v[48:51], v[96:99], v[232:235], v[48:51]
    ds_read_b64_tr_b16 v[90:91], v15 offset:10016
    s_waitcnt lgkmcnt(6)
    v_mfma_f32_16x16x32_bf16 v[52:55], v[100:103], v[228:231], v[52:55]
    v_mfma_f32_16x16x32_bf16 v[56:59], v[100:103], v[232:235], v[56:59]
    s_barrier
    ds_read_b64_tr_b16 v[92:93], v3 offset:16384
    ds_read_b64_tr_b16 v[94:95], v3 offset:17408
    s_waitcnt lgkmcnt(6)
    v_mfma_f32_16x16x32_bf16 v[60:63], v[104:107], v[228:231], v[60:63]
    ds_read_b64_tr_b16 v[96:97], v15 offset:16416
    v_mfma_f32_16x16x32_bf16 v[64:67], v[104:107], v[232:235], v[64:67]
    ds_read_b64_tr_b16 v[98:99], v15 offset:17440
    s_mov_b32 s23, 0xb000
    buffer_load_dwordx4 v[216:219], v4, s[8:11], s23 offen offset:1024 sc1
    s_waitcnt lgkmcnt(6)
    v_mfma_f32_16x16x32_bf16 v[68:71], v[84:87], v[228:231], v[68:71]
    ds_read_b64_tr_b16 v[100:101], v3 offset:16640
    v_mfma_f32_16x16x32_bf16 v[72:75], v[84:87], v[232:235], v[72:75]
    ds_read_b64_tr_b16 v[102:103], v3 offset:17664
    s_waitcnt lgkmcnt(6)
    v_mfma_f32_16x16x32_bf16 v[76:79], v[88:91], v[228:231], v[76:79]
    ds_read_b64_tr_b16 v[104:105], v15 offset:16672
    v_mfma_f32_16x16x32_bf16 v[80:83], v[88:91], v[232:235], v[80:83]
    ds_read_b64_tr_b16 v[106:107], v15 offset:17696
    s_waitcnt vmcnt(9) lgkmcnt(6)
    v_mfma_f32_16x16x32_bf16 v[20:23], v[92:95], v[140:143], v[20:23]
    ds_read_b64_tr_b16 v[84:85], v3 offset:16896
    s_waitcnt vmcnt(7)
    v_mfma_f32_16x16x32_bf16 v[24:27], v[92:95], v[144:147], v[24:27]
    ds_read_b64_tr_b16 v[86:87], v3 offset:17920
    s_lshl_b32 s26, s63, 2
    s_add_u32 s26, s26, 0x530000
    v_mov_b32 v168, s14
    v_mov_b32 v169, 0
    s_mov_b64 exec, 1
    buffer_store_dword v168, v169, s[8:11], s26 offen sc1
    s_mov_b64 exec, -1
    s_nop 3
    s_waitcnt lgkmcnt(6)
    v_mfma_f32_16x16x32_bf16 v[28:31], v[96:99], v[140:143], v[28:31]
    ds_read_b64_tr_b16 v[88:89], v15 offset:16928
    v_mfma_f32_16x16x32_bf16 v[32:35], v[96:99], v[144:147], v[32:35]
    ds_read_b64_tr_b16 v[90:91], v15 offset:17952
    s_mov_b32 s23, 0x3800
    buffer_load_dwordx4 v[220:223], v4, s[8:11], s23 offen offset:0 sc1
    s_waitcnt lgkmcnt(6)
    v_mfma_f32_16x16x32_bf16 v[36:39], v[100:103], v[140:143], v[36:39]
    ds_read_b64_tr_b16 v[92:93], v3 offset:17152
    v_mfma_f32_16x16x32_bf16 v[40:43], v[100:103], v[144:147], v[40:43]
    ds_read_b64_tr_b16 v[94:95], v3 offset:18176
    s_waitcnt lgkmcnt(6)
    v_mfma_f32_16x16x32_bf16 v[44:47], v[104:107], v[140:143], v[44:47]
    ds_read_b64_tr_b16 v[96:97], v15 offset:17184
    v_mfma_f32_16x16x32_bf16 v[48:51], v[104:107], v[144:147], v[48:51]
    ds_read_b64_tr_b16 v[98:99], v15 offset:18208
    s_mov_b32 s26, 0x480000
    buffer_load_dword v18, v17, s[68:71], s26 offen
    s_waitcnt lgkmcnt(6)
    v_mfma_f32_16x16x32_bf16 v[52:55], v[84:87], v[140:143], v[52:55]
    ds_read_b64_tr_b16 v[100:101], v3 offset:24576
    v_mfma_f32_16x16x32_bf16 v[56:59], v[84:87], v[144:147], v[56:59]
    ds_read_b64_tr_b16 v[102:103], v3 offset:25600
    s_waitcnt lgkmcnt(6)
    v_mfma_f32_16x16x32_bf16 v[60:63], v[88:91], v[140:143], v[60:63]
    ds_read_b64_tr_b16 v[104:105], v15 offset:24608
    v_mfma_f32_16x16x32_bf16 v[64:67], v[88:91], v[144:147], v[64:67]
    ds_read_b64_tr_b16 v[106:107], v15 offset:25632
    s_mov_b32 s23, 0xb800
    buffer_load_dwordx4 v[224:227], v4, s[8:11], s23 offen offset:0 sc1
    s_waitcnt lgkmcnt(6)
    v_mfma_f32_16x16x32_bf16 v[68:71], v[92:95], v[140:143], v[68:71]
    ds_read_b64_tr_b16 v[84:85], v3 offset:24832
    v_mfma_f32_16x16x32_bf16 v[72:75], v[92:95], v[144:147], v[72:75]
    ds_read_b64_tr_b16 v[86:87], v3 offset:25856
    s_waitcnt lgkmcnt(6)
    v_mfma_f32_16x16x32_bf16 v[76:79], v[96:99], v[140:143], v[76:79]
    ds_read_b64_tr_b16 v[88:89], v15 offset:24864
    v_mfma_f32_16x16x32_bf16 v[80:83], v[96:99], v[144:147], v[80:83]
    ds_read_b64_tr_b16 v[90:91], v15 offset:25888
    s_waitcnt vmcnt(10) lgkmcnt(6)
    v_mfma_f32_16x16x32_bf16 v[20:23], v[100:103], v[148:151], v[20:23]
    ds_read_b64_tr_b16 v[92:93], v3 offset:25088
    s_waitcnt vmcnt(9)
    v_mfma_f32_16x16x32_bf16 v[24:27], v[100:103], v[152:155], v[24:27]
    ds_read_b64_tr_b16 v[94:95], v3 offset:26112
    s_waitcnt lgkmcnt(6)
    v_mfma_f32_16x16x32_bf16 v[28:31], v[104:107], v[148:151], v[28:31]
    ds_read_b64_tr_b16 v[96:97], v15 offset:25120
    v_mfma_f32_16x16x32_bf16 v[32:35], v[104:107], v[152:155], v[32:35]
    ds_read_b64_tr_b16 v[98:99], v15 offset:26144
    s_mov_b32 s23, 0x3800
    buffer_load_dwordx4 v[228:231], v4, s[8:11], s23 offen offset:1024 sc1
    s_waitcnt lgkmcnt(6)
    v_mfma_f32_16x16x32_bf16 v[36:39], v[84:87], v[148:151], v[36:39]
    ds_read_b64_tr_b16 v[100:101], v3 offset:25344
    v_mfma_f32_16x16x32_bf16 v[40:43], v[84:87], v[152:155], v[40:43]
    ds_read_b64_tr_b16 v[102:103], v3 offset:26368
    s_waitcnt lgkmcnt(6)
    v_mfma_f32_16x16x32_bf16 v[44:47], v[88:91], v[148:151], v[44:47]
    ds_read_b64_tr_b16 v[104:105], v15 offset:25376
    v_mfma_f32_16x16x32_bf16 v[48:51], v[88:91], v[152:155], v[48:51]
    ds_read_b64_tr_b16 v[106:107], v15 offset:26400
    s_waitcnt lgkmcnt(6)
    v_mfma_f32_16x16x32_bf16 v[52:55], v[92:95], v[148:151], v[52:55]
    v_mfma_f32_16x16x32_bf16 v[56:59], v[92:95], v[152:155], v[56:59]
    s_barrier
    ds_read_b64_tr_b16 v[84:85], v3 offset:32768
    ds_read_b64_tr_b16 v[86:87], v3 offset:33792
    s_waitcnt lgkmcnt(6)
    v_mfma_f32_16x16x32_bf16 v[60:63], v[96:99], v[148:151], v[60:63]
    ds_read_b64_tr_b16 v[88:89], v15 offset:32800
    v_mfma_f32_16x16x32_bf16 v[64:67], v[96:99], v[152:155], v[64:67]
    ds_read_b64_tr_b16 v[90:91], v15 offset:33824
    s_mov_b32 s23, 0xb800
    buffer_load_dwordx4 v[232:235], v4, s[8:11], s23 offen offset:1024 sc1
    s_waitcnt lgkmcnt(6)
    v_mfma_f32_16x16x32_bf16 v[68:71], v[100:103], v[148:151], v[68:71]
    ds_read_b64_tr_b16 v[92:93], v3 offset:33024
    v_mfma_f32_16x16x32_bf16 v[72:75], v[100:103], v[152:155], v[72:75]
    ds_read_b64_tr_b16 v[94:95], v3 offset:34048
    s_waitcnt lgkmcnt(6)
    v_mfma_f32_16x16x32_bf16 v[76:79], v[104:107], v[148:151], v[76:79]
    ds_read_b64_tr_b16 v[96:97], v15 offset:33056
    v_mfma_f32_16x16x32_bf16 v[80:83], v[104:107], v[152:155], v[80:83]
    ds_read_b64_tr_b16 v[98:99], v15 offset:34080
    s_waitcnt vmcnt(10) lgkmcnt(6)
    v_mfma_f32_16x16x32_bf16 v[20:23], v[84:87], v[204:207], v[20:23]
    ds_read_b64_tr_b16 v[100:101], v3 offset:33280
    s_waitcnt vmcnt(8)
    v_mfma_f32_16x16x32_bf16 v[24:27], v[84:87], v[208:211], v[24:27]
    ds_read_b64_tr_b16 v[102:103], v3 offset:34304
    s_waitcnt lgkmcnt(6)
    v_mfma_f32_16x16x32_bf16 v[28:31], v[88:91], v[204:207], v[28:31]
    ds_read_b64_tr_b16 v[104:105], v15 offset:33312
    v_mfma_f32_16x16x32_bf16 v[32:35], v[88:91], v[208:211], v[32:35]
    ds_read_b64_tr_b16 v[106:107], v15 offset:34336
    s_mov_b32 s23, 0x4000
    buffer_load_dwordx4 v[140:143], v4, s[8:11], s23 offen offset:0 sc1
    s_waitcnt lgkmcnt(6)
    v_mfma_f32_16x16x32_bf16 v[36:39], v[92:95], v[204:207], v[36:39]
    ds_read_b64_tr_b16 v[84:85], v3 offset:33536
    v_mfma_f32_16x16x32_bf16 v[40:43], v[92:95], v[208:211], v[40:43]
    ds_read_b64_tr_b16 v[86:87], v3 offset:34560
    s_waitcnt lgkmcnt(6)
    v_mfma_f32_16x16x32_bf16 v[44:47], v[96:99], v[204:207], v[44:47]
    ds_read_b64_tr_b16 v[88:89], v15 offset:33568
    v_mfma_f32_16x16x32_bf16 v[48:51], v[96:99], v[208:211], v[48:51]
    ds_read_b64_tr_b16 v[90:91], v15 offset:34592
    s_mov_b32 s26, 0x500000
    buffer_load_dword v18, v17, s[68:71], s26 offen
    s_waitcnt lgkmcnt(6)
    v_mfma_f32_16x16x32_bf16 v[52:55], v[100:103], v[204:207], v[52:55]
    ds_read_b64_tr_b16 v[92:93], v3 offset:40960
    v_mfma_f32_16x16x32_bf16 v[56:59], v[100:103], v[208:211], v[56:59]
    ds_read_b64_tr_b16 v[94:95], v3 offset:41984
    s_waitcnt lgkmcnt(6)
    v_mfma_f32_16x16x32_bf16 v[60:63], v[104:107], v[204:207], v[60:63]
    ds_read_b64_tr_b16 v[96:97], v15 offset:40992
    v_mfma_f32_16x16x32_bf16 v[64:67], v[104:107], v[208:211], v[64:67]
    ds_read_b64_tr_b16 v[98:99], v15 offset:42016
    s_mov_b32 s23, 0xc000
    buffer_load_dwordx4 v[144:147], v4, s[8:11], s23 offen offset:0 sc1
    s_waitcnt lgkmcnt(6)
    v_mfma_f32_16x16x32_bf16 v[68:71], v[84:87], v[204:207], v[68:71]
    ds_read_b64_tr_b16 v[100:101], v3 offset:41216
    v_mfma_f32_16x16x32_bf16 v[72:75], v[84:87], v[208:211], v[72:75]
    ds_read_b64_tr_b16 v[102:103], v3 offset:42240
    s_waitcnt lgkmcnt(6)
    v_mfma_f32_16x16x32_bf16 v[76:79], v[88:91], v[204:207], v[76:79]
    ds_read_b64_tr_b16 v[104:105], v15 offset:41248
    v_mfma_f32_16x16x32_bf16 v[80:83], v[88:91], v[208:211], v[80:83]
    ds_read_b64_tr_b16 v[106:107], v15 offset:42272
    s_waitcnt vmcnt(10) lgkmcnt(6)
    v_mfma_f32_16x16x32_bf16 v[20:23], v[92:95], v[212:215], v[20:23]
    ds_read_b64_tr_b16 v[84:85], v3 offset:41472
    s_waitcnt vmcnt(9)
    v_mfma_f32_16x16x32_bf16 v[24:27], v[92:95], v[216:219], v[24:27]
    ds_read_b64_tr_b16 v[86:87], v3 offset:42496
    s_waitcnt lgkmcnt(6)
    v_mfma_f32_16x16x32_bf16 v[28:31], v[96:99], v[212:215], v[28:31]
    ds_read_b64_tr_b16 v[88:89], v15 offset:41504
    v_mfma_f32_16x16x32_bf16 v[32:35], v[96:99], v[216:219], v[32:35]
    ds_read_b64_tr_b16 v[90:91], v15 offset:42528
    s_mov_b32 s23, 0x4000
    buffer_load_dwordx4 v[148:151], v4, s[8:11], s23 offen offset:1024 sc1
    s_waitcnt lgkmcnt(6)
    v_mfma_f32_16x16x32_bf16 v[36:39], v[100:103], v[212:215], v[36:39]
    ds_read_b64_tr_b16 v[92:93], v3 offset:41728
    v_mfma_f32_16x16x32_bf16 v[40:43], v[100:103], v[216:219], v[40:43]
    ds_read_b64_tr_b16 v[94:95], v3 offset:42752
    s_waitcnt lgkmcnt(6)
    v_mfma_f32_16x16x32_bf16 v[44:47], v[104:107], v[212:215], v[44:47]
    ds_read_b64_tr_b16 v[96:97], v15 offset:41760
    v_mfma_f32_16x16x32_bf16 v[48:51], v[104:107], v[216:219], v[48:51]
    ds_read_b64_tr_b16 v[98:99], v15 offset:42784
    s_waitcnt lgkmcnt(6)
    v_mfma_f32_16x16x32_bf16 v[52:55], v[84:87], v[212:215], v[52:55]
    v_mfma_f32_16x16x32_bf16 v[56:59], v[84:87], v[216:219], v[56:59]
    s_barrier
    ds_read_b64_tr_b16 v[100:101], v3 offset:49152
    ds_read_b64_tr_b16 v[102:103], v3 offset:50176
    s_waitcnt lgkmcnt(6)
    v_mfma_f32_16x16x32_bf16 v[60:63], v[88:91], v[212:215], v[60:63]
    ds_read_b64_tr_b16 v[104:105], v15 offset:49184
    v_mfma_f32_16x16x32_bf16 v[64:67], v[88:91], v[216:219], v[64:67]
    ds_read_b64_tr_b16 v[106:107], v15 offset:50208
    s_mov_b32 s23, 0xc000
    buffer_load_dwordx4 v[152:155], v4, s[8:11], s23 offen offset:1024 sc1
    s_waitcnt lgkmcnt(6)
    v_mfma_f32_16x16x32_bf16 v[68:71], v[92:95], v[212:215], v[68:71]
    ds_read_b64_tr_b16 v[84:85], v3 offset:49408
    v_mfma_f32_16x16x32_bf16 v[72:75], v[92:95], v[216:219], v[72:75]
    ds_read_b64_tr_b16 v[86:87], v3 offset:50432
    s_waitcnt lgkmcnt(6)
    v_mfma_f32_16x16x32_bf16 v[76:79], v[96:99], v[212:215], v[76:79]
    ds_read_b64_tr_b16 v[88:89], v15 offset:49440
    v_mfma_f32_16x16x32_bf16 v[80:83], v[96:99], v[216:219], v[80:83]
    ds_read_b64_tr_b16 v[90:91], v15 offset:50464
    s_waitcnt vmcnt(9) lgkmcnt(6)
    v_mfma_f32_16x16x32_bf16 v[20:23], v[100:103], v[220:223], v[20:23]
    ds_read_b64_tr_b16 v[92:93], v3 offset:49664
    s_waitcnt vmcnt(7)
    v_mfma_f32_16x16x32_bf16 v[24:27], v[100:103], v[224:227], v[24:27]
    ds_read_b64_tr_b16 v[94:95], v3 offset:50688
    s_waitcnt lgkmcnt(6)
    v_mfma_f32_16x16x32_bf16 v[28:31], v[104:107], v[220:223], v[28:31]
    ds_read_b64_tr_b16 v[96:97], v15 offset:49696
    v_mfma_f32_16x16x32_bf16 v[32:35], v[104:107], v[224:227], v[32:35]
    ds_read_b64_tr_b16 v[98:99], v15 offset:50720
    s_mov_b32 s23, 0x4800
    buffer_load_dwordx4 v[204:207], v4, s[8:11], s23 offen offset:0 sc1
    s_waitcnt lgkmcnt(6)
    v_mfma_f32_16x16x32_bf16 v[36:39], v[84:87], v[220:223], v[36:39]
    ds_read_b64_tr_b16 v[100:101], v3 offset:49920
    v_mfma_f32_16x16x32_bf16 v[40:43], v[84:87], v[224:227], v[40:43]
    ds_read_b64_tr_b16 v[102:103], v3 offset:50944
    s_waitcnt lgkmcnt(6)
    v_mfma_f32_16x16x32_bf16 v[44:47], v[88:91], v[220:223], v[44:47]
    ds_read_b64_tr_b16 v[104:105], v15 offset:49952
    v_mfma_f32_16x16x32_bf16 v[48:51], v[88:91], v[224:227], v[48:51]
    ds_read_b64_tr_b16 v[106:107], v15 offset:50976
    s_mov_b32 s26, 0x580000
    buffer_load_dword v18, v17, s[68:71], s26 offen
    s_waitcnt lgkmcnt(6)
    v_mfma_f32_16x16x32_bf16 v[52:55], v[92:95], v[220:223], v[52:55]
    ds_read_b64_tr_b16 v[84:85], v3 offset:57344
    v_mfma_f32_16x16x32_bf16 v[56:59], v[92:95], v[224:227], v[56:59]
    ds_read_b64_tr_b16 v[86:87], v3 offset:58368
    s_waitcnt lgkmcnt(6)
    v_mfma_f32_16x16x32_bf16 v[60:63], v[96:99], v[220:223], v[60:63]
    ds_read_b64_tr_b16 v[88:89], v15 offset:57376
    v_mfma_f32_16x16x32_bf16 v[64:67], v[96:99], v[224:227], v[64:67]
    ds_read_b64_tr_b16 v[90:91], v15 offset:58400
    s_mov_b32 s23, 0xc800
    buffer_load_dwordx4 v[208:211], v4, s[8:11], s23 offen offset:0 sc1
    s_waitcnt lgkmcnt(6)
    v_mfma_f32_16x16x32_bf16 v[68:71], v[100:103], v[220:223], v[68:71]
    ds_read_b64_tr_b16 v[92:93], v3 offset:57600
    v_mfma_f32_16x16x32_bf16 v[72:75], v[100:103], v[224:227], v[72:75]
    ds_read_b64_tr_b16 v[94:95], v3 offset:58624
    s_waitcnt lgkmcnt(6)
    v_mfma_f32_16x16x32_bf16 v[76:79], v[104:107], v[220:223], v[76:79]
    ds_read_b64_tr_b16 v[96:97], v15 offset:57632
    v_mfma_f32_16x16x32_bf16 v[80:83], v[104:107], v[224:227], v[80:83]
    ds_read_b64_tr_b16 v[98:99], v15 offset:58656
    s_waitcnt vmcnt(9) lgkmcnt(6)
    v_mfma_f32_16x16x32_bf16 v[20:23], v[84:87], v[228:231], v[20:23]
    ds_read_b64_tr_b16 v[100:101], v3 offset:57856
    s_waitcnt vmcnt(8)
    v_mfma_f32_16x16x32_bf16 v[24:27], v[84:87], v[232:235], v[24:27]
    ds_read_b64_tr_b16 v[102:103], v3 offset:58880
    s_waitcnt lgkmcnt(6)
    v_mfma_f32_16x16x32_bf16 v[28:31], v[88:91], v[228:231], v[28:31]
    ds_read_b64_tr_b16 v[104:105], v15 offset:57888
    v_mfma_f32_16x16x32_bf16 v[32:35], v[88:91], v[232:235], v[32:35]
    ds_read_b64_tr_b16 v[106:107], v15 offset:58912
    s_mov_b32 s23, 0x4800
    buffer_load_dwordx4 v[212:215], v4, s[8:11], s23 offen offset:1024 sc1
    s_waitcnt lgkmcnt(6)
    v_mfma_f32_16x16x32_bf16 v[36:39], v[92:95], v[228:231], v[36:39]
    ds_read_b64_tr_b16 v[84:85], v3 offset:58112
    v_mfma_f32_16x16x32_bf16 v[40:43], v[92:95], v[232:235], v[40:43]
    ds_read_b64_tr_b16 v[86:87], v3 offset:59136
    s_waitcnt lgkmcnt(6)
    v_mfma_f32_16x16x32_bf16 v[44:47], v[96:99], v[228:231], v[44:47]
    ds_read_b64_tr_b16 v[88:89], v15 offset:58144
    v_mfma_f32_16x16x32_bf16 v[48:51], v[96:99], v[232:235], v[48:51]
    ds_read_b64_tr_b16 v[90:91], v15 offset:59168
    s_waitcnt lgkmcnt(6)
    v_mfma_f32_16x16x32_bf16 v[52:55], v[100:103], v[228:231], v[52:55]
    v_mfma_f32_16x16x32_bf16 v[56:59], v[100:103], v[232:235], v[56:59]
    s_barrier
    ds_read_b64_tr_b16 v[92:93], v3 offset:0
    ds_read_b64_tr_b16 v[94:95], v3 offset:1024
    s_waitcnt lgkmcnt(6)
    v_mfma_f32_16x16x32_bf16 v[60:63], v[104:107], v[228:231], v[60:63]
    ds_read_b64_tr_b16 v[96:97], v15 offset:32
    v_mfma_f32_16x16x32_bf16 v[64:67], v[104:107], v[232:235], v[64:67]
    ds_read_b64_tr_b16 v[98:99], v15 offset:1056
    s_mov_b32 s23, 0xc800
    buffer_load_dwordx4 v[216:219], v4, s[8:11], s23 offen offset:1024 sc1
    s_waitcnt lgkmcnt(6)
    v_mfma_f32_16x16x32_bf16 v[68:71], v[84:87], v[228:231], v[68:71]
    ds_read_b64_tr_b16 v[100:101], v3 offset:256
    v_mfma_f32_16x16x32_bf16 v[72:75], v[84:87], v[232:235], v[72:75]
    ds_read_b64_tr_b16 v[102:103], v3 offset:1280
    s_waitcnt lgkmcnt(6)
    v_mfma_f32_16x16x32_bf16 v[76:79], v[88:91], v[228:231], v[76:79]
    ds_read_b64_tr_b16 v[104:105], v15 offset:288
    v_mfma_f32_16x16x32_bf16 v[80:83], v[88:91], v[232:235], v[80:83]
    ds_read_b64_tr_b16 v[106:107], v15 offset:1312
    s_waitcnt vmcnt(9) lgkmcnt(6)
    v_mfma_f32_16x16x32_bf16 v[20:23], v[92:95], v[140:143], v[20:23]
    ds_read_b64_tr_b16 v[84:85], v3 offset:512
    s_waitcnt vmcnt(7)
    v_mfma_f32_16x16x32_bf16 v[24:27], v[92:95], v[144:147], v[24:27]
    ds_read_b64_tr_b16 v[86:87], v3 offset:1536
    s_waitcnt lgkmcnt(6)
    v_mfma_f32_16x16x32_bf16 v[28:31], v[96:99], v[140:143], v[28:31]
    ds_read_b64_tr_b16 v[88:89], v15 offset:544
    v_mfma_f32_16x16x32_bf16 v[32:35], v[96:99], v[144:147], v[32:35]
    ds_read_b64_tr_b16 v[90:91], v15 offset:1568
    s_mov_b32 s23, 0x5000
    buffer_load_dwordx4 v[220:223], v4, s[8:11], s23 offen offset:0 sc1
    s_waitcnt lgkmcnt(6)
    v_mfma_f32_16x16x32_bf16 v[36:39], v[100:103], v[140:143], v[36:39]
    ds_read_b64_tr_b16 v[92:93], v3 offset:768
    v_mfma_f32_16x16x32_bf16 v[40:43], v[100:103], v[144:147], v[40:43]
    ds_read_b64_tr_b16 v[94:95], v3 offset:1792
    s_waitcnt lgkmcnt(6)
    v_mfma_f32_16x16x32_bf16 v[44:47], v[104:107], v[140:143], v[44:47]
    ds_read_b64_tr_b16 v[96:97], v15 offset:800
    v_mfma_f32_16x16x32_bf16 v[48:51], v[104:107], v[144:147], v[48:51]
    ds_read_b64_tr_b16 v[98:99], v15 offset:1824
    s_mov_b32 s26, 0x600000
    buffer_load_dword v18, v17, s[68:71], s26 offen
    s_waitcnt lgkmcnt(6)
    v_mfma_f32_16x16x32_bf16 v[52:55], v[84:87], v[140:143], v[52:55]
    ds_read_b64_tr_b16 v[100:101], v3 offset:8192
    v_mfma_f32_16x16x32_bf16 v[56:59], v[84:87], v[144:147], v[56:59]
    ds_read_b64_tr_b16 v[102:103], v3 offset:9216
    s_waitcnt lgkmcnt(6)
    v_mfma_f32_16x16x32_bf16 v[60:63], v[88:91], v[140:143], v[60:63]
    ds_read_b64_tr_b16 v[104:105], v15 offset:8224
    v_mfma_f32_16x16x32_bf16 v[64:67], v[88:91], v[144:147], v[64:67]
    ds_read_b64_tr_b16 v[106:107], v15 offset:9248
    s_mov_b32 s23, 0xd000
    buffer_load_dwordx4 v[224:227], v4, s[8:11], s23 offen offset:0 sc1
    s_waitcnt lgkmcnt(6)
    v_mfma_f32_16x16x32_bf16 v[68:71], v[92:95], v[140:143], v[68:71]
    ds_read_b64_tr_b16 v[84:85], v3 offset:8448
    v_mfma_f32_16x16x32_bf16 v[72:75], v[92:95], v[144:147], v[72:75]
    ds_read_b64_tr_b16 v[86:87], v3 offset:9472
    s_waitcnt lgkmcnt(6)
    v_mfma_f32_16x16x32_bf16 v[76:79], v[96:99], v[140:143], v[76:79]
    ds_read_b64_tr_b16 v[88:89], v15 offset:8480
    v_mfma_f32_16x16x32_bf16 v[80:83], v[96:99], v[144:147], v[80:83]
    ds_read_b64_tr_b16 v[90:91], v15 offset:9504
    s_waitcnt vmcnt(9) lgkmcnt(6)
    v_mfma_f32_16x16x32_bf16 v[20:23], v[100:103], v[148:151], v[20:23]
    ds_read_b64_tr_b16 v[92:93], v3 offset:8704
    s_waitcnt vmcnt(8)
    v_mfma_f32_16x16x32_bf16 v[24:27], v[100:103], v[152:155], v[24:27]
    ds_read_b64_tr_b16 v[94:95], v3 offset:9728
    s_waitcnt lgkmcnt(6)
    v_mfma_f32_16x16x32_bf16 v[28:31], v[104:107], v[148:151], v[28:31]
    ds_read_b64_tr_b16 v[96:97], v15 offset:8736
    v_mfma_f32_16x16x32_bf16 v[32:35], v[104:107], v[152:155], v[32:35]
    ds_read_b64_tr_b16 v[98:99], v15 offset:9760
    s_mov_b32 s23, 0x5000
    buffer_load_dwordx4 v[228:231], v4, s[8:11], s23 offen offset:1024 sc1
    s_waitcnt lgkmcnt(6)
    v_mfma_f32_16x16x32_bf16 v[36:39], v[84:87], v[148:151], v[36:39]
    ds_read_b64_tr_b16 v[100:101], v3 offset:8960
    v_mfma_f32_16x16x32_bf16 v[40:43], v[84:87], v[152:155], v[40:43]
    ds_read_b64_tr_b16 v[102:103], v3 offset:9984
    s_waitcnt lgkmcnt(6)
    v_mfma_f32_16x16x32_bf16 v[44:47], v[88:91], v[148:151], v[44:47]
    ds_read_b64_tr_b16 v[104:105], v15 offset:8992
    v_mfma_f32_16x16x32_bf16 v[48:51], v[88:91], v[152:155], v[48:51]
    ds_read_b64_tr_b16 v[106:107], v15 offset:10016
    s_waitcnt lgkmcnt(6)
    v_mfma_f32_16x16x32_bf16 v[52:55], v[92:95], v[148:151], v[52:55]
    v_mfma_f32_16x16x32_bf16 v[56:59], v[92:95], v[152:155], v[56:59]
    s_barrier
    ds_read_b64_tr_b16 v[84:85], v3 offset:16384
    ds_read_b64_tr_b16 v[86:87], v3 offset:17408
    s_waitcnt lgkmcnt(6)
    v_mfma_f32_16x16x32_bf16 v[60:63], v[96:99], v[148:151], v[60:63]
    ds_read_b64_tr_b16 v[88:89], v15 offset:16416
    v_mfma_f32_16x16x32_bf16 v[64:67], v[96:99], v[152:155], v[64:67]
    ds_read_b64_tr_b16 v[90:91], v15 offset:17440
    s_mov_b32 s23, 0xd000
    buffer_load_dwordx4 v[232:235], v4, s[8:11], s23 offen offset:1024 sc1
    s_waitcnt lgkmcnt(6)
    v_mfma_f32_16x16x32_bf16 v[68:71], v[100:103], v[148:151], v[68:71]
    ds_read_b64_tr_b16 v[92:93], v3 offset:16640
    v_mfma_f32_16x16x32_bf16 v[72:75], v[100:103], v[152:155], v[72:75]
    ds_read_b64_tr_b16 v[94:95], v3 offset:17664
    s_waitcnt lgkmcnt(6)
    v_mfma_f32_16x16x32_bf16 v[76:79], v[104:107], v[148:151], v[76:79]
    ds_read_b64_tr_b16 v[96:97], v15 offset:16672
    v_mfma_f32_16x16x32_bf16 v[80:83], v[104:107], v[152:155], v[80:83]
    ds_read_b64_tr_b16 v[98:99], v15 offset:17696
    s_waitcnt vmcnt(9) lgkmcnt(6)
    v_mfma_f32_16x16x32_bf16 v[20:23], v[84:87], v[204:207], v[20:23]
    ds_read_b64_tr_b16 v[100:101], v3 offset:16896
    s_waitcnt vmcnt(7)
    v_mfma_f32_16x16x32_bf16 v[24:27], v[84:87], v[208:211], v[24:27]
    ds_read_b64_tr_b16 v[102:103], v3 offset:17920
    s_waitcnt lgkmcnt(6)
    v_mfma_f32_16x16x32_bf16 v[28:31], v[88:91], v[204:207], v[28:31]
    ds_read_b64_tr_b16 v[104:105], v15 offset:16928
    v_mfma_f32_16x16x32_bf16 v[32:35], v[88:91], v[208:211], v[32:35]
    ds_read_b64_tr_b16 v[106:107], v15 offset:17952
    s_mov_b32 s23, 0x5800
    buffer_load_dwordx4 v[140:143], v4, s[8:11], s23 offen offset:0 sc1
    s_waitcnt lgkmcnt(6)
    v_mfma_f32_16x16x32_bf16 v[36:39], v[92:95], v[204:207], v[36:39]
    ds_read_b64_tr_b16 v[84:85], v3 offset:17152
    v_mfma_f32_16x16x32_bf16 v[40:43], v[92:95], v[208:211], v[40:43]
    ds_read_b64_tr_b16 v[86:87], v3 offset:18176
    s_waitcnt lgkmcnt(6)
    v_mfma_f32_16x16x32_bf16 v[44:47], v[96:99], v[204:207], v[44:47]
    ds_read_b64_tr_b16 v[88:89], v15 offset:17184
    v_mfma_f32_16x16x32_bf16 v[48:51], v[96:99], v[208:211], v[48:51]
    ds_read_b64_tr_b16 v[90:91], v15 offset:18208
    s_mov_b32 s26, 0x680000
    buffer_load_dword v18, v17, s[68:71], s26 offen
    s_waitcnt lgkmcnt(6)
    v_mfma_f32_16x16x32_bf16 v[52:55], v[100:103], v[204:207], v[52:55]
    ds_read_b64_tr_b16 v[92:93], v3 offset:24576
    v_mfma_f32_16x16x32_bf16 v[56:59], v[100:103], v[208:211], v[56:59]
    ds_read_b64_tr_b16 v[94:95], v3 offset:25600
    s_waitcnt lgkmcnt(6)
    v_mfma_f32_16x16x32_bf16 v[60:63], v[104:107], v[204:207], v[60:63]
    ds_read_b64_tr_b16 v[96:97], v15 offset:24608
    v_mfma_f32_16x16x32_bf16 v[64:67], v[104:107], v[208:211], v[64:67]
    ds_read_b64_tr_b16 v[98:99], v15 offset:25632
    s_mov_b32 s23, 0xd800
    buffer_load_dwordx4 v[144:147], v4, s[8:11], s23 offen offset:0 sc1
    s_waitcnt lgkmcnt(6)
    v_mfma_f32_16x16x32_bf16 v[68:71], v[84:87], v[204:207], v[68:71]
    ds_read_b64_tr_b16 v[100:101], v3 offset:24832
    v_mfma_f32_16x16x32_bf16 v[72:75], v[84:87], v[208:211], v[72:75]
    ds_read_b64_tr_b16 v[102:103], v3 offset:25856
    s_waitcnt lgkmcnt(6)
    v_mfma_f32_16x16x32_bf16 v[76:79], v[88:91], v[204:207], v[76:79]
    ds_read_b64_tr_b16 v[104:105], v15 offset:24864
    v_mfma_f32_16x16x32_bf16 v[80:83], v[88:91], v[208:211], v[80:83]
    ds_read_b64_tr_b16 v[106:107], v15 offset:25888
    s_waitcnt vmcnt(9) lgkmcnt(6)
    v_mfma_f32_16x16x32_bf16 v[20:23], v[92:95], v[212:215], v[20:23]
    ds_read_b64_tr_b16 v[84:85], v3 offset:25088
    s_waitcnt vmcnt(8)
    v_mfma_f32_16x16x32_bf16 v[24:27], v[92:95], v[216:219], v[24:27]
    ds_read_b64_tr_b16 v[86:87], v3 offset:26112
    s_waitcnt lgkmcnt(6)
    v_mfma_f32_16x16x32_bf16 v[28:31], v[96:99], v[212:215], v[28:31]
    ds_read_b64_tr_b16 v[88:89], v15 offset:25120
    v_mfma_f32_16x16x32_bf16 v[32:35], v[96:99], v[216:219], v[32:35]
    ds_read_b64_tr_b16 v[90:91], v15 offset:26144
    s_mov_b32 s23, 0x5800
    buffer_load_dwordx4 v[148:151], v4, s[8:11], s23 offen offset:1024 sc1
    s_waitcnt lgkmcnt(6)
    v_mfma_f32_16x16x32_bf16 v[36:39], v[100:103], v[212:215], v[36:39]
    ds_read_b64_tr_b16 v[92:93], v3 offset:25344
    v_mfma_f32_16x16x32_bf16 v[40:43], v[100:103], v[216:219], v[40:43]
    ds_read_b64_tr_b16 v[94:95], v3 offset:26368
    s_waitcnt lgkmcnt(6)
    v_mfma_f32_16x16x32_bf16 v[44:47], v[104:107], v[212:215], v[44:47]
    ds_read_b64_tr_b16 v[96:97], v15 offset:25376
    v_mfma_f32_16x16x32_bf16 v[48:51], v[104:107], v[216:219], v[48:51]
    ds_read_b64_tr_b16 v[98:99], v15 offset:26400
    s_waitcnt lgkmcnt(6)
    v_mfma_f32_16x16x32_bf16 v[52:55], v[84:87], v[212:215], v[52:55]
    v_mfma_f32_16x16x32_bf16 v[56:59], v[84:87], v[216:219], v[56:59]
    s_barrier
    ds_read_b64_tr_b16 v[100:101], v3 offset:32768
    ds_read_b64_tr_b16 v[102:103], v3 offset:33792
    s_waitcnt lgkmcnt(6)
    v_mfma_f32_16x16x32_bf16 v[60:63], v[88:91], v[212:215], v[60:63]
    ds_read_b64_tr_b16 v[104:105], v15 offset:32800
    v_mfma_f32_16x16x32_bf16 v[64:67], v[88:91], v[216:219], v[64:67]
    ds_read_b64_tr_b16 v[106:107], v15 offset:33824
    s_mov_b32 s23, 0xd800
    buffer_load_dwordx4 v[152:155], v4, s[8:11], s23 offen offset:1024 sc1
    s_waitcnt lgkmcnt(6)
    v_mfma_f32_16x16x32_bf16 v[68:71], v[92:95], v[212:215], v[68:71]
    ds_read_b64_tr_b16 v[84:85], v3 offset:33024
    v_mfma_f32_16x16x32_bf16 v[72:75], v[92:95], v[216:219], v[72:75]
    ds_read_b64_tr_b16 v[86:87], v3 offset:34048
    s_waitcnt lgkmcnt(6)
    v_mfma_f32_16x16x32_bf16 v[76:79], v[96:99], v[212:215], v[76:79]
    ds_read_b64_tr_b16 v[88:89], v15 offset:33056
    v_mfma_f32_16x16x32_bf16 v[80:83], v[96:99], v[216:219], v[80:83]
    ds_read_b64_tr_b16 v[90:91], v15 offset:34080
    s_waitcnt vmcnt(9) lgkmcnt(6)
    v_mfma_f32_16x16x32_bf16 v[20:23], v[100:103], v[220:223], v[20:23]
    ds_read_b64_tr_b16 v[92:93], v3 offset:33280
    s_waitcnt vmcnt(7)
    v_mfma_f32_16x16x32_bf16 v[24:27], v[100:103], v[224:227], v[24:27]
    ds_read_b64_tr_b16 v[94:95], v3 offset:34304
    s_waitcnt lgkmcnt(6)
    v_mfma_f32_16x16x32_bf16 v[28:31], v[104:107], v[220:223], v[28:31]
    ds_read_b64_tr_b16 v[96:97], v15 offset:33312
    v_mfma_f32_16x16x32_bf16 v[32:35], v[104:107], v[224:227], v[32:35]
    ds_read_b64_tr_b16 v[98:99], v15 offset:34336
    s_mov_b32 s23, 0x6000
    buffer_load_dwordx4 v[204:207], v4, s[8:11], s23 offen offset:0 sc1
    s_waitcnt lgkmcnt(6)
    v_mfma_f32_16x16x32_bf16 v[36:39], v[84:87], v[220:223], v[36:39]
    ds_read_b64_tr_b16 v[100:101], v3 offset:33536
    v_mfma_f32_16x16x32_bf16 v[40:43], v[84:87], v[224:227], v[40:43]
    ds_read_b64_tr_b16 v[102:103], v3 offset:34560
    s_waitcnt lgkmcnt(6)
    v_mfma_f32_16x16x32_bf16 v[44:47], v[88:91], v[220:223], v[44:47]
    ds_read_b64_tr_b16 v[104:105], v15 offset:33568
    v_mfma_f32_16x16x32_bf16 v[48:51], v[88:91], v[224:227], v[48:51]
    ds_read_b64_tr_b16 v[106:107], v15 offset:34592
    s_mov_b32 s26, 0x700000
    buffer_load_dword v18, v17, s[68:71], s26 offen
    s_waitcnt lgkmcnt(6)
    v_mfma_f32_16x16x32_bf16 v[52:55], v[92:95], v[220:223], v[52:55]
    ds_read_b64_tr_b16 v[84:85], v3 offset:40960
    v_mfma_f32_16x16x32_bf16 v[56:59], v[92:95], v[224:227], v[56:59]
    ds_read_b64_tr_b16 v[86:87], v3 offset:41984
    s_waitcnt lgkmcnt(6)
    v_mfma_f32_16x16x32_bf16 v[60:63], v[96:99], v[220:223], v[60:63]
    ds_read_b64_tr_b16 v[88:89], v15 offset:40992
    v_mfma_f32_16x16x32_bf16 v[64:67], v[96:99], v[224:227], v[64:67]
    ds_read_b64_tr_b16 v[90:91], v15 offset:42016
    s_mov_b32 s23, 0xe000
    buffer_load_dwordx4 v[208:211], v4, s[8:11], s23 offen offset:0 sc1
    s_waitcnt lgkmcnt(6)
    v_mfma_f32_16x16x32_bf16 v[68:71], v[100:103], v[220:223], v[68:71]
    ds_read_b64_tr_b16 v[92:93], v3 offset:41216
    v_mfma_f32_16x16x32_bf16 v[72:75], v[100:103], v[224:227], v[72:75]
    ds_read_b64_tr_b16 v[94:95], v3 offset:42240
    s_waitcnt lgkmcnt(6)
    v_mfma_f32_16x16x32_bf16 v[76:79], v[104:107], v[220:223], v[76:79]
    ds_read_b64_tr_b16 v[96:97], v15 offset:41248
    v_mfma_f32_16x16x32_bf16 v[80:83], v[104:107], v[224:227], v[80:83]
    ds_read_b64_tr_b16 v[98:99], v15 offset:42272
    s_waitcnt vmcnt(9) lgkmcnt(6)
    v_mfma_f32_16x16x32_bf16 v[20:23], v[84:87], v[228:231], v[20:23]
    ds_read_b64_tr_b16 v[100:101], v3 offset:41472
    s_waitcnt vmcnt(8)
    v_mfma_f32_16x16x32_bf16 v[24:27], v[84:87], v[232:235], v[24:27]
    ds_read_b64_tr_b16 v[102:103], v3 offset:42496
    s_waitcnt lgkmcnt(6)
    v_mfma_f32_16x16x32_bf16 v[28:31], v[88:91], v[228:231], v[28:31]
    ds_read_b64_tr_b16 v[104:105], v15 offset:41504
    v_mfma_f32_16x16x32_bf16 v[32:35], v[88:91], v[232:235], v[32:35]
    ds_read_b64_tr_b16 v[106:107], v15 offset:42528
    s_mov_b32 s23, 0x6000
    buffer_load_dwordx4 v[212:215], v4, s[8:11], s23 offen offset:1024 sc1
    s_waitcnt lgkmcnt(6)
    v_mfma_f32_16x16x32_bf16 v[36:39], v[92:95], v[228:231], v[36:39]
    ds_read_b64_tr_b16 v[84:85], v3 offset:41728
    v_mfma_f32_16x16x32_bf16 v[40:43], v[92:95], v[232:235], v[40:43]
    ds_read_b64_tr_b16 v[86:87], v3 offset:42752
    s_waitcnt lgkmcnt(6)
    v_mfma_f32_16x16x32_bf16 v[44:47], v[96:99], v[228:231], v[44:47]
    ds_read_b64_tr_b16 v[88:89], v15 offset:41760
    v_mfma_f32_16x16x32_bf16 v[48:51], v[96:99], v[232:235], v[48:51]
    ds_read_b64_tr_b16 v[90:91], v15 offset:42784
    s_waitcnt lgkmcnt(6)
    v_mfma_f32_16x16x32_bf16 v[52:55], v[100:103], v[228:231], v[52:55]
    v_mfma_f32_16x16x32_bf16 v[56:59], v[100:103], v[232:235], v[56:59]
    s_barrier
    ds_read_b64_tr_b16 v[92:93], v3 offset:49152
    ds_read_b64_tr_b16 v[94:95], v3 offset:50176
    s_waitcnt lgkmcnt(6)
    v_mfma_f32_16x16x32_bf16 v[60:63], v[104:107], v[228:231], v[60:63]
    ds_read_b64_tr_b16 v[96:97], v15 offset:49184
    v_mfma_f32_16x16x32_bf16 v[64:67], v[104:107], v[232:235], v[64:67]
    ds_read_b64_tr_b16 v[98:99], v15 offset:50208
    s_mov_b32 s23, 0xe000
    buffer_load_dwordx4 v[216:219], v4, s[8:11], s23 offen offset:1024 sc1
    s_waitcnt lgkmcnt(6)
    v_mfma_f32_16x16x32_bf16 v[68:71], v[84:87], v[228:231], v[68:71]
    ds_read_b64_tr_b16 v[100:101], v3 offset:49408
    v_mfma_f32_16x16x32_bf16 v[72:75], v[84:87], v[232:235], v[72:75]
    ds_read_b64_tr_b16 v[102:103], v3 offset:50432
    s_waitcnt lgkmcnt(6)
    v_mfma_f32_16x16x32_bf16 v[76:79], v[88:91], v[228:231], v[76:79]
    ds_read_b64_tr_b16 v[104:105], v15 offset:49440
    v_mfma_f32_16x16x32_bf16 v[80:83], v[88:91], v[232:235], v[80:83]
    ds_read_b64_tr_b16 v[106:107], v15 offset:50464
    s_waitcnt vmcnt(9) lgkmcnt(6)
    v_mfma_f32_16x16x32_bf16 v[20:23], v[92:95], v[140:143], v[20:23]
    ds_read_b64_tr_b16 v[84:85], v3 offset:49664
    s_waitcnt vmcnt(7)
    v_mfma_f32_16x16x32_bf16 v[24:27], v[92:95], v[144:147], v[24:27]
    ds_read_b64_tr_b16 v[86:87], v3 offset:50688
    s_waitcnt lgkmcnt(6)
    v_mfma_f32_16x16x32_bf16 v[28:31], v[96:99], v[140:143], v[28:31]
    ds_read_b64_tr_b16 v[88:89], v15 offset:49696
    v_mfma_f32_16x16x32_bf16 v[32:35], v[96:99], v[144:147], v[32:35]
    ds_read_b64_tr_b16 v[90:91], v15 offset:50720
    s_mov_b32 s23, 0x6800
    buffer_load_dwordx4 v[220:223], v4, s[8:11], s23 offen offset:0 sc1
    s_waitcnt lgkmcnt(6)
    v_mfma_f32_16x16x32_bf16 v[36:39], v[100:103], v[140:143], v[36:39]
    ds_read_b64_tr_b16 v[92:93], v3 offset:49920
    v_mfma_f32_16x16x32_bf16 v[40:43], v[100:103], v[144:147], v[40:43]
    ds_read_b64_tr_b16 v[94:95], v3 offset:50944
    s_waitcnt lgkmcnt(6)
    v_mfma_f32_16x16x32_bf16 v[44:47], v[104:107], v[140:143], v[44:47]
    ds_read_b64_tr_b16 v[96:97], v15 offset:49952
    v_mfma_f32_16x16x32_bf16 v[48:51], v[104:107], v[144:147], v[48:51]
    ds_read_b64_tr_b16 v[98:99], v15 offset:50976
    s_mov_b32 s26, 0x780000
    buffer_load_dword v18, v17, s[68:71], s26 offen
    s_waitcnt lgkmcnt(6)
    v_mfma_f32_16x16x32_bf16 v[52:55], v[84:87], v[140:143], v[52:55]
    ds_read_b64_tr_b16 v[100:101], v3 offset:57344
    v_mfma_f32_16x16x32_bf16 v[56:59], v[84:87], v[144:147], v[56:59]
    ds_read_b64_tr_b16 v[102:103], v3 offset:58368
    s_waitcnt lgkmcnt(6)
    v_mfma_f32_16x16x32_bf16 v[60:63], v[88:91], v[140:143], v[60:63]
    ds_read_b64_tr_b16 v[104:105], v15 offset:57376
    v_mfma_f32_16x16x32_bf16 v[64:67], v[88:91], v[144:147], v[64:67]
    ds_read_b64_tr_b16 v[106:107], v15 offset:58400
    s_mov_b32 s23, 0xe800
    buffer_load_dwordx4 v[224:227], v4, s[8:11], s23 offen offset:0 sc1
    s_waitcnt lgkmcnt(6)
    v_mfma_f32_16x16x32_bf16 v[68:71], v[92:95], v[140:143], v[68:71]
    ds_read_b64_tr_b16 v[84:85], v3 offset:57600
    v_mfma_f32_16x16x32_bf16 v[72:75], v[92:95], v[144:147], v[72:75]
    ds_read_b64_tr_b16 v[86:87], v3 offset:58624
    s_waitcnt lgkmcnt(6)
    v_mfma_f32_16x16x32_bf16 v[76:79], v[96:99], v[140:143], v[76:79]
    ds_read_b64_tr_b16 v[88:89], v15 offset:57632
    v_mfma_f32_16x16x32_bf16 v[80:83], v[96:99], v[144:147], v[80:83]
    ds_read_b64_tr_b16 v[90:91], v15 offset:58656
    s_waitcnt vmcnt(9) lgkmcnt(6)
    v_mfma_f32_16x16x32_bf16 v[20:23], v[100:103], v[148:151], v[20:23]
    ds_read_b64_tr_b16 v[92:93], v3 offset:57856
    s_waitcnt vmcnt(8)
    v_mfma_f32_16x16x32_bf16 v[24:27], v[100:103], v[152:155], v[24:27]
    ds_read_b64_tr_b16 v[94:95], v3 offset:58880
    s_waitcnt lgkmcnt(6)
    v_mfma_f32_16x16x32_bf16 v[28:31], v[104:107], v[148:151], v[28:31]
    ds_read_b64_tr_b16 v[96:97], v15 offset:57888
    v_mfma_f32_16x16x32_bf16 v[32:35], v[104:107], v[152:155], v[32:35]
    ds_read_b64_tr_b16 v[98:99], v15 offset:58912
    s_mov_b32 s23, 0x6800
    buffer_load_dwordx4 v[228:231], v4, s[8:11], s23 offen offset:1024 sc1
    s_waitcnt lgkmcnt(6)
    v_mfma_f32_16x16x32_bf16 v[36:39], v[84:87], v[148:151], v[36:39]
    ds_read_b64_tr_b16 v[100:101], v3 offset:58112
    v_mfma_f32_16x16x32_bf16 v[40:43], v[84:87], v[152:155], v[40:43]
    ds_read_b64_tr_b16 v[102:103], v3 offset:59136
    s_waitcnt lgkmcnt(6)
    v_mfma_f32_16x16x32_bf16 v[44:47], v[88:91], v[148:151], v[44:47]
    ds_read_b64_tr_b16 v[104:105], v15 offset:58144
    v_mfma_f32_16x16x32_bf16 v[48:51], v[88:91], v[152:155], v[48:51]
    ds_read_b64_tr_b16 v[106:107], v15 offset:59168
    s_waitcnt lgkmcnt(6)
    v_mfma_f32_16x16x32_bf16 v[52:55], v[92:95], v[148:151], v[52:55]
    v_mfma_f32_16x16x32_bf16 v[56:59], v[92:95], v[152:155], v[56:59]
    s_barrier
    ds_read_b64_tr_b16 v[84:85], v3 offset:0
    ds_read_b64_tr_b16 v[86:87], v3 offset:1024
    s_waitcnt lgkmcnt(6)
    v_mfma_f32_16x16x32_bf16 v[60:63], v[96:99], v[148:151], v[60:63]
    ds_read_b64_tr_b16 v[88:89], v15 offset:32
    v_mfma_f32_16x16x32_bf16 v[64:67], v[96:99], v[152:155], v[64:67]
    ds_read_b64_tr_b16 v[90:91], v15 offset:1056
    s_mov_b32 s23, 0xe800
    buffer_load_dwordx4 v[232:235], v4, s[8:11], s23 offen offset:1024 sc1
    s_waitcnt lgkmcnt(6)
    v_mfma_f32_16x16x32_bf16 v[68:71], v[100:103], v[148:151], v[68:71]
    ds_read_b64_tr_b16 v[92:93], v3 offset:256
    v_mfma_f32_16x16x32_bf16 v[72:75], v[100:103], v[152:155], v[72:75]
    ds_read_b64_tr_b16 v[94:95], v3 offset:1280
    s_waitcnt lgkmcnt(6)
    v_mfma_f32_16x16x32_bf16 v[76:79], v[104:107], v[148:151], v[76:79]
    ds_read_b64_tr_b16 v[96:97], v15 offset:288
    v_mfma_f32_16x16x32_bf16 v[80:83], v[104:107], v[152:155], v[80:83]
    ds_read_b64_tr_b16 v[98:99], v15 offset:1312
    s_waitcnt vmcnt(9) lgkmcnt(6)
    v_mfma_f32_16x16x32_bf16 v[20:23], v[84:87], v[204:207], v[20:23]
    ds_read_b64_tr_b16 v[100:101], v3 offset:512
    s_waitcnt vmcnt(7)
    v_mfma_f32_16x16x32_bf16 v[24:27], v[84:87], v[208:211], v[24:27]
    ds_read_b64_tr_b16 v[102:103], v3 offset:1536
    s_waitcnt lgkmcnt(6)
    v_mfma_f32_16x16x32_bf16 v[28:31], v[88:91], v[204:207], v[28:31]
    ds_read_b64_tr_b16 v[104:105], v15 offset:544
    v_mfma_f32_16x16x32_bf16 v[32:35], v[88:91], v[208:211], v[32:35]
    ds_read_b64_tr_b16 v[106:107], v15 offset:1568
    s_mov_b32 s23, 0x7000
    buffer_load_dwordx4 v[140:143], v4, s[8:11], s23 offen offset:0 sc1
    s_waitcnt lgkmcnt(6)
    v_mfma_f32_16x16x32_bf16 v[36:39], v[92:95], v[204:207], v[36:39]
    ds_read_b64_tr_b16 v[84:85], v3 offset:768
    v_mfma_f32_16x16x32_bf16 v[40:43], v[92:95], v[208:211], v[40:43]
    ds_read_b64_tr_b16 v[86:87], v3 offset:1792
    s_waitcnt lgkmcnt(6)
    v_mfma_f32_16x16x32_bf16 v[44:47], v[96:99], v[204:207], v[44:47]
    ds_read_b64_tr_b16 v[88:89], v15 offset:800
    v_mfma_f32_16x16x32_bf16 v[48:51], v[96:99], v[208:211], v[48:51]
    ds_read_b64_tr_b16 v[90:91], v15 offset:1824
    s_waitcnt lgkmcnt(6)
    v_mfma_f32_16x16x32_bf16 v[52:55], v[100:103], v[204:207], v[52:55]
    ds_read_b64_tr_b16 v[92:93], v3 offset:8192
    v_mfma_f32_16x16x32_bf16 v[56:59], v[100:103], v[208:211], v[56:59]
    ds_read_b64_tr_b16 v[94:95], v3 offset:9216
    s_waitcnt lgkmcnt(6)
    v_mfma_f32_16x16x32_bf16 v[60:63], v[104:107], v[204:207], v[60:63]
    ds_read_b64_tr_b16 v[96:97], v15 offset:8224
    v_mfma_f32_16x16x32_bf16 v[64:67], v[104:107], v[208:211], v[64:67]
    ds_read_b64_tr_b16 v[98:99], v15 offset:9248
    s_mov_b32 s23, 0xf000
    buffer_load_dwordx4 v[144:147], v4, s[8:11], s23 offen offset:0 sc1
    s_waitcnt lgkmcnt(6)
    v_mfma_f32_16x16x32_bf16 v[68:71], v[84:87], v[204:207], v[68:71]
    ds_read_b64_tr_b16 v[100:101], v3 offset:8448
    v_mfma_f32_16x16x32_bf16 v[72:75], v[84:87], v[208:211], v[72:75]
    ds_read_b64_tr_b16 v[102:103], v3 offset:9472
    s_waitcnt lgkmcnt(6)
    v_mfma_f32_16x16x32_bf16 v[76:79], v[88:91], v[204:207], v[76:79]
    ds_read_b64_tr_b16 v[104:105], v15 offset:8480
    v_mfma_f32_16x16x32_bf16 v[80:83], v[88:91], v[208:211], v[80:83]
    ds_read_b64_tr_b16 v[106:107], v15 offset:9504
    s_waitcnt vmcnt(8) lgkmcnt(6)
    v_mfma_f32_16x16x32_bf16 v[20:23], v[92:95], v[212:215], v[20:23]
    ds_read_b64_tr_b16 v[84:85], v3 offset:8704
    s_waitcnt vmcnt(7)
    v_mfma_f32_16x16x32_bf16 v[24:27], v[92:95], v[216:219], v[24:27]
    ds_read_b64_tr_b16 v[86:87], v3 offset:9728
    s_waitcnt lgkmcnt(6)
    v_mfma_f32_16x16x32_bf16 v[28:31], v[96:99], v[212:215], v[28:31]
    ds_read_b64_tr_b16 v[88:89], v15 offset:8736
    v_mfma_f32_16x16x32_bf16 v[32:35], v[96:99], v[216:219], v[32:35]
    ds_read_b64_tr_b16 v[90:91], v15 offset:9760
    s_mov_b32 s23, 0x7000
    buffer_load_dwordx4 v[148:151], v4, s[8:11], s23 offen offset:1024 sc1
    s_waitcnt lgkmcnt(6)
    v_mfma_f32_16x16x32_bf16 v[36:39], v[100:103], v[212:215], v[36:39]
    ds_read_b64_tr_b16 v[92:93], v3 offset:8960
    v_mfma_f32_16x16x32_bf16 v[40:43], v[100:103], v[216:219], v[40:43]
    ds_read_b64_tr_b16 v[94:95], v3 offset:9984
    s_waitcnt lgkmcnt(6)
    v_mfma_f32_16x16x32_bf16 v[44:47], v[104:107], v[212:215], v[44:47]
    ds_read_b64_tr_b16 v[96:97], v15 offset:8992
    v_mfma_f32_16x16x32_bf16 v[48:51], v[104:107], v[216:219], v[48:51]
    ds_read_b64_tr_b16 v[98:99], v15 offset:10016
    s_waitcnt lgkmcnt(6)
    v_mfma_f32_16x16x32_bf16 v[52:55], v[84:87], v[212:215], v[52:55]
    v_mfma_f32_16x16x32_bf16 v[56:59], v[84:87], v[216:219], v[56:59]
    s_barrier
    ds_read_b64_tr_b16 v[100:101], v3 offset:16384
    ds_read_b64_tr_b16 v[102:103], v3 offset:17408
    s_waitcnt lgkmcnt(6)
    v_mfma_f32_16x16x32_bf16 v[60:63], v[88:91], v[212:215], v[60:63]
    ds_read_b64_tr_b16 v[104:105], v15 offset:16416
    v_mfma_f32_16x16x32_bf16 v[64:67], v[88:91], v[216:219], v[64:67]
    ds_read_b64_tr_b16 v[106:107], v15 offset:17440
    s_mov_b32 s23, 0xf000
    buffer_load_dwordx4 v[152:155], v4, s[8:11], s23 offen offset:1024 sc1
    s_waitcnt lgkmcnt(6)
    v_mfma_f32_16x16x32_bf16 v[68:71], v[92:95], v[212:215], v[68:71]
    ds_read_b64_tr_b16 v[84:85], v3 offset:16640
    v_mfma_f32_16x16x32_bf16 v[72:75], v[92:95], v[216:219], v[72:75]
    ds_read_b64_tr_b16 v[86:87], v3 offset:17664
    s_waitcnt lgkmcnt(6)
    v_mfma_f32_16x16x32_bf16 v[76:79], v[96:99], v[212:215], v[76:79]
    ds_read_b64_tr_b16 v[88:89], v15 offset:16672
    v_mfma_f32_16x16x32_bf16 v[80:83], v[96:99], v[216:219], v[80:83]
    ds_read_b64_tr_b16 v[90:91], v15 offset:17696
    s_waitcnt vmcnt(8) lgkmcnt(6)
    v_mfma_f32_16x16x32_bf16 v[20:23], v[100:103], v[220:223], v[20:23]
    ds_read_b64_tr_b16 v[92:93], v3 offset:16896
    s_waitcnt vmcnt(6)
    v_mfma_f32_16x16x32_bf16 v[24:27], v[100:103], v[224:227], v[24:27]
    ds_read_b64_tr_b16 v[94:95], v3 offset:17920
    s_waitcnt lgkmcnt(6)
    v_mfma_f32_16x16x32_bf16 v[28:31], v[104:107], v[220:223], v[28:31]
    ds_read_b64_tr_b16 v[96:97], v15 offset:16928
    v_mfma_f32_16x16x32_bf16 v[32:35], v[104:107], v[224:227], v[32:35]
    ds_read_b64_tr_b16 v[98:99], v15 offset:17952
    s_mov_b32 s23, 0x7800
    buffer_load_dwordx4 v[204:207], v4, s[8:11], s23 offen offset:0 sc1
    s_waitcnt lgkmcnt(6)
    v_mfma_f32_16x16x32_bf16 v[36:39], v[84:87], v[220:223], v[36:39]
    ds_read_b64_tr_b16 v[100:101], v3 offset:17152
    v_mfma_f32_16x16x32_bf16 v[40:43], v[84:87], v[224:227], v[40:43]
    ds_read_b64_tr_b16 v[102:103], v3 offset:18176
    s_waitcnt lgkmcnt(6)
    v_mfma_f32_16x16x32_bf16 v[44:47], v[88:91], v[220:223], v[44:47]
    ds_read_b64_tr_b16 v[104:105], v15 offset:17184
    v_mfma_f32_16x16x32_bf16 v[48:51], v[88:91], v[224:227], v[48:51]
    ds_read_b64_tr_b16 v[106:107], v15 offset:18208
    s_waitcnt lgkmcnt(6)
    v_mfma_f32_16x16x32_bf16 v[52:55], v[92:95], v[220:223], v[52:55]
    ds_read_b64_tr_b16 v[84:85], v3 offset:24576
    v_mfma_f32_16x16x32_bf16 v[56:59], v[92:95], v[224:227], v[56:59]
    ds_read_b64_tr_b16 v[86:87], v3 offset:25600
    s_waitcnt lgkmcnt(6)
    v_mfma_f32_16x16x32_bf16 v[60:63], v[96:99], v[220:223], v[60:63]
    ds_read_b64_tr_b16 v[88:89], v15 offset:24608
    v_mfma_f32_16x16x32_bf16 v[64:67], v[96:99], v[224:227], v[64:67]
    ds_read_b64_tr_b16 v[90:91], v15 offset:25632
    s_mov_b32 s23, 0xf800
    buffer_load_dwordx4 v[208:211], v4, s[8:11], s23 offen offset:0 sc1
    s_waitcnt lgkmcnt(6)
    v_mfma_f32_16x16x32_bf16 v[68:71], v[100:103], v[220:223], v[68:71]
    ds_read_b64_tr_b16 v[92:93], v3 offset:24832
    v_mfma_f32_16x16x32_bf16 v[72:75], v[100:103], v[224:227], v[72:75]
    ds_read_b64_tr_b16 v[94:95], v3 offset:25856
    s_waitcnt lgkmcnt(6)
    v_mfma_f32_16x16x32_bf16 v[76:79], v[104:107], v[220:223], v[76:79]
    ds_read_b64_tr_b16 v[96:97], v15 offset:24864
    v_mfma_f32_16x16x32_bf16 v[80:83], v[104:107], v[224:227], v[80:83]
    ds_read_b64_tr_b16 v[98:99], v15 offset:25888
    s_waitcnt vmcnt(7) lgkmcnt(6)
    v_mfma_f32_16x16x32_bf16 v[20:23], v[84:87], v[228:231], v[20:23]
    ds_read_b64_tr_b16 v[100:101], v3 offset:25088
    s_waitcnt vmcnt(6)
    v_mfma_f32_16x16x32_bf16 v[24:27], v[84:87], v[232:235], v[24:27]
    ds_read_b64_tr_b16 v[102:103], v3 offset:26112
    s_waitcnt lgkmcnt(6)
    v_mfma_f32_16x16x32_bf16 v[28:31], v[88:91], v[228:231], v[28:31]
    ds_read_b64_tr_b16 v[104:105], v15 offset:25120
    v_mfma_f32_16x16x32_bf16 v[32:35], v[88:91], v[232:235], v[32:35]
    ds_read_b64_tr_b16 v[106:107], v15 offset:26144
    s_mov_b32 s23, 0x7800
    buffer_load_dwordx4 v[212:215], v4, s[8:11], s23 offen offset:1024 sc1
    s_waitcnt lgkmcnt(6)
    v_mfma_f32_16x16x32_bf16 v[36:39], v[92:95], v[228:231], v[36:39]
    ds_read_b64_tr_b16 v[84:85], v3 offset:25344
    v_mfma_f32_16x16x32_bf16 v[40:43], v[92:95], v[232:235], v[40:43]
    ds_read_b64_tr_b16 v[86:87], v3 offset:26368
    s_waitcnt lgkmcnt(6)
    v_mfma_f32_16x16x32_bf16 v[44:47], v[96:99], v[228:231], v[44:47]
    ds_read_b64_tr_b16 v[88:89], v15 offset:25376
    v_mfma_f32_16x16x32_bf16 v[48:51], v[96:99], v[232:235], v[48:51]
    ds_read_b64_tr_b16 v[90:91], v15 offset:26400
    s_waitcnt lgkmcnt(6)
    v_mfma_f32_16x16x32_bf16 v[52:55], v[100:103], v[228:231], v[52:55]
    v_mfma_f32_16x16x32_bf16 v[56:59], v[100:103], v[232:235], v[56:59]
    s_barrier
    ds_read_b64_tr_b16 v[92:93], v3 offset:32768
    ds_read_b64_tr_b16 v[94:95], v3 offset:33792
    s_waitcnt lgkmcnt(6)
    v_mfma_f32_16x16x32_bf16 v[60:63], v[104:107], v[228:231], v[60:63]
    ds_read_b64_tr_b16 v[96:97], v15 offset:32800
    v_mfma_f32_16x16x32_bf16 v[64:67], v[104:107], v[232:235], v[64:67]
    ds_read_b64_tr_b16 v[98:99], v15 offset:33824
    s_mov_b32 s23, 0xf800
    buffer_load_dwordx4 v[216:219], v4, s[8:11], s23 offen offset:1024 sc1
    s_waitcnt lgkmcnt(6)
    v_mfma_f32_16x16x32_bf16 v[68:71], v[84:87], v[228:231], v[68:71]
    ds_read_b64_tr_b16 v[100:101], v3 offset:33024
    v_mfma_f32_16x16x32_bf16 v[72:75], v[84:87], v[232:235], v[72:75]
    ds_read_b64_tr_b16 v[102:103], v3 offset:34048
    s_waitcnt lgkmcnt(6)
    v_mfma_f32_16x16x32_bf16 v[76:79], v[88:91], v[228:231], v[76:79]
    ds_read_b64_tr_b16 v[104:105], v15 offset:33056
    v_mfma_f32_16x16x32_bf16 v[80:83], v[88:91], v[232:235], v[80:83]
    ds_read_b64_tr_b16 v[106:107], v15 offset:34080
    s_waitcnt vmcnt(7) lgkmcnt(6)
    v_mfma_f32_16x16x32_bf16 v[20:23], v[92:95], v[140:143], v[20:23]
    ds_read_b64_tr_b16 v[84:85], v3 offset:33280
    s_waitcnt vmcnt(6)
    v_mfma_f32_16x16x32_bf16 v[24:27], v[92:95], v[144:147], v[24:27]
    ds_read_b64_tr_b16 v[86:87], v3 offset:34304
    s_waitcnt lgkmcnt(6)
    v_mfma_f32_16x16x32_bf16 v[28:31], v[96:99], v[140:143], v[28:31]
    ds_read_b64_tr_b16 v[88:89], v15 offset:33312
    v_mfma_f32_16x16x32_bf16 v[32:35], v[96:99], v[144:147], v[32:35]
    ds_read_b64_tr_b16 v[90:91], v15 offset:34336
    s_waitcnt lgkmcnt(6)
    v_mfma_f32_16x16x32_bf16 v[36:39], v[100:103], v[140:143], v[36:39]
    ds_read_b64_tr_b16 v[92:93], v3 offset:33536
    v_mfma_f32_16x16x32_bf16 v[40:43], v[100:103], v[144:147], v[40:43]
    ds_read_b64_tr_b16 v[94:95], v3 offset:34560
    s_waitcnt lgkmcnt(6)
    v_mfma_f32_16x16x32_bf16 v[44:47], v[104:107], v[140:143], v[44:47]
    ds_read_b64_tr_b16 v[96:97], v15 offset:33568
    v_mfma_f32_16x16x32_bf16 v[48:51], v[104:107], v[144:147], v[48:51]
    ds_read_b64_tr_b16 v[98:99], v15 offset:34592
    s_waitcnt lgkmcnt(6)
    v_mfma_f32_16x16x32_bf16 v[52:55], v[84:87], v[140:143], v[52:55]
    ds_read_b64_tr_b16 v[100:101], v3 offset:40960
    v_mfma_f32_16x16x32_bf16 v[56:59], v[84:87], v[144:147], v[56:59]
    ds_read_b64_tr_b16 v[102:103], v3 offset:41984
    s_waitcnt lgkmcnt(6)
    v_mfma_f32_16x16x32_bf16 v[60:63], v[88:91], v[140:143], v[60:63]
    ds_read_b64_tr_b16 v[104:105], v15 offset:40992
    v_mfma_f32_16x16x32_bf16 v[64:67], v[88:91], v[144:147], v[64:67]
    ds_read_b64_tr_b16 v[106:107], v15 offset:42016
    s_waitcnt lgkmcnt(6)
    v_mfma_f32_16x16x32_bf16 v[68:71], v[92:95], v[140:143], v[68:71]
    ds_read_b64_tr_b16 v[84:85], v3 offset:41216
    v_mfma_f32_16x16x32_bf16 v[72:75], v[92:95], v[144:147], v[72:75]
    ds_read_b64_tr_b16 v[86:87], v3 offset:42240
    s_waitcnt lgkmcnt(6)
    v_mfma_f32_16x16x32_bf16 v[76:79], v[96:99], v[140:143], v[76:79]
    ds_read_b64_tr_b16 v[88:89], v15 offset:41248
    v_mfma_f32_16x16x32_bf16 v[80:83], v[96:99], v[144:147], v[80:83]
    ds_read_b64_tr_b16 v[90:91], v15 offset:42272
    s_waitcnt vmcnt(5) lgkmcnt(6)
    v_mfma_f32_16x16x32_bf16 v[20:23], v[100:103], v[148:151], v[20:23]
    ds_read_b64_tr_b16 v[92:93], v3 offset:41472
    s_waitcnt vmcnt(4)
    v_mfma_f32_16x16x32_bf16 v[24:27], v[100:103], v[152:155], v[24:27]
    ds_read_b64_tr_b16 v[94:95], v3 offset:42496
    s_waitcnt lgkmcnt(6)
    v_mfma_f32_16x16x32_bf16 v[28:31], v[104:107], v[148:151], v[28:31]
    ds_read_b64_tr_b16 v[96:97], v15 offset:41504
    v_mfma_f32_16x16x32_bf16 v[32:35], v[104:107], v[152:155], v[32:35]
    ds_read_b64_tr_b16 v[98:99], v15 offset:42528
    s_waitcnt lgkmcnt(6)
    v_mfma_f32_16x16x32_bf16 v[36:39], v[84:87], v[148:151], v[36:39]
    ds_read_b64_tr_b16 v[100:101], v3 offset:41728
    v_mfma_f32_16x16x32_bf16 v[40:43], v[84:87], v[152:155], v[40:43]
    ds_read_b64_tr_b16 v[102:103], v3 offset:42752
    s_waitcnt lgkmcnt(6)
    v_mfma_f32_16x16x32_bf16 v[44:47], v[88:91], v[148:151], v[44:47]
    ds_read_b64_tr_b16 v[104:105], v15 offset:41760
    v_mfma_f32_16x16x32_bf16 v[48:51], v[88:91], v[152:155], v[48:51]
    ds_read_b64_tr_b16 v[106:107], v15 offset:42784
    s_waitcnt lgkmcnt(6)
    v_mfma_f32_16x16x32_bf16 v[52:55], v[92:95], v[148:151], v[52:55]
    v_mfma_f32_16x16x32_bf16 v[56:59], v[92:95], v[152:155], v[56:59]
    s_barrier
    ds_read_b64_tr_b16 v[84:85], v3 offset:49152
    ds_read_b64_tr_b16 v[86:87], v3 offset:50176
    s_waitcnt lgkmcnt(6)
    v_mfma_f32_16x16x32_bf16 v[60:63], v[96:99], v[148:151], v[60:63]
    ds_read_b64_tr_b16 v[88:89], v15 offset:49184
    v_mfma_f32_16x16x32_bf16 v[64:67], v[96:99], v[152:155], v[64:67]
    ds_read_b64_tr_b16 v[90:91], v15 offset:50208
    s_waitcnt lgkmcnt(6)
    v_mfma_f32_16x16x32_bf16 v[68:71], v[100:103], v[148:151], v[68:71]
    ds_read_b64_tr_b16 v[92:93], v3 offset:49408
    v_mfma_f32_16x16x32_bf16 v[72:75], v[100:103], v[152:155], v[72:75]
    ds_read_b64_tr_b16 v[94:95], v3 offset:50432
    s_waitcnt lgkmcnt(6)
    v_mfma_f32_16x16x32_bf16 v[76:79], v[104:107], v[148:151], v[76:79]
    ds_read_b64_tr_b16 v[96:97], v15 offset:49440
    v_mfma_f32_16x16x32_bf16 v[80:83], v[104:107], v[152:155], v[80:83]
    ds_read_b64_tr_b16 v[98:99], v15 offset:50464
    s_waitcnt vmcnt(3) lgkmcnt(6)
    v_mfma_f32_16x16x32_bf16 v[20:23], v[84:87], v[204:207], v[20:23]
    ds_read_b64_tr_b16 v[100:101], v3 offset:49664
    s_waitcnt vmcnt(2)
    v_mfma_f32_16x16x32_bf16 v[24:27], v[84:87], v[208:211], v[24:27]
    ds_read_b64_tr_b16 v[102:103], v3 offset:50688
    s_waitcnt lgkmcnt(6)
    v_mfma_f32_16x16x32_bf16 v[28:31], v[88:91], v[204:207], v[28:31]
    ds_read_b64_tr_b16 v[104:105], v15 offset:49696
    v_mfma_f32_16x16x32_bf16 v[32:35], v[88:91], v[208:211], v[32:35]
    ds_read_b64_tr_b16 v[106:107], v15 offset:50720
    s_waitcnt lgkmcnt(6)
    v_mfma_f32_16x16x32_bf16 v[36:39], v[92:95], v[204:207], v[36:39]
    ds_read_b64_tr_b16 v[84:85], v3 offset:49920
    v_mfma_f32_16x16x32_bf16 v[40:43], v[92:95], v[208:211], v[40:43]
    ds_read_b64_tr_b16 v[86:87], v3 offset:50944
    s_waitcnt lgkmcnt(6)
    v_mfma_f32_16x16x32_bf16 v[44:47], v[96:99], v[204:207], v[44:47]
    ds_read_b64_tr_b16 v[88:89], v15 offset:49952
    v_mfma_f32_16x16x32_bf16 v[48:51], v[96:99], v[208:211], v[48:51]
    ds_read_b64_tr_b16 v[90:91], v15 offset:50976
    s_waitcnt lgkmcnt(6)
    v_mfma_f32_16x16x32_bf16 v[52:55], v[100:103], v[204:207], v[52:55]
    ds_read_b64_tr_b16 v[92:93], v3 offset:57344
    v_mfma_f32_16x16x32_bf16 v[56:59], v[100:103], v[208:211], v[56:59]
    ds_read_b64_tr_b16 v[94:95], v3 offset:58368
    s_waitcnt lgkmcnt(6)
    v_mfma_f32_16x16x32_bf16 v[60:63], v[104:107], v[204:207], v[60:63]
    ds_read_b64_tr_b16 v[96:97], v15 offset:57376
    v_mfma_f32_16x16x32_bf16 v[64:67], v[104:107], v[208:211], v[64:67]
    ds_read_b64_tr_b16 v[98:99], v15 offset:58400
    s_waitcnt lgkmcnt(6)
    v_mfma_f32_16x16x32_bf16 v[68:71], v[84:87], v[204:207], v[68:71]
    ds_read_b64_tr_b16 v[100:101], v3 offset:57600
    v_mfma_f32_16x16x32_bf16 v[72:75], v[84:87], v[208:211], v[72:75]
    ds_read_b64_tr_b16 v[102:103], v3 offset:58624
    s_waitcnt lgkmcnt(6)
    v_mfma_f32_16x16x32_bf16 v[76:79], v[88:91], v[204:207], v[76:79]
    ds_read_b64_tr_b16 v[104:105], v15 offset:57632
    v_mfma_f32_16x16x32_bf16 v[80:83], v[88:91], v[208:211], v[80:83]
    ds_read_b64_tr_b16 v[106:107], v15 offset:58656
    s_waitcnt vmcnt(1) lgkmcnt(6)
    v_mfma_f32_16x16x32_bf16 v[20:23], v[92:95], v[212:215], v[20:23]
    ds_read_b64_tr_b16 v[84:85], v3 offset:57856
    s_waitcnt vmcnt(0)
    v_mfma_f32_16x16x32_bf16 v[24:27], v[92:95], v[216:219], v[24:27]
    ds_read_b64_tr_b16 v[86:87], v3 offset:58880
    s_waitcnt lgkmcnt(6)
    v_mfma_f32_16x16x32_bf16 v[28:31], v[96:99], v[212:215], v[28:31]
    ds_read_b64_tr_b16 v[88:89], v15 offset:57888
    v_mfma_f32_16x16x32_bf16 v[32:35], v[96:99], v[216:219], v[32:35]
    ds_read_b64_tr_b16 v[90:91], v15 offset:58912
    s_waitcnt lgkmcnt(6)
    v_mfma_f32_16x16x32_bf16 v[36:39], v[100:103], v[212:215], v[36:39]
    ds_read_b64_tr_b16 v[92:93], v3 offset:58112
    v_mfma_f32_16x16x32_bf16 v[40:43], v[100:103], v[216:219], v[40:43]
    ds_read_b64_tr_b16 v[94:95], v3 offset:59136
    s_waitcnt lgkmcnt(6)
    v_mfma_f32_16x16x32_bf16 v[44:47], v[104:107], v[212:215], v[44:47]
    ds_read_b64_tr_b16 v[96:97], v15 offset:58144
    v_mfma_f32_16x16x32_bf16 v[48:51], v[104:107], v[216:219], v[48:51]
    ds_read_b64_tr_b16 v[98:99], v15 offset:59168
    s_waitcnt lgkmcnt(6)
    v_mfma_f32_16x16x32_bf16 v[52:55], v[84:87], v[212:215], v[52:55]
    v_mfma_f32_16x16x32_bf16 v[56:59], v[84:87], v[216:219], v[56:59]
    s_waitcnt lgkmcnt(4)
    v_mfma_f32_16x16x32_bf16 v[60:63], v[88:91], v[212:215], v[60:63]
    v_mfma_f32_16x16x32_bf16 v[64:67], v[88:91], v[216:219], v[64:67]
    s_waitcnt lgkmcnt(2)
    v_mfma_f32_16x16x32_bf16 v[68:71], v[92:95], v[212:215], v[68:71]
    v_mfma_f32_16x16x32_bf16 v[72:75], v[92:95], v[216:219], v[72:75]
    s_waitcnt lgkmcnt(0)
    v_mfma_f32_16x16x32_bf16 v[76:79], v[96:99], v[212:215], v[76:79]
    v_mfma_f32_16x16x32_bf16 v[80:83], v[96:99], v[216:219], v[80:83]
    s_mov_b32 s24, 0x3e0293ee
    v_cvt_pk_bf16_f32 v108, v20, v21
    v_cvt_pk_bf16_f32 v109, v22, v23
    v_cvt_pk_bf16_f32 v124, v24, v25
    v_cvt_pk_bf16_f32 v125, v26, v27
    v_cvt_pk_bf16_f32 v110, v28, v29
    v_cvt_pk_bf16_f32 v111, v30, v31
    v_cvt_pk_bf16_f32 v126, v32, v33
    v_cvt_pk_bf16_f32 v127, v34, v35
    v_cvt_pk_bf16_f32 v112, v36, v37
    v_cvt_pk_bf16_f32 v113, v38, v39
    v_cvt_pk_bf16_f32 v128, v40, v41
    v_cvt_pk_bf16_f32 v129, v42, v43
    v_cvt_pk_bf16_f32 v114, v44, v45
    v_cvt_pk_bf16_f32 v115, v46, v47
    v_cvt_pk_bf16_f32 v130, v48, v49
    v_cvt_pk_bf16_f32 v131, v50, v51
    v_cvt_pk_bf16_f32 v116, v52, v53
    v_cvt_pk_bf16_f32 v117, v54, v55
    v_cvt_pk_bf16_f32 v132, v56, v57
    v_cvt_pk_bf16_f32 v133, v58, v59
    v_cvt_pk_bf16_f32 v118, v60, v61
    v_cvt_pk_bf16_f32 v119, v62, v63
    v_cvt_pk_bf16_f32 v134, v64, v65
    v_cvt_pk_bf16_f32 v135, v66, v67
    v_cvt_pk_bf16_f32 v120, v68, v69
    v_cvt_pk_bf16_f32 v121, v70, v71
    v_cvt_pk_bf16_f32 v136, v72, v73
    v_cvt_pk_bf16_f32 v137, v74, v75
    v_cvt_pk_bf16_f32 v122, v76, v77
    v_cvt_pk_bf16_f32 v123, v78, v79
    v_cvt_pk_bf16_f32 v138, v80, v81
    v_cvt_pk_bf16_f32 v139, v82, v83
    v_add_u32 v2, 0x10000, v1
    v_add_u32 v3, 0x20000, v1
    s_barrier
    ds_read_b128 v[84:87], v2 offset:0
    ds_read_b128 v[88:91], v2 offset:1024
    ds_read_b128 v[92:95], v2 offset:2048
    ds_read_b128 v[96:99], v2 offset:3072
    s_waitcnt lgkmcnt(3)
    v_mfma_f32_16x16x32_bf16 v[140:143], v[84:87], v[108:111], 0
    v_mfma_f32_16x16x32_bf16 v[144:147], v[84:87], v[124:127], 0
    ds_read_b128 v[100:103], v2 offset:4096
    s_waitcnt lgkmcnt(3)
    v_mfma_f32_16x16x32_bf16 v[148:151], v[88:91], v[108:111], 0
    v_mfma_f32_16x16x32_bf16 v[152:155], v[88:91], v[124:127], 0
    ds_read_b128 v[104:107], v2 offset:5120
    s_mov_b64 s[64:65], s[52:53]
    s_mov_b32 s66, 0x800
    s_mov_b32 s67, 0x20000
    s_mov_b64 s[68:69], s[54:55]
    s_mov_b32 s70, 0xc00000
    s_mov_b32 s71, 0x20000
    s_and_b32 s100, s2, 7
    s_lshl_b32 s100, s100, 5
    s_lshr_b32 s26, s2, 3
    s_add_u32 s100, s100, s26
    v_lshrrev_b32 v13, 1, v8
    v_lshlrev_b32 v14, 4, v13
    buffer_load_dwordx4 v[244:247], v14, s[64:67], 0 offen
    s_mov_b32 s26, 98304
    v_mul_lo_u32 v13, s26, v13
    v_and_b32 v14, 1, v8
    v_lshl_add_u32 v13, v14, 4, v13
    s_lshl_b32 s25, s100, 5
    s_add_u32 s25, s25, 4096
    s_waitcnt lgkmcnt(3)
    v_mfma_f32_16x16x32_bf16 v[140:143], v[92:95], v[112:115], v[140:143]
    v_mfma_f32_16x16x32_bf16 v[144:147], v[92:95], v[128:131], v[144:147]
    ds_read_b128 v[84:87], v2 offset:6144
    s_waitcnt lgkmcnt(3)
    v_mfma_f32_16x16x32_bf16 v[148:151], v[96:99], v[112:115], v[148:151]
    v_mfma_f32_16x16x32_bf16 v[152:155], v[96:99], v[128:131], v[152:155]
    ds_read_b128 v[88:91], v2 offset:7168
    s_add_u32 s26, s25, 0
    buffer_load_dwordx4 v[204:207], v13, s[68:71], s26 offen
    s_waitcnt lgkmcnt(3)
    v_mfma_f32_16x16x32_bf16 v[140:143], v[100:103], v[116:119], v[140:143]
    v_mfma_f32_16x16x32_bf16 v[144:147], v[100:103], v[132:135], v[144:147]
    s_barrier
    ds_read_b128 v[92:95], v2 offset:16384
    s_waitcnt lgkmcnt(3)
    v_mfma_f32_16x16x32_bf16 v[148:151], v[104:107], v[116:119], v[148:151]
    v_mfma_f32_16x16x32_bf16 v[152:155], v[104:107], v[132:135], v[152:155]
    ds_read_b128 v[96:99], v2 offset:17408
    s_add_u32 s26, s25, 12288
    buffer_load_dwordx4 v[208:211], v13, s[68:71], s26 offen
    s_waitcnt lgkmcnt(3)
    v_mfma_f32_16x16x32_bf16 v[140:143], v[84:87], v[120:123], v[140:143]
    v_mfma_f32_16x16x32_bf16 v[144:147], v[84:87], v[136:139], v[144:147]
    ds_read_b128 v[100:103], v2 offset:18432
    s_waitcnt lgkmcnt(3)
    v_mfma_f32_16x16x32_bf16 v[148:151], v[88:91], v[120:123], v[148:151]
    v_mfma_f32_16x16x32_bf16 v[152:155], v[88:91], v[136:139], v[152:155]
    ds_read_b128 v[104:107], v2 offset:19456
    s_add_u32 s26, s25, 24576
    buffer_load_dwordx4 v[212:215], v13, s[68:71], s26 offen
    s_waitcnt lgkmcnt(3)
    v_mfma_f32_16x16x32_bf16 v[156:159], v[92:95], v[108:111], 0
    v_mfma_f32_16x16x32_bf16 v[160:163], v[92:95], v[124:127], 0
    ds_read_b128 v[84:87], v2 offset:20480
    s_waitcnt lgkmcnt(3)
    v_mfma_f32_16x16x32_bf16 v[164:167], v[96:99], v[108:111], 0
    v_mfma_f32_16x16x32_bf16 v[168:171], v[96:99], v[124:127], 0
    ds_read_b128 v[88:91], v2 offset:21504
    s_add_u32 s26, s25, 36864
    buffer_load_dwordx4 v[216:219], v13, s[68:71], s26 offen
    s_waitcnt lgkmcnt(3)
    v_mfma_f32_16x16x32_bf16 v[156:159], v[100:103], v[112:115], v[156:159]
    v_mfma_f32_16x16x32_bf16 v[160:163], v[100:103], v[128:131], v[160:163]
    ds_read_b128 v[92:95], v2 offset:22528
    s_waitcnt lgkmcnt(3)
    v_mfma_f32_16x16x32_bf16 v[164:167], v[104:107], v[112:115], v[164:167]
    v_max3_f32 v9, v140, v141, v142
    v_mfma_f32_16x16x32_bf16 v[168:171], v[104:107], v[128:131], v[168:171]
    ds_read_b128 v[96:99], v2 offset:23552
    v_max3_f32 v9, v9, v143, v148
    s_add_u32 s26, s25, 49152
    buffer_load_dwordx4 v[220:223], v13, s[68:71], s26 offen
    s_waitcnt lgkmcnt(3)
    v_mfma_f32_16x16x32_bf16 v[156:159], v[84:87], v[116:119], v[156:159]
    v_max3_f32 v9, v9, v149, v150
    v_mfma_f32_16x16x32_bf16 v[160:163], v[84:87], v[132:135], v[160:163]
    s_barrier
    ds_read_b128 v[100:103], v2 offset:32768
    v_max_f32 v9, v9, v151
    s_waitcnt lgkmcnt(3)
    v_mfma_f32_16x16x32_bf16 v[164:167], v[88:91], v[116:119], v[164:167]
    v_max3_f32 v10, v144, v145, v146
    v_mfma_f32_16x16x32_bf16 v[168:171], v[88:91], v[132:135], v[168:171]
    ds_read_b128 v[104:107], v2 offset:33792
    v_max3_f32 v10, v10, v147, v152
    s_add_u32 s26, s25, 61440
    buffer_load_dwordx4 v[224:227], v13, s[68:71], s26 offen
    s_waitcnt lgkmcnt(3)
    v_mfma_f32_16x16x32_bf16 v[156:159], v[92:95], v[120:123], v[156:159]
    v_max3_f32 v10, v10, v153, v154
    v_mfma_f32_16x16x32_bf16 v[160:163], v[92:95], v[136:139], v[160:163]
    ds_read_b128 v[84:87], v2 offset:34816
    v_max_f32 v10, v10, v155
    s_waitcnt lgkmcnt(3)
    v_mfma_f32_16x16x32_bf16 v[164:167], v[96:99], v[120:123], v[164:167]
    v_mfma_f32_16x16x32_bf16 v[168:171], v[96:99], v[136:139], v[168:171]
    ds_read_b128 v[88:91], v2 offset:35840
    v_max3_f32 v9, v9, v156, v157
    v_max3_f32 v9, v9, v158, v159
    s_nop 3
    v_max3_f32 v9, v9, v164, v165
    v_max3_f32 v9, v9, v166, v167
    v_max3_f32 v10, v10, v160, v161
    v_max3_f32 v10, v10, v162, v163
    v_max3_f32 v10, v10, v168, v169
    v_max3_f32 v10, v10, v170, v171
    v_mov_b32 v11, v9
    v_mov_b32 v12, v10
    s_nop 0
    v_permlane16_swap_b32 v9, v11
    v_permlane16_swap_b32 v10, v12
    v_max_f32 v9, v9, v11
    v_max_f32 v10, v10, v12
    v_mov_b32 v11, v9
    v_mov_b32 v12, v10
    s_nop 0
    v_permlane32_swap_b32 v9, v11
    v_permlane32_swap_b32 v10, v12
    v_max_f32 v9, v9, v11
    v_max_f32 v10, v10, v12
    v_sub_f32 v172, 0, v9
    v_sub_f32 v173, 0, v9
    v_sub_f32 v174, 0, v9
    v_sub_f32 v175, 0, v9
    v_sub_f32 v176, 0, v10
    v_sub_f32 v177, 0, v10
    v_sub_f32 v178, 0, v10
    v_sub_f32 v179, 0, v10
    v_add_f32 v140, v140, v172
    v_add_f32 v141, v141, v172
    v_exp_f32 v140, v140
    v_exp_f32 v141, v141
    s_nop 0
    v_add_f32 v15, v140, v141
    v_cvt_pk_bf16_f32 v188, v140, v141
    v_add_f32 v142, v142, v172
    v_add_f32 v143, v143, v172
    v_exp_f32 v142, v142
    v_exp_f32 v143, v143
    v_add_f32 v15, v15, v142
    v_add_f32 v15, v15, v143
    v_cvt_pk_bf16_f32 v189, v142, v143
    v_add_f32 v144, v144, v176
    v_add_f32 v145, v145, v176
    v_exp_f32 v144, v144
    v_exp_f32 v145, v145
    s_nop 0
    v_add_f32 v16, v144, v145
    v_cvt_pk_bf16_f32 v192, v144, v145
    v_add_f32 v146, v146, v176
    v_add_f32 v147, v147, v176
    v_exp_f32 v146, v146
    v_exp_f32 v147, v147
    v_add_f32 v16, v16, v146
    v_add_f32 v16, v16, v147
    v_cvt_pk_bf16_f32 v193, v146, v147
    v_add_f32 v148, v148, v172
    v_add_f32 v149, v149, v172
    v_exp_f32 v148, v148
    v_exp_f32 v149, v149
    v_add_f32 v15, v15, v148
    v_add_f32 v15, v15, v149
    v_cvt_pk_bf16_f32 v190, v148, v149
    v_add_f32 v150, v150, v172
    v_add_f32 v151, v151, v172
    v_exp_f32 v150, v150
    v_exp_f32 v151, v151
    v_add_f32 v15, v15, v150
    v_add_f32 v15, v15, v151
    v_cvt_pk_bf16_f32 v191, v150, v151
    v_add_f32 v152, v152, v176
    v_add_f32 v153, v153, v176
    v_exp_f32 v152, v152
    v_exp_f32 v153, v153
    v_add_f32 v16, v16, v152
    v_add_f32 v16, v16, v153
    v_cvt_pk_bf16_f32 v194, v152, v153
    v_add_f32 v154, v154, v176
    v_add_f32 v155, v155, v176
    v_exp_f32 v154, v154
    v_exp_f32 v155, v155
    v_add_f32 v16, v16, v154
    v_add_f32 v16, v16, v155
    v_cvt_pk_bf16_f32 v195, v154, v155
    s_add_u32 s26, s25, 73728
    buffer_load_dwordx4 v[228:231], v13, s[68:71], s26 offen
    s_waitcnt lgkmcnt(3)
    v_mfma_f32_16x16x32_bf16 v[140:143], v[100:103], v[108:111], v[172:175]
    v_add_f32 v156, v156, v172
    v_add_f32 v157, v157, v172
    v_mfma_f32_16x16x32_bf16 v[144:147], v[100:103], v[124:127], v[176:179]
    ds_read_b128 v[92:95], v2 offset:36864
    v_exp_f32 v156, v156
    v_exp_f32 v157, v157
    s_waitcnt lgkmcnt(3)
    v_mfma_f32_16x16x32_bf16 v[148:151], v[104:107], v[108:111], v[172:175]
    v_add_f32 v15, v15, v156
    v_add_f32 v15, v15, v157
    v_mfma_f32_16x16x32_bf16 v[152:155], v[104:107], v[124:127], v[176:179]
    ds_read_b128 v[96:99], v2 offset:37888
    v_cvt_pk_bf16_f32 v196, v156, v157
    s_add_u32 s26, s25, 86016
    buffer_load_dwordx4 v[232:235], v13, s[68:71], s26 offen
    s_waitcnt lgkmcnt(3)
    v_mfma_f32_16x16x32_bf16 v[140:143], v[84:87], v[112:115], v[140:143]
    v_add_f32 v158, v158, v172
    v_add_f32 v159, v159, v172
    v_mfma_f32_16x16x32_bf16 v[144:147], v[84:87], v[128:131], v[144:147]
    ds_read_b128 v[100:103], v2 offset:38912
    v_exp_f32 v158, v158
    v_exp_f32 v159, v159
    s_waitcnt lgkmcnt(3)
    v_mfma_f32_16x16x32_bf16 v[148:151], v[88:91], v[112:115], v[148:151]
    v_add_f32 v15, v15, v158
    v_add_f32 v15, v15, v159
    v_mfma_f32_16x16x32_bf16 v[152:155], v[88:91], v[128:131], v[152:155]
    ds_read_b128 v[104:107], v2 offset:39936
    v_cvt_pk_bf16_f32 v197, v158, v159
    s_waitcnt lgkmcnt(3)
    v_mfma_f32_16x16x32_bf16 v[140:143], v[92:95], v[116:119], v[140:143]
    v_add_f32 v160, v160, v176
    v_add_f32 v161, v161, v176
    v_mfma_f32_16x16x32_bf16 v[144:147], v[92:95], v[132:135], v[144:147]
    ds_read_b128 v[84:87], v2 offset:8192
    v_exp_f32 v160, v160
    v_exp_f32 v161, v161
    s_waitcnt lgkmcnt(3)
    v_mfma_f32_16x16x32_bf16 v[148:151], v[96:99], v[116:119], v[148:151]
    v_add_f32 v16, v16, v160
    v_add_f32 v16, v16, v161
    v_mfma_f32_16x16x32_bf16 v[152:155], v[96:99], v[132:135], v[152:155]
    ds_read_b128 v[88:91], v2 offset:9216
    v_cvt_pk_bf16_f32 v200, v160, v161
    s_waitcnt lgkmcnt(3)
    v_mfma_f32_16x16x32_bf16 v[140:143], v[100:103], v[120:123], v[140:143]
    v_add_f32 v162, v162, v176
    v_add_f32 v163, v163, v176
    v_mfma_f32_16x16x32_bf16 v[144:147], v[100:103], v[136:139], v[144:147]
    ds_read_b128 v[92:95], v2 offset:10240
    v_exp_f32 v162, v162
    v_exp_f32 v163, v163
    s_waitcnt lgkmcnt(3)
    v_mfma_f32_16x16x32_bf16 v[148:151], v[104:107], v[120:123], v[148:151]
    v_add_f32 v16, v16, v162
    v_add_f32 v16, v16, v163
    v_mfma_f32_16x16x32_bf16 v[152:155], v[104:107], v[136:139], v[152:155]
    ds_read_b128 v[96:99], v2 offset:11264
    v_cvt_pk_bf16_f32 v201, v162, v163
    s_waitcnt lgkmcnt(3)
    v_mfma_f32_16x16x32_bf16 v[20:23], v[84:87], v[188:191], 0
    v_add_f32 v164, v164, v172
    v_add_f32 v165, v165, v172
    v_mfma_f32_16x16x32_bf16 v[24:27], v[84:87], v[192:195], 0
    ds_read_b128 v[100:103], v2 offset:12288
    v_exp_f32 v164, v164
    v_exp_f32 v165, v165
    s_waitcnt lgkmcnt(3)
    v_mfma_f32_16x16x32_bf16 v[28:31], v[88:91], v[188:191], 0
    v_add_f32 v15, v15, v164
    v_add_f32 v15, v15, v165
    v_mfma_f32_16x16x32_bf16 v[32:35], v[88:91], v[192:195], 0
    ds_read_b128 v[104:107], v2 offset:13312
    v_cvt_pk_bf16_f32 v198, v164, v165
    s_waitcnt lgkmcnt(3)
    v_mfma_f32_16x16x32_bf16 v[36:39], v[92:95], v[188:191], 0
    v_add_f32 v166, v166, v172
    v_add_f32 v167, v167, v172
    v_mfma_f32_16x16x32_bf16 v[40:43], v[92:95], v[192:195], 0
    ds_read_b128 v[84:87], v2 offset:14336
    v_exp_f32 v166, v166
    v_exp_f32 v167, v167
    s_waitcnt lgkmcnt(3)
    v_mfma_f32_16x16x32_bf16 v[44:47], v[96:99], v[188:191], 0
    v_add_f32 v15, v15, v166
    v_add_f32 v15, v15, v167
    v_mfma_f32_16x16x32_bf16 v[48:51], v[96:99], v[192:195], 0
    ds_read_b128 v[88:91], v2 offset:15360
    v_cvt_pk_bf16_f32 v199, v166, v167
    s_waitcnt lgkmcnt(3)
    v_mfma_f32_16x16x32_bf16 v[52:55], v[100:103], v[188:191], 0
    v_add_f32 v168, v168, v176
    v_add_f32 v169, v169, v176
    v_mfma_f32_16x16x32_bf16 v[56:59], v[100:103], v[192:195], 0
    s_barrier
    ds_read_b128 v[92:95], v2 offset:49152
    v_exp_f32 v168, v168
    v_exp_f32 v169, v169
    s_waitcnt lgkmcnt(3)
    v_mfma_f32_16x16x32_bf16 v[60:63], v[104:107], v[188:191], 0
    v_add_f32 v16, v16, v168
    v_add_f32 v16, v16, v169
    v_mfma_f32_16x16x32_bf16 v[64:67], v[104:107], v[192:195], 0
    ds_read_b128 v[96:99], v2 offset:50176
    v_cvt_pk_bf16_f32 v202, v168, v169
    s_waitcnt lgkmcnt(3)
    v_mfma_f32_16x16x32_bf16 v[68:71], v[84:87], v[188:191], 0
    v_add_f32 v170, v170, v176
    v_add_f32 v171, v171, v176
    v_mfma_f32_16x16x32_bf16 v[72:75], v[84:87], v[192:195], 0
    ds_read_b128 v[100:103], v2 offset:51200
    v_exp_f32 v170, v170
    v_exp_f32 v171, v171
    s_waitcnt lgkmcnt(3)
    v_mfma_f32_16x16x32_bf16 v[76:79], v[88:91], v[188:191], 0
    v_add_f32 v16, v16, v170
    v_add_f32 v16, v16, v171
    v_mfma_f32_16x16x32_bf16 v[80:83], v[88:91], v[192:195], 0
    ds_read_b128 v[104:107], v2 offset:52224
    v_cvt_pk_bf16_f32 v203, v170, v171
    s_waitcnt lgkmcnt(3)
    v_mfma_f32_16x16x32_bf16 v[156:159], v[92:95], v[108:111], v[172:175]
    v_exp_f32 v140, v140
    v_exp_f32 v141, v141
    v_mfma_f32_16x16x32_bf16 v[160:163], v[92:95], v[124:127], v[176:179]
    ds_read_b128 v[84:87], v2 offset:53248
    v_add_f32 v15, v15, v140
    s_waitcnt lgkmcnt(3)
    v_mfma_f32_16x16x32_bf16 v[164:167], v[96:99], v[108:111], v[172:175]
    v_add_f32 v15, v15, v141
    v_mfma_f32_16x16x32_bf16 v[168:171], v[96:99], v[124:127], v[176:179]
    ds_read_b128 v[88:91], v2 offset:54272
    v_cvt_pk_bf16_f32 v188, v140, v141
    s_waitcnt lgkmcnt(3)
    v_mfma_f32_16x16x32_bf16 v[156:159], v[100:103], v[112:115], v[156:159]
    v_exp_f32 v142, v142
    v_exp_f32 v143, v143
    v_mfma_f32_16x16x32_bf16 v[160:163], v[100:103], v[128:131], v[160:163]
    ds_read_b128 v[92:95], v2 offset:55296
    v_add_f32 v15, v15, v142
    s_waitcnt lgkmcnt(3)
    v_mfma_f32_16x16x32_bf16 v[164:167], v[104:107], v[112:115], v[164:167]
    v_add_f32 v15, v15, v143
    v_mfma_f32_16x16x32_bf16 v[168:171], v[104:107], v[128:131], v[168:171]
    ds_read_b128 v[96:99], v2 offset:56320
    v_cvt_pk_bf16_f32 v189, v142, v143
    s_waitcnt lgkmcnt(3)
    v_mfma_f32_16x16x32_bf16 v[156:159], v[84:87], v[116:119], v[156:159]
    v_exp_f32 v144, v144
    v_exp_f32 v145, v145
    v_mfma_f32_16x16x32_bf16 v[160:163], v[84:87], v[132:135], v[160:163]
    ds_read_b128 v[100:103], v2 offset:24576
    v_add_f32 v16, v16, v144
    s_waitcnt lgkmcnt(3)
    v_mfma_f32_16x16x32_bf16 v[164:167], v[88:91], v[116:119], v[164:167]
    v_add_f32 v16, v16, v145
    v_mfma_f32_16x16x32_bf16 v[168:171], v[88:91], v[132:135], v[168:171]
    ds_read_b128 v[104:107], v2 offset:25600
    v_cvt_pk_bf16_f32 v192, v144, v145
    s_waitcnt lgkmcnt(3)
    v_mfma_f32_16x16x32_bf16 v[156:159], v[92:95], v[120:123], v[156:159]
    v_exp_f32 v146, v146
    v_exp_f32 v147, v147
    v_mfma_f32_16x16x32_bf16 v[160:163], v[92:95], v[136:139], v[160:163]
    ds_read_b128 v[84:87], v2 offset:26624
    v_add_f32 v16, v16, v146
    s_waitcnt lgkmcnt(3)
    v_mfma_f32_16x16x32_bf16 v[164:167], v[96:99], v[120:123], v[164:167]
    v_add_f32 v16, v16, v147
    v_mfma_f32_16x16x32_bf16 v[168:171], v[96:99], v[136:139], v[168:171]
    ds_read_b128 v[88:91], v2 offset:27648
    v_cvt_pk_bf16_f32 v193, v146, v147
    s_waitcnt lgkmcnt(3)
    v_mfma_f32_16x16x32_bf16 v[20:23], v[100:103], v[196:199], v[20:23]
    v_exp_f32 v148, v148
    v_exp_f32 v149, v149
    v_mfma_f32_16x16x32_bf16 v[24:27], v[100:103], v[200:203], v[24:27]
    ds_read_b128 v[92:95], v2 offset:28672
    v_add_f32 v15, v15, v148
    s_waitcnt lgkmcnt(3)
    v_mfma_f32_16x16x32_bf16 v[28:31], v[104:107], v[196:199], v[28:31]
    v_add_f32 v15, v15, v149
    v_mfma_f32_16x16x32_bf16 v[32:35], v[104:107], v[200:203], v[32:35]
    ds_read_b128 v[96:99], v2 offset:29696
    v_cvt_pk_bf16_f32 v190, v148, v149
    s_waitcnt lgkmcnt(3)
    v_mfma_f32_16x16x32_bf16 v[36:39], v[84:87], v[196:199], v[36:39]
    v_exp_f32 v150, v150
    v_exp_f32 v151, v151
    v_mfma_f32_16x16x32_bf16 v[40:43], v[84:87], v[200:203], v[40:43]
    ds_read_b128 v[100:103], v2 offset:30720
    v_add_f32 v15, v15, v150
    s_waitcnt lgkmcnt(3)
    v_mfma_f32_16x16x32_bf16 v[44:47], v[88:91], v[196:199], v[44:47]
    v_add_f32 v15, v15, v151
    v_mfma_f32_16x16x32_bf16 v[48:51], v[88:91], v[200:203], v[48:51]
    ds_read_b128 v[104:107], v2 offset:31744
    v_cvt_pk_bf16_f32 v191, v150, v151
    s_waitcnt lgkmcnt(3)
    v_mfma_f32_16x16x32_bf16 v[52:55], v[92:95], v[196:199], v[52:55]
    v_exp_f32 v152, v152
    v_exp_f32 v153, v153
    v_mfma_f32_16x16x32_bf16 v[56:59], v[92:95], v[200:203], v[56:59]
    s_barrier
    ds_read_b128 v[84:87], v3 offset:0
    v_add_f32 v16, v16, v152
    s_waitcnt lgkmcnt(3)
    v_mfma_f32_16x16x32_bf16 v[60:63], v[96:99], v[196:199], v[60:63]
    v_add_f32 v16, v16, v153
    v_mfma_f32_16x16x32_bf16 v[64:67], v[96:99], v[200:203], v[64:67]
    ds_read_b128 v[88:91], v3 offset:1024
    v_cvt_pk_bf16_f32 v194, v152, v153
    s_waitcnt lgkmcnt(3)
    v_mfma_f32_16x16x32_bf16 v[68:71], v[100:103], v[196:199], v[68:71]
    v_exp_f32 v154, v154
    v_exp_f32 v155, v155
    v_mfma_f32_16x16x32_bf16 v[72:75], v[100:103], v[200:203], v[72:75]
    ds_read_b128 v[92:95], v3 offset:2048
    v_add_f32 v16, v16, v154
    s_waitcnt lgkmcnt(3)
    v_mfma_f32_16x16x32_bf16 v[76:79], v[104:107], v[196:199], v[76:79]
    v_add_f32 v16, v16, v155
    v_mfma_f32_16x16x32_bf16 v[80:83], v[104:107], v[200:203], v[80:83]
    ds_read_b128 v[96:99], v3 offset:3072
    v_cvt_pk_bf16_f32 v195, v154, v155
    s_waitcnt lgkmcnt(3)
    v_mfma_f32_16x16x32_bf16 v[140:143], v[84:87], v[108:111], v[172:175]
    v_exp_f32 v156, v156
    v_exp_f32 v157, v157
    v_mfma_f32_16x16x32_bf16 v[144:147], v[84:87], v[124:127], v[176:179]
    ds_read_b128 v[100:103], v3 offset:4096
    v_add_f32 v15, v15, v156
    s_waitcnt lgkmcnt(3)
    v_mfma_f32_16x16x32_bf16 v[148:151], v[88:91], v[108:111], v[172:175]
    v_add_f32 v15, v15, v157
    v_mfma_f32_16x16x32_bf16 v[152:155], v[88:91], v[124:127], v[176:179]
    ds_read_b128 v[104:107], v3 offset:5120
    v_cvt_pk_bf16_f32 v196, v156, v157
    s_waitcnt lgkmcnt(3)
    v_mfma_f32_16x16x32_bf16 v[140:143], v[92:95], v[112:115], v[140:143]
    v_exp_f32 v158, v158
    v_exp_f32 v159, v159
    v_mfma_f32_16x16x32_bf16 v[144:147], v[92:95], v[128:131], v[144:147]
    ds_read_b128 v[84:87], v3 offset:6144
    v_add_f32 v15, v15, v158
    s_waitcnt lgkmcnt(3)
    v_mfma_f32_16x16x32_bf16 v[148:151], v[96:99], v[112:115], v[148:151]
    v_add_f32 v15, v15, v159
    v_mfma_f32_16x16x32_bf16 v[152:155], v[96:99], v[128:131], v[152:155]
    ds_read_b128 v[88:91], v3 offset:7168
    v_cvt_pk_bf16_f32 v197, v158, v159
    s_waitcnt lgkmcnt(3)
    v_mfma_f32_16x16x32_bf16 v[140:143], v[100:103], v[116:119], v[140:143]
    v_exp_f32 v160, v160
    v_exp_f32 v161, v161
    v_mfma_f32_16x16x32_bf16 v[144:147], v[100:103], v[132:135], v[144:147]
    ds_read_b128 v[92:95], v2 offset:40960
    v_add_f32 v16, v16, v160
    s_waitcnt lgkmcnt(3)
    v_mfma_f32_16x16x32_bf16 v[148:151], v[104:107], v[116:119], v[148:151]
    v_add_f32 v16, v16, v161
    v_mfma_f32_16x16x32_bf16 v[152:155], v[104:107], v[132:135], v[152:155]
    ds_read_b128 v[96:99], v2 offset:41984
    v_cvt_pk_bf16_f32 v200, v160, v161
    s_waitcnt lgkmcnt(3)
    v_mfma_f32_16x16x32_bf16 v[140:143], v[84:87], v[120:123], v[140:143]
    v_exp_f32 v162, v162
    v_exp_f32 v163, v163
    v_mfma_f32_16x16x32_bf16 v[144:147], v[84:87], v[136:139], v[144:147]
    ds_read_b128 v[100:103], v2 offset:43008
    v_add_f32 v16, v16, v162
    s_waitcnt lgkmcnt(3)
    v_mfma_f32_16x16x32_bf16 v[148:151], v[88:91], v[120:123], v[148:151]
    v_add_f32 v16, v16, v163
    v_mfma_f32_16x16x32_bf16 v[152:155], v[88:91], v[136:139], v[152:155]
    ds_read_b128 v[104:107], v2 offset:44032
    v_cvt_pk_bf16_f32 v201, v162, v163
    s_waitcnt lgkmcnt(3)
    v_mfma_f32_16x16x32_bf16 v[20:23], v[92:95], v[188:191], v[20:23]
    v_exp_f32 v164, v164
    v_exp_f32 v165, v165
    v_mfma_f32_16x16x32_bf16 v[24:27], v[92:95], v[192:195], v[24:27]
    ds_read_b128 v[84:87], v2 offset:45056
    v_add_f32 v15, v15, v164
    s_waitcnt lgkmcnt(3)
    v_mfma_f32_16x16x32_bf16 v[28:31], v[96:99], v[188:191], v[28:31]
    v_add_f32 v15, v15, v165
    v_mfma_f32_16x16x32_bf16 v[32:35], v[96:99], v[192:195], v[32:35]
    ds_read_b128 v[88:91], v2 offset:46080
    v_cvt_pk_bf16_f32 v198, v164, v165
    s_waitcnt lgkmcnt(3)
    v_mfma_f32_16x16x32_bf16 v[36:39], v[100:103], v[188:191], v[36:39]
    v_exp_f32 v166, v166
    v_exp_f32 v167, v167
    v_mfma_f32_16x16x32_bf16 v[40:43], v[100:103], v[192:195], v[40:43]
    ds_read_b128 v[92:95], v2 offset:47104
    v_add_f32 v15, v15, v166
    s_waitcnt lgkmcnt(3)
    v_mfma_f32_16x16x32_bf16 v[44:47], v[104:107], v[188:191], v[44:47]
    v_add_f32 v15, v15, v167
    v_mfma_f32_16x16x32_bf16 v[48:51], v[104:107], v[192:195], v[48:51]
    ds_read_b128 v[96:99], v2 offset:48128
    v_cvt_pk_bf16_f32 v199, v166, v167
    s_waitcnt lgkmcnt(3)
    v_mfma_f32_16x16x32_bf16 v[52:55], v[84:87], v[188:191], v[52:55]
    v_exp_f32 v168, v168
    v_exp_f32 v169, v169
    v_mfma_f32_16x16x32_bf16 v[56:59], v[84:87], v[192:195], v[56:59]
    s_barrier
    ds_read_b128 v[100:103], v3 offset:16384
    v_add_f32 v16, v16, v168
    s_waitcnt lgkmcnt(3)
    v_mfma_f32_16x16x32_bf16 v[60:63], v[88:91], v[188:191], v[60:63]
    v_add_f32 v16, v16, v169
    v_mfma_f32_16x16x32_bf16 v[64:67], v[88:91], v[192:195], v[64:67]
    ds_read_b128 v[104:107], v3 offset:17408
    v_cvt_pk_bf16_f32 v202, v168, v169
    s_waitcnt lgkmcnt(3)
    v_mfma_f32_16x16x32_bf16 v[68:71], v[92:95], v[188:191], v[68:71]
    v_exp_f32 v170, v170
    v_exp_f32 v171, v171
    v_mfma_f32_16x16x32_bf16 v[72:75], v[92:95], v[192:195], v[72:75]
    ds_read_b128 v[84:87], v3 offset:18432
    v_add_f32 v16, v16, v170
    s_waitcnt lgkmcnt(3)
    v_mfma_f32_16x16x32_bf16 v[76:79], v[96:99], v[188:191], v[76:79]
    v_add_f32 v16, v16, v171
    v_mfma_f32_16x16x32_bf16 v[80:83], v[96:99], v[192:195], v[80:83]
    ds_read_b128 v[88:91], v3 offset:19456
    v_cvt_pk_bf16_f32 v203, v170, v171
    s_waitcnt lgkmcnt(3)
    v_mfma_f32_16x16x32_bf16 v[156:159], v[100:103], v[108:111], v[172:175]
    v_exp_f32 v140, v140
    v_exp_f32 v141, v141
    v_mfma_f32_16x16x32_bf16 v[160:163], v[100:103], v[124:127], v[176:179]
    ds_read_b128 v[92:95], v3 offset:20480
    v_add_f32 v15, v15, v140
    s_waitcnt vmcnt(8)
    v_lshlrev_b32 v236, 16, v244
    v_and_b32 v237, 0xffff0000, v244
    v_lshlrev_b32 v238, 16, v245
    v_and_b32 v239, 0xffff0000, v245
    v_lshlrev_b32 v240, 16, v246
    v_and_b32 v241, 0xffff0000, v246
    v_lshlrev_b32 v242, 16, v247
    s_waitcnt lgkmcnt(3)
    v_mfma_f32_16x16x32_bf16 v[164:167], v[104:107], v[108:111], v[172:175]
    v_add_f32 v15, v15, v141
    v_mfma_f32_16x16x32_bf16 v[168:171], v[104:107], v[124:127], v[176:179]
    ds_read_b128 v[96:99], v3 offset:21504
    v_cvt_pk_bf16_f32 v188, v140, v141
    v_and_b32 v243, 0xffff0000, v247
    v_mul_f32 v4, 0xbfb8aa3b, v236
    v_exp_f32 v4, v4
    s_nop 0
    v_add_f32 v4, 1.0, v4
    v_rcp_f32 v4, v4
    s_nop 0
    v_mul_f32 v236, v236, v4
    v_mul_f32 v10, 0xbfb8aa3b, v237
    s_waitcnt lgkmcnt(3)
    v_mfma_f32_16x16x32_bf16 v[156:159], v[84:87], v[112:115], v[156:159]
    v_exp_f32 v142, v142
    v_exp_f32 v143, v143
    v_mfma_f32_16x16x32_bf16 v[160:163], v[84:87], v[128:131], v[160:163]
    ds_read_b128 v[100:103], v3 offset:22528
    v_add_f32 v15, v15, v142
    v_exp_f32 v10, v10
    s_nop 0
    v_add_f32 v10, 1.0, v10
    v_rcp_f32 v10, v10
    s_nop 0
    v_mul_f32 v237, v237, v10
    v_mul_f32 v5, 0xbfb8aa3b, v238
    v_exp_f32 v5, v5
    s_nop 0
    v_add_f32 v5, 1.0, v5
    s_waitcnt lgkmcnt(3)
    v_mfma_f32_16x16x32_bf16 v[164:167], v[88:91], v[112:115], v[164:167]
    v_add_f32 v15, v15, v143
    v_mfma_f32_16x16x32_bf16 v[168:171], v[88:91], v[128:131], v[168:171]
    ds_read_b128 v[104:107], v3 offset:23552
    v_cvt_pk_bf16_f32 v189, v142, v143
    v_rcp_f32 v5, v5
    s_nop 0
    v_mul_f32 v238, v238, v5
    v_mul_f32 v12, 0xbfb8aa3b, v239
    v_exp_f32 v12, v12
    s_nop 0
    v_add_f32 v12, 1.0, v12
    v_rcp_f32 v12, v12
    s_nop 0
    v_mul_f32 v239, v239, v12
    s_waitcnt lgkmcnt(3)
    v_mfma_f32_16x16x32_bf16 v[156:159], v[92:95], v[116:119], v[156:159]
    v_exp_f32 v144, v144
    v_exp_f32 v145, v145
    v_mfma_f32_16x16x32_bf16 v[160:163], v[92:95], v[132:135], v[160:163]
    ds_read_b128 v[84:87], v2 offset:57344
    v_add_f32 v16, v16, v144
    v_mul_f32 v4, 0xbfb8aa3b, v240
    v_exp_f32 v4, v4
    s_nop 0
    v_add_f32 v4, 1.0, v4
    v_rcp_f32 v4, v4
    s_nop 0
    v_mul_f32 v240, v240, v4
    v_mul_f32 v10, 0xbfb8aa3b, v241
    v_exp_f32 v10, v10
    s_waitcnt lgkmcnt(3)
    v_mfma_f32_16x16x32_bf16 v[164:167], v[96:99], v[116:119], v[164:167]
    v_add_f32 v16, v16, v145
    v_mfma_f32_16x16x32_bf16 v[168:171], v[96:99], v[132:135], v[168:171]
    ds_read_b128 v[88:91], v2 offset:58368
    v_cvt_pk_bf16_f32 v192, v144, v145
    v_add_f32 v10, 1.0, v10
    v_rcp_f32 v10, v10
    s_nop 0
    v_mul_f32 v241, v241, v10
    v_mul_f32 v5, 0xbfb8aa3b, v242
    v_exp_f32 v5, v5
    s_nop 0
    v_add_f32 v5, 1.0, v5
    v_rcp_f32 v5, v5
    s_and_b32 s26, s12, 24
    s_lshl_b32 s26, s26, 18
    s_lshr_b32 s27, s2, 3
    s_lshl_b32 s27, s27, 16
    s_add_u32 s26, s26, s27
    v_lshrrev_b32 v17, 6, v8
    v_lshlrev_b32 v17, 10, v17
    v_lshl_add_u32 v17, v0, 7, v17
    v_add_u32 v17, s26, v17
    v_cmp_gt_u32 vcc, 8, v0
    v_bfrev_b32 v18, -2
    s_nop 0
    v_cndmask_b32 v17, v18, v17, vcc
    s_waitcnt lgkmcnt(3)
    v_mfma_f32_16x16x32_bf16 v[156:159], v[100:103], v[120:123], v[156:159]
    v_exp_f32 v146, v146
    v_exp_f32 v147, v147
    v_mfma_f32_16x16x32_bf16 v[160:163], v[100:103], v[136:139], v[160:163]
    ds_read_b128 v[92:95], v2 offset:59392
    v_add_f32 v16, v16, v146
    v_mul_f32 v242, v242, v5
    v_mul_f32 v12, 0xbfb8aa3b, v243
    v_exp_f32 v12, v12
    s_nop 0
    v_add_f32 v12, 1.0, v12
    v_rcp_f32 v12, v12
    s_nop 0
    v_mul_f32 v243, v243, v12
    s_mov_b64 s[20:21], s[40:41]
    s_mov_b32 s22, 0x800000
    s_mov_b32 s23, 0x20000
    s_mov_b32 s26, 0x0
    buffer_load_dword v18, v17, s[20:23], s26 offen
    s_waitcnt lgkmcnt(3)
    v_mfma_f32_16x16x32_bf16 v[164:167], v[104:107], v[120:123], v[164:167]
    v_add_f32 v16, v16, v147
    v_mfma_f32_16x16x32_bf16 v[168:171], v[104:107], v[136:139], v[168:171]
    ds_read_b128 v[96:99], v2 offset:60416
    v_cvt_pk_bf16_f32 v193, v146, v147
    v_cvt_pk_bf16_f32 v4, v236, v237
    v_lshlrev_b32 v236, 16, v4
    v_and_b32 v237, 0xffff0000, v4
    v_cvt_pk_bf16_f32 v4, v238, v239
    v_lshlrev_b32 v238, 16, v4
    v_and_b32 v239, 0xffff0000, v4
    v_cvt_pk_bf16_f32 v4, v240, v241
    s_waitcnt lgkmcnt(3)
    v_mfma_f32_16x16x32_bf16 v[20:23], v[84:87], v[196:199], v[20:23]
    v_exp_f32 v148, v148
    v_exp_f32 v149, v149
    v_mfma_f32_16x16x32_bf16 v[24:27], v[84:87], v[200:203], v[24:27]
    ds_read_b128 v[100:103], v2 offset:61440
    v_add_f32 v15, v15, v148
    v_lshlrev_b32 v240, 16, v4
    v_and_b32 v241, 0xffff0000, v4
    v_cvt_pk_bf16_f32 v4, v242, v243
    v_lshlrev_b32 v242, 16, v4
    v_and_b32 v243, 0xffff0000, v4
    s_waitcnt vmcnt(8)
    v_lshlrev_b32 v4, 16, v204
    v_and_b32 v10, 0xffff0000, v204
    s_waitcnt lgkmcnt(3)
    v_mfma_f32_16x16x32_bf16 v[28:31], v[88:91], v[196:199], v[28:31]
    v_add_f32 v15, v15, v149
    v_mfma_f32_16x16x32_bf16 v[32:35], v[88:91], v[200:203], v[32:35]
    ds_read_b128 v[104:107], v2 offset:62464
    v_cvt_pk_bf16_f32 v190, v148, v149
    v_lshlrev_b32 v5, 16, v205
    v_and_b32 v12, 0xffff0000, v205
    v_mul_f32 v244, v236, v4
    v_mul_f32 v245, v236, v10
    v_mul_f32 v246, v236, v5
    v_mul_f32 v247, v236, v12
    v_lshlrev_b32 v4, 16, v206
    s_mov_b64 s[20:21], s[40:41]
    s_mov_b32 s22, 0x800000
    s_mov_b32 s23, 0x20000
    s_mov_b32 s26, 0x1000
    buffer_load_dword v18, v17, s[20:23], s26 offen
    s_waitcnt lgkmcnt(3)
    v_mfma_f32_16x16x32_bf16 v[36:39], v[92:95], v[196:199], v[36:39]
    v_exp_f32 v150, v150
    v_exp_f32 v151, v151
    v_mfma_f32_16x16x32_bf16 v[40:43], v[92:95], v[200:203], v[40:43]
    ds_read_b128 v[84:87], v2 offset:63488
    v_add_f32 v15, v15, v150
    v_and_b32 v10, 0xffff0000, v206
    v_lshlrev_b32 v5, 16, v207
    v_and_b32 v12, 0xffff0000, v207
    v_mul_f32 v248, v236, v4
    v_mul_f32 v249, v236, v10
    v_mul_f32 v250, v236, v5
    v_mul_f32 v251, v236, v12
    s_waitcnt lgkmcnt(3)
    v_mfma_f32_16x16x32_bf16 v[44:47], v[96:99], v[196:199], v[44:47]
    v_add_f32 v15, v15, v151
    v_mfma_f32_16x16x32_bf16 v[48:51], v[96:99], v[200:203], v[48:51]
    ds_read_b128 v[88:91], v2 offset:64512
    v_cvt_pk_bf16_f32 v191, v150, v151
    s_waitcnt vmcnt(8)
    v_lshlrev_b32 v4, 16, v208
    v_and_b32 v10, 0xffff0000, v208
    v_lshlrev_b32 v5, 16, v209
    v_and_b32 v12, 0xffff0000, v209
    v_fmac_f32 v244, v237, v4
    v_fmac_f32 v245, v237, v10
    v_fmac_f32 v246, v237, v5
    s_waitcnt lgkmcnt(3)
    v_mfma_f32_16x16x32_bf16 v[52:55], v[100:103], v[196:199], v[52:55]
    v_exp_f32 v152, v152
    v_exp_f32 v153, v153
    v_mfma_f32_16x16x32_bf16 v[56:59], v[100:103], v[200:203], v[56:59]
    s_barrier
    ds_read_b128 v[92:95], v2 offset:0
    v_add_f32 v16, v16, v152
    v_fmac_f32 v247, v237, v12
    v_lshlrev_b32 v4, 16, v210
    v_and_b32 v10, 0xffff0000, v210
    v_lshlrev_b32 v5, 16, v211
    v_and_b32 v12, 0xffff0000, v211
    v_fmac_f32 v248, v237, v4
    s_mov_b64 s[20:21], s[40:41]
    s_mov_b32 s22, 0x800000
    s_mov_b32 s23, 0x20000
    s_mov_b32 s26, 0x2000
    buffer_load_dword v18, v17, s[20:23], s26 offen
    s_waitcnt lgkmcnt(3)
    v_mfma_f32_16x16x32_bf16 v[60:63], v[104:107], v[196:199], v[60:63]
    v_add_f32 v16, v16, v153
    v_mfma_f32_16x16x32_bf16 v[64:67], v[104:107], v[200:203], v[64:67]
    ds_read_b128 v[96:99], v2 offset:1024
    v_cvt_pk_bf16_f32 v194, v152, v153
    v_fmac_f32 v249, v237, v10
    v_fmac_f32 v250, v237, v5
    v_fmac_f32 v251, v237, v12
    s_waitcnt vmcnt(8)
    v_lshlrev_b32 v4, 16, v212
    v_and_b32 v10, 0xffff0000, v212
    v_lshlrev_b32 v5, 16, v213
    v_and_b32 v12, 0xffff0000, v213
    s_waitcnt lgkmcnt(3)
    v_mfma_f32_16x16x32_bf16 v[68:71], v[84:87], v[196:199], v[68:71]
    v_exp_f32 v154, v154
    v_exp_f32 v155, v155
    v_mfma_f32_16x16x32_bf16 v[72:75], v[84:87], v[200:203], v[72:75]
    ds_read_b128 v[100:103], v2 offset:2048
    v_add_f32 v16, v16, v154
    v_fmac_f32 v244, v238, v4
    v_fmac_f32 v245, v238, v10
    v_fmac_f32 v246, v238, v5
    v_fmac_f32 v247, v238, v12
    v_lshlrev_b32 v4, 16, v214
    v_and_b32 v10, 0xffff0000, v214
    v_lshlrev_b32 v5, 16, v215
    s_waitcnt lgkmcnt(3)
    v_mfma_f32_16x16x32_bf16 v[76:79], v[88:91], v[196:199], v[76:79]
    v_add_f32 v16, v16, v155
    v_mfma_f32_16x16x32_bf16 v[80:83], v[88:91], v[200:203], v[80:83]
    ds_read_b128 v[104:107], v2 offset:3072
    v_cvt_pk_bf16_f32 v195, v154, v155
    v_and_b32 v12, 0xffff0000, v215
    v_fmac_f32 v248, v238, v4
    v_fmac_f32 v249, v238, v10
    v_fmac_f32 v250, v238, v5
    v_fmac_f32 v251, v238, v12
    s_waitcnt vmcnt(7)
    v_lshlrev_b32 v4, 16, v216
    v_and_b32 v10, 0xffff0000, v216
    s_waitcnt lgkmcnt(3)
    v_mfma_f32_16x16x32_bf16 v[140:143], v[92:95], v[108:111], v[172:175]
    v_exp_f32 v156, v156
    v_exp_f32 v157, v157
    v_mfma_f32_16x16x32_bf16 v[144:147], v[92:95], v[124:127], v[176:179]
    ds_read_b128 v[84:87], v2 offset:4096
    v_add_f32 v15, v15, v156
    v_lshlrev_b32 v5, 16, v217
    v_and_b32 v12, 0xffff0000, v217
    v_fmac_f32 v244, v239, v4
    v_fmac_f32 v245, v239, v10
    v_fmac_f32 v246, v239, v5
    v_fmac_f32 v247, v239, v12
    v_lshlrev_b32 v4, 16, v218
    s_mov_b64 s[20:21], s[40:41]
    s_mov_b32 s22, 0x800000
    s_mov_b32 s23, 0x20000
    s_mov_b32 s26, 0x3000
    buffer_load_dword v18, v17, s[20:23], s26 offen
    s_waitcnt lgkmcnt(3)
    v_mfma_f32_16x16x32_bf16 v[148:151], v[96:99], v[108:111], v[172:175]
    v_add_f32 v15, v15, v157
    v_mfma_f32_16x16x32_bf16 v[152:155], v[96:99], v[124:127], v[176:179]
    ds_read_b128 v[88:91], v2 offset:5120
    v_cvt_pk_bf16_f32 v196, v156, v157
    v_and_b32 v10, 0xffff0000, v218
    v_lshlrev_b32 v5, 16, v219
    v_and_b32 v12, 0xffff0000, v219
    v_fmac_f32 v248, v239, v4
    v_fmac_f32 v249, v239, v10
    v_fmac_f32 v250, v239, v5
    v_fmac_f32 v251, v239, v12
    s_waitcnt lgkmcnt(3)
    v_mfma_f32_16x16x32_bf16 v[140:143], v[100:103], v[112:115], v[140:143]
    v_exp_f32 v158, v158
    v_exp_f32 v159, v159
    v_mfma_f32_16x16x32_bf16 v[144:147], v[100:103], v[128:131], v[144:147]
    ds_read_b128 v[92:95], v2 offset:6144
    v_add_f32 v15, v15, v158
    s_waitcnt vmcnt(7)
    v_lshlrev_b32 v4, 16, v220
    v_and_b32 v10, 0xffff0000, v220
    v_lshlrev_b32 v5, 16, v221
    v_and_b32 v12, 0xffff0000, v221
    v_fmac_f32 v244, v240, v4
    v_fmac_f32 v245, v240, v10
    s_waitcnt lgkmcnt(3)
    v_mfma_f32_16x16x32_bf16 v[148:151], v[104:107], v[112:115], v[148:151]
    v_add_f32 v15, v15, v159
    v_mfma_f32_16x16x32_bf16 v[152:155], v[104:107], v[128:131], v[152:155]
    ds_read_b128 v[96:99], v2 offset:7168
    v_cvt_pk_bf16_f32 v197, v158, v159
    v_fmac_f32 v246, v240, v5
    v_fmac_f32 v247, v240, v12
    v_lshlrev_b32 v4, 16, v222
    v_and_b32 v10, 0xffff0000, v222
    v_lshlrev_b32 v5, 16, v223
    v_and_b32 v12, 0xffff0000, v223
    v_fmac_f32 v248, v240, v4
    s_mov_b64 s[20:21], s[40:41]
    s_mov_b32 s22, 0x800000
    s_mov_b32 s23, 0x20000
    s_mov_b32 s26, 0x4000
    buffer_load_dword v18, v17, s[20:23], s26 offen
    s_waitcnt lgkmcnt(3)
    v_mfma_f32_16x16x32_bf16 v[140:143], v[84:87], v[116:119], v[140:143]
    v_exp_f32 v160, v160
    v_exp_f32 v161, v161
    v_mfma_f32_16x16x32_bf16 v[144:147], v[84:87], v[132:135], v[144:147]
    ds_read_b128 v[100:103], v3 offset:8192
    v_add_f32 v16, v16, v160
    v_fmac_f32 v249, v240, v10
    v_fmac_f32 v250, v240, v5
    v_fmac_f32 v251, v240, v12
    s_waitcnt vmcnt(7)
    v_lshlrev_b32 v4, 16, v224
    v_and_b32 v10, 0xffff0000, v224
    v_lshlrev_b32 v5, 16, v225
    v_and_b32 v12, 0xffff0000, v225
    s_waitcnt lgkmcnt(3)
    v_mfma_f32_16x16x32_bf16 v[148:151], v[88:91], v[116:119], v[148:151]
    v_add_f32 v16, v16, v161
    v_mfma_f32_16x16x32_bf16 v[152:155], v[88:91], v[132:135], v[152:155]
    ds_read_b128 v[104:107], v3 offset:9216
    v_cvt_pk_bf16_f32 v200, v160, v161
    v_fmac_f32 v244, v241, v4
    v_fmac_f32 v245, v241, v10
    v_fmac_f32 v246, v241, v5
    v_fmac_f32 v247, v241, v12
    v_lshlrev_b32 v4, 16, v226
    v_and_b32 v10, 0xffff0000, v226
    v_lshlrev_b32 v5, 16, v227
    s_waitcnt lgkmcnt(3)
    v_mfma_f32_16x16x32_bf16 v[140:143], v[92:95], v[120:123], v[140:143]
    v_exp_f32 v162, v162
    v_exp_f32 v163, v163
    v_mfma_f32_16x16x32_bf16 v[144:147], v[92:95], v[136:139], v[144:147]
    ds_read_b128 v[84:87], v3 offset:10240
    v_add_f32 v16, v16, v162
    v_and_b32 v12, 0xffff0000, v227
    v_fmac_f32 v248, v241, v4
    v_fmac_f32 v249, v241, v10
    v_fmac_f32 v250, v241, v5
    v_fmac_f32 v251, v241, v12
    s_waitcnt vmcnt(6)
    v_lshlrev_b32 v4, 16, v228
    v_and_b32 v10, 0xffff0000, v228
    s_waitcnt lgkmcnt(3)
    v_mfma_f32_16x16x32_bf16 v[148:151], v[96:99], v[120:123], v[148:151]
    v_add_f32 v16, v16, v163
    v_mfma_f32_16x16x32_bf16 v[152:155], v[96:99], v[136:139], v[152:155]
    ds_read_b128 v[88:91], v3 offset:11264
    v_cvt_pk_bf16_f32 v201, v162, v163
    v_lshlrev_b32 v5, 16, v229
    v_and_b32 v12, 0xffff0000, v229
    v_fmac_f32 v244, v242, v4
    v_fmac_f32 v245, v242, v10
    v_fmac_f32 v246, v242, v5
    v_fmac_f32 v247, v242, v12
    v_lshlrev_b32 v4, 16, v230
    s_mov_b64 s[20:21], s[40:41]
    s_mov_b32 s22, 0x800000
    s_mov_b32 s23, 0x20000
    s_mov_b32 s26, 0x5000
    buffer_load_dword v18, v17, s[20:23], s26 offen
    s_waitcnt lgkmcnt(3)
    v_mfma_f32_16x16x32_bf16 v[20:23], v[100:103], v[188:191], v[20:23]
    v_exp_f32 v164, v164
    v_exp_f32 v165, v165
    v_mfma_f32_16x16x32_bf16 v[24:27], v[100:103], v[192:195], v[24:27]
    ds_read_b128 v[92:95], v3 offset:12288
    v_add_f32 v15, v15, v164
    v_and_b32 v10, 0xffff0000, v230
    v_lshlrev_b32 v5, 16, v231
    v_and_b32 v12, 0xffff0000, v231
    v_fmac_f32 v248, v242, v4
    v_fmac_f32 v249, v242, v10
    v_fmac_f32 v250, v242, v5
    s_waitcnt lgkmcnt(3)
    v_mfma_f32_16x16x32_bf16 v[28:31], v[104:107], v[188:191], v[28:31]
    v_add_f32 v15, v15, v165
    v_mfma_f32_16x16x32_bf16 v[32:35], v[104:107], v[192:195], v[32:35]
    ds_read_b128 v[96:99], v3 offset:13312
    v_cvt_pk_bf16_f32 v198, v164, v165
    v_fmac_f32 v251, v242, v12
    s_waitcnt vmcnt(6)
    v_lshlrev_b32 v4, 16, v232
    v_and_b32 v10, 0xffff0000, v232
    v_lshlrev_b32 v5, 16, v233
    v_and_b32 v12, 0xffff0000, v233
    v_fmac_f32 v244, v243, v4
    v_fmac_f32 v245, v243, v10
    s_waitcnt lgkmcnt(3)
    v_mfma_f32_16x16x32_bf16 v[36:39], v[84:87], v[188:191], v[36:39]
    v_exp_f32 v166, v166
    v_exp_f32 v167, v167
    v_mfma_f32_16x16x32_bf16 v[40:43], v[84:87], v[192:195], v[40:43]
    ds_read_b128 v[100:103], v3 offset:14336
    v_add_f32 v15, v15, v166
    v_fmac_f32 v246, v243, v5
    v_fmac_f32 v247, v243, v12
    v_lshlrev_b32 v4, 16, v234
    v_and_b32 v10, 0xffff0000, v234
    v_lshlrev_b32 v5, 16, v235
    v_and_b32 v12, 0xffff0000, v235
    v_fmac_f32 v248, v243, v4
    s_mov_b64 s[20:21], s[40:41]
    s_mov_b32 s22, 0x800000
    s_mov_b32 s23, 0x20000
    s_mov_b32 s26, 0x6000
    buffer_load_dword v18, v17, s[20:23], s26 offen
    s_waitcnt lgkmcnt(3)
    v_mfma_f32_16x16x32_bf16 v[44:47], v[88:91], v[188:191], v[44:47]
    v_add_f32 v15, v15, v167
    v_mfma_f32_16x16x32_bf16 v[48:51], v[88:91], v[192:195], v[48:51]
    ds_read_b128 v[104:107], v3 offset:15360
    v_cvt_pk_bf16_f32 v199, v166, v167
    v_fmac_f32 v249, v243, v10
    v_fmac_f32 v250, v243, v5
    v_fmac_f32 v251, v243, v12
    v_permlane32_swap_b32 v244, v248
    v_permlane32_swap_b32 v245, v249
    v_permlane32_swap_b32 v246, v250
    v_permlane32_swap_b32 v247, v251
    s_waitcnt lgkmcnt(3)
    v_mfma_f32_16x16x32_bf16 v[52:55], v[92:95], v[188:191], v[52:55]
    v_exp_f32 v168, v168
    v_exp_f32 v169, v169
    v_mfma_f32_16x16x32_bf16 v[56:59], v[92:95], v[192:195], v[56:59]
    s_barrier
    ds_read_b128 v[84:87], v2 offset:16384
    v_add_f32 v16, v16, v168
    v_add_f32 v244, v244, v248
    v_add_f32 v245, v245, v249
    v_add_f32 v246, v246, v250
    v_add_f32 v247, v247, v251
    s_nop 0
    v_permlane16_swap_b32 v244, v246
    v_permlane16_swap_b32 v245, v247
    v_add_f32 v244, v244, v246
    s_waitcnt lgkmcnt(3)
    v_mfma_f32_16x16x32_bf16 v[60:63], v[96:99], v[188:191], v[60:63]
    v_add_f32 v16, v16, v169
    v_mfma_f32_16x16x32_bf16 v[64:67], v[96:99], v[192:195], v[64:67]
    ds_read_b128 v[88:91], v2 offset:17408
    v_cvt_pk_bf16_f32 v202, v168, v169
    v_add_f32 v245, v245, v247
    v_add_f32_dpp v244, v244, v244 row_ror:8 row_mask:0xf bank_mask:0xf
    s_nop 0
    v_add_f32_dpp v245, v245, v245 row_ror:8 row_mask:0xf bank_mask:0xf
    v_add_f32_dpp v244, v244, v244 row_ror:4 row_mask:0xf bank_mask:0xf
    s_nop 0
    v_add_f32_dpp v245, v245, v245 row_ror:4 row_mask:0xf bank_mask:0xf
    v_add_f32_dpp v244, v244, v244 row_ror:2 row_mask:0xf bank_mask:0xf
    s_nop 0
    v_add_f32_dpp v245, v245, v245 row_ror:2 row_mask:0xf bank_mask:0xf
    s_waitcnt lgkmcnt(3)
    v_mfma_f32_16x16x32_bf16 v[68:71], v[100:103], v[188:191], v[68:71]
    v_exp_f32 v170, v170
    v_exp_f32 v171, v171
    v_mfma_f32_16x16x32_bf16 v[72:75], v[100:103], v[192:195], v[72:75]
    ds_read_b128 v[92:95], v2 offset:18432
    v_add_f32 v16, v16, v170
    v_lshrrev_b32 v13, 6, v8
    v_lshlrev_b32 v13, 6, v13
    v_lshl_add_u32 v13, v14, 5, v13
    v_bfe_u32 v14, v8, 4, 2
    v_lshl_add_u32 v13, v14, 3, v13
    ds_write_b64 v13, v[244:245] offset:49152
    s_mov_b64 s[20:21], s[40:41]
    s_mov_b32 s22, 0x800000
    s_mov_b32 s23, 0x20000
    s_mov_b32 s26, 0x7000
    buffer_load_dword v18, v17, s[20:23], s26 offen
    s_waitcnt lgkmcnt(4)
    v_mfma_f32_16x16x32_bf16 v[76:79], v[104:107], v[188:191], v[76:79]
    v_add_f32 v16, v16, v171
    v_mfma_f32_16x16x32_bf16 v[80:83], v[104:107], v[192:195], v[80:83]
    ds_read_b128 v[96:99], v2 offset:19456
    v_cvt_pk_bf16_f32 v203, v170, v171
    s_waitcnt lgkmcnt(4)
    v_mfma_f32_16x16x32_bf16 v[156:159], v[84:87], v[108:111], v[172:175]
    v_exp_f32 v140, v140
    v_exp_f32 v141, v141
    v_mfma_f32_16x16x32_bf16 v[160:163], v[84:87], v[124:127], v[176:179]
    ds_read_b128 v[100:103], v2 offset:20480
    v_add_f32 v15, v15, v140
    s_waitcnt lgkmcnt(4)
    v_mfma_f32_16x16x32_bf16 v[164:167], v[88:91], v[108:111], v[172:175]
    v_add_f32 v15, v15, v141
    v_mfma_f32_16x16x32_bf16 v[168:171], v[88:91], v[124:127], v[176:179]
    ds_read_b128 v[104:107], v2 offset:21504
    v_cvt_pk_bf16_f32 v188, v140, v141
    s_mov_b64 s[20:21], s[40:41]
    s_mov_b32 s22, 0x800000
    s_mov_b32 s23, 0x20000
    s_mov_b32 s26, 0x8000
    buffer_load_dword v18, v17, s[20:23], s26 offen
    s_waitcnt lgkmcnt(4)
    v_mfma_f32_16x16x32_bf16 v[156:159], v[92:95], v[112:115], v[156:159]
    v_exp_f32 v142, v142
    v_exp_f32 v143, v143
    v_mfma_f32_16x16x32_bf16 v[160:163], v[92:95], v[128:131], v[160:163]
    ds_read_b128 v[84:87], v2 offset:22528
    v_add_f32 v15, v15, v142
    s_waitcnt lgkmcnt(3)
    v_mfma_f32_16x16x32_bf16 v[164:167], v[96:99], v[112:115], v[164:167]
    v_add_f32 v15, v15, v143
    v_mfma_f32_16x16x32_bf16 v[168:171], v[96:99], v[128:131], v[168:171]
    ds_read_b128 v[88:91], v2 offset:23552
    v_cvt_pk_bf16_f32 v189, v142, v143
    s_waitcnt lgkmcnt(0)
    v_mfma_f32_16x16x32_bf16 v[156:159], v[100:103], v[116:119], v[156:159]
    v_exp_f32 v144, v144
    v_exp_f32 v145, v145
    v_mfma_f32_16x16x32_bf16 v[160:163], v[100:103], v[132:135], v[160:163]
    ds_read_b128 v[92:95], v3 offset:24576
    v_add_f32 v16, v16, v144
    s_mov_b64 s[20:21], s[40:41]
    s_mov_b32 s22, 0x800000
    s_mov_b32 s23, 0x20000
    s_mov_b32 s26, 0x9000
    buffer_load_dword v18, v17, s[20:23], s26 offen
    v_mfma_f32_16x16x32_bf16 v[164:167], v[104:107], v[116:119], v[164:167]
    v_add_f32 v16, v16, v145
    v_mfma_f32_16x16x32_bf16 v[168:171], v[104:107], v[132:135], v[168:171]
    ds_read_b128 v[96:99], v3 offset:25600
    v_cvt_pk_bf16_f32 v192, v144, v145
    v_mfma_f32_16x16x32_bf16 v[156:159], v[84:87], v[120:123], v[156:159]
    v_exp_f32 v146, v146
    v_exp_f32 v147, v147
    v_mfma_f32_16x16x32_bf16 v[160:163], v[84:87], v[136:139], v[160:163]
    ds_read_b128 v[100:103], v3 offset:26624
    v_add_f32 v16, v16, v146
    v_mfma_f32_16x16x32_bf16 v[164:167], v[88:91], v[120:123], v[164:167]
    v_add_f32 v16, v16, v147
    v_mfma_f32_16x16x32_bf16 v[168:171], v[88:91], v[136:139], v[168:171]
    ds_read_b128 v[104:107], v3 offset:27648
    v_cvt_pk_bf16_f32 v193, v146, v147
    s_waitcnt lgkmcnt(3)
    v_mfma_f32_16x16x32_bf16 v[20:23], v[92:95], v[196:199], v[20:23]
    v_exp_f32 v148, v148
    v_exp_f32 v149, v149
    v_mfma_f32_16x16x32_bf16 v[24:27], v[92:95], v[200:203], v[24:27]
    ds_read_b128 v[84:87], v3 offset:28672
    v_add_f32 v15, v15, v148
    s_mov_b64 s[20:21], s[40:41]
    s_mov_b32 s22, 0x800000
    s_mov_b32 s23, 0x20000
    s_mov_b32 s26, 0xa000
    buffer_load_dword v18, v17, s[20:23], s26 offen
    s_waitcnt lgkmcnt(3)
    v_mfma_f32_16x16x32_bf16 v[28:31], v[96:99], v[196:199], v[28:31]
    v_add_f32 v15, v15, v149
    v_mfma_f32_16x16x32_bf16 v[32:35], v[96:99], v[200:203], v[32:35]
    ds_read_b128 v[88:91], v3 offset:29696
    v_cvt_pk_bf16_f32 v190, v148, v149
    s_waitcnt lgkmcnt(3)
    v_mfma_f32_16x16x32_bf16 v[36:39], v[100:103], v[196:199], v[36:39]
    v_exp_f32 v150, v150
    v_exp_f32 v151, v151
    v_mfma_f32_16x16x32_bf16 v[40:43], v[100:103], v[200:203], v[40:43]
    ds_read_b128 v[92:95], v3 offset:30720
    v_add_f32 v15, v15, v150
    s_waitcnt lgkmcnt(3)
    v_mfma_f32_16x16x32_bf16 v[44:47], v[104:107], v[196:199], v[44:47]
    v_add_f32 v15, v15, v151
    v_mfma_f32_16x16x32_bf16 v[48:51], v[104:107], v[200:203], v[48:51]
    ds_read_b128 v[96:99], v3 offset:31744
    v_cvt_pk_bf16_f32 v191, v150, v151
    s_mov_b64 s[20:21], s[40:41]
    s_mov_b32 s22, 0x800000
    s_mov_b32 s23, 0x20000
    s_mov_b32 s26, 0xb000
    buffer_load_dword v18, v17, s[20:23], s26 offen
    s_waitcnt lgkmcnt(3)
    v_mfma_f32_16x16x32_bf16 v[52:55], v[84:87], v[196:199], v[52:55]
    v_exp_f32 v152, v152
    v_exp_f32 v153, v153
    v_mfma_f32_16x16x32_bf16 v[56:59], v[84:87], v[200:203], v[56:59]
    s_barrier
    ds_read_b128 v[100:103], v2 offset:32768
    v_add_f32 v16, v16, v152
    s_waitcnt lgkmcnt(3)
    v_mfma_f32_16x16x32_bf16 v[60:63], v[88:91], v[196:199], v[60:63]
    v_add_f32 v16, v16, v153
    v_mfma_f32_16x16x32_bf16 v[64:67], v[88:91], v[200:203], v[64:67]
    ds_read_b128 v[104:107], v2 offset:33792
    v_cvt_pk_bf16_f32 v194, v152, v153
    s_waitcnt lgkmcnt(3)
    v_mfma_f32_16x16x32_bf16 v[68:71], v[92:95], v[196:199], v[68:71]
    v_exp_f32 v154, v154
    v_exp_f32 v155, v155
    v_mfma_f32_16x16x32_bf16 v[72:75], v[92:95], v[200:203], v[72:75]
    ds_read_b128 v[84:87], v2 offset:34816
    v_add_f32 v16, v16, v154
    s_waitcnt lgkmcnt(3)
    v_mfma_f32_16x16x32_bf16 v[76:79], v[96:99], v[196:199], v[76:79]
    v_add_f32 v16, v16, v155
    v_mfma_f32_16x16x32_bf16 v[80:83], v[96:99], v[200:203], v[80:83]
    ds_read_b128 v[88:91], v2 offset:35840
    v_cvt_pk_bf16_f32 v195, v154, v155
    s_mov_b64 s[20:21], s[40:41]
    s_mov_b32 s22, 0x800000
    s_mov_b32 s23, 0x20000
    s_mov_b32 s26, 0xc000
    buffer_load_dword v18, v17, s[20:23], s26 offen
    s_waitcnt lgkmcnt(3)
    v_mfma_f32_16x16x32_bf16 v[140:143], v[100:103], v[108:111], v[172:175]
    v_exp_f32 v156, v156
    v_exp_f32 v157, v157
    v_mfma_f32_16x16x32_bf16 v[144:147], v[100:103], v[124:127], v[176:179]
    ds_read_b128 v[92:95], v2 offset:36864
    v_add_f32 v15, v15, v156
    s_waitcnt lgkmcnt(3)
    v_mfma_f32_16x16x32_bf16 v[148:151], v[104:107], v[108:111], v[172:175]
    v_add_f32 v15, v15, v157
    v_mfma_f32_16x16x32_bf16 v[152:155], v[104:107], v[124:127], v[176:179]
    ds_read_b128 v[96:99], v2 offset:37888
    v_cvt_pk_bf16_f32 v196, v156, v157
    s_waitcnt lgkmcnt(3)
    v_mfma_f32_16x16x32_bf16 v[140:143], v[84:87], v[112:115], v[140:143]
    v_exp_f32 v158, v158
    v_exp_f32 v159, v159
    v_mfma_f32_16x16x32_bf16 v[144:147], v[84:87], v[128:131], v[144:147]
    ds_read_b128 v[100:103], v2 offset:38912
    v_add_f32 v15, v15, v158
    v_and_b32 v13, 15, v0
    v_lshlrev_b32 v13, 2, v13
    ds_read_b32 v244, v13 offset:49152
    ds_read_b32 v245, v13 offset:49216
    ds_read_b32 v246, v13 offset:49280
    ds_read_b32 v247, v13 offset:49344
    s_mov_b64 s[20:21], s[40:41]
    s_mov_b32 s22, 0x800000
    s_mov_b32 s23, 0x20000
    s_mov_b32 s26, 0xd000
    buffer_load_dword v18, v17, s[20:23], s26 offen
    s_waitcnt lgkmcnt(7)
    v_mfma_f32_16x16x32_bf16 v[148:151], v[88:91], v[112:115], v[148:151]
    v_add_f32 v15, v15, v159
    v_mfma_f32_16x16x32_bf16 v[152:155], v[88:91], v[128:131], v[152:155]
    ds_read_b128 v[104:107], v2 offset:39936
    v_cvt_pk_bf16_f32 v197, v158, v159
    s_waitcnt lgkmcnt(7)
    v_mfma_f32_16x16x32_bf16 v[140:143], v[92:95], v[116:119], v[140:143]
    v_exp_f32 v160, v160
    v_exp_f32 v161, v161
    v_mfma_f32_16x16x32_bf16 v[144:147], v[92:95], v[132:135], v[144:147]
    ds_read_b128 v[84:87], v2 offset:8192
    v_add_f32 v16, v16, v160
    s_waitcnt lgkmcnt(7)
    v_mfma_f32_16x16x32_bf16 v[148:151], v[96:99], v[116:119], v[148:151]
    v_add_f32 v16, v16, v161
    v_mfma_f32_16x16x32_bf16 v[152:155], v[96:99], v[132:135], v[152:155]
    ds_read_b128 v[88:91], v2 offset:9216
    v_cvt_pk_bf16_f32 v200, v160, v161
    s_waitcnt lgkmcnt(7)
    v_mfma_f32_16x16x32_bf16 v[140:143], v[100:103], v[120:123], v[140:143]
    v_exp_f32 v162, v162
    v_exp_f32 v163, v163
    v_mfma_f32_16x16x32_bf16 v[144:147], v[100:103], v[136:139], v[144:147]
    ds_read_b128 v[92:95], v2 offset:10240
    v_add_f32 v16, v16, v162
    s_mov_b64 s[20:21], s[40:41]
    s_mov_b32 s22, 0x800000
    s_mov_b32 s23, 0x20000
    s_mov_b32 s26, 0xe000
    buffer_load_dword v18, v17, s[20:23], s26 offen
    s_waitcnt lgkmcnt(3)
    v_mfma_f32_16x16x32_bf16 v[148:151], v[104:107], v[120:123], v[148:151]
    v_add_f32 v16, v16, v163
    v_mfma_f32_16x16x32_bf16 v[152:155], v[104:107], v[136:139], v[152:155]
    ds_read_b128 v[96:99], v2 offset:11264
    v_cvt_pk_bf16_f32 v201, v162, v163
    s_waitcnt lgkmcnt(3)
    v_mfma_f32_16x16x32_bf16 v[20:23], v[84:87], v[188:191], v[20:23]
    v_exp_f32 v164, v164
    v_exp_f32 v165, v165
    v_mfma_f32_16x16x32_bf16 v[24:27], v[84:87], v[192:195], v[24:27]
    ds_read_b128 v[100:103], v2 offset:12288
    v_add_f32 v15, v15, v164
    v_add_f32 v244, v244, v246
    v_add_f32 v245, v245, v247
    v_add_f32 v244, v244, v245
    v_cvt_pk_bf16_f32 v244, v244, v244
    v_lshlrev_b32 v244, 16, v244
    s_lshr_b32 s26, s100, 6
    s_cmp_eq_u32 s26, 2
    s_cselect_b32 s26, 1.0, 0
    v_add_f32 v244, s26, v244
    v_cvt_pk_bf16_f32 v244, v244, v244
    v_lshlrev_b32 v244, 16, v244
    v_or_b32 v244, 1, v244
    s_lshl_b32 s26, s100, 6
    s_add_u32 s26, s26, 0xa20000
    s_cmp_eq_u32 s3, 4
    s_cselect_b32 s26, s26, 0x7ffffff0
    s_mov_b64 exec, 0xffff
    buffer_store_dword v244, v13, s[8:11], s26 offen sc1
    s_mov_b64 exec, -1
    s_nop 3
    s_waitcnt lgkmcnt(3)
    v_mfma_f32_16x16x32_bf16 v[28:31], v[88:91], v[188:191], v[28:31]
    v_add_f32 v15, v15, v165
    v_mfma_f32_16x16x32_bf16 v[32:35], v[88:91], v[192:195], v[32:35]
    ds_read_b128 v[104:107], v2 offset:13312
    v_cvt_pk_bf16_f32 v198, v164, v165
    s_mov_b64 s[20:21], s[40:41]
    s_mov_b32 s22, 0x800000
    s_mov_b32 s23, 0x20000
    s_mov_b32 s26, 0xf000
    buffer_load_dword v18, v17, s[20:23], s26 offen
    s_waitcnt lgkmcnt(3)
    v_mfma_f32_16x16x32_bf16 v[36:39], v[92:95], v[188:191], v[36:39]
    v_exp_f32 v166, v166
    v_exp_f32 v167, v167
    v_mfma_f32_16x16x32_bf16 v[40:43], v[92:95], v[192:195], v[40:43]
    ds_read_b128 v[84:87], v2 offset:14336
    v_add_f32 v15, v15, v166
    s_waitcnt lgkmcnt(3)
    v_mfma_f32_16x16x32_bf16 v[44:47], v[96:99], v[188:191], v[44:47]
    v_add_f32 v15, v15, v167
    v_mfma_f32_16x16x32_bf16 v[48:51], v[96:99], v[192:195], v[48:51]
    ds_read_b128 v[88:91], v2 offset:15360
    v_cvt_pk_bf16_f32 v199, v166, v167
    v_lshrrev_b32 v6, 3, v8
    v_and_b32 v7, 7, v8
    s_bfe_u32 s25, s2, 0x10002
    s_mul_i32 s25, s25, 28
    s_lshr_b32 s26, s2, 3
    s_add_u32 s25, s25, s26
    s_lshl_b32 s25, s25, 7
    s_bfe_u32 s24, s2, 0x10001
    s_mul_i32 s24, s24, 3670016
    s_add_u32 s24, s24, s25
    s_mov_b32 s26, 114688
    v_mul_lo_u32 v19, s26, v6
    v_lshl_add_u32 v19, v7, 4, v19
    s_bitcmp0_b32 s2, 0
    s_cselect_b32 s64, s46, s48
    s_cselect_b32 s65, s47, s49
    s_cmp_lt_u32 s2, 224
    s_cselect_b32 s66, 0x700000, 0
    s_mov_b32 s67, 0x20000
    s_waitcnt lgkmcnt(3)
    v_mfma_f32_16x16x32_bf16 v[52:55], v[100:103], v[188:191], v[52:55]
    v_exp_f32 v168, v168
    v_exp_f32 v169, v169
    v_mfma_f32_16x16x32_bf16 v[56:59], v[100:103], v[192:195], v[56:59]
    s_barrier
    ds_read_b128 v[92:95], v2 offset:49152
    v_add_f32 v16, v16, v168
    s_add_u32 s25, s24, 0
    buffer_load_dwordx4 v[204:207], v19, s[64:67], s25 offen
    s_waitcnt lgkmcnt(3)
    v_mfma_f32_16x16x32_bf16 v[60:63], v[104:107], v[188:191], v[60:63]
    v_add_f32 v16, v16, v169
    v_mfma_f32_16x16x32_bf16 v[64:67], v[104:107], v[192:195], v[64:67]
    ds_read_b128 v[96:99], v2 offset:50176
    v_cvt_pk_bf16_f32 v202, v168, v169
    s_waitcnt lgkmcnt(3)
    v_mfma_f32_16x16x32_bf16 v[68:71], v[84:87], v[188:191], v[68:71]
    v_exp_f32 v170, v170
    v_exp_f32 v171, v171
    v_mfma_f32_16x16x32_bf16 v[72:75], v[84:87], v[192:195], v[72:75]
    ds_read_b128 v[100:103], v2 offset:51200
    v_add_f32 v16, v16, v170
    s_waitcnt lgkmcnt(3)
    v_mfma_f32_16x16x32_bf16 v[76:79], v[88:91], v[188:191], v[76:79]
    v_add_f32 v16, v16, v171
    v_mfma_f32_16x16x32_bf16 v[80:83], v[88:91], v[192:195], v[80:83]
    ds_read_b128 v[104:107], v2 offset:52224
    v_cvt_pk_bf16_f32 v203, v170, v171
    s_waitcnt lgkmcnt(3)
    v_mfma_f32_16x16x32_bf16 v[156:159], v[92:95], v[108:111], v[172:175]
    v_exp_f32 v140, v140
    v_exp_f32 v141, v141
    v_mfma_f32_16x16x32_bf16 v[160:163], v[92:95], v[124:127], v[176:179]
    ds_read_b128 v[84:87], v2 offset:53248
    v_add_f32 v15, v15, v140
    s_add_u32 s25, s24, 7168
    buffer_load_dwordx4 v[208:211], v19, s[64:67], s25 offen
    s_waitcnt lgkmcnt(3)
    v_mfma_f32_16x16x32_bf16 v[164:167], v[96:99], v[108:111], v[172:175]
    v_add_f32 v15, v15, v141
    v_mfma_f32_16x16x32_bf16 v[168:171], v[96:99], v[124:127], v[176:179]
    ds_read_b128 v[88:91], v2 offset:54272
    v_cvt_pk_bf16_f32 v188, v140, v141
    s_waitcnt lgkmcnt(3)
    v_mfma_f32_16x16x32_bf16 v[156:159], v[100:103], v[112:115], v[156:159]
    v_exp_f32 v142, v142
    v_exp_f32 v143, v143
    v_mfma_f32_16x16x32_bf16 v[160:163], v[100:103], v[128:131], v[160:163]
    ds_read_b128 v[92:95], v2 offset:55296
    v_add_f32 v15, v15, v142
    s_waitcnt lgkmcnt(3)
    v_mfma_f32_16x16x32_bf16 v[164:167], v[104:107], v[112:115], v[164:167]
    v_add_f32 v15, v15, v143
    v_mfma_f32_16x16x32_bf16 v[168:171], v[104:107], v[128:131], v[168:171]
    ds_read_b128 v[96:99], v2 offset:56320
    v_cvt_pk_bf16_f32 v189, v142, v143
    s_waitcnt lgkmcnt(3)
    v_mfma_f32_16x16x32_bf16 v[156:159], v[84:87], v[116:119], v[156:159]
    v_exp_f32 v144, v144
    v_exp_f32 v145, v145
    v_mfma_f32_16x16x32_bf16 v[160:163], v[84:87], v[132:135], v[160:163]
    ds_read_b128 v[100:103], v2 offset:24576
    v_add_f32 v16, v16, v144
    s_add_u32 s25, s24, 14336
    buffer_load_dwordx4 v[212:215], v19, s[64:67], s25 offen
    s_waitcnt lgkmcnt(3)
    v_mfma_f32_16x16x32_bf16 v[164:167], v[88:91], v[116:119], v[164:167]
    v_add_f32 v16, v16, v145
    v_mfma_f32_16x16x32_bf16 v[168:171], v[88:91], v[132:135], v[168:171]
    ds_read_b128 v[104:107], v2 offset:25600
    v_cvt_pk_bf16_f32 v192, v144, v145
    s_waitcnt lgkmcnt(3)
    v_mfma_f32_16x16x32_bf16 v[156:159], v[92:95], v[120:123], v[156:159]
    v_exp_f32 v146, v146
    v_exp_f32 v147, v147
    v_mfma_f32_16x16x32_bf16 v[160:163], v[92:95], v[136:139], v[160:163]
    ds_read_b128 v[84:87], v2 offset:26624
    v_add_f32 v16, v16, v146
    s_waitcnt lgkmcnt(3)
    v_mfma_f32_16x16x32_bf16 v[164:167], v[96:99], v[120:123], v[164:167]
    v_add_f32 v16, v16, v147
    v_mfma_f32_16x16x32_bf16 v[168:171], v[96:99], v[136:139], v[168:171]
    ds_read_b128 v[88:91], v2 offset:27648
    v_cvt_pk_bf16_f32 v193, v146, v147
    s_waitcnt lgkmcnt(3)
    v_mfma_f32_16x16x32_bf16 v[20:23], v[100:103], v[196:199], v[20:23]
    v_exp_f32 v148, v148
    v_exp_f32 v149, v149
    v_mfma_f32_16x16x32_bf16 v[24:27], v[100:103], v[200:203], v[24:27]
    ds_read_b128 v[92:95], v2 offset:28672
    v_add_f32 v15, v15, v148
    s_waitcnt lgkmcnt(3)
    v_mfma_f32_16x16x32_bf16 v[28:31], v[104:107], v[196:199], v[28:31]
    v_add_f32 v15, v15, v149
    v_mfma_f32_16x16x32_bf16 v[32:35], v[104:107], v[200:203], v[32:35]
    ds_read_b128 v[96:99], v2 offset:29696
    v_cvt_pk_bf16_f32 v190, v148, v149
    s_add_u32 s25, s24, 21504
    buffer_load_dwordx4 v[216:219], v19, s[64:67], s25 offen
    s_waitcnt lgkmcnt(3)
    v_mfma_f32_16x16x32_bf16 v[36:39], v[84:87], v[196:199], v[36:39]
    v_exp_f32 v150, v150
    v_exp_f32 v151, v151
    v_mfma_f32_16x16x32_bf16 v[40:43], v[84:87], v[200:203], v[40:43]
    ds_read_b128 v[100:103], v2 offset:30720
    v_add_f32 v15, v15, v150
    s_waitcnt lgkmcnt(3)
    v_mfma_f32_16x16x32_bf16 v[44:47], v[88:91], v[196:199], v[44:47]
    v_add_f32 v15, v15, v151
    v_mfma_f32_16x16x32_bf16 v[48:51], v[88:91], v[200:203], v[48:51]
    ds_read_b128 v[104:107], v2 offset:31744
    v_cvt_pk_bf16_f32 v191, v150, v151
    s_waitcnt lgkmcnt(3)
    v_mfma_f32_16x16x32_bf16 v[52:55], v[92:95], v[196:199], v[52:55]
    v_exp_f32 v152, v152
    v_exp_f32 v153, v153
    v_mfma_f32_16x16x32_bf16 v[56:59], v[92:95], v[200:203], v[56:59]
    s_barrier
    ds_read_b128 v[84:87], v3 offset:0
    v_add_f32 v16, v16, v152
    s_waitcnt lgkmcnt(3)
    v_mfma_f32_16x16x32_bf16 v[60:63], v[96:99], v[196:199], v[60:63]
    v_add_f32 v16, v16, v153
    v_mfma_f32_16x16x32_bf16 v[64:67], v[96:99], v[200:203], v[64:67]
    ds_read_b128 v[88:91], v3 offset:1024
    v_cvt_pk_bf16_f32 v194, v152, v153
    s_add_u32 s25, s24, 28672
    buffer_load_dwordx4 v[220:223], v19, s[64:67], s25 offen
    s_waitcnt lgkmcnt(3)
    v_mfma_f32_16x16x32_bf16 v[68:71], v[100:103], v[196:199], v[68:71]
    v_exp_f32 v154, v154
    v_exp_f32 v155, v155
    v_mfma_f32_16x16x32_bf16 v[72:75], v[100:103], v[200:203], v[72:75]
    ds_read_b128 v[92:95], v3 offset:2048
    v_add_f32 v16, v16, v154
    s_waitcnt lgkmcnt(3)
    v_mfma_f32_16x16x32_bf16 v[76:79], v[104:107], v[196:199], v[76:79]
    v_add_f32 v16, v16, v155
    v_mfma_f32_16x16x32_bf16 v[80:83], v[104:107], v[200:203], v[80:83]
    ds_read_b128 v[96:99], v3 offset:3072
    v_cvt_pk_bf16_f32 v195, v154, v155
    s_waitcnt lgkmcnt(3)
    v_mfma_f32_16x16x32_bf16 v[140:143], v[84:87], v[108:111], v[172:175]
    v_exp_f32 v156, v156
    v_exp_f32 v157, v157
    v_mfma_f32_16x16x32_bf16 v[144:147], v[84:87], v[124:127], v[176:179]
    ds_read_b128 v[100:103], v3 offset:4096
    v_add_f32 v15, v15, v156
    s_waitcnt lgkmcnt(3)
    v_mfma_f32_16x16x32_bf16 v[148:151], v[88:91], v[108:111], v[172:175]
    v_add_f32 v15, v15, v157
    v_mfma_f32_16x16x32_bf16 v[152:155], v[88:91], v[124:127], v[176:179]
    ds_read_b128 v[104:107], v3 offset:5120
    v_cvt_pk_bf16_f32 v196, v156, v157
    s_waitcnt lgkmcnt(3)
    v_mfma_f32_16x16x32_bf16 v[140:143], v[92:95], v[112:115], v[140:143]
    v_exp_f32 v158, v158
    v_exp_f32 v159, v159
    v_mfma_f32_16x16x32_bf16 v[144:147], v[92:95], v[128:131], v[144:147]
    ds_read_b128 v[84:87], v3 offset:6144
    v_add_f32 v15, v15, v158
    s_add_u32 s25, s24, 35840
    buffer_load_dwordx4 v[224:227], v19, s[64:67], s25 offen
    s_waitcnt lgkmcnt(3)
    v_mfma_f32_16x16x32_bf16 v[148:151], v[96:99], v[112:115], v[148:151]
    v_add_f32 v15, v15, v159
    v_mfma_f32_16x16x32_bf16 v[152:155], v[96:99], v[128:131], v[152:155]
    ds_read_b128 v[88:91], v3 offset:7168
    v_cvt_pk_bf16_f32 v197, v158, v159
    s_waitcnt lgkmcnt(3)
    v_mfma_f32_16x16x32_bf16 v[140:143], v[100:103], v[116:119], v[140:143]
    v_exp_f32 v160, v160
    v_exp_f32 v161, v161
    v_mfma_f32_16x16x32_bf16 v[144:147], v[100:103], v[132:135], v[144:147]
    ds_read_b128 v[92:95], v2 offset:40960
    v_add_f32 v16, v16, v160
    s_waitcnt lgkmcnt(3)
    v_mfma_f32_16x16x32_bf16 v[148:151], v[104:107], v[116:119], v[148:151]
    v_add_f32 v16, v16, v161
    v_mfma_f32_16x16x32_bf16 v[152:155], v[104:107], v[132:135], v[152:155]
    ds_read_b128 v[96:99], v2 offset:41984
    v_cvt_pk_bf16_f32 v200, v160, v161
    s_waitcnt lgkmcnt(3)
    v_mfma_f32_16x16x32_bf16 v[140:143], v[84:87], v[120:123], v[140:143]
    v_exp_f32 v162, v162
    v_exp_f32 v163, v163
    v_mfma_f32_16x16x32_bf16 v[144:147], v[84:87], v[136:139], v[144:147]
    ds_read_b128 v[100:103], v2 offset:43008
    v_add_f32 v16, v16, v162
    s_add_u32 s25, s24, 43008
    buffer_load_dwordx4 v[228:231], v19, s[64:67], s25 offen
    s_waitcnt lgkmcnt(3)
    v_mfma_f32_16x16x32_bf16 v[148:151], v[88:91], v[120:123], v[148:151]
    v_add_f32 v16, v16, v163
    v_mfma_f32_16x16x32_bf16 v[152:155], v[88:91], v[136:139], v[152:155]
    ds_read_b128 v[104:107], v2 offset:44032
    v_cvt_pk_bf16_f32 v201, v162, v163
    s_waitcnt lgkmcnt(3)
    v_mfma_f32_16x16x32_bf16 v[20:23], v[92:95], v[188:191], v[20:23]
    v_exp_f32 v164, v164
    v_exp_f32 v165, v165
    v_mfma_f32_16x16x32_bf16 v[24:27], v[92:95], v[192:195], v[24:27]
    ds_read_b128 v[84:87], v2 offset:45056
    v_add_f32 v15, v15, v164
    s_waitcnt lgkmcnt(3)
    v_mfma_f32_16x16x32_bf16 v[28:31], v[96:99], v[188:191], v[28:31]
    v_add_f32 v15, v15, v165
    v_mfma_f32_16x16x32_bf16 v[32:35], v[96:99], v[192:195], v[32:35]
    ds_read_b128 v[88:91], v2 offset:46080
    v_cvt_pk_bf16_f32 v198, v164, v165
    s_waitcnt lgkmcnt(3)
    v_mfma_f32_16x16x32_bf16 v[36:39], v[100:103], v[188:191], v[36:39]
    v_exp_f32 v166, v166
    v_exp_f32 v167, v167
    v_mfma_f32_16x16x32_bf16 v[40:43], v[100:103], v[192:195], v[40:43]
    ds_read_b128 v[92:95], v2 offset:47104
    v_add_f32 v15, v15, v166
    s_add_u32 s25, s24, 50176
    buffer_load_dwordx4 v[232:235], v19, s[64:67], s25 offen
    s_waitcnt lgkmcnt(3)
    v_mfma_f32_16x16x32_bf16 v[44:47], v[104:107], v[188:191], v[44:47]
    v_add_f32 v15, v15, v167
    v_mfma_f32_16x16x32_bf16 v[48:51], v[104:107], v[192:195], v[48:51]
    ds_read_b128 v[96:99], v2 offset:48128
    v_cvt_pk_bf16_f32 v199, v166, v167
    s_waitcnt lgkmcnt(3)
    v_mfma_f32_16x16x32_bf16 v[52:55], v[84:87], v[188:191], v[52:55]
    v_exp_f32 v168, v168
    v_exp_f32 v169, v169
    v_mfma_f32_16x16x32_bf16 v[56:59], v[84:87], v[192:195], v[56:59]
    s_barrier
    ds_read_b128 v[100:103], v3 offset:16384
    v_add_f32 v16, v16, v168
    s_waitcnt lgkmcnt(3)
    v_mfma_f32_16x16x32_bf16 v[60:63], v[88:91], v[188:191], v[60:63]
    v_add_f32 v16, v16, v169
    v_mfma_f32_16x16x32_bf16 v[64:67], v[88:91], v[192:195], v[64:67]
    ds_read_b128 v[104:107], v3 offset:17408
    v_cvt_pk_bf16_f32 v202, v168, v169
    s_waitcnt lgkmcnt(3)
    v_mfma_f32_16x16x32_bf16 v[68:71], v[92:95], v[188:191], v[68:71]
    v_exp_f32 v170, v170
    v_exp_f32 v171, v171
    v_mfma_f32_16x16x32_bf16 v[72:75], v[92:95], v[192:195], v[72:75]
    ds_read_b128 v[84:87], v3 offset:18432
    v_add_f32 v16, v16, v170
    s_waitcnt lgkmcnt(3)
    v_mfma_f32_16x16x32_bf16 v[76:79], v[96:99], v[188:191], v[76:79]
    v_add_f32 v16, v16, v171
    v_mfma_f32_16x16x32_bf16 v[80:83], v[96:99], v[192:195], v[80:83]
    ds_read_b128 v[88:91], v3 offset:19456
    v_cvt_pk_bf16_f32 v203, v170, v171
    s_add_u32 s25, s24, 57344
    buffer_load_dwordx4 v[236:239], v19, s[64:67], s25 offen
    s_waitcnt lgkmcnt(3)
    v_mfma_f32_16x16x32_bf16 v[156:159], v[100:103], v[108:111], v[172:175]
    v_exp_f32 v140, v140
    v_exp_f32 v141, v141
    v_mfma_f32_16x16x32_bf16 v[160:163], v[100:103], v[124:127], v[176:179]
    ds_read_b128 v[92:95], v3 offset:20480
    v_add_f32 v15, v15, v140
    s_waitcnt lgkmcnt(3)
    v_mfma_f32_16x16x32_bf16 v[164:167], v[104:107], v[108:111], v[172:175]
    v_add_f32 v15, v15, v141
    v_mfma_f32_16x16x32_bf16 v[168:171], v[104:107], v[124:127], v[176:179]
    ds_read_b128 v[96:99], v3 offset:21504
    v_cvt_pk_bf16_f32 v188, v140, v141
    s_waitcnt lgkmcnt(3)
    v_mfma_f32_16x16x32_bf16 v[156:159], v[84:87], v[112:115], v[156:159]
    v_exp_f32 v142, v142
    v_exp_f32 v143, v143
    v_mfma_f32_16x16x32_bf16 v[160:163], v[84:87], v[128:131], v[160:163]
    ds_read_b128 v[100:103], v3 offset:22528
    v_add_f32 v15, v15, v142
    s_waitcnt lgkmcnt(3)
    v_mfma_f32_16x16x32_bf16 v[164:167], v[88:91], v[112:115], v[164:167]
    v_add_f32 v15, v15, v143
    v_mfma_f32_16x16x32_bf16 v[168:171], v[88:91], v[128:131], v[168:171]
    ds_read_b128 v[104:107], v3 offset:23552
    v_cvt_pk_bf16_f32 v189, v142, v143
    s_add_u32 s25, s24, 64512
    buffer_load_dwordx4 v[240:243], v19, s[64:67], s25 offen
    s_waitcnt lgkmcnt(3)
    v_mfma_f32_16x16x32_bf16 v[156:159], v[92:95], v[116:119], v[156:159]
    v_exp_f32 v144, v144
    v_exp_f32 v145, v145
    v_mfma_f32_16x16x32_bf16 v[160:163], v[92:95], v[132:135], v[160:163]
    ds_read_b128 v[84:87], v2 offset:57344
    v_add_f32 v16, v16, v144
    s_waitcnt lgkmcnt(3)
    v_mfma_f32_16x16x32_bf16 v[164:167], v[96:99], v[116:119], v[164:167]
    v_add_f32 v16, v16, v145
    v_mfma_f32_16x16x32_bf16 v[168:171], v[96:99], v[132:135], v[168:171]
    ds_read_b128 v[88:91], v2 offset:58368
    v_cvt_pk_bf16_f32 v192, v144, v145
    s_waitcnt lgkmcnt(3)
    v_mfma_f32_16x16x32_bf16 v[156:159], v[100:103], v[120:123], v[156:159]
    v_exp_f32 v146, v146
    v_exp_f32 v147, v147
    v_mfma_f32_16x16x32_bf16 v[160:163], v[100:103], v[136:139], v[160:163]
    ds_read_b128 v[92:95], v2 offset:59392
    v_add_f32 v16, v16, v146
    s_waitcnt lgkmcnt(3)
    v_mfma_f32_16x16x32_bf16 v[164:167], v[104:107], v[120:123], v[164:167]
    v_add_f32 v16, v16, v147
    v_mfma_f32_16x16x32_bf16 v[168:171], v[104:107], v[136:139], v[168:171]
    ds_read_b128 v[96:99], v2 offset:60416
    v_cvt_pk_bf16_f32 v193, v146, v147
    s_waitcnt lgkmcnt(3)
    v_mfma_f32_16x16x32_bf16 v[20:23], v[84:87], v[196:199], v[20:23]
    v_exp_f32 v148, v148
    v_exp_f32 v149, v149
    v_mfma_f32_16x16x32_bf16 v[24:27], v[84:87], v[200:203], v[24:27]
    ds_read_b128 v[100:103], v2 offset:61440
    v_add_f32 v15, v15, v148
    s_add_u32 s25, s24, 71680
    buffer_load_dwordx4 v[244:247], v19, s[64:67], s25 offen
    s_waitcnt lgkmcnt(3)
    v_mfma_f32_16x16x32_bf16 v[28:31], v[88:91], v[196:199], v[28:31]
    v_add_f32 v15, v15, v149
    v_mfma_f32_16x16x32_bf16 v[32:35], v[88:91], v[200:203], v[32:35]
    ds_read_b128 v[104:107], v2 offset:62464
    v_cvt_pk_bf16_f32 v190, v148, v149
    s_waitcnt lgkmcnt(3)
    v_mfma_f32_16x16x32_bf16 v[36:39], v[92:95], v[196:199], v[36:39]
    v_exp_f32 v150, v150
    v_exp_f32 v151, v151
    v_mfma_f32_16x16x32_bf16 v[40:43], v[92:95], v[200:203], v[40:43]
    ds_read_b128 v[84:87], v2 offset:63488
    v_add_f32 v15, v15, v150
    s_waitcnt lgkmcnt(3)
    v_mfma_f32_16x16x32_bf16 v[44:47], v[96:99], v[196:199], v[44:47]
    v_add_f32 v15, v15, v151
    v_mfma_f32_16x16x32_bf16 v[48:51], v[96:99], v[200:203], v[48:51]
    ds_read_b128 v[88:91], v2 offset:64512
    v_cvt_pk_bf16_f32 v191, v150, v151
    s_waitcnt lgkmcnt(3)
    v_mfma_f32_16x16x32_bf16 v[52:55], v[100:103], v[196:199], v[52:55]
    v_exp_f32 v152, v152
    v_exp_f32 v153, v153
    v_mfma_f32_16x16x32_bf16 v[56:59], v[100:103], v[200:203], v[56:59]
    s_barrier
    ds_read_b128 v[92:95], v2 offset:0
    v_add_f32 v16, v16, v152
    s_add_u32 s25, s24, 78848
    buffer_load_dwordx4 v[248:251], v19, s[64:67], s25 offen
    s_waitcnt lgkmcnt(3)
    v_mfma_f32_16x16x32_bf16 v[60:63], v[104:107], v[196:199], v[60:63]
    v_add_f32 v16, v16, v153
    v_mfma_f32_16x16x32_bf16 v[64:67], v[104:107], v[200:203], v[64:67]
    ds_read_b128 v[96:99], v2 offset:1024
    v_cvt_pk_bf16_f32 v194, v152, v153
    s_waitcnt lgkmcnt(3)
    v_mfma_f32_16x16x32_bf16 v[68:71], v[84:87], v[196:199], v[68:71]
    v_exp_f32 v154, v154
    v_exp_f32 v155, v155
    v_mfma_f32_16x16x32_bf16 v[72:75], v[84:87], v[200:203], v[72:75]
    ds_read_b128 v[100:103], v2 offset:2048
    v_add_f32 v16, v16, v154
    s_waitcnt lgkmcnt(3)
    v_mfma_f32_16x16x32_bf16 v[76:79], v[88:91], v[196:199], v[76:79]
    v_add_f32 v16, v16, v155
    v_mfma_f32_16x16x32_bf16 v[80:83], v[88:91], v[200:203], v[80:83]
    ds_read_b128 v[104:107], v2 offset:3072
    v_cvt_pk_bf16_f32 v195, v154, v155
    s_waitcnt lgkmcnt(3)
    v_mfma_f32_16x16x32_bf16 v[140:143], v[92:95], v[108:111], v[172:175]
    v_exp_f32 v156, v156
    v_exp_f32 v157, v157
    v_mfma_f32_16x16x32_bf16 v[144:147], v[92:95], v[124:127], v[176:179]
    ds_read_b128 v[84:87], v2 offset:4096
    v_add_f32 v15, v15, v156
    s_add_u32 s25, s24, 86016
    buffer_load_dwordx4 v[252:255], v19, s[64:67], s25 offen
    s_waitcnt lgkmcnt(3)
    v_mfma_f32_16x16x32_bf16 v[148:151], v[96:99], v[108:111], v[172:175]
    v_add_f32 v15, v15, v157
    v_mfma_f32_16x16x32_bf16 v[152:155], v[96:99], v[124:127], v[176:179]
    ds_read_b128 v[88:91], v2 offset:5120
    v_cvt_pk_bf16_f32 v196, v156, v157
    s_waitcnt lgkmcnt(3)
    v_mfma_f32_16x16x32_bf16 v[140:143], v[100:103], v[112:115], v[140:143]
    v_exp_f32 v158, v158
    v_exp_f32 v159, v159
    v_mfma_f32_16x16x32_bf16 v[144:147], v[100:103], v[128:131], v[144:147]
    ds_read_b128 v[92:95], v2 offset:6144
    v_add_f32 v15, v15, v158
    s_waitcnt lgkmcnt(3)
    v_mfma_f32_16x16x32_bf16 v[148:151], v[104:107], v[112:115], v[148:151]
    v_add_f32 v15, v15, v159
    v_mfma_f32_16x16x32_bf16 v[152:155], v[104:107], v[128:131], v[152:155]
    ds_read_b128 v[96:99], v2 offset:7168
    v_cvt_pk_bf16_f32 v197, v158, v159
    s_waitcnt lgkmcnt(3)
    v_mfma_f32_16x16x32_bf16 v[140:143], v[84:87], v[116:119], v[140:143]
    v_exp_f32 v160, v160
    v_exp_f32 v161, v161
    v_mfma_f32_16x16x32_bf16 v[144:147], v[84:87], v[132:135], v[144:147]
    ds_read_b128 v[100:103], v3 offset:8192
    v_add_f32 v16, v16, v160
    s_waitcnt lgkmcnt(3)
    v_mfma_f32_16x16x32_bf16 v[148:151], v[88:91], v[116:119], v[148:151]
    v_add_f32 v16, v16, v161
    v_mfma_f32_16x16x32_bf16 v[152:155], v[88:91], v[132:135], v[152:155]
    ds_read_b128 v[104:107], v3 offset:9216
    v_cvt_pk_bf16_f32 v200, v160, v161
    s_add_u32 s25, s24, 93184
    buffer_load_dwordx4 v[180:183], v19, s[64:67], s25 offen
    s_waitcnt lgkmcnt(3)
    v_mfma_f32_16x16x32_bf16 v[140:143], v[92:95], v[120:123], v[140:143]
    v_exp_f32 v162, v162
    v_exp_f32 v163, v163
    v_mfma_f32_16x16x32_bf16 v[144:147], v[92:95], v[136:139], v[144:147]
    ds_read_b128 v[84:87], v3 offset:10240
    v_add_f32 v16, v16, v162
    s_waitcnt lgkmcnt(3)
    v_mfma_f32_16x16x32_bf16 v[148:151], v[96:99], v[120:123], v[148:151]
    v_add_f32 v16, v16, v163
    v_mfma_f32_16x16x32_bf16 v[152:155], v[96:99], v[136:139], v[152:155]
    ds_read_b128 v[88:91], v3 offset:11264
    v_cvt_pk_bf16_f32 v201, v162, v163
    s_waitcnt lgkmcnt(3)
    v_mfma_f32_16x16x32_bf16 v[20:23], v[100:103], v[188:191], v[20:23]
    v_exp_f32 v164, v164
    v_exp_f32 v165, v165
    v_mfma_f32_16x16x32_bf16 v[24:27], v[100:103], v[192:195], v[24:27]
    ds_read_b128 v[92:95], v3 offset:12288
    v_add_f32 v15, v15, v164
    s_waitcnt lgkmcnt(3)
    v_mfma_f32_16x16x32_bf16 v[28:31], v[104:107], v[188:191], v[28:31]
    v_add_f32 v15, v15, v165
    v_mfma_f32_16x16x32_bf16 v[32:35], v[104:107], v[192:195], v[32:35]
    ds_read_b128 v[96:99], v3 offset:13312
    v_cvt_pk_bf16_f32 v198, v164, v165
    s_add_u32 s25, s24, 100352
    buffer_load_dwordx4 v[184:187], v19, s[64:67], s25 offen
    s_waitcnt lgkmcnt(3)
    v_mfma_f32_16x16x32_bf16 v[36:39], v[84:87], v[188:191], v[36:39]
    v_exp_f32 v166, v166
    v_exp_f32 v167, v167
    v_mfma_f32_16x16x32_bf16 v[40:43], v[84:87], v[192:195], v[40:43]
    ds_read_b128 v[100:103], v3 offset:14336
    v_add_f32 v15, v15, v166
    s_waitcnt lgkmcnt(3)
    v_mfma_f32_16x16x32_bf16 v[44:47], v[88:91], v[188:191], v[44:47]
    v_add_f32 v15, v15, v167
    v_mfma_f32_16x16x32_bf16 v[48:51], v[88:91], v[192:195], v[48:51]
    ds_read_b128 v[104:107], v3 offset:15360
    v_cvt_pk_bf16_f32 v199, v166, v167
    s_waitcnt lgkmcnt(3)
    v_mfma_f32_16x16x32_bf16 v[52:55], v[92:95], v[188:191], v[52:55]
    v_exp_f32 v168, v168
    v_exp_f32 v169, v169
    v_mfma_f32_16x16x32_bf16 v[56:59], v[92:95], v[192:195], v[56:59]
    s_barrier
    ds_read_b128 v[84:87], v2 offset:16384
    v_add_f32 v16, v16, v168
    s_waitcnt lgkmcnt(3)
    v_mfma_f32_16x16x32_bf16 v[60:63], v[96:99], v[188:191], v[60:63]
    v_add_f32 v16, v16, v169
    v_mfma_f32_16x16x32_bf16 v[64:67], v[96:99], v[192:195], v[64:67]
    ds_read_b128 v[88:91], v2 offset:17408
    v_cvt_pk_bf16_f32 v202, v168, v169
    s_waitcnt lgkmcnt(3)
    v_mfma_f32_16x16x32_bf16 v[68:71], v[100:103], v[188:191], v[68:71]
    v_exp_f32 v170, v170
    v_exp_f32 v171, v171
    v_mfma_f32_16x16x32_bf16 v[72:75], v[100:103], v[192:195], v[72:75]
    ds_read_b128 v[92:95], v2 offset:18432
    v_add_f32 v16, v16, v170
    s_waitcnt lgkmcnt(3)
    v_mfma_f32_16x16x32_bf16 v[76:79], v[104:107], v[188:191], v[76:79]
    v_add_f32 v16, v16, v171
    v_mfma_f32_16x16x32_bf16 v[80:83], v[104:107], v[192:195], v[80:83]
    ds_read_b128 v[96:99], v2 offset:19456
    v_cvt_pk_bf16_f32 v203, v170, v171
    s_waitcnt lgkmcnt(3)
    v_mfma_f32_16x16x32_bf16 v[156:159], v[84:87], v[108:111], v[172:175]
    v_exp_f32 v140, v140
    v_exp_f32 v141, v141
    v_mfma_f32_16x16x32_bf16 v[160:163], v[84:87], v[124:127], v[176:179]
    ds_read_b128 v[100:103], v2 offset:20480
    v_add_f32 v15, v15, v140
    s_waitcnt lgkmcnt(3)
    v_mfma_f32_16x16x32_bf16 v[164:167], v[88:91], v[108:111], v[172:175]
    v_add_f32 v15, v15, v141
    v_mfma_f32_16x16x32_bf16 v[168:171], v[88:91], v[124:127], v[176:179]
    ds_read_b128 v[104:107], v2 offset:21504
    v_cvt_pk_bf16_f32 v188, v140, v141
    s_waitcnt lgkmcnt(3)
    v_mfma_f32_16x16x32_bf16 v[156:159], v[92:95], v[112:115], v[156:159]
    v_exp_f32 v142, v142
    v_exp_f32 v143, v143
    v_mfma_f32_16x16x32_bf16 v[160:163], v[92:95], v[128:131], v[160:163]
    ds_read_b128 v[84:87], v2 offset:22528
    v_add_f32 v15, v15, v142
    s_waitcnt lgkmcnt(3)
    v_mfma_f32_16x16x32_bf16 v[164:167], v[96:99], v[112:115], v[164:167]
    v_add_f32 v15, v15, v143
    v_mfma_f32_16x16x32_bf16 v[168:171], v[96:99], v[128:131], v[168:171]
    ds_read_b128 v[88:91], v2 offset:23552
    v_cvt_pk_bf16_f32 v189, v142, v143
    s_waitcnt lgkmcnt(3)
    v_mfma_f32_16x16x32_bf16 v[156:159], v[100:103], v[116:119], v[156:159]
    v_exp_f32 v144, v144
    v_exp_f32 v145, v145
    v_mfma_f32_16x16x32_bf16 v[160:163], v[100:103], v[132:135], v[160:163]
    ds_read_b128 v[92:95], v3 offset:24576
    v_add_f32 v16, v16, v144
    s_waitcnt lgkmcnt(3)
    v_mfma_f32_16x16x32_bf16 v[164:167], v[104:107], v[116:119], v[164:167]
    v_add_f32 v16, v16, v145
    v_mfma_f32_16x16x32_bf16 v[168:171], v[104:107], v[132:135], v[168:171]
    ds_read_b128 v[96:99], v3 offset:25600
    v_cvt_pk_bf16_f32 v192, v144, v145
    s_waitcnt lgkmcnt(3)
    v_mfma_f32_16x16x32_bf16 v[156:159], v[84:87], v[120:123], v[156:159]
    v_exp_f32 v146, v146
    v_exp_f32 v147, v147
    v_mfma_f32_16x16x32_bf16 v[160:163], v[84:87], v[136:139], v[160:163]
    ds_read_b128 v[100:103], v3 offset:26624
    v_add_f32 v16, v16, v146
    s_waitcnt lgkmcnt(3)
    v_mfma_f32_16x16x32_bf16 v[164:167], v[88:91], v[120:123], v[164:167]
    v_add_f32 v16, v16, v147
    v_mfma_f32_16x16x32_bf16 v[168:171], v[88:91], v[136:139], v[168:171]
    ds_read_b128 v[104:107], v3 offset:27648
    v_cvt_pk_bf16_f32 v193, v146, v147
    s_waitcnt lgkmcnt(3)
    v_mfma_f32_16x16x32_bf16 v[20:23], v[92:95], v[196:199], v[20:23]
    v_exp_f32 v148, v148
    v_exp_f32 v149, v149
    v_mfma_f32_16x16x32_bf16 v[24:27], v[92:95], v[200:203], v[24:27]
    ds_read_b128 v[84:87], v3 offset:28672
    v_add_f32 v15, v15, v148
    s_waitcnt lgkmcnt(3)
    v_mfma_f32_16x16x32_bf16 v[28:31], v[96:99], v[196:199], v[28:31]
    v_add_f32 v15, v15, v149
    v_mfma_f32_16x16x32_bf16 v[32:35], v[96:99], v[200:203], v[32:35]
    ds_read_b128 v[88:91], v3 offset:29696
    v_cvt_pk_bf16_f32 v190, v148, v149
    s_waitcnt lgkmcnt(3)
    v_mfma_f32_16x16x32_bf16 v[36:39], v[100:103], v[196:199], v[36:39]
    v_exp_f32 v150, v150
    v_exp_f32 v151, v151
    v_mfma_f32_16x16x32_bf16 v[40:43], v[100:103], v[200:203], v[40:43]
    ds_read_b128 v[92:95], v3 offset:30720
    v_add_f32 v15, v15, v150
    s_waitcnt lgkmcnt(3)
    v_mfma_f32_16x16x32_bf16 v[44:47], v[104:107], v[196:199], v[44:47]
    v_add_f32 v15, v15, v151
    v_mfma_f32_16x16x32_bf16 v[48:51], v[104:107], v[200:203], v[48:51]
    ds_read_b128 v[96:99], v3 offset:31744
    v_cvt_pk_bf16_f32 v191, v150, v151
    s_waitcnt lgkmcnt(3)
    v_mfma_f32_16x16x32_bf16 v[52:55], v[84:87], v[196:199], v[52:55]
    v_exp_f32 v152, v152
    v_exp_f32 v153, v153
    v_mfma_f32_16x16x32_bf16 v[56:59], v[84:87], v[200:203], v[56:59]
    s_barrier
    ds_read_b128 v[100:103], v2 offset:32768
    v_add_f32 v16, v16, v152
    s_waitcnt lgkmcnt(3)
    v_mfma_f32_16x16x32_bf16 v[60:63], v[88:91], v[196:199], v[60:63]
    v_add_f32 v16, v16, v153
    v_mfma_f32_16x16x32_bf16 v[64:67], v[88:91], v[200:203], v[64:67]
    ds_read_b128 v[104:107], v2 offset:33792
    v_cvt_pk_bf16_f32 v194, v152, v153
    s_waitcnt lgkmcnt(3)
    v_mfma_f32_16x16x32_bf16 v[68:71], v[92:95], v[196:199], v[68:71]
    v_exp_f32 v154, v154
    v_exp_f32 v155, v155
    v_mfma_f32_16x16x32_bf16 v[72:75], v[92:95], v[200:203], v[72:75]
    ds_read_b128 v[84:87], v2 offset:34816
    v_add_f32 v16, v16, v154
    s_waitcnt lgkmcnt(3)
    v_mfma_f32_16x16x32_bf16 v[76:79], v[96:99], v[196:199], v[76:79]
    v_add_f32 v16, v16, v155
    v_mfma_f32_16x16x32_bf16 v[80:83], v[96:99], v[200:203], v[80:83]
    ds_read_b128 v[88:91], v2 offset:35840
    v_cvt_pk_bf16_f32 v195, v154, v155
    s_waitcnt lgkmcnt(3)
    v_mfma_f32_16x16x32_bf16 v[140:143], v[100:103], v[108:111], v[172:175]
    v_exp_f32 v156, v156
    v_exp_f32 v157, v157
    v_mfma_f32_16x16x32_bf16 v[144:147], v[100:103], v[124:127], v[176:179]
    ds_read_b128 v[92:95], v2 offset:36864
    v_add_f32 v15, v15, v156
    s_waitcnt lgkmcnt(3)
    v_mfma_f32_16x16x32_bf16 v[148:151], v[104:107], v[108:111], v[172:175]
    v_add_f32 v15, v15, v157
    v_mfma_f32_16x16x32_bf16 v[152:155], v[104:107], v[124:127], v[176:179]
    ds_read_b128 v[96:99], v2 offset:37888
    v_cvt_pk_bf16_f32 v196, v156, v157
    s_waitcnt lgkmcnt(3)
    v_mfma_f32_16x16x32_bf16 v[140:143], v[84:87], v[112:115], v[140:143]
    v_exp_f32 v158, v158
    v_exp_f32 v159, v159
    v_mfma_f32_16x16x32_bf16 v[144:147], v[84:87], v[128:131], v[144:147]
    ds_read_b128 v[100:103], v2 offset:38912
    v_add_f32 v15, v15, v158
    s_waitcnt lgkmcnt(3)
    v_mfma_f32_16x16x32_bf16 v[148:151], v[88:91], v[112:115], v[148:151]
    v_add_f32 v15, v15, v159
    v_mfma_f32_16x16x32_bf16 v[152:155], v[88:91], v[128:131], v[152:155]
    ds_read_b128 v[104:107], v2 offset:39936
    v_cvt_pk_bf16_f32 v197, v158, v159
    s_waitcnt lgkmcnt(3)
    v_mfma_f32_16x16x32_bf16 v[140:143], v[92:95], v[116:119], v[140:143]
    v_exp_f32 v160, v160
    v_exp_f32 v161, v161
    v_mfma_f32_16x16x32_bf16 v[144:147], v[92:95], v[132:135], v[144:147]
    ds_read_b128 v[84:87], v2 offset:8192
    v_add_f32 v16, v16, v160
    s_waitcnt lgkmcnt(3)
    v_mfma_f32_16x16x32_bf16 v[148:151], v[96:99], v[116:119], v[148:151]
    v_add_f32 v16, v16, v161
    v_mfma_f32_16x16x32_bf16 v[152:155], v[96:99], v[132:135], v[152:155]
    ds_read_b128 v[88:91], v2 offset:9216
    v_cvt_pk_bf16_f32 v200, v160, v161
    s_waitcnt lgkmcnt(3)
    v_mfma_f32_16x16x32_bf16 v[140:143], v[100:103], v[120:123], v[140:143]
    v_exp_f32 v162, v162
    v_exp_f32 v163, v163
    v_mfma_f32_16x16x32_bf16 v[144:147], v[100:103], v[136:139], v[144:147]
    ds_read_b128 v[92:95], v2 offset:10240
    v_add_f32 v16, v16, v162
    s_waitcnt lgkmcnt(3)
    v_mfma_f32_16x16x32_bf16 v[148:151], v[104:107], v[120:123], v[148:151]
    v_add_f32 v16, v16, v163
    v_mfma_f32_16x16x32_bf16 v[152:155], v[104:107], v[136:139], v[152:155]
    ds_read_b128 v[96:99], v2 offset:11264
    v_cvt_pk_bf16_f32 v201, v162, v163
    s_waitcnt lgkmcnt(3)
    v_mfma_f32_16x16x32_bf16 v[20:23], v[84:87], v[188:191], v[20:23]
    v_exp_f32 v164, v164
    v_exp_f32 v165, v165
    v_mfma_f32_16x16x32_bf16 v[24:27], v[84:87], v[192:195], v[24:27]
    ds_read_b128 v[100:103], v2 offset:12288
    v_add_f32 v15, v15, v164
    s_waitcnt lgkmcnt(3)
    v_mfma_f32_16x16x32_bf16 v[28:31], v[88:91], v[188:191], v[28:31]
    v_add_f32 v15, v15, v165
    v_mfma_f32_16x16x32_bf16 v[32:35], v[88:91], v[192:195], v[32:35]
    ds_read_b128 v[104:107], v2 offset:13312
    v_cvt_pk_bf16_f32 v198, v164, v165
    s_waitcnt lgkmcnt(3)
    v_mfma_f32_16x16x32_bf16 v[36:39], v[92:95], v[188:191], v[36:39]
    v_exp_f32 v166, v166
    v_exp_f32 v167, v167
    v_mfma_f32_16x16x32_bf16 v[40:43], v[92:95], v[192:195], v[40:43]
    ds_read_b128 v[84:87], v2 offset:14336
    v_add_f32 v15, v15, v166
    s_waitcnt lgkmcnt(3)
    v_mfma_f32_16x16x32_bf16 v[44:47], v[96:99], v[188:191], v[44:47]
    v_add_f32 v15, v15, v167
    v_mfma_f32_16x16x32_bf16 v[48:51], v[96:99], v[192:195], v[48:51]
    ds_read_b128 v[88:91], v2 offset:15360
    v_cvt_pk_bf16_f32 v199, v166, v167
    s_waitcnt lgkmcnt(3)
    v_mfma_f32_16x16x32_bf16 v[52:55], v[100:103], v[188:191], v[52:55]
    v_exp_f32 v168, v168
    v_exp_f32 v169, v169
    v_mfma_f32_16x16x32_bf16 v[56:59], v[100:103], v[192:195], v[56:59]
    s_barrier
    ds_read_b128 v[92:95], v2 offset:49152
    v_add_f32 v16, v16, v168
    s_waitcnt lgkmcnt(3)
    v_mfma_f32_16x16x32_bf16 v[60:63], v[104:107], v[188:191], v[60:63]
    v_add_f32 v16, v16, v169
    v_mfma_f32_16x16x32_bf16 v[64:67], v[104:107], v[192:195], v[64:67]
    ds_read_b128 v[96:99], v2 offset:50176
    v_cvt_pk_bf16_f32 v202, v168, v169
    s_waitcnt lgkmcnt(3)
    v_mfma_f32_16x16x32_bf16 v[68:71], v[84:87], v[188:191], v[68:71]
    v_exp_f32 v170, v170
    v_exp_f32 v171, v171
    v_mfma_f32_16x16x32_bf16 v[72:75], v[84:87], v[192:195], v[72:75]
    ds_read_b128 v[100:103], v2 offset:51200
    v_add_f32 v16, v16, v170
    s_waitcnt lgkmcnt(3)
    v_mfma_f32_16x16x32_bf16 v[76:79], v[88:91], v[188:191], v[76:79]
    v_add_f32 v16, v16, v171
    v_mfma_f32_16x16x32_bf16 v[80:83], v[88:91], v[192:195], v[80:83]
    ds_read_b128 v[104:107], v2 offset:52224
    v_cvt_pk_bf16_f32 v203, v170, v171
    s_waitcnt lgkmcnt(3)
    v_mfma_f32_16x16x32_bf16 v[156:159], v[92:95], v[108:111], v[172:175]
    v_exp_f32 v140, v140
    v_exp_f32 v141, v141
    v_mfma_f32_16x16x32_bf16 v[160:163], v[92:95], v[124:127], v[176:179]
    ds_read_b128 v[84:87], v2 offset:53248
    v_add_f32 v15, v15, v140
    s_waitcnt lgkmcnt(3)
    v_mfma_f32_16x16x32_bf16 v[164:167], v[96:99], v[108:111], v[172:175]
    v_add_f32 v15, v15, v141
    v_mfma_f32_16x16x32_bf16 v[168:171], v[96:99], v[124:127], v[176:179]
    ds_read_b128 v[88:91], v2 offset:54272
    v_cvt_pk_bf16_f32 v188, v140, v141
    s_waitcnt lgkmcnt(3)
    v_mfma_f32_16x16x32_bf16 v[156:159], v[100:103], v[112:115], v[156:159]
    v_exp_f32 v142, v142
    v_exp_f32 v143, v143
    v_mfma_f32_16x16x32_bf16 v[160:163], v[100:103], v[128:131], v[160:163]
    ds_read_b128 v[92:95], v2 offset:55296
    v_add_f32 v15, v15, v142
    s_waitcnt lgkmcnt(3)
    v_mfma_f32_16x16x32_bf16 v[164:167], v[104:107], v[112:115], v[164:167]
    v_add_f32 v15, v15, v143
    v_mfma_f32_16x16x32_bf16 v[168:171], v[104:107], v[128:131], v[168:171]
    ds_read_b128 v[96:99], v2 offset:56320
    v_cvt_pk_bf16_f32 v189, v142, v143
    s_waitcnt lgkmcnt(3)
    v_mfma_f32_16x16x32_bf16 v[156:159], v[84:87], v[116:119], v[156:159]
    v_exp_f32 v144, v144
    v_exp_f32 v145, v145
    v_mfma_f32_16x16x32_bf16 v[160:163], v[84:87], v[132:135], v[160:163]
    ds_read_b128 v[100:103], v2 offset:24576
    v_add_f32 v16, v16, v144
    s_waitcnt lgkmcnt(3)
    v_mfma_f32_16x16x32_bf16 v[164:167], v[88:91], v[116:119], v[164:167]
    v_add_f32 v16, v16, v145
    v_mfma_f32_16x16x32_bf16 v[168:171], v[88:91], v[132:135], v[168:171]
    ds_read_b128 v[104:107], v2 offset:25600
    v_cvt_pk_bf16_f32 v192, v144, v145
    s_waitcnt lgkmcnt(3)
    v_mfma_f32_16x16x32_bf16 v[156:159], v[92:95], v[120:123], v[156:159]
    v_exp_f32 v146, v146
    v_exp_f32 v147, v147
    v_mfma_f32_16x16x32_bf16 v[160:163], v[92:95], v[136:139], v[160:163]
    ds_read_b128 v[84:87], v2 offset:26624
    v_add_f32 v16, v16, v146
    s_waitcnt lgkmcnt(3)
    v_mfma_f32_16x16x32_bf16 v[164:167], v[96:99], v[120:123], v[164:167]
    v_add_f32 v16, v16, v147
    v_mfma_f32_16x16x32_bf16 v[168:171], v[96:99], v[136:139], v[168:171]
    ds_read_b128 v[88:91], v2 offset:27648
    v_cvt_pk_bf16_f32 v193, v146, v147
    s_waitcnt lgkmcnt(3)
    v_mfma_f32_16x16x32_bf16 v[20:23], v[100:103], v[196:199], v[20:23]
    v_exp_f32 v148, v148
    v_exp_f32 v149, v149
    v_mfma_f32_16x16x32_bf16 v[24:27], v[100:103], v[200:203], v[24:27]
    ds_read_b128 v[92:95], v2 offset:28672
    v_add_f32 v15, v15, v148
    s_waitcnt lgkmcnt(3)
    v_mfma_f32_16x16x32_bf16 v[28:31], v[104:107], v[196:199], v[28:31]
    v_add_f32 v15, v15, v149
    v_mfma_f32_16x16x32_bf16 v[32:35], v[104:107], v[200:203], v[32:35]
    ds_read_b128 v[96:99], v2 offset:29696
    v_cvt_pk_bf16_f32 v190, v148, v149
    s_waitcnt lgkmcnt(3)
    v_mfma_f32_16x16x32_bf16 v[36:39], v[84:87], v[196:199], v[36:39]
    v_exp_f32 v150, v150
    v_exp_f32 v151, v151
    v_mfma_f32_16x16x32_bf16 v[40:43], v[84:87], v[200:203], v[40:43]
    ds_read_b128 v[100:103], v2 offset:30720
    v_add_f32 v15, v15, v150
    s_waitcnt lgkmcnt(3)
    v_mfma_f32_16x16x32_bf16 v[44:47], v[88:91], v[196:199], v[44:47]
    v_add_f32 v15, v15, v151
    v_mfma_f32_16x16x32_bf16 v[48:51], v[88:91], v[200:203], v[48:51]
    ds_read_b128 v[104:107], v2 offset:31744
    v_cvt_pk_bf16_f32 v191, v150, v151
    s_waitcnt lgkmcnt(3)
    v_mfma_f32_16x16x32_bf16 v[52:55], v[92:95], v[196:199], v[52:55]
    v_exp_f32 v152, v152
    v_exp_f32 v153, v153
    v_mfma_f32_16x16x32_bf16 v[56:59], v[92:95], v[200:203], v[56:59]
    ds_read_b128 v[84:87], v2 offset:40960
    v_add_f32 v16, v16, v152
    s_waitcnt lgkmcnt(3)
    v_mfma_f32_16x16x32_bf16 v[60:63], v[96:99], v[196:199], v[60:63]
    v_add_f32 v16, v16, v153
    v_mfma_f32_16x16x32_bf16 v[64:67], v[96:99], v[200:203], v[64:67]
    ds_read_b128 v[88:91], v2 offset:41984
    v_cvt_pk_bf16_f32 v194, v152, v153
    s_waitcnt lgkmcnt(3)
    v_mfma_f32_16x16x32_bf16 v[68:71], v[100:103], v[196:199], v[68:71]
    v_exp_f32 v154, v154
    v_exp_f32 v155, v155
    v_mfma_f32_16x16x32_bf16 v[72:75], v[100:103], v[200:203], v[72:75]
    ds_read_b128 v[92:95], v2 offset:43008
    v_add_f32 v16, v16, v154
    s_waitcnt lgkmcnt(3)
    v_mfma_f32_16x16x32_bf16 v[76:79], v[104:107], v[196:199], v[76:79]
    v_add_f32 v16, v16, v155
    v_mfma_f32_16x16x32_bf16 v[80:83], v[104:107], v[200:203], v[80:83]
    ds_read_b128 v[96:99], v2 offset:44032
    v_cvt_pk_bf16_f32 v195, v154, v155
    s_waitcnt lgkmcnt(3)
    v_mfma_f32_16x16x32_bf16 v[20:23], v[84:87], v[188:191], v[20:23]
    v_exp_f32 v156, v156
    v_exp_f32 v157, v157
    v_add_f32 v15, v15, v156
    v_mfma_f32_16x16x32_bf16 v[24:27], v[84:87], v[192:195], v[24:27]
    ds_read_b128 v[100:103], v2 offset:45056
    v_add_f32 v15, v15, v157
    v_cvt_pk_bf16_f32 v196, v156, v157
    s_waitcnt lgkmcnt(3)
    v_mfma_f32_16x16x32_bf16 v[28:31], v[88:91], v[188:191], v[28:31]
    v_exp_f32 v158, v158
    v_exp_f32 v159, v159
    v_add_f32 v15, v15, v158
    v_mfma_f32_16x16x32_bf16 v[32:35], v[88:91], v[192:195], v[32:35]
    ds_read_b128 v[104:107], v2 offset:46080
    v_add_f32 v15, v15, v159
    v_cvt_pk_bf16_f32 v197, v158, v159
    s_waitcnt lgkmcnt(3)
    v_mfma_f32_16x16x32_bf16 v[36:39], v[92:95], v[188:191], v[36:39]
    v_exp_f32 v160, v160
    v_exp_f32 v161, v161
    v_add_f32 v16, v16, v160
    v_mfma_f32_16x16x32_bf16 v[40:43], v[92:95], v[192:195], v[40:43]
    ds_read_b128 v[84:87], v2 offset:47104
    v_add_f32 v16, v16, v161
    v_cvt_pk_bf16_f32 v200, v160, v161
    s_waitcnt lgkmcnt(3)
    v_mfma_f32_16x16x32_bf16 v[44:47], v[96:99], v[188:191], v[44:47]
    v_exp_f32 v162, v162
    v_exp_f32 v163, v163
    v_add_f32 v16, v16, v162
    v_mfma_f32_16x16x32_bf16 v[48:51], v[96:99], v[192:195], v[48:51]
    ds_read_b128 v[88:91], v2 offset:48128
    v_add_f32 v16, v16, v163
    v_cvt_pk_bf16_f32 v201, v162, v163
    s_waitcnt lgkmcnt(3)
    v_mfma_f32_16x16x32_bf16 v[52:55], v[100:103], v[188:191], v[52:55]
    v_exp_f32 v164, v164
    v_exp_f32 v165, v165
    v_add_f32 v15, v15, v164
    v_mfma_f32_16x16x32_bf16 v[56:59], v[100:103], v[192:195], v[56:59]
    ds_read_b128 v[92:95], v2 offset:57344
    v_add_f32 v15, v15, v165
    v_cvt_pk_bf16_f32 v198, v164, v165
    s_waitcnt lgkmcnt(3)
    v_mfma_f32_16x16x32_bf16 v[60:63], v[104:107], v[188:191], v[60:63]
    v_exp_f32 v166, v166
    v_exp_f32 v167, v167
    v_add_f32 v15, v15, v166
    v_mfma_f32_16x16x32_bf16 v[64:67], v[104:107], v[192:195], v[64:67]
    ds_read_b128 v[96:99], v2 offset:58368
    v_add_f32 v15, v15, v167
    v_cvt_pk_bf16_f32 v199, v166, v167
    s_waitcnt lgkmcnt(3)
    v_mfma_f32_16x16x32_bf16 v[68:71], v[84:87], v[188:191], v[68:71]
    v_exp_f32 v168, v168
    v_exp_f32 v169, v169
    v_add_f32 v16, v16, v168
    v_mfma_f32_16x16x32_bf16 v[72:75], v[84:87], v[192:195], v[72:75]
    ds_read_b128 v[100:103], v2 offset:59392
    v_add_f32 v16, v16, v169
    v_cvt_pk_bf16_f32 v202, v168, v169
    s_waitcnt lgkmcnt(3)
    v_mfma_f32_16x16x32_bf16 v[76:79], v[88:91], v[188:191], v[76:79]
    v_exp_f32 v170, v170
    v_exp_f32 v171, v171
    v_add_f32 v16, v16, v170
    v_mfma_f32_16x16x32_bf16 v[80:83], v[88:91], v[192:195], v[80:83]
    ds_read_b128 v[104:107], v2 offset:60416
    v_add_f32 v16, v16, v171
    v_cvt_pk_bf16_f32 v203, v170, v171
    s_waitcnt lgkmcnt(3)
    v_mfma_f32_16x16x32_bf16 v[20:23], v[92:95], v[196:199], v[20:23]
    v_mfma_f32_16x16x32_bf16 v[24:27], v[92:95], v[200:203], v[24:27]
    ds_read_b128 v[84:87], v2 offset:61440
    s_waitcnt lgkmcnt(3)
    v_mfma_f32_16x16x32_bf16 v[28:31], v[96:99], v[196:199], v[28:31]
    v_mfma_f32_16x16x32_bf16 v[32:35], v[96:99], v[200:203], v[32:35]
    ds_read_b128 v[88:91], v2 offset:62464
    s_waitcnt lgkmcnt(3)
    v_mfma_f32_16x16x32_bf16 v[36:39], v[100:103], v[196:199], v[36:39]
    v_mfma_f32_16x16x32_bf16 v[40:43], v[100:103], v[200:203], v[40:43]
    ds_read_b128 v[92:95], v2 offset:63488
    s_waitcnt lgkmcnt(3)
    v_mfma_f32_16x16x32_bf16 v[44:47], v[104:107], v[196:199], v[44:47]
    v_mfma_f32_16x16x32_bf16 v[48:51], v[104:107], v[200:203], v[48:51]
    ds_read_b128 v[96:99], v2 offset:64512
    s_waitcnt lgkmcnt(3)
    v_mfma_f32_16x16x32_bf16 v[52:55], v[84:87], v[196:199], v[52:55]
    v_mfma_f32_16x16x32_bf16 v[56:59], v[84:87], v[200:203], v[56:59]
    s_waitcnt lgkmcnt(2)
    v_mfma_f32_16x16x32_bf16 v[60:63], v[88:91], v[196:199], v[60:63]
    v_mfma_f32_16x16x32_bf16 v[64:67], v[88:91], v[200:203], v[64:67]
    s_waitcnt lgkmcnt(1)
    v_mfma_f32_16x16x32_bf16 v[68:71], v[92:95], v[196:199], v[68:71]
    v_mfma_f32_16x16x32_bf16 v[72:75], v[92:95], v[200:203], v[72:75]
    s_waitcnt lgkmcnt(0)
    v_mfma_f32_16x16x32_bf16 v[76:79], v[96:99], v[196:199], v[76:79]
    v_mfma_f32_16x16x32_bf16 v[80:83], v[96:99], v[200:203], v[80:83]
fz_chk:
    s_setprio 0
    v_mov_b32 v9, v15
    v_mov_b32 v11, v16
    s_nop 0
    v_permlane16_swap_b32 v15, v9
    v_permlane16_swap_b32 v16, v11
    v_add_f32 v15, v15, v9
    v_add_f32 v16, v16, v11
    v_mov_b32 v9, v15
    v_mov_b32 v11, v16
    s_nop 0
    v_permlane32_swap_b32 v15, v9
    v_permlane32_swap_b32 v16, v11
    v_add_f32 v15, v15, v9
    v_add_f32 v16, v16, v11
    v_max3_f32 v10, |v20|, |v21|, v15
    v_max3_f32 v12, |v22|, |v23|, v16
    v_max3_f32 v10, |v24|, |v25|, v10
    v_max3_f32 v12, |v26|, |v27|, v12
    v_max3_f32 v10, |v28|, |v29|, v10
    v_max3_f32 v12, |v30|, |v31|, v12
    v_max3_f32 v10, |v32|, |v33|, v10
    v_max3_f32 v12, |v34|, |v35|, v12
    v_max3_f32 v10, |v36|, |v37|, v10
    v_max3_f32 v12, |v38|, |v39|, v12
    v_max3_f32 v10, |v40|, |v41|, v10
    v_max3_f32 v12, |v42|, |v43|, v12
    v_max3_f32 v10, |v44|, |v45|, v10
    v_max3_f32 v12, |v46|, |v47|, v12
    v_max3_f32 v10, |v48|, |v49|, v10
    v_max3_f32 v12, |v50|, |v51|, v12
    v_max3_f32 v10, |v52|, |v53|, v10
    v_max3_f32 v12, |v54|, |v55|, v12
    v_max3_f32 v10, |v56|, |v57|, v10
    v_max3_f32 v12, |v58|, |v59|, v12
    v_max3_f32 v10, |v60|, |v61|, v10
    v_max3_f32 v12, |v62|, |v63|, v12
    v_max3_f32 v10, |v64|, |v65|, v10
    v_max3_f32 v12, |v66|, |v67|, v12
    v_max3_f32 v10, |v68|, |v69|, v10
    v_max3_f32 v12, |v70|, |v71|, v12
    v_max3_f32 v10, |v72|, |v73|, v10
    v_max3_f32 v12, |v74|, |v75|, v12
    v_max3_f32 v10, |v76|, |v77|, v10
    v_max3_f32 v12, |v78|, |v79|, v12
    v_max3_f32 v10, |v80|, |v81|, v10
    v_max3_f32 v12, |v82|, |v83|, v12
    v_max_f32 v10, v10, v12
    s_mov_b32 s26, 0x7b800000
    v_cmp_ngt_f32 vcc, s26, v10
    v_cmp_u_f32 s[26:27], v15, v16
    s_or_b64 vcc, vcc, s[26:27]
    s_cbranch_vccnz fz_slow
fz_epi:
    s_cmp_lt_u32 s3, 4
    s_cbranch_scc1 fz_nw15
    s_add_u32 s25, s24, 107520
    buffer_load_dwordx4 v[172:175], v19, s[64:67], s25 offen
fz_nw15:
    v_rcp_f32 v10, v15
    v_rcp_f32 v12, v16
    s_lshl_b32 s19, s13, 3
    s_add_u32 s19, s19, s3
    s_mul_i32 s20, s19, 262144
    s_lshl_b32 s25, s12, 12
    s_add_u32 s20, s20, s25
    s_add_u32 s20, s20, 0x1000000
    s_add_u32 s25, s20, 131072
    v_pk_mul_f32 v[148:149], v[20:21], v[10:11] op_sel_hi:[1,0]
    v_pk_mul_f32 v[150:151], v[22:23], v[10:11] op_sel_hi:[1,0]
    v_pk_mul_f32 v[152:153], v[28:29], v[10:11] op_sel_hi:[1,0]
    v_pk_mul_f32 v[154:155], v[30:31], v[10:11] op_sel_hi:[1,0]
    v_cvt_pk_bf16_f32 v108, v148, v149
    v_cvt_pk_bf16_f32 v109, v150, v151
    v_cvt_pk_bf16_f32 v110, v152, v153
    v_cvt_pk_bf16_f32 v111, v154, v155
    buffer_store_dwordx4 v[108:111], v1, s[8:11], s20 offen offset:0 sc1
    v_pk_mul_f32 v[164:165], v[24:25], v[12:13] op_sel_hi:[1,0]
    v_pk_mul_f32 v[166:167], v[26:27], v[12:13] op_sel_hi:[1,0]
    v_pk_mul_f32 v[168:169], v[32:33], v[12:13] op_sel_hi:[1,0]
    v_pk_mul_f32 v[170:171], v[34:35], v[12:13] op_sel_hi:[1,0]
    v_cvt_pk_bf16_f32 v124, v164, v165
    v_cvt_pk_bf16_f32 v125, v166, v167
    v_cvt_pk_bf16_f32 v126, v168, v169
    v_cvt_pk_bf16_f32 v127, v170, v171
    buffer_store_dwordx4 v[124:127], v1, s[8:11], s25 offen offset:0 sc1
    v_pk_mul_f32 v[148:149], v[36:37], v[10:11] op_sel_hi:[1,0]
    v_pk_mul_f32 v[150:151], v[38:39], v[10:11] op_sel_hi:[1,0]
    v_pk_mul_f32 v[152:153], v[44:45], v[10:11] op_sel_hi:[1,0]
    v_pk_mul_f32 v[154:155], v[46:47], v[10:11] op_sel_hi:[1,0]
    v_cvt_pk_bf16_f32 v112, v148, v149
    v_cvt_pk_bf16_f32 v113, v150, v151
    v_cvt_pk_bf16_f32 v114, v152, v153
    v_cvt_pk_bf16_f32 v115, v154, v155
    buffer_store_dwordx4 v[112:115], v1, s[8:11], s20 offen offset:1024 sc1
    v_pk_mul_f32 v[164:165], v[40:41], v[12:13] op_sel_hi:[1,0]
    v_pk_mul_f32 v[166:167], v[42:43], v[12:13] op_sel_hi:[1,0]
    v_pk_mul_f32 v[168:169], v[48:49], v[12:13] op_sel_hi:[1,0]
    v_pk_mul_f32 v[170:171], v[50:51], v[12:13] op_sel_hi:[1,0]
    v_cvt_pk_bf16_f32 v128, v164, v165
    v_cvt_pk_bf16_f32 v129, v166, v167
    v_cvt_pk_bf16_f32 v130, v168, v169
    v_cvt_pk_bf16_f32 v131, v170, v171
    buffer_store_dwordx4 v[128:131], v1, s[8:11], s25 offen offset:1024 sc1
    v_pk_mul_f32 v[148:149], v[52:53], v[10:11] op_sel_hi:[1,0]
    v_pk_mul_f32 v[150:151], v[54:55], v[10:11] op_sel_hi:[1,0]
    v_pk_mul_f32 v[152:153], v[60:61], v[10:11] op_sel_hi:[1,0]
    v_pk_mul_f32 v[154:155], v[62:63], v[10:11] op_sel_hi:[1,0]
    v_cvt_pk_bf16_f32 v116, v148, v149
    v_cvt_pk_bf16_f32 v117, v150, v151
    v_cvt_pk_bf16_f32 v118, v152, v153
    v_cvt_pk_bf16_f32 v119, v154, v155
    buffer_store_dwordx4 v[116:119], v1, s[8:11], s20 offen offset:2048 sc1
    v_pk_mul_f32 v[164:165], v[56:57], v[12:13] op_sel_hi:[1,0]
    v_pk_mul_f32 v[166:167], v[58:59], v[12:13] op_sel_hi:[1,0]
    v_pk_mul_f32 v[168:169], v[64:65], v[12:13] op_sel_hi:[1,0]
    v_pk_mul_f32 v[170:171], v[66:67], v[12:13] op_sel_hi:[1,0]
    v_cvt_pk_bf16_f32 v132, v164, v165
    v_cvt_pk_bf16_f32 v133, v166, v167
    v_cvt_pk_bf16_f32 v134, v168, v169
    v_cvt_pk_bf16_f32 v135, v170, v171
    buffer_store_dwordx4 v[132:135], v1, s[8:11], s25 offen offset:2048 sc1
    v_pk_mul_f32 v[148:149], v[68:69], v[10:11] op_sel_hi:[1,0]
    v_pk_mul_f32 v[150:151], v[70:71], v[10:11] op_sel_hi:[1,0]
    v_pk_mul_f32 v[152:153], v[76:77], v[10:11] op_sel_hi:[1,0]
    v_pk_mul_f32 v[154:155], v[78:79], v[10:11] op_sel_hi:[1,0]
    v_cvt_pk_bf16_f32 v120, v148, v149
    v_cvt_pk_bf16_f32 v121, v150, v151
    v_cvt_pk_bf16_f32 v122, v152, v153
    v_cvt_pk_bf16_f32 v123, v154, v155
    buffer_store_dwordx4 v[120:123], v1, s[8:11], s20 offen offset:3072 sc1
    v_pk_mul_f32 v[164:165], v[72:73], v[12:13] op_sel_hi:[1,0]
    v_pk_mul_f32 v[166:167], v[74:75], v[12:13] op_sel_hi:[1,0]
    v_pk_mul_f32 v[168:169], v[80:81], v[12:13] op_sel_hi:[1,0]
    v_pk_mul_f32 v[170:171], v[82:83], v[12:13] op_sel_hi:[1,0]
    v_cvt_pk_bf16_f32 v136, v164, v165
    v_cvt_pk_bf16_f32 v137, v166, v167
    v_cvt_pk_bf16_f32 v138, v168, v169
    v_cvt_pk_bf16_f32 v139, v170, v171
    buffer_store_dwordx4 v[136:139], v1, s[8:11], s25 offen offset:3072 sc1
    s_cmp_ge_u32 s3, 4
    s_cbranch_scc1 fz_p3B
    v_bfe_u32 v9, v0, 2, 2
    v_lshrrev_b32 v10, 4, v0
    v_and_b32 v11, 3, v0
    v_lshlrev_b32 v3, 10, v10
    v_lshl_add_u32 v3, v9, 6, v3
    v_lshl_add_u32 v3, v11, 3, v3
    v_bfe_u32 v12, v0, 4, 1
    v_lshlrev_b32 v12, 5, v12
    v_sub_u32 v2, v3, v12
    v_add_u32 v3, v3, v12
    s_lshl_b32 s19, s13, 3
    s_add_u32 s19, s19, s3
    s_mul_i32 s19, s19, 262144
    v_add_u32 v4, s19, v1
    s_and_b32 s62, s12, 24
    s_and_b32 s19, s12, 7
    s_lshl_b32 s20, s19, 2
    s_lshr_b32 s20, 0x54732160, s20
    s_and_b32 s20, s20, 7
    s_lshl_b32 s20, s20, 2
    s_bfm_b32 s21, s20, 0
    s_and_b32 s22, s21, 0x51764320
    s_lshl_b32 s22, s22, 4
    s_lshl_b32 s21, s21, 4
    s_or_b32 s21, s21, 15
    s_andn2_b32 s21, 0x51764320, s21
    s_or_b32 s42, s21, s22
    s_or_b32 s42, s42, s19
    s_bfe_u32 s96, s2, 0x10002
    s_mul_i32 s96, s96, 28
    s_lshr_b32 s26, s2, 3
    s_add_u32 s96, s96, s26
    s_and_b32 s97, s2, 1
    s_bfe_u32 s98, s2, 0x10001
    s_bfe_u32 s99, s2, 0x40003
    s_and_b32 s100, s2, 7
    s_lshl_b32 s100, s100, 1
    s_lshr_b32 s26, s2, 7
    s_add_u32 s100, s100, s26
    v_lshrrev_b32 v9, 4, v0
    v_lshlrev_b32 v13, 4, v9
    s_add_u32 s19, s12, 1
    s_and_b32 s19, s19, 7
    s_lshl_b32 s26, s19, 9
    s_add_u32 s26, s26, 0x22000
    v_add_u32 v13, s26, v13
    v_and_b32 v14, 15, v0
    v_lshlrev_b32 v14, 6, v14
    v_lshl_add_u32 v14, v9, 4, v14
    s_lshr_b32 s18, s12, 3
    s_lshl_b32 s18, s18, 22
    s_lshl_b32 s26, s13, 3
    s_add_u32 s26, s26, s3
    s_lshl_b32 s26, s26, 16
    s_add_u32 s18, s18, s26
    s_lshl_b32 s19, s19, 12
    s_add_u32 s18, s18, s19
    s_add_u32 s18, s18, 0x2000000
    s_add_u32 s19, s18, 0x8000
    v_add_u32 v15, 0x10000, v3
    v_add_u32 v16, 0x10000, v2
    s_lshl_b32 s26, s13, 3
    s_add_u32 s26, s26, s3
    s_lshl_b32 s26, s26, 2
    s_lshr_b32 s27, s12, 3
    s_add_u32 s26, s26, s27
    s_lshl_b32 s26, s26, 7
    s_add_u32 s20, s26, 0x540000
    s_and_b32 s27, s12, 7
    s_lshl_b32 s27, s27, 2
    s_add_u32 s26, s20, s27
    v_mov_b32 v9, s14
    v_mov_b32 v10, 0
    s_waitcnt vmcnt(0)
    s_mov_b64 exec, 1
    buffer_store_dword v9, v10, s[8:11], s26 offen sc1
    s_mov_b64 exec, -1
    s_waitcnt lgkmcnt(0)
    s_barrier
    ds_read_b64_tr_b16 v[84:85], v3 offset:0
    ds_read_b64_tr_b16 v[86:87], v3 offset:4096
    ds_read_b64_tr_b16 v[88:89], v2 offset:32
    ds_read_b64_tr_b16 v[90:91], v2 offset:4128
    ds_read_b64_tr_b16 v[92:93], v3 offset:256
    ds_read_b64_tr_b16 v[94:95], v3 offset:4352
    ds_read_b64_tr_b16 v[96:97], v2 offset:288
    ds_read_b64_tr_b16 v[98:99], v2 offset:4384
    s_waitcnt lgkmcnt(6)
    v_mfma_f32_16x16x32_bf16 v[20:23], v[84:87], v[108:111], 0
    ds_read_b64_tr_b16 v[100:101], v3 offset:512
    v_mfma_f32_16x16x32_bf16 v[24:27], v[84:87], v[124:127], 0
    s_bfe_u32 s22, s42, 0x30004
    s_or_b32 s22, s22, s62
    s_lshl_b32 s22, s22, 18
    s_add_u32 s22, s22, s16
    s_add_u32 s22, s22, 0x20000
    s_add_u32 m0, s17, 0xc000
    s_nop 0
    buffer_load_dwordx4 v17, s[4:7], s22 offen lds
    ds_read_b64_tr_b16 v[102:103], v3 offset:4608
    s_waitcnt lgkmcnt(6)
    v_mfma_f32_16x16x32_bf16 v[28:31], v[88:91], v[108:111], 0
    ds_read_b64_tr_b16 v[104:105], v2 offset:544
    v_mfma_f32_16x16x32_bf16 v[32:35], v[88:91], v[124:127], 0
    ds_read_b64_tr_b16 v[106:107], v2 offset:4640
    s_waitcnt lgkmcnt(6)
    v_mfma_f32_16x16x32_bf16 v[36:39], v[92:95], v[108:111], 0
    s_bfe_u32 s22, s42, 0x30004
    s_or_b32 s22, s22, s62
    s_lshl_b32 s22, s22, 18
    s_add_u32 s22, s22, s16
    s_add_u32 s22, s22, 0x22000
    s_add_u32 m0, s17, 0xc400
    s_nop 0
    buffer_load_dwordx4 v18, s[4:7], s22 offen lds
    ds_read_b64_tr_b16 v[84:85], v3 offset:768
    v_mfma_f32_16x16x32_bf16 v[40:43], v[92:95], v[124:127], 0
    ds_read_b64_tr_b16 v[86:87], v3 offset:4864
    s_waitcnt lgkmcnt(6)
    v_mfma_f32_16x16x32_bf16 v[44:47], v[96:99], v[108:111], 0
    ds_read_b64_tr_b16 v[88:89], v2 offset:800
    v_mfma_f32_16x16x32_bf16 v[48:51], v[96:99], v[124:127], 0
    s_bfe_u32 s22, s42, 0x30004
    s_or_b32 s22, s22, s62
    s_lshl_b32 s22, s22, 18
    s_add_u32 s22, s22, s16
    s_add_u32 s22, s22, 0x24000
    s_add_u32 m0, s17, 0xc800
    s_nop 0
    buffer_load_dwordx4 v17, s[4:7], s22 offen lds
    ds_read_b64_tr_b16 v[90:91], v2 offset:4896
    s_waitcnt lgkmcnt(6)
    v_mfma_f32_16x16x32_bf16 v[52:55], v[100:103], v[108:111], 0
    ds_read_b64_tr_b16 v[92:93], v3 offset:8192
    v_mfma_f32_16x16x32_bf16 v[56:59], v[100:103], v[124:127], 0
    ds_read_b64_tr_b16 v[94:95], v3 offset:12288
    s_waitcnt lgkmcnt(6)
    v_mfma_f32_16x16x32_bf16 v[60:63], v[104:107], v[108:111], 0
    s_bfe_u32 s22, s42, 0x30004
    s_or_b32 s22, s22, s62
    s_lshl_b32 s22, s22, 18
    s_add_u32 s22, s22, s16
    s_add_u32 s22, s22, 0x26000
    s_add_u32 m0, s17, 0xcc00
    s_nop 0
    buffer_load_dwordx4 v18, s[4:7], s22 offen lds
    ds_read_b64_tr_b16 v[96:97], v2 offset:8224
    v_mfma_f32_16x16x32_bf16 v[64:67], v[104:107], v[124:127], 0
    ds_read_b64_tr_b16 v[98:99], v2 offset:12320
    s_waitcnt lgkmcnt(6)
    v_mfma_f32_16x16x32_bf16 v[68:71], v[84:87], v[108:111], 0
    ds_read_b64_tr_b16 v[100:101], v3 offset:8448
    v_mfma_f32_16x16x32_bf16 v[72:75], v[84:87], v[124:127], 0
    s_bfe_u32 s22, s42, 0x30008
    s_or_b32 s22, s22, s62
    s_lshl_b32 s22, s22, 18
    s_add_u32 s22, s22, s16
    s_add_u32 s22, s22, 0x0
    s_add_u32 m0, s17, 0x10000
    s_nop 0
    buffer_load_dwordx4 v17, s[4:7], s22 offen lds
    ds_read_b64_tr_b16 v[102:103], v3 offset:12544
    s_waitcnt lgkmcnt(6)
    v_mfma_f32_16x16x32_bf16 v[76:79], v[88:91], v[108:111], 0
    ds_read_b64_tr_b16 v[104:105], v2 offset:8480
    v_mfma_f32_16x16x32_bf16 v[80:83], v[88:91], v[124:127], 0
    ds_read_b64_tr_b16 v[106:107], v2 offset:12576
    s_waitcnt lgkmcnt(6)
    v_mfma_f32_16x16x32_bf16 v[20:23], v[92:95], v[112:115], v[20:23]
    s_bfe_u32 s22, s42, 0x30008
    s_or_b32 s22, s22, s62
    s_lshl_b32 s22, s22, 18
    s_add_u32 s22, s22, s16
    s_add_u32 s22, s22, 0x2000
    s_add_u32 m0, s17, 0x10400
    s_nop 0
    buffer_load_dwordx4 v18, s[4:7], s22 offen lds
    ds_read_b64_tr_b16 v[84:85], v3 offset:8704
    v_mfma_f32_16x16x32_bf16 v[24:27], v[92:95], v[128:131], v[24:27]
    ds_read_b64_tr_b16 v[86:87], v3 offset:12800
    s_waitcnt lgkmcnt(6)
    v_mfma_f32_16x16x32_bf16 v[28:31], v[96:99], v[112:115], v[28:31]
    ds_read_b64_tr_b16 v[88:89], v2 offset:8736
    v_mfma_f32_16x16x32_bf16 v[32:35], v[96:99], v[128:131], v[32:35]
    s_bfe_u32 s22, s42, 0x30008
    s_or_b32 s22, s22, s62
    s_lshl_b32 s22, s22, 18
    s_add_u32 s22, s22, s16
    s_add_u32 s22, s22, 0x4000
    s_add_u32 m0, s17, 0x10800
    s_nop 0
    buffer_load_dwordx4 v17, s[4:7], s22 offen lds
    ds_read_b64_tr_b16 v[90:91], v2 offset:12832
    s_waitcnt lgkmcnt(6)
    v_mfma_f32_16x16x32_bf16 v[36:39], v[100:103], v[112:115], v[36:39]
    ds_read_b64_tr_b16 v[92:93], v3 offset:8960
    v_mfma_f32_16x16x32_bf16 v[40:43], v[100:103], v[128:131], v[40:43]
    ds_read_b64_tr_b16 v[94:95], v3 offset:13056
    s_waitcnt lgkmcnt(6)
    v_mfma_f32_16x16x32_bf16 v[44:47], v[104:107], v[112:115], v[44:47]
    s_bfe_u32 s22, s42, 0x30008
    s_or_b32 s22, s22, s62
    s_lshl_b32 s22, s22, 18
    s_add_u32 s22, s22, s16
    s_add_u32 s22, s22, 0x6000
    s_add_u32 m0, s17, 0x10c00
    s_nop 0
    buffer_load_dwordx4 v18, s[4:7], s22 offen lds
    ds_read_b64_tr_b16 v[96:97], v2 offset:8992
    v_mfma_f32_16x16x32_bf16 v[48:51], v[104:107], v[128:131], v[48:51]
    ds_read_b64_tr_b16 v[98:99], v2 offset:13088
    s_waitcnt lgkmcnt(6)
    v_mfma_f32_16x16x32_bf16 v[52:55], v[84:87], v[112:115], v[52:55]
    v_mfma_f32_16x16x32_bf16 v[56:59], v[84:87], v[128:131], v[56:59]
    s_bfe_u32 s22, s42, 0x30008
    s_or_b32 s22, s22, s62
    s_lshl_b32 s22, s22, 18
    s_add_u32 s22, s22, s16
    s_add_u32 s22, s22, 0x20000
    s_add_u32 m0, s17, 0x14000
    s_nop 0
    buffer_load_dwordx4 v17, s[4:7], s22 offen lds
    s_barrier
    ds_read_b64_tr_b16 v[100:101], v3 offset:16384
    ds_read_b64_tr_b16 v[102:103], v3 offset:20480
    s_waitcnt lgkmcnt(6)
    v_mfma_f32_16x16x32_bf16 v[60:63], v[88:91], v[112:115], v[60:63]
    ds_read_b64_tr_b16 v[104:105], v2 offset:16416
    v_mfma_f32_16x16x32_bf16 v[64:67], v[88:91], v[128:131], v[64:67]
    s_bfe_u32 s22, s42, 0x3000c
    s_or_b32 s22, s22, s62
    s_lshl_b32 s22, s22, 18
    s_add_u32 s22, s22, s16
    s_add_u32 s22, s22, 0x0
    s_add_u32 m0, s17, 0x18000
    s_nop 0
    buffer_load_dwordx4 v17, s[4:7], s22 offen lds
    ds_read_b64_tr_b16 v[106:107], v2 offset:20512
    s_waitcnt lgkmcnt(6)
    v_mfma_f32_16x16x32_bf16 v[68:71], v[92:95], v[112:115], v[68:71]
    s_bfe_u32 s22, s42, 0x30008
    s_or_b32 s22, s22, s62
    s_lshl_b32 s22, s22, 18
    s_add_u32 s22, s22, s16
    s_add_u32 s22, s22, 0x22000
    s_add_u32 m0, s17, 0x14400
    s_nop 0
    buffer_load_dwordx4 v18, s[4:7], s22 offen lds
    ds_read_b64_tr_b16 v[84:85], v3 offset:16640
    v_mfma_f32_16x16x32_bf16 v[72:75], v[92:95], v[128:131], v[72:75]
    ds_read_b64_tr_b16 v[86:87], v3 offset:20736
    s_waitcnt lgkmcnt(6)
    v_mfma_f32_16x16x32_bf16 v[76:79], v[96:99], v[112:115], v[76:79]
    ds_read_b64_tr_b16 v[88:89], v2 offset:16672
    v_mfma_f32_16x16x32_bf16 v[80:83], v[96:99], v[128:131], v[80:83]
    s_bfe_u32 s22, s42, 0x30008
    s_or_b32 s22, s22, s62
    s_lshl_b32 s22, s22, 18
    s_add_u32 s22, s22, s16
    s_add_u32 s22, s22, 0x24000
    s_add_u32 m0, s17, 0x14800
    s_nop 0
    buffer_load_dwordx4 v17, s[4:7], s22 offen lds
    ds_read_b64_tr_b16 v[90:91], v2 offset:20768
    s_waitcnt lgkmcnt(6)
    v_mfma_f32_16x16x32_bf16 v[20:23], v[100:103], v[116:119], v[20:23]
    ds_read_b64_tr_b16 v[92:93], v3 offset:16896
    v_mfma_f32_16x16x32_bf16 v[24:27], v[100:103], v[132:135], v[24:27]
    ds_read_b64_tr_b16 v[94:95], v3 offset:20992
    s_waitcnt lgkmcnt(6)
    v_mfma_f32_16x16x32_bf16 v[28:31], v[104:107], v[116:119], v[28:31]
    s_bfe_u32 s22, s42, 0x30008
    s_or_b32 s22, s22, s62
    s_lshl_b32 s22, s22, 18
    s_add_u32 s22, s22, s16
    s_add_u32 s22, s22, 0x26000
    s_add_u32 m0, s17, 0x14c00
    s_nop 0
    buffer_load_dwordx4 v18, s[4:7], s22 offen lds
    ds_read_b64_tr_b16 v[96:97], v2 offset:16928
    v_mfma_f32_16x16x32_bf16 v[32:35], v[104:107], v[132:135], v[32:35]
    s_bfe_u32 s22, s42, 0x3000c
    s_or_b32 s22, s22, s62
    s_lshl_b32 s22, s22, 18
    s_add_u32 s22, s22, s16
    s_add_u32 s22, s22, 0x2000
    s_add_u32 m0, s17, 0x18400
    s_nop 0
    buffer_load_dwordx4 v18, s[4:7], s22 offen lds
    ds_read_b64_tr_b16 v[98:99], v2 offset:21024
    s_waitcnt lgkmcnt(6)
    v_mfma_f32_16x16x32_bf16 v[36:39], v[84:87], v[116:119], v[36:39]
    ds_read_b64_tr_b16 v[100:101], v3 offset:17152
    v_mfma_f32_16x16x32_bf16 v[40:43], v[84:87], v[132:135], v[40:43]
    ds_read_b64_tr_b16 v[102:103], v3 offset:21248
    s_waitcnt lgkmcnt(6)
    v_mfma_f32_16x16x32_bf16 v[44:47], v[88:91], v[116:119], v[44:47]
    ds_read_b64_tr_b16 v[104:105], v2 offset:17184
    v_mfma_f32_16x16x32_bf16 v[48:51], v[88:91], v[132:135], v[48:51]
    ds_read_b64_tr_b16 v[106:107], v2 offset:21280
    s_waitcnt lgkmcnt(6)
    v_mfma_f32_16x16x32_bf16 v[52:55], v[92:95], v[116:119], v[52:55]
    ds_read_b64_tr_b16 v[84:85], v3 offset:24576
    v_mfma_f32_16x16x32_bf16 v[56:59], v[92:95], v[132:135], v[56:59]
    ds_read_b64_tr_b16 v[86:87], v3 offset:28672
    s_waitcnt lgkmcnt(6)
    v_mfma_f32_16x16x32_bf16 v[60:63], v[96:99], v[116:119], v[60:63]
    ds_read_b64_tr_b16 v[88:89], v2 offset:24608
    v_mfma_f32_16x16x32_bf16 v[64:67], v[96:99], v[132:135], v[64:67]
    s_bfe_u32 s22, s42, 0x3000c
    s_or_b32 s22, s22, s62
    s_lshl_b32 s22, s22, 18
    s_add_u32 s22, s22, s16
    s_add_u32 s22, s22, 0x4000
    s_add_u32 m0, s17, 0x18800
    s_nop 0
    buffer_load_dwordx4 v17, s[4:7], s22 offen lds
    ds_read_b64_tr_b16 v[90:91], v2 offset:28704
    s_waitcnt lgkmcnt(6)
    v_mfma_f32_16x16x32_bf16 v[68:71], v[100:103], v[116:119], v[68:71]
    ds_read_b64_tr_b16 v[92:93], v3 offset:24832
    v_mfma_f32_16x16x32_bf16 v[72:75], v[100:103], v[132:135], v[72:75]
    ds_read_b64_tr_b16 v[94:95], v3 offset:28928
    s_waitcnt lgkmcnt(6)
    v_mfma_f32_16x16x32_bf16 v[76:79], v[104:107], v[116:119], v[76:79]
    ds_read_b64_tr_b16 v[96:97], v2 offset:24864
    v_mfma_f32_16x16x32_bf16 v[80:83], v[104:107], v[132:135], v[80:83]
    ds_read_b64_tr_b16 v[98:99], v2 offset:28960
    s_waitcnt lgkmcnt(6)
    v_mfma_f32_16x16x32_bf16 v[20:23], v[84:87], v[120:123], v[20:23]
    ds_read_b64_tr_b16 v[100:101], v3 offset:25088
    v_mfma_f32_16x16x32_bf16 v[24:27], v[84:87], v[136:139], v[24:27]
    ds_read_b64_tr_b16 v[102:103], v3 offset:29184
    s_waitcnt lgkmcnt(6)
    v_mfma_f32_16x16x32_bf16 v[28:31], v[88:91], v[120:123], v[28:31]
    ds_read_b64_tr_b16 v[104:105], v2 offset:25120
    v_mfma_f32_16x16x32_bf16 v[32:35], v[88:91], v[136:139], v[32:35]
    s_bfe_u32 s22, s42, 0x3000c
    s_or_b32 s22, s22, s62
    s_lshl_b32 s22, s22, 18
    s_add_u32 s22, s22, s16
    s_add_u32 s22, s22, 0x6000
    s_add_u32 m0, s17, 0x18c00
    s_nop 0
    buffer_load_dwordx4 v18, s[4:7], s22 offen lds
    ds_read_b64_tr_b16 v[106:107], v2 offset:29216
    s_waitcnt lgkmcnt(6)
    v_mfma_f32_16x16x32_bf16 v[36:39], v[92:95], v[120:123], v[36:39]
    ds_read_b64_tr_b16 v[84:85], v3 offset:25344
    v_mfma_f32_16x16x32_bf16 v[40:43], v[92:95], v[136:139], v[40:43]
    ds_read_b64_tr_b16 v[86:87], v3 offset:29440
    s_waitcnt lgkmcnt(6)
    v_mfma_f32_16x16x32_bf16 v[44:47], v[96:99], v[120:123], v[44:47]
    ds_read_b64_tr_b16 v[88:89], v2 offset:25376
    v_mfma_f32_16x16x32_bf16 v[48:51], v[96:99], v[136:139], v[48:51]
    ds_read_b64_tr_b16 v[90:91], v2 offset:29472
    s_waitcnt lgkmcnt(6)
    v_mfma_f32_16x16x32_bf16 v[52:55], v[100:103], v[120:123], v[52:55]
    v_mfma_f32_16x16x32_bf16 v[56:59], v[100:103], v[136:139], v[56:59]
    s_barrier
    ds_read_b64_tr_b16 v[92:93], v3 offset:32768
    ds_read_b64_tr_b16 v[94:95], v3 offset:36864
    s_waitcnt lgkmcnt(6)
    v_mfma_f32_16x16x32_bf16 v[60:63], v[104:107], v[120:123], v[60:63]
    ds_read_b64_tr_b16 v[96:97], v2 offset:32800
    v_mfma_f32_16x16x32_bf16 v[64:67], v[104:107], v[136:139], v[64:67]
    s_bfe_u32 s22, s42, 0x3000c
    s_or_b32 s22, s22, s62
    s_lshl_b32 s22, s22, 18
    s_add_u32 s22, s22, s16
    s_add_u32 s22, s22, 0x20000
    s_add_u32 m0, s17, 0x1c000
    s_nop 0
    buffer_load_dwordx4 v17, s[4:7], s22 offen lds
    ds_read_b64_tr_b16 v[98:99], v2 offset:36896
    s_waitcnt lgkmcnt(6)
    v_mfma_f32_16x16x32_bf16 v[68:71], v[84:87], v[120:123], v[68:71]
    ds_read_b64_tr_b16 v[100:101], v3 offset:33024
    v_mfma_f32_16x16x32_bf16 v[72:75], v[84:87], v[136:139], v[72:75]
    ds_read_b64_tr_b16 v[102:103], v3 offset:37120
    s_waitcnt lgkmcnt(6)
    v_mfma_f32_16x16x32_bf16 v[76:79], v[88:91], v[120:123], v[76:79]
    ds_read_b64_tr_b16 v[104:105], v2 offset:33056
    v_mfma_f32_16x16x32_bf16 v[80:83], v[88:91], v[136:139], v[80:83]
    ds_read_b64_tr_b16 v[106:107], v2 offset:37152
    v_and_b32 v9, 7, v0
    v_lshlrev_b32 v9, 2, v9
    s_mov_b32 s27, 0
fz_oAp:
    buffer_load_dword v10, v9, s[8:11], s20 offen sc1
    s_waitcnt vmcnt(0)
    v_cmp_ne_u32 vcc, s14, v10
    s_and_b32 vcc_lo, vcc_lo, 0xdd
    s_mov_b32 vcc_hi, 0
    s_add_u32 s27, s27, 1
    s_cmp_ge_u32 s27, 65536
    s_cbranch_scc1 fz_oAg
    s_cbranch_vccz fz_oAg
    s_sleep 1
    s_branch fz_oAp
fz_oAg:
    s_bfe_u32 s21, s42, 0x30004
    s_or_b32 s21, s21, s62
    s_lshl_b32 s21, s21, 12
    s_add_u32 s23, s21, 0x1000000
    buffer_load_dwordx4 v[140:143], v4, s[8:11], s23 offen offset:0 sc1
    s_add_u32 s23, s21, 0x1020000
    buffer_load_dwordx4 v[144:147], v4, s[8:11], s23 offen offset:0 sc1
    s_add_u32 s23, s21, 0x1000000
    buffer_load_dwordx4 v[148:151], v4, s[8:11], s23 offen offset:1024 sc1
    s_add_u32 s23, s21, 0x1020000
    buffer_load_dwordx4 v[152:155], v4, s[8:11], s23 offen offset:1024 sc1
    s_add_u32 s23, s21, 0x1000800
    buffer_load_dwordx4 v[156:159], v4, s[8:11], s23 offen offset:0 sc1
    s_add_u32 s23, s21, 0x1020800
    buffer_load_dwordx4 v[160:163], v4, s[8:11], s23 offen offset:0 sc1
    s_add_u32 s23, s21, 0x1000800
    buffer_load_dwordx4 v[164:167], v4, s[8:11], s23 offen offset:1024 sc1
    s_add_u32 s23, s21, 0x1020800
    buffer_load_dwordx4 v[168:171], v4, s[8:11], s23 offen offset:1024 sc1
    s_bfe_u32 s21, s42, 0x30008
    s_or_b32 s21, s21, s62
    s_lshl_b32 s21, s21, 12
    s_add_u32 s23, s21, 0x1000000
    buffer_load_dwordx4 v[188:191], v4, s[8:11], s23 offen offset:0 sc1
    s_add_u32 s23, s21, 0x1020000
    buffer_load_dwordx4 v[192:195], v4, s[8:11], s23 offen offset:0 sc1
    s_add_u32 s23, s21, 0x1000000
    buffer_load_dwordx4 v[196:199], v4, s[8:11], s23 offen offset:1024 sc1
    s_add_u32 s23, s21, 0x1020000
    buffer_load_dwordx4 v[200:203], v4, s[8:11], s23 offen offset:1024 sc1
    s_waitcnt vmcnt(11) lgkmcnt(6)
    v_mfma_f32_16x16x32_bf16 v[20:23], v[92:95], v[140:143], v[20:23]
    ds_read_b64_tr_b16 v[84:85], v3 offset:33280
    s_waitcnt vmcnt(10)
    v_mfma_f32_16x16x32_bf16 v[24:27], v[92:95], v[144:147], v[24:27]
    ds_read_b64_tr_b16 v[86:87], v3 offset:37376
    s_waitcnt lgkmcnt(6)
    v_mfma_f32_16x16x32_bf16 v[28:31], v[96:99], v[140:143], v[28:31]
    ds_read_b64_tr_b16 v[88:89], v2 offset:33312
    v_mfma_f32_16x16x32_bf16 v[32:35], v[96:99], v[144:147], v[32:35]
    s_bfe_u32 s22, s42, 0x3000c
    s_or_b32 s22, s22, s62
    s_lshl_b32 s22, s22, 18
    s_add_u32 s22, s22, s16
    s_add_u32 s22, s22, 0x22000
    s_add_u32 m0, s17, 0x1c400
    s_nop 0
    buffer_load_dwordx4 v18, s[4:7], s22 offen lds
    ds_read_b64_tr_b16 v[90:91], v2 offset:37408
    s_waitcnt lgkmcnt(6)
    v_mfma_f32_16x16x32_bf16 v[36:39], v[100:103], v[140:143], v[36:39]
    ds_read_b64_tr_b16 v[92:93], v3 offset:33536
    v_mfma_f32_16x16x32_bf16 v[40:43], v[100:103], v[144:147], v[40:43]
    ds_read_b64_tr_b16 v[94:95], v3 offset:37632
    s_waitcnt lgkmcnt(6)
    v_mfma_f32_16x16x32_bf16 v[44:47], v[104:107], v[140:143], v[44:47]
    ds_read_b64_tr_b16 v[96:97], v2 offset:33568
    v_mfma_f32_16x16x32_bf16 v[48:51], v[104:107], v[144:147], v[48:51]
    ds_read_b64_tr_b16 v[98:99], v2 offset:37664
    s_add_u32 s23, s21, 0x1000800
    buffer_load_dwordx4 v[108:111], v4, s[8:11], s23 offen offset:0 sc1
    s_waitcnt lgkmcnt(6)
    v_mfma_f32_16x16x32_bf16 v[52:55], v[84:87], v[140:143], v[52:55]
    ds_read_b64_tr_b16 v[100:101], v3 offset:40960
    v_mfma_f32_16x16x32_bf16 v[56:59], v[84:87], v[144:147], v[56:59]
    ds_read_b64_tr_b16 v[102:103], v3 offset:45056
    s_waitcnt lgkmcnt(6)
    v_mfma_f32_16x16x32_bf16 v[60:63], v[88:91], v[140:143], v[60:63]
    ds_read_b64_tr_b16 v[104:105], v2 offset:40992
    v_mfma_f32_16x16x32_bf16 v[64:67], v[88:91], v[144:147], v[64:67]
    s_bfe_u32 s22, s42, 0x3000c
    s_or_b32 s22, s22, s62
    s_lshl_b32 s22, s22, 18
    s_add_u32 s22, s22, s16
    s_add_u32 s22, s22, 0x24000
    s_add_u32 m0, s17, 0x1c800
    s_nop 0
    buffer_load_dwordx4 v17, s[4:7], s22 offen lds
    ds_read_b64_tr_b16 v[106:107], v2 offset:45088
    s_waitcnt lgkmcnt(6)
    v_mfma_f32_16x16x32_bf16 v[68:71], v[92:95], v[140:143], v[68:71]
    ds_read_b64_tr_b16 v[84:85], v3 offset:41216
    v_mfma_f32_16x16x32_bf16 v[72:75], v[92:95], v[144:147], v[72:75]
    ds_read_b64_tr_b16 v[86:87], v3 offset:45312
    s_waitcnt lgkmcnt(6)
    v_mfma_f32_16x16x32_bf16 v[76:79], v[96:99], v[140:143], v[76:79]
    ds_read_b64_tr_b16 v[88:89], v2 offset:41248
    v_mfma_f32_16x16x32_bf16 v[80:83], v[96:99], v[144:147], v[80:83]
    ds_read_b64_tr_b16 v[90:91], v2 offset:45344
    s_add_u32 s23, s21, 0x1020800
    buffer_load_dwordx4 v[112:115], v4, s[8:11], s23 offen offset:0 sc1
    s_waitcnt vmcnt(13) lgkmcnt(6)
    v_mfma_f32_16x16x32_bf16 v[20:23], v[100:103], v[148:151], v[20:23]
    ds_read_b64_tr_b16 v[92:93], v3 offset:41472
    s_waitcnt vmcnt(12)
    v_mfma_f32_16x16x32_bf16 v[24:27], v[100:103], v[152:155], v[24:27]
    ds_read_b64_tr_b16 v[94:95], v3 offset:45568
    s_waitcnt lgkmcnt(6)
    v_mfma_f32_16x16x32_bf16 v[28:31], v[104:107], v[148:151], v[28:31]
    ds_read_b64_tr_b16 v[96:97], v2 offset:41504
    v_mfma_f32_16x16x32_bf16 v[32:35], v[104:107], v[152:155], v[32:35]
    s_bfe_u32 s22, s42, 0x3000c
    s_or_b32 s22, s22, s62
    s_lshl_b32 s22, s22, 18
    s_add_u32 s22, s22, s16
    s_add_u32 s22, s22, 0x26000
    s_add_u32 m0, s17, 0x1cc00
    s_nop 0
    buffer_load_dwordx4 v18, s[4:7], s22 offen lds
    ds_read_b64_tr_b16 v[98:99], v2 offset:45600
    s_waitcnt lgkmcnt(6)
    v_mfma_f32_16x16x32_bf16 v[36:39], v[84:87], v[148:151], v[36:39]
    ds_read_b64_tr_b16 v[100:101], v3 offset:41728
    v_mfma_f32_16x16x32_bf16 v[40:43], v[84:87], v[152:155], v[40:43]
    ds_read_b64_tr_b16 v[102:103], v3 offset:45824
    s_waitcnt lgkmcnt(6)
    v_mfma_f32_16x16x32_bf16 v[44:47], v[88:91], v[148:151], v[44:47]
    ds_read_b64_tr_b16 v[104:105], v2 offset:41760
    v_mfma_f32_16x16x32_bf16 v[48:51], v[88:91], v[152:155], v[48:51]
    ds_read_b64_tr_b16 v[106:107], v2 offset:45856
    s_add_u32 s23, s21, 0x1000800
    buffer_load_dwordx4 v[116:119], v4, s[8:11], s23 offen offset:1024 sc1
    s_waitcnt lgkmcnt(6)
    v_mfma_f32_16x16x32_bf16 v[52:55], v[92:95], v[148:151], v[52:55]
    v_mfma_f32_16x16x32_bf16 v[56:59], v[92:95], v[152:155], v[56:59]
    s_barrier
    ds_read_b64_tr_b16 v[84:85], v3 offset:49152
    ds_read_b64_tr_b16 v[86:87], v3 offset:53248
    s_waitcnt lgkmcnt(6)
    v_mfma_f32_16x16x32_bf16 v[60:63], v[96:99], v[148:151], v[60:63]
    ds_read_b64_tr_b16 v[88:89], v2 offset:49184
    v_mfma_f32_16x16x32_bf16 v[64:67], v[96:99], v[152:155], v[64:67]
    s_bfe_u32 s22, s42, 0x30010
    s_or_b32 s22, s22, s62
    s_lshl_b32 s22, s22, 18
    s_add_u32 s22, s22, s16
    s_add_u32 s22, s22, 0x0
    s_add_u32 m0, s17, 0x0
    s_nop 0
    buffer_load_dwordx4 v17, s[4:7], s22 offen lds
    ds_read_b64_tr_b16 v[90:91], v2 offset:53280
    s_waitcnt lgkmcnt(6)
    v_mfma_f32_16x16x32_bf16 v[68:71], v[100:103], v[148:151], v[68:71]
    ds_read_b64_tr_b16 v[92:93], v3 offset:49408
    v_mfma_f32_16x16x32_bf16 v[72:75], v[100:103], v[152:155], v[72:75]
    ds_read_b64_tr_b16 v[94:95], v3 offset:53504
    s_waitcnt lgkmcnt(6)
    v_mfma_f32_16x16x32_bf16 v[76:79], v[104:107], v[148:151], v[76:79]
    ds_read_b64_tr_b16 v[96:97], v2 offset:49440
    v_mfma_f32_16x16x32_bf16 v[80:83], v[104:107], v[152:155], v[80:83]
    ds_read_b64_tr_b16 v[98:99], v2 offset:53536
    s_add_u32 s23, s21, 0x1020800
    buffer_load_dwordx4 v[120:123], v4, s[8:11], s23 offen offset:1024 sc1
    s_waitcnt vmcnt(15) lgkmcnt(6)
    v_mfma_f32_16x16x32_bf16 v[20:23], v[84:87], v[156:159], v[20:23]
    ds_read_b64_tr_b16 v[100:101], v3 offset:49664
    s_waitcnt vmcnt(14)
    v_mfma_f32_16x16x32_bf16 v[24:27], v[84:87], v[160:163], v[24:27]
    ds_read_b64_tr_b16 v[102:103], v3 offset:53760
    s_waitcnt lgkmcnt(6)
    v_mfma_f32_16x16x32_bf16 v[28:31], v[88:91], v[156:159], v[28:31]
    ds_read_b64_tr_b16 v[104:105], v2 offset:49696
    v_mfma_f32_16x16x32_bf16 v[32:35], v[88:91], v[160:163], v[32:35]
    s_bfe_u32 s22, s42, 0x30010
    s_or_b32 s22, s22, s62
    s_lshl_b32 s22, s22, 18
    s_add_u32 s22, s22, s16
    s_add_u32 s22, s22, 0x2000
    s_add_u32 m0, s17, 0x400
    s_nop 0
    buffer_load_dwordx4 v18, s[4:7], s22 offen lds
    ds_read_b64_tr_b16 v[106:107], v2 offset:53792
    s_waitcnt lgkmcnt(6)
    v_mfma_f32_16x16x32_bf16 v[36:39], v[92:95], v[156:159], v[36:39]
    ds_read_b64_tr_b16 v[84:85], v3 offset:49920
    v_mfma_f32_16x16x32_bf16 v[40:43], v[92:95], v[160:163], v[40:43]
    ds_read_b64_tr_b16 v[86:87], v3 offset:54016
    s_waitcnt lgkmcnt(6)
    v_mfma_f32_16x16x32_bf16 v[44:47], v[96:99], v[156:159], v[44:47]
    ds_read_b64_tr_b16 v[88:89], v2 offset:49952
    v_mfma_f32_16x16x32_bf16 v[48:51], v[96:99], v[160:163], v[48:51]
    ds_read_b64_tr_b16 v[90:91], v2 offset:54048
    s_bfe_u32 s21, s42, 0x3000c
    s_or_b32 s21, s21, s62
    s_lshl_b32 s21, s21, 12
    s_add_u32 s23, s21, 0x1000000
    buffer_load_dwordx4 v[140:143], v4, s[8:11], s23 offen offset:0 sc1
    s_waitcnt lgkmcnt(6)
    v_mfma_f32_16x16x32_bf16 v[52:55], v[100:103], v[156:159], v[52:55]
    ds_read_b64_tr_b16 v[92:93], v3 offset:57344
    v_mfma_f32_16x16x32_bf16 v[56:59], v[100:103], v[160:163], v[56:59]
    ds_read_b64_tr_b16 v[94:95], v3 offset:61440
    s_waitcnt lgkmcnt(6)
    v_mfma_f32_16x16x32_bf16 v[60:63], v[104:107], v[156:159], v[60:63]
    ds_read_b64_tr_b16 v[96:97], v2 offset:57376
    v_mfma_f32_16x16x32_bf16 v[64:67], v[104:107], v[160:163], v[64:67]
    s_bfe_u32 s22, s42, 0x30010
    s_or_b32 s22, s22, s62
    s_lshl_b32 s22, s22, 18
    s_add_u32 s22, s22, s16
    s_add_u32 s22, s22, 0x4000
    s_add_u32 m0, s17, 0x800
    s_nop 0
    buffer_load_dwordx4 v17, s[4:7], s22 offen lds
    ds_read_b64_tr_b16 v[98:99], v2 offset:61472
    s_waitcnt lgkmcnt(6)
    v_mfma_f32_16x16x32_bf16 v[68:71], v[84:87], v[156:159], v[68:71]
    ds_read_b64_tr_b16 v[100:101], v3 offset:57600
    v_mfma_f32_16x16x32_bf16 v[72:75], v[84:87], v[160:163], v[72:75]
    ds_read_b64_tr_b16 v[102:103], v3 offset:61696
    s_waitcnt lgkmcnt(6)
    v_mfma_f32_16x16x32_bf16 v[76:79], v[88:91], v[156:159], v[76:79]
    ds_read_b64_tr_b16 v[104:105], v2 offset:57632
    v_mfma_f32_16x16x32_bf16 v[80:83], v[88:91], v[160:163], v[80:83]
    ds_read_b64_tr_b16 v[106:107], v2 offset:61728
    s_add_u32 s23, s21, 0x1020000
    buffer_load_dwordx4 v[144:147], v4, s[8:11], s23 offen offset:0 sc1
    s_waitcnt vmcnt(17) lgkmcnt(6)
    v_mfma_f32_16x16x32_bf16 v[20:23], v[92:95], v[164:167], v[20:23]
    ds_read_b64_tr_b16 v[84:85], v3 offset:57856
    s_waitcnt vmcnt(16)
    v_mfma_f32_16x16x32_bf16 v[24:27], v[92:95], v[168:171], v[24:27]
    ds_read_b64_tr_b16 v[86:87], v3 offset:61952
    s_waitcnt lgkmcnt(6)
    v_mfma_f32_16x16x32_bf16 v[28:31], v[96:99], v[164:167], v[28:31]
    ds_read_b64_tr_b16 v[88:89], v2 offset:57888
    v_mfma_f32_16x16x32_bf16 v[32:35], v[96:99], v[168:171], v[32:35]
    s_bfe_u32 s22, s42, 0x30010
    s_or_b32 s22, s22, s62
    s_lshl_b32 s22, s22, 18
    s_add_u32 s22, s22, s16
    s_add_u32 s22, s22, 0x6000
    s_add_u32 m0, s17, 0xc00
    s_nop 0
    buffer_load_dwordx4 v18, s[4:7], s22 offen lds
    ds_read_b64_tr_b16 v[90:91], v2 offset:61984
    s_waitcnt lgkmcnt(6)
    v_mfma_f32_16x16x32_bf16 v[36:39], v[100:103], v[164:167], v[36:39]
    ds_read_b64_tr_b16 v[92:93], v3 offset:58112
    v_mfma_f32_16x16x32_bf16 v[40:43], v[100:103], v[168:171], v[40:43]
    ds_read_b64_tr_b16 v[94:95], v3 offset:62208
    s_waitcnt lgkmcnt(6)
    v_mfma_f32_16x16x32_bf16 v[44:47], v[104:107], v[164:167], v[44:47]
    ds_read_b64_tr_b16 v[96:97], v2 offset:58144
    v_mfma_f32_16x16x32_bf16 v[48:51], v[104:107], v[168:171], v[48:51]
    ds_read_b64_tr_b16 v[98:99], v2 offset:62240
    s_add_u32 s23, s21, 0x1000000
    buffer_load_dwordx4 v[148:151], v4, s[8:11], s23 offen offset:1024 sc1
    s_waitcnt lgkmcnt(6)
    v_mfma_f32_16x16x32_bf16 v[52:55], v[84:87], v[164:167], v[52:55]
    v_mfma_f32_16x16x32_bf16 v[56:59], v[84:87], v[168:171], v[56:59]
    s_barrier
    ds_read_b64_tr_b16 v[100:101], v15 offset:0
    ds_read_b64_tr_b16 v[102:103], v15 offset:4096
    s_waitcnt lgkmcnt(6)
    v_mfma_f32_16x16x32_bf16 v[60:63], v[88:91], v[164:167], v[60:63]
    ds_read_b64_tr_b16 v[104:105], v16 offset:32
    v_mfma_f32_16x16x32_bf16 v[64:67], v[88:91], v[168:171], v[64:67]
    s_bfe_u32 s22, s42, 0x30010
    s_or_b32 s22, s22, s62
    s_lshl_b32 s22, s22, 18
    s_add_u32 s22, s22, s16
    s_add_u32 s22, s22, 0x20000
    s_add_u32 m0, s17, 0x4000
    s_nop 0
    buffer_load_dwordx4 v17, s[4:7], s22 offen lds
    ds_read_b64_tr_b16 v[106:107], v16 offset:4128
    s_waitcnt lgkmcnt(6)
    v_mfma_f32_16x16x32_bf16 v[68:71], v[92:95], v[164:167], v[68:71]
    ds_read_b64_tr_b16 v[84:85], v15 offset:256
    v_mfma_f32_16x16x32_bf16 v[72:75], v[92:95], v[168:171], v[72:75]
    ds_read_b64_tr_b16 v[86:87], v15 offset:4352
    s_waitcnt lgkmcnt(6)
    v_mfma_f32_16x16x32_bf16 v[76:79], v[96:99], v[164:167], v[76:79]
    ds_read_b64_tr_b16 v[88:89], v16 offset:288
    v_mfma_f32_16x16x32_bf16 v[80:83], v[96:99], v[168:171], v[80:83]
    ds_read_b64_tr_b16 v[90:91], v16 offset:4384
    s_add_u32 s23, s21, 0x1020000
    buffer_load_dwordx4 v[152:155], v4, s[8:11], s23 offen offset:1024 sc1
    s_waitcnt vmcnt(19) lgkmcnt(6)
    v_mfma_f32_16x16x32_bf16 v[20:23], v[100:103], v[188:191], v[20:23]
    ds_read_b64_tr_b16 v[92:93], v15 offset:512
    s_waitcnt vmcnt(18)
    v_mfma_f32_16x16x32_bf16 v[24:27], v[100:103], v[192:195], v[24:27]
    ds_read_b64_tr_b16 v[94:95], v15 offset:4608
    s_waitcnt lgkmcnt(6)
    v_mfma_f32_16x16x32_bf16 v[28:31], v[104:107], v[188:191], v[28:31]
    ds_read_b64_tr_b16 v[96:97], v16 offset:544
    v_mfma_f32_16x16x32_bf16 v[32:35], v[104:107], v[192:195], v[32:35]
    s_bfe_u32 s22, s42, 0x30010
    s_or_b32 s22, s22, s62
    s_lshl_b32 s22, s22, 18
    s_add_u32 s22, s22, s16
    s_add_u32 s22, s22, 0x22000
    s_add_u32 m0, s17, 0x4400
    s_nop 0
    buffer_load_dwordx4 v18, s[4:7], s22 offen lds
    ds_read_b64_tr_b16 v[98:99], v16 offset:4640
    s_waitcnt lgkmcnt(6)
    v_mfma_f32_16x16x32_bf16 v[36:39], v[84:87], v[188:191], v[36:39]
    ds_read_b64_tr_b16 v[100:101], v15 offset:768
    v_mfma_f32_16x16x32_bf16 v[40:43], v[84:87], v[192:195], v[40:43]
    ds_read_b64_tr_b16 v[102:103], v15 offset:4864
    s_waitcnt lgkmcnt(6)
    v_mfma_f32_16x16x32_bf16 v[44:47], v[88:91], v[188:191], v[44:47]
    ds_read_b64_tr_b16 v[104:105], v16 offset:800
    v_mfma_f32_16x16x32_bf16 v[48:51], v[88:91], v[192:195], v[48:51]
    ds_read_b64_tr_b16 v[106:107], v16 offset:4896
    s_add_u32 s23, s21, 0x1000800
    buffer_load_dwordx4 v[156:159], v4, s[8:11], s23 offen offset:0 sc1
    s_waitcnt lgkmcnt(6)
    v_mfma_f32_16x16x32_bf16 v[52:55], v[92:95], v[188:191], v[52:55]
    ds_read_b64_tr_b16 v[84:85], v15 offset:8192
    v_mfma_f32_16x16x32_bf16 v[56:59], v[92:95], v[192:195], v[56:59]
    ds_read_b64_tr_b16 v[86:87], v15 offset:12288
    s_waitcnt lgkmcnt(6)
    v_mfma_f32_16x16x32_bf16 v[60:63], v[96:99], v[188:191], v[60:63]
    ds_read_b64_tr_b16 v[88:89], v16 offset:8224
    v_mfma_f32_16x16x32_bf16 v[64:67], v[96:99], v[192:195], v[64:67]
    s_bfe_u32 s22, s42, 0x30010
    s_or_b32 s22, s22, s62
    s_lshl_b32 s22, s22, 18
    s_add_u32 s22, s22, s16
    s_add_u32 s22, s22, 0x24000
    s_add_u32 m0, s17, 0x4800
    s_nop 0
    buffer_load_dwordx4 v17, s[4:7], s22 offen lds
    ds_read_b64_tr_b16 v[90:91], v16 offset:12320
    s_waitcnt lgkmcnt(6)
    v_mfma_f32_16x16x32_bf16 v[68:71], v[100:103], v[188:191], v[68:71]
    ds_read_b64_tr_b16 v[92:93], v15 offset:8448
    v_mfma_f32_16x16x32_bf16 v[72:75], v[100:103], v[192:195], v[72:75]
    ds_read_b64_tr_b16 v[94:95], v15 offset:12544
    s_waitcnt lgkmcnt(6)
    v_mfma_f32_16x16x32_bf16 v[76:79], v[104:107], v[188:191], v[76:79]
    ds_read_b64_tr_b16 v[96:97], v16 offset:8480
    v_mfma_f32_16x16x32_bf16 v[80:83], v[104:107], v[192:195], v[80:83]
    ds_read_b64_tr_b16 v[98:99], v16 offset:12576
    s_add_u32 s23, s21, 0x1020800
    buffer_load_dwordx4 v[160:163], v4, s[8:11], s23 offen offset:0 sc1
    s_waitcnt vmcnt(21) lgkmcnt(6)
    v_mfma_f32_16x16x32_bf16 v[20:23], v[84:87], v[196:199], v[20:23]
    ds_read_b64_tr_b16 v[100:101], v15 offset:8704
    s_waitcnt vmcnt(20)
    v_mfma_f32_16x16x32_bf16 v[24:27], v[84:87], v[200:203], v[24:27]
    ds_read_b64_tr_b16 v[102:103], v15 offset:12800
    s_waitcnt lgkmcnt(6)
    v_mfma_f32_16x16x32_bf16 v[28:31], v[88:91], v[196:199], v[28:31]
    ds_read_b64_tr_b16 v[104:105], v16 offset:8736
    v_mfma_f32_16x16x32_bf16 v[32:35], v[88:91], v[200:203], v[32:35]
    s_bfe_u32 s22, s42, 0x30010
    s_or_b32 s22, s22, s62
    s_lshl_b32 s22, s22, 18
    s_add_u32 s22, s22, s16
    s_add_u32 s22, s22, 0x26000
    s_add_u32 m0, s17, 0x4c00
    s_nop 0
    buffer_load_dwordx4 v18, s[4:7], s22 offen lds
    ds_read_b64_tr_b16 v[106:107], v16 offset:12832
    s_waitcnt lgkmcnt(6)
    v_mfma_f32_16x16x32_bf16 v[36:39], v[92:95], v[196:199], v[36:39]
    ds_read_b64_tr_b16 v[84:85], v15 offset:8960
    v_mfma_f32_16x16x32_bf16 v[40:43], v[92:95], v[200:203], v[40:43]
    ds_read_b64_tr_b16 v[86:87], v15 offset:13056
    s_waitcnt lgkmcnt(6)
    v_mfma_f32_16x16x32_bf16 v[44:47], v[96:99], v[196:199], v[44:47]
    ds_read_b64_tr_b16 v[88:89], v16 offset:8992
    v_mfma_f32_16x16x32_bf16 v[48:51], v[96:99], v[200:203], v[48:51]
    ds_read_b64_tr_b16 v[90:91], v16 offset:13088
    s_add_u32 s23, s21, 0x1000800
    buffer_load_dwordx4 v[164:167], v4, s[8:11], s23 offen offset:1024 sc1
    s_waitcnt lgkmcnt(6)
    v_mfma_f32_16x16x32_bf16 v[52:55], v[100:103], v[196:199], v[52:55]
    v_mfma_f32_16x16x32_bf16 v[56:59], v[100:103], v[200:203], v[56:59]
    s_barrier
    ds_read_b64_tr_b16 v[92:93], v15 offset:16384
    ds_read_b64_tr_b16 v[94:95], v15 offset:20480
    s_waitcnt lgkmcnt(6)
    v_mfma_f32_16x16x32_bf16 v[60:63], v[104:107], v[196:199], v[60:63]
    ds_read_b64_tr_b16 v[96:97], v16 offset:16416
    v_mfma_f32_16x16x32_bf16 v[64:67], v[104:107], v[200:203], v[64:67]
    s_bfe_u32 s22, s42, 0x30014
    s_or_b32 s22, s22, s62
    s_lshl_b32 s22, s22, 18
    s_add_u32 s22, s22, s16
    s_add_u32 s22, s22, 0x0
    s_add_u32 m0, s17, 0x8000
    s_nop 0
    buffer_load_dwordx4 v17, s[4:7], s22 offen lds
    ds_read_b64_tr_b16 v[98:99], v16 offset:20512
    s_waitcnt lgkmcnt(6)
    v_mfma_f32_16x16x32_bf16 v[68:71], v[84:87], v[196:199], v[68:71]
    ds_read_b64_tr_b16 v[100:101], v15 offset:16640
    v_mfma_f32_16x16x32_bf16 v[72:75], v[84:87], v[200:203], v[72:75]
    ds_read_b64_tr_b16 v[102:103], v15 offset:20736
    s_waitcnt lgkmcnt(6)
    v_mfma_f32_16x16x32_bf16 v[76:79], v[88:91], v[196:199], v[76:79]
    ds_read_b64_tr_b16 v[104:105], v16 offset:16672
    v_mfma_f32_16x16x32_bf16 v[80:83], v[88:91], v[200:203], v[80:83]
    ds_read_b64_tr_b16 v[106:107], v16 offset:20768
    s_add_u32 s23, s21, 0x1020800
    buffer_load_dwordx4 v[168:171], v4, s[8:11], s23 offen offset:1024 sc1
    s_waitcnt vmcnt(22) lgkmcnt(6)
    v_mfma_f32_16x16x32_bf16 v[20:23], v[92:95], v[108:111], v[20:23]
    ds_read_b64_tr_b16 v[84:85], v15 offset:16896
    s_waitcnt vmcnt(20)
    v_mfma_f32_16x16x32_bf16 v[24:27], v[92:95], v[112:115], v[24:27]
    ds_read_b64_tr_b16 v[86:87], v15 offset:20992
    s_waitcnt lgkmcnt(6)
    v_mfma_f32_16x16x32_bf16 v[28:31], v[96:99], v[108:111], v[28:31]
    ds_read_b64_tr_b16 v[88:89], v16 offset:16928
    v_mfma_f32_16x16x32_bf16 v[32:35], v[96:99], v[112:115], v[32:35]
    s_bfe_u32 s22, s42, 0x30014
    s_or_b32 s22, s22, s62
    s_lshl_b32 s22, s22, 18
    s_add_u32 s22, s22, s16
    s_add_u32 s22, s22, 0x2000
    s_add_u32 m0, s17, 0x8400
    s_nop 0
    buffer_load_dwordx4 v18, s[4:7], s22 offen lds
    ds_read_b64_tr_b16 v[90:91], v16 offset:21024
    s_waitcnt lgkmcnt(6)
    v_mfma_f32_16x16x32_bf16 v[36:39], v[100:103], v[108:111], v[36:39]
    ds_read_b64_tr_b16 v[92:93], v15 offset:17152
    v_mfma_f32_16x16x32_bf16 v[40:43], v[100:103], v[112:115], v[40:43]
    ds_read_b64_tr_b16 v[94:95], v15 offset:21248
    s_waitcnt lgkmcnt(6)
    v_mfma_f32_16x16x32_bf16 v[44:47], v[104:107], v[108:111], v[44:47]
    ds_read_b64_tr_b16 v[96:97], v16 offset:17184
    v_mfma_f32_16x16x32_bf16 v[48:51], v[104:107], v[112:115], v[48:51]
    ds_read_b64_tr_b16 v[98:99], v16 offset:21280
    s_bfe_u32 s21, s42, 0x30010
    s_or_b32 s21, s21, s62
    s_lshl_b32 s21, s21, 12
    s_add_u32 s23, s21, 0x1000000
    buffer_load_dwordx4 v[188:191], v4, s[8:11], s23 offen offset:0 sc1
    s_waitcnt lgkmcnt(6)
    v_mfma_f32_16x16x32_bf16 v[52:55], v[84:87], v[108:111], v[52:55]
    ds_read_b64_tr_b16 v[100:101], v15 offset:24576
    v_mfma_f32_16x16x32_bf16 v[56:59], v[84:87], v[112:115], v[56:59]
    ds_read_b64_tr_b16 v[102:103], v15 offset:28672
    s_waitcnt lgkmcnt(6)
    v_mfma_f32_16x16x32_bf16 v[60:63], v[88:91], v[108:111], v[60:63]
    ds_read_b64_tr_b16 v[104:105], v16 offset:24608
    v_mfma_f32_16x16x32_bf16 v[64:67], v[88:91], v[112:115], v[64:67]
    s_bfe_u32 s22, s42, 0x30014
    s_or_b32 s22, s22, s62
    s_lshl_b32 s22, s22, 18
    s_add_u32 s22, s22, s16
    s_add_u32 s22, s22, 0x4000
    s_add_u32 m0, s17, 0x8800
    s_nop 0
    buffer_load_dwordx4 v17, s[4:7], s22 offen lds
    ds_read_b64_tr_b16 v[106:107], v16 offset:28704
    s_waitcnt lgkmcnt(6)
    v_mfma_f32_16x16x32_bf16 v[68:71], v[92:95], v[108:111], v[68:71]
    ds_read_b64_tr_b16 v[84:85], v15 offset:24832
    v_mfma_f32_16x16x32_bf16 v[72:75], v[92:95], v[112:115], v[72:75]
    ds_read_b64_tr_b16 v[86:87], v15 offset:28928
    s_waitcnt lgkmcnt(6)
    v_mfma_f32_16x16x32_bf16 v[76:79], v[96:99], v[108:111], v[76:79]
    ds_read_b64_tr_b16 v[88:89], v16 offset:24864
    v_mfma_f32_16x16x32_bf16 v[80:83], v[96:99], v[112:115], v[80:83]
    ds_read_b64_tr_b16 v[90:91], v16 offset:28960
    s_add_u32 s23, s21, 0x1020000
    buffer_load_dwordx4 v[192:195], v4, s[8:11], s23 offen offset:0 sc1
    s_waitcnt vmcnt(22) lgkmcnt(6)
    v_mfma_f32_16x16x32_bf16 v[20:23], v[100:103], v[116:119], v[20:23]
    ds_read_b64_tr_b16 v[92:93], v15 offset:25088
    s_waitcnt vmcnt(20)
    v_mfma_f32_16x16x32_bf16 v[24:27], v[100:103], v[120:123], v[24:27]
    ds_read_b64_tr_b16 v[94:95], v15 offset:29184
    s_waitcnt lgkmcnt(6)
    v_mfma_f32_16x16x32_bf16 v[28:31], v[104:107], v[116:119], v[28:31]
    ds_read_b64_tr_b16 v[96:97], v16 offset:25120
    v_mfma_f32_16x16x32_bf16 v[32:35], v[104:107], v[120:123], v[32:35]
    s_bfe_u32 s22, s42, 0x30014
    s_or_b32 s22, s22, s62
    s_lshl_b32 s22, s22, 18
    s_add_u32 s22, s22, s16
    s_add_u32 s22, s22, 0x6000
    s_add_u32 m0, s17, 0x8c00
    s_nop 0
    buffer_load_dwordx4 v18, s[4:7], s22 offen lds
    ds_read_b64_tr_b16 v[98:99], v16 offset:29216
    s_waitcnt lgkmcnt(6)
    v_mfma_f32_16x16x32_bf16 v[36:39], v[84:87], v[116:119], v[36:39]
    ds_read_b64_tr_b16 v[100:101], v15 offset:25344
    v_mfma_f32_16x16x32_bf16 v[40:43], v[84:87], v[120:123], v[40:43]
    ds_read_b64_tr_b16 v[102:103], v15 offset:29440
    s_waitcnt lgkmcnt(6)
    v_mfma_f32_16x16x32_bf16 v[44:47], v[88:91], v[116:119], v[44:47]
    ds_read_b64_tr_b16 v[104:105], v16 offset:25376
    v_mfma_f32_16x16x32_bf16 v[48:51], v[88:91], v[120:123], v[48:51]
    ds_read_b64_tr_b16 v[106:107], v16 offset:29472
    s_add_u32 s23, s21, 0x1000000
    buffer_load_dwordx4 v[196:199], v4, s[8:11], s23 offen offset:1024 sc1
    s_waitcnt lgkmcnt(6)
    v_mfma_f32_16x16x32_bf16 v[52:55], v[92:95], v[116:119], v[52:55]
    v_mfma_f32_16x16x32_bf16 v[56:59], v[92:95], v[120:123], v[56:59]
    s_barrier
    ds_read_b64_tr_b16 v[84:85], v15 offset:32768
    ds_read_b64_tr_b16 v[86:87], v15 offset:36864
    s_waitcnt lgkmcnt(6)
    v_mfma_f32_16x16x32_bf16 v[60:63], v[96:99], v[116:119], v[60:63]
    ds_read_b64_tr_b16 v[88:89], v16 offset:32800
    v_mfma_f32_16x16x32_bf16 v[64:67], v[96:99], v[120:123], v[64:67]
    s_bfe_u32 s22, s42, 0x30014
    s_or_b32 s22, s22, s62
    s_lshl_b32 s22, s22, 18
    s_add_u32 s22, s22, s16
    s_add_u32 s22, s22, 0x20000
    s_add_u32 m0, s17, 0xc000
    s_nop 0
    buffer_load_dwordx4 v17, s[4:7], s22 offen lds
    ds_read_b64_tr_b16 v[90:91], v16 offset:36896
    s_waitcnt lgkmcnt(6)
    v_mfma_f32_16x16x32_bf16 v[68:71], v[100:103], v[116:119], v[68:71]
    ds_read_b64_tr_b16 v[92:93], v15 offset:33024
    v_mfma_f32_16x16x32_bf16 v[72:75], v[100:103], v[120:123], v[72:75]
    ds_read_b64_tr_b16 v[94:95], v15 offset:37120
    s_waitcnt lgkmcnt(6)
    v_mfma_f32_16x16x32_bf16 v[76:79], v[104:107], v[116:119], v[76:79]
    ds_read_b64_tr_b16 v[96:97], v16 offset:33056
    v_mfma_f32_16x16x32_bf16 v[80:83], v[104:107], v[120:123], v[80:83]
    ds_read_b64_tr_b16 v[98:99], v16 offset:37152
    s_add_u32 s23, s21, 0x1020000
    buffer_load_dwordx4 v[200:203], v4, s[8:11], s23 offen offset:1024 sc1
    s_waitcnt vmcnt(22) lgkmcnt(6)
    v_mfma_f32_16x16x32_bf16 v[20:23], v[84:87], v[140:143], v[20:23]
    ds_read_b64_tr_b16 v[100:101], v15 offset:33280
    s_waitcnt vmcnt(20)
    v_mfma_f32_16x16x32_bf16 v[24:27], v[84:87], v[144:147], v[24:27]
    ds_read_b64_tr_b16 v[102:103], v15 offset:37376
    s_waitcnt lgkmcnt(6)
    v_mfma_f32_16x16x32_bf16 v[28:31], v[88:91], v[140:143], v[28:31]
    ds_read_b64_tr_b16 v[104:105], v16 offset:33312
    v_mfma_f32_16x16x32_bf16 v[32:35], v[88:91], v[144:147], v[32:35]
    s_bfe_u32 s22, s42, 0x30014
    s_or_b32 s22, s22, s62
    s_lshl_b32 s22, s22, 18
    s_add_u32 s22, s22, s16
    s_add_u32 s22, s22, 0x22000
    s_add_u32 m0, s17, 0xc400
    s_nop 0
    buffer_load_dwordx4 v18, s[4:7], s22 offen lds
    ds_read_b64_tr_b16 v[106:107], v16 offset:37408
    s_waitcnt lgkmcnt(6)
    v_mfma_f32_16x16x32_bf16 v[36:39], v[92:95], v[140:143], v[36:39]
    ds_read_b64_tr_b16 v[84:85], v15 offset:33536
    v_mfma_f32_16x16x32_bf16 v[40:43], v[92:95], v[144:147], v[40:43]
    ds_read_b64_tr_b16 v[86:87], v15 offset:37632
    s_waitcnt lgkmcnt(6)
    v_mfma_f32_16x16x32_bf16 v[44:47], v[96:99], v[140:143], v[44:47]
    ds_read_b64_tr_b16 v[88:89], v16 offset:33568
    v_mfma_f32_16x16x32_bf16 v[48:51], v[96:99], v[144:147], v[48:51]
    ds_read_b64_tr_b16 v[90:91], v16 offset:37664
    s_add_u32 s23, s21, 0x1000800
    buffer_load_dwordx4 v[108:111], v4, s[8:11], s23 offen offset:0 sc1
    s_waitcnt lgkmcnt(6)
    v_mfma_f32_16x16x32_bf16 v[52:55], v[100:103], v[140:143], v[52:55]
    ds_read_b64_tr_b16 v[92:93], v15 offset:40960
    v_mfma_f32_16x16x32_bf16 v[56:59], v[100:103], v[144:147], v[56:59]
    ds_read_b64_tr_b16 v[94:95], v15 offset:45056
    s_waitcnt lgkmcnt(6)
    v_mfma_f32_16x16x32_bf16 v[60:63], v[104:107], v[140:143], v[60:63]
    ds_read_b64_tr_b16 v[96:97], v16 offset:40992
    v_mfma_f32_16x16x32_bf16 v[64:67], v[104:107], v[144:147], v[64:67]
    s_bfe_u32 s22, s42, 0x30014
    s_or_b32 s22, s22, s62
    s_lshl_b32 s22, s22, 18
    s_add_u32 s22, s22, s16
    s_add_u32 s22, s22, 0x24000
    s_add_u32 m0, s17, 0xc800
    s_nop 0
    buffer_load_dwordx4 v17, s[4:7], s22 offen lds
    ds_read_b64_tr_b16 v[98:99], v16 offset:45088
    s_waitcnt lgkmcnt(6)
    v_mfma_f32_16x16x32_bf16 v[68:71], v[84:87], v[140:143], v[68:71]
    ds_read_b64_tr_b16 v[100:101], v15 offset:41216
    v_mfma_f32_16x16x32_bf16 v[72:75], v[84:87], v[144:147], v[72:75]
    ds_read_b64_tr_b16 v[102:103], v15 offset:45312
    s_waitcnt lgkmcnt(6)
    v_mfma_f32_16x16x32_bf16 v[76:79], v[88:91], v[140:143], v[76:79]
    ds_read_b64_tr_b16 v[104:105], v16 offset:41248
    v_mfma_f32_16x16x32_bf16 v[80:83], v[88:91], v[144:147], v[80:83]
    ds_read_b64_tr_b16 v[106:107], v16 offset:45344
    s_add_u32 s23, s21, 0x1020800
    buffer_load_dwordx4 v[112:115], v4, s[8:11], s23 offen offset:0 sc1
    s_waitcnt vmcnt(22) lgkmcnt(6)
    v_mfma_f32_16x16x32_bf16 v[20:23], v[92:95], v[148:151], v[20:23]
    ds_read_b64_tr_b16 v[84:85], v15 offset:41472
    s_waitcnt vmcnt(20)
    v_mfma_f32_16x16x32_bf16 v[24:27], v[92:95], v[152:155], v[24:27]
    ds_read_b64_tr_b16 v[86:87], v15 offset:45568
    s_waitcnt lgkmcnt(6)
    v_mfma_f32_16x16x32_bf16 v[28:31], v[96:99], v[148:151], v[28:31]
    ds_read_b64_tr_b16 v[88:89], v16 offset:41504
    v_mfma_f32_16x16x32_bf16 v[32:35], v[96:99], v[152:155], v[32:35]
    s_bfe_u32 s22, s42, 0x30014
    s_or_b32 s22, s22, s62
    s_lshl_b32 s22, s22, 18
    s_add_u32 s22, s22, s16
    s_add_u32 s22, s22, 0x26000
    s_add_u32 m0, s17, 0xcc00
    s_nop 0
    buffer_load_dwordx4 v18, s[4:7], s22 offen lds
    ds_read_b64_tr_b16 v[90:91], v16 offset:45600
    s_waitcnt lgkmcnt(6)
    v_mfma_f32_16x16x32_bf16 v[36:39], v[100:103], v[148:151], v[36:39]
    ds_read_b64_tr_b16 v[92:93], v15 offset:41728
    v_mfma_f32_16x16x32_bf16 v[40:43], v[100:103], v[152:155], v[40:43]
    ds_read_b64_tr_b16 v[94:95], v15 offset:45824
    s_waitcnt lgkmcnt(6)
    v_mfma_f32_16x16x32_bf16 v[44:47], v[104:107], v[148:151], v[44:47]
    ds_read_b64_tr_b16 v[96:97], v16 offset:41760
    v_mfma_f32_16x16x32_bf16 v[48:51], v[104:107], v[152:155], v[48:51]
    ds_read_b64_tr_b16 v[98:99], v16 offset:45856
    s_add_u32 s23, s21, 0x1000800
    buffer_load_dwordx4 v[116:119], v4, s[8:11], s23 offen offset:1024 sc1
    s_waitcnt lgkmcnt(6)
    v_mfma_f32_16x16x32_bf16 v[52:55], v[84:87], v[148:151], v[52:55]
    v_mfma_f32_16x16x32_bf16 v[56:59], v[84:87], v[152:155], v[56:59]
    s_barrier
    ds_read_b64_tr_b16 v[100:101], v15 offset:49152
    ds_read_b64_tr_b16 v[102:103], v15 offset:53248
    s_waitcnt lgkmcnt(6)
    v_mfma_f32_16x16x32_bf16 v[60:63], v[88:91], v[148:151], v[60:63]
    ds_read_b64_tr_b16 v[104:105], v16 offset:49184
    v_mfma_f32_16x16x32_bf16 v[64:67], v[88:91], v[152:155], v[64:67]
    s_bfe_u32 s22, s42, 0x30018
    s_or_b32 s22, s22, s62
    s_lshl_b32 s22, s22, 18
    s_add_u32 s22, s22, s16
    s_add_u32 s22, s22, 0x0
    s_add_u32 m0, s17, 0x10000
    s_nop 0
    buffer_load_dwordx4 v17, s[4:7], s22 offen lds
    ds_read_b64_tr_b16 v[106:107], v16 offset:53280
    s_waitcnt lgkmcnt(6)
    v_mfma_f32_16x16x32_bf16 v[68:71], v[92:95], v[148:151], v[68:71]
    ds_read_b64_tr_b16 v[84:85], v15 offset:49408
    v_mfma_f32_16x16x32_bf16 v[72:75], v[92:95], v[152:155], v[72:75]
    ds_read_b64_tr_b16 v[86:87], v15 offset:53504
    s_waitcnt lgkmcnt(6)
    v_mfma_f32_16x16x32_bf16 v[76:79], v[96:99], v[148:151], v[76:79]
    ds_read_b64_tr_b16 v[88:89], v16 offset:49440
    v_mfma_f32_16x16x32_bf16 v[80:83], v[96:99], v[152:155], v[80:83]
    ds_read_b64_tr_b16 v[90:91], v16 offset:53536
    s_add_u32 s23, s21, 0x1020800
    buffer_load_dwordx4 v[120:123], v4, s[8:11], s23 offen offset:1024 sc1
    s_waitcnt vmcnt(22) lgkmcnt(6)
    v_mfma_f32_16x16x32_bf16 v[20:23], v[100:103], v[156:159], v[20:23]
    ds_read_b64_tr_b16 v[92:93], v15 offset:49664
    s_waitcnt vmcnt(20)
    v_mfma_f32_16x16x32_bf16 v[24:27], v[100:103], v[160:163], v[24:27]
    ds_read_b64_tr_b16 v[94:95], v15 offset:53760
    s_waitcnt lgkmcnt(6)
    v_mfma_f32_16x16x32_bf16 v[28:31], v[104:107], v[156:159], v[28:31]
    ds_read_b64_tr_b16 v[96:97], v16 offset:49696
    v_mfma_f32_16x16x32_bf16 v[32:35], v[104:107], v[160:163], v[32:35]
    s_bfe_u32 s22, s42, 0x30018
    s_or_b32 s22, s22, s62
    s_lshl_b32 s22, s22, 18
    s_add_u32 s22, s22, s16
    s_add_u32 s22, s22, 0x2000
    s_add_u32 m0, s17, 0x10400
    s_nop 0
    buffer_load_dwordx4 v18, s[4:7], s22 offen lds
    ds_read_b64_tr_b16 v[98:99], v16 offset:53792
    s_waitcnt lgkmcnt(6)
    v_mfma_f32_16x16x32_bf16 v[36:39], v[84:87], v[156:159], v[36:39]
    ds_read_b64_tr_b16 v[100:101], v15 offset:49920
    v_mfma_f32_16x16x32_bf16 v[40:43], v[84:87], v[160:163], v[40:43]
    ds_read_b64_tr_b16 v[102:103], v15 offset:54016
    buffer_load_dword v10, v9, s[8:11], s20 offen sc1
    s_waitcnt lgkmcnt(6)
    v_mfma_f32_16x16x32_bf16 v[44:47], v[88:91], v[156:159], v[44:47]
    ds_read_b64_tr_b16 v[104:105], v16 offset:49952
    v_mfma_f32_16x16x32_bf16 v[48:51], v[88:91], v[160:163], v[48:51]
    ds_read_b64_tr_b16 v[106:107], v16 offset:54048
    s_bfe_u32 s21, s42, 0x30014
    s_or_b32 s21, s21, s62
    s_lshl_b32 s21, s21, 12
    s_add_u32 s23, s21, 0x1000000
    buffer_load_dwordx4 v[140:143], v4, s[8:11], s23 offen offset:0 sc1
    s_waitcnt lgkmcnt(6)
    v_mfma_f32_16x16x32_bf16 v[52:55], v[92:95], v[156:159], v[52:55]
    ds_read_b64_tr_b16 v[84:85], v15 offset:57344
    v_mfma_f32_16x16x32_bf16 v[56:59], v[92:95], v[160:163], v[56:59]
    ds_read_b64_tr_b16 v[86:87], v15 offset:61440
    s_waitcnt lgkmcnt(6)
    v_mfma_f32_16x16x32_bf16 v[60:63], v[96:99], v[156:159], v[60:63]
    ds_read_b64_tr_b16 v[88:89], v16 offset:57376
    v_mfma_f32_16x16x32_bf16 v[64:67], v[96:99], v[160:163], v[64:67]
    s_bfe_u32 s22, s42, 0x30018
    s_or_b32 s22, s22, s62
    s_lshl_b32 s22, s22, 18
    s_add_u32 s22, s22, s16
    s_add_u32 s22, s22, 0x4000
    s_add_u32 m0, s17, 0x10800
    s_nop 0
    buffer_load_dwordx4 v17, s[4:7], s22 offen lds
    ds_read_b64_tr_b16 v[90:91], v16 offset:61472
    s_waitcnt lgkmcnt(6)
    v_mfma_f32_16x16x32_bf16 v[68:71], v[100:103], v[156:159], v[68:71]
    ds_read_b64_tr_b16 v[92:93], v15 offset:57600
    v_mfma_f32_16x16x32_bf16 v[72:75], v[100:103], v[160:163], v[72:75]
    ds_read_b64_tr_b16 v[94:95], v15 offset:61696
    s_waitcnt lgkmcnt(6)
    v_mfma_f32_16x16x32_bf16 v[76:79], v[104:107], v[156:159], v[76:79]
    ds_read_b64_tr_b16 v[96:97], v16 offset:57632
    v_mfma_f32_16x16x32_bf16 v[80:83], v[104:107], v[160:163], v[80:83]
    ds_read_b64_tr_b16 v[98:99], v16 offset:61728
    s_add_u32 s23, s21, 0x1020000
    buffer_load_dwordx4 v[144:147], v4, s[8:11], s23 offen offset:0 sc1
    s_waitcnt vmcnt(23) lgkmcnt(6)
    v_mfma_f32_16x16x32_bf16 v[20:23], v[84:87], v[164:167], v[20:23]
    ds_read_b64_tr_b16 v[100:101], v15 offset:57856
    s_waitcnt vmcnt(21)
    v_mfma_f32_16x16x32_bf16 v[24:27], v[84:87], v[168:171], v[24:27]
    ds_read_b64_tr_b16 v[102:103], v15 offset:61952
    s_waitcnt lgkmcnt(6)
    v_mfma_f32_16x16x32_bf16 v[28:31], v[88:91], v[164:167], v[28:31]
    ds_read_b64_tr_b16 v[104:105], v16 offset:57888
    v_mfma_f32_16x16x32_bf16 v[32:35], v[88:91], v[168:171], v[32:35]
    s_bfe_u32 s22, s42, 0x30018
    s_or_b32 s22, s22, s62
    s_lshl_b32 s22, s22, 18
    s_add_u32 s22, s22, s16
    s_add_u32 s22, s22, 0x6000
    s_add_u32 m0, s17, 0x10c00
    s_nop 0
    buffer_load_dwordx4 v18, s[4:7], s22 offen lds
    ds_read_b64_tr_b16 v[106:107], v16 offset:61984
    s_waitcnt lgkmcnt(6)
    v_mfma_f32_16x16x32_bf16 v[36:39], v[92:95], v[164:167], v[36:39]
    ds_read_b64_tr_b16 v[84:85], v15 offset:58112
    v_mfma_f32_16x16x32_bf16 v[40:43], v[92:95], v[168:171], v[40:43]
    ds_read_b64_tr_b16 v[86:87], v15 offset:62208
    s_waitcnt lgkmcnt(6)
    v_mfma_f32_16x16x32_bf16 v[44:47], v[96:99], v[164:167], v[44:47]
    ds_read_b64_tr_b16 v[88:89], v16 offset:58144
    v_mfma_f32_16x16x32_bf16 v[48:51], v[96:99], v[168:171], v[48:51]
    ds_read_b64_tr_b16 v[90:91], v16 offset:62240
    s_add_u32 s23, s21, 0x1000000
    buffer_load_dwordx4 v[148:151], v4, s[8:11], s23 offen offset:1024 sc1
    s_waitcnt lgkmcnt(6)
    v_mfma_f32_16x16x32_bf16 v[52:55], v[100:103], v[164:167], v[52:55]
    v_mfma_f32_16x16x32_bf16 v[56:59], v[100:103], v[168:171], v[56:59]
    s_barrier
    ds_read_b64_tr_b16 v[92:93], v3 offset:0
    ds_read_b64_tr_b16 v[94:95], v3 offset:4096
    s_waitcnt lgkmcnt(6)
    v_mfma_f32_16x16x32_bf16 v[60:63], v[104:107], v[164:167], v[60:63]
    ds_read_b64_tr_b16 v[96:97], v2 offset:32
    v_mfma_f32_16x16x32_bf16 v[64:67], v[104:107], v[168:171], v[64:67]
    s_bfe_u32 s22, s42, 0x30018
    s_or_b32 s22, s22, s62
    s_lshl_b32 s22, s22, 18
    s_add_u32 s22, s22, s16
    s_add_u32 s22, s22, 0x20000
    s_add_u32 m0, s17, 0x14000
    s_nop 0
    buffer_load_dwordx4 v17, s[4:7], s22 offen lds
    ds_read_b64_tr_b16 v[98:99], v2 offset:4128
    s_waitcnt lgkmcnt(6)
    v_mfma_f32_16x16x32_bf16 v[68:71], v[84:87], v[164:167], v[68:71]
    ds_read_b64_tr_b16 v[100:101], v3 offset:256
    v_mfma_f32_16x16x32_bf16 v[72:75], v[84:87], v[168:171], v[72:75]
    ds_read_b64_tr_b16 v[102:103], v3 offset:4352
    s_waitcnt lgkmcnt(6)
    v_mfma_f32_16x16x32_bf16 v[76:79], v[88:91], v[164:167], v[76:79]
    ds_read_b64_tr_b16 v[104:105], v2 offset:288
    v_mfma_f32_16x16x32_bf16 v[80:83], v[88:91], v[168:171], v[80:83]
    ds_read_b64_tr_b16 v[106:107], v2 offset:4384
    s_add_u32 s23, s21, 0x1020000
    buffer_load_dwordx4 v[152:155], v4, s[8:11], s23 offen offset:1024 sc1
    s_waitcnt vmcnt(23) lgkmcnt(6)
    v_mfma_f32_16x16x32_bf16 v[20:23], v[92:95], v[188:191], v[20:23]
    ds_read_b64_tr_b16 v[84:85], v3 offset:512
    s_waitcnt vmcnt(21)
    v_mfma_f32_16x16x32_bf16 v[24:27], v[92:95], v[192:195], v[24:27]
    ds_read_b64_tr_b16 v[86:87], v3 offset:4608
    s_waitcnt lgkmcnt(6)
    v_mfma_f32_16x16x32_bf16 v[28:31], v[96:99], v[188:191], v[28:31]
    ds_read_b64_tr_b16 v[88:89], v2 offset:544
    v_mfma_f32_16x16x32_bf16 v[32:35], v[96:99], v[192:195], v[32:35]
    s_bfe_u32 s22, s42, 0x30018
    s_or_b32 s22, s22, s62
    s_lshl_b32 s22, s22, 18
    s_add_u32 s22, s22, s16
    s_add_u32 s22, s22, 0x22000
    s_add_u32 m0, s17, 0x14400
    s_nop 0
    buffer_load_dwordx4 v18, s[4:7], s22 offen lds
    ds_read_b64_tr_b16 v[90:91], v2 offset:4640
    s_waitcnt lgkmcnt(6)
    v_mfma_f32_16x16x32_bf16 v[36:39], v[100:103], v[188:191], v[36:39]
    ds_read_b64_tr_b16 v[92:93], v3 offset:768
    v_mfma_f32_16x16x32_bf16 v[40:43], v[100:103], v[192:195], v[40:43]
    ds_read_b64_tr_b16 v[94:95], v3 offset:4864
    s_waitcnt lgkmcnt(6)
    v_mfma_f32_16x16x32_bf16 v[44:47], v[104:107], v[188:191], v[44:47]
    ds_read_b64_tr_b16 v[96:97], v2 offset:800
    v_mfma_f32_16x16x32_bf16 v[48:51], v[104:107], v[192:195], v[48:51]
    ds_read_b64_tr_b16 v[98:99], v2 offset:4896
    s_add_u32 s23, s21, 0x1000800
    buffer_load_dwordx4 v[156:159], v4, s[8:11], s23 offen offset:0 sc1
    s_waitcnt lgkmcnt(6)
    v_mfma_f32_16x16x32_bf16 v[52:55], v[84:87], v[188:191], v[52:55]
    ds_read_b64_tr_b16 v[100:101], v3 offset:8192
    v_mfma_f32_16x16x32_bf16 v[56:59], v[84:87], v[192:195], v[56:59]
    ds_read_b64_tr_b16 v[102:103], v3 offset:12288
    s_waitcnt lgkmcnt(6)
    v_mfma_f32_16x16x32_bf16 v[60:63], v[88:91], v[188:191], v[60:63]
    ds_read_b64_tr_b16 v[104:105], v2 offset:8224
    v_mfma_f32_16x16x32_bf16 v[64:67], v[88:91], v[192:195], v[64:67]
    s_bfe_u32 s22, s42, 0x30018
    s_or_b32 s22, s22, s62
    s_lshl_b32 s22, s22, 18
    s_add_u32 s22, s22, s16
    s_add_u32 s22, s22, 0x24000
    s_add_u32 m0, s17, 0x14800
    s_nop 0
    buffer_load_dwordx4 v17, s[4:7], s22 offen lds
    ds_read_b64_tr_b16 v[106:107], v2 offset:12320
    s_waitcnt lgkmcnt(6)
    v_mfma_f32_16x16x32_bf16 v[68:71], v[92:95], v[188:191], v[68:71]
    ds_read_b64_tr_b16 v[84:85], v3 offset:8448
    v_mfma_f32_16x16x32_bf16 v[72:75], v[92:95], v[192:195], v[72:75]
    ds_read_b64_tr_b16 v[86:87], v3 offset:12544
    s_waitcnt lgkmcnt(6)
    v_mfma_f32_16x16x32_bf16 v[76:79], v[96:99], v[188:191], v[76:79]
    ds_read_b64_tr_b16 v[88:89], v2 offset:8480
    v_mfma_f32_16x16x32_bf16 v[80:83], v[96:99], v[192:195], v[80:83]
    ds_read_b64_tr_b16 v[90:91], v2 offset:12576
    s_add_u32 s23, s21, 0x1020800
    buffer_load_dwordx4 v[160:163], v4, s[8:11], s23 offen offset:0 sc1
    s_waitcnt vmcnt(23) lgkmcnt(6)
    v_mfma_f32_16x16x32_bf16 v[20:23], v[100:103], v[196:199], v[20:23]
    ds_read_b64_tr_b16 v[92:93], v3 offset:8704
    s_waitcnt vmcnt(21)
    v_mfma_f32_16x16x32_bf16 v[24:27], v[100:103], v[200:203], v[24:27]
    ds_read_b64_tr_b16 v[94:95], v3 offset:12800
    s_waitcnt lgkmcnt(6)
    v_mfma_f32_16x16x32_bf16 v[28:31], v[104:107], v[196:199], v[28:31]
    ds_read_b64_tr_b16 v[96:97], v2 offset:8736
    v_mfma_f32_16x16x32_bf16 v[32:35], v[104:107], v[200:203], v[32:35]
    s_bfe_u32 s22, s42, 0x30018
    s_or_b32 s22, s22, s62
    s_lshl_b32 s22, s22, 18
    s_add_u32 s22, s22, s16
    s_add_u32 s22, s22, 0x26000
    s_add_u32 m0, s17, 0x14c00
    s_nop 0
    buffer_load_dwordx4 v18, s[4:7], s22 offen lds
    ds_read_b64_tr_b16 v[98:99], v2 offset:12832
    s_waitcnt lgkmcnt(6)
    v_mfma_f32_16x16x32_bf16 v[36:39], v[84:87], v[196:199], v[36:39]
    ds_read_b64_tr_b16 v[100:101], v3 offset:8960
    v_mfma_f32_16x16x32_bf16 v[40:43], v[84:87], v[200:203], v[40:43]
    ds_read_b64_tr_b16 v[102:103], v3 offset:13056
    s_waitcnt lgkmcnt(6)
    v_mfma_f32_16x16x32_bf16 v[44:47], v[88:91], v[196:199], v[44:47]
    ds_read_b64_tr_b16 v[104:105], v2 offset:8992
    v_mfma_f32_16x16x32_bf16 v[48:51], v[88:91], v[200:203], v[48:51]
    ds_read_b64_tr_b16 v[106:107], v2 offset:13088
    s_add_u32 s23, s21, 0x1000800
    buffer_load_dwordx4 v[164:167], v4, s[8:11], s23 offen offset:1024 sc1
    s_waitcnt lgkmcnt(6)
    v_mfma_f32_16x16x32_bf16 v[52:55], v[92:95], v[196:199], v[52:55]
    v_mfma_f32_16x16x32_bf16 v[56:59], v[92:95], v[200:203], v[56:59]
    s_barrier
    ds_read_b64_tr_b16 v[84:85], v3 offset:16384
    ds_read_b64_tr_b16 v[86:87], v3 offset:20480
    s_waitcnt lgkmcnt(6)
    v_mfma_f32_16x16x32_bf16 v[60:63], v[96:99], v[196:199], v[60:63]
    ds_read_b64_tr_b16 v[88:89], v2 offset:16416
    v_mfma_f32_16x16x32_bf16 v[64:67], v[96:99], v[200:203], v[64:67]
    s_bfe_u32 s22, s42, 0x3001c
    s_or_b32 s22, s22, s62
    s_lshl_b32 s22, s22, 18
    s_add_u32 s22, s22, s16
    s_add_u32 s22, s22, 0x0
    s_add_u32 m0, s17, 0x18000
    s_nop 0
    buffer_load_dwordx4 v17, s[4:7], s22 offen lds
    ds_read_b64_tr_b16 v[90:91], v2 offset:20512
    s_waitcnt lgkmcnt(6)
    v_mfma_f32_16x16x32_bf16 v[68:71], v[100:103], v[196:199], v[68:71]
    ds_read_b64_tr_b16 v[92:93], v3 offset:16640
    v_mfma_f32_16x16x32_bf16 v[72:75], v[100:103], v[200:203], v[72:75]
    ds_read_b64_tr_b16 v[94:95], v3 offset:20736
    s_waitcnt lgkmcnt(6)
    v_mfma_f32_16x16x32_bf16 v[76:79], v[104:107], v[196:199], v[76:79]
    ds_read_b64_tr_b16 v[96:97], v2 offset:16672
    v_mfma_f32_16x16x32_bf16 v[80:83], v[104:107], v[200:203], v[80:83]
    ds_read_b64_tr_b16 v[98:99], v2 offset:20768
    s_add_u32 s23, s21, 0x1020800
    buffer_load_dwordx4 v[168:171], v4, s[8:11], s23 offen offset:1024 sc1
    s_waitcnt vmcnt(15)
    v_cmp_ne_u32 vcc, s14, v10
    s_cbranch_vccz fz_o2gA
    s_mov_b32 s27, 0
fz_o2pA:
    buffer_load_dword v10, v9, s[8:11], s20 offen sc1
    s_waitcnt vmcnt(0)
    v_cmp_ne_u32 vcc, s14, v10
    s_add_u32 s27, s27, 1
    s_cmp_ge_u32 s27, 65536
    s_nop 4
    s_cbranch_scc1 fz_o2gA
    s_cbranch_vccnz fz_o2pA
fz_o2gA:
    s_waitcnt lgkmcnt(6)
    v_mfma_f32_16x16x32_bf16 v[20:23], v[84:87], v[108:111], v[20:23]
    ds_read_b64_tr_b16 v[100:101], v3 offset:16896
    v_mfma_f32_16x16x32_bf16 v[24:27], v[84:87], v[112:115], v[24:27]
    ds_read_b64_tr_b16 v[102:103], v3 offset:20992
    s_waitcnt lgkmcnt(6)
    v_mfma_f32_16x16x32_bf16 v[28:31], v[88:91], v[108:111], v[28:31]
    ds_read_b64_tr_b16 v[104:105], v2 offset:16928
    v_mfma_f32_16x16x32_bf16 v[32:35], v[88:91], v[112:115], v[32:35]
    s_bfe_u32 s22, s42, 0x3001c
    s_or_b32 s22, s22, s62
    s_lshl_b32 s22, s22, 18
    s_add_u32 s22, s22, s16
    s_add_u32 s22, s22, 0x2000
    s_add_u32 m0, s17, 0x18400
    s_nop 0
    buffer_load_dwordx4 v18, s[4:7], s22 offen lds
    ds_read_b64_tr_b16 v[106:107], v2 offset:21024
    s_waitcnt lgkmcnt(6)
    v_mfma_f32_16x16x32_bf16 v[36:39], v[92:95], v[108:111], v[36:39]
    ds_read_b64_tr_b16 v[84:85], v3 offset:17152
    v_mfma_f32_16x16x32_bf16 v[40:43], v[92:95], v[112:115], v[40:43]
    ds_read_b64_tr_b16 v[86:87], v3 offset:21248
    s_waitcnt lgkmcnt(6)
    v_mfma_f32_16x16x32_bf16 v[44:47], v[96:99], v[108:111], v[44:47]
    ds_read_b64_tr_b16 v[88:89], v2 offset:17184
    v_mfma_f32_16x16x32_bf16 v[48:51], v[96:99], v[112:115], v[48:51]
    ds_read_b64_tr_b16 v[90:91], v2 offset:21280
    s_bfe_u32 s21, s42, 0x30018
    s_or_b32 s21, s21, s62
    s_lshl_b32 s21, s21, 12
    s_add_u32 s23, s21, 0x1000000
    buffer_load_dwordx4 v[188:191], v4, s[8:11], s23 offen offset:0 sc1
    s_waitcnt lgkmcnt(6)
    v_mfma_f32_16x16x32_bf16 v[52:55], v[100:103], v[108:111], v[52:55]
    ds_read_b64_tr_b16 v[92:93], v3 offset:24576
    v_mfma_f32_16x16x32_bf16 v[56:59], v[100:103], v[112:115], v[56:59]
    ds_read_b64_tr_b16 v[94:95], v3 offset:28672
    s_waitcnt lgkmcnt(6)
    v_mfma_f32_16x16x32_bf16 v[60:63], v[104:107], v[108:111], v[60:63]
    ds_read_b64_tr_b16 v[96:97], v2 offset:24608
    v_mfma_f32_16x16x32_bf16 v[64:67], v[104:107], v[112:115], v[64:67]
    s_bfe_u32 s22, s42, 0x3001c
    s_or_b32 s22, s22, s62
    s_lshl_b32 s22, s22, 18
    s_add_u32 s22, s22, s16
    s_add_u32 s22, s22, 0x4000
    s_add_u32 m0, s17, 0x18800
    s_nop 0
    buffer_load_dwordx4 v17, s[4:7], s22 offen lds
    ds_read_b64_tr_b16 v[98:99], v2 offset:28704
    s_waitcnt lgkmcnt(6)
    v_mfma_f32_16x16x32_bf16 v[68:71], v[84:87], v[108:111], v[68:71]
    ds_read_b64_tr_b16 v[100:101], v3 offset:24832
    v_mfma_f32_16x16x32_bf16 v[72:75], v[84:87], v[112:115], v[72:75]
    ds_read_b64_tr_b16 v[102:103], v3 offset:28928
    s_waitcnt lgkmcnt(6)
    v_mfma_f32_16x16x32_bf16 v[76:79], v[88:91], v[108:111], v[76:79]
    ds_read_b64_tr_b16 v[104:105], v2 offset:24864
    v_mfma_f32_16x16x32_bf16 v[80:83], v[88:91], v[112:115], v[80:83]
    ds_read_b64_tr_b16 v[106:107], v2 offset:28960
    s_add_u32 s23, s21, 0x1020000
    buffer_load_dwordx4 v[192:195], v4, s[8:11], s23 offen offset:0 sc1
    s_waitcnt lgkmcnt(6)
    v_mfma_f32_16x16x32_bf16 v[20:23], v[92:95], v[116:119], v[20:23]
    ds_read_b64_tr_b16 v[84:85], v3 offset:25088
    v_mfma_f32_16x16x32_bf16 v[24:27], v[92:95], v[120:123], v[24:27]
    ds_read_b64_tr_b16 v[86:87], v3 offset:29184
    s_waitcnt lgkmcnt(6)
    v_mfma_f32_16x16x32_bf16 v[28:31], v[96:99], v[116:119], v[28:31]
    ds_read_b64_tr_b16 v[88:89], v2 offset:25120
    v_mfma_f32_16x16x32_bf16 v[32:35], v[96:99], v[120:123], v[32:35]
    s_bfe_u32 s22, s42, 0x3001c
    s_or_b32 s22, s22, s62
    s_lshl_b32 s22, s22, 18
    s_add_u32 s22, s22, s16
    s_add_u32 s22, s22, 0x6000
    s_add_u32 m0, s17, 0x18c00
    s_nop 0
    buffer_load_dwordx4 v18, s[4:7], s22 offen lds
    ds_read_b64_tr_b16 v[90:91], v2 offset:29216
    s_waitcnt lgkmcnt(6)
    v_mfma_f32_16x16x32_bf16 v[36:39], v[100:103], v[116:119], v[36:39]
    ds_read_b64_tr_b16 v[92:93], v3 offset:25344
    v_mfma_f32_16x16x32_bf16 v[40:43], v[100:103], v[120:123], v[40:43]
    ds_read_b64_tr_b16 v[94:95], v3 offset:29440
    s_waitcnt lgkmcnt(6)
    v_mfma_f32_16x16x32_bf16 v[44:47], v[104:107], v[116:119], v[44:47]
    ds_read_b64_tr_b16 v[96:97], v2 offset:25376
    v_mfma_f32_16x16x32_bf16 v[48:51], v[104:107], v[120:123], v[48:51]
    ds_read_b64_tr_b16 v[98:99], v2 offset:29472
    s_add_u32 s23, s21, 0x1000000
    buffer_load_dwordx4 v[196:199], v4, s[8:11], s23 offen offset:1024 sc1
    s_waitcnt lgkmcnt(6)
    v_mfma_f32_16x16x32_bf16 v[52:55], v[84:87], v[116:119], v[52:55]
    v_mfma_f32_16x16x32_bf16 v[56:59], v[84:87], v[120:123], v[56:59]
    s_barrier
    ds_read_b64_tr_b16 v[100:101], v3 offset:32768
    ds_read_b64_tr_b16 v[102:103], v3 offset:36864
    s_waitcnt lgkmcnt(6)
    v_mfma_f32_16x16x32_bf16 v[60:63], v[88:91], v[116:119], v[60:63]
    ds_read_b64_tr_b16 v[104:105], v2 offset:32800
    v_mfma_f32_16x16x32_bf16 v[64:67], v[88:91], v[120:123], v[64:67]
    s_bfe_u32 s22, s42, 0x3001c
    s_or_b32 s22, s22, s62
    s_lshl_b32 s22, s22, 18
    s_add_u32 s22, s22, s16
    s_add_u32 s22, s22, 0x20000
    s_add_u32 m0, s17, 0x1c000
    s_nop 0
    buffer_load_dwordx4 v17, s[4:7], s22 offen lds
    ds_read_b64_tr_b16 v[106:107], v2 offset:36896
    s_waitcnt lgkmcnt(6)
    v_mfma_f32_16x16x32_bf16 v[68:71], v[92:95], v[116:119], v[68:71]
    ds_read_b64_tr_b16 v[84:85], v3 offset:33024
    v_mfma_f32_16x16x32_bf16 v[72:75], v[92:95], v[120:123], v[72:75]
    ds_read_b64_tr_b16 v[86:87], v3 offset:37120
    s_waitcnt lgkmcnt(6)
    v_mfma_f32_16x16x32_bf16 v[76:79], v[96:99], v[116:119], v[76:79]
    ds_read_b64_tr_b16 v[88:89], v2 offset:33056
    v_mfma_f32_16x16x32_bf16 v[80:83], v[96:99], v[120:123], v[80:83]
    ds_read_b64_tr_b16 v[90:91], v2 offset:37152
    s_add_u32 s23, s21, 0x1020000
    buffer_load_dwordx4 v[200:203], v4, s[8:11], s23 offen offset:1024 sc1
    s_waitcnt vmcnt(22) lgkmcnt(6)
    v_mfma_f32_16x16x32_bf16 v[20:23], v[100:103], v[140:143], v[20:23]
    ds_read_b64_tr_b16 v[92:93], v3 offset:33280
    s_waitcnt vmcnt(20)
    v_mfma_f32_16x16x32_bf16 v[24:27], v[100:103], v[144:147], v[24:27]
    ds_read_b64_tr_b16 v[94:95], v3 offset:37376
    s_waitcnt lgkmcnt(6)
    v_mfma_f32_16x16x32_bf16 v[28:31], v[104:107], v[140:143], v[28:31]
    ds_read_b64_tr_b16 v[96:97], v2 offset:33312
    v_mfma_f32_16x16x32_bf16 v[32:35], v[104:107], v[144:147], v[32:35]
    s_bfe_u32 s22, s42, 0x3001c
    s_or_b32 s22, s22, s62
    s_lshl_b32 s22, s22, 18
    s_add_u32 s22, s22, s16
    s_add_u32 s22, s22, 0x22000
    s_add_u32 m0, s17, 0x1c400
    s_nop 0
    buffer_load_dwordx4 v18, s[4:7], s22 offen lds
    ds_read_b64_tr_b16 v[98:99], v2 offset:37408
    s_waitcnt lgkmcnt(6)
    v_mfma_f32_16x16x32_bf16 v[36:39], v[84:87], v[140:143], v[36:39]
    ds_read_b64_tr_b16 v[100:101], v3 offset:33536
    v_mfma_f32_16x16x32_bf16 v[40:43], v[84:87], v[144:147], v[40:43]
    ds_read_b64_tr_b16 v[102:103], v3 offset:37632
    s_waitcnt lgkmcnt(6)
    v_mfma_f32_16x16x32_bf16 v[44:47], v[88:91], v[140:143], v[44:47]
    ds_read_b64_tr_b16 v[104:105], v2 offset:33568
    v_mfma_f32_16x16x32_bf16 v[48:51], v[88:91], v[144:147], v[48:51]
    ds_read_b64_tr_b16 v[106:107], v2 offset:37664
    s_add_u32 s23, s21, 0x1000800
    buffer_load_dwordx4 v[108:111], v4, s[8:11], s23 offen offset:0 sc1
    s_waitcnt lgkmcnt(6)
    v_mfma_f32_16x16x32_bf16 v[52:55], v[92:95], v[140:143], v[52:55]
    ds_read_b64_tr_b16 v[84:85], v3 offset:40960
    v_mfma_f32_16x16x32_bf16 v[56:59], v[92:95], v[144:147], v[56:59]
    ds_read_b64_tr_b16 v[86:87], v3 offset:45056
    s_waitcnt lgkmcnt(6)
    v_mfma_f32_16x16x32_bf16 v[60:63], v[96:99], v[140:143], v[60:63]
    ds_read_b64_tr_b16 v[88:89], v2 offset:40992
    v_mfma_f32_16x16x32_bf16 v[64:67], v[96:99], v[144:147], v[64:67]
    s_bfe_u32 s22, s42, 0x3001c
    s_or_b32 s22, s22, s62
    s_lshl_b32 s22, s22, 18
    s_add_u32 s22, s22, s16
    s_add_u32 s22, s22, 0x24000
    s_add_u32 m0, s17, 0x1c800
    s_nop 0
    buffer_load_dwordx4 v17, s[4:7], s22 offen lds
    ds_read_b64_tr_b16 v[90:91], v2 offset:45088
    s_waitcnt lgkmcnt(6)
    v_mfma_f32_16x16x32_bf16 v[68:71], v[100:103], v[140:143], v[68:71]
    ds_read_b64_tr_b16 v[92:93], v3 offset:41216
    v_mfma_f32_16x16x32_bf16 v[72:75], v[100:103], v[144:147], v[72:75]
    ds_read_b64_tr_b16 v[94:95], v3 offset:45312
    s_waitcnt lgkmcnt(6)
    v_mfma_f32_16x16x32_bf16 v[76:79], v[104:107], v[140:143], v[76:79]
    ds_read_b64_tr_b16 v[96:97], v2 offset:41248
    v_mfma_f32_16x16x32_bf16 v[80:83], v[104:107], v[144:147], v[80:83]
    ds_read_b64_tr_b16 v[98:99], v2 offset:45344
    s_add_u32 s23, s21, 0x1020800
    buffer_load_dwordx4 v[112:115], v4, s[8:11], s23 offen offset:0 sc1
    s_waitcnt vmcnt(22) lgkmcnt(6)
    v_mfma_f32_16x16x32_bf16 v[20:23], v[84:87], v[148:151], v[20:23]
    ds_read_b64_tr_b16 v[100:101], v3 offset:41472
    s_waitcnt vmcnt(20)
    v_mfma_f32_16x16x32_bf16 v[24:27], v[84:87], v[152:155], v[24:27]
    ds_read_b64_tr_b16 v[102:103], v3 offset:45568
    s_waitcnt lgkmcnt(6)
    v_mfma_f32_16x16x32_bf16 v[28:31], v[88:91], v[148:151], v[28:31]
    ds_read_b64_tr_b16 v[104:105], v2 offset:41504
    v_mfma_f32_16x16x32_bf16 v[32:35], v[88:91], v[152:155], v[32:35]
    s_bfe_u32 s22, s42, 0x3001c
    s_or_b32 s22, s22, s62
    s_lshl_b32 s22, s22, 18
    s_add_u32 s22, s22, s16
    s_add_u32 s22, s22, 0x26000
    s_add_u32 m0, s17, 0x1cc00
    s_nop 0
    buffer_load_dwordx4 v18, s[4:7], s22 offen lds
    ds_read_b64_tr_b16 v[106:107], v2 offset:45600
    s_waitcnt lgkmcnt(6)
    v_mfma_f32_16x16x32_bf16 v[36:39], v[92:95], v[148:151], v[36:39]
    ds_read_b64_tr_b16 v[84:85], v3 offset:41728
    v_mfma_f32_16x16x32_bf16 v[40:43], v[92:95], v[152:155], v[40:43]
    ds_read_b64_tr_b16 v[86:87], v3 offset:45824
    s_waitcnt lgkmcnt(6)
    v_mfma_f32_16x16x32_bf16 v[44:47], v[96:99], v[148:151], v[44:47]
    ds_read_b64_tr_b16 v[88:89], v2 offset:41760
    v_mfma_f32_16x16x32_bf16 v[48:51], v[96:99], v[152:155], v[48:51]
    ds_read_b64_tr_b16 v[90:91], v2 offset:45856
    s_add_u32 s23, s21, 0x1000800
    buffer_load_dwordx4 v[116:119], v4, s[8:11], s23 offen offset:1024 sc1
    s_waitcnt lgkmcnt(6)
    v_mfma_f32_16x16x32_bf16 v[52:55], v[100:103], v[148:151], v[52:55]
    v_mfma_f32_16x16x32_bf16 v[56:59], v[100:103], v[152:155], v[56:59]
    s_barrier
    ds_read_b64_tr_b16 v[92:93], v3 offset:49152
    ds_read_b64_tr_b16 v[94:95], v3 offset:53248
    s_waitcnt lgkmcnt(6)
    v_mfma_f32_16x16x32_bf16 v[60:63], v[104:107], v[148:151], v[60:63]
    ds_read_b64_tr_b16 v[96:97], v2 offset:49184
    v_mfma_f32_16x16x32_bf16 v[64:67], v[104:107], v[152:155], v[64:67]
    ds_read_b64_tr_b16 v[98:99], v2 offset:53280
    s_waitcnt lgkmcnt(6)
    v_mfma_f32_16x16x32_bf16 v[68:71], v[84:87], v[148:151], v[68:71]
    ds_read_b64_tr_b16 v[100:101], v3 offset:49408
    v_mfma_f32_16x16x32_bf16 v[72:75], v[84:87], v[152:155], v[72:75]
    ds_read_b64_tr_b16 v[102:103], v3 offset:53504
    s_waitcnt lgkmcnt(6)
    v_mfma_f32_16x16x32_bf16 v[76:79], v[88:91], v[148:151], v[76:79]
    ds_read_b64_tr_b16 v[104:105], v2 offset:49440
    v_mfma_f32_16x16x32_bf16 v[80:83], v[88:91], v[152:155], v[80:83]
    ds_read_b64_tr_b16 v[106:107], v2 offset:53536
    s_add_u32 s23, s21, 0x1020800
    buffer_load_dwordx4 v[120:123], v4, s[8:11], s23 offen offset:1024 sc1
    s_waitcnt vmcnt(21) lgkmcnt(6)
    v_mfma_f32_16x16x32_bf16 v[20:23], v[92:95], v[156:159], v[20:23]
    ds_read_b64_tr_b16 v[84:85], v3 offset:49664
    s_waitcnt vmcnt(19)
    v_mfma_f32_16x16x32_bf16 v[24:27], v[92:95], v[160:163], v[24:27]
    ds_read_b64_tr_b16 v[86:87], v3 offset:53760
    s_waitcnt lgkmcnt(6)
    v_mfma_f32_16x16x32_bf16 v[28:31], v[96:99], v[156:159], v[28:31]
    ds_read_b64_tr_b16 v[88:89], v2 offset:49696
    v_mfma_f32_16x16x32_bf16 v[32:35], v[96:99], v[160:163], v[32:35]
    ds_read_b64_tr_b16 v[90:91], v2 offset:53792
    s_waitcnt lgkmcnt(6)
    v_mfma_f32_16x16x32_bf16 v[36:39], v[100:103], v[156:159], v[36:39]
    ds_read_b64_tr_b16 v[92:93], v3 offset:49920
    v_mfma_f32_16x16x32_bf16 v[40:43], v[100:103], v[160:163], v[40:43]
    ds_read_b64_tr_b16 v[94:95], v3 offset:54016
    s_waitcnt lgkmcnt(6)
    v_mfma_f32_16x16x32_bf16 v[44:47], v[104:107], v[156:159], v[44:47]
    ds_read_b64_tr_b16 v[96:97], v2 offset:49952
    v_mfma_f32_16x16x32_bf16 v[48:51], v[104:107], v[160:163], v[48:51]
    ds_read_b64_tr_b16 v[98:99], v2 offset:54048
    s_bfe_u32 s21, s42, 0x3001c
    s_or_b32 s21, s21, s62
    s_lshl_b32 s21, s21, 12
    s_add_u32 s23, s21, 0x1000000
    buffer_load_dwordx4 v[140:143], v4, s[8:11], s23 offen offset:0 sc1
    s_waitcnt lgkmcnt(6)
    v_mfma_f32_16x16x32_bf16 v[52:55], v[84:87], v[156:159], v[52:55]
    ds_read_b64_tr_b16 v[100:101], v3 offset:57344
    v_mfma_f32_16x16x32_bf16 v[56:59], v[84:87], v[160:163], v[56:59]
    ds_read_b64_tr_b16 v[102:103], v3 offset:61440
    s_waitcnt lgkmcnt(6)
    v_mfma_f32_16x16x32_bf16 v[60:63], v[88:91], v[156:159], v[60:63]
    ds_read_b64_tr_b16 v[104:105], v2 offset:57376
    v_mfma_f32_16x16x32_bf16 v[64:67], v[88:91], v[160:163], v[64:67]
    ds_read_b64_tr_b16 v[106:107], v2 offset:61472
    s_waitcnt lgkmcnt(6)
    v_mfma_f32_16x16x32_bf16 v[68:71], v[92:95], v[156:159], v[68:71]
    ds_read_b64_tr_b16 v[84:85], v3 offset:57600
    v_mfma_f32_16x16x32_bf16 v[72:75], v[92:95], v[160:163], v[72:75]
    ds_read_b64_tr_b16 v[86:87], v3 offset:61696
    s_waitcnt lgkmcnt(6)
    v_mfma_f32_16x16x32_bf16 v[76:79], v[96:99], v[156:159], v[76:79]
    ds_read_b64_tr_b16 v[88:89], v2 offset:57632
    v_mfma_f32_16x16x32_bf16 v[80:83], v[96:99], v[160:163], v[80:83]
    ds_read_b64_tr_b16 v[90:91], v2 offset:61728
    s_add_u32 s23, s21, 0x1020000
    buffer_load_dwordx4 v[144:147], v4, s[8:11], s23 offen offset:0 sc1
    s_waitcnt vmcnt(19) lgkmcnt(6)
    v_mfma_f32_16x16x32_bf16 v[20:23], v[100:103], v[164:167], v[20:23]
    ds_read_b64_tr_b16 v[92:93], v3 offset:57856
    s_waitcnt vmcnt(17)
    v_mfma_f32_16x16x32_bf16 v[24:27], v[100:103], v[168:171], v[24:27]
    ds_read_b64_tr_b16 v[94:95], v3 offset:61952
    s_waitcnt lgkmcnt(6)
    v_mfma_f32_16x16x32_bf16 v[28:31], v[104:107], v[164:167], v[28:31]
    ds_read_b64_tr_b16 v[96:97], v2 offset:57888
    v_mfma_f32_16x16x32_bf16 v[32:35], v[104:107], v[168:171], v[32:35]
    ds_read_b64_tr_b16 v[98:99], v2 offset:61984
    s_waitcnt lgkmcnt(6)
    v_mfma_f32_16x16x32_bf16 v[36:39], v[84:87], v[164:167], v[36:39]
    ds_read_b64_tr_b16 v[100:101], v3 offset:58112
    v_mfma_f32_16x16x32_bf16 v[40:43], v[84:87], v[168:171], v[40:43]
    ds_read_b64_tr_b16 v[102:103], v3 offset:62208
    s_waitcnt lgkmcnt(6)
    v_mfma_f32_16x16x32_bf16 v[44:47], v[88:91], v[164:167], v[44:47]
    ds_read_b64_tr_b16 v[104:105], v2 offset:58144
    v_mfma_f32_16x16x32_bf16 v[48:51], v[88:91], v[168:171], v[48:51]
    ds_read_b64_tr_b16 v[106:107], v2 offset:62240
    s_add_u32 s23, s21, 0x1000000
    buffer_load_dwordx4 v[148:151], v4, s[8:11], s23 offen offset:1024 sc1
    s_waitcnt lgkmcnt(6)
    v_mfma_f32_16x16x32_bf16 v[52:55], v[92:95], v[164:167], v[52:55]
    v_mfma_f32_16x16x32_bf16 v[56:59], v[92:95], v[168:171], v[56:59]
    s_waitcnt vmcnt(5)
    s_barrier
    ds_read_b64_tr_b16 v[84:85], v15 offset:0
    ds_read_b64_tr_b16 v[86:87], v15 offset:4096
    s_waitcnt lgkmcnt(6)
    v_mfma_f32_16x16x32_bf16 v[60:63], v[96:99], v[164:167], v[60:63]
    ds_read_b64_tr_b16 v[88:89], v16 offset:32
    v_mfma_f32_16x16x32_bf16 v[64:67], v[96:99], v[168:171], v[64:67]
    ds_read_b64_tr_b16 v[90:91], v16 offset:4128
    s_waitcnt lgkmcnt(6)
    v_mfma_f32_16x16x32_bf16 v[68:71], v[100:103], v[164:167], v[68:71]
    ds_read_b64_tr_b16 v[92:93], v15 offset:256
    v_mfma_f32_16x16x32_bf16 v[72:75], v[100:103], v[168:171], v[72:75]
    ds_read_b64_tr_b16 v[94:95], v15 offset:4352
    s_waitcnt lgkmcnt(6)
    v_mfma_f32_16x16x32_bf16 v[76:79], v[104:107], v[164:167], v[76:79]
    ds_read_b64_tr_b16 v[96:97], v16 offset:288
    v_mfma_f32_16x16x32_bf16 v[80:83], v[104:107], v[168:171], v[80:83]
    ds_read_b64_tr_b16 v[98:99], v16 offset:4384
    s_add_u32 s23, s21, 0x1020000
    buffer_load_dwordx4 v[152:155], v4, s[8:11], s23 offen offset:1024 sc1
    s_waitcnt lgkmcnt(6)
    v_mfma_f32_16x16x32_bf16 v[20:23], v[84:87], v[188:191], v[20:23]
    ds_read_b64_tr_b16 v[100:101], v15 offset:512
    v_mfma_f32_16x16x32_bf16 v[24:27], v[84:87], v[192:195], v[24:27]
    ds_read_b64_tr_b16 v[102:103], v15 offset:4608
    s_waitcnt lgkmcnt(6)
    v_mfma_f32_16x16x32_bf16 v[28:31], v[88:91], v[188:191], v[28:31]
    ds_read_b64_tr_b16 v[104:105], v16 offset:544
    v_mfma_f32_16x16x32_bf16 v[32:35], v[88:91], v[192:195], v[32:35]
    ds_read_b64_tr_b16 v[106:107], v16 offset:4640
    s_waitcnt lgkmcnt(6)
    v_mfma_f32_16x16x32_bf16 v[36:39], v[92:95], v[188:191], v[36:39]
    ds_read_b64_tr_b16 v[84:85], v15 offset:768
    v_mfma_f32_16x16x32_bf16 v[40:43], v[92:95], v[192:195], v[40:43]
    ds_read_b64_tr_b16 v[86:87], v15 offset:4864
    s_waitcnt lgkmcnt(6)
    v_mfma_f32_16x16x32_bf16 v[44:47], v[96:99], v[188:191], v[44:47]
    ds_read_b64_tr_b16 v[88:89], v16 offset:800
    v_mfma_f32_16x16x32_bf16 v[48:51], v[96:99], v[192:195], v[48:51]
    ds_read_b64_tr_b16 v[90:91], v16 offset:4896
    s_add_u32 s23, s21, 0x1000800
    buffer_load_dwordx4 v[156:159], v4, s[8:11], s23 offen offset:0 sc1
    s_waitcnt lgkmcnt(6)
    v_mfma_f32_16x16x32_bf16 v[52:55], v[100:103], v[188:191], v[52:55]
    ds_read_b64_tr_b16 v[92:93], v15 offset:8192
    v_mfma_f32_16x16x32_bf16 v[56:59], v[100:103], v[192:195], v[56:59]
    ds_read_b64_tr_b16 v[94:95], v15 offset:12288
    s_waitcnt lgkmcnt(6)
    v_mfma_f32_16x16x32_bf16 v[60:63], v[104:107], v[188:191], v[60:63]
    ds_read_b64_tr_b16 v[96:97], v16 offset:8224
    v_mfma_f32_16x16x32_bf16 v[64:67], v[104:107], v[192:195], v[64:67]
    ds_read_b64_tr_b16 v[98:99], v16 offset:12320
    s_waitcnt lgkmcnt(6)
    v_mfma_f32_16x16x32_bf16 v[68:71], v[84:87], v[188:191], v[68:71]
    ds_read_b64_tr_b16 v[100:101], v15 offset:8448
    v_mfma_f32_16x16x32_bf16 v[72:75], v[84:87], v[192:195], v[72:75]
    ds_read_b64_tr_b16 v[102:103], v15 offset:12544
    s_waitcnt lgkmcnt(6)
    v_mfma_f32_16x16x32_bf16 v[76:79], v[88:91], v[188:191], v[76:79]
    ds_read_b64_tr_b16 v[104:105], v16 offset:8480
    v_mfma_f32_16x16x32_bf16 v[80:83], v[88:91], v[192:195], v[80:83]
    ds_read_b64_tr_b16 v[106:107], v16 offset:12576
    s_add_u32 s23, s21, 0x1020800
    buffer_load_dwordx4 v[160:163], v4, s[8:11], s23 offen offset:0 sc1
    s_waitcnt lgkmcnt(6)
    v_mfma_f32_16x16x32_bf16 v[20:23], v[92:95], v[196:199], v[20:23]
    ds_read_b64_tr_b16 v[84:85], v15 offset:8704
    v_mfma_f32_16x16x32_bf16 v[24:27], v[92:95], v[200:203], v[24:27]
    ds_read_b64_tr_b16 v[86:87], v15 offset:12800
    s_waitcnt lgkmcnt(6)
    v_mfma_f32_16x16x32_bf16 v[28:31], v[96:99], v[196:199], v[28:31]
    ds_read_b64_tr_b16 v[88:89], v16 offset:8736
    v_mfma_f32_16x16x32_bf16 v[32:35], v[96:99], v[200:203], v[32:35]
    ds_read_b64_tr_b16 v[90:91], v16 offset:12832
    s_waitcnt lgkmcnt(6)
    v_mfma_f32_16x16x32_bf16 v[36:39], v[100:103], v[196:199], v[36:39]
    ds_read_b64_tr_b16 v[92:93], v15 offset:8960
    v_mfma_f32_16x16x32_bf16 v[40:43], v[100:103], v[200:203], v[40:43]
    ds_read_b64_tr_b16 v[94:95], v15 offset:13056
    s_waitcnt lgkmcnt(6)
    v_mfma_f32_16x16x32_bf16 v[44:47], v[104:107], v[196:199], v[44:47]
    ds_read_b64_tr_b16 v[96:97], v16 offset:8992
    v_mfma_f32_16x16x32_bf16 v[48:51], v[104:107], v[200:203], v[48:51]
    ds_read_b64_tr_b16 v[98:99], v16 offset:13088
    s_add_u32 s23, s21, 0x1000800
    buffer_load_dwordx4 v[164:167], v4, s[8:11], s23 offen offset:1024 sc1
    s_waitcnt lgkmcnt(6)
    v_mfma_f32_16x16x32_bf16 v[52:55], v[84:87], v[196:199], v[52:55]
    ds_read_b64_tr_b16 v[100:101], v15 offset:16384
    v_mfma_f32_16x16x32_bf16 v[56:59], v[84:87], v[200:203], v[56:59]
    ds_read_b64_tr_b16 v[102:103], v15 offset:20480
    s_waitcnt lgkmcnt(6)
    v_mfma_f32_16x16x32_bf16 v[60:63], v[88:91], v[196:199], v[60:63]
    ds_read_b64_tr_b16 v[104:105], v16 offset:16416
    v_mfma_f32_16x16x32_bf16 v[64:67], v[88:91], v[200:203], v[64:67]
    ds_read_b64_tr_b16 v[106:107], v16 offset:20512
    s_waitcnt lgkmcnt(6)
    v_mfma_f32_16x16x32_bf16 v[68:71], v[92:95], v[196:199], v[68:71]
    ds_read_b64_tr_b16 v[84:85], v15 offset:24576
    v_mfma_f32_16x16x32_bf16 v[72:75], v[92:95], v[200:203], v[72:75]
    ds_read_b64_tr_b16 v[86:87], v15 offset:28672
    s_waitcnt lgkmcnt(6)
    v_mfma_f32_16x16x32_bf16 v[76:79], v[96:99], v[196:199], v[76:79]
    ds_read_b64_tr_b16 v[88:89], v16 offset:24608
    v_mfma_f32_16x16x32_bf16 v[80:83], v[96:99], v[200:203], v[80:83]
    ds_read_b64_tr_b16 v[90:91], v16 offset:28704
    s_add_u32 s23, s21, 0x1020800
    buffer_load_dwordx4 v[168:171], v4, s[8:11], s23 offen offset:1024 sc1
    s_waitcnt lgkmcnt(6)
    v_mfma_f32_16x16x32_bf16 v[20:23], v[100:103], v[108:111], v[20:23]
    ds_read_b64_tr_b16 v[92:93], v15 offset:32768
    v_mfma_f32_16x16x32_bf16 v[24:27], v[100:103], v[112:115], v[24:27]
    ds_read_b64_tr_b16 v[94:95], v15 offset:36864
    s_waitcnt lgkmcnt(6)
    v_mfma_f32_16x16x32_bf16 v[28:31], v[104:107], v[108:111], v[28:31]
    ds_read_b64_tr_b16 v[96:97], v16 offset:32800
    v_mfma_f32_16x16x32_bf16 v[32:35], v[104:107], v[112:115], v[32:35]
    ds_read_b64_tr_b16 v[98:99], v16 offset:36896
    s_waitcnt vmcnt(9) lgkmcnt(6)
    v_mfma_f32_16x16x32_bf16 v[20:23], v[84:87], v[116:119], v[20:23]
    ds_read_b64_tr_b16 v[100:101], v15 offset:40960
    s_waitcnt vmcnt(8)
    v_mfma_f32_16x16x32_bf16 v[24:27], v[84:87], v[120:123], v[24:27]
    ds_read_b64_tr_b16 v[102:103], v15 offset:45056
    s_waitcnt lgkmcnt(6)
    v_mfma_f32_16x16x32_bf16 v[28:31], v[88:91], v[116:119], v[28:31]
    ds_read_b64_tr_b16 v[104:105], v16 offset:40992
    v_mfma_f32_16x16x32_bf16 v[32:35], v[88:91], v[120:123], v[32:35]
    ds_read_b64_tr_b16 v[106:107], v16 offset:45088
    s_waitcnt vmcnt(7) lgkmcnt(6)
    v_mfma_f32_16x16x32_bf16 v[20:23], v[92:95], v[140:143], v[20:23]
    ds_read_b64_tr_b16 v[84:85], v15 offset:49152
    s_waitcnt vmcnt(6)
    v_mfma_f32_16x16x32_bf16 v[24:27], v[92:95], v[144:147], v[24:27]
    ds_read_b64_tr_b16 v[86:87], v15 offset:53248
    s_waitcnt lgkmcnt(6)
    v_mfma_f32_16x16x32_bf16 v[28:31], v[96:99], v[140:143], v[28:31]
    ds_read_b64_tr_b16 v[88:89], v16 offset:49184
    v_mfma_f32_16x16x32_bf16 v[32:35], v[96:99], v[144:147], v[32:35]
    ds_read_b64_tr_b16 v[90:91], v16 offset:53280
    s_waitcnt vmcnt(5) lgkmcnt(6)
    v_mfma_f32_16x16x32_bf16 v[20:23], v[100:103], v[148:151], v[20:23]
    ds_read_b64_tr_b16 v[92:93], v15 offset:57344
    s_waitcnt vmcnt(4)
    v_mfma_f32_16x16x32_bf16 v[24:27], v[100:103], v[152:155], v[24:27]
    ds_read_b64_tr_b16 v[94:95], v15 offset:61440
    s_waitcnt lgkmcnt(6)
    v_mfma_f32_16x16x32_bf16 v[28:31], v[104:107], v[148:151], v[28:31]
    ds_read_b64_tr_b16 v[96:97], v16 offset:57376
    v_mfma_f32_16x16x32_bf16 v[32:35], v[104:107], v[152:155], v[32:35]
    ds_read_b64_tr_b16 v[98:99], v16 offset:61472
    s_waitcnt vmcnt(3) lgkmcnt(6)
    v_mfma_f32_16x16x32_bf16 v[20:23], v[84:87], v[156:159], v[20:23]
    ds_read_b64_tr_b16 v[100:101], v15 offset:16640
    s_waitcnt vmcnt(2)
    v_mfma_f32_16x16x32_bf16 v[24:27], v[84:87], v[160:163], v[24:27]
    ds_read_b64_tr_b16 v[102:103], v15 offset:20736
    s_waitcnt lgkmcnt(6)
    v_mfma_f32_16x16x32_bf16 v[28:31], v[88:91], v[156:159], v[28:31]
    ds_read_b64_tr_b16 v[104:105], v16 offset:16672
    v_mfma_f32_16x16x32_bf16 v[32:35], v[88:91], v[160:163], v[32:35]
    ds_read_b64_tr_b16 v[106:107], v16 offset:20768
    s_waitcnt vmcnt(1) lgkmcnt(6)
    v_mfma_f32_16x16x32_bf16 v[20:23], v[92:95], v[164:167], v[20:23]
    ds_read_b64_tr_b16 v[84:85], v15 offset:24832
    s_waitcnt vmcnt(0)
    v_mfma_f32_16x16x32_bf16 v[24:27], v[92:95], v[168:171], v[24:27]
    ds_read_b64_tr_b16 v[86:87], v15 offset:28928
    s_waitcnt lgkmcnt(6)
    v_mfma_f32_16x16x32_bf16 v[28:31], v[96:99], v[164:167], v[28:31]
    ds_read_b64_tr_b16 v[88:89], v16 offset:24864
    v_mfma_f32_16x16x32_bf16 v[32:35], v[96:99], v[168:171], v[32:35]
    ds_read_b64_tr_b16 v[90:91], v16 offset:28960
    ds_read_b128 v[124:127], v13 offset:0
    ds_read_b128 v[128:131], v13 offset:64
    s_waitcnt lgkmcnt(8)
    v_mfma_f32_16x16x32_bf16 v[36:39], v[100:103], v[108:111], v[36:39]
    ds_read_b64_tr_b16 v[92:93], v15 offset:33024
    v_mfma_f32_16x16x32_bf16 v[40:43], v[100:103], v[112:115], v[40:43]
    ds_read_b64_tr_b16 v[94:95], v15 offset:37120
    s_waitcnt lgkmcnt(8)
    v_mfma_f32_16x16x32_bf16 v[44:47], v[104:107], v[108:111], v[44:47]
    ds_read_b64_tr_b16 v[96:97], v16 offset:33056
    v_mfma_f32_16x16x32_bf16 v[48:51], v[104:107], v[112:115], v[48:51]
    ds_read_b64_tr_b16 v[98:99], v16 offset:37152
    s_waitcnt lgkmcnt(8)
    v_mfma_f32_16x16x32_bf16 v[36:39], v[84:87], v[116:119], v[36:39]
    s_waitcnt lgkmcnt(5)
    v_pk_mul_f32 v[132:133], v[20:21], v[124:125]
    v_pk_mul_f32 v[134:135], v[22:23], v[126:127]
    ds_read_b64_tr_b16 v[100:101], v15 offset:41216
    v_mfma_f32_16x16x32_bf16 v[40:43], v[84:87], v[120:123], v[40:43]
    s_waitcnt lgkmcnt(5)
    v_pk_mul_f32 v[136:137], v[28:29], v[128:129]
    ds_read_b64_tr_b16 v[102:103], v15 offset:45312
    v_mfma_f32_16x16x32_bf16 v[44:47], v[88:91], v[116:119], v[44:47]
    v_pk_mul_f32 v[138:139], v[30:31], v[130:131]
    v_cvt_pk_bf16_f32 v132, v132, v133
    ds_read_b64_tr_b16 v[104:105], v16 offset:41248
    v_mfma_f32_16x16x32_bf16 v[48:51], v[88:91], v[120:123], v[48:51]
    v_cvt_pk_bf16_f32 v133, v134, v135
    ds_read_b64_tr_b16 v[106:107], v16 offset:45344
    s_waitcnt lgkmcnt(6)
    v_mfma_f32_16x16x32_bf16 v[36:39], v[92:95], v[140:143], v[36:39]
    v_cvt_pk_bf16_f32 v134, v136, v137
    v_cvt_pk_bf16_f32 v135, v138, v139
    ds_read_b64_tr_b16 v[84:85], v15 offset:49408
    v_mfma_f32_16x16x32_bf16 v[40:43], v[92:95], v[144:147], v[40:43]
    v_permlane32_swap_b32 v132, v134
    ds_read_b64_tr_b16 v[86:87], v15 offset:53504
    s_waitcnt lgkmcnt(6)
    v_mfma_f32_16x16x32_bf16 v[44:47], v[96:99], v[140:143], v[44:47]
    v_permlane32_swap_b32 v133, v135
    v_permlane16_swap_b32 v132, v134
    ds_read_b64_tr_b16 v[88:89], v16 offset:49440
    v_mfma_f32_16x16x32_bf16 v[48:51], v[96:99], v[144:147], v[48:51]
    v_permlane16_swap_b32 v133, v135
    ds_read_b64_tr_b16 v[90:91], v16 offset:53536
    s_waitcnt lgkmcnt(6)
    v_mfma_f32_16x16x32_bf16 v[36:39], v[100:103], v[148:151], v[36:39]
    buffer_store_dwordx4 v[132:135], v14, s[8:11], s18 offen offset:0 sc1
    ds_read_b64_tr_b16 v[92:93], v15 offset:57600
    v_mfma_f32_16x16x32_bf16 v[40:43], v[100:103], v[152:155], v[40:43]
    v_pk_mul_f32 v[132:133], v[24:25], v[124:125]
    v_pk_mul_f32 v[134:135], v[26:27], v[126:127]
    ds_read_b64_tr_b16 v[94:95], v15 offset:61696
    s_waitcnt lgkmcnt(6)
    v_mfma_f32_16x16x32_bf16 v[44:47], v[104:107], v[148:151], v[44:47]
    v_pk_mul_f32 v[136:137], v[32:33], v[128:129]
    ds_read_b64_tr_b16 v[96:97], v16 offset:57632
    v_mfma_f32_16x16x32_bf16 v[48:51], v[104:107], v[152:155], v[48:51]
    v_pk_mul_f32 v[138:139], v[34:35], v[130:131]
    v_cvt_pk_bf16_f32 v132, v132, v133
    ds_read_b64_tr_b16 v[98:99], v16 offset:61728
    s_waitcnt lgkmcnt(6)
    v_mfma_f32_16x16x32_bf16 v[36:39], v[84:87], v[156:159], v[36:39]
    v_cvt_pk_bf16_f32 v133, v134, v135
    ds_read_b64_tr_b16 v[100:101], v15 offset:16896
    v_mfma_f32_16x16x32_bf16 v[40:43], v[84:87], v[160:163], v[40:43]
    v_cvt_pk_bf16_f32 v134, v136, v137
    v_cvt_pk_bf16_f32 v135, v138, v139
    ds_read_b64_tr_b16 v[102:103], v15 offset:20992
    s_waitcnt lgkmcnt(6)
    v_mfma_f32_16x16x32_bf16 v[44:47], v[88:91], v[156:159], v[44:47]
    v_permlane32_swap_b32 v132, v134
    ds_read_b64_tr_b16 v[104:105], v16 offset:16928
    v_mfma_f32_16x16x32_bf16 v[48:51], v[88:91], v[160:163], v[48:51]
    v_permlane32_swap_b32 v133, v135
    v_permlane16_swap_b32 v132, v134
    ds_read_b64_tr_b16 v[106:107], v16 offset:21024
    s_waitcnt lgkmcnt(6)
    v_mfma_f32_16x16x32_bf16 v[36:39], v[92:95], v[164:167], v[36:39]
    v_permlane16_swap_b32 v133, v135
    ds_read_b64_tr_b16 v[84:85], v15 offset:25088
    v_mfma_f32_16x16x32_bf16 v[40:43], v[92:95], v[168:171], v[40:43]
    buffer_store_dwordx4 v[132:135], v14, s[8:11], s19 offen offset:0 sc1
    ds_read_b64_tr_b16 v[86:87], v15 offset:29184
    s_waitcnt lgkmcnt(6)
    v_mfma_f32_16x16x32_bf16 v[44:47], v[96:99], v[164:167], v[44:47]
    ds_read_b64_tr_b16 v[88:89], v16 offset:25120
    v_mfma_f32_16x16x32_bf16 v[48:51], v[96:99], v[168:171], v[48:51]
    ds_read_b64_tr_b16 v[90:91], v16 offset:29216
    ds_read_b128 v[124:127], v13 offset:128
    ds_read_b128 v[128:131], v13 offset:192
    s_waitcnt lgkmcnt(8)
    v_mfma_f32_16x16x32_bf16 v[52:55], v[100:103], v[108:111], v[52:55]
    ds_read_b64_tr_b16 v[92:93], v15 offset:33280
    v_mfma_f32_16x16x32_bf16 v[56:59], v[100:103], v[112:115], v[56:59]
    ds_read_b64_tr_b16 v[94:95], v15 offset:37376
    s_waitcnt lgkmcnt(8)
    v_mfma_f32_16x16x32_bf16 v[60:63], v[104:107], v[108:111], v[60:63]
    ds_read_b64_tr_b16 v[96:97], v16 offset:33312
    v_mfma_f32_16x16x32_bf16 v[64:67], v[104:107], v[112:115], v[64:67]
    ds_read_b64_tr_b16 v[98:99], v16 offset:37408
    s_waitcnt lgkmcnt(8)
    v_mfma_f32_16x16x32_bf16 v[52:55], v[84:87], v[116:119], v[52:55]
    s_waitcnt lgkmcnt(5)
    v_pk_mul_f32 v[132:133], v[36:37], v[124:125]
    v_pk_mul_f32 v[134:135], v[38:39], v[126:127]
    ds_read_b64_tr_b16 v[100:101], v15 offset:41472
    v_mfma_f32_16x16x32_bf16 v[56:59], v[84:87], v[120:123], v[56:59]
    s_waitcnt lgkmcnt(5)
    v_pk_mul_f32 v[136:137], v[44:45], v[128:129]
    ds_read_b64_tr_b16 v[102:103], v15 offset:45568
    v_mfma_f32_16x16x32_bf16 v[60:63], v[88:91], v[116:119], v[60:63]
    v_pk_mul_f32 v[138:139], v[46:47], v[130:131]
    v_cvt_pk_bf16_f32 v132, v132, v133
    ds_read_b64_tr_b16 v[104:105], v16 offset:41504
    v_mfma_f32_16x16x32_bf16 v[64:67], v[88:91], v[120:123], v[64:67]
    v_cvt_pk_bf16_f32 v133, v134, v135
    ds_read_b64_tr_b16 v[106:107], v16 offset:45600
    s_waitcnt lgkmcnt(6)
    v_mfma_f32_16x16x32_bf16 v[52:55], v[92:95], v[140:143], v[52:55]
    v_cvt_pk_bf16_f32 v134, v136, v137
    v_cvt_pk_bf16_f32 v135, v138, v139
    ds_read_b64_tr_b16 v[84:85], v15 offset:49664
    v_mfma_f32_16x16x32_bf16 v[56:59], v[92:95], v[144:147], v[56:59]
    v_permlane32_swap_b32 v132, v134
    ds_read_b64_tr_b16 v[86:87], v15 offset:53760
    s_waitcnt lgkmcnt(6)
    v_mfma_f32_16x16x32_bf16 v[60:63], v[96:99], v[140:143], v[60:63]
    v_permlane32_swap_b32 v133, v135
    v_permlane16_swap_b32 v132, v134
    ds_read_b64_tr_b16 v[88:89], v16 offset:49696
    v_mfma_f32_16x16x32_bf16 v[64:67], v[96:99], v[144:147], v[64:67]
    v_permlane16_swap_b32 v133, v135
    ds_read_b64_tr_b16 v[90:91], v16 offset:53792
    s_waitcnt lgkmcnt(6)
    v_mfma_f32_16x16x32_bf16 v[52:55], v[100:103], v[148:151], v[52:55]
    buffer_store_dwordx4 v[132:135], v14, s[8:11], s18 offen offset:1024 sc1
    ds_read_b64_tr_b16 v[92:93], v15 offset:57856
    v_mfma_f32_16x16x32_bf16 v[56:59], v[100:103], v[152:155], v[56:59]
    v_pk_mul_f32 v[132:133], v[40:41], v[124:125]
    v_pk_mul_f32 v[134:135], v[42:43], v[126:127]
    ds_read_b64_tr_b16 v[94:95], v15 offset:61952
    s_waitcnt lgkmcnt(6)
    v_mfma_f32_16x16x32_bf16 v[60:63], v[104:107], v[148:151], v[60:63]
    v_pk_mul_f32 v[136:137], v[48:49], v[128:129]
    ds_read_b64_tr_b16 v[96:97], v16 offset:57888
    v_mfma_f32_16x16x32_bf16 v[64:67], v[104:107], v[152:155], v[64:67]
    v_pk_mul_f32 v[138:139], v[50:51], v[130:131]
    v_cvt_pk_bf16_f32 v132, v132, v133
    ds_read_b64_tr_b16 v[98:99], v16 offset:61984
    s_waitcnt lgkmcnt(6)
    v_mfma_f32_16x16x32_bf16 v[52:55], v[84:87], v[156:159], v[52:55]
    v_cvt_pk_bf16_f32 v133, v134, v135
    ds_read_b64_tr_b16 v[100:101], v15 offset:17152
    v_mfma_f32_16x16x32_bf16 v[56:59], v[84:87], v[160:163], v[56:59]
    v_cvt_pk_bf16_f32 v134, v136, v137
    v_cvt_pk_bf16_f32 v135, v138, v139
    ds_read_b64_tr_b16 v[102:103], v15 offset:21248
    s_waitcnt lgkmcnt(6)
    v_mfma_f32_16x16x32_bf16 v[60:63], v[88:91], v[156:159], v[60:63]
    v_permlane32_swap_b32 v132, v134
    ds_read_b64_tr_b16 v[104:105], v16 offset:17184
    v_mfma_f32_16x16x32_bf16 v[64:67], v[88:91], v[160:163], v[64:67]
    v_permlane32_swap_b32 v133, v135
    v_permlane16_swap_b32 v132, v134
    ds_read_b64_tr_b16 v[106:107], v16 offset:21280
    s_waitcnt lgkmcnt(6)
    v_mfma_f32_16x16x32_bf16 v[52:55], v[92:95], v[164:167], v[52:55]
    v_permlane16_swap_b32 v133, v135
    ds_read_b64_tr_b16 v[84:85], v15 offset:25344
    v_mfma_f32_16x16x32_bf16 v[56:59], v[92:95], v[168:171], v[56:59]
    buffer_store_dwordx4 v[132:135], v14, s[8:11], s19 offen offset:1024 sc1
    ds_read_b64_tr_b16 v[86:87], v15 offset:29440
    s_waitcnt lgkmcnt(6)
    v_mfma_f32_16x16x32_bf16 v[60:63], v[96:99], v[164:167], v[60:63]
    ds_read_b64_tr_b16 v[88:89], v16 offset:25376
    v_mfma_f32_16x16x32_bf16 v[64:67], v[96:99], v[168:171], v[64:67]
    ds_read_b64_tr_b16 v[90:91], v16 offset:29472
    ds_read_b128 v[124:127], v13 offset:256
    ds_read_b128 v[128:131], v13 offset:320
    s_waitcnt lgkmcnt(8)
    v_mfma_f32_16x16x32_bf16 v[68:71], v[100:103], v[108:111], v[68:71]
    ds_read_b64_tr_b16 v[92:93], v15 offset:33536
    v_mfma_f32_16x16x32_bf16 v[72:75], v[100:103], v[112:115], v[72:75]
    ds_read_b64_tr_b16 v[94:95], v15 offset:37632
    s_waitcnt lgkmcnt(8)
    v_mfma_f32_16x16x32_bf16 v[76:79], v[104:107], v[108:111], v[76:79]
    ds_read_b64_tr_b16 v[96:97], v16 offset:33568
    v_mfma_f32_16x16x32_bf16 v[80:83], v[104:107], v[112:115], v[80:83]
    ds_read_b64_tr_b16 v[98:99], v16 offset:37664
    s_waitcnt lgkmcnt(8)
    v_mfma_f32_16x16x32_bf16 v[68:71], v[84:87], v[116:119], v[68:71]
    s_waitcnt lgkmcnt(5)
    v_pk_mul_f32 v[132:133], v[52:53], v[124:125]
    v_pk_mul_f32 v[134:135], v[54:55], v[126:127]
    ds_read_b64_tr_b16 v[100:101], v15 offset:41728
    v_mfma_f32_16x16x32_bf16 v[72:75], v[84:87], v[120:123], v[72:75]
    s_waitcnt lgkmcnt(5)
    v_pk_mul_f32 v[136:137], v[60:61], v[128:129]
    ds_read_b64_tr_b16 v[102:103], v15 offset:45824
    v_mfma_f32_16x16x32_bf16 v[76:79], v[88:91], v[116:119], v[76:79]
    v_pk_mul_f32 v[138:139], v[62:63], v[130:131]
    v_cvt_pk_bf16_f32 v132, v132, v133
    ds_read_b64_tr_b16 v[104:105], v16 offset:41760
    v_mfma_f32_16x16x32_bf16 v[80:83], v[88:91], v[120:123], v[80:83]
    v_cvt_pk_bf16_f32 v133, v134, v135
    ds_read_b64_tr_b16 v[106:107], v16 offset:45856
    s_waitcnt lgkmcnt(6)
    v_mfma_f32_16x16x32_bf16 v[68:71], v[92:95], v[140:143], v[68:71]
    v_cvt_pk_bf16_f32 v134, v136, v137
    v_cvt_pk_bf16_f32 v135, v138, v139
    ds_read_b64_tr_b16 v[84:85], v15 offset:49920
    v_mfma_f32_16x16x32_bf16 v[72:75], v[92:95], v[144:147], v[72:75]
    v_permlane32_swap_b32 v132, v134
    ds_read_b64_tr_b16 v[86:87], v15 offset:54016
    s_waitcnt lgkmcnt(6)
    v_mfma_f32_16x16x32_bf16 v[76:79], v[96:99], v[140:143], v[76:79]
    v_permlane32_swap_b32 v133, v135
    v_permlane16_swap_b32 v132, v134
    ds_read_b64_tr_b16 v[88:89], v16 offset:49952
    v_mfma_f32_16x16x32_bf16 v[80:83], v[96:99], v[144:147], v[80:83]
    v_permlane16_swap_b32 v133, v135
    ds_read_b64_tr_b16 v[90:91], v16 offset:54048
    s_waitcnt lgkmcnt(6)
    v_mfma_f32_16x16x32_bf16 v[68:71], v[100:103], v[148:151], v[68:71]
    buffer_store_dwordx4 v[132:135], v14, s[8:11], s18 offen offset:2048 sc1
    ds_read_b64_tr_b16 v[92:93], v15 offset:58112
    v_mfma_f32_16x16x32_bf16 v[72:75], v[100:103], v[152:155], v[72:75]
    v_pk_mul_f32 v[132:133], v[56:57], v[124:125]
    v_pk_mul_f32 v[134:135], v[58:59], v[126:127]
    ds_read_b64_tr_b16 v[94:95], v15 offset:62208
    s_waitcnt lgkmcnt(6)
    v_mfma_f32_16x16x32_bf16 v[76:79], v[104:107], v[148:151], v[76:79]
    v_pk_mul_f32 v[136:137], v[64:65], v[128:129]
    ds_read_b64_tr_b16 v[96:97], v16 offset:58144
    v_mfma_f32_16x16x32_bf16 v[80:83], v[104:107], v[152:155], v[80:83]
    v_pk_mul_f32 v[138:139], v[66:67], v[130:131]
    v_cvt_pk_bf16_f32 v132, v132, v133
    ds_read_b64_tr_b16 v[98:99], v16 offset:62240
    s_waitcnt lgkmcnt(6)
    v_mfma_f32_16x16x32_bf16 v[68:71], v[84:87], v[156:159], v[68:71]
    v_cvt_pk_bf16_f32 v133, v134, v135
    v_mfma_f32_16x16x32_bf16 v[72:75], v[84:87], v[160:163], v[72:75]
    v_cvt_pk_bf16_f32 v134, v136, v137
    v_cvt_pk_bf16_f32 v135, v138, v139
    s_waitcnt lgkmcnt(4)
    v_mfma_f32_16x16x32_bf16 v[76:79], v[88:91], v[156:159], v[76:79]
    v_permlane32_swap_b32 v132, v134
    v_mfma_f32_16x16x32_bf16 v[80:83], v[88:91], v[160:163], v[80:83]
    v_permlane32_swap_b32 v133, v135
    v_permlane16_swap_b32 v132, v134
    s_waitcnt lgkmcnt(2)
    v_mfma_f32_16x16x32_bf16 v[68:71], v[92:95], v[164:167], v[68:71]
    v_permlane16_swap_b32 v133, v135
    v_mfma_f32_16x16x32_bf16 v[72:75], v[92:95], v[168:171], v[72:75]
    buffer_store_dwordx4 v[132:135], v14, s[8:11], s19 offen offset:2048 sc1
    s_waitcnt lgkmcnt(0)
    v_mfma_f32_16x16x32_bf16 v[76:79], v[96:99], v[164:167], v[76:79]
    v_mfma_f32_16x16x32_bf16 v[80:83], v[96:99], v[168:171], v[80:83]
    ds_read_b128 v[124:127], v13 offset:384
    ds_read_b128 v[128:131], v13 offset:448
    s_waitcnt lgkmcnt(1)
    v_pk_mul_f32 v[132:133], v[68:69], v[124:125]
    v_pk_mul_f32 v[134:135], v[70:71], v[126:127]
    s_waitcnt lgkmcnt(0)
    s_nop 0
    v_pk_mul_f32 v[136:137], v[76:77], v[128:129]
    v_pk_mul_f32 v[138:139], v[78:79], v[130:131]
    v_cvt_pk_bf16_f32 v132, v132, v133
    v_cvt_pk_bf16_f32 v133, v134, v135
    v_cvt_pk_bf16_f32 v134, v136, v137
    v_cvt_pk_bf16_f32 v135, v138, v139
    s_nop 0
    v_permlane32_swap_b32 v132, v134
    v_permlane32_swap_b32 v133, v135
    s_nop 0
    v_permlane16_swap_b32 v132, v134
    v_permlane16_swap_b32 v133, v135
    buffer_store_dwordx4 v[132:135], v14, s[8:11], s18 offen offset:3072 sc1
    s_nop 1
    v_pk_mul_f32 v[132:133], v[72:73], v[124:125]
    v_pk_mul_f32 v[134:135], v[74:75], v[126:127]
    v_pk_mul_f32 v[136:137], v[80:81], v[128:129]
    v_pk_mul_f32 v[138:139], v[82:83], v[130:131]
    v_cvt_pk_bf16_f32 v132, v132, v133
    v_cvt_pk_bf16_f32 v133, v134, v135
    v_cvt_pk_bf16_f32 v134, v136, v137
    v_cvt_pk_bf16_f32 v135, v138, v139
    s_nop 0
    v_permlane32_swap_b32 v132, v134
    v_permlane32_swap_b32 v133, v135
    s_nop 0
    v_permlane16_swap_b32 v132, v134
    v_permlane16_swap_b32 v133, v135
    buffer_store_dwordx4 v[132:135], v14, s[8:11], s19 offen offset:3072 sc1
    s_branch fz_p3e
fz_p3B:
    v_bfe_u32 v9, v0, 2, 2
    v_lshrrev_b32 v10, 4, v0
    v_and_b32 v11, 3, v0
    v_lshlrev_b32 v3, 10, v10
    v_lshl_add_u32 v3, v9, 6, v3
    v_lshl_add_u32 v3, v11, 3, v3
    v_bfe_u32 v12, v0, 4, 1
    v_lshlrev_b32 v12, 5, v12
    v_sub_u32 v2, v3, v12
    v_add_u32 v3, v3, v12
    s_lshl_b32 s19, s13, 3
    s_add_u32 s19, s19, s3
    s_mul_i32 s19, s19, 262144
    v_add_u32 v4, s19, v1
    s_and_b32 s62, s12, 24
    s_and_b32 s19, s12, 7
    s_lshl_b32 s20, s19, 2
    s_lshr_b32 s20, 0x54732160, s20
    s_and_b32 s20, s20, 7
    s_lshl_b32 s20, s20, 2
    s_bfm_b32 s21, s20, 0
    s_and_b32 s22, s21, 0x51764320
    s_lshl_b32 s22, s22, 4
    s_lshl_b32 s21, s21, 4
    s_or_b32 s21, s21, 15
    s_andn2_b32 s21, 0x51764320, s21
    s_or_b32 s42, s21, s22
    s_or_b32 s42, s42, s19
    s_bfe_u32 s96, s2, 0x10002
    s_mul_i32 s96, s96, 28
    s_lshr_b32 s26, s2, 3
    s_add_u32 s96, s96, s26
    s_and_b32 s97, s2, 1
    s_bfe_u32 s98, s2, 0x10001
    s_bfe_u32 s99, s2, 0x40003
    s_and_b32 s100, s2, 7
    s_lshl_b32 s100, s100, 1
    s_lshr_b32 s26, s2, 7
    s_add_u32 s100, s100, s26
    v_lshrrev_b32 v9, 4, v0
    v_lshlrev_b32 v13, 4, v9
    s_add_u32 s19, s12, 1
    s_and_b32 s19, s19, 7
    s_lshl_b32 s26, s19, 9
    s_add_u32 s26, s26, 0x22000
    v_add_u32 v13, s26, v13
    v_and_b32 v14, 15, v0
    v_lshlrev_b32 v14, 6, v14
    v_lshl_add_u32 v14, v9, 4, v14
    s_lshr_b32 s18, s12, 3
    s_lshl_b32 s18, s18, 22
    s_lshl_b32 s26, s13, 3
    s_add_u32 s26, s26, s3
    s_lshl_b32 s26, s26, 16
    s_add_u32 s18, s18, s26
    s_lshl_b32 s19, s19, 12
    s_add_u32 s18, s18, s19
    s_add_u32 s18, s18, 0x2000000
    s_add_u32 s19, s18, 0x8000
    v_add_u32 v15, 0x10000, v3
    v_add_u32 v16, 0x10000, v2
    s_lshl_b32 s26, s13, 3
    s_add_u32 s26, s26, s3
    s_lshl_b32 s26, s26, 2
    s_lshr_b32 s27, s12, 3
    s_add_u32 s26, s26, s27
    s_lshl_b32 s26, s26, 7
    s_add_u32 s20, s26, 0x540000
    s_and_b32 s27, s12, 7
    s_lshl_b32 s27, s27, 2
    s_add_u32 s26, s20, s27
    v_mov_b32 v9, s14
    v_mov_b32 v10, 0
    s_waitcnt vmcnt(0)
    s_mov_b64 exec, 1
    buffer_store_dword v9, v10, s[8:11], s26 offen sc1
    s_mov_b64 exec, -1
    s_waitcnt lgkmcnt(0)
    s_barrier
    ds_read_b64_tr_b16 v[84:85], v3 offset:0
    ds_read_b64_tr_b16 v[86:87], v3 offset:4096
    ds_read_b64_tr_b16 v[88:89], v2 offset:32
    ds_read_b64_tr_b16 v[90:91], v2 offset:4128
    ds_read_b64_tr_b16 v[92:93], v3 offset:256
    ds_read_b64_tr_b16 v[94:95], v3 offset:4352
    ds_read_b64_tr_b16 v[96:97], v2 offset:288
    ds_read_b64_tr_b16 v[98:99], v2 offset:4384
    s_waitcnt lgkmcnt(6)
    v_mfma_f32_16x16x32_bf16 v[20:23], v[84:87], v[108:111], 0
    ds_read_b64_tr_b16 v[100:101], v3 offset:512
    v_mfma_f32_16x16x32_bf16 v[24:27], v[84:87], v[124:127], 0
    ds_read_b64_tr_b16 v[102:103], v3 offset:4608
    s_waitcnt lgkmcnt(6)
    v_mfma_f32_16x16x32_bf16 v[28:31], v[88:91], v[108:111], 0
    ds_read_b64_tr_b16 v[104:105], v2 offset:544
    v_mfma_f32_16x16x32_bf16 v[32:35], v[88:91], v[124:127], 0
    ds_read_b64_tr_b16 v[106:107], v2 offset:4640
    s_waitcnt lgkmcnt(6)
    v_mfma_f32_16x16x32_bf16 v[36:39], v[92:95], v[108:111], 0
    ds_read_b64_tr_b16 v[84:85], v3 offset:768
    v_mfma_f32_16x16x32_bf16 v[40:43], v[92:95], v[124:127], 0
    ds_read_b64_tr_b16 v[86:87], v3 offset:4864
    s_waitcnt lgkmcnt(6)
    v_mfma_f32_16x16x32_bf16 v[44:47], v[96:99], v[108:111], 0
    ds_read_b64_tr_b16 v[88:89], v2 offset:800
    v_mfma_f32_16x16x32_bf16 v[48:51], v[96:99], v[124:127], 0
    ds_read_b64_tr_b16 v[90:91], v2 offset:4896
    s_waitcnt lgkmcnt(6)
    v_mfma_f32_16x16x32_bf16 v[52:55], v[100:103], v[108:111], 0
    ds_read_b64_tr_b16 v[92:93], v3 offset:8192
    v_mfma_f32_16x16x32_bf16 v[56:59], v[100:103], v[124:127], 0
    ds_read_b64_tr_b16 v[94:95], v3 offset:12288
    s_waitcnt lgkmcnt(6)
    v_mfma_f32_16x16x32_bf16 v[60:63], v[104:107], v[108:111], 0
    ds_read_b64_tr_b16 v[96:97], v2 offset:8224
    v_mfma_f32_16x16x32_bf16 v[64:67], v[104:107], v[124:127], 0
    ds_read_b64_tr_b16 v[98:99], v2 offset:12320
    s_waitcnt lgkmcnt(6)
    v_mfma_f32_16x16x32_bf16 v[68:71], v[84:87], v[108:111], 0
    ds_read_b64_tr_b16 v[100:101], v3 offset:8448
    v_mfma_f32_16x16x32_bf16 v[72:75], v[84:87], v[124:127], 0
    ds_read_b64_tr_b16 v[102:103], v3 offset:12544
    s_waitcnt lgkmcnt(6)
    v_mfma_f32_16x16x32_bf16 v[76:79], v[88:91], v[108:111], 0
    ds_read_b64_tr_b16 v[104:105], v2 offset:8480
    v_mfma_f32_16x16x32_bf16 v[80:83], v[88:91], v[124:127], 0
    ds_read_b64_tr_b16 v[106:107], v2 offset:12576
    s_waitcnt lgkmcnt(6)
    v_mfma_f32_16x16x32_bf16 v[20:23], v[92:95], v[112:115], v[20:23]
    ds_read_b64_tr_b16 v[84:85], v3 offset:8704
    v_mfma_f32_16x16x32_bf16 v[24:27], v[92:95], v[128:131], v[24:27]
    ds_read_b64_tr_b16 v[86:87], v3 offset:12800
    s_waitcnt lgkmcnt(6)
    v_mfma_f32_16x16x32_bf16 v[28:31], v[96:99], v[112:115], v[28:31]
    ds_read_b64_tr_b16 v[88:89], v2 offset:8736
    v_mfma_f32_16x16x32_bf16 v[32:35], v[96:99], v[128:131], v[32:35]
    ds_read_b64_tr_b16 v[90:91], v2 offset:12832
    s_waitcnt lgkmcnt(6)
    v_mfma_f32_16x16x32_bf16 v[36:39], v[100:103], v[112:115], v[36:39]
    ds_read_b64_tr_b16 v[92:93], v3 offset:8960
    v_mfma_f32_16x16x32_bf16 v[40:43], v[100:103], v[128:131], v[40:43]
    ds_read_b64_tr_b16 v[94:95], v3 offset:13056
    s_waitcnt lgkmcnt(6)
    v_mfma_f32_16x16x32_bf16 v[44:47], v[104:107], v[112:115], v[44:47]
    ds_read_b64_tr_b16 v[96:97], v2 offset:8992
    v_mfma_f32_16x16x32_bf16 v[48:51], v[104:107], v[128:131], v[48:51]
    ds_read_b64_tr_b16 v[98:99], v2 offset:13088
    s_waitcnt lgkmcnt(6)
    v_mfma_f32_16x16x32_bf16 v[52:55], v[84:87], v[112:115], v[52:55]
    v_mfma_f32_16x16x32_bf16 v[56:59], v[84:87], v[128:131], v[56:59]
    s_barrier
    ds_read_b64_tr_b16 v[100:101], v3 offset:16384
    ds_read_b64_tr_b16 v[102:103], v3 offset:20480
    s_waitcnt lgkmcnt(6)
    v_mfma_f32_16x16x32_bf16 v[60:63], v[88:91], v[112:115], v[60:63]
    ds_read_b64_tr_b16 v[104:105], v2 offset:16416
    v_mfma_f32_16x16x32_bf16 v[64:67], v[88:91], v[128:131], v[64:67]
    ds_read_b64_tr_b16 v[106:107], v2 offset:20512
    s_waitcnt lgkmcnt(6)
    v_mfma_f32_16x16x32_bf16 v[68:71], v[92:95], v[112:115], v[68:71]
    ds_read_b64_tr_b16 v[84:85], v3 offset:16640
    v_mfma_f32_16x16x32_bf16 v[72:75], v[92:95], v[128:131], v[72:75]
    ds_read_b64_tr_b16 v[86:87], v3 offset:20736
    s_waitcnt lgkmcnt(6)
    v_mfma_f32_16x16x32_bf16 v[76:79], v[96:99], v[112:115], v[76:79]
    ds_read_b64_tr_b16 v[88:89], v2 offset:16672
    v_mfma_f32_16x16x32_bf16 v[80:83], v[96:99], v[128:131], v[80:83]
    ds_read_b64_tr_b16 v[90:91], v2 offset:20768
    s_waitcnt lgkmcnt(6)
    v_mfma_f32_16x16x32_bf16 v[20:23], v[100:103], v[116:119], v[20:23]
    ds_read_b64_tr_b16 v[92:93], v3 offset:16896
    v_mfma_f32_16x16x32_bf16 v[24:27], v[100:103], v[132:135], v[24:27]
    ds_read_b64_tr_b16 v[94:95], v3 offset:20992
    s_waitcnt lgkmcnt(6)
    v_mfma_f32_16x16x32_bf16 v[28:31], v[104:107], v[116:119], v[28:31]
    ds_read_b64_tr_b16 v[96:97], v2 offset:16928
    v_mfma_f32_16x16x32_bf16 v[32:35], v[104:107], v[132:135], v[32:35]
    ds_read_b64_tr_b16 v[98:99], v2 offset:21024
    s_waitcnt lgkmcnt(6)
    v_mfma_f32_16x16x32_bf16 v[36:39], v[84:87], v[116:119], v[36:39]
    ds_read_b64_tr_b16 v[100:101], v3 offset:17152
    v_mfma_f32_16x16x32_bf16 v[40:43], v[84:87], v[132:135], v[40:43]
    ds_read_b64_tr_b16 v[102:103], v3 offset:21248
    s_waitcnt lgkmcnt(6)
    v_mfma_f32_16x16x32_bf16 v[44:47], v[88:91], v[116:119], v[44:47]
    ds_read_b64_tr_b16 v[104:105], v2 offset:17184
    v_mfma_f32_16x16x32_bf16 v[48:51], v[88:91], v[132:135], v[48:51]
    ds_read_b64_tr_b16 v[106:107], v2 offset:21280
    s_waitcnt lgkmcnt(6)
    v_mfma_f32_16x16x32_bf16 v[52:55], v[92:95], v[116:119], v[52:55]
    ds_read_b64_tr_b16 v[84:85], v3 offset:24576
    v_mfma_f32_16x16x32_bf16 v[56:59], v[92:95], v[132:135], v[56:59]
    ds_read_b64_tr_b16 v[86:87], v3 offset:28672
    s_waitcnt lgkmcnt(6)
    v_mfma_f32_16x16x32_bf16 v[60:63], v[96:99], v[116:119], v[60:63]
    ds_read_b64_tr_b16 v[88:89], v2 offset:24608
    v_mfma_f32_16x16x32_bf16 v[64:67], v[96:99], v[132:135], v[64:67]
    ds_read_b64_tr_b16 v[90:91], v2 offset:28704
    s_waitcnt lgkmcnt(6)
    v_mfma_f32_16x16x32_bf16 v[68:71], v[100:103], v[116:119], v[68:71]
    ds_read_b64_tr_b16 v[92:93], v3 offset:24832
    v_mfma_f32_16x16x32_bf16 v[72:75], v[100:103], v[132:135], v[72:75]
    ds_read_b64_tr_b16 v[94:95], v3 offset:28928
    s_waitcnt lgkmcnt(6)
    v_mfma_f32_16x16x32_bf16 v[76:79], v[104:107], v[116:119], v[76:79]
    ds_read_b64_tr_b16 v[96:97], v2 offset:24864
    v_mfma_f32_16x16x32_bf16 v[80:83], v[104:107], v[132:135], v[80:83]
    ds_read_b64_tr_b16 v[98:99], v2 offset:28960
    s_waitcnt lgkmcnt(6)
    v_mfma_f32_16x16x32_bf16 v[20:23], v[84:87], v[120:123], v[20:23]
    ds_read_b64_tr_b16 v[100:101], v3 offset:25088
    v_mfma_f32_16x16x32_bf16 v[24:27], v[84:87], v[136:139], v[24:27]
    ds_read_b64_tr_b16 v[102:103], v3 offset:29184
    s_waitcnt lgkmcnt(6)
    v_mfma_f32_16x16x32_bf16 v[28:31], v[88:91], v[120:123], v[28:31]
    ds_read_b64_tr_b16 v[104:105], v2 offset:25120
    v_mfma_f32_16x16x32_bf16 v[32:35], v[88:91], v[136:139], v[32:35]
    ds_read_b64_tr_b16 v[106:107], v2 offset:29216
    s_waitcnt lgkmcnt(6)
    v_mfma_f32_16x16x32_bf16 v[36:39], v[92:95], v[120:123], v[36:39]
    ds_read_b64_tr_b16 v[84:85], v3 offset:25344
    v_mfma_f32_16x16x32_bf16 v[40:43], v[92:95], v[136:139], v[40:43]
    ds_read_b64_tr_b16 v[86:87], v3 offset:29440
    s_waitcnt lgkmcnt(6)
    v_mfma_f32_16x16x32_bf16 v[44:47], v[96:99], v[120:123], v[44:47]
    ds_read_b64_tr_b16 v[88:89], v2 offset:25376
    v_mfma_f32_16x16x32_bf16 v[48:51], v[96:99], v[136:139], v[48:51]
    ds_read_b64_tr_b16 v[90:91], v2 offset:29472
    s_waitcnt lgkmcnt(6)
    v_mfma_f32_16x16x32_bf16 v[52:55], v[100:103], v[120:123], v[52:55]
    v_mfma_f32_16x16x32_bf16 v[56:59], v[100:103], v[136:139], v[56:59]
    s_barrier
    ds_read_b64_tr_b16 v[92:93], v3 offset:32768
    ds_read_b64_tr_b16 v[94:95], v3 offset:36864
    s_waitcnt lgkmcnt(6)
    v_mfma_f32_16x16x32_bf16 v[60:63], v[104:107], v[120:123], v[60:63]
    ds_read_b64_tr_b16 v[96:97], v2 offset:32800
    v_mfma_f32_16x16x32_bf16 v[64:67], v[104:107], v[136:139], v[64:67]
    ds_read_b64_tr_b16 v[98:99], v2 offset:36896
    s_waitcnt lgkmcnt(6)
    v_mfma_f32_16x16x32_bf16 v[68:71], v[84:87], v[120:123], v[68:71]
    ds_read_b64_tr_b16 v[100:101], v3 offset:33024
    v_mfma_f32_16x16x32_bf16 v[72:75], v[84:87], v[136:139], v[72:75]
    ds_read_b64_tr_b16 v[102:103], v3 offset:37120
    s_waitcnt lgkmcnt(6)
    v_mfma_f32_16x16x32_bf16 v[76:79], v[88:91], v[120:123], v[76:79]
    ds_read_b64_tr_b16 v[104:105], v2 offset:33056
    v_mfma_f32_16x16x32_bf16 v[80:83], v[88:91], v[136:139], v[80:83]
    ds_read_b64_tr_b16 v[106:107], v2 offset:37152
    v_and_b32 v9, 7, v0
    v_lshlrev_b32 v9, 2, v9
    s_mov_b32 s27, 0
fz_oBp:
    buffer_load_dword v10, v9, s[8:11], s20 offen sc1
    s_waitcnt vmcnt(0)
    v_cmp_ne_u32 vcc, s14, v10
    s_and_b32 vcc_lo, vcc_lo, 0xdd
    s_mov_b32 vcc_hi, 0
    s_add_u32 s27, s27, 1
    s_cmp_ge_u32 s27, 65536
    s_cbranch_scc1 fz_oBg
    s_cbranch_vccz fz_oBg
    s_sleep 1
    s_branch fz_oBp
fz_oBg:
    s_bfe_u32 s21, s42, 0x30004
    s_or_b32 s21, s21, s62
    s_lshl_b32 s21, s21, 12
    s_add_u32 s23, s21, 0x1000000
    buffer_load_dwordx4 v[140:143], v4, s[8:11], s23 offen offset:0 sc1
    s_add_u32 s23, s21, 0x1020000
    buffer_load_dwordx4 v[144:147], v4, s[8:11], s23 offen offset:0 sc1
    s_add_u32 s23, s21, 0x1000000
    buffer_load_dwordx4 v[148:151], v4, s[8:11], s23 offen offset:1024 sc1
    s_add_u32 s23, s21, 0x1020000
    buffer_load_dwordx4 v[152:155], v4, s[8:11], s23 offen offset:1024 sc1
    s_add_u32 s23, s21, 0x1000800
    buffer_load_dwordx4 v[156:159], v4, s[8:11], s23 offen offset:0 sc1
    s_add_u32 s23, s21, 0x1020800
    buffer_load_dwordx4 v[160:163], v4, s[8:11], s23 offen offset:0 sc1
    s_add_u32 s23, s21, 0x1000800
    buffer_load_dwordx4 v[164:167], v4, s[8:11], s23 offen offset:1024 sc1
    s_add_u32 s23, s21, 0x1020800
    buffer_load_dwordx4 v[168:171], v4, s[8:11], s23 offen offset:1024 sc1
    s_bfe_u32 s21, s42, 0x30008
    s_or_b32 s21, s21, s62
    s_lshl_b32 s21, s21, 12
    s_add_u32 s23, s21, 0x1000000
    buffer_load_dwordx4 v[188:191], v4, s[8:11], s23 offen offset:0 sc1
    s_add_u32 s23, s21, 0x1020000
    buffer_load_dwordx4 v[192:195], v4, s[8:11], s23 offen offset:0 sc1
    s_add_u32 s23, s21, 0x1000000
    buffer_load_dwordx4 v[196:199], v4, s[8:11], s23 offen offset:1024 sc1
    s_add_u32 s23, s21, 0x1020000
    buffer_load_dwordx4 v[200:203], v4, s[8:11], s23 offen offset:1024 sc1
    s_waitcnt vmcnt(11) lgkmcnt(6)
    v_mfma_f32_16x16x32_bf16 v[20:23], v[92:95], v[140:143], v[20:23]
    ds_read_b64_tr_b16 v[84:85], v3 offset:33280
    s_waitcnt vmcnt(10)
    v_mfma_f32_16x16x32_bf16 v[24:27], v[92:95], v[144:147], v[24:27]
    ds_read_b64_tr_b16 v[86:87], v3 offset:37376
    s_waitcnt lgkmcnt(6)
    v_mfma_f32_16x16x32_bf16 v[28:31], v[96:99], v[140:143], v[28:31]
    ds_read_b64_tr_b16 v[88:89], v2 offset:33312
    v_mfma_f32_16x16x32_bf16 v[32:35], v[96:99], v[144:147], v[32:35]
    ds_read_b64_tr_b16 v[90:91], v2 offset:37408
    s_add_u32 s23, s21, 0x1000800
    buffer_load_dwordx4 v[108:111], v4, s[8:11], s23 offen offset:0 sc1
    s_waitcnt lgkmcnt(6)
    v_mfma_f32_16x16x32_bf16 v[36:39], v[100:103], v[140:143], v[36:39]
    ds_read_b64_tr_b16 v[92:93], v3 offset:33536
    v_mfma_f32_16x16x32_bf16 v[40:43], v[100:103], v[144:147], v[40:43]
    ds_read_b64_tr_b16 v[94:95], v3 offset:37632
    s_waitcnt lgkmcnt(6)
    v_mfma_f32_16x16x32_bf16 v[44:47], v[104:107], v[140:143], v[44:47]
    ds_read_b64_tr_b16 v[96:97], v2 offset:33568
    v_mfma_f32_16x16x32_bf16 v[48:51], v[104:107], v[144:147], v[48:51]
    ds_read_b64_tr_b16 v[98:99], v2 offset:37664
    s_waitcnt lgkmcnt(6)
    v_mfma_f32_16x16x32_bf16 v[52:55], v[84:87], v[140:143], v[52:55]
    ds_read_b64_tr_b16 v[100:101], v3 offset:40960
    v_mfma_f32_16x16x32_bf16 v[56:59], v[84:87], v[144:147], v[56:59]
    ds_read_b64_tr_b16 v[102:103], v3 offset:45056
    s_waitcnt lgkmcnt(6)
    v_mfma_f32_16x16x32_bf16 v[60:63], v[88:91], v[140:143], v[60:63]
    ds_read_b64_tr_b16 v[104:105], v2 offset:40992
    v_mfma_f32_16x16x32_bf16 v[64:67], v[88:91], v[144:147], v[64:67]
    ds_read_b64_tr_b16 v[106:107], v2 offset:45088
    s_add_u32 s23, s21, 0x1020800
    buffer_load_dwordx4 v[112:115], v4, s[8:11], s23 offen offset:0 sc1
    s_waitcnt lgkmcnt(6)
    v_mfma_f32_16x16x32_bf16 v[68:71], v[92:95], v[140:143], v[68:71]
    ds_read_b64_tr_b16 v[84:85], v3 offset:41216
    v_mfma_f32_16x16x32_bf16 v[72:75], v[92:95], v[144:147], v[72:75]
    ds_read_b64_tr_b16 v[86:87], v3 offset:45312
    s_waitcnt lgkmcnt(6)
    v_mfma_f32_16x16x32_bf16 v[76:79], v[96:99], v[140:143], v[76:79]
    ds_read_b64_tr_b16 v[88:89], v2 offset:41248
    v_mfma_f32_16x16x32_bf16 v[80:83], v[96:99], v[144:147], v[80:83]
    ds_read_b64_tr_b16 v[90:91], v2 offset:45344
    s_waitcnt vmcnt(11) lgkmcnt(6)
    v_mfma_f32_16x16x32_bf16 v[20:23], v[100:103], v[148:151], v[20:23]
    ds_read_b64_tr_b16 v[92:93], v3 offset:41472
    s_waitcnt vmcnt(10)
    v_mfma_f32_16x16x32_bf16 v[24:27], v[100:103], v[152:155], v[24:27]
    ds_read_b64_tr_b16 v[94:95], v3 offset:45568
    s_waitcnt lgkmcnt(6)
    v_mfma_f32_16x16x32_bf16 v[28:31], v[104:107], v[148:151], v[28:31]
    ds_read_b64_tr_b16 v[96:97], v2 offset:41504
    v_mfma_f32_16x16x32_bf16 v[32:35], v[104:107], v[152:155], v[32:35]
    ds_read_b64_tr_b16 v[98:99], v2 offset:45600
    s_add_u32 s23, s21, 0x1000800
    buffer_load_dwordx4 v[116:119], v4, s[8:11], s23 offen offset:1024 sc1
    s_waitcnt lgkmcnt(6)
    v_mfma_f32_16x16x32_bf16 v[36:39], v[84:87], v[148:151], v[36:39]
    ds_read_b64_tr_b16 v[100:101], v3 offset:41728
    v_mfma_f32_16x16x32_bf16 v[40:43], v[84:87], v[152:155], v[40:43]
    ds_read_b64_tr_b16 v[102:103], v3 offset:45824
    s_waitcnt lgkmcnt(6)
    v_mfma_f32_16x16x32_bf16 v[44:47], v[88:91], v[148:151], v[44:47]
    ds_read_b64_tr_b16 v[104:105], v2 offset:41760
    v_mfma_f32_16x16x32_bf16 v[48:51], v[88:91], v[152:155], v[48:51]
    ds_read_b64_tr_b16 v[106:107], v2 offset:45856
    s_waitcnt lgkmcnt(6)
    v_mfma_f32_16x16x32_bf16 v[52:55], v[92:95], v[148:151], v[52:55]
    v_mfma_f32_16x16x32_bf16 v[56:59], v[92:95], v[152:155], v[56:59]
    s_barrier
    ds_read_b64_tr_b16 v[84:85], v3 offset:49152
    ds_read_b64_tr_b16 v[86:87], v3 offset:53248
    s_waitcnt lgkmcnt(6)
    v_mfma_f32_16x16x32_bf16 v[60:63], v[96:99], v[148:151], v[60:63]
    ds_read_b64_tr_b16 v[88:89], v2 offset:49184
    v_mfma_f32_16x16x32_bf16 v[64:67], v[96:99], v[152:155], v[64:67]
    ds_read_b64_tr_b16 v[90:91], v2 offset:53280
    s_add_u32 s23, s21, 0x1020800
    buffer_load_dwordx4 v[120:123], v4, s[8:11], s23 offen offset:1024 sc1
    s_waitcnt lgkmcnt(6)
    v_mfma_f32_16x16x32_bf16 v[68:71], v[100:103], v[148:151], v[68:71]
    ds_read_b64_tr_b16 v[92:93], v3 offset:49408
    v_mfma_f32_16x16x32_bf16 v[72:75], v[100:103], v[152:155], v[72:75]
    ds_read_b64_tr_b16 v[94:95], v3 offset:53504
    s_waitcnt lgkmcnt(6)
    v_mfma_f32_16x16x32_bf16 v[76:79], v[104:107], v[148:151], v[76:79]
    ds_read_b64_tr_b16 v[96:97], v2 offset:49440
    v_mfma_f32_16x16x32_bf16 v[80:83], v[104:107], v[152:155], v[80:83]
    ds_read_b64_tr_b16 v[98:99], v2 offset:53536
    s_waitcnt vmcnt(11) lgkmcnt(6)
    v_mfma_f32_16x16x32_bf16 v[20:23], v[84:87], v[156:159], v[20:23]
    ds_read_b64_tr_b16 v[100:101], v3 offset:49664
    s_waitcnt vmcnt(10)
    v_mfma_f32_16x16x32_bf16 v[24:27], v[84:87], v[160:163], v[24:27]
    ds_read_b64_tr_b16 v[102:103], v3 offset:53760
    s_waitcnt lgkmcnt(6)
    v_mfma_f32_16x16x32_bf16 v[28:31], v[88:91], v[156:159], v[28:31]
    ds_read_b64_tr_b16 v[104:105], v2 offset:49696
    v_mfma_f32_16x16x32_bf16 v[32:35], v[88:91], v[160:163], v[32:35]
    ds_read_b64_tr_b16 v[106:107], v2 offset:53792
    s_bfe_u32 s21, s42, 0x3000c
    s_or_b32 s21, s21, s62
    s_lshl_b32 s21, s21, 12
    s_add_u32 s23, s21, 0x1000000
    buffer_load_dwordx4 v[140:143], v4, s[8:11], s23 offen offset:0 sc1
    s_waitcnt lgkmcnt(6)
    v_mfma_f32_16x16x32_bf16 v[36:39], v[92:95], v[156:159], v[36:39]
    ds_read_b64_tr_b16 v[84:85], v3 offset:49920
    v_mfma_f32_16x16x32_bf16 v[40:43], v[92:95], v[160:163], v[40:43]
    ds_read_b64_tr_b16 v[86:87], v3 offset:54016
    s_waitcnt lgkmcnt(6)
    v_mfma_f32_16x16x32_bf16 v[44:47], v[96:99], v[156:159], v[44:47]
    ds_read_b64_tr_b16 v[88:89], v2 offset:49952
    v_mfma_f32_16x16x32_bf16 v[48:51], v[96:99], v[160:163], v[48:51]
    ds_read_b64_tr_b16 v[90:91], v2 offset:54048
    s_waitcnt lgkmcnt(6)
    v_mfma_f32_16x16x32_bf16 v[52:55], v[100:103], v[156:159], v[52:55]
    ds_read_b64_tr_b16 v[92:93], v3 offset:57344
    v_mfma_f32_16x16x32_bf16 v[56:59], v[100:103], v[160:163], v[56:59]
    ds_read_b64_tr_b16 v[94:95], v3 offset:61440
    s_waitcnt lgkmcnt(6)
    v_mfma_f32_16x16x32_bf16 v[60:63], v[104:107], v[156:159], v[60:63]
    ds_read_b64_tr_b16 v[96:97], v2 offset:57376
    v_mfma_f32_16x16x32_bf16 v[64:67], v[104:107], v[160:163], v[64:67]
    ds_read_b64_tr_b16 v[98:99], v2 offset:61472
    s_add_u32 s23, s21, 0x1020000
    buffer_load_dwordx4 v[144:147], v4, s[8:11], s23 offen offset:0 sc1
    s_waitcnt lgkmcnt(6)
    v_mfma_f32_16x16x32_bf16 v[68:71], v[84:87], v[156:159], v[68:71]
    ds_read_b64_tr_b16 v[100:101], v3 offset:57600
    v_mfma_f32_16x16x32_bf16 v[72:75], v[84:87], v[160:163], v[72:75]
    ds_read_b64_tr_b16 v[102:103], v3 offset:61696
    s_waitcnt lgkmcnt(6)
    v_mfma_f32_16x16x32_bf16 v[76:79], v[88:91], v[156:159], v[76:79]
    ds_read_b64_tr_b16 v[104:105], v2 offset:57632
    v_mfma_f32_16x16x32_bf16 v[80:83], v[88:91], v[160:163], v[80:83]
    ds_read_b64_tr_b16 v[106:107], v2 offset:61728
    s_waitcnt vmcnt(11) lgkmcnt(6)
    v_mfma_f32_16x16x32_bf16 v[20:23], v[92:95], v[164:167], v[20:23]
    ds_read_b64_tr_b16 v[84:85], v3 offset:57856
    s_waitcnt vmcnt(10)
    v_mfma_f32_16x16x32_bf16 v[24:27], v[92:95], v[168:171], v[24:27]
    ds_read_b64_tr_b16 v[86:87], v3 offset:61952
    s_waitcnt lgkmcnt(6)
    v_mfma_f32_16x16x32_bf16 v[28:31], v[96:99], v[164:167], v[28:31]
    ds_read_b64_tr_b16 v[88:89], v2 offset:57888
    v_mfma_f32_16x16x32_bf16 v[32:35], v[96:99], v[168:171], v[32:35]
    ds_read_b64_tr_b16 v[90:91], v2 offset:61984
    s_add_u32 s23, s21, 0x1000000
    buffer_load_dwordx4 v[148:151], v4, s[8:11], s23 offen offset:1024 sc1
    s_waitcnt lgkmcnt(6)
    v_mfma_f32_16x16x32_bf16 v[36:39], v[100:103], v[164:167], v[36:39]
    ds_read_b64_tr_b16 v[92:93], v3 offset:58112
    v_mfma_f32_16x16x32_bf16 v[40:43], v[100:103], v[168:171], v[40:43]
    ds_read_b64_tr_b16 v[94:95], v3 offset:62208
    s_waitcnt lgkmcnt(6)
    v_mfma_f32_16x16x32_bf16 v[44:47], v[104:107], v[164:167], v[44:47]
    ds_read_b64_tr_b16 v[96:97], v2 offset:58144
    v_mfma_f32_16x16x32_bf16 v[48:51], v[104:107], v[168:171], v[48:51]
    ds_read_b64_tr_b16 v[98:99], v2 offset:62240
    s_waitcnt lgkmcnt(6)
    v_mfma_f32_16x16x32_bf16 v[52:55], v[84:87], v[164:167], v[52:55]
    v_mfma_f32_16x16x32_bf16 v[56:59], v[84:87], v[168:171], v[56:59]
    s_barrier
    ds_read_b64_tr_b16 v[100:101], v15 offset:0
    ds_read_b64_tr_b16 v[102:103], v15 offset:4096
    s_waitcnt lgkmcnt(6)
    v_mfma_f32_16x16x32_bf16 v[60:63], v[88:91], v[164:167], v[60:63]
    ds_read_b64_tr_b16 v[104:105], v16 offset:32
    v_mfma_f32_16x16x32_bf16 v[64:67], v[88:91], v[168:171], v[64:67]
    ds_read_b64_tr_b16 v[106:107], v16 offset:4128
    s_add_u32 s23, s21, 0x1020000
    buffer_load_dwordx4 v[152:155], v4, s[8:11], s23 offen offset:1024 sc1
    s_waitcnt lgkmcnt(6)
    v_mfma_f32_16x16x32_bf16 v[68:71], v[92:95], v[164:167], v[68:71]
    ds_read_b64_tr_b16 v[84:85], v15 offset:256
    v_mfma_f32_16x16x32_bf16 v[72:75], v[92:95], v[168:171], v[72:75]
    ds_read_b64_tr_b16 v[86:87], v15 offset:4352
    s_waitcnt lgkmcnt(6)
    v_mfma_f32_16x16x32_bf16 v[76:79], v[96:99], v[164:167], v[76:79]
    ds_read_b64_tr_b16 v[88:89], v16 offset:288
    v_mfma_f32_16x16x32_bf16 v[80:83], v[96:99], v[168:171], v[80:83]
    ds_read_b64_tr_b16 v[90:91], v16 offset:4384
    s_waitcnt vmcnt(11) lgkmcnt(6)
    v_mfma_f32_16x16x32_bf16 v[20:23], v[100:103], v[188:191], v[20:23]
    ds_read_b64_tr_b16 v[92:93], v15 offset:512
    s_waitcnt vmcnt(10)
    v_mfma_f32_16x16x32_bf16 v[24:27], v[100:103], v[192:195], v[24:27]
    ds_read_b64_tr_b16 v[94:95], v15 offset:4608
    s_waitcnt lgkmcnt(6)
    v_mfma_f32_16x16x32_bf16 v[28:31], v[104:107], v[188:191], v[28:31]
    ds_read_b64_tr_b16 v[96:97], v16 offset:544
    v_mfma_f32_16x16x32_bf16 v[32:35], v[104:107], v[192:195], v[32:35]
    ds_read_b64_tr_b16 v[98:99], v16 offset:4640
    s_add_u32 s23, s21, 0x1000800
    buffer_load_dwordx4 v[156:159], v4, s[8:11], s23 offen offset:0 sc1
    s_waitcnt lgkmcnt(6)
    v_mfma_f32_16x16x32_bf16 v[36:39], v[84:87], v[188:191], v[36:39]
    ds_read_b64_tr_b16 v[100:101], v15 offset:768
    v_mfma_f32_16x16x32_bf16 v[40:43], v[84:87], v[192:195], v[40:43]
    ds_read_b64_tr_b16 v[102:103], v15 offset:4864
    s_waitcnt lgkmcnt(6)
    v_mfma_f32_16x16x32_bf16 v[44:47], v[88:91], v[188:191], v[44:47]
    ds_read_b64_tr_b16 v[104:105], v16 offset:800
    v_mfma_f32_16x16x32_bf16 v[48:51], v[88:91], v[192:195], v[48:51]
    ds_read_b64_tr_b16 v[106:107], v16 offset:4896
    s_waitcnt lgkmcnt(6)
    v_mfma_f32_16x16x32_bf16 v[52:55], v[92:95], v[188:191], v[52:55]
    ds_read_b64_tr_b16 v[84:85], v15 offset:8192
    v_mfma_f32_16x16x32_bf16 v[56:59], v[92:95], v[192:195], v[56:59]
    ds_read_b64_tr_b16 v[86:87], v15 offset:12288
    s_waitcnt lgkmcnt(6)
    v_mfma_f32_16x16x32_bf16 v[60:63], v[96:99], v[188:191], v[60:63]
    ds_read_b64_tr_b16 v[88:89], v16 offset:8224
    v_mfma_f32_16x16x32_bf16 v[64:67], v[96:99], v[192:195], v[64:67]
    ds_read_b64_tr_b16 v[90:91], v16 offset:12320
    s_add_u32 s23, s21, 0x1020800
    buffer_load_dwordx4 v[160:163], v4, s[8:11], s23 offen offset:0 sc1
    s_waitcnt lgkmcnt(6)
    v_mfma_f32_16x16x32_bf16 v[68:71], v[100:103], v[188:191], v[68:71]
    ds_read_b64_tr_b16 v[92:93], v15 offset:8448
    v_mfma_f32_16x16x32_bf16 v[72:75], v[100:103], v[192:195], v[72:75]
    ds_read_b64_tr_b16 v[94:95], v15 offset:12544
    s_waitcnt lgkmcnt(6)
    v_mfma_f32_16x16x32_bf16 v[76:79], v[104:107], v[188:191], v[76:79]
    ds_read_b64_tr_b16 v[96:97], v16 offset:8480
    v_mfma_f32_16x16x32_bf16 v[80:83], v[104:107], v[192:195], v[80:83]
    ds_read_b64_tr_b16 v[98:99], v16 offset:12576
    s_waitcnt vmcnt(11) lgkmcnt(6)
    v_mfma_f32_16x16x32_bf16 v[20:23], v[84:87], v[196:199], v[20:23]
    ds_read_b64_tr_b16 v[100:101], v15 offset:8704
    s_waitcnt vmcnt(10)
    v_mfma_f32_16x16x32_bf16 v[24:27], v[84:87], v[200:203], v[24:27]
    ds_read_b64_tr_b16 v[102:103], v15 offset:12800
    s_waitcnt lgkmcnt(6)
    v_mfma_f32_16x16x32_bf16 v[28:31], v[88:91], v[196:199], v[28:31]
    ds_read_b64_tr_b16 v[104:105], v16 offset:8736
    v_mfma_f32_16x16x32_bf16 v[32:35], v[88:91], v[200:203], v[32:35]
    ds_read_b64_tr_b16 v[106:107], v16 offset:12832
    s_add_u32 s23, s21, 0x1000800
    buffer_load_dwordx4 v[164:167], v4, s[8:11], s23 offen offset:1024 sc1
    s_waitcnt lgkmcnt(6)
    v_mfma_f32_16x16x32_bf16 v[36:39], v[92:95], v[196:199], v[36:39]
    ds_read_b64_tr_b16 v[84:85], v15 offset:8960
    v_mfma_f32_16x16x32_bf16 v[40:43], v[92:95], v[200:203], v[40:43]
    ds_read_b64_tr_b16 v[86:87], v15 offset:13056
    s_waitcnt lgkmcnt(6)
    v_mfma_f32_16x16x32_bf16 v[44:47], v[96:99], v[196:199], v[44:47]
    ds_read_b64_tr_b16 v[88:89], v16 offset:8992
    v_mfma_f32_16x16x32_bf16 v[48:51], v[96:99], v[200:203], v[48:51]
    ds_read_b64_tr_b16 v[90:91], v16 offset:13088
    s_waitcnt lgkmcnt(6)
    v_mfma_f32_16x16x32_bf16 v[52:55], v[100:103], v[196:199], v[52:55]
    v_mfma_f32_16x16x32_bf16 v[56:59], v[100:103], v[200:203], v[56:59]
    s_barrier
    ds_read_b64_tr_b16 v[92:93], v15 offset:16384
    ds_read_b64_tr_b16 v[94:95], v15 offset:20480
    s_waitcnt lgkmcnt(6)
    v_mfma_f32_16x16x32_bf16 v[60:63], v[104:107], v[196:199], v[60:63]
    ds_read_b64_tr_b16 v[96:97], v16 offset:16416
    v_mfma_f32_16x16x32_bf16 v[64:67], v[104:107], v[200:203], v[64:67]
    ds_read_b64_tr_b16 v[98:99], v16 offset:20512
    s_add_u32 s23, s21, 0x1020800
    buffer_load_dwordx4 v[168:171], v4, s[8:11], s23 offen offset:1024 sc1
    s_waitcnt lgkmcnt(6)
    v_mfma_f32_16x16x32_bf16 v[68:71], v[84:87], v[196:199], v[68:71]
    ds_read_b64_tr_b16 v[100:101], v15 offset:16640
    v_mfma_f32_16x16x32_bf16 v[72:75], v[84:87], v[200:203], v[72:75]
    ds_read_b64_tr_b16 v[102:103], v15 offset:20736
    s_waitcnt lgkmcnt(6)
    v_mfma_f32_16x16x32_bf16 v[76:79], v[88:91], v[196:199], v[76:79]
    ds_read_b64_tr_b16 v[104:105], v16 offset:16672
    v_mfma_f32_16x16x32_bf16 v[80:83], v[88:91], v[200:203], v[80:83]
    ds_read_b64_tr_b16 v[106:107], v16 offset:20768
    s_waitcnt vmcnt(11) lgkmcnt(6)
    v_mfma_f32_16x16x32_bf16 v[20:23], v[92:95], v[108:111], v[20:23]
    ds_read_b64_tr_b16 v[84:85], v15 offset:16896
    s_waitcnt vmcnt(10)
    v_mfma_f32_16x16x32_bf16 v[24:27], v[92:95], v[112:115], v[24:27]
    ds_read_b64_tr_b16 v[86:87], v15 offset:20992
    s_waitcnt lgkmcnt(6)
    v_mfma_f32_16x16x32_bf16 v[28:31], v[96:99], v[108:111], v[28:31]
    ds_read_b64_tr_b16 v[88:89], v16 offset:16928
    v_mfma_f32_16x16x32_bf16 v[32:35], v[96:99], v[112:115], v[32:35]
    ds_read_b64_tr_b16 v[90:91], v16 offset:21024
    s_bfe_u32 s21, s42, 0x30010
    s_or_b32 s21, s21, s62
    s_lshl_b32 s21, s21, 12
    s_add_u32 s23, s21, 0x1000000
    buffer_load_dwordx4 v[188:191], v4, s[8:11], s23 offen offset:0 sc1
    s_waitcnt lgkmcnt(6)
    v_mfma_f32_16x16x32_bf16 v[36:39], v[100:103], v[108:111], v[36:39]
    ds_read_b64_tr_b16 v[92:93], v15 offset:17152
    v_mfma_f32_16x16x32_bf16 v[40:43], v[100:103], v[112:115], v[40:43]
    ds_read_b64_tr_b16 v[94:95], v15 offset:21248
    s_waitcnt lgkmcnt(6)
    v_mfma_f32_16x16x32_bf16 v[44:47], v[104:107], v[108:111], v[44:47]
    ds_read_b64_tr_b16 v[96:97], v16 offset:17184
    v_mfma_f32_16x16x32_bf16 v[48:51], v[104:107], v[112:115], v[48:51]
    ds_read_b64_tr_b16 v[98:99], v16 offset:21280
    s_waitcnt lgkmcnt(6)
    v_mfma_f32_16x16x32_bf16 v[52:55], v[84:87], v[108:111], v[52:55]
    ds_read_b64_tr_b16 v[100:101], v15 offset:24576
    v_mfma_f32_16x16x32_bf16 v[56:59], v[84:87], v[112:115], v[56:59]
    ds_read_b64_tr_b16 v[102:103], v15 offset:28672
    s_waitcnt lgkmcnt(6)
    v_mfma_f32_16x16x32_bf16 v[60:63], v[88:91], v[108:111], v[60:63]
    ds_read_b64_tr_b16 v[104:105], v16 offset:24608
    v_mfma_f32_16x16x32_bf16 v[64:67], v[88:91], v[112:115], v[64:67]
    ds_read_b64_tr_b16 v[106:107], v16 offset:28704
    s_add_u32 s23, s21, 0x1020000
    buffer_load_dwordx4 v[192:195], v4, s[8:11], s23 offen offset:0 sc1
    s_waitcnt lgkmcnt(6)
    v_mfma_f32_16x16x32_bf16 v[68:71], v[92:95], v[108:111], v[68:71]
    ds_read_b64_tr_b16 v[84:85], v15 offset:24832
    v_mfma_f32_16x16x32_bf16 v[72:75], v[92:95], v[112:115], v[72:75]
    ds_read_b64_tr_b16 v[86:87], v15 offset:28928
    s_waitcnt lgkmcnt(6)
    v_mfma_f32_16x16x32_bf16 v[76:79], v[96:99], v[108:111], v[76:79]
    ds_read_b64_tr_b16 v[88:89], v16 offset:24864
    v_mfma_f32_16x16x32_bf16 v[80:83], v[96:99], v[112:115], v[80:83]
    ds_read_b64_tr_b16 v[90:91], v16 offset:28960
    s_waitcnt vmcnt(11) lgkmcnt(6)
    v_mfma_f32_16x16x32_bf16 v[20:23], v[100:103], v[116:119], v[20:23]
    ds_read_b64_tr_b16 v[92:93], v15 offset:25088
    s_waitcnt vmcnt(10)
    v_mfma_f32_16x16x32_bf16 v[24:27], v[100:103], v[120:123], v[24:27]
    ds_read_b64_tr_b16 v[94:95], v15 offset:29184
    s_waitcnt lgkmcnt(6)
    v_mfma_f32_16x16x32_bf16 v[28:31], v[104:107], v[116:119], v[28:31]
    ds_read_b64_tr_b16 v[96:97], v16 offset:25120
    v_mfma_f32_16x16x32_bf16 v[32:35], v[104:107], v[120:123], v[32:35]
    ds_read_b64_tr_b16 v[98:99], v16 offset:29216
    s_add_u32 s23, s21, 0x1000000
    buffer_load_dwordx4 v[196:199], v4, s[8:11], s23 offen offset:1024 sc1
    s_waitcnt lgkmcnt(6)
    v_mfma_f32_16x16x32_bf16 v[36:39], v[84:87], v[116:119], v[36:39]
    ds_read_b64_tr_b16 v[100:101], v15 offset:25344
    v_mfma_f32_16x16x32_bf16 v[40:43], v[84:87], v[120:123], v[40:43]
    ds_read_b64_tr_b16 v[102:103], v15 offset:29440
    s_waitcnt lgkmcnt(6)
    v_mfma_f32_16x16x32_bf16 v[44:47], v[88:91], v[116:119], v[44:47]
    ds_read_b64_tr_b16 v[104:105], v16 offset:25376
    v_mfma_f32_16x16x32_bf16 v[48:51], v[88:91], v[120:123], v[48:51]
    ds_read_b64_tr_b16 v[106:107], v16 offset:29472
    s_waitcnt lgkmcnt(6)
    v_mfma_f32_16x16x32_bf16 v[52:55], v[92:95], v[116:119], v[52:55]
    v_mfma_f32_16x16x32_bf16 v[56:59], v[92:95], v[120:123], v[56:59]
    s_barrier
    ds_read_b64_tr_b16 v[84:85], v15 offset:32768
    ds_read_b64_tr_b16 v[86:87], v15 offset:36864
    s_waitcnt lgkmcnt(6)
    v_mfma_f32_16x16x32_bf16 v[60:63], v[96:99], v[116:119], v[60:63]
    ds_read_b64_tr_b16 v[88:89], v16 offset:32800
    v_mfma_f32_16x16x32_bf16 v[64:67], v[96:99], v[120:123], v[64:67]
    ds_read_b64_tr_b16 v[90:91], v16 offset:36896
    s_add_u32 s23, s21, 0x1020000
    buffer_load_dwordx4 v[200:203], v4, s[8:11], s23 offen offset:1024 sc1
    s_waitcnt lgkmcnt(6)
    v_mfma_f32_16x16x32_bf16 v[68:71], v[100:103], v[116:119], v[68:71]
    ds_read_b64_tr_b16 v[92:93], v15 offset:33024
    v_mfma_f32_16x16x32_bf16 v[72:75], v[100:103], v[120:123], v[72:75]
    ds_read_b64_tr_b16 v[94:95], v15 offset:37120
    s_waitcnt lgkmcnt(6)
    v_mfma_f32_16x16x32_bf16 v[76:79], v[104:107], v[116:119], v[76:79]
    ds_read_b64_tr_b16 v[96:97], v16 offset:33056
    v_mfma_f32_16x16x32_bf16 v[80:83], v[104:107], v[120:123], v[80:83]
    ds_read_b64_tr_b16 v[98:99], v16 offset:37152
    s_waitcnt vmcnt(11) lgkmcnt(6)
    v_mfma_f32_16x16x32_bf16 v[20:23], v[84:87], v[140:143], v[20:23]
    ds_read_b64_tr_b16 v[100:101], v15 offset:33280
    s_waitcnt vmcnt(10)
    v_mfma_f32_16x16x32_bf16 v[24:27], v[84:87], v[144:147], v[24:27]
    ds_read_b64_tr_b16 v[102:103], v15 offset:37376
    s_waitcnt lgkmcnt(6)
    v_mfma_f32_16x16x32_bf16 v[28:31], v[88:91], v[140:143], v[28:31]
    ds_read_b64_tr_b16 v[104:105], v16 offset:33312
    v_mfma_f32_16x16x32_bf16 v[32:35], v[88:91], v[144:147], v[32:35]
    ds_read_b64_tr_b16 v[106:107], v16 offset:37408
    s_add_u32 s23, s21, 0x1000800
    buffer_load_dwordx4 v[108:111], v4, s[8:11], s23 offen offset:0 sc1
    s_waitcnt lgkmcnt(6)
    v_mfma_f32_16x16x32_bf16 v[36:39], v[92:95], v[140:143], v[36:39]
    ds_read_b64_tr_b16 v[84:85], v15 offset:33536
    v_mfma_f32_16x16x32_bf16 v[40:43], v[92:95], v[144:147], v[40:43]
    ds_read_b64_tr_b16 v[86:87], v15 offset:37632
    s_waitcnt lgkmcnt(6)
    v_mfma_f32_16x16x32_bf16 v[44:47], v[96:99], v[140:143], v[44:47]
    ds_read_b64_tr_b16 v[88:89], v16 offset:33568
    v_mfma_f32_16x16x32_bf16 v[48:51], v[96:99], v[144:147], v[48:51]
    ds_read_b64_tr_b16 v[90:91], v16 offset:37664
    s_waitcnt lgkmcnt(6)
    v_mfma_f32_16x16x32_bf16 v[52:55], v[100:103], v[140:143], v[52:55]
    ds_read_b64_tr_b16 v[92:93], v15 offset:40960
    v_mfma_f32_16x16x32_bf16 v[56:59], v[100:103], v[144:147], v[56:59]
    ds_read_b64_tr_b16 v[94:95], v15 offset:45056
    s_waitcnt lgkmcnt(6)
    v_mfma_f32_16x16x32_bf16 v[60:63], v[104:107], v[140:143], v[60:63]
    ds_read_b64_tr_b16 v[96:97], v16 offset:40992
    v_mfma_f32_16x16x32_bf16 v[64:67], v[104:107], v[144:147], v[64:67]
    ds_read_b64_tr_b16 v[98:99], v16 offset:45088
    s_add_u32 s23, s21, 0x1020800
    buffer_load_dwordx4 v[112:115], v4, s[8:11], s23 offen offset:0 sc1
    s_waitcnt lgkmcnt(6)
    v_mfma_f32_16x16x32_bf16 v[68:71], v[84:87], v[140:143], v[68:71]
    ds_read_b64_tr_b16 v[100:101], v15 offset:41216
    v_mfma_f32_16x16x32_bf16 v[72:75], v[84:87], v[144:147], v[72:75]
    ds_read_b64_tr_b16 v[102:103], v15 offset:45312
    s_waitcnt lgkmcnt(6)
    v_mfma_f32_16x16x32_bf16 v[76:79], v[88:91], v[140:143], v[76:79]
    ds_read_b64_tr_b16 v[104:105], v16 offset:41248
    v_mfma_f32_16x16x32_bf16 v[80:83], v[88:91], v[144:147], v[80:83]
    ds_read_b64_tr_b16 v[106:107], v16 offset:45344
    s_waitcnt vmcnt(11) lgkmcnt(6)
    v_mfma_f32_16x16x32_bf16 v[20:23], v[92:95], v[148:151], v[20:23]
    ds_read_b64_tr_b16 v[84:85], v15 offset:41472
    s_waitcnt vmcnt(10)
    v_mfma_f32_16x16x32_bf16 v[24:27], v[92:95], v[152:155], v[24:27]
    ds_read_b64_tr_b16 v[86:87], v15 offset:45568
    s_waitcnt lgkmcnt(6)
    v_mfma_f32_16x16x32_bf16 v[28:31], v[96:99], v[148:151], v[28:31]
    ds_read_b64_tr_b16 v[88:89], v16 offset:41504
    v_mfma_f32_16x16x32_bf16 v[32:35], v[96:99], v[152:155], v[32:35]
    ds_read_b64_tr_b16 v[90:91], v16 offset:45600
    s_add_u32 s23, s21, 0x1000800
    buffer_load_dwordx4 v[116:119], v4, s[8:11], s23 offen offset:1024 sc1
    s_waitcnt lgkmcnt(6)
    v_mfma_f32_16x16x32_bf16 v[36:39], v[100:103], v[148:151], v[36:39]
    ds_read_b64_tr_b16 v[92:93], v15 offset:41728
    v_mfma_f32_16x16x32_bf16 v[40:43], v[100:103], v[152:155], v[40:43]
    ds_read_b64_tr_b16 v[94:95], v15 offset:45824
    s_waitcnt lgkmcnt(6)
    v_mfma_f32_16x16x32_bf16 v[44:47], v[104:107], v[148:151], v[44:47]
    ds_read_b64_tr_b16 v[96:97], v16 offset:41760
    v_mfma_f32_16x16x32_bf16 v[48:51], v[104:107], v[152:155], v[48:51]
    ds_read_b64_tr_b16 v[98:99], v16 offset:45856
    s_waitcnt lgkmcnt(6)
    v_mfma_f32_16x16x32_bf16 v[52:55], v[84:87], v[148:151], v[52:55]
    v_mfma_f32_16x16x32_bf16 v[56:59], v[84:87], v[152:155], v[56:59]
    s_barrier
    ds_read_b64_tr_b16 v[100:101], v15 offset:49152
    ds_read_b64_tr_b16 v[102:103], v15 offset:53248
    s_waitcnt lgkmcnt(6)
    v_mfma_f32_16x16x32_bf16 v[60:63], v[88:91], v[148:151], v[60:63]
    ds_read_b64_tr_b16 v[104:105], v16 offset:49184
    v_mfma_f32_16x16x32_bf16 v[64:67], v[88:91], v[152:155], v[64:67]
    ds_read_b64_tr_b16 v[106:107], v16 offset:53280
    s_add_u32 s23, s21, 0x1020800
    buffer_load_dwordx4 v[120:123], v4, s[8:11], s23 offen offset:1024 sc1
    s_waitcnt lgkmcnt(6)
    v_mfma_f32_16x16x32_bf16 v[68:71], v[92:95], v[148:151], v[68:71]
    ds_read_b64_tr_b16 v[84:85], v15 offset:49408
    v_mfma_f32_16x16x32_bf16 v[72:75], v[92:95], v[152:155], v[72:75]
    ds_read_b64_tr_b16 v[86:87], v15 offset:53504
    s_waitcnt lgkmcnt(6)
    v_mfma_f32_16x16x32_bf16 v[76:79], v[96:99], v[148:151], v[76:79]
    ds_read_b64_tr_b16 v[88:89], v16 offset:49440
    v_mfma_f32_16x16x32_bf16 v[80:83], v[96:99], v[152:155], v[80:83]
    ds_read_b64_tr_b16 v[90:91], v16 offset:53536
    s_waitcnt vmcnt(11) lgkmcnt(6)
    v_mfma_f32_16x16x32_bf16 v[20:23], v[100:103], v[156:159], v[20:23]
    ds_read_b64_tr_b16 v[92:93], v15 offset:49664
    s_waitcnt vmcnt(10)
    v_mfma_f32_16x16x32_bf16 v[24:27], v[100:103], v[160:163], v[24:27]
    ds_read_b64_tr_b16 v[94:95], v15 offset:53760
    s_waitcnt lgkmcnt(6)
    v_mfma_f32_16x16x32_bf16 v[28:31], v[104:107], v[156:159], v[28:31]
    ds_read_b64_tr_b16 v[96:97], v16 offset:49696
    v_mfma_f32_16x16x32_bf16 v[32:35], v[104:107], v[160:163], v[32:35]
    ds_read_b64_tr_b16 v[98:99], v16 offset:53792
    s_bfe_u32 s21, s42, 0x30014
    s_or_b32 s21, s21, s62
    s_lshl_b32 s21, s21, 12
    s_add_u32 s23, s21, 0x1000000
    buffer_load_dwordx4 v[140:143], v4, s[8:11], s23 offen offset:0 sc1
    s_waitcnt lgkmcnt(6)
    v_mfma_f32_16x16x32_bf16 v[36:39], v[84:87], v[156:159], v[36:39]
    ds_read_b64_tr_b16 v[100:101], v15 offset:49920
    v_mfma_f32_16x16x32_bf16 v[40:43], v[84:87], v[160:163], v[40:43]
    ds_read_b64_tr_b16 v[102:103], v15 offset:54016
    buffer_load_dword v10, v9, s[8:11], s20 offen sc1
    s_waitcnt lgkmcnt(6)
    v_mfma_f32_16x16x32_bf16 v[44:47], v[88:91], v[156:159], v[44:47]
    ds_read_b64_tr_b16 v[104:105], v16 offset:49952
    v_mfma_f32_16x16x32_bf16 v[48:51], v[88:91], v[160:163], v[48:51]
    ds_read_b64_tr_b16 v[106:107], v16 offset:54048
    s_waitcnt lgkmcnt(6)
    v_mfma_f32_16x16x32_bf16 v[52:55], v[92:95], v[156:159], v[52:55]
    ds_read_b64_tr_b16 v[84:85], v15 offset:57344
    v_mfma_f32_16x16x32_bf16 v[56:59], v[92:95], v[160:163], v[56:59]
    ds_read_b64_tr_b16 v[86:87], v15 offset:61440
    s_waitcnt lgkmcnt(6)
    v_mfma_f32_16x16x32_bf16 v[60:63], v[96:99], v[156:159], v[60:63]
    ds_read_b64_tr_b16 v[88:89], v16 offset:57376
    v_mfma_f32_16x16x32_bf16 v[64:67], v[96:99], v[160:163], v[64:67]
    ds_read_b64_tr_b16 v[90:91], v16 offset:61472
    s_add_u32 s23, s21, 0x1020000
    buffer_load_dwordx4 v[144:147], v4, s[8:11], s23 offen offset:0 sc1
    s_waitcnt lgkmcnt(6)
    v_mfma_f32_16x16x32_bf16 v[68:71], v[100:103], v[156:159], v[68:71]
    ds_read_b64_tr_b16 v[92:93], v15 offset:57600
    v_mfma_f32_16x16x32_bf16 v[72:75], v[100:103], v[160:163], v[72:75]
    ds_read_b64_tr_b16 v[94:95], v15 offset:61696
    s_waitcnt lgkmcnt(6)
    v_mfma_f32_16x16x32_bf16 v[76:79], v[104:107], v[156:159], v[76:79]
    ds_read_b64_tr_b16 v[96:97], v16 offset:57632
    v_mfma_f32_16x16x32_bf16 v[80:83], v[104:107], v[160:163], v[80:83]
    ds_read_b64_tr_b16 v[98:99], v16 offset:61728
    s_waitcnt vmcnt(12) lgkmcnt(6)
    v_mfma_f32_16x16x32_bf16 v[20:23], v[84:87], v[164:167], v[20:23]
    ds_read_b64_tr_b16 v[100:101], v15 offset:57856
    s_waitcnt vmcnt(11)
    v_mfma_f32_16x16x32_bf16 v[24:27], v[84:87], v[168:171], v[24:27]
    ds_read_b64_tr_b16 v[102:103], v15 offset:61952
    s_waitcnt lgkmcnt(6)
    v_mfma_f32_16x16x32_bf16 v[28:31], v[88:91], v[164:167], v[28:31]
    ds_read_b64_tr_b16 v[104:105], v16 offset:57888
    v_mfma_f32_16x16x32_bf16 v[32:35], v[88:91], v[168:171], v[32:35]
    ds_read_b64_tr_b16 v[106:107], v16 offset:61984
    s_add_u32 s23, s21, 0x1000000
    buffer_load_dwordx4 v[148:151], v4, s[8:11], s23 offen offset:1024 sc1
    s_waitcnt lgkmcnt(6)
    v_mfma_f32_16x16x32_bf16 v[36:39], v[92:95], v[164:167], v[36:39]
    ds_read_b64_tr_b16 v[84:85], v15 offset:58112
    v_mfma_f32_16x16x32_bf16 v[40:43], v[92:95], v[168:171], v[40:43]
    ds_read_b64_tr_b16 v[86:87], v15 offset:62208
    s_waitcnt lgkmcnt(6)
    v_mfma_f32_16x16x32_bf16 v[44:47], v[96:99], v[164:167], v[44:47]
    ds_read_b64_tr_b16 v[88:89], v16 offset:58144
    v_mfma_f32_16x16x32_bf16 v[48:51], v[96:99], v[168:171], v[48:51]
    ds_read_b64_tr_b16 v[90:91], v16 offset:62240
    s_waitcnt lgkmcnt(6)
    v_mfma_f32_16x16x32_bf16 v[52:55], v[100:103], v[164:167], v[52:55]
    v_mfma_f32_16x16x32_bf16 v[56:59], v[100:103], v[168:171], v[56:59]
    s_barrier
    ds_read_b64_tr_b16 v[92:93], v3 offset:0
    ds_read_b64_tr_b16 v[94:95], v3 offset:4096
    s_waitcnt lgkmcnt(6)
    v_mfma_f32_16x16x32_bf16 v[60:63], v[104:107], v[164:167], v[60:63]
    ds_read_b64_tr_b16 v[96:97], v2 offset:32
    v_mfma_f32_16x16x32_bf16 v[64:67], v[104:107], v[168:171], v[64:67]
    ds_read_b64_tr_b16 v[98:99], v2 offset:4128
    s_add_u32 s23, s21, 0x1020000
    buffer_load_dwordx4 v[152:155], v4, s[8:11], s23 offen offset:1024 sc1
    s_waitcnt lgkmcnt(6)
    v_mfma_f32_16x16x32_bf16 v[68:71], v[84:87], v[164:167], v[68:71]
    ds_read_b64_tr_b16 v[100:101], v3 offset:256
    v_mfma_f32_16x16x32_bf16 v[72:75], v[84:87], v[168:171], v[72:75]
    ds_read_b64_tr_b16 v[102:103], v3 offset:4352
    s_waitcnt lgkmcnt(6)
    v_mfma_f32_16x16x32_bf16 v[76:79], v[88:91], v[164:167], v[76:79]
    ds_read_b64_tr_b16 v[104:105], v2 offset:288
    v_mfma_f32_16x16x32_bf16 v[80:83], v[88:91], v[168:171], v[80:83]
    ds_read_b64_tr_b16 v[106:107], v2 offset:4384
    s_waitcnt vmcnt(12) lgkmcnt(6)
    v_mfma_f32_16x16x32_bf16 v[20:23], v[92:95], v[188:191], v[20:23]
    ds_read_b64_tr_b16 v[84:85], v3 offset:512
    s_waitcnt vmcnt(11)
    v_mfma_f32_16x16x32_bf16 v[24:27], v[92:95], v[192:195], v[24:27]
    ds_read_b64_tr_b16 v[86:87], v3 offset:4608
    s_waitcnt lgkmcnt(6)
    v_mfma_f32_16x16x32_bf16 v[28:31], v[96:99], v[188:191], v[28:31]
    ds_read_b64_tr_b16 v[88:89], v2 offset:544
    v_mfma_f32_16x16x32_bf16 v[32:35], v[96:99], v[192:195], v[32:35]
    ds_read_b64_tr_b16 v[90:91], v2 offset:4640
    s_add_u32 s23, s21, 0x1000800
    buffer_load_dwordx4 v[156:159], v4, s[8:11], s23 offen offset:0 sc1
    s_waitcnt lgkmcnt(6)
    v_mfma_f32_16x16x32_bf16 v[36:39], v[100:103], v[188:191], v[36:39]
    ds_read_b64_tr_b16 v[92:93], v3 offset:768
    v_mfma_f32_16x16x32_bf16 v[40:43], v[100:103], v[192:195], v[40:43]
    ds_read_b64_tr_b16 v[94:95], v3 offset:4864
    s_waitcnt lgkmcnt(6)
    v_mfma_f32_16x16x32_bf16 v[44:47], v[104:107], v[188:191], v[44:47]
    ds_read_b64_tr_b16 v[96:97], v2 offset:800
    v_mfma_f32_16x16x32_bf16 v[48:51], v[104:107], v[192:195], v[48:51]
    ds_read_b64_tr_b16 v[98:99], v2 offset:4896
    s_waitcnt lgkmcnt(6)
    v_mfma_f32_16x16x32_bf16 v[52:55], v[84:87], v[188:191], v[52:55]
    ds_read_b64_tr_b16 v[100:101], v3 offset:8192
    v_mfma_f32_16x16x32_bf16 v[56:59], v[84:87], v[192:195], v[56:59]
    ds_read_b64_tr_b16 v[102:103], v3 offset:12288
    s_waitcnt lgkmcnt(6)
    v_mfma_f32_16x16x32_bf16 v[60:63], v[88:91], v[188:191], v[60:63]
    ds_read_b64_tr_b16 v[104:105], v2 offset:8224
    v_mfma_f32_16x16x32_bf16 v[64:67], v[88:91], v[192:195], v[64:67]
    ds_read_b64_tr_b16 v[106:107], v2 offset:12320
    s_add_u32 s23, s21, 0x1020800
    buffer_load_dwordx4 v[160:163], v4, s[8:11], s23 offen offset:0 sc1
    s_waitcnt lgkmcnt(6)
    v_mfma_f32_16x16x32_bf16 v[68:71], v[92:95], v[188:191], v[68:71]
    ds_read_b64_tr_b16 v[84:85], v3 offset:8448
    v_mfma_f32_16x16x32_bf16 v[72:75], v[92:95], v[192:195], v[72:75]
    ds_read_b64_tr_b16 v[86:87], v3 offset:12544
    s_waitcnt lgkmcnt(6)
    v_mfma_f32_16x16x32_bf16 v[76:79], v[96:99], v[188:191], v[76:79]
    ds_read_b64_tr_b16 v[88:89], v2 offset:8480
    v_mfma_f32_16x16x32_bf16 v[80:83], v[96:99], v[192:195], v[80:83]
    ds_read_b64_tr_b16 v[90:91], v2 offset:12576
    s_waitcnt vmcnt(12) lgkmcnt(6)
    v_mfma_f32_16x16x32_bf16 v[20:23], v[100:103], v[196:199], v[20:23]
    ds_read_b64_tr_b16 v[92:93], v3 offset:8704
    s_waitcnt vmcnt(11)
    v_mfma_f32_16x16x32_bf16 v[24:27], v[100:103], v[200:203], v[24:27]
    ds_read_b64_tr_b16 v[94:95], v3 offset:12800
    s_waitcnt lgkmcnt(6)
    v_mfma_f32_16x16x32_bf16 v[28:31], v[104:107], v[196:199], v[28:31]
    ds_read_b64_tr_b16 v[96:97], v2 offset:8736
    v_mfma_f32_16x16x32_bf16 v[32:35], v[104:107], v[200:203], v[32:35]
    ds_read_b64_tr_b16 v[98:99], v2 offset:12832
    s_add_u32 s23, s21, 0x1000800
    buffer_load_dwordx4 v[164:167], v4, s[8:11], s23 offen offset:1024 sc1
    s_waitcnt lgkmcnt(6)
    v_mfma_f32_16x16x32_bf16 v[36:39], v[84:87], v[196:199], v[36:39]
    ds_read_b64_tr_b16 v[100:101], v3 offset:8960
    v_mfma_f32_16x16x32_bf16 v[40:43], v[84:87], v[200:203], v[40:43]
    ds_read_b64_tr_b16 v[102:103], v3 offset:13056
    s_waitcnt lgkmcnt(6)
    v_mfma_f32_16x16x32_bf16 v[44:47], v[88:91], v[196:199], v[44:47]
    ds_read_b64_tr_b16 v[104:105], v2 offset:8992
    v_mfma_f32_16x16x32_bf16 v[48:51], v[88:91], v[200:203], v[48:51]
    ds_read_b64_tr_b16 v[106:107], v2 offset:13088
    s_waitcnt lgkmcnt(6)
    v_mfma_f32_16x16x32_bf16 v[52:55], v[92:95], v[196:199], v[52:55]
    v_mfma_f32_16x16x32_bf16 v[56:59], v[92:95], v[200:203], v[56:59]
    s_barrier
    ds_read_b64_tr_b16 v[84:85], v3 offset:16384
    ds_read_b64_tr_b16 v[86:87], v3 offset:20480
    s_waitcnt lgkmcnt(6)
    v_mfma_f32_16x16x32_bf16 v[60:63], v[96:99], v[196:199], v[60:63]
    ds_read_b64_tr_b16 v[88:89], v2 offset:16416
    v_mfma_f32_16x16x32_bf16 v[64:67], v[96:99], v[200:203], v[64:67]
    ds_read_b64_tr_b16 v[90:91], v2 offset:20512
    s_add_u32 s23, s21, 0x1020800
    buffer_load_dwordx4 v[168:171], v4, s[8:11], s23 offen offset:1024 sc1
    s_waitcnt lgkmcnt(6)
    v_mfma_f32_16x16x32_bf16 v[68:71], v[100:103], v[196:199], v[68:71]
    ds_read_b64_tr_b16 v[92:93], v3 offset:16640
    v_mfma_f32_16x16x32_bf16 v[72:75], v[100:103], v[200:203], v[72:75]
    ds_read_b64_tr_b16 v[94:95], v3 offset:20736
    s_waitcnt lgkmcnt(6)
    v_mfma_f32_16x16x32_bf16 v[76:79], v[104:107], v[196:199], v[76:79]
    ds_read_b64_tr_b16 v[96:97], v2 offset:16672
    v_mfma_f32_16x16x32_bf16 v[80:83], v[104:107], v[200:203], v[80:83]
    ds_read_b64_tr_b16 v[98:99], v2 offset:20768
    s_waitcnt vmcnt(7)
    v_cmp_ne_u32 vcc, s14, v10
    s_cbranch_vccz fz_o2gB
    s_mov_b32 s27, 0
fz_o2pB:
    buffer_load_dword v10, v9, s[8:11], s20 offen sc1
    s_waitcnt vmcnt(0)
    v_cmp_ne_u32 vcc, s14, v10
    s_add_u32 s27, s27, 1
    s_cmp_ge_u32 s27, 65536
    s_nop 4
    s_cbranch_scc1 fz_o2gB
    s_cbranch_vccnz fz_o2pB
fz_o2gB:
    s_waitcnt lgkmcnt(6)
    v_mfma_f32_16x16x32_bf16 v[20:23], v[84:87], v[108:111], v[20:23]
    ds_read_b64_tr_b16 v[100:101], v3 offset:16896
    v_mfma_f32_16x16x32_bf16 v[24:27], v[84:87], v[112:115], v[24:27]
    ds_read_b64_tr_b16 v[102:103], v3 offset:20992
    s_waitcnt lgkmcnt(6)
    v_mfma_f32_16x16x32_bf16 v[28:31], v[88:91], v[108:111], v[28:31]
    ds_read_b64_tr_b16 v[104:105], v2 offset:16928
    v_mfma_f32_16x16x32_bf16 v[32:35], v[88:91], v[112:115], v[32:35]
    ds_read_b64_tr_b16 v[106:107], v2 offset:21024
    s_bfe_u32 s21, s42, 0x30018
    s_or_b32 s21, s21, s62
    s_lshl_b32 s21, s21, 12
    s_add_u32 s23, s21, 0x1000000
    buffer_load_dwordx4 v[188:191], v4, s[8:11], s23 offen offset:0 sc1
    s_waitcnt lgkmcnt(6)
    v_mfma_f32_16x16x32_bf16 v[36:39], v[92:95], v[108:111], v[36:39]
    ds_read_b64_tr_b16 v[84:85], v3 offset:17152
    v_mfma_f32_16x16x32_bf16 v[40:43], v[92:95], v[112:115], v[40:43]
    ds_read_b64_tr_b16 v[86:87], v3 offset:21248
    s_waitcnt lgkmcnt(6)
    v_mfma_f32_16x16x32_bf16 v[44:47], v[96:99], v[108:111], v[44:47]
    ds_read_b64_tr_b16 v[88:89], v2 offset:17184
    v_mfma_f32_16x16x32_bf16 v[48:51], v[96:99], v[112:115], v[48:51]
    ds_read_b64_tr_b16 v[90:91], v2 offset:21280
    s_waitcnt lgkmcnt(6)
    v_mfma_f32_16x16x32_bf16 v[52:55], v[100:103], v[108:111], v[52:55]
    ds_read_b64_tr_b16 v[92:93], v3 offset:24576
    v_mfma_f32_16x16x32_bf16 v[56:59], v[100:103], v[112:115], v[56:59]
    ds_read_b64_tr_b16 v[94:95], v3 offset:28672
    s_waitcnt lgkmcnt(6)
    v_mfma_f32_16x16x32_bf16 v[60:63], v[104:107], v[108:111], v[60:63]
    ds_read_b64_tr_b16 v[96:97], v2 offset:24608
    v_mfma_f32_16x16x32_bf16 v[64:67], v[104:107], v[112:115], v[64:67]
    ds_read_b64_tr_b16 v[98:99], v2 offset:28704
    s_add_u32 s23, s21, 0x1020000
    buffer_load_dwordx4 v[192:195], v4, s[8:11], s23 offen offset:0 sc1
    s_waitcnt lgkmcnt(6)
    v_mfma_f32_16x16x32_bf16 v[68:71], v[84:87], v[108:111], v[68:71]
    ds_read_b64_tr_b16 v[100:101], v3 offset:24832
    v_mfma_f32_16x16x32_bf16 v[72:75], v[84:87], v[112:115], v[72:75]
    ds_read_b64_tr_b16 v[102:103], v3 offset:28928
    s_waitcnt lgkmcnt(6)
    v_mfma_f32_16x16x32_bf16 v[76:79], v[88:91], v[108:111], v[76:79]
    ds_read_b64_tr_b16 v[104:105], v2 offset:24864
    v_mfma_f32_16x16x32_bf16 v[80:83], v[88:91], v[112:115], v[80:83]
    ds_read_b64_tr_b16 v[106:107], v2 offset:28960
    s_waitcnt lgkmcnt(6)
    v_mfma_f32_16x16x32_bf16 v[20:23], v[92:95], v[116:119], v[20:23]
    ds_read_b64_tr_b16 v[84:85], v3 offset:25088
    v_mfma_f32_16x16x32_bf16 v[24:27], v[92:95], v[120:123], v[24:27]
    ds_read_b64_tr_b16 v[86:87], v3 offset:29184
    s_waitcnt lgkmcnt(6)
    v_mfma_f32_16x16x32_bf16 v[28:31], v[96:99], v[116:119], v[28:31]
    ds_read_b64_tr_b16 v[88:89], v2 offset:25120
    v_mfma_f32_16x16x32_bf16 v[32:35], v[96:99], v[120:123], v[32:35]
    ds_read_b64_tr_b16 v[90:91], v2 offset:29216
    s_add_u32 s23, s21, 0x1000000
    buffer_load_dwordx4 v[196:199], v4, s[8:11], s23 offen offset:1024 sc1
    s_waitcnt lgkmcnt(6)
    v_mfma_f32_16x16x32_bf16 v[36:39], v[100:103], v[116:119], v[36:39]
    ds_read_b64_tr_b16 v[92:93], v3 offset:25344
    v_mfma_f32_16x16x32_bf16 v[40:43], v[100:103], v[120:123], v[40:43]
    ds_read_b64_tr_b16 v[94:95], v3 offset:29440
    s_waitcnt lgkmcnt(6)
    v_mfma_f32_16x16x32_bf16 v[44:47], v[104:107], v[116:119], v[44:47]
    ds_read_b64_tr_b16 v[96:97], v2 offset:25376
    v_mfma_f32_16x16x32_bf16 v[48:51], v[104:107], v[120:123], v[48:51]
    ds_read_b64_tr_b16 v[98:99], v2 offset:29472
    s_waitcnt lgkmcnt(6)
    v_mfma_f32_16x16x32_bf16 v[52:55], v[84:87], v[116:119], v[52:55]
    v_mfma_f32_16x16x32_bf16 v[56:59], v[84:87], v[120:123], v[56:59]
    s_barrier
    ds_read_b64_tr_b16 v[100:101], v3 offset:32768
    ds_read_b64_tr_b16 v[102:103], v3 offset:36864
    s_waitcnt lgkmcnt(6)
    v_mfma_f32_16x16x32_bf16 v[60:63], v[88:91], v[116:119], v[60:63]
    ds_read_b64_tr_b16 v[104:105], v2 offset:32800
    v_mfma_f32_16x16x32_bf16 v[64:67], v[88:91], v[120:123], v[64:67]
    ds_read_b64_tr_b16 v[106:107], v2 offset:36896
    s_add_u32 s23, s21, 0x1020000
    buffer_load_dwordx4 v[200:203], v4, s[8:11], s23 offen offset:1024 sc1
    s_waitcnt lgkmcnt(6)
    v_mfma_f32_16x16x32_bf16 v[68:71], v[92:95], v[116:119], v[68:71]
    ds_read_b64_tr_b16 v[84:85], v3 offset:33024
    v_mfma_f32_16x16x32_bf16 v[72:75], v[92:95], v[120:123], v[72:75]
    ds_read_b64_tr_b16 v[86:87], v3 offset:37120
    s_waitcnt lgkmcnt(6)
    v_mfma_f32_16x16x32_bf16 v[76:79], v[96:99], v[116:119], v[76:79]
    ds_read_b64_tr_b16 v[88:89], v2 offset:33056
    v_mfma_f32_16x16x32_bf16 v[80:83], v[96:99], v[120:123], v[80:83]
    ds_read_b64_tr_b16 v[90:91], v2 offset:37152
    s_waitcnt lgkmcnt(6)
    v_mfma_f32_16x16x32_bf16 v[20:23], v[100:103], v[140:143], v[20:23]
    ds_read_b64_tr_b16 v[92:93], v3 offset:33280
    s_waitcnt vmcnt(10)
    v_mfma_f32_16x16x32_bf16 v[24:27], v[100:103], v[144:147], v[24:27]
    ds_read_b64_tr_b16 v[94:95], v3 offset:37376
    s_waitcnt lgkmcnt(6)
    v_mfma_f32_16x16x32_bf16 v[28:31], v[104:107], v[140:143], v[28:31]
    ds_read_b64_tr_b16 v[96:97], v2 offset:33312
    v_mfma_f32_16x16x32_bf16 v[32:35], v[104:107], v[144:147], v[32:35]
    ds_read_b64_tr_b16 v[98:99], v2 offset:37408
    s_add_u32 s23, s21, 0x1000800
    buffer_load_dwordx4 v[108:111], v4, s[8:11], s23 offen offset:0 sc1
    s_waitcnt lgkmcnt(6)
    v_mfma_f32_16x16x32_bf16 v[36:39], v[84:87], v[140:143], v[36:39]
    ds_read_b64_tr_b16 v[100:101], v3 offset:33536
    v_mfma_f32_16x16x32_bf16 v[40:43], v[84:87], v[144:147], v[40:43]
    ds_read_b64_tr_b16 v[102:103], v3 offset:37632
    s_waitcnt lgkmcnt(6)
    v_mfma_f32_16x16x32_bf16 v[44:47], v[88:91], v[140:143], v[44:47]
    ds_read_b64_tr_b16 v[104:105], v2 offset:33568
    v_mfma_f32_16x16x32_bf16 v[48:51], v[88:91], v[144:147], v[48:51]
    ds_read_b64_tr_b16 v[106:107], v2 offset:37664
    s_waitcnt lgkmcnt(6)
    v_mfma_f32_16x16x32_bf16 v[52:55], v[92:95], v[140:143], v[52:55]
    ds_read_b64_tr_b16 v[84:85], v3 offset:40960
    v_mfma_f32_16x16x32_bf16 v[56:59], v[92:95], v[144:147], v[56:59]
    ds_read_b64_tr_b16 v[86:87], v3 offset:45056
    s_waitcnt lgkmcnt(6)
    v_mfma_f32_16x16x32_bf16 v[60:63], v[96:99], v[140:143], v[60:63]
    ds_read_b64_tr_b16 v[88:89], v2 offset:40992
    v_mfma_f32_16x16x32_bf16 v[64:67], v[96:99], v[144:147], v[64:67]
    ds_read_b64_tr_b16 v[90:91], v2 offset:45088
    s_add_u32 s23, s21, 0x1020800
    buffer_load_dwordx4 v[112:115], v4, s[8:11], s23 offen offset:0 sc1
    s_waitcnt lgkmcnt(6)
    v_mfma_f32_16x16x32_bf16 v[68:71], v[100:103], v[140:143], v[68:71]
    ds_read_b64_tr_b16 v[92:93], v3 offset:41216
    v_mfma_f32_16x16x32_bf16 v[72:75], v[100:103], v[144:147], v[72:75]
    ds_read_b64_tr_b16 v[94:95], v3 offset:45312
    s_waitcnt lgkmcnt(6)
    v_mfma_f32_16x16x32_bf16 v[76:79], v[104:107], v[140:143], v[76:79]
    ds_read_b64_tr_b16 v[96:97], v2 offset:41248
    v_mfma_f32_16x16x32_bf16 v[80:83], v[104:107], v[144:147], v[80:83]
    ds_read_b64_tr_b16 v[98:99], v2 offset:45344
    s_waitcnt vmcnt(11) lgkmcnt(6)
    v_mfma_f32_16x16x32_bf16 v[20:23], v[84:87], v[148:151], v[20:23]
    ds_read_b64_tr_b16 v[100:101], v3 offset:41472
    s_waitcnt vmcnt(10)
    v_mfma_f32_16x16x32_bf16 v[24:27], v[84:87], v[152:155], v[24:27]
    ds_read_b64_tr_b16 v[102:103], v3 offset:45568
    s_waitcnt lgkmcnt(6)
    v_mfma_f32_16x16x32_bf16 v[28:31], v[88:91], v[148:151], v[28:31]
    ds_read_b64_tr_b16 v[104:105], v2 offset:41504
    v_mfma_f32_16x16x32_bf16 v[32:35], v[88:91], v[152:155], v[32:35]
    ds_read_b64_tr_b16 v[106:107], v2 offset:45600
    s_add_u32 s23, s21, 0x1000800
    buffer_load_dwordx4 v[116:119], v4, s[8:11], s23 offen offset:1024 sc1
    s_waitcnt lgkmcnt(6)
    v_mfma_f32_16x16x32_bf16 v[36:39], v[92:95], v[148:151], v[36:39]
    ds_read_b64_tr_b16 v[84:85], v3 offset:41728
    v_mfma_f32_16x16x32_bf16 v[40:43], v[92:95], v[152:155], v[40:43]
    ds_read_b64_tr_b16 v[86:87], v3 offset:45824
    s_waitcnt lgkmcnt(6)
    v_mfma_f32_16x16x32_bf16 v[44:47], v[96:99], v[148:151], v[44:47]
    ds_read_b64_tr_b16 v[88:89], v2 offset:41760
    v_mfma_f32_16x16x32_bf16 v[48:51], v[96:99], v[152:155], v[48:51]
    ds_read_b64_tr_b16 v[90:91], v2 offset:45856
    s_waitcnt lgkmcnt(6)
    v_mfma_f32_16x16x32_bf16 v[52:55], v[100:103], v[148:151], v[52:55]
    v_mfma_f32_16x16x32_bf16 v[56:59], v[100:103], v[152:155], v[56:59]
    s_barrier
    ds_read_b64_tr_b16 v[92:93], v3 offset:49152
    ds_read_b64_tr_b16 v[94:95], v3 offset:53248
    s_waitcnt lgkmcnt(6)
    v_mfma_f32_16x16x32_bf16 v[60:63], v[104:107], v[148:151], v[60:63]
    ds_read_b64_tr_b16 v[96:97], v2 offset:49184
    v_mfma_f32_16x16x32_bf16 v[64:67], v[104:107], v[152:155], v[64:67]
    ds_read_b64_tr_b16 v[98:99], v2 offset:53280
    s_add_u32 s23, s21, 0x1020800
    buffer_load_dwordx4 v[120:123], v4, s[8:11], s23 offen offset:1024 sc1
    s_waitcnt lgkmcnt(6)
    v_mfma_f32_16x16x32_bf16 v[68:71], v[84:87], v[148:151], v[68:71]
    ds_read_b64_tr_b16 v[100:101], v3 offset:49408
    v_mfma_f32_16x16x32_bf16 v[72:75], v[84:87], v[152:155], v[72:75]
    ds_read_b64_tr_b16 v[102:103], v3 offset:53504
    s_waitcnt lgkmcnt(6)
    v_mfma_f32_16x16x32_bf16 v[76:79], v[88:91], v[148:151], v[76:79]
    ds_read_b64_tr_b16 v[104:105], v2 offset:49440
    v_mfma_f32_16x16x32_bf16 v[80:83], v[88:91], v[152:155], v[80:83]
    ds_read_b64_tr_b16 v[106:107], v2 offset:53536
    s_waitcnt vmcnt(11) lgkmcnt(6)
    v_mfma_f32_16x16x32_bf16 v[20:23], v[92:95], v[156:159], v[20:23]
    ds_read_b64_tr_b16 v[84:85], v3 offset:49664
    s_waitcnt vmcnt(10)
    v_mfma_f32_16x16x32_bf16 v[24:27], v[92:95], v[160:163], v[24:27]
    ds_read_b64_tr_b16 v[86:87], v3 offset:53760
    s_waitcnt lgkmcnt(6)
    v_mfma_f32_16x16x32_bf16 v[28:31], v[96:99], v[156:159], v[28:31]
    ds_read_b64_tr_b16 v[88:89], v2 offset:49696
    v_mfma_f32_16x16x32_bf16 v[32:35], v[96:99], v[160:163], v[32:35]
    ds_read_b64_tr_b16 v[90:91], v2 offset:53792
    s_bfe_u32 s21, s42, 0x3001c
    s_or_b32 s21, s21, s62
    s_lshl_b32 s21, s21, 12
    s_add_u32 s23, s21, 0x1000000
    buffer_load_dwordx4 v[140:143], v4, s[8:11], s23 offen offset:0 sc1
    s_waitcnt lgkmcnt(6)
    v_mfma_f32_16x16x32_bf16 v[36:39], v[100:103], v[156:159], v[36:39]
    ds_read_b64_tr_b16 v[92:93], v3 offset:49920
    v_mfma_f32_16x16x32_bf16 v[40:43], v[100:103], v[160:163], v[40:43]
    ds_read_b64_tr_b16 v[94:95], v3 offset:54016
    s_waitcnt lgkmcnt(6)
    v_mfma_f32_16x16x32_bf16 v[44:47], v[104:107], v[156:159], v[44:47]
    ds_read_b64_tr_b16 v[96:97], v2 offset:49952
    v_mfma_f32_16x16x32_bf16 v[48:51], v[104:107], v[160:163], v[48:51]
    ds_read_b64_tr_b16 v[98:99], v2 offset:54048
    s_waitcnt lgkmcnt(6)
    v_mfma_f32_16x16x32_bf16 v[52:55], v[84:87], v[156:159], v[52:55]
    ds_read_b64_tr_b16 v[100:101], v3 offset:57344
    v_mfma_f32_16x16x32_bf16 v[56:59], v[84:87], v[160:163], v[56:59]
    ds_read_b64_tr_b16 v[102:103], v3 offset:61440
    s_waitcnt lgkmcnt(6)
    v_mfma_f32_16x16x32_bf16 v[60:63], v[88:91], v[156:159], v[60:63]
    ds_read_b64_tr_b16 v[104:105], v2 offset:57376
    v_mfma_f32_16x16x32_bf16 v[64:67], v[88:91], v[160:163], v[64:67]
    ds_read_b64_tr_b16 v[106:107], v2 offset:61472
    s_add_u32 s23, s21, 0x1020000
    buffer_load_dwordx4 v[144:147], v4, s[8:11], s23 offen offset:0 sc1
    s_waitcnt lgkmcnt(6)
    v_mfma_f32_16x16x32_bf16 v[68:71], v[92:95], v[156:159], v[68:71]
    ds_read_b64_tr_b16 v[84:85], v3 offset:57600
    v_mfma_f32_16x16x32_bf16 v[72:75], v[92:95], v[160:163], v[72:75]
    ds_read_b64_tr_b16 v[86:87], v3 offset:61696
    s_waitcnt lgkmcnt(6)
    v_mfma_f32_16x16x32_bf16 v[76:79], v[96:99], v[156:159], v[76:79]
    ds_read_b64_tr_b16 v[88:89], v2 offset:57632
    v_mfma_f32_16x16x32_bf16 v[80:83], v[96:99], v[160:163], v[80:83]
    ds_read_b64_tr_b16 v[90:91], v2 offset:61728
    s_waitcnt vmcnt(11) lgkmcnt(6)
    v_mfma_f32_16x16x32_bf16 v[20:23], v[100:103], v[164:167], v[20:23]
    ds_read_b64_tr_b16 v[92:93], v3 offset:57856
    s_waitcnt vmcnt(10)
    v_mfma_f32_16x16x32_bf16 v[24:27], v[100:103], v[168:171], v[24:27]
    ds_read_b64_tr_b16 v[94:95], v3 offset:61952
    s_waitcnt lgkmcnt(6)
    v_mfma_f32_16x16x32_bf16 v[28:31], v[104:107], v[164:167], v[28:31]
    ds_read_b64_tr_b16 v[96:97], v2 offset:57888
    v_mfma_f32_16x16x32_bf16 v[32:35], v[104:107], v[168:171], v[32:35]
    ds_read_b64_tr_b16 v[98:99], v2 offset:61984
    s_add_u32 s23, s21, 0x1000000
    buffer_load_dwordx4 v[148:151], v4, s[8:11], s23 offen offset:1024 sc1
    s_waitcnt lgkmcnt(6)
    v_mfma_f32_16x16x32_bf16 v[36:39], v[84:87], v[164:167], v[36:39]
    ds_read_b64_tr_b16 v[100:101], v3 offset:58112
    v_mfma_f32_16x16x32_bf16 v[40:43], v[84:87], v[168:171], v[40:43]
    ds_read_b64_tr_b16 v[102:103], v3 offset:62208
    s_waitcnt lgkmcnt(6)
    v_mfma_f32_16x16x32_bf16 v[44:47], v[88:91], v[164:167], v[44:47]
    ds_read_b64_tr_b16 v[104:105], v2 offset:58144
    v_mfma_f32_16x16x32_bf16 v[48:51], v[88:91], v[168:171], v[48:51]
    ds_read_b64_tr_b16 v[106:107], v2 offset:62240
    s_waitcnt lgkmcnt(6)
    v_mfma_f32_16x16x32_bf16 v[52:55], v[92:95], v[164:167], v[52:55]
    v_mfma_f32_16x16x32_bf16 v[56:59], v[92:95], v[168:171], v[56:59]
    s_barrier
    ds_read_b64_tr_b16 v[84:85], v15 offset:0
    ds_read_b64_tr_b16 v[86:87], v15 offset:4096
    s_waitcnt lgkmcnt(6)
    v_mfma_f32_16x16x32_bf16 v[60:63], v[96:99], v[164:167], v[60:63]
    ds_read_b64_tr_b16 v[88:89], v16 offset:32
    v_mfma_f32_16x16x32_bf16 v[64:67], v[96:99], v[168:171], v[64:67]
    ds_read_b64_tr_b16 v[90:91], v16 offset:4128
    s_add_u32 s23, s21, 0x1020000
    buffer_load_dwordx4 v[152:155], v4, s[8:11], s23 offen offset:1024 sc1
    s_waitcnt lgkmcnt(6)
    v_mfma_f32_16x16x32_bf16 v[68:71], v[100:103], v[164:167], v[68:71]
    ds_read_b64_tr_b16 v[92:93], v15 offset:256
    v_mfma_f32_16x16x32_bf16 v[72:75], v[100:103], v[168:171], v[72:75]
    ds_read_b64_tr_b16 v[94:95], v15 offset:4352
    s_waitcnt lgkmcnt(6)
    v_mfma_f32_16x16x32_bf16 v[76:79], v[104:107], v[164:167], v[76:79]
    ds_read_b64_tr_b16 v[96:97], v16 offset:288
    v_mfma_f32_16x16x32_bf16 v[80:83], v[104:107], v[168:171], v[80:83]
    ds_read_b64_tr_b16 v[98:99], v16 offset:4384
    s_waitcnt vmcnt(11) lgkmcnt(6)
    v_mfma_f32_16x16x32_bf16 v[20:23], v[84:87], v[188:191], v[20:23]
    ds_read_b64_tr_b16 v[100:101], v15 offset:512
    s_waitcnt vmcnt(10)
    v_mfma_f32_16x16x32_bf16 v[24:27], v[84:87], v[192:195], v[24:27]
    ds_read_b64_tr_b16 v[102:103], v15 offset:4608
    s_waitcnt lgkmcnt(6)
    v_mfma_f32_16x16x32_bf16 v[28:31], v[88:91], v[188:191], v[28:31]
    ds_read_b64_tr_b16 v[104:105], v16 offset:544
    v_mfma_f32_16x16x32_bf16 v[32:35], v[88:91], v[192:195], v[32:35]
    ds_read_b64_tr_b16 v[106:107], v16 offset:4640
    s_add_u32 s23, s21, 0x1000800
    buffer_load_dwordx4 v[156:159], v4, s[8:11], s23 offen offset:0 sc1
    s_waitcnt lgkmcnt(6)
    v_mfma_f32_16x16x32_bf16 v[36:39], v[92:95], v[188:191], v[36:39]
    ds_read_b64_tr_b16 v[84:85], v15 offset:768
    v_mfma_f32_16x16x32_bf16 v[40:43], v[92:95], v[192:195], v[40:43]
    ds_read_b64_tr_b16 v[86:87], v15 offset:4864
    s_waitcnt lgkmcnt(6)
    v_mfma_f32_16x16x32_bf16 v[44:47], v[96:99], v[188:191], v[44:47]
    ds_read_b64_tr_b16 v[88:89], v16 offset:800
    v_mfma_f32_16x16x32_bf16 v[48:51], v[96:99], v[192:195], v[48:51]
    ds_read_b64_tr_b16 v[90:91], v16 offset:4896
    s_waitcnt lgkmcnt(6)
    v_mfma_f32_16x16x32_bf16 v[52:55], v[100:103], v[188:191], v[52:55]
    ds_read_b64_tr_b16 v[92:93], v15 offset:8192
    v_mfma_f32_16x16x32_bf16 v[56:59], v[100:103], v[192:195], v[56:59]
    ds_read_b64_tr_b16 v[94:95], v15 offset:12288
    s_waitcnt lgkmcnt(6)
    v_mfma_f32_16x16x32_bf16 v[60:63], v[104:107], v[188:191], v[60:63]
    ds_read_b64_tr_b16 v[96:97], v16 offset:8224
    v_mfma_f32_16x16x32_bf16 v[64:67], v[104:107], v[192:195], v[64:67]
    ds_read_b64_tr_b16 v[98:99], v16 offset:12320
    s_add_u32 s23, s21, 0x1020800
    buffer_load_dwordx4 v[160:163], v4, s[8:11], s23 offen offset:0 sc1
    s_waitcnt lgkmcnt(6)
    v_mfma_f32_16x16x32_bf16 v[68:71], v[84:87], v[188:191], v[68:71]
    ds_read_b64_tr_b16 v[100:101], v15 offset:8448
    v_mfma_f32_16x16x32_bf16 v[72:75], v[84:87], v[192:195], v[72:75]
    ds_read_b64_tr_b16 v[102:103], v15 offset:12544
    s_waitcnt lgkmcnt(6)
    v_mfma_f32_16x16x32_bf16 v[76:79], v[88:91], v[188:191], v[76:79]
    ds_read_b64_tr_b16 v[104:105], v16 offset:8480
    v_mfma_f32_16x16x32_bf16 v[80:83], v[88:91], v[192:195], v[80:83]
    ds_read_b64_tr_b16 v[106:107], v16 offset:12576
    s_waitcnt vmcnt(11) lgkmcnt(6)
    v_mfma_f32_16x16x32_bf16 v[20:23], v[92:95], v[196:199], v[20:23]
    ds_read_b64_tr_b16 v[84:85], v15 offset:8704
    s_waitcnt vmcnt(10)
    v_mfma_f32_16x16x32_bf16 v[24:27], v[92:95], v[200:203], v[24:27]
    ds_read_b64_tr_b16 v[86:87], v15 offset:12800
    s_waitcnt lgkmcnt(6)
    v_mfma_f32_16x16x32_bf16 v[28:31], v[96:99], v[196:199], v[28:31]
    ds_read_b64_tr_b16 v[88:89], v16 offset:8736
    v_mfma_f32_16x16x32_bf16 v[32:35], v[96:99], v[200:203], v[32:35]
    ds_read_b64_tr_b16 v[90:91], v16 offset:12832
    s_add_u32 s23, s21, 0x1000800
    buffer_load_dwordx4 v[164:167], v4, s[8:11], s23 offen offset:1024 sc1
    s_waitcnt lgkmcnt(6)
    v_mfma_f32_16x16x32_bf16 v[36:39], v[100:103], v[196:199], v[36:39]
    ds_read_b64_tr_b16 v[92:93], v15 offset:8960
    v_mfma_f32_16x16x32_bf16 v[40:43], v[100:103], v[200:203], v[40:43]
    ds_read_b64_tr_b16 v[94:95], v15 offset:13056
    s_waitcnt lgkmcnt(6)
    v_mfma_f32_16x16x32_bf16 v[44:47], v[104:107], v[196:199], v[44:47]
    ds_read_b64_tr_b16 v[96:97], v16 offset:8992
    v_mfma_f32_16x16x32_bf16 v[48:51], v[104:107], v[200:203], v[48:51]
    ds_read_b64_tr_b16 v[98:99], v16 offset:13088
    s_waitcnt lgkmcnt(6)
    v_mfma_f32_16x16x32_bf16 v[52:55], v[84:87], v[196:199], v[52:55]
    ds_read_b64_tr_b16 v[100:101], v15 offset:16384
    v_mfma_f32_16x16x32_bf16 v[56:59], v[84:87], v[200:203], v[56:59]
    ds_read_b64_tr_b16 v[102:103], v15 offset:20480
    s_waitcnt lgkmcnt(6)
    v_mfma_f32_16x16x32_bf16 v[60:63], v[88:91], v[196:199], v[60:63]
    ds_read_b64_tr_b16 v[104:105], v16 offset:16416
    v_mfma_f32_16x16x32_bf16 v[64:67], v[88:91], v[200:203], v[64:67]
    ds_read_b64_tr_b16 v[106:107], v16 offset:20512
    s_add_u32 s23, s21, 0x1020800
    buffer_load_dwordx4 v[168:171], v4, s[8:11], s23 offen offset:1024 sc1
    s_waitcnt lgkmcnt(6)
    v_mfma_f32_16x16x32_bf16 v[68:71], v[92:95], v[196:199], v[68:71]
    ds_read_b64_tr_b16 v[84:85], v15 offset:24576
    v_mfma_f32_16x16x32_bf16 v[72:75], v[92:95], v[200:203], v[72:75]
    ds_read_b64_tr_b16 v[86:87], v15 offset:28672
    s_waitcnt lgkmcnt(6)
    v_mfma_f32_16x16x32_bf16 v[76:79], v[96:99], v[196:199], v[76:79]
    ds_read_b64_tr_b16 v[88:89], v16 offset:24608
    v_mfma_f32_16x16x32_bf16 v[80:83], v[96:99], v[200:203], v[80:83]
    ds_read_b64_tr_b16 v[90:91], v16 offset:28704
    s_waitcnt vmcnt(11) lgkmcnt(6)
    v_mfma_f32_16x16x32_bf16 v[20:23], v[100:103], v[108:111], v[20:23]
    ds_read_b64_tr_b16 v[92:93], v15 offset:32768
    s_waitcnt vmcnt(10)
    v_mfma_f32_16x16x32_bf16 v[24:27], v[100:103], v[112:115], v[24:27]
    ds_read_b64_tr_b16 v[94:95], v15 offset:36864
    s_waitcnt lgkmcnt(6)
    v_mfma_f32_16x16x32_bf16 v[28:31], v[104:107], v[108:111], v[28:31]
    ds_read_b64_tr_b16 v[96:97], v16 offset:32800
    v_mfma_f32_16x16x32_bf16 v[32:35], v[104:107], v[112:115], v[32:35]
    ds_read_b64_tr_b16 v[98:99], v16 offset:36896
    s_waitcnt vmcnt(9) lgkmcnt(6)
    v_mfma_f32_16x16x32_bf16 v[20:23], v[84:87], v[116:119], v[20:23]
    ds_read_b64_tr_b16 v[100:101], v15 offset:40960
    s_waitcnt vmcnt(8)
    v_mfma_f32_16x16x32_bf16 v[24:27], v[84:87], v[120:123], v[24:27]
    ds_read_b64_tr_b16 v[102:103], v15 offset:45056
    s_waitcnt lgkmcnt(6)
    v_mfma_f32_16x16x32_bf16 v[28:31], v[88:91], v[116:119], v[28:31]
    ds_read_b64_tr_b16 v[104:105], v16 offset:40992
    v_mfma_f32_16x16x32_bf16 v[32:35], v[88:91], v[120:123], v[32:35]
    ds_read_b64_tr_b16 v[106:107], v16 offset:45088
    s_waitcnt vmcnt(7) lgkmcnt(6)
    v_mfma_f32_16x16x32_bf16 v[20:23], v[92:95], v[140:143], v[20:23]
    ds_read_b64_tr_b16 v[84:85], v15 offset:49152
    s_waitcnt vmcnt(6)
    v_mfma_f32_16x16x32_bf16 v[24:27], v[92:95], v[144:147], v[24:27]
    ds_read_b64_tr_b16 v[86:87], v15 offset:53248
    s_waitcnt lgkmcnt(6)
    v_mfma_f32_16x16x32_bf16 v[28:31], v[96:99], v[140:143], v[28:31]
    ds_read_b64_tr_b16 v[88:89], v16 offset:49184
    v_mfma_f32_16x16x32_bf16 v[32:35], v[96:99], v[144:147], v[32:35]
    ds_read_b64_tr_b16 v[90:91], v16 offset:53280
    s_waitcnt vmcnt(5) lgkmcnt(6)
    v_mfma_f32_16x16x32_bf16 v[20:23], v[100:103], v[148:151], v[20:23]
    ds_read_b64_tr_b16 v[92:93], v15 offset:57344
    s_waitcnt vmcnt(4)
    v_mfma_f32_16x16x32_bf16 v[24:27], v[100:103], v[152:155], v[24:27]
    ds_read_b64_tr_b16 v[94:95], v15 offset:61440
    s_waitcnt lgkmcnt(6)
    v_mfma_f32_16x16x32_bf16 v[28:31], v[104:107], v[148:151], v[28:31]
    ds_read_b64_tr_b16 v[96:97], v16 offset:57376
    v_mfma_f32_16x16x32_bf16 v[32:35], v[104:107], v[152:155], v[32:35]
    ds_read_b64_tr_b16 v[98:99], v16 offset:61472
    s_waitcnt vmcnt(3) lgkmcnt(6)
    v_mfma_f32_16x16x32_bf16 v[20:23], v[84:87], v[156:159], v[20:23]
    ds_read_b64_tr_b16 v[100:101], v15 offset:16640
    s_waitcnt vmcnt(2)
    v_mfma_f32_16x16x32_bf16 v[24:27], v[84:87], v[160:163], v[24:27]
    ds_read_b64_tr_b16 v[102:103], v15 offset:20736
    s_waitcnt lgkmcnt(6)
    v_mfma_f32_16x16x32_bf16 v[28:31], v[88:91], v[156:159], v[28:31]
    ds_read_b64_tr_b16 v[104:105], v16 offset:16672
    v_mfma_f32_16x16x32_bf16 v[32:35], v[88:91], v[160:163], v[32:35]
    ds_read_b64_tr_b16 v[106:107], v16 offset:20768
    s_waitcnt vmcnt(1) lgkmcnt(6)
    v_mfma_f32_16x16x32_bf16 v[20:23], v[92:95], v[164:167], v[20:23]
    ds_read_b64_tr_b16 v[84:85], v15 offset:24832
    s_waitcnt vmcnt(0)
    v_mfma_f32_16x16x32_bf16 v[24:27], v[92:95], v[168:171], v[24:27]
    ds_read_b64_tr_b16 v[86:87], v15 offset:28928
    s_waitcnt lgkmcnt(6)
    v_mfma_f32_16x16x32_bf16 v[28:31], v[96:99], v[164:167], v[28:31]
    ds_read_b64_tr_b16 v[88:89], v16 offset:24864
    v_mfma_f32_16x16x32_bf16 v[32:35], v[96:99], v[168:171], v[32:35]
    ds_read_b64_tr_b16 v[90:91], v16 offset:28960
    ds_read_b128 v[124:127], v13 offset:0
    ds_read_b128 v[128:131], v13 offset:64
    s_waitcnt lgkmcnt(8)
    v_mfma_f32_16x16x32_bf16 v[36:39], v[100:103], v[108:111], v[36:39]
    ds_read_b64_tr_b16 v[92:93], v15 offset:33024
    v_mfma_f32_16x16x32_bf16 v[40:43], v[100:103], v[112:115], v[40:43]
    ds_read_b64_tr_b16 v[94:95], v15 offset:37120
    s_waitcnt lgkmcnt(8)
    v_mfma_f32_16x16x32_bf16 v[44:47], v[104:107], v[108:111], v[44:47]
    ds_read_b64_tr_b16 v[96:97], v16 offset:33056
    v_mfma_f32_16x16x32_bf16 v[48:51], v[104:107], v[112:115], v[48:51]
    ds_read_b64_tr_b16 v[98:99], v16 offset:37152
    s_waitcnt lgkmcnt(8)
    v_mfma_f32_16x16x32_bf16 v[36:39], v[84:87], v[116:119], v[36:39]
    s_waitcnt lgkmcnt(5)
    v_pk_mul_f32 v[132:133], v[20:21], v[124:125]
    v_pk_mul_f32 v[134:135], v[22:23], v[126:127]
    ds_read_b64_tr_b16 v[100:101], v15 offset:41216
    v_mfma_f32_16x16x32_bf16 v[40:43], v[84:87], v[120:123], v[40:43]
    s_waitcnt lgkmcnt(5)
    v_pk_mul_f32 v[136:137], v[28:29], v[128:129]
    ds_read_b64_tr_b16 v[102:103], v15 offset:45312
    v_mfma_f32_16x16x32_bf16 v[44:47], v[88:91], v[116:119], v[44:47]
    v_pk_mul_f32 v[138:139], v[30:31], v[130:131]
    v_cvt_pk_bf16_f32 v132, v132, v133
    ds_read_b64_tr_b16 v[104:105], v16 offset:41248
    v_mfma_f32_16x16x32_bf16 v[48:51], v[88:91], v[120:123], v[48:51]
    v_cvt_pk_bf16_f32 v133, v134, v135
    ds_read_b64_tr_b16 v[106:107], v16 offset:45344
    s_waitcnt lgkmcnt(6)
    v_mfma_f32_16x16x32_bf16 v[36:39], v[92:95], v[140:143], v[36:39]
    v_cvt_pk_bf16_f32 v134, v136, v137
    v_cvt_pk_bf16_f32 v135, v138, v139
    ds_read_b64_tr_b16 v[84:85], v15 offset:49408
    v_mfma_f32_16x16x32_bf16 v[40:43], v[92:95], v[144:147], v[40:43]
    v_permlane32_swap_b32 v132, v134
    ds_read_b64_tr_b16 v[86:87], v15 offset:53504
    s_waitcnt lgkmcnt(6)
    v_mfma_f32_16x16x32_bf16 v[44:47], v[96:99], v[140:143], v[44:47]
    v_permlane32_swap_b32 v133, v135
    v_permlane16_swap_b32 v132, v134
    ds_read_b64_tr_b16 v[88:89], v16 offset:49440
    v_mfma_f32_16x16x32_bf16 v[48:51], v[96:99], v[144:147], v[48:51]
    v_permlane16_swap_b32 v133, v135
    ds_read_b64_tr_b16 v[90:91], v16 offset:53536
    s_waitcnt lgkmcnt(6)
    v_mfma_f32_16x16x32_bf16 v[36:39], v[100:103], v[148:151], v[36:39]
    buffer_store_dwordx4 v[132:135], v14, s[8:11], s18 offen offset:0 sc1
    ds_read_b64_tr_b16 v[92:93], v15 offset:57600
    v_mfma_f32_16x16x32_bf16 v[40:43], v[100:103], v[152:155], v[40:43]
    v_pk_mul_f32 v[132:133], v[24:25], v[124:125]
    v_pk_mul_f32 v[134:135], v[26:27], v[126:127]
    ds_read_b64_tr_b16 v[94:95], v15 offset:61696
    s_waitcnt lgkmcnt(6)
    v_mfma_f32_16x16x32_bf16 v[44:47], v[104:107], v[148:151], v[44:47]
    v_pk_mul_f32 v[136:137], v[32:33], v[128:129]
    ds_read_b64_tr_b16 v[96:97], v16 offset:57632
    v_mfma_f32_16x16x32_bf16 v[48:51], v[104:107], v[152:155], v[48:51]
    v_pk_mul_f32 v[138:139], v[34:35], v[130:131]
    v_cvt_pk_bf16_f32 v132, v132, v133
    ds_read_b64_tr_b16 v[98:99], v16 offset:61728
    s_waitcnt lgkmcnt(6)
    v_mfma_f32_16x16x32_bf16 v[36:39], v[84:87], v[156:159], v[36:39]
    v_cvt_pk_bf16_f32 v133, v134, v135
    ds_read_b64_tr_b16 v[100:101], v15 offset:16896
    v_mfma_f32_16x16x32_bf16 v[40:43], v[84:87], v[160:163], v[40:43]
    v_cvt_pk_bf16_f32 v134, v136, v137
    v_cvt_pk_bf16_f32 v135, v138, v139
    ds_read_b64_tr_b16 v[102:103], v15 offset:20992
    s_waitcnt lgkmcnt(6)
    v_mfma_f32_16x16x32_bf16 v[44:47], v[88:91], v[156:159], v[44:47]
    v_permlane32_swap_b32 v132, v134
    ds_read_b64_tr_b16 v[104:105], v16 offset:16928
    v_mfma_f32_16x16x32_bf16 v[48:51], v[88:91], v[160:163], v[48:51]
    v_permlane32_swap_b32 v133, v135
    v_permlane16_swap_b32 v132, v134
    ds_read_b64_tr_b16 v[106:107], v16 offset:21024
    s_waitcnt lgkmcnt(6)
    v_mfma_f32_16x16x32_bf16 v[36:39], v[92:95], v[164:167], v[36:39]
    v_permlane16_swap_b32 v133, v135
    ds_read_b64_tr_b16 v[84:85], v15 offset:25088
    v_mfma_f32_16x16x32_bf16 v[40:43], v[92:95], v[168:171], v[40:43]
    buffer_store_dwordx4 v[132:135], v14, s[8:11], s19 offen offset:0 sc1
    ds_read_b64_tr_b16 v[86:87], v15 offset:29184
    s_waitcnt lgkmcnt(6)
    v_mfma_f32_16x16x32_bf16 v[44:47], v[96:99], v[164:167], v[44:47]
    ds_read_b64_tr_b16 v[88:89], v16 offset:25120
    v_mfma_f32_16x16x32_bf16 v[48:51], v[96:99], v[168:171], v[48:51]
    ds_read_b64_tr_b16 v[90:91], v16 offset:29216
    ds_read_b128 v[124:127], v13 offset:128
    ds_read_b128 v[128:131], v13 offset:192
    s_waitcnt lgkmcnt(8)
    v_mfma_f32_16x16x32_bf16 v[52:55], v[100:103], v[108:111], v[52:55]
    ds_read_b64_tr_b16 v[92:93], v15 offset:33280
    v_mfma_f32_16x16x32_bf16 v[56:59], v[100:103], v[112:115], v[56:59]
    ds_read_b64_tr_b16 v[94:95], v15 offset:37376
    s_waitcnt lgkmcnt(8)
    v_mfma_f32_16x16x32_bf16 v[60:63], v[104:107], v[108:111], v[60:63]
    ds_read_b64_tr_b16 v[96:97], v16 offset:33312
    v_mfma_f32_16x16x32_bf16 v[64:67], v[104:107], v[112:115], v[64:67]
    ds_read_b64_tr_b16 v[98:99], v16 offset:37408
    s_waitcnt lgkmcnt(8)
    v_mfma_f32_16x16x32_bf16 v[52:55], v[84:87], v[116:119], v[52:55]
    s_waitcnt lgkmcnt(5)
    v_pk_mul_f32 v[132:133], v[36:37], v[124:125]
    v_pk_mul_f32 v[134:135], v[38:39], v[126:127]
    ds_read_b64_tr_b16 v[100:101], v15 offset:41472
    v_mfma_f32_16x16x32_bf16 v[56:59], v[84:87], v[120:123], v[56:59]
    s_waitcnt lgkmcnt(5)
    v_pk_mul_f32 v[136:137], v[44:45], v[128:129]
    ds_read_b64_tr_b16 v[102:103], v15 offset:45568
    v_mfma_f32_16x16x32_bf16 v[60:63], v[88:91], v[116:119], v[60:63]
    v_pk_mul_f32 v[138:139], v[46:47], v[130:131]
    v_cvt_pk_bf16_f32 v132, v132, v133
    ds_read_b64_tr_b16 v[104:105], v16 offset:41504
    v_mfma_f32_16x16x32_bf16 v[64:67], v[88:91], v[120:123], v[64:67]
    v_cvt_pk_bf16_f32 v133, v134, v135
    ds_read_b64_tr_b16 v[106:107], v16 offset:45600
    s_waitcnt lgkmcnt(6)
    v_mfma_f32_16x16x32_bf16 v[52:55], v[92:95], v[140:143], v[52:55]
    v_cvt_pk_bf16_f32 v134, v136, v137
    v_cvt_pk_bf16_f32 v135, v138, v139
    ds_read_b64_tr_b16 v[84:85], v15 offset:49664
    v_mfma_f32_16x16x32_bf16 v[56:59], v[92:95], v[144:147], v[56:59]
    v_permlane32_swap_b32 v132, v134
    ds_read_b64_tr_b16 v[86:87], v15 offset:53760
    s_waitcnt lgkmcnt(6)
    v_mfma_f32_16x16x32_bf16 v[60:63], v[96:99], v[140:143], v[60:63]
    v_permlane32_swap_b32 v133, v135
    v_permlane16_swap_b32 v132, v134
    ds_read_b64_tr_b16 v[88:89], v16 offset:49696
    v_mfma_f32_16x16x32_bf16 v[64:67], v[96:99], v[144:147], v[64:67]
    v_permlane16_swap_b32 v133, v135
    ds_read_b64_tr_b16 v[90:91], v16 offset:53792
    s_waitcnt lgkmcnt(6)
    v_mfma_f32_16x16x32_bf16 v[52:55], v[100:103], v[148:151], v[52:55]
    buffer_store_dwordx4 v[132:135], v14, s[8:11], s18 offen offset:1024 sc1
    ds_read_b64_tr_b16 v[92:93], v15 offset:57856
    v_mfma_f32_16x16x32_bf16 v[56:59], v[100:103], v[152:155], v[56:59]
    v_pk_mul_f32 v[132:133], v[40:41], v[124:125]
    v_pk_mul_f32 v[134:135], v[42:43], v[126:127]
    ds_read_b64_tr_b16 v[94:95], v15 offset:61952
    s_waitcnt lgkmcnt(6)
    v_mfma_f32_16x16x32_bf16 v[60:63], v[104:107], v[148:151], v[60:63]
    v_pk_mul_f32 v[136:137], v[48:49], v[128:129]
    ds_read_b64_tr_b16 v[96:97], v16 offset:57888
    v_mfma_f32_16x16x32_bf16 v[64:67], v[104:107], v[152:155], v[64:67]
    v_pk_mul_f32 v[138:139], v[50:51], v[130:131]
    v_cvt_pk_bf16_f32 v132, v132, v133
    ds_read_b64_tr_b16 v[98:99], v16 offset:61984
    s_waitcnt lgkmcnt(6)
    v_mfma_f32_16x16x32_bf16 v[52:55], v[84:87], v[156:159], v[52:55]
    v_cvt_pk_bf16_f32 v133, v134, v135
    ds_read_b64_tr_b16 v[100:101], v15 offset:17152
    v_mfma_f32_16x16x32_bf16 v[56:59], v[84:87], v[160:163], v[56:59]
    v_cvt_pk_bf16_f32 v134, v136, v137
    v_cvt_pk_bf16_f32 v135, v138, v139
    ds_read_b64_tr_b16 v[102:103], v15 offset:21248
    s_waitcnt lgkmcnt(6)
    v_mfma_f32_16x16x32_bf16 v[60:63], v[88:91], v[156:159], v[60:63]
    v_permlane32_swap_b32 v132, v134
    ds_read_b64_tr_b16 v[104:105], v16 offset:17184
    v_mfma_f32_16x16x32_bf16 v[64:67], v[88:91], v[160:163], v[64:67]
    v_permlane32_swap_b32 v133, v135
    v_permlane16_swap_b32 v132, v134
    ds_read_b64_tr_b16 v[106:107], v16 offset:21280
    s_waitcnt lgkmcnt(6)
    v_mfma_f32_16x16x32_bf16 v[52:55], v[92:95], v[164:167], v[52:55]
    v_permlane16_swap_b32 v133, v135
    ds_read_b64_tr_b16 v[84:85], v15 offset:25344
    v_mfma_f32_16x16x32_bf16 v[56:59], v[92:95], v[168:171], v[56:59]
    buffer_store_dwordx4 v[132:135], v14, s[8:11], s19 offen offset:1024 sc1
    ds_read_b64_tr_b16 v[86:87], v15 offset:29440
    s_waitcnt lgkmcnt(6)
    v_mfma_f32_16x16x32_bf16 v[60:63], v[96:99], v[164:167], v[60:63]
    ds_read_b64_tr_b16 v[88:89], v16 offset:25376
    v_mfma_f32_16x16x32_bf16 v[64:67], v[96:99], v[168:171], v[64:67]
    ds_read_b64_tr_b16 v[90:91], v16 offset:29472
    ds_read_b128 v[124:127], v13 offset:256
    ds_read_b128 v[128:131], v13 offset:320
    s_waitcnt lgkmcnt(8)
    v_mfma_f32_16x16x32_bf16 v[68:71], v[100:103], v[108:111], v[68:71]
    ds_read_b64_tr_b16 v[92:93], v15 offset:33536
    v_mfma_f32_16x16x32_bf16 v[72:75], v[100:103], v[112:115], v[72:75]
    ds_read_b64_tr_b16 v[94:95], v15 offset:37632
    s_waitcnt lgkmcnt(8)
    v_mfma_f32_16x16x32_bf16 v[76:79], v[104:107], v[108:111], v[76:79]
    ds_read_b64_tr_b16 v[96:97], v16 offset:33568
    v_mfma_f32_16x16x32_bf16 v[80:83], v[104:107], v[112:115], v[80:83]
    ds_read_b64_tr_b16 v[98:99], v16 offset:37664
    s_waitcnt lgkmcnt(8)
    v_mfma_f32_16x16x32_bf16 v[68:71], v[84:87], v[116:119], v[68:71]
    s_waitcnt lgkmcnt(5)
    v_pk_mul_f32 v[132:133], v[52:53], v[124:125]
    v_pk_mul_f32 v[134:135], v[54:55], v[126:127]
    ds_read_b64_tr_b16 v[100:101], v15 offset:41728
    v_mfma_f32_16x16x32_bf16 v[72:75], v[84:87], v[120:123], v[72:75]
    s_waitcnt lgkmcnt(5)
    v_pk_mul_f32 v[136:137], v[60:61], v[128:129]
    ds_read_b64_tr_b16 v[102:103], v15 offset:45824
    v_mfma_f32_16x16x32_bf16 v[76:79], v[88:91], v[116:119], v[76:79]
    v_pk_mul_f32 v[138:139], v[62:63], v[130:131]
    v_cvt_pk_bf16_f32 v132, v132, v133
    ds_read_b64_tr_b16 v[104:105], v16 offset:41760
    v_mfma_f32_16x16x32_bf16 v[80:83], v[88:91], v[120:123], v[80:83]
    v_cvt_pk_bf16_f32 v133, v134, v135
    ds_read_b64_tr_b16 v[106:107], v16 offset:45856
    s_waitcnt lgkmcnt(6)
    v_mfma_f32_16x16x32_bf16 v[68:71], v[92:95], v[140:143], v[68:71]
    v_cvt_pk_bf16_f32 v134, v136, v137
    v_cvt_pk_bf16_f32 v135, v138, v139
    ds_read_b64_tr_b16 v[84:85], v15 offset:49920
    v_mfma_f32_16x16x32_bf16 v[72:75], v[92:95], v[144:147], v[72:75]
    v_permlane32_swap_b32 v132, v134
    ds_read_b64_tr_b16 v[86:87], v15 offset:54016
    s_waitcnt lgkmcnt(6)
    v_mfma_f32_16x16x32_bf16 v[76:79], v[96:99], v[140:143], v[76:79]
    v_permlane32_swap_b32 v133, v135
    v_permlane16_swap_b32 v132, v134
    ds_read_b64_tr_b16 v[88:89], v16 offset:49952
    v_mfma_f32_16x16x32_bf16 v[80:83], v[96:99], v[144:147], v[80:83]
    v_permlane16_swap_b32 v133, v135
    ds_read_b64_tr_b16 v[90:91], v16 offset:54048
    s_waitcnt lgkmcnt(6)
    v_mfma_f32_16x16x32_bf16 v[68:71], v[100:103], v[148:151], v[68:71]
    buffer_store_dwordx4 v[132:135], v14, s[8:11], s18 offen offset:2048 sc1
    ds_read_b64_tr_b16 v[92:93], v15 offset:58112
    v_mfma_f32_16x16x32_bf16 v[72:75], v[100:103], v[152:155], v[72:75]
    v_pk_mul_f32 v[132:133], v[56:57], v[124:125]
    v_pk_mul_f32 v[134:135], v[58:59], v[126:127]
    ds_read_b64_tr_b16 v[94:95], v15 offset:62208
    s_waitcnt lgkmcnt(6)
    v_mfma_f32_16x16x32_bf16 v[76:79], v[104:107], v[148:151], v[76:79]
    v_pk_mul_f32 v[136:137], v[64:65], v[128:129]
    ds_read_b64_tr_b16 v[96:97], v16 offset:58144
    v_mfma_f32_16x16x32_bf16 v[80:83], v[104:107], v[152:155], v[80:83]
    v_pk_mul_f32 v[138:139], v[66:67], v[130:131]
    v_cvt_pk_bf16_f32 v132, v132, v133
    ds_read_b64_tr_b16 v[98:99], v16 offset:62240
    s_waitcnt lgkmcnt(6)
    v_mfma_f32_16x16x32_bf16 v[68:71], v[84:87], v[156:159], v[68:71]
    v_cvt_pk_bf16_f32 v133, v134, v135
    v_mfma_f32_16x16x32_bf16 v[72:75], v[84:87], v[160:163], v[72:75]
    v_cvt_pk_bf16_f32 v134, v136, v137
    v_cvt_pk_bf16_f32 v135, v138, v139
    s_waitcnt lgkmcnt(4)
    v_mfma_f32_16x16x32_bf16 v[76:79], v[88:91], v[156:159], v[76:79]
    v_permlane32_swap_b32 v132, v134
    v_mfma_f32_16x16x32_bf16 v[80:83], v[88:91], v[160:163], v[80:83]
    v_permlane32_swap_b32 v133, v135
    v_permlane16_swap_b32 v132, v134
    s_waitcnt lgkmcnt(2)
    v_mfma_f32_16x16x32_bf16 v[68:71], v[92:95], v[164:167], v[68:71]
    v_permlane16_swap_b32 v133, v135
    v_mfma_f32_16x16x32_bf16 v[72:75], v[92:95], v[168:171], v[72:75]
    buffer_store_dwordx4 v[132:135], v14, s[8:11], s19 offen offset:2048 sc1
    s_waitcnt lgkmcnt(0)
    v_mfma_f32_16x16x32_bf16 v[76:79], v[96:99], v[164:167], v[76:79]
    v_mfma_f32_16x16x32_bf16 v[80:83], v[96:99], v[168:171], v[80:83]
    ds_read_b128 v[124:127], v13 offset:384
    ds_read_b128 v[128:131], v13 offset:448
    s_waitcnt lgkmcnt(1)
    v_pk_mul_f32 v[132:133], v[68:69], v[124:125]
    v_pk_mul_f32 v[134:135], v[70:71], v[126:127]
    s_waitcnt lgkmcnt(0)
    s_nop 0
    v_pk_mul_f32 v[136:137], v[76:77], v[128:129]
    v_pk_mul_f32 v[138:139], v[78:79], v[130:131]
    v_cvt_pk_bf16_f32 v132, v132, v133
    v_cvt_pk_bf16_f32 v133, v134, v135
    v_cvt_pk_bf16_f32 v134, v136, v137
    v_cvt_pk_bf16_f32 v135, v138, v139
    s_nop 0
    v_permlane32_swap_b32 v132, v134
    v_permlane32_swap_b32 v133, v135
    s_nop 0
    v_permlane16_swap_b32 v132, v134
    v_permlane16_swap_b32 v133, v135
    buffer_store_dwordx4 v[132:135], v14, s[8:11], s18 offen offset:3072 sc1
    s_nop 1
    v_pk_mul_f32 v[132:133], v[72:73], v[124:125]
    v_pk_mul_f32 v[134:135], v[74:75], v[126:127]
    v_pk_mul_f32 v[136:137], v[80:81], v[128:129]
    v_pk_mul_f32 v[138:139], v[82:83], v[130:131]
    v_cvt_pk_bf16_f32 v132, v132, v133
    v_cvt_pk_bf16_f32 v133, v134, v135
    v_cvt_pk_bf16_f32 v134, v136, v137
    v_cvt_pk_bf16_f32 v135, v138, v139
    s_nop 0
    v_permlane32_swap_b32 v132, v134
    v_permlane32_swap_b32 v133, v135
    s_nop 0
    v_permlane16_swap_b32 v132, v134
    v_permlane16_swap_b32 v133, v135
    buffer_store_dwordx4 v[132:135], v14, s[8:11], s19 offen offset:3072 sc1
fz_p3e:
    s_lshl_b32 s26, s13, 3
    s_add_u32 s26, s26, s3
    s_lshl_b32 s26, s26, 7
    s_lshl_b32 s27, s12, 2
    s_add_u32 s26, s26, s27
    s_add_u32 s26, s26, 0x550000
    v_mov_b32 v7, s14
    v_mov_b32 v6, 0
    v_mov_b32 v16, s3
    v_lshl_add_u32 v17, v16, 6, v0
    v_lshlrev_b32 v5, 2, v17
    v_lshrrev_b32 v13, 3, v8
    v_and_b32 v14, 7, v8
    s_lshl_b32 s16, s13, 8
    s_lshl_b32 s27, s12, 3
    s_add_u32 s16, s16, s27
    s_add_u32 s16, s16, s3
    s_lshl_b32 s17, s16, 11
    s_mov_b64 s[28:29], s[32:33]
    s_mov_b32 s30, 0x400000
    s_mov_b32 s31, 0x20000
    s_mov_b64 s[64:65], s[56:57]
    s_mov_b32 s66, 0x400000
    s_mov_b32 s67, 0x20000
    v_add_u32 v15, 0x20000, v1
    ds_read_b128 v[72:75], v15 offset:0
    ds_read_b128 v[76:79], v15 offset:1024
    ds_read_b128 v[80:83], v15 offset:2048
    ds_read_b128 v[84:87], v15 offset:3072
    ds_read_b128 v[88:91], v15 offset:4096
    ds_read_b128 v[92:95], v15 offset:5120
    ds_read_b128 v[96:99], v15 offset:6144
    ds_read_b128 v[100:103], v15 offset:7168
    s_waitcnt vmcnt(0)
    s_mov_b64 exec, 1
    buffer_store_dword v7, v6, s[8:11], s26 offen sc1
    s_mov_b64 exec, -1
    buffer_load_dwordx4 v[128:131], v1, s[28:31], s17 offen offset:0
    buffer_load_dwordx4 v[132:135], v1, s[28:31], s17 offen offset:1024
    v_mov_b32 v190, 0
    v_mov_b32 v196, 0
    s_waitcnt lgkmcnt(5)
    v_lshlrev_b32 v144, 16, v80
    v_and_b32 v145, 0xffff0000, v80
    s_waitcnt lgkmcnt(1)
    v_lshlrev_b32 v146, 16, v96
    v_and_b32 v147, 0xffff0000, v96
    v_pk_mul_f32 v[104:105], v[144:145], v[146:147]
    v_lshlrev_b32 v144, 16, v72
    v_and_b32 v145, 0xffff0000, v72
    v_fmac_f32 v190, v144, v146
    v_fmac_f32 v190, v145, v147
    v_add_f32 v196, v196, v104
    v_add_f32 v196, v196, v105
    v_lshlrev_b32 v144, 16, v81
    v_and_b32 v145, 0xffff0000, v81
    v_lshlrev_b32 v146, 16, v97
    v_and_b32 v147, 0xffff0000, v97
    v_pk_mul_f32 v[106:107], v[144:145], v[146:147]
    v_lshlrev_b32 v144, 16, v73
    v_and_b32 v145, 0xffff0000, v73
    v_fmac_f32 v190, v144, v146
    v_fmac_f32 v190, v145, v147
    v_add_f32 v196, v196, v106
    v_add_f32 v196, v196, v107
    v_lshlrev_b32 v144, 16, v82
    v_and_b32 v145, 0xffff0000, v82
    v_lshlrev_b32 v146, 16, v98
    v_and_b32 v147, 0xffff0000, v98
    v_pk_mul_f32 v[108:109], v[144:145], v[146:147]
    v_lshlrev_b32 v144, 16, v74
    v_and_b32 v145, 0xffff0000, v74
    v_fmac_f32 v190, v144, v146
    v_fmac_f32 v190, v145, v147
    v_add_f32 v196, v196, v108
    v_add_f32 v196, v196, v109
    v_lshlrev_b32 v144, 16, v83
    v_and_b32 v145, 0xffff0000, v83
    v_lshlrev_b32 v146, 16, v99
    v_and_b32 v147, 0xffff0000, v99
    v_pk_mul_f32 v[110:111], v[144:145], v[146:147]
    v_lshlrev_b32 v144, 16, v75
    v_and_b32 v145, 0xffff0000, v75
    v_fmac_f32 v190, v144, v146
    v_fmac_f32 v190, v145, v147
    v_add_f32 v196, v196, v110
    v_add_f32 v196, v196, v111
    v_lshlrev_b32 v144, 16, v84
    v_and_b32 v145, 0xffff0000, v84
    s_waitcnt lgkmcnt(0)
    v_lshlrev_b32 v146, 16, v100
    v_and_b32 v147, 0xffff0000, v100
    v_pk_mul_f32 v[112:113], v[144:145], v[146:147]
    v_lshlrev_b32 v144, 16, v76
    v_and_b32 v145, 0xffff0000, v76
    v_fmac_f32 v190, v144, v146
    v_fmac_f32 v190, v145, v147
    v_add_f32 v196, v196, v112
    v_add_f32 v196, v196, v113
    v_lshlrev_b32 v144, 16, v85
    v_and_b32 v145, 0xffff0000, v85
    v_lshlrev_b32 v146, 16, v101
    v_and_b32 v147, 0xffff0000, v101
    v_pk_mul_f32 v[114:115], v[144:145], v[146:147]
    v_lshlrev_b32 v144, 16, v77
    v_and_b32 v145, 0xffff0000, v77
    v_fmac_f32 v190, v144, v146
    v_fmac_f32 v190, v145, v147
    v_add_f32 v196, v196, v114
    v_add_f32 v196, v196, v115
    v_lshlrev_b32 v144, 16, v86
    v_and_b32 v145, 0xffff0000, v86
    v_lshlrev_b32 v146, 16, v102
    v_and_b32 v147, 0xffff0000, v102
    v_pk_mul_f32 v[116:117], v[144:145], v[146:147]
    v_lshlrev_b32 v144, 16, v78
    v_and_b32 v145, 0xffff0000, v78
    v_fmac_f32 v190, v144, v146
    v_fmac_f32 v190, v145, v147
    v_add_f32 v196, v196, v116
    v_add_f32 v196, v196, v117
    v_lshlrev_b32 v144, 16, v87
    v_and_b32 v145, 0xffff0000, v87
    v_lshlrev_b32 v146, 16, v103
    v_and_b32 v147, 0xffff0000, v103
    v_pk_mul_f32 v[118:119], v[144:145], v[146:147]
    v_lshlrev_b32 v144, 16, v79
    v_and_b32 v145, 0xffff0000, v79
    v_fmac_f32 v190, v144, v146
    v_fmac_f32 v190, v145, v147
    v_add_f32 v196, v196, v118
    v_add_f32 v196, v196, v119
    v_add_f32_dpp v190, v190, v190 row_ror:1 row_mask:0xf bank_mask:0xf
    s_nop 0
    v_add_f32_dpp v196, v196, v196 row_ror:1 row_mask:0xf bank_mask:0xf
    v_add_f32_dpp v190, v190, v190 row_ror:2 row_mask:0xf bank_mask:0xf
    s_nop 0
    v_add_f32_dpp v196, v196, v196 row_ror:2 row_mask:0xf bank_mask:0xf
    v_add_f32_dpp v190, v190, v190 row_ror:4 row_mask:0xf bank_mask:0xf
    s_nop 0
    v_add_f32_dpp v196, v196, v196 row_ror:4 row_mask:0xf bank_mask:0xf
    v_add_f32_dpp v190, v190, v190 row_ror:8 row_mask:0xf bank_mask:0xf
    s_nop 0
    v_add_f32_dpp v196, v196, v196 row_ror:8 row_mask:0xf bank_mask:0xf
    v_mov_b32 v144, v190
    s_nop 1
    v_permlane16_swap_b32 v190, v144
    v_add_f32 v190, v190, v144
    v_mov_b32 v145, v196
    s_nop 1
    v_permlane16_swap_b32 v196, v145
    v_add_f32 v196, v196, v145
    v_mov_b32 v144, v190
    s_nop 1
    v_permlane32_swap_b32 v190, v144
    v_add_f32 v190, v190, v144
    v_mov_b32 v145, v196
    s_nop 1
    v_permlane32_swap_b32 v196, v145
    v_add_f32 v196, v196, v145
    v_lshlrev_b32 v7, 2, v8
    s_lshl_b32 s25, s98, 10
    s_add_u32 s25, s25, 131072
    v_add_u32 v11, s25, v7
    ds_read_b32 v168, v11 offset:2048
    ds_read_b32 v170, v11
    s_lshl_b32 s18, s99, 7
    s_add_u32 s25, s18, 131072
    v_lshl_add_u32 v11, v0, 1, s25
    ds_read_u16 v125, v11 offset:2048
    ds_read_u16 v126, v11 offset:0
    ds_read_u16 v127, v11 offset:4096
    s_waitcnt lgkmcnt(2)
    v_lshlrev_b32 v125, 16, v125
    s_waitcnt lgkmcnt(1)
    v_lshlrev_b32 v126, 16, v126
    s_waitcnt lgkmcnt(0)
    v_lshlrev_b32 v127, 16, v127
    v_and_b32 v169, 0xffff0000, v168
    v_lshlrev_b32 v168, 16, v168
    v_and_b32 v171, 0xffff0000, v170
    v_lshlrev_b32 v170, 16, v170
    s_waitcnt vmcnt(1)
    v_lshlrev_b32 v24, 16, v128
    v_and_b32 v25, 0xffff0000, v128
    v_lshlrev_b32 v26, 16, v129
    v_and_b32 v27, 0xffff0000, v129
    v_lshlrev_b32 v28, 16, v130
    v_and_b32 v29, 0xffff0000, v130
    v_lshlrev_b32 v30, 16, v131
    v_and_b32 v31, 0xffff0000, v131
    s_waitcnt vmcnt(0)
    v_lshlrev_b32 v32, 16, v132
    v_and_b32 v33, 0xffff0000, v132
    v_lshlrev_b32 v34, 16, v133
    v_and_b32 v35, 0xffff0000, v133
    v_lshlrev_b32 v36, 16, v134
    v_and_b32 v37, 0xffff0000, v134
    v_lshlrev_b32 v38, 16, v135
    v_and_b32 v39, 0xffff0000, v135
    s_lshr_b32 s24, s16, 4
    s_lshl_b32 s24, s24, 15
    s_and_b32 s27, s16, 15
    s_lshl_b32 s27, s27, 6
    s_add_u32 s24, s24, s27
    s_add_u32 s24, s24, 0x2000000
    v_lshrrev_b32 v3, 2, v0
    v_lshlrev_b32 v3, 10, v3
    v_and_b32 v2, 3, v0
    v_lshl_add_u32 v3, v2, 4, v3
    v_and_b32 v11, 31, v0
    v_lshlrev_b32 v11, 2, v11
    s_lshl_b32 s22, s13, 3
    s_lshr_b32 s23, s12, 2
    s_add_u32 s22, s22, s23
    s_lshl_b32 s22, s22, 7
    s_add_u32 s22, s22, 0x550000
    s_mov_b32 s27, 0
fz_rp:
    buffer_load_dword v144, v11, s[8:11], s22 offen sc1
    s_waitcnt vmcnt(0)
    v_cmp_ne_u32 vcc, s14, v144
    s_add_u32 s27, s27, 1
    s_cmp_ge_u32 s27, 65536
    s_cbranch_scc1 fz_rg
    s_cbranch_vccz fz_rg
    s_sleep 1
    s_branch fz_rp
fz_rg:
    s_add_u32 s25, s24, 0x0
    buffer_load_dwordx4 v[40:43], v3, s[8:11], s25 offen sc1
    s_add_u32 s25, s24, 0x400000
    buffer_load_dwordx4 v[48:51], v3, s[8:11], s25 offen sc1
    s_add_u32 s25, s24, 0x800000
    buffer_load_dwordx4 v[56:59], v3, s[8:11], s25 offen sc1
    s_add_u32 s25, s24, 0xc00000
    buffer_load_dwordx4 v[64:67], v3, s[8:11], s25 offen sc1
    s_add_u32 s25, s24, 0x4000
    buffer_load_dwordx4 v[44:47], v3, s[8:11], s25 offen sc1
    s_add_u32 s25, s24, 0x404000
    buffer_load_dwordx4 v[52:55], v3, s[8:11], s25 offen sc1
    s_add_u32 s25, s24, 0x804000
    buffer_load_dwordx4 v[60:63], v3, s[8:11], s25 offen sc1
    s_add_u32 s25, s24, 0xc04000
    buffer_load_dwordx4 v[68:71], v3, s[8:11], s25 offen sc1
    s_waitcnt vmcnt(7)
    v_lshlrev_b32 v144, 16, v40
    v_and_b32 v145, 0xffff0000, v40
    s_waitcnt vmcnt(6)
    v_lshlrev_b32 v146, 16, v48
    v_and_b32 v147, 0xffff0000, v48
    v_pk_add_f32 v[144:145], v[144:145], v[146:147]
    s_waitcnt vmcnt(5)
    v_lshlrev_b32 v146, 16, v56
    v_and_b32 v147, 0xffff0000, v56
    v_pk_add_f32 v[144:145], v[144:145], v[146:147]
    s_waitcnt vmcnt(4)
    v_lshlrev_b32 v146, 16, v64
    v_and_b32 v147, 0xffff0000, v64
    v_pk_add_f32 v[144:145], v[144:145], v[146:147]
    v_pk_add_f32 v[24:25], v[24:25], v[144:145]
    v_cvt_pk_bf16_f32 v11, v24, v25
    v_lshlrev_b32 v24, 16, v11
    v_and_b32 v25, 0xffff0000, v11
    v_lshlrev_b32 v148, 16, v41
    v_and_b32 v149, 0xffff0000, v41
    v_lshlrev_b32 v150, 16, v49
    v_and_b32 v151, 0xffff0000, v49
    v_pk_add_f32 v[148:149], v[148:149], v[150:151]
    v_lshlrev_b32 v150, 16, v57
    v_and_b32 v151, 0xffff0000, v57
    v_pk_add_f32 v[148:149], v[148:149], v[150:151]
    v_lshlrev_b32 v150, 16, v65
    v_and_b32 v151, 0xffff0000, v65
    v_pk_add_f32 v[148:149], v[148:149], v[150:151]
    v_pk_add_f32 v[26:27], v[26:27], v[148:149]
    v_cvt_pk_bf16_f32 v12, v26, v27
    v_lshlrev_b32 v26, 16, v12
    v_and_b32 v27, 0xffff0000, v12
    v_lshlrev_b32 v144, 16, v42
    v_and_b32 v145, 0xffff0000, v42
    v_lshlrev_b32 v146, 16, v50
    v_and_b32 v147, 0xffff0000, v50
    v_pk_add_f32 v[144:145], v[144:145], v[146:147]
    v_lshlrev_b32 v146, 16, v58
    v_and_b32 v147, 0xffff0000, v58
    v_pk_add_f32 v[144:145], v[144:145], v[146:147]
    v_lshlrev_b32 v146, 16, v66
    v_and_b32 v147, 0xffff0000, v66
    v_pk_add_f32 v[144:145], v[144:145], v[146:147]
    v_pk_add_f32 v[28:29], v[28:29], v[144:145]
    v_cvt_pk_bf16_f32 v11, v28, v29
    v_lshlrev_b32 v28, 16, v11
    v_and_b32 v29, 0xffff0000, v11
    v_lshlrev_b32 v148, 16, v43
    v_and_b32 v149, 0xffff0000, v43
    v_lshlrev_b32 v150, 16, v51
    v_and_b32 v151, 0xffff0000, v51
    v_pk_add_f32 v[148:149], v[148:149], v[150:151]
    v_lshlrev_b32 v150, 16, v59
    v_and_b32 v151, 0xffff0000, v59
    v_pk_add_f32 v[148:149], v[148:149], v[150:151]
    v_lshlrev_b32 v150, 16, v67
    v_and_b32 v151, 0xffff0000, v67
    v_pk_add_f32 v[148:149], v[148:149], v[150:151]
    v_pk_add_f32 v[30:31], v[30:31], v[148:149]
    v_cvt_pk_bf16_f32 v12, v30, v31
    v_lshlrev_b32 v30, 16, v12
    v_and_b32 v31, 0xffff0000, v12
    s_waitcnt vmcnt(3)
    v_lshlrev_b32 v144, 16, v44
    v_and_b32 v145, 0xffff0000, v44
    s_waitcnt vmcnt(2)
    v_lshlrev_b32 v146, 16, v52
    v_and_b32 v147, 0xffff0000, v52
    v_pk_add_f32 v[144:145], v[144:145], v[146:147]
    s_waitcnt vmcnt(1)
    v_lshlrev_b32 v146, 16, v60
    v_and_b32 v147, 0xffff0000, v60
    v_pk_add_f32 v[144:145], v[144:145], v[146:147]
    s_waitcnt vmcnt(0)
    v_lshlrev_b32 v146, 16, v68
    v_and_b32 v147, 0xffff0000, v68
    v_pk_add_f32 v[144:145], v[144:145], v[146:147]
    v_pk_add_f32 v[32:33], v[32:33], v[144:145]
    v_cvt_pk_bf16_f32 v11, v32, v33
    v_lshlrev_b32 v32, 16, v11
    v_and_b32 v33, 0xffff0000, v11
    v_lshlrev_b32 v148, 16, v45
    v_and_b32 v149, 0xffff0000, v45
    v_lshlrev_b32 v150, 16, v53
    v_and_b32 v151, 0xffff0000, v53
    v_pk_add_f32 v[148:149], v[148:149], v[150:151]
    v_lshlrev_b32 v150, 16, v61
    v_and_b32 v151, 0xffff0000, v61
    v_pk_add_f32 v[148:149], v[148:149], v[150:151]
    v_lshlrev_b32 v150, 16, v69
    v_and_b32 v151, 0xffff0000, v69
    v_pk_add_f32 v[148:149], v[148:149], v[150:151]
    v_pk_add_f32 v[34:35], v[34:35], v[148:149]
    v_cvt_pk_bf16_f32 v12, v34, v35
    v_lshlrev_b32 v34, 16, v12
    v_and_b32 v35, 0xffff0000, v12
    v_lshlrev_b32 v144, 16, v46
    v_and_b32 v145, 0xffff0000, v46
    v_lshlrev_b32 v146, 16, v54
    v_and_b32 v147, 0xffff0000, v54
    v_pk_add_f32 v[144:145], v[144:145], v[146:147]
    v_lshlrev_b32 v146, 16, v62
    v_and_b32 v147, 0xffff0000, v62
    v_pk_add_f32 v[144:145], v[144:145], v[146:147]
    v_lshlrev_b32 v146, 16, v70
    v_and_b32 v147, 0xffff0000, v70
    v_pk_add_f32 v[144:145], v[144:145], v[146:147]
    v_pk_add_f32 v[36:37], v[36:37], v[144:145]
    v_cvt_pk_bf16_f32 v11, v36, v37
    v_lshlrev_b32 v36, 16, v11
    v_and_b32 v37, 0xffff0000, v11
    v_lshlrev_b32 v148, 16, v47
    v_and_b32 v149, 0xffff0000, v47
    v_lshlrev_b32 v150, 16, v55
    v_and_b32 v151, 0xffff0000, v55
    v_pk_add_f32 v[148:149], v[148:149], v[150:151]
    v_lshlrev_b32 v150, 16, v63
    v_and_b32 v151, 0xffff0000, v63
    v_pk_add_f32 v[148:149], v[148:149], v[150:151]
    v_lshlrev_b32 v150, 16, v71
    v_and_b32 v151, 0xffff0000, v71
    v_pk_add_f32 v[148:149], v[148:149], v[150:151]
    v_pk_add_f32 v[38:39], v[38:39], v[148:149]
    v_cvt_pk_bf16_f32 v12, v38, v39
    v_lshlrev_b32 v38, 16, v12
    v_and_b32 v39, 0xffff0000, v12
    v_readfirstlane_b32 s25, v24
    s_nop 1
    v_mov_b32 v188, s25
    v_pk_add_f32 v[40:41], v[24:25], v[188:189] op_sel_hi:[1,0] neg_lo:[0,1] neg_hi:[0,1]
    v_pk_add_f32 v[42:43], v[26:27], v[188:189] op_sel_hi:[1,0] neg_lo:[0,1] neg_hi:[0,1]
    v_pk_add_f32 v[44:45], v[28:29], v[188:189] op_sel_hi:[1,0] neg_lo:[0,1] neg_hi:[0,1]
    v_pk_add_f32 v[46:47], v[30:31], v[188:189] op_sel_hi:[1,0] neg_lo:[0,1] neg_hi:[0,1]
    v_pk_add_f32 v[48:49], v[32:33], v[188:189] op_sel_hi:[1,0] neg_lo:[0,1] neg_hi:[0,1]
    v_pk_add_f32 v[50:51], v[34:35], v[188:189] op_sel_hi:[1,0] neg_lo:[0,1] neg_hi:[0,1]
    v_pk_add_f32 v[52:53], v[36:37], v[188:189] op_sel_hi:[1,0] neg_lo:[0,1] neg_hi:[0,1]
    v_pk_add_f32 v[54:55], v[38:39], v[188:189] op_sel_hi:[1,0] neg_lo:[0,1] neg_hi:[0,1]
    v_pk_add_f32 v[148:149], v[40:41], v[42:43]
    v_pk_mul_f32 v[144:145], v[40:41], v[40:41]
    v_pk_mul_f32 v[146:147], v[40:41], v[104:105]
    v_pk_fma_f32 v[144:145], v[42:43], v[42:43], v[144:145]
    v_pk_fma_f32 v[146:147], v[42:43], v[106:107], v[146:147]
    v_pk_add_f32 v[148:149], v[148:149], v[44:45]
    v_pk_fma_f32 v[144:145], v[44:45], v[44:45], v[144:145]
    v_pk_fma_f32 v[146:147], v[44:45], v[108:109], v[146:147]
    v_pk_add_f32 v[148:149], v[148:149], v[46:47]
    v_pk_fma_f32 v[144:145], v[46:47], v[46:47], v[144:145]
    v_pk_fma_f32 v[146:147], v[46:47], v[110:111], v[146:147]
    v_pk_add_f32 v[148:149], v[148:149], v[48:49]
    v_pk_fma_f32 v[144:145], v[48:49], v[48:49], v[144:145]
    v_pk_fma_f32 v[146:147], v[48:49], v[112:113], v[146:147]
    v_pk_add_f32 v[148:149], v[148:149], v[50:51]
    v_pk_fma_f32 v[144:145], v[50:51], v[50:51], v[144:145]
    v_pk_fma_f32 v[146:147], v[50:51], v[114:115], v[146:147]
    v_pk_add_f32 v[148:149], v[148:149], v[52:53]
    v_pk_fma_f32 v[144:145], v[52:53], v[52:53], v[144:145]
    v_pk_fma_f32 v[146:147], v[52:53], v[116:117], v[146:147]
    v_pk_add_f32 v[148:149], v[148:149], v[54:55]
    v_pk_fma_f32 v[144:145], v[54:55], v[54:55], v[144:145]
    v_pk_fma_f32 v[146:147], v[54:55], v[118:119], v[146:147]
    v_add_f32 v192, v148, v149
    v_add_f32 v193, v144, v145
    v_add_f32 v194, v146, v147
    v_add_f32_dpp v192, v192, v192 row_ror:1 row_mask:0xf bank_mask:0xf
    v_add_f32_dpp v193, v193, v193 row_ror:1 row_mask:0xf bank_mask:0xf
    v_add_f32_dpp v194, v194, v194 row_ror:1 row_mask:0xf bank_mask:0xf
    v_add_f32_dpp v192, v192, v192 row_ror:2 row_mask:0xf bank_mask:0xf
    v_add_f32_dpp v193, v193, v193 row_ror:2 row_mask:0xf bank_mask:0xf
    v_add_f32_dpp v194, v194, v194 row_ror:2 row_mask:0xf bank_mask:0xf
    v_add_f32_dpp v192, v192, v192 row_ror:4 row_mask:0xf bank_mask:0xf
    v_add_f32_dpp v193, v193, v193 row_ror:4 row_mask:0xf bank_mask:0xf
    v_add_f32_dpp v194, v194, v194 row_ror:4 row_mask:0xf bank_mask:0xf
    v_add_f32_dpp v192, v192, v192 row_ror:8 row_mask:0xf bank_mask:0xf
    v_add_f32_dpp v193, v193, v193 row_ror:8 row_mask:0xf bank_mask:0xf
    v_add_f32_dpp v194, v194, v194 row_ror:8 row_mask:0xf bank_mask:0xf
    v_mov_b32 v144, v192
    s_nop 1
    v_permlane16_swap_b32 v192, v144
    v_add_f32 v192, v192, v144
    v_mov_b32 v145, v193
    s_nop 1
    v_permlane16_swap_b32 v193, v145
    v_add_f32 v193, v193, v145
    v_mov_b32 v146, v194
    s_nop 1
    v_permlane16_swap_b32 v194, v146
    v_add_f32 v194, v194, v146
    v_mov_b32 v144, v192
    s_nop 1
    v_permlane32_swap_b32 v192, v144
    v_add_f32 v192, v192, v144
    v_mov_b32 v145, v193
    s_nop 1
    v_permlane32_swap_b32 v193, v145
    v_add_f32 v193, v193, v145
    v_mov_b32 v146, v194
    s_nop 1
    v_permlane32_swap_b32 v194, v146
    v_add_f32 v194, v194, v146
    v_mul_f32 v192, 0x3a800000, v192
    v_mul_f32 v193, 0x3a800000, v193
    v_fma_f32 v193, -v192, v192, v193
    v_max_f32 v193, 0, v193
    v_fma_f32 v194, -v192, v196, v194
    v_add_f32 v192, s25, v192
    v_add_f32 v144, 0x3727c5ac, v193
    v_rsq_f32 v144, v144
    s_nop 0
    v_fma_f32 v23, v194, v144, v190
    v_cvt_pk_bf16_f32 v192, v192, v192
    v_lshlrev_b32 v192, 16, v192
    v_cvt_pk_bf16_f32 v193, v193, v193
    v_lshlrev_b32 v193, 16, v193
    v_add_f32 v193, 0x3727c5ac, v193
    v_cvt_pk_bf16_f32 v193, v193, v193
    v_lshlrev_b32 v193, 16, v193
    v_sqrt_f32 v194, v193
    s_nop 0
    v_cvt_pk_bf16_f32 v194, v194, v194
    v_lshlrev_b32 v194, 16, v194
    v_rcp_f32 v195, v194
    v_mov_b32 v21, v192
    v_mov_b32 v22, v194
    v_ashrrev_i32 v12, 31, v23
    v_or_b32 v12, 0x80000000, v12
    v_xor_b32 v20, v23, v12
    v_and_b32 v20, 0xfffff800, v20
    v_max_u32 v20, 0x800, v20
    s_sub_u32 s24, 2047, s16
    v_or_b32 v20, s24, v20
    v_lshlrev_b32 v11, 4, v16
    ds_write_b128 v11, v[20:23]
    s_waitcnt lgkmcnt(0)
    s_barrier
    s_cmp_lg_u32 s3, 0
    s_cbranch_scc1 fz_nk
    v_and_b32 v11, 7, v0
    v_lshlrev_b32 v11, 4, v11
    ds_read_b32 v144, v11 offset:0
    s_waitcnt lgkmcnt(0)
    v_mov_b32 v145, v144
    s_nop 1
    v_max_u32_dpp v145, v145, v145 row_ror:1 row_mask:0xf bank_mask:0xf
    s_nop 1
    v_max_u32_dpp v145, v145, v145 row_ror:2 row_mask:0xf bank_mask:0xf
    s_nop 1
    v_max_u32_dpp v145, v145, v145 row_ror:4 row_mask:0xf bank_mask:0xf
    v_cmp_eq_u32 vcc, v144, v145
    s_ff1_i32_b64 s26, vcc
    s_lshl_b32 s26, s26, 4
    v_mov_b32 v11, s26
    ds_read_b128 v[20:23], v11 offset:0
    s_lshl_b32 s24, s2, 4
    s_add_u32 s24, s24, 0xa70000
    s_mov_b64 exec, 1
    s_waitcnt lgkmcnt(0)
    buffer_store_dwordx4 v[20:23], v6, s[8:11], s24 offen sc1
    s_mov_b64 exec, -1
fz_nk:
    s_waitcnt lgkmcnt(0)
    v_lshlrev_b32 v2, 5, v14
    v_bfe_u32 v4, v0, 4, 2
    v_lshl_add_u32 v2, v4, 3, v2
    v_bfe_u32 v4, v17, 6, 2
    v_lshl_add_u32 v2, v4, 8, v2
    v_lshlrev_b32 v4, 2, v0
    s_cmp_lt_u32 s3, 4
    s_cbranch_scc1 fz_dn
    v_sub_f32 v40, v24, v192
    v_sub_f32 v41, v25, v192
    v_sub_f32 v42, v26, v192
    v_sub_f32 v43, v27, v192
    v_sub_f32 v44, v28, v192
    v_sub_f32 v45, v29, v192
    v_sub_f32 v46, v30, v192
    v_sub_f32 v47, v31, v192
    v_cvt_pk_bf16_f32 v12, v40, v41
    v_lshlrev_b32 v40, 16, v12
    v_and_b32 v41, 0xffff0000, v12
    v_cvt_pk_bf16_f32 v12, v42, v43
    v_lshlrev_b32 v42, 16, v12
    v_and_b32 v43, 0xffff0000, v12
    v_cvt_pk_bf16_f32 v12, v44, v45
    v_lshlrev_b32 v44, 16, v12
    v_and_b32 v45, 0xffff0000, v12
    v_cvt_pk_bf16_f32 v12, v46, v47
    v_lshlrev_b32 v46, 16, v12
    v_and_b32 v47, 0xffff0000, v12
    v_mul_f32 v40, v40, v195
    v_mul_f32 v41, v41, v195
    v_mul_f32 v42, v42, v195
    v_mul_f32 v43, v43, v195
    v_mul_f32 v44, v44, v195
    v_mul_f32 v45, v45, v195
    v_mul_f32 v46, v46, v195
    v_mul_f32 v47, v47, v195
    v_cvt_pk_bf16_f32 v12, v40, v41
    v_lshlrev_b32 v40, 16, v12
    v_and_b32 v41, 0xffff0000, v12
    v_cvt_pk_bf16_f32 v12, v42, v43
    v_lshlrev_b32 v42, 16, v12
    v_and_b32 v43, 0xffff0000, v12
    v_cvt_pk_bf16_f32 v12, v44, v45
    v_lshlrev_b32 v44, 16, v12
    v_and_b32 v45, 0xffff0000, v12
    v_cvt_pk_bf16_f32 v12, v46, v47
    v_lshlrev_b32 v46, 16, v12
    v_and_b32 v47, 0xffff0000, v12
    v_lshlrev_b32 v48, 16, v80
    v_and_b32 v49, 0xffff0000, v80
    v_lshlrev_b32 v50, 16, v81
    v_and_b32 v51, 0xffff0000, v81
    v_lshlrev_b32 v52, 16, v82
    v_and_b32 v53, 0xffff0000, v82
    v_lshlrev_b32 v54, 16, v83
    v_and_b32 v55, 0xffff0000, v83
    v_pk_mul_f32 v[40:41], v[40:41], v[48:49]
    v_pk_mul_f32 v[42:43], v[42:43], v[50:51]
    v_pk_mul_f32 v[44:45], v[44:45], v[52:53]
    v_pk_mul_f32 v[46:47], v[46:47], v[54:55]
    v_cvt_pk_bf16_f32 v12, v40, v41
    v_lshlrev_b32 v40, 16, v12
    v_and_b32 v41, 0xffff0000, v12
    v_cvt_pk_bf16_f32 v12, v42, v43
    v_lshlrev_b32 v42, 16, v12
    v_and_b32 v43, 0xffff0000, v12
    v_cvt_pk_bf16_f32 v12, v44, v45
    v_lshlrev_b32 v44, 16, v12
    v_and_b32 v45, 0xffff0000, v12
    v_cvt_pk_bf16_f32 v12, v46, v47
    v_lshlrev_b32 v46, 16, v12
    v_and_b32 v47, 0xffff0000, v12
    v_lshlrev_b32 v48, 16, v72
    v_and_b32 v49, 0xffff0000, v72
    v_lshlrev_b32 v50, 16, v73
    v_and_b32 v51, 0xffff0000, v73
    v_lshlrev_b32 v52, 16, v74
    v_and_b32 v53, 0xffff0000, v74
    v_lshlrev_b32 v54, 16, v75
    v_and_b32 v55, 0xffff0000, v75
    v_pk_add_f32 v[40:41], v[40:41], v[48:49]
    v_pk_add_f32 v[42:43], v[42:43], v[50:51]
    v_pk_add_f32 v[44:45], v[44:45], v[52:53]
    v_pk_add_f32 v[46:47], v[46:47], v[54:55]
    v_cvt_pk_bf16_f32 v12, v40, v41
    v_lshlrev_b32 v40, 16, v12
    v_and_b32 v41, 0xffff0000, v12
    v_cvt_pk_bf16_f32 v12, v42, v43
    v_lshlrev_b32 v42, 16, v12
    v_and_b32 v43, 0xffff0000, v12
    v_cvt_pk_bf16_f32 v12, v44, v45
    v_lshlrev_b32 v44, 16, v12
    v_and_b32 v45, 0xffff0000, v12
    v_cvt_pk_bf16_f32 v12, v46, v47
    v_lshlrev_b32 v46, 16, v12
    v_and_b32 v47, 0xffff0000, v12
    v_lshlrev_b32 v48, 16, v88
    v_and_b32 v49, 0xffff0000, v88
    v_lshlrev_b32 v50, 16, v89
    v_and_b32 v51, 0xffff0000, v89
    v_lshlrev_b32 v52, 16, v90
    v_and_b32 v53, 0xffff0000, v90
    v_lshlrev_b32 v54, 16, v91
    v_and_b32 v55, 0xffff0000, v91
    v_pk_mul_f32 v[40:41], v[40:41], v[48:49]
    v_pk_mul_f32 v[42:43], v[42:43], v[50:51]
    v_pk_mul_f32 v[44:45], v[44:45], v[52:53]
    v_pk_mul_f32 v[46:47], v[46:47], v[54:55]
    v_cvt_pk_bf16_f32 v12, v40, v41
    v_lshlrev_b32 v40, 16, v12
    v_and_b32 v41, 0xffff0000, v12
    v_cvt_pk_bf16_f32 v12, v42, v43
    v_lshlrev_b32 v42, 16, v12
    v_and_b32 v43, 0xffff0000, v12
    v_cvt_pk_bf16_f32 v12, v44, v45
    v_lshlrev_b32 v44, 16, v12
    v_and_b32 v45, 0xffff0000, v12
    v_cvt_pk_bf16_f32 v12, v46, v47
    v_lshlrev_b32 v46, 16, v12
    v_and_b32 v47, 0xffff0000, v12
    v_pk_add_f32 v[40:41], v[40:41], v[24:25]
    v_pk_add_f32 v[42:43], v[42:43], v[26:27]
    v_pk_add_f32 v[44:45], v[44:45], v[28:29]
    v_pk_add_f32 v[46:47], v[46:47], v[30:31]
    v_cvt_pk_bf16_f32 v56, v40, v41
    v_cvt_pk_bf16_f32 v57, v42, v43
    v_cvt_pk_bf16_f32 v58, v44, v45
    v_cvt_pk_bf16_f32 v59, v46, v47
    v_sub_f32 v40, v32, v192
    v_sub_f32 v41, v33, v192
    v_sub_f32 v42, v34, v192
    v_sub_f32 v43, v35, v192
    v_sub_f32 v44, v36, v192
    v_sub_f32 v45, v37, v192
    v_sub_f32 v46, v38, v192
    v_sub_f32 v47, v39, v192
    v_cvt_pk_bf16_f32 v12, v40, v41
    v_lshlrev_b32 v40, 16, v12
    v_and_b32 v41, 0xffff0000, v12
    v_cvt_pk_bf16_f32 v12, v42, v43
    v_lshlrev_b32 v42, 16, v12
    v_and_b32 v43, 0xffff0000, v12
    v_cvt_pk_bf16_f32 v12, v44, v45
    v_lshlrev_b32 v44, 16, v12
    v_and_b32 v45, 0xffff0000, v12
    v_cvt_pk_bf16_f32 v12, v46, v47
    v_lshlrev_b32 v46, 16, v12
    v_and_b32 v47, 0xffff0000, v12
    v_mul_f32 v40, v40, v195
    v_mul_f32 v41, v41, v195
    v_mul_f32 v42, v42, v195
    v_mul_f32 v43, v43, v195
    v_mul_f32 v44, v44, v195
    v_mul_f32 v45, v45, v195
    v_mul_f32 v46, v46, v195
    v_mul_f32 v47, v47, v195
    v_cvt_pk_bf16_f32 v12, v40, v41
    v_lshlrev_b32 v40, 16, v12
    v_and_b32 v41, 0xffff0000, v12
    v_cvt_pk_bf16_f32 v12, v42, v43
    v_lshlrev_b32 v42, 16, v12
    v_and_b32 v43, 0xffff0000, v12
    v_cvt_pk_bf16_f32 v12, v44, v45
    v_lshlrev_b32 v44, 16, v12
    v_and_b32 v45, 0xffff0000, v12
    v_cvt_pk_bf16_f32 v12, v46, v47
    v_lshlrev_b32 v46, 16, v12
    v_and_b32 v47, 0xffff0000, v12
    v_lshlrev_b32 v48, 16, v84
    v_and_b32 v49, 0xffff0000, v84
    v_lshlrev_b32 v50, 16, v85
    v_and_b32 v51, 0xffff0000, v85
    v_lshlrev_b32 v52, 16, v86
    v_and_b32 v53, 0xffff0000, v86
    v_lshlrev_b32 v54, 16, v87
    v_and_b32 v55, 0xffff0000, v87
    v_pk_mul_f32 v[40:41], v[40:41], v[48:49]
    v_pk_mul_f32 v[42:43], v[42:43], v[50:51]
    v_pk_mul_f32 v[44:45], v[44:45], v[52:53]
    v_pk_mul_f32 v[46:47], v[46:47], v[54:55]
    v_cvt_pk_bf16_f32 v12, v40, v41
    v_lshlrev_b32 v40, 16, v12
    v_and_b32 v41, 0xffff0000, v12
    v_cvt_pk_bf16_f32 v12, v42, v43
    v_lshlrev_b32 v42, 16, v12
    v_and_b32 v43, 0xffff0000, v12
    v_cvt_pk_bf16_f32 v12, v44, v45
    v_lshlrev_b32 v44, 16, v12
    v_and_b32 v45, 0xffff0000, v12
    v_cvt_pk_bf16_f32 v12, v46, v47
    v_lshlrev_b32 v46, 16, v12
    v_and_b32 v47, 0xffff0000, v12
    v_lshlrev_b32 v48, 16, v76
    v_and_b32 v49, 0xffff0000, v76
    v_lshlrev_b32 v50, 16, v77
    v_and_b32 v51, 0xffff0000, v77
    v_lshlrev_b32 v52, 16, v78
    v_and_b32 v53, 0xffff0000, v78
    v_lshlrev_b32 v54, 16, v79
    v_and_b32 v55, 0xffff0000, v79
    v_pk_add_f32 v[40:41], v[40:41], v[48:49]
    v_pk_add_f32 v[42:43], v[42:43], v[50:51]
    v_pk_add_f32 v[44:45], v[44:45], v[52:53]
    v_pk_add_f32 v[46:47], v[46:47], v[54:55]
    v_cvt_pk_bf16_f32 v12, v40, v41
    v_lshlrev_b32 v40, 16, v12
    v_and_b32 v41, 0xffff0000, v12
    v_cvt_pk_bf16_f32 v12, v42, v43
    v_lshlrev_b32 v42, 16, v12
    v_and_b32 v43, 0xffff0000, v12
    v_cvt_pk_bf16_f32 v12, v44, v45
    v_lshlrev_b32 v44, 16, v12
    v_and_b32 v45, 0xffff0000, v12
    v_cvt_pk_bf16_f32 v12, v46, v47
    v_lshlrev_b32 v46, 16, v12
    v_and_b32 v47, 0xffff0000, v12
    v_lshlrev_b32 v48, 16, v92
    v_and_b32 v49, 0xffff0000, v92
    v_lshlrev_b32 v50, 16, v93
    v_and_b32 v51, 0xffff0000, v93
    v_lshlrev_b32 v52, 16, v94
    v_and_b32 v53, 0xffff0000, v94
    v_lshlrev_b32 v54, 16, v95
    v_and_b32 v55, 0xffff0000, v95
    v_pk_mul_f32 v[40:41], v[40:41], v[48:49]
    v_pk_mul_f32 v[42:43], v[42:43], v[50:51]
    v_pk_mul_f32 v[44:45], v[44:45], v[52:53]
    v_pk_mul_f32 v[46:47], v[46:47], v[54:55]
    v_cvt_pk_bf16_f32 v12, v40, v41
    v_lshlrev_b32 v40, 16, v12
    v_and_b32 v41, 0xffff0000, v12
    v_cvt_pk_bf16_f32 v12, v42, v43
    v_lshlrev_b32 v42, 16, v12
    v_and_b32 v43, 0xffff0000, v12
    v_cvt_pk_bf16_f32 v12, v44, v45
    v_lshlrev_b32 v44, 16, v12
    v_and_b32 v45, 0xffff0000, v12
    v_cvt_pk_bf16_f32 v12, v46, v47
    v_lshlrev_b32 v46, 16, v12
    v_and_b32 v47, 0xffff0000, v12
    v_pk_add_f32 v[40:41], v[40:41], v[32:33]
    v_pk_add_f32 v[42:43], v[42:43], v[34:35]
    v_pk_add_f32 v[44:45], v[44:45], v[36:37]
    v_pk_add_f32 v[46:47], v[46:47], v[38:39]
    v_cvt_pk_bf16_f32 v60, v40, v41
    v_cvt_pk_bf16_f32 v61, v42, v43
    v_cvt_pk_bf16_f32 v62, v44, v45
    v_cvt_pk_bf16_f32 v63, v46, v47
    v_lshrrev_b32 v15, 6, v7
    v_lshlrev_b32 v15, 10, v15
    v_and_b32 v11, 63, v7
    v_add_u32 v15, v15, v11
    v_lshlrev_b32 v11, 2, v7
    s_mov_b32 s26, 0xa70000
    s_mov_b32 s27, 0
fz_wp:
    buffer_load_dwordx4 v[20:23], v11, s[8:11], s26 offen sc1
    s_waitcnt vmcnt(0)
    v_cmp_eq_u32 vcc, 0, v20
    s_add_u32 s27, s27, 1
    s_cmp_ge_u32 s27, 65536
    s_cbranch_scc1 fz_wg
    s_cbranch_vccz fz_wg
    s_sleep 1
    s_branch fz_wp
fz_wg:
    v_mov_b32 v144, v20
    s_nop 1
    v_max_u32_dpp v144, v144, v144 row_ror:1 row_mask:0xf bank_mask:0xf
    s_nop 1
    v_max_u32_dpp v144, v144, v144 row_ror:2 row_mask:0xf bank_mask:0xf
    s_nop 1
    v_max_u32_dpp v144, v144, v144 row_ror:4 row_mask:0xf bank_mask:0xf
    s_nop 1
    v_max_u32_dpp v144, v144, v144 row_ror:8 row_mask:0xf bank_mask:0xf
    v_mov_b32 v145, v144
    s_nop 1
    v_permlane16_swap_b32 v144, v145
    v_max_u32 v144, v144, v145
    v_mov_b32 v145, v144
    s_nop 1
    v_permlane32_swap_b32 v144, v145
    v_max_u32 v144, v144, v145
    v_cmp_eq_u32 vcc, v144, v20
    v_lshlrev_b32 v11, 4, v16
    s_and_saveexec_b64 s[26:27], vcc
    ds_write_b128 v11, v[20:23] offset:192
    s_mov_b64 exec, s[26:27]
    s_waitcnt lgkmcnt(0)
    s_barrier
    v_and_b32 v11, 3, v0
    v_lshlrev_b32 v11, 4, v11
    ds_read_b32 v144, v11 offset:256
    s_waitcnt lgkmcnt(0)
    v_mov_b32 v145, v144
    s_nop 1
    v_max_u32_dpp v145, v145, v145 row_ror:1 row_mask:0xf bank_mask:0xf
    s_nop 1
    v_max_u32_dpp v145, v145, v145 row_ror:2 row_mask:0xf bank_mask:0xf
    v_cmp_eq_u32 vcc, v144, v145
    s_ff1_i32_b64 s26, vcc
    s_lshl_b32 s26, s26, 4
    v_mov_b32 v11, s26
    ds_read_b128 v[20:23], v11 offset:256
    s_waitcnt lgkmcnt(0)
    v_and_b32 v144, 0x7ff, v20
    v_sub_u32 v144, 2047, v144
    s_nop 0
    v_readfirstlane_b32 s101, v144
    s_lshl_b32 s62, s101, 11
    v_rcp_f32 v167, v22
    s_cmp_lg_u32 s101, s16
    s_cselect_b32 s23, s17, 0x7ffffff0
    s_lshl_b32 s24, s98, 10
    s_add_u32 s24, s62, s24
    s_lshr_b32 s25, s101, 4
    s_lshl_b32 s25, s25, 15
    s_and_b32 s27, s101, 15
    s_lshl_b32 s27, s27, 6
    s_add_u32 s25, s25, s27
    s_add_u32 s25, s25, 0x2000000
    s_lshl_b32 s26, s98, 14
    s_add_u32 s25, s25, s26
    s_add_u32 s26, s25, 0x0
    buffer_load_dword v40, v15, s[8:11], s26 offen sc1
    s_add_u32 s26, s25, 0x400000
    buffer_load_dword v41, v15, s[8:11], s26 offen sc1
    s_add_u32 s26, s25, 0x800000
    buffer_load_dword v42, v15, s[8:11], s26 offen sc1
    s_add_u32 s26, s25, 0xc00000
    buffer_load_dword v43, v15, s[8:11], s26 offen sc1
    buffer_load_dword v166, v7, s[28:31], s24 offen
    s_waitcnt vmcnt(4)
    v_lshlrev_b32 v144, 16, v40
    v_and_b32 v145, 0xffff0000, v40
    s_waitcnt vmcnt(3)
    v_lshlrev_b32 v146, 16, v41
    v_and_b32 v147, 0xffff0000, v41
    v_pk_add_f32 v[128:129], v[144:145], v[146:147]
    s_waitcnt vmcnt(2)
    v_lshlrev_b32 v144, 16, v42
    v_and_b32 v145, 0xffff0000, v42
    v_pk_add_f32 v[128:129], v[144:145], v[128:129]
    s_waitcnt vmcnt(1)
    v_lshlrev_b32 v144, 16, v43
    v_and_b32 v145, 0xffff0000, v43
    v_pk_add_f32 v[128:129], v[144:145], v[128:129]
    s_waitcnt vmcnt(0)
    v_lshlrev_b32 v144, 16, v166
    v_and_b32 v145, 0xffff0000, v166
    v_pk_add_f32 v[128:129], v[144:145], v[128:129]
    v_cvt_pk_bf16_f32 v144, v128, v129
    v_lshlrev_b32 v128, 16, v144
    v_and_b32 v129, 0xffff0000, v144
    v_sub_f32 v128, v128, v21
    v_sub_f32 v129, v129, v21
    v_cvt_pk_bf16_f32 v144, v128, v129
    v_lshlrev_b32 v128, 16, v144
    v_and_b32 v129, 0xffff0000, v144
    v_mul_f32 v145, v128, v167
    v_fma_f32 v128, -v145, v22, v128
    v_fma_f32 v128, v128, v167, v145
    v_mul_f32 v145, v129, v167
    v_fma_f32 v129, -v145, v22, v129
    v_fma_f32 v129, v129, v167, v145
    v_cvt_pk_bf16_f32 v144, v128, v129
    v_lshlrev_b32 v128, 16, v144
    v_and_b32 v129, 0xffff0000, v144
    v_mul_f32 v128, v128, v168
    v_mul_f32 v129, v129, v169
    v_cvt_pk_bf16_f32 v144, v128, v129
    v_lshlrev_b32 v128, 16, v144
    v_and_b32 v129, 0xffff0000, v144
    v_add_f32 v128, v128, v170
    v_add_f32 v129, v129, v171
    v_cvt_pk_bf16_f32 v144, v128, v129
    v_lshlrev_b32 v128, 16, v144
    v_and_b32 v129, 0xffff0000, v144
    v_lshlrev_b32 v11, 1, v7
    ds_write_b64 v11, v[128:129] offset:512
    v_lshlrev_b32 v11, 6, v13
    s_waitcnt lgkmcnt(0)
    ds_read_b128 v[128:131], v11 offset:512
    ds_read_b128 v[132:135], v11 offset:528
    ds_read_b128 v[136:139], v11 offset:544
    ds_read_b128 v[140:143], v11 offset:560
    s_lshl_b32 s26, s97, 1
    s_add_u32 s26, s26, s98
    s_mul_i32 s26, s26, 14336
    s_lshl_b32 s25, s96, 8
    s_add_u32 s26, s26, s25
    s_add_u32 s26, s26, 0xa10000
    s_cmp_lt_u32 s2, 224
    s_cselect_b32 s26, s26, 0x7ffffff0
    s_cmp_eq_u32 s3, 4
    s_cselect_b32 s26, s26, 0x7ffffff0
    s_mov_b32 s25, s26
    s_waitcnt lgkmcnt(3)
    v_lshrrev_b32 v144, 16, v128
    v_dot2_f32_bf16 v157, v204, v128, 0
    v_dot2_f32_bf16 v156, v204, v144, 0
    v_dot2_f32_bf16 v159, v205, v128, 0
    v_dot2_f32_bf16 v158, v205, v144, 0
    v_dot2_f32_bf16 v161, v206, v128, 0
    v_dot2_f32_bf16 v160, v206, v144, 0
    v_dot2_f32_bf16 v163, v207, v128, 0
    v_dot2_f32_bf16 v162, v207, v144, 0
    v_lshrrev_b32 v145, 16, v129
    v_dot2c_f32_bf16 v157, v208, v129
    v_dot2c_f32_bf16 v156, v208, v145
    v_dot2c_f32_bf16 v159, v209, v129
    v_dot2c_f32_bf16 v158, v209, v145
    v_dot2c_f32_bf16 v161, v210, v129
    v_dot2c_f32_bf16 v160, v210, v145
    v_dot2c_f32_bf16 v163, v211, v129
    v_dot2c_f32_bf16 v162, v211, v145
    v_lshrrev_b32 v146, 16, v130
    v_dot2c_f32_bf16 v157, v212, v130
    v_dot2c_f32_bf16 v156, v212, v146
    v_dot2c_f32_bf16 v159, v213, v130
    v_dot2c_f32_bf16 v158, v213, v146
    v_dot2c_f32_bf16 v161, v214, v130
    v_dot2c_f32_bf16 v160, v214, v146
    v_dot2c_f32_bf16 v163, v215, v130
    v_dot2c_f32_bf16 v162, v215, v146
    v_lshrrev_b32 v147, 16, v131
    v_dot2c_f32_bf16 v157, v216, v131
    v_dot2c_f32_bf16 v156, v216, v147
    v_dot2c_f32_bf16 v159, v217, v131
    v_dot2c_f32_bf16 v158, v217, v147
    v_dot2c_f32_bf16 v161, v218, v131
    v_dot2c_f32_bf16 v160, v218, v147
    v_dot2c_f32_bf16 v163, v219, v131
    v_dot2c_f32_bf16 v162, v219, v147
    s_waitcnt lgkmcnt(2)
    v_lshrrev_b32 v148, 16, v132
    v_dot2c_f32_bf16 v157, v220, v132
    v_dot2c_f32_bf16 v156, v220, v148
    v_dot2c_f32_bf16 v159, v221, v132
    v_dot2c_f32_bf16 v158, v221, v148
    v_dot2c_f32_bf16 v161, v222, v132
    v_dot2c_f32_bf16 v160, v222, v148
    v_dot2c_f32_bf16 v163, v223, v132
    v_dot2c_f32_bf16 v162, v223, v148
    v_lshrrev_b32 v149, 16, v133
    v_dot2c_f32_bf16 v157, v224, v133
    v_dot2c_f32_bf16 v156, v224, v149
    v_dot2c_f32_bf16 v159, v225, v133
    v_dot2c_f32_bf16 v158, v225, v149
    v_dot2c_f32_bf16 v161, v226, v133
    v_dot2c_f32_bf16 v160, v226, v149
    v_dot2c_f32_bf16 v163, v227, v133
    v_dot2c_f32_bf16 v162, v227, v149
    v_lshrrev_b32 v150, 16, v134
    v_dot2c_f32_bf16 v157, v228, v134
    v_dot2c_f32_bf16 v156, v228, v150
    v_dot2c_f32_bf16 v159, v229, v134
    v_dot2c_f32_bf16 v158, v229, v150
    v_dot2c_f32_bf16 v161, v230, v134
    v_dot2c_f32_bf16 v160, v230, v150
    v_dot2c_f32_bf16 v163, v231, v134
    v_dot2c_f32_bf16 v162, v231, v150
    v_lshrrev_b32 v151, 16, v135
    v_dot2c_f32_bf16 v157, v232, v135
    v_dot2c_f32_bf16 v156, v232, v151
    v_dot2c_f32_bf16 v159, v233, v135
    v_dot2c_f32_bf16 v158, v233, v151
    v_dot2c_f32_bf16 v161, v234, v135
    v_dot2c_f32_bf16 v160, v234, v151
    v_dot2c_f32_bf16 v163, v235, v135
    v_dot2c_f32_bf16 v162, v235, v151
    s_waitcnt lgkmcnt(1)
    v_lshrrev_b32 v144, 16, v136
    v_dot2c_f32_bf16 v157, v236, v136
    v_dot2c_f32_bf16 v156, v236, v144
    v_dot2c_f32_bf16 v159, v237, v136
    v_dot2c_f32_bf16 v158, v237, v144
    v_dot2c_f32_bf16 v161, v238, v136
    v_dot2c_f32_bf16 v160, v238, v144
    v_dot2c_f32_bf16 v163, v239, v136
    v_dot2c_f32_bf16 v162, v239, v144
    v_lshrrev_b32 v145, 16, v137
    v_dot2c_f32_bf16 v157, v240, v137
    v_dot2c_f32_bf16 v156, v240, v145
    v_dot2c_f32_bf16 v159, v241, v137
    v_dot2c_f32_bf16 v158, v241, v145
    v_dot2c_f32_bf16 v161, v242, v137
    v_dot2c_f32_bf16 v160, v242, v145
    v_dot2c_f32_bf16 v163, v243, v137
    v_dot2c_f32_bf16 v162, v243, v145
    v_lshrrev_b32 v146, 16, v138
    v_dot2c_f32_bf16 v157, v244, v138
    v_dot2c_f32_bf16 v156, v244, v146
    v_dot2c_f32_bf16 v159, v245, v138
    v_dot2c_f32_bf16 v158, v245, v146
    v_dot2c_f32_bf16 v161, v246, v138
    v_dot2c_f32_bf16 v160, v246, v146
    v_dot2c_f32_bf16 v163, v247, v138
    v_dot2c_f32_bf16 v162, v247, v146
    v_lshrrev_b32 v147, 16, v139
    v_dot2c_f32_bf16 v157, v248, v139
    v_dot2c_f32_bf16 v156, v248, v147
    v_dot2c_f32_bf16 v159, v249, v139
    v_dot2c_f32_bf16 v158, v249, v147
    v_dot2c_f32_bf16 v161, v250, v139
    v_dot2c_f32_bf16 v160, v250, v147
    v_dot2c_f32_bf16 v163, v251, v139
    v_dot2c_f32_bf16 v162, v251, v147
    s_waitcnt lgkmcnt(0)
    v_lshrrev_b32 v148, 16, v140
    v_dot2c_f32_bf16 v157, v252, v140
    v_dot2c_f32_bf16 v156, v252, v148
    v_dot2c_f32_bf16 v159, v253, v140
    v_dot2c_f32_bf16 v158, v253, v148
    v_dot2c_f32_bf16 v161, v254, v140
    v_dot2c_f32_bf16 v160, v254, v148
    v_dot2c_f32_bf16 v163, v255, v140
    v_dot2c_f32_bf16 v162, v255, v148
    v_lshrrev_b32 v149, 16, v141
    v_dot2c_f32_bf16 v157, v180, v141
    v_dot2c_f32_bf16 v156, v180, v149
    v_dot2c_f32_bf16 v159, v181, v141
    v_dot2c_f32_bf16 v158, v181, v149
    v_dot2c_f32_bf16 v161, v182, v141
    v_dot2c_f32_bf16 v160, v182, v149
    v_dot2c_f32_bf16 v163, v183, v141
    v_dot2c_f32_bf16 v162, v183, v149
    v_lshrrev_b32 v150, 16, v142
    v_dot2c_f32_bf16 v157, v184, v142
    v_dot2c_f32_bf16 v156, v184, v150
    v_dot2c_f32_bf16 v159, v185, v142
    v_dot2c_f32_bf16 v158, v185, v150
    v_dot2c_f32_bf16 v161, v186, v142
    v_dot2c_f32_bf16 v160, v186, v150
    v_dot2c_f32_bf16 v163, v187, v142
    v_dot2c_f32_bf16 v162, v187, v150
    v_lshrrev_b32 v151, 16, v143
    v_dot2c_f32_bf16 v157, v172, v143
    v_dot2c_f32_bf16 v156, v172, v151
    v_dot2c_f32_bf16 v159, v173, v143
    v_dot2c_f32_bf16 v158, v173, v151
    v_dot2c_f32_bf16 v161, v174, v143
    v_dot2c_f32_bf16 v160, v174, v151
    v_dot2c_f32_bf16 v163, v175, v143
    v_dot2c_f32_bf16 v162, v175, v151
    s_nop 0
    v_permlane32_swap_b32 v156, v160
    v_permlane32_swap_b32 v157, v161
    v_permlane32_swap_b32 v158, v162
    v_permlane32_swap_b32 v159, v163
    v_add_f32 v156, v156, v160
    v_add_f32 v157, v157, v161
    v_add_f32 v158, v158, v162
    v_add_f32 v159, v159, v163
    s_nop 0
    v_permlane16_swap_b32 v156, v158
    v_permlane16_swap_b32 v157, v159
    v_add_f32 v156, v156, v158
    v_add_f32 v157, v157, v159
    s_nop 0
    v_add_f32_dpp v156, v156, v156 row_ror:8 row_mask:0xf bank_mask:0xf
    v_add_f32_dpp v157, v157, v157 row_ror:8 row_mask:0xf bank_mask:0xf
    ds_write_b64 v2, v[156:157] offset:4096
    s_waitcnt lgkmcnt(0)
    s_barrier
    ds_read_b32 v156, v4 offset:4096
    ds_read_b32 v157, v4 offset:4352
    ds_read_b32 v158, v4 offset:4608
    ds_read_b32 v159, v4 offset:4864
    s_waitcnt lgkmcnt(1)
    v_add_f32 v156, v156, v158
    s_waitcnt lgkmcnt(0)
    v_add_f32 v157, v157, v159
    v_add_f32 v156, v156, v157
    v_or_b32 v156, 1, v156
    buffer_store_dword v156, v4, s[8:11], s25 offen sc1
    s_cmp_lg_u32 s101, s16
    s_cselect_b32 s23, s17, 0x7ffffff0
    buffer_store_dwordx4 v[56:59], v1, s[64:67], s23 offen offset:0 sc1
    buffer_store_dwordx4 v[60:63], v1, s[64:67], s23 offen offset:1024 sc1
    s_branch fz_end
fz_dn:
    v_sub_f32 v40, v24, v192
    v_sub_f32 v41, v25, v192
    v_sub_f32 v42, v26, v192
    v_sub_f32 v43, v27, v192
    v_sub_f32 v44, v28, v192
    v_sub_f32 v45, v29, v192
    v_sub_f32 v46, v30, v192
    v_sub_f32 v47, v31, v192
    v_cvt_pk_bf16_f32 v12, v40, v41
    v_lshlrev_b32 v40, 16, v12
    v_and_b32 v41, 0xffff0000, v12
    v_cvt_pk_bf16_f32 v12, v42, v43
    v_lshlrev_b32 v42, 16, v12
    v_and_b32 v43, 0xffff0000, v12
    v_cvt_pk_bf16_f32 v12, v44, v45
    v_lshlrev_b32 v44, 16, v12
    v_and_b32 v45, 0xffff0000, v12
    v_cvt_pk_bf16_f32 v12, v46, v47
    v_lshlrev_b32 v46, 16, v12
    v_and_b32 v47, 0xffff0000, v12
    v_mul_f32 v40, v40, v195
    v_mul_f32 v41, v41, v195
    v_mul_f32 v42, v42, v195
    v_mul_f32 v43, v43, v195
    v_mul_f32 v44, v44, v195
    v_mul_f32 v45, v45, v195
    v_mul_f32 v46, v46, v195
    v_mul_f32 v47, v47, v195
    v_cvt_pk_bf16_f32 v12, v40, v41
    v_lshlrev_b32 v40, 16, v12
    v_and_b32 v41, 0xffff0000, v12
    v_cvt_pk_bf16_f32 v12, v42, v43
    v_lshlrev_b32 v42, 16, v12
    v_and_b32 v43, 0xffff0000, v12
    v_cvt_pk_bf16_f32 v12, v44, v45
    v_lshlrev_b32 v44, 16, v12
    v_and_b32 v45, 0xffff0000, v12
    v_cvt_pk_bf16_f32 v12, v46, v47
    v_lshlrev_b32 v46, 16, v12
    v_and_b32 v47, 0xffff0000, v12
    v_lshlrev_b32 v48, 16, v80
    v_and_b32 v49, 0xffff0000, v80
    v_lshlrev_b32 v50, 16, v81
    v_and_b32 v51, 0xffff0000, v81
    v_lshlrev_b32 v52, 16, v82
    v_and_b32 v53, 0xffff0000, v82
    v_lshlrev_b32 v54, 16, v83
    v_and_b32 v55, 0xffff0000, v83
    v_pk_mul_f32 v[40:41], v[40:41], v[48:49]
    v_pk_mul_f32 v[42:43], v[42:43], v[50:51]
    v_pk_mul_f32 v[44:45], v[44:45], v[52:53]
    v_pk_mul_f32 v[46:47], v[46:47], v[54:55]
    v_cvt_pk_bf16_f32 v12, v40, v41
    v_lshlrev_b32 v40, 16, v12
    v_and_b32 v41, 0xffff0000, v12
    v_cvt_pk_bf16_f32 v12, v42, v43
    v_lshlrev_b32 v42, 16, v12
    v_and_b32 v43, 0xffff0000, v12
    v_cvt_pk_bf16_f32 v12, v44, v45
    v_lshlrev_b32 v44, 16, v12
    v_and_b32 v45, 0xffff0000, v12
    v_cvt_pk_bf16_f32 v12, v46, v47
    v_lshlrev_b32 v46, 16, v12
    v_and_b32 v47, 0xffff0000, v12
    v_lshlrev_b32 v48, 16, v72
    v_and_b32 v49, 0xffff0000, v72
    v_lshlrev_b32 v50, 16, v73
    v_and_b32 v51, 0xffff0000, v73
    v_lshlrev_b32 v52, 16, v74
    v_and_b32 v53, 0xffff0000, v74
    v_lshlrev_b32 v54, 16, v75
    v_and_b32 v55, 0xffff0000, v75
    v_pk_add_f32 v[40:41], v[40:41], v[48:49]
    v_pk_add_f32 v[42:43], v[42:43], v[50:51]
    v_pk_add_f32 v[44:45], v[44:45], v[52:53]
    v_pk_add_f32 v[46:47], v[46:47], v[54:55]
    v_cvt_pk_bf16_f32 v12, v40, v41
    v_lshlrev_b32 v40, 16, v12
    v_and_b32 v41, 0xffff0000, v12
    v_cvt_pk_bf16_f32 v12, v42, v43
    v_lshlrev_b32 v42, 16, v12
    v_and_b32 v43, 0xffff0000, v12
    v_cvt_pk_bf16_f32 v12, v44, v45
    v_lshlrev_b32 v44, 16, v12
    v_and_b32 v45, 0xffff0000, v12
    v_cvt_pk_bf16_f32 v12, v46, v47
    v_lshlrev_b32 v46, 16, v12
    v_and_b32 v47, 0xffff0000, v12
    v_lshlrev_b32 v48, 16, v88
    v_and_b32 v49, 0xffff0000, v88
    v_lshlrev_b32 v50, 16, v89
    v_and_b32 v51, 0xffff0000, v89
    v_lshlrev_b32 v52, 16, v90
    v_and_b32 v53, 0xffff0000, v90
    v_lshlrev_b32 v54, 16, v91
    v_and_b32 v55, 0xffff0000, v91
    v_pk_mul_f32 v[40:41], v[40:41], v[48:49]
    v_pk_mul_f32 v[42:43], v[42:43], v[50:51]
    v_pk_mul_f32 v[44:45], v[44:45], v[52:53]
    v_pk_mul_f32 v[46:47], v[46:47], v[54:55]
    v_cvt_pk_bf16_f32 v12, v40, v41
    v_lshlrev_b32 v40, 16, v12
    v_and_b32 v41, 0xffff0000, v12
    v_cvt_pk_bf16_f32 v12, v42, v43
    v_lshlrev_b32 v42, 16, v12
    v_and_b32 v43, 0xffff0000, v12
    v_cvt_pk_bf16_f32 v12, v44, v45
    v_lshlrev_b32 v44, 16, v12
    v_and_b32 v45, 0xffff0000, v12
    v_cvt_pk_bf16_f32 v12, v46, v47
    v_lshlrev_b32 v46, 16, v12
    v_and_b32 v47, 0xffff0000, v12
    v_pk_add_f32 v[40:41], v[40:41], v[24:25]
    v_pk_add_f32 v[42:43], v[42:43], v[26:27]
    v_pk_add_f32 v[44:45], v[44:45], v[28:29]
    v_pk_add_f32 v[46:47], v[46:47], v[30:31]
    v_cvt_pk_bf16_f32 v56, v40, v41
    v_cvt_pk_bf16_f32 v57, v42, v43
    v_cvt_pk_bf16_f32 v58, v44, v45
    v_cvt_pk_bf16_f32 v59, v46, v47
    v_sub_f32 v40, v32, v192
    v_sub_f32 v41, v33, v192
    v_sub_f32 v42, v34, v192
    v_sub_f32 v43, v35, v192
    v_sub_f32 v44, v36, v192
    v_sub_f32 v45, v37, v192
    v_sub_f32 v46, v38, v192
    v_sub_f32 v47, v39, v192
    v_cvt_pk_bf16_f32 v12, v40, v41
    v_lshlrev_b32 v40, 16, v12
    v_and_b32 v41, 0xffff0000, v12
    v_cvt_pk_bf16_f32 v12, v42, v43
    v_lshlrev_b32 v42, 16, v12
    v_and_b32 v43, 0xffff0000, v12
    v_cvt_pk_bf16_f32 v12, v44, v45
    v_lshlrev_b32 v44, 16, v12
    v_and_b32 v45, 0xffff0000, v12
    v_cvt_pk_bf16_f32 v12, v46, v47
    v_lshlrev_b32 v46, 16, v12
    v_and_b32 v47, 0xffff0000, v12
    v_mul_f32 v40, v40, v195
    v_mul_f32 v41, v41, v195
    v_mul_f32 v42, v42, v195
    v_mul_f32 v43, v43, v195
    v_mul_f32 v44, v44, v195
    v_mul_f32 v45, v45, v195
    v_mul_f32 v46, v46, v195
    v_mul_f32 v47, v47, v195
    v_cvt_pk_bf16_f32 v12, v40, v41
    v_lshlrev_b32 v40, 16, v12
    v_and_b32 v41, 0xffff0000, v12
    v_cvt_pk_bf16_f32 v12, v42, v43
    v_lshlrev_b32 v42, 16, v12
    v_and_b32 v43, 0xffff0000, v12
    v_cvt_pk_bf16_f32 v12, v44, v45
    v_lshlrev_b32 v44, 16, v12
    v_and_b32 v45, 0xffff0000, v12
    v_cvt_pk_bf16_f32 v12, v46, v47
    v_lshlrev_b32 v46, 16, v12
    v_and_b32 v47, 0xffff0000, v12
    v_lshlrev_b32 v48, 16, v84
    v_and_b32 v49, 0xffff0000, v84
    v_lshlrev_b32 v50, 16, v85
    v_and_b32 v51, 0xffff0000, v85
    v_lshlrev_b32 v52, 16, v86
    v_and_b32 v53, 0xffff0000, v86
    v_lshlrev_b32 v54, 16, v87
    v_and_b32 v55, 0xffff0000, v87
    v_pk_mul_f32 v[40:41], v[40:41], v[48:49]
    v_pk_mul_f32 v[42:43], v[42:43], v[50:51]
    v_pk_mul_f32 v[44:45], v[44:45], v[52:53]
    v_pk_mul_f32 v[46:47], v[46:47], v[54:55]
    v_cvt_pk_bf16_f32 v12, v40, v41
    v_lshlrev_b32 v40, 16, v12
    v_and_b32 v41, 0xffff0000, v12
    v_cvt_pk_bf16_f32 v12, v42, v43
    v_lshlrev_b32 v42, 16, v12
    v_and_b32 v43, 0xffff0000, v12
    v_cvt_pk_bf16_f32 v12, v44, v45
    v_lshlrev_b32 v44, 16, v12
    v_and_b32 v45, 0xffff0000, v12
    v_cvt_pk_bf16_f32 v12, v46, v47
    v_lshlrev_b32 v46, 16, v12
    v_and_b32 v47, 0xffff0000, v12
    v_lshlrev_b32 v48, 16, v76
    v_and_b32 v49, 0xffff0000, v76
    v_lshlrev_b32 v50, 16, v77
    v_and_b32 v51, 0xffff0000, v77
    v_lshlrev_b32 v52, 16, v78
    v_and_b32 v53, 0xffff0000, v78
    v_lshlrev_b32 v54, 16, v79
    v_and_b32 v55, 0xffff0000, v79
    v_pk_add_f32 v[40:41], v[40:41], v[48:49]
    v_pk_add_f32 v[42:43], v[42:43], v[50:51]
    v_pk_add_f32 v[44:45], v[44:45], v[52:53]
    v_pk_add_f32 v[46:47], v[46:47], v[54:55]
    v_cvt_pk_bf16_f32 v12, v40, v41
    v_lshlrev_b32 v40, 16, v12
    v_and_b32 v41, 0xffff0000, v12
    v_cvt_pk_bf16_f32 v12, v42, v43
    v_lshlrev_b32 v42, 16, v12
    v_and_b32 v43, 0xffff0000, v12
    v_cvt_pk_bf16_f32 v12, v44, v45
    v_lshlrev_b32 v44, 16, v12
    v_and_b32 v45, 0xffff0000, v12
    v_cvt_pk_bf16_f32 v12, v46, v47
    v_lshlrev_b32 v46, 16, v12
    v_and_b32 v47, 0xffff0000, v12
    v_lshlrev_b32 v48, 16, v92
    v_and_b32 v49, 0xffff0000, v92
    v_lshlrev_b32 v50, 16, v93
    v_and_b32 v51, 0xffff0000, v93
    v_lshlrev_b32 v52, 16, v94
    v_and_b32 v53, 0xffff0000, v94
    v_lshlrev_b32 v54, 16, v95
    v_and_b32 v55, 0xffff0000, v95
    v_pk_mul_f32 v[40:41], v[40:41], v[48:49]
    v_pk_mul_f32 v[42:43], v[42:43], v[50:51]
    v_pk_mul_f32 v[44:45], v[44:45], v[52:53]
    v_pk_mul_f32 v[46:47], v[46:47], v[54:55]
    v_cvt_pk_bf16_f32 v12, v40, v41
    v_lshlrev_b32 v40, 16, v12
    v_and_b32 v41, 0xffff0000, v12
    v_cvt_pk_bf16_f32 v12, v42, v43
    v_lshlrev_b32 v42, 16, v12
    v_and_b32 v43, 0xffff0000, v12
    v_cvt_pk_bf16_f32 v12, v44, v45
    v_lshlrev_b32 v44, 16, v12
    v_and_b32 v45, 0xffff0000, v12
    v_cvt_pk_bf16_f32 v12, v46, v47
    v_lshlrev_b32 v46, 16, v12
    v_and_b32 v47, 0xffff0000, v12
    v_pk_add_f32 v[40:41], v[40:41], v[32:33]
    v_pk_add_f32 v[42:43], v[42:43], v[34:35]
    v_pk_add_f32 v[44:45], v[44:45], v[36:37]
    v_pk_add_f32 v[46:47], v[46:47], v[38:39]
    v_cvt_pk_bf16_f32 v60, v40, v41
    v_cvt_pk_bf16_f32 v61, v42, v43
    v_cvt_pk_bf16_f32 v62, v44, v45
    v_cvt_pk_bf16_f32 v63, v46, v47
    s_barrier
    v_and_b32 v11, 3, v0
    v_lshlrev_b32 v11, 4, v11
    ds_read_b32 v144, v11 offset:256
    s_waitcnt lgkmcnt(0)
    v_mov_b32 v145, v144
    s_nop 1
    v_max_u32_dpp v145, v145, v145 row_ror:1 row_mask:0xf bank_mask:0xf
    s_nop 1
    v_max_u32_dpp v145, v145, v145 row_ror:2 row_mask:0xf bank_mask:0xf
    v_cmp_eq_u32 vcc, v144, v145
    s_ff1_i32_b64 s26, vcc
    s_lshl_b32 s26, s26, 4
    v_mov_b32 v11, s26
    ds_read_b128 v[20:23], v11 offset:256
    s_waitcnt lgkmcnt(0)
    v_and_b32 v144, 0x7ff, v20
    v_sub_u32 v144, 2047, v144
    s_nop 0
    v_readfirstlane_b32 s101, v144
    s_lshl_b32 s62, s101, 11
    v_rcp_f32 v167, v22
    s_cmp_lg_u32 s101, s16
    s_cselect_b32 s23, s17, 0x7ffffff0
    s_add_u32 s62, s62, s18
    v_lshlrev_b32 v12, 1, v0
    s_lshr_b32 s25, s101, 4
    s_lshl_b32 s25, s25, 15
    s_and_b32 s27, s101, 15
    s_lshl_b32 s27, s27, 6
    s_add_u32 s25, s25, s27
    s_add_u32 s25, s25, 0x2000000
    s_lshl_b32 s26, s99, 11
    s_add_u32 s25, s25, s26
    v_lshrrev_b32 v15, 5, v0
    v_lshlrev_b32 v15, 10, v15
    v_and_b32 v11, 63, v12
    v_add_u32 v15, v15, v11
    s_add_u32 s26, s25, 0x0
    buffer_load_ushort v40, v15, s[8:11], s26 offen sc1
    s_add_u32 s26, s25, 0x400000
    buffer_load_ushort v41, v15, s[8:11], s26 offen sc1
    s_add_u32 s26, s25, 0x800000
    buffer_load_ushort v42, v15, s[8:11], s26 offen sc1
    s_add_u32 s26, s25, 0xc00000
    buffer_load_ushort v43, v15, s[8:11], s26 offen sc1
    buffer_load_ushort v44, v12, s[28:31], s62 offen
    buffer_store_dwordx4 v[56:59], v1, s[64:67], s23 offen offset:0 sc1
    buffer_store_dwordx4 v[60:63], v1, s[64:67], s23 offen offset:1024 sc1
    v_min_u32 v7, 223, v17
    v_lshlrev_b32 v7, 2, v7
    s_mul_i32 s24, s100, 896
    s_add_u32 s24, s24, 0xa10000
    v_mul_u32_u24 v11, 28, v13
    s_barrier
    s_mov_b32 s27, 0
fz_ap:
    s_add_u32 s25, s24, 0
    buffer_load_dword v120, v7, s[8:11], s25 offen sc1
    s_add_u32 s25, s24, 14336
    buffer_load_dword v121, v7, s[8:11], s25 offen sc1
    s_add_u32 s25, s24, 28672
    buffer_load_dword v122, v7, s[8:11], s25 offen sc1
    s_add_u32 s25, s24, 43008
    buffer_load_dword v123, v7, s[8:11], s25 offen sc1
    s_waitcnt vmcnt(2)
    v_min_u32 v124, v120, v121
    s_waitcnt vmcnt(0)
    v_min3_u32 v124, v124, v122, v123
    v_cmp_eq_u32 vcc, 0, v124
    s_add_u32 s27, s27, 1
    s_cmp_ge_u32 s27, 65536
    s_cbranch_scc1 fz_ag
    s_cbranch_vccz fz_ag
    s_branch fz_ap
fz_ag:
    v_add_f32 v120, v120, v121
    v_add_f32 v122, v122, v123
    v_cvt_pk_bf16_f32 v124, v120, v122
    v_lshlrev_b32 v120, 16, v124
    v_and_b32 v122, 0xffff0000, v124
    v_mul_f32 v124, 0xbfb8aa3b, v120
    v_exp_f32 v124, v124
    s_nop 0
    v_add_f32 v124, 1.0, v124
    v_rcp_f32 v124, v124
    s_nop 0
    v_mul_f32 v120, v120, v124
    v_cvt_pk_bf16_f32 v120, v120, v120
    v_lshlrev_b32 v120, 16, v120
    v_mul_f32 v120, v120, v122
    v_cvt_pk_bf16_f32 v120, v120, v120
    v_lshlrev_b32 v120, 16, v120
    ds_write_b32 v5, v120 offset:8192
    s_waitcnt lgkmcnt(0)
    s_barrier
    ds_read_b32 v128, v11 offset:8192
    ds_read_b32 v129, v11 offset:8196
    ds_read_b32 v130, v11 offset:8200
    ds_read_b32 v131, v11 offset:8204
    ds_read_b32 v132, v11 offset:8208
    ds_read_b32 v133, v11 offset:8212
    ds_read_b32 v134, v11 offset:8216
    s_lshl_b32 s24, s99, 12
    s_add_u32 s24, s24, 0xa00000
    s_lshl_b32 s25, s100, 8
    s_add_u32 s25, s25, s24
    s_waitcnt lgkmcnt(6)
    v_lshrrev_b32 v144, 16, v128
    v_dot2_f32_bf16 v157, v204, v128, 0
    v_dot2_f32_bf16 v156, v204, v144, 0
    v_dot2_f32_bf16 v159, v205, v128, 0
    v_dot2_f32_bf16 v158, v205, v144, 0
    v_dot2_f32_bf16 v161, v206, v128, 0
    v_dot2_f32_bf16 v160, v206, v144, 0
    v_dot2_f32_bf16 v163, v207, v128, 0
    v_dot2_f32_bf16 v162, v207, v144, 0
    s_waitcnt lgkmcnt(5)
    v_lshrrev_b32 v145, 16, v129
    v_dot2c_f32_bf16 v157, v208, v129
    v_dot2c_f32_bf16 v156, v208, v145
    v_dot2c_f32_bf16 v159, v209, v129
    v_dot2c_f32_bf16 v158, v209, v145
    v_dot2c_f32_bf16 v161, v210, v129
    v_dot2c_f32_bf16 v160, v210, v145
    v_dot2c_f32_bf16 v163, v211, v129
    v_dot2c_f32_bf16 v162, v211, v145
    s_waitcnt lgkmcnt(4)
    v_lshrrev_b32 v146, 16, v130
    v_dot2c_f32_bf16 v157, v212, v130
    v_dot2c_f32_bf16 v156, v212, v146
    v_dot2c_f32_bf16 v159, v213, v130
    v_dot2c_f32_bf16 v158, v213, v146
    v_dot2c_f32_bf16 v161, v214, v130
    v_dot2c_f32_bf16 v160, v214, v146
    v_dot2c_f32_bf16 v163, v215, v130
    v_dot2c_f32_bf16 v162, v215, v146
    s_waitcnt lgkmcnt(3)
    v_lshrrev_b32 v147, 16, v131
    v_dot2c_f32_bf16 v157, v216, v131
    v_dot2c_f32_bf16 v156, v216, v147
    v_dot2c_f32_bf16 v159, v217, v131
    v_dot2c_f32_bf16 v158, v217, v147
    v_dot2c_f32_bf16 v161, v218, v131
    v_dot2c_f32_bf16 v160, v218, v147
    v_dot2c_f32_bf16 v163, v219, v131
    v_dot2c_f32_bf16 v162, v219, v147
    s_waitcnt lgkmcnt(2)
    v_lshrrev_b32 v148, 16, v132
    v_dot2c_f32_bf16 v157, v220, v132
    v_dot2c_f32_bf16 v156, v220, v148
    v_dot2c_f32_bf16 v159, v221, v132
    v_dot2c_f32_bf16 v158, v221, v148
    v_dot2c_f32_bf16 v161, v222, v132
    v_dot2c_f32_bf16 v160, v222, v148
    v_dot2c_f32_bf16 v163, v223, v132
    v_dot2c_f32_bf16 v162, v223, v148
    s_waitcnt lgkmcnt(1)
    v_lshrrev_b32 v149, 16, v133
    v_dot2c_f32_bf16 v157, v224, v133
    v_dot2c_f32_bf16 v156, v224, v149
    v_dot2c_f32_bf16 v159, v225, v133
    v_dot2c_f32_bf16 v158, v225, v149
    v_dot2c_f32_bf16 v161, v226, v133
    v_dot2c_f32_bf16 v160, v226, v149
    v_dot2c_f32_bf16 v163, v227, v133
    v_dot2c_f32_bf16 v162, v227, v149
    s_waitcnt lgkmcnt(0)
    v_lshrrev_b32 v150, 16, v134
    v_dot2c_f32_bf16 v157, v228, v134
    v_dot2c_f32_bf16 v156, v228, v150
    v_dot2c_f32_bf16 v159, v229, v134
    v_dot2c_f32_bf16 v158, v229, v150
    v_dot2c_f32_bf16 v161, v230, v134
    v_dot2c_f32_bf16 v160, v230, v150
    v_dot2c_f32_bf16 v163, v231, v134
    v_dot2c_f32_bf16 v162, v231, v150
    s_nop 0
    v_permlane32_swap_b32 v156, v160
    v_permlane32_swap_b32 v157, v161
    v_permlane32_swap_b32 v158, v162
    v_permlane32_swap_b32 v159, v163
    v_add_f32 v156, v156, v160
    v_add_f32 v157, v157, v161
    v_add_f32 v158, v158, v162
    v_add_f32 v159, v159, v163
    s_nop 0
    v_permlane16_swap_b32 v156, v158
    v_permlane16_swap_b32 v157, v159
    v_add_f32 v156, v156, v158
    v_add_f32 v157, v157, v159
    s_nop 0
    v_add_f32_dpp v156, v156, v156 row_ror:8 row_mask:0xf bank_mask:0xf
    v_add_f32_dpp v157, v157, v157 row_ror:8 row_mask:0xf bank_mask:0xf
    ds_write_b64 v2, v[156:157] offset:12288
    s_waitcnt lgkmcnt(0)
    s_barrier
    ds_read_b32 v156, v4 offset:12288
    ds_read_b32 v157, v4 offset:12544
    ds_read_b32 v158, v4 offset:12800
    ds_read_b32 v159, v4 offset:13056
    s_waitcnt lgkmcnt(1)
    v_add_f32 v156, v156, v158
    s_waitcnt lgkmcnt(0)
    v_add_f32 v157, v157, v159
    v_add_f32 v156, v156, v157
    v_or_b32 v156, 1, v156
    s_cmp_lg_u32 s3, 0
    s_cbranch_scc1 fz_end
    buffer_store_dword v156, v4, s[8:11], s25 offen sc1
    s_cmp_lg_u32 s100, 15
    s_cbranch_scc1 fz_end
    v_mov_b32 v190, v23
    v_cvt_pk_bf16_f32 v190, v190, v190
    v_lshlrev_b32 v190, 16, v190
    v_mul_f32 v190, 0xbfb8aa3b, v190
    v_exp_f32 v190, v190
    s_nop 0
    v_add_f32 v190, 1.0, v190
    v_rcp_f32 v190, v190
    s_nop 0
    v_cvt_pk_bf16_f32 v190, v190, v190
    v_lshlrev_b32 v190, 16, v190
    v_lshlrev_b32 v40, 16, v40
    v_lshlrev_b32 v41, 16, v41
    v_lshlrev_b32 v42, 16, v42
    v_lshlrev_b32 v43, 16, v43
    v_lshlrev_b32 v44, 16, v44
    v_add_f32 v188, v40, v41
    v_add_f32 v188, v188, v42
    v_add_f32 v188, v188, v43
    v_add_f32 v188, v44, v188
    v_cvt_pk_bf16_f32 v188, v188, v188
    v_lshlrev_b32 v188, 16, v188
    v_mov_b32 v189, v188
    v_mov_b32 v191, v188
    v_sub_f32 v189, v189, v21
    v_sub_f32 v191, v191, v21
    v_cvt_pk_bf16_f32 v148, v189, v191
    v_lshlrev_b32 v189, 16, v148
    v_and_b32 v191, 0xffff0000, v148
    v_mul_f32 v149, v189, v167
    v_fma_f32 v189, -v149, v22, v189
    v_fma_f32 v189, v189, v167, v149
    v_mul_f32 v149, v191, v167
    v_fma_f32 v191, -v149, v22, v191
    v_fma_f32 v191, v191, v167, v149
    v_cvt_pk_bf16_f32 v148, v189, v191
    v_lshlrev_b32 v189, 16, v148
    v_and_b32 v191, 0xffff0000, v148
    v_mul_f32 v189, v189, v125
    v_mul_f32 v191, v191, v125
    v_cvt_pk_bf16_f32 v148, v189, v191
    v_lshlrev_b32 v189, 16, v148
    v_and_b32 v191, 0xffff0000, v148
    v_add_f32 v189, v189, v126
    v_add_f32 v191, v191, v126
    v_cvt_pk_bf16_f32 v189, v189, v189
    v_lshlrev_b32 v189, 16, v189
    s_mov_b32 s27, 0
fz_yp:
    buffer_load_dword v104, v4, s[8:11], s24 offen offset:0 sc1
    buffer_load_dword v105, v4, s[8:11], s24 offen offset:256 sc1
    buffer_load_dword v106, v4, s[8:11], s24 offen offset:512 sc1
    buffer_load_dword v107, v4, s[8:11], s24 offen offset:768 sc1
    buffer_load_dword v108, v4, s[8:11], s24 offen offset:1024 sc1
    buffer_load_dword v109, v4, s[8:11], s24 offen offset:1280 sc1
    buffer_load_dword v110, v4, s[8:11], s24 offen offset:1536 sc1
    buffer_load_dword v111, v4, s[8:11], s24 offen offset:1792 sc1
    buffer_load_dword v112, v4, s[8:11], s24 offen offset:2048 sc1
    buffer_load_dword v113, v4, s[8:11], s24 offen offset:2304 sc1
    buffer_load_dword v114, v4, s[8:11], s24 offen offset:2560 sc1
    buffer_load_dword v115, v4, s[8:11], s24 offen offset:2816 sc1
    buffer_load_dword v116, v4, s[8:11], s24 offen offset:3072 sc1
    buffer_load_dword v117, v4, s[8:11], s24 offen offset:3328 sc1
    buffer_load_dword v118, v4, s[8:11], s24 offen offset:3584 sc1
    s_waitcnt vmcnt(12)
    v_min3_u32 v7, v104, v105, v106
    s_waitcnt vmcnt(10)
    v_min3_u32 v7, v7, v107, v108
    s_waitcnt vmcnt(8)
    v_min3_u32 v7, v7, v109, v110
    s_waitcnt vmcnt(6)
    v_min3_u32 v7, v7, v111, v112
    s_waitcnt vmcnt(4)
    v_min3_u32 v7, v7, v113, v114
    s_waitcnt vmcnt(2)
    v_min3_u32 v7, v7, v115, v116
    s_waitcnt vmcnt(0)
    v_min3_u32 v7, v7, v117, v118
    v_cmp_eq_u32 vcc, 0, v7
    s_add_u32 s27, s27, 1
    s_cmp_ge_u32 s27, 65536
    s_cbranch_scc1 fz_yg
    s_cbranch_vccz fz_yg
    s_branch fz_yp
fz_yg:
    v_mov_b32 v119, v156
    v_add_f32 v104, v104, v112
    v_add_f32 v105, v105, v113
    v_add_f32 v106, v106, v114
    v_add_f32 v107, v107, v115
    v_add_f32 v108, v108, v116
    v_add_f32 v109, v109, v117
    v_add_f32 v110, v110, v118
    v_add_f32 v111, v111, v119
    v_add_f32 v104, v104, v108
    v_add_f32 v105, v105, v109
    v_add_f32 v106, v106, v110
    v_add_f32 v107, v107, v111
    v_add_f32 v104, v104, v106
    v_add_f32 v105, v105, v107
    v_add_f32 v104, v104, v105
    v_cvt_pk_bf16_f32 v104, v104, v104
    v_lshlrev_b32 v104, 16, v104
    v_mul_f32 v104, v104, v190
    v_cvt_pk_bf16_f32 v104, v104, v104
    v_lshlrev_b32 v104, 16, v104
    v_add_f32 v104, v104, v189
    v_cvt_pk_bf16_f32 v104, v104, v104
    v_lshlrev_b32 v104, 16, v104
    v_mul_f32 v104, v104, v127
    v_cvt_pk_bf16_f32 v104, v104, v104
    v_lshlrev_b32 v104, 16, v104
    v_add_f32 v104, v104, v188
    v_cvt_pk_bf16_f32 v104, v104, v104
    buffer_store_short v104, v12, s[64:67], s62 offen sc1
    s_cmp_lg_u32 s99, 0
    s_cbranch_scc1 fz_end
    s_mov_b32 s26, 0x570000
    v_mov_b32 v7, s14
    s_mov_b64 exec, 1
    buffer_store_dword v7, v6, s[8:11], s26 offen sc1
    s_mov_b64 exec, -1
    s_branch fz_end
fz_slow:
    s_waitcnt vmcnt(0) lgkmcnt(0)
    s_nop 15
    s_nop 3
    s_cmp_eq_u32 s15, 0x7777
    s_cbranch_scc1 fz_epi
    s_mov_b32 s15, 0x7777
    v_add_u32 v5, s18, v1
    v_mov_b32 v9, 0xff7fffff
    v_mov_b32 v10, 0xff7fffff
    s_mov_b32 s22, 0
fz_s1:
    s_add_u32 s23, s22, 4096
    buffer_load_dwordx4 v[84:87], v5, s[8:11], s22 offen offset:0 sc1
    buffer_load_dwordx4 v[88:91], v5, s[8:11], s22 offen offset:1024 sc1
    buffer_load_dwordx4 v[92:95], v5, s[8:11], s22 offen offset:2048 sc1
    buffer_load_dwordx4 v[96:99], v5, s[8:11], s22 offen offset:3072 sc1
    buffer_load_dwordx4 v[100:103], v5, s[8:11], s23 offen offset:0 sc1
    buffer_load_dwordx4 v[104:107], v5, s[8:11], s23 offen offset:1024 sc1
    buffer_load_dwordx4 v[156:159], v5, s[8:11], s23 offen offset:2048 sc1
    buffer_load_dwordx4 v[160:163], v5, s[8:11], s23 offen offset:3072 sc1
    s_waitcnt vmcnt(7)
    v_mfma_f32_16x16x32_bf16 v[140:143], v[84:87], v[108:111], 0
    v_mfma_f32_16x16x32_bf16 v[144:147], v[84:87], v[124:127], 0
    s_waitcnt vmcnt(6)
    v_mfma_f32_16x16x32_bf16 v[148:151], v[88:91], v[108:111], 0
    v_mfma_f32_16x16x32_bf16 v[152:155], v[88:91], v[124:127], 0
    s_waitcnt vmcnt(5)
    v_mfma_f32_16x16x32_bf16 v[140:143], v[92:95], v[112:115], v[140:143]
    v_mfma_f32_16x16x32_bf16 v[144:147], v[92:95], v[128:131], v[144:147]
    s_waitcnt vmcnt(4)
    v_mfma_f32_16x16x32_bf16 v[148:151], v[96:99], v[112:115], v[148:151]
    v_mfma_f32_16x16x32_bf16 v[152:155], v[96:99], v[128:131], v[152:155]
    s_waitcnt vmcnt(3)
    v_mfma_f32_16x16x32_bf16 v[140:143], v[100:103], v[116:119], v[140:143]
    v_mfma_f32_16x16x32_bf16 v[144:147], v[100:103], v[132:135], v[144:147]
    s_waitcnt vmcnt(2)
    v_mfma_f32_16x16x32_bf16 v[148:151], v[104:107], v[116:119], v[148:151]
    v_mfma_f32_16x16x32_bf16 v[152:155], v[104:107], v[132:135], v[152:155]
    s_waitcnt vmcnt(1)
    v_mfma_f32_16x16x32_bf16 v[140:143], v[156:159], v[120:123], v[140:143]
    v_mfma_f32_16x16x32_bf16 v[144:147], v[156:159], v[136:139], v[144:147]
    s_waitcnt vmcnt(0)
    v_mfma_f32_16x16x32_bf16 v[148:151], v[160:163], v[120:123], v[148:151]
    v_mfma_f32_16x16x32_bf16 v[152:155], v[160:163], v[136:139], v[152:155]
    s_nop 3
    v_max3_f32 v9, v9, v140, v141
    v_max3_f32 v9, v9, v142, v143
    v_max3_f32 v10, v10, v144, v145
    v_max3_f32 v10, v10, v146, v147
    v_max3_f32 v9, v9, v148, v149
    v_max3_f32 v9, v9, v150, v151
    v_max3_f32 v10, v10, v152, v153
    v_max3_f32 v10, v10, v154, v155
    s_add_u32 s22, s22, 16384
    s_cmp_lt_u32 s22, 0x40000
    s_cbranch_scc1 fz_s1
    v_mov_b32 v11, v9
    v_mov_b32 v12, v10
    s_nop 0
    v_permlane16_swap_b32 v9, v11
    v_permlane16_swap_b32 v10, v12
    v_max_f32 v9, v9, v11
    v_max_f32 v10, v10, v12
    v_mov_b32 v11, v9
    v_mov_b32 v12, v10
    s_nop 0
    v_permlane32_swap_b32 v9, v11
    v_permlane32_swap_b32 v10, v12
    v_max_f32 v9, v9, v11
    v_max_f32 v10, v10, v12
    v_sub_f32 v172, 0, v9
    v_sub_f32 v173, 0, v9
    v_sub_f32 v174, 0, v9
    v_sub_f32 v175, 0, v9
    v_sub_f32 v176, 0, v10
    v_sub_f32 v177, 0, v10
    v_sub_f32 v178, 0, v10
    v_sub_f32 v179, 0, v10
    v_mov_b32 v20, 0
    v_mov_b32 v21, 0
    v_mov_b32 v22, 0
    v_mov_b32 v23, 0
    v_mov_b32 v24, 0
    v_mov_b32 v25, 0
    v_mov_b32 v26, 0
    v_mov_b32 v27, 0
    v_mov_b32 v28, 0
    v_mov_b32 v29, 0
    v_mov_b32 v30, 0
    v_mov_b32 v31, 0
    v_mov_b32 v32, 0
    v_mov_b32 v33, 0
    v_mov_b32 v34, 0
    v_mov_b32 v35, 0
    v_mov_b32 v36, 0
    v_mov_b32 v37, 0
    v_mov_b32 v38, 0
    v_mov_b32 v39, 0
    v_mov_b32 v40, 0
    v_mov_b32 v41, 0
    v_mov_b32 v42, 0
    v_mov_b32 v43, 0
    v_mov_b32 v44, 0
    v_mov_b32 v45, 0
    v_mov_b32 v46, 0
    v_mov_b32 v47, 0
    v_mov_b32 v48, 0
    v_mov_b32 v49, 0
    v_mov_b32 v50, 0
    v_mov_b32 v51, 0
    v_mov_b32 v52, 0
    v_mov_b32 v53, 0
    v_mov_b32 v54, 0
    v_mov_b32 v55, 0
    v_mov_b32 v56, 0
    v_mov_b32 v57, 0
    v_mov_b32 v58, 0
    v_mov_b32 v59, 0
    v_mov_b32 v60, 0
    v_mov_b32 v61, 0
    v_mov_b32 v62, 0
    v_mov_b32 v63, 0
    v_mov_b32 v64, 0
    v_mov_b32 v65, 0
    v_mov_b32 v66, 0
    v_mov_b32 v67, 0
    v_mov_b32 v68, 0
    v_mov_b32 v69, 0
    v_mov_b32 v70, 0
    v_mov_b32 v71, 0
    v_mov_b32 v72, 0
    v_mov_b32 v73, 0
    v_mov_b32 v74, 0
    v_mov_b32 v75, 0
    v_mov_b32 v76, 0
    v_mov_b32 v77, 0
    v_mov_b32 v78, 0
    v_mov_b32 v79, 0
    v_mov_b32 v80, 0
    v_mov_b32 v81, 0
    v_mov_b32 v82, 0
    v_mov_b32 v83, 0
    v_mov_b32 v15, 0
    v_mov_b32 v16, 0
    s_mov_b32 s22, 0
fz_s2:
    s_add_u32 s23, s22, 4096
    buffer_load_dwordx4 v[84:87], v5, s[8:11], s22 offen offset:0 sc1
    buffer_load_dwordx4 v[88:91], v5, s[8:11], s22 offen offset:1024 sc1
    buffer_load_dwordx4 v[92:95], v5, s[8:11], s22 offen offset:2048 sc1
    buffer_load_dwordx4 v[96:99], v5, s[8:11], s22 offen offset:3072 sc1
    buffer_load_dwordx4 v[100:103], v5, s[8:11], s23 offen offset:0 sc1
    buffer_load_dwordx4 v[104:107], v5, s[8:11], s23 offen offset:1024 sc1
    buffer_load_dwordx4 v[156:159], v5, s[8:11], s23 offen offset:2048 sc1
    buffer_load_dwordx4 v[160:163], v5, s[8:11], s23 offen offset:3072 sc1
    s_waitcnt vmcnt(7)
    v_mfma_f32_16x16x32_bf16 v[140:143], v[84:87], v[108:111], v[172:175]
    v_mfma_f32_16x16x32_bf16 v[144:147], v[84:87], v[124:127], v[176:179]
    s_waitcnt vmcnt(6)
    v_mfma_f32_16x16x32_bf16 v[148:151], v[88:91], v[108:111], v[172:175]
    v_mfma_f32_16x16x32_bf16 v[152:155], v[88:91], v[124:127], v[176:179]
    s_waitcnt vmcnt(5)
    v_mfma_f32_16x16x32_bf16 v[140:143], v[92:95], v[112:115], v[140:143]
    v_mfma_f32_16x16x32_bf16 v[144:147], v[92:95], v[128:131], v[144:147]
    s_waitcnt vmcnt(4)
    v_mfma_f32_16x16x32_bf16 v[148:151], v[96:99], v[112:115], v[148:151]
    v_mfma_f32_16x16x32_bf16 v[152:155], v[96:99], v[128:131], v[152:155]
    s_waitcnt vmcnt(3)
    v_mfma_f32_16x16x32_bf16 v[140:143], v[100:103], v[116:119], v[140:143]
    v_mfma_f32_16x16x32_bf16 v[144:147], v[100:103], v[132:135], v[144:147]
    s_waitcnt vmcnt(2)
    v_mfma_f32_16x16x32_bf16 v[148:151], v[104:107], v[116:119], v[148:151]
    v_mfma_f32_16x16x32_bf16 v[152:155], v[104:107], v[132:135], v[152:155]
    s_waitcnt vmcnt(1)
    v_mfma_f32_16x16x32_bf16 v[140:143], v[156:159], v[120:123], v[140:143]
    v_mfma_f32_16x16x32_bf16 v[144:147], v[156:159], v[136:139], v[144:147]
    s_waitcnt vmcnt(0)
    v_mfma_f32_16x16x32_bf16 v[148:151], v[160:163], v[120:123], v[148:151]
    v_mfma_f32_16x16x32_bf16 v[152:155], v[160:163], v[136:139], v[152:155]
    s_add_u32 s26, s22, 8192
    s_add_u32 s23, s22, 12288
    buffer_load_dwordx4 v[84:87], v5, s[8:11], s26 offen offset:0 sc1
    buffer_load_dwordx4 v[88:91], v5, s[8:11], s26 offen offset:1024 sc1
    buffer_load_dwordx4 v[92:95], v5, s[8:11], s26 offen offset:2048 sc1
    buffer_load_dwordx4 v[96:99], v5, s[8:11], s26 offen offset:3072 sc1
    buffer_load_dwordx4 v[100:103], v5, s[8:11], s23 offen offset:0 sc1
    buffer_load_dwordx4 v[104:107], v5, s[8:11], s23 offen offset:1024 sc1
    buffer_load_dwordx4 v[156:159], v5, s[8:11], s23 offen offset:2048 sc1
    buffer_load_dwordx4 v[160:163], v5, s[8:11], s23 offen offset:3072 sc1
    v_exp_f32 v140, v140
    v_exp_f32 v141, v141
    v_add_f32 v15, v15, v140
    v_add_f32 v15, v15, v141
    v_cvt_pk_bf16_f32 v188, v140, v141
    v_exp_f32 v142, v142
    v_exp_f32 v143, v143
    v_add_f32 v15, v15, v142
    v_add_f32 v15, v15, v143
    v_cvt_pk_bf16_f32 v189, v142, v143
    v_exp_f32 v144, v144
    v_exp_f32 v145, v145
    v_add_f32 v16, v16, v144
    v_add_f32 v16, v16, v145
    v_cvt_pk_bf16_f32 v192, v144, v145
    v_exp_f32 v146, v146
    v_exp_f32 v147, v147
    v_add_f32 v16, v16, v146
    v_add_f32 v16, v16, v147
    v_cvt_pk_bf16_f32 v193, v146, v147
    v_exp_f32 v148, v148
    v_exp_f32 v149, v149
    v_add_f32 v15, v15, v148
    v_add_f32 v15, v15, v149
    v_cvt_pk_bf16_f32 v190, v148, v149
    v_exp_f32 v150, v150
    v_exp_f32 v151, v151
    v_add_f32 v15, v15, v150
    v_add_f32 v15, v15, v151
    v_cvt_pk_bf16_f32 v191, v150, v151
    v_exp_f32 v152, v152
    v_exp_f32 v153, v153
    v_add_f32 v16, v16, v152
    v_add_f32 v16, v16, v153
    v_cvt_pk_bf16_f32 v194, v152, v153
    v_exp_f32 v154, v154
    v_exp_f32 v155, v155
    v_add_f32 v16, v16, v154
    v_add_f32 v16, v16, v155
    v_cvt_pk_bf16_f32 v195, v154, v155
    s_waitcnt vmcnt(7)
    v_mfma_f32_16x16x32_bf16 v[20:23], v[84:87], v[188:191], v[20:23]
    v_mfma_f32_16x16x32_bf16 v[24:27], v[84:87], v[192:195], v[24:27]
    s_waitcnt vmcnt(6)
    v_mfma_f32_16x16x32_bf16 v[28:31], v[88:91], v[188:191], v[28:31]
    v_mfma_f32_16x16x32_bf16 v[32:35], v[88:91], v[192:195], v[32:35]
    s_waitcnt vmcnt(5)
    v_mfma_f32_16x16x32_bf16 v[36:39], v[92:95], v[188:191], v[36:39]
    v_mfma_f32_16x16x32_bf16 v[40:43], v[92:95], v[192:195], v[40:43]
    s_waitcnt vmcnt(4)
    v_mfma_f32_16x16x32_bf16 v[44:47], v[96:99], v[188:191], v[44:47]
    v_mfma_f32_16x16x32_bf16 v[48:51], v[96:99], v[192:195], v[48:51]
    s_waitcnt vmcnt(3)
    v_mfma_f32_16x16x32_bf16 v[52:55], v[100:103], v[188:191], v[52:55]
    v_mfma_f32_16x16x32_bf16 v[56:59], v[100:103], v[192:195], v[56:59]
    s_waitcnt vmcnt(2)
    v_mfma_f32_16x16x32_bf16 v[60:63], v[104:107], v[188:191], v[60:63]
    v_mfma_f32_16x16x32_bf16 v[64:67], v[104:107], v[192:195], v[64:67]
    s_waitcnt vmcnt(1)
    v_mfma_f32_16x16x32_bf16 v[68:71], v[156:159], v[188:191], v[68:71]
    v_mfma_f32_16x16x32_bf16 v[72:75], v[156:159], v[192:195], v[72:75]
    s_waitcnt vmcnt(0)
    v_mfma_f32_16x16x32_bf16 v[76:79], v[160:163], v[188:191], v[76:79]
    v_mfma_f32_16x16x32_bf16 v[80:83], v[160:163], v[192:195], v[80:83]
    s_add_u32 s22, s22, 16384
    s_cmp_lt_u32 s22, 0x40000
    s_cbranch_scc1 fz_s2
    s_waitcnt vmcnt(0) lgkmcnt(0)
    s_nop 15
    s_nop 3
    s_branch fz_chk
fz_end:
    s_endpgm
.section .rodata,"a"
.p2align 6
.amdhsa_kernel adaLN_cond__sliding_block_cached__moe_arch_mod__prompt_kernel
  .amdhsa_next_free_vgpr 256
  .amdhsa_next_free_sgpr 102
  .amdhsa_accum_offset 256
  .amdhsa_group_segment_fixed_size 0
  .amdhsa_kernarg_size 120
  .amdhsa_user_sgpr_count 2
  .amdhsa_user_sgpr_kernarg_segment_ptr 1
  .amdhsa_system_sgpr_workgroup_id_x 1
  .amdhsa_float_denorm_mode_32 3
.end_amdhsa_kernel
```

```asm
; @launch grid=(256,1,1) block=(512,1,1) lds=163840
.amdgcn_target "amdgcn-amd-amdhsa--gfx950"
.text
.globl adaLN_cond__sliding_block_cached__moe_arch_mod__prompt_kernel
.p2align 8
.type adaLN_cond__sliding_block_cached__moe_arch_mod__prompt_kernel,@function
adaLN_cond__sliding_block_cached__moe_arch_mod__prompt_kernel:
fz_start:
    s_cmp_ge_u32 s2, 256
    s_cbranch_scc1 fz_end
    s_load_dwordx16 s[32:47], s[0:1], 0
    s_load_dwordx8 s[48:55], s[0:1], 64
    s_load_dwordx4 s[56:59], s[0:1], 96
    s_load_dwordx2 s[60:61], s[0:1], 112
    s_and_b32 s12, s2, 3
    s_lshl_b32 s12, s12, 3
    s_bfe_u32 s13, s2, 0x30003
    s_add_u32 s12, s12, s13
    s_bfe_u32 s13, s2, 0x10002
    s_lshl_b32 s13, s13, 2
    s_lshr_b32 s19, s2, 6
    s_add_u32 s13, s13, s19
    s_mov_b32 s15, 0
    v_and_b32 v8, 255, v0
    v_lshrrev_b32 v9, 6, v0
    v_and_b32 v0, 63, v0
    v_readfirstlane_b32 s3, v9
    v_lshlrev_b32 v1, 4, v0
    s_mov_b32 s10, 0x3400000
    s_mov_b32 s11, 0x20000
    s_lshl_b32 s19, s13, 3
    s_add_u32 s19, s19, s3
    s_lshl_b32 s20, s19, 16
    v_add_u32 v4, s20, v1
    v_bfe_u32 v9, v0, 2, 2
    v_lshrrev_b32 v10, 4, v0
    v_and_b32 v11, 3, v0
    v_bfe_u32 v13, v0, 4, 1
    v_lshlrev_b32 v3, 11, v10
    v_lshl_add_u32 v3, v9, 6, v3
    v_lshl_add_u32 v3, v11, 3, v3
    v_lshlrev_b32 v16, 5, v13
    v_sub_u32 v15, v3, v16
    v_add_u32 v3, v3, v16
    v_lshlrev_b32 v2, 6, v10
    v_lshl_add_u32 v2, v11, 4, v2
    v_lshl_add_u32 v2, v9, 13, v2
    v_xor_b32 v16, 32, v2
    s_lshr_b32 s18, s12, 3
    s_lshl_b32 s18, s18, 18
    s_add_u32 s18, s18, 0x400000
    v_add_u32 v5, s18, v1
    v_mov_b32 v17, 0
    v_mov_b32 v18, 0
    v_mov_b32 v19, 0
    s_lshl_b32 s16, s3, 17
    s_lshl_b32 s17, s3, 12
    s_cmp_ge_u32 s3, 4
    s_cbranch_scc1 fz_roleB
    v_and_b32 v20, 7, v8
    v_bfe_u32 v26, v8, 3, 3
    v_lshlrev_b32 v22, 4, v26
    s_lshl_b32 s19, s3, 9
    v_add_u32 v22, s19, v22
    v_lshl_add_u32 v21, v20, 11, v22
    v_mov_b32 v25, 0
    s_lshl_b32 s25, s2, 14
    s_waitcnt lgkmcnt(0)
    s_mov_b64 s[8:9], s[60:61]
    s_mov_b64 s[28:29], s[32:33]
    s_mov_b32 s30, 0x400000
    s_mov_b32 s31, 0x20000
    s_barrier
    buffer_load_dwordx4 v[36:39], v21, s[28:31], s25 offen offset:0
    buffer_load_dwordx4 v[40:43], v21, s[28:31], s25 offen offset:128
    buffer_load_dwordx4 v[44:47], v21, s[28:31], s25 offen offset:256
    buffer_load_dwordx4 v[48:51], v21, s[28:31], s25 offen offset:384
    s_mov_b32 s27, 0x570000
    buffer_load_dword v24, v25, s[8:11], s27 offen sc1
    s_lshl_b32 s19, s12, 8
    s_add_u32 s4, s38, s19
    s_addc_u32 s5, s39, 0
    s_sub_u32 s6, 0x800000, s19
    s_mov_b32 s7, 0x20000
    s_waitcnt vmcnt(4)
    v_lshlrev_b32 v52, 16, v36
    v_and_b32 v53, 0xffff0000, v36
    v_lshlrev_b32 v54, 16, v37
    v_and_b32 v55, 0xffff0000, v37
    v_lshlrev_b32 v56, 16, v38
    v_and_b32 v57, 0xffff0000, v38
    v_lshlrev_b32 v58, 16, v39
    v_and_b32 v59, 0xffff0000, v39
    s_waitcnt vmcnt(3)
    v_lshlrev_b32 v60, 16, v40
    v_and_b32 v61, 0xffff0000, v40
    v_lshlrev_b32 v62, 16, v41
    v_and_b32 v63, 0xffff0000, v41
    v_lshlrev_b32 v64, 16, v42
    v_and_b32 v65, 0xffff0000, v42
    v_lshlrev_b32 v66, 16, v43
    v_and_b32 v67, 0xffff0000, v43
    s_waitcnt vmcnt(2)
    v_lshlrev_b32 v68, 16, v44
    v_and_b32 v69, 0xffff0000, v44
    v_lshlrev_b32 v70, 16, v45
    v_and_b32 v71, 0xffff0000, v45
    v_lshlrev_b32 v72, 16, v46
    v_and_b32 v73, 0xffff0000, v46
    v_lshlrev_b32 v74, 16, v47
    v_and_b32 v75, 0xffff0000, v47
    s_waitcnt vmcnt(1)
    v_lshlrev_b32 v76, 16, v48
    v_and_b32 v77, 0xffff0000, v48
    v_lshlrev_b32 v78, 16, v49
    v_and_b32 v79, 0xffff0000, v49
    v_lshlrev_b32 v80, 16, v50
    v_and_b32 v81, 0xffff0000, v50
    v_lshlrev_b32 v82, 16, v51
    v_and_b32 v83, 0xffff0000, v51
    s_waitcnt vmcnt(0)
    v_readfirstlane_b32 s14, v24
    s_add_u32 s14, s14, 1
    v_lshlrev_b32 v30, 5, v20
    s_lshl_b32 s19, s3, 3
    v_add_u32 v23, s19, v30
    v_add_f32 v31, v52, v53
    v_add_f32 v32, v54, v55
    v_add_f32 v31, v31, v56
    v_add_f32 v32, v32, v57
    v_add_f32 v31, v31, v58
    v_add_f32 v32, v32, v59
    v_add_f32 v31, v31, v60
    v_add_f32 v32, v32, v61
    v_add_f32 v31, v31, v62
    v_add_f32 v32, v32, v63
    v_add_f32 v31, v31, v64
    v_add_f32 v32, v32, v65
    v_add_f32 v31, v31, v66
    v_add_f32 v32, v32, v67
    v_add_f32 v31, v31, v68
    v_add_f32 v32, v32, v69
    v_add_f32 v31, v31, v70
    v_add_f32 v32, v32, v71
    v_add_f32 v31, v31, v72
    v_add_f32 v32, v32, v73
    v_add_f32 v31, v31, v74
    v_add_f32 v32, v32, v75
    v_add_f32 v31, v31, v76
    v_add_f32 v32, v32, v77
    v_add_f32 v31, v31, v78
    v_add_f32 v32, v32, v79
    v_add_f32 v31, v31, v80
    v_add_f32 v32, v32, v81
    v_add_f32 v31, v31, v82
    v_add_f32 v32, v32, v83
    v_add_f32 v26, v31, v32
    s_nop 1
    v_add_f32_dpp v26, v26, v26 row_ror:8 row_mask:0xf bank_mask:0xf
    v_mov_b32 v148, v26
    s_nop 1
    v_permlane16_swap_b32 v26, v148
    v_add_f32 v26, v26, v148
    v_mov_b32 v148, v26
    s_nop 1
    v_permlane32_swap_b32 v26, v148
    v_add_f32 v26, v26, v148
    v_mul_f32 v26, 0x3b800000, v26
    v_sub_f32 v28, v52, v26
    v_mul_f32 v31, v28, v28
    v_sub_f32 v29, v53, v26
    v_mul_f32 v32, v29, v29
    v_sub_f32 v28, v54, v26
    v_sub_f32 v29, v55, v26
    v_fmac_f32 v31, v28, v28
    v_fmac_f32 v32, v29, v29
    v_sub_f32 v28, v56, v26
    v_sub_f32 v29, v57, v26
    v_fmac_f32 v31, v28, v28
    v_fmac_f32 v32, v29, v29
    v_sub_f32 v28, v58, v26
    v_sub_f32 v29, v59, v26
    v_fmac_f32 v31, v28, v28
    v_fmac_f32 v32, v29, v29
    v_sub_f32 v28, v60, v26
    v_sub_f32 v29, v61, v26
    v_fmac_f32 v31, v28, v28
    v_fmac_f32 v32, v29, v29
    v_sub_f32 v28, v62, v26
    v_sub_f32 v29, v63, v26
    v_fmac_f32 v31, v28, v28
    v_fmac_f32 v32, v29, v29
    v_sub_f32 v28, v64, v26
    v_sub_f32 v29, v65, v26
    v_fmac_f32 v31, v28, v28
    v_fmac_f32 v32, v29, v29
    v_sub_f32 v28, v66, v26
    v_sub_f32 v29, v67, v26
    v_fmac_f32 v31, v28, v28
    v_fmac_f32 v32, v29, v29
    v_sub_f32 v28, v68, v26
    v_sub_f32 v29, v69, v26
    v_fmac_f32 v31, v28, v28
    v_fmac_f32 v32, v29, v29
    v_sub_f32 v28, v70, v26
    v_sub_f32 v29, v71, v26
    v_fmac_f32 v31, v28, v28
    v_fmac_f32 v32, v29, v29
    v_sub_f32 v28, v72, v26
    v_sub_f32 v29, v73, v26
    v_fmac_f32 v31, v28, v28
    v_fmac_f32 v32, v29, v29
    v_sub_f32 v28, v74, v26
    v_sub_f32 v29, v75, v26
    v_fmac_f32 v31, v28, v28
    v_fmac_f32 v32, v29, v29
    v_sub_f32 v28, v76, v26
    v_sub_f32 v29, v77, v26
    v_fmac_f32 v31, v28, v28
    v_fmac_f32 v32, v29, v29
    v_sub_f32 v28, v78, v26
    v_sub_f32 v29, v79, v26
    v_fmac_f32 v31, v28, v28
    v_fmac_f32 v32, v29, v29
    v_sub_f32 v28, v80, v26
    v_sub_f32 v29, v81, v26
    v_fmac_f32 v31, v28, v28
    v_fmac_f32 v32, v29, v29
    v_sub_f32 v28, v82, v26
    v_sub_f32 v29, v83, v26
    v_fmac_f32 v31, v28, v28
    v_fmac_f32 v32, v29, v29
    v_add_f32 v27, v31, v32
    s_nop 1
    v_add_f32_dpp v27, v27, v27 row_ror:8 row_mask:0xf bank_mask:0xf
    v_mov_b32 v148, v27
    s_nop 1
    v_permlane16_swap_b32 v27, v148
    v_add_f32 v27, v27, v148
    v_mov_b32 v148, v27
    s_nop 1
    v_permlane32_swap_b32 v27, v148
    v_add_f32 v27, v27, v148
    v_add_u32 v23, 0x20400, v23
    ds_write_b64 v23, v[26:27]
    v_add_u32 v30, 0x20400, v30
    s_waitcnt lgkmcnt(0)
    s_barrier
    ds_read_b128 v[148:151], v30
    ds_read_b128 v[152:155], v30 offset:16
    s_waitcnt lgkmcnt(1)
    v_add_f32 v31, v148, v150
    s_waitcnt lgkmcnt(0)
    v_add_f32 v32, v152, v154
    v_add_f32 v26, v31, v32
    v_mul_f32 v26, 0x3e800000, v26
    v_add_f32 v31, v149, v151
    v_add_f32 v32, v153, v155
    v_add_f32 v27, v31, v32
    v_sub_f32 v148, v148, v26
    v_sub_f32 v150, v150, v26
    v_sub_f32 v152, v152, v26
    v_sub_f32 v154, v154, v26
    v_mul_f32 v31, v148, v148
    v_fmac_f32 v31, v150, v150
    v_fmac_f32 v31, v152, v152
    v_fmac_f32 v31, v154, v154
    v_fmamk_f32 v27, v31, 0x43800000, v27
    v_mul_f32 v27, 0x3a800000, v27
    v_cvt_pk_bf16_f32 v26, v26, v26
    v_lshlrev_b32 v26, 16, v26
    v_cvt_pk_bf16_f32 v27, v27, v27
    v_lshlrev_b32 v27, 16, v27
    v_add_f32 v27, 0x3727c5ac, v27
    v_cvt_pk_bf16_f32 v27, v27, v27
    v_lshlrev_b32 v27, 16, v27
    v_sqrt_f32 v28, v27
    s_nop 0
    v_cvt_pk_bf16_f32 v28, v28, v28
    v_lshlrev_b32 v28, 16, v28
    v_rcp_f32 v29, v28
    s_nop 0
    v_mov_b32 v28, v29
    v_pk_add_f32 v[52:53], v[52:53], v[26:27] op_sel_hi:[1,0] neg_lo:[0,1] neg_hi:[0,1]
    v_pk_add_f32 v[54:55], v[54:55], v[26:27] op_sel_hi:[1,0] neg_lo:[0,1] neg_hi:[0,1]
    v_pk_add_f32 v[56:57], v[56:57], v[26:27] op_sel_hi:[1,0] neg_lo:[0,1] neg_hi:[0,1]
    v_pk_add_f32 v[58:59], v[58:59], v[26:27] op_sel_hi:[1,0] neg_lo:[0,1] neg_hi:[0,1]
    v_pk_add_f32 v[60:61], v[60:61], v[26:27] op_sel_hi:[1,0] neg_lo:[0,1] neg_hi:[0,1]
    v_pk_add_f32 v[62:63], v[62:63], v[26:27] op_sel_hi:[1,0] neg_lo:[0,1] neg_hi:[0,1]
    v_pk_add_f32 v[64:65], v[64:65], v[26:27] op_sel_hi:[1,0] neg_lo:[0,1] neg_hi:[0,1]
    v_pk_add_f32 v[66:67], v[66:67], v[26:27] op_sel_hi:[1,0] neg_lo:[0,1] neg_hi:[0,1]
    v_pk_add_f32 v[68:69], v[68:69], v[26:27] op_sel_hi:[1,0] neg_lo:[0,1] neg_hi:[0,1]
    v_pk_add_f32 v[70:71], v[70:71], v[26:27] op_sel_hi:[1,0] neg_lo:[0,1] neg_hi:[0,1]
    v_pk_add_f32 v[72:73], v[72:73], v[26:27] op_sel_hi:[1,0] neg_lo:[0,1] neg_hi:[0,1]
    v_pk_add_f32 v[74:75], v[74:75], v[26:27] op_sel_hi:[1,0] neg_lo:[0,1] neg_hi:[0,1]
    v_pk_add_f32 v[76:77], v[76:77], v[26:27] op_sel_hi:[1,0] neg_lo:[0,1] neg_hi:[0,1]
    v_pk_add_f32 v[78:79], v[78:79], v[26:27] op_sel_hi:[1,0] neg_lo:[0,1] neg_hi:[0,1]
    v_pk_add_f32 v[80:81], v[80:81], v[26:27] op_sel_hi:[1,0] neg_lo:[0,1] neg_hi:[0,1]
    v_pk_add_f32 v[82:83], v[82:83], v[26:27] op_sel_hi:[1,0] neg_lo:[0,1] neg_hi:[0,1]
    v_cvt_pk_bf16_f32 v31, v52, v53
    v_lshlrev_b32 v52, 16, v31
    v_and_b32 v53, 0xffff0000, v31
    v_cvt_pk_bf16_f32 v31, v54, v55
    v_lshlrev_b32 v54, 16, v31
    v_and_b32 v55, 0xffff0000, v31
    v_cvt_pk_bf16_f32 v31, v56, v57
    v_lshlrev_b32 v56, 16, v31
    v_and_b32 v57, 0xffff0000, v31
    v_cvt_pk_bf16_f32 v31, v58, v59
    v_lshlrev_b32 v58, 16, v31
    v_and_b32 v59, 0xffff0000, v31
    v_cvt_pk_bf16_f32 v31, v60, v61
    v_lshlrev_b32 v60, 16, v31
    v_and_b32 v61, 0xffff0000, v31
    v_cvt_pk_bf16_f32 v31, v62, v63
    v_lshlrev_b32 v62, 16, v31
    v_and_b32 v63, 0xffff0000, v31
    v_cvt_pk_bf16_f32 v31, v64, v65
    v_lshlrev_b32 v64, 16, v31
    v_and_b32 v65, 0xffff0000, v31
    v_cvt_pk_bf16_f32 v31, v66, v67
    v_lshlrev_b32 v66, 16, v31
    v_and_b32 v67, 0xffff0000, v31
    v_cvt_pk_bf16_f32 v31, v68, v69
    v_lshlrev_b32 v68, 16, v31
    v_and_b32 v69, 0xffff0000, v31
    v_cvt_pk_bf16_f32 v31, v70, v71
    v_lshlrev_b32 v70, 16, v31
    v_and_b32 v71, 0xffff0000, v31
    v_cvt_pk_bf16_f32 v31, v72, v73
    v_lshlrev_b32 v72, 16, v31
    v_and_b32 v73, 0xffff0000, v31
    v_cvt_pk_bf16_f32 v31, v74, v75
    v_lshlrev_b32 v74, 16, v31
    v_and_b32 v75, 0xffff0000, v31
    v_cvt_pk_bf16_f32 v31, v76, v77
    v_lshlrev_b32 v76, 16, v31
    v_and_b32 v77, 0xffff0000, v31
    v_cvt_pk_bf16_f32 v31, v78, v79
    v_lshlrev_b32 v78, 16, v31
    v_and_b32 v79, 0xffff0000, v31
    v_cvt_pk_bf16_f32 v31, v80, v81
    v_lshlrev_b32 v80, 16, v31
    v_and_b32 v81, 0xffff0000, v31
    v_cvt_pk_bf16_f32 v31, v82, v83
    v_lshlrev_b32 v82, 16, v31
    v_and_b32 v83, 0xffff0000, v31
    v_pk_mul_f32 v[52:53], v[52:53], v[28:29] op_sel_hi:[1,0]
    v_pk_mul_f32 v[54:55], v[54:55], v[28:29] op_sel_hi:[1,0]
    v_pk_mul_f32 v[56:57], v[56:57], v[28:29] op_sel_hi:[1,0]
    v_pk_mul_f32 v[58:59], v[58:59], v[28:29] op_sel_hi:[1,0]
    v_pk_mul_f32 v[60:61], v[60:61], v[28:29] op_sel_hi:[1,0]
    v_pk_mul_f32 v[62:63], v[62:63], v[28:29] op_sel_hi:[1,0]
    v_pk_mul_f32 v[64:65], v[64:65], v[28:29] op_sel_hi:[1,0]
    v_pk_mul_f32 v[66:67], v[66:67], v[28:29] op_sel_hi:[1,0]
    v_pk_mul_f32 v[68:69], v[68:69], v[28:29] op_sel_hi:[1,0]
    v_pk_mul_f32 v[70:71], v[70:71], v[28:29] op_sel_hi:[1,0]
    v_pk_mul_f32 v[72:73], v[72:73], v[28:29] op_sel_hi:[1,0]
    v_pk_mul_f32 v[74:75], v[74:75], v[28:29] op_sel_hi:[1,0]
    v_pk_mul_f32 v[76:77], v[76:77], v[28:29] op_sel_hi:[1,0]
    v_pk_mul_f32 v[78:79], v[78:79], v[28:29] op_sel_hi:[1,0]
    v_pk_mul_f32 v[80:81], v[80:81], v[28:29] op_sel_hi:[1,0]
    v_pk_mul_f32 v[82:83], v[82:83], v[28:29] op_sel_hi:[1,0]
    v_cvt_pk_bf16_f32 v31, v52, v53
    v_lshlrev_b32 v52, 16, v31
    v_and_b32 v53, 0xffff0000, v31
    v_cvt_pk_bf16_f32 v31, v54, v55
    v_lshlrev_b32 v54, 16, v31
    v_and_b32 v55, 0xffff0000, v31
    v_cvt_pk_bf16_f32 v31, v56, v57
    v_lshlrev_b32 v56, 16, v31
    v_and_b32 v57, 0xffff0000, v31
    v_cvt_pk_bf16_f32 v31, v58, v59
    v_lshlrev_b32 v58, 16, v31
    v_and_b32 v59, 0xffff0000, v31
    v_cvt_pk_bf16_f32 v31, v60, v61
    v_lshlrev_b32 v60, 16, v31
    v_and_b32 v61, 0xffff0000, v31
    v_cvt_pk_bf16_f32 v31, v62, v63
    v_lshlrev_b32 v62, 16, v31
    v_and_b32 v63, 0xffff0000, v31
    v_cvt_pk_bf16_f32 v31, v64, v65
    v_lshlrev_b32 v64, 16, v31
    v_and_b32 v65, 0xffff0000, v31
    v_cvt_pk_bf16_f32 v31, v66, v67
    v_lshlrev_b32 v66, 16, v31
    v_and_b32 v67, 0xffff0000, v31
    v_cvt_pk_bf16_f32 v31, v68, v69
    v_lshlrev_b32 v68, 16, v31
    v_and_b32 v69, 0xffff0000, v31
    v_cvt_pk_bf16_f32 v31, v70, v71
    v_lshlrev_b32 v70, 16, v31
    v_and_b32 v71, 0xffff0000, v31
    v_cvt_pk_bf16_f32 v31, v72, v73
    v_lshlrev_b32 v72, 16, v31
    v_and_b32 v73, 0xffff0000, v31
    v_cvt_pk_bf16_f32 v31, v74, v75
    v_lshlrev_b32 v74, 16, v31
    v_and_b32 v75, 0xffff0000, v31
    v_cvt_pk_bf16_f32 v31, v76, v77
    v_lshlrev_b32 v76, 16, v31
    v_and_b32 v77, 0xffff0000, v31
    v_cvt_pk_bf16_f32 v31, v78, v79
    v_lshlrev_b32 v78, 16, v31
    v_and_b32 v79, 0xffff0000, v31
    v_cvt_pk_bf16_f32 v31, v80, v81
    v_lshlrev_b32 v80, 16, v31
    v_and_b32 v81, 0xffff0000, v31
    v_cvt_pk_bf16_f32 v31, v82, v83
    v_lshlrev_b32 v82, 16, v31
    v_and_b32 v83, 0xffff0000, v31
    v_lshlrev_b32 v33, 1, v22
    v_add_u32 v33, 0x21000, v33
    v_lshlrev_b32 v23, 4, v22
    v_lshl_add_u32 v23, v20, 4, v23
    s_lshr_b32 s23, s2, 1
    s_lshl_b32 s23, s23, 15
    s_and_b32 s24, s2, 1
    s_lshl_b32 s24, s24, 7
    s_add_u32 s23, s23, s24
    s_barrier
    ds_read_b128 v[84:87], v33 offset:4096
    ds_read_b128 v[116:119], v33 offset:0
    ds_read_b128 v[88:91], v33 offset:4112
    ds_read_b128 v[120:123], v33 offset:16
    ds_read_b128 v[92:95], v33 offset:4352
    ds_read_b128 v[124:127], v33 offset:256
    ds_read_b128 v[96:99], v33 offset:4368
    ds_read_b128 v[128:131], v33 offset:272
    ds_read_b128 v[100:103], v33 offset:4608
    ds_read_b128 v[132:135], v33 offset:512
    ds_read_b128 v[104:107], v33 offset:4624
    ds_read_b128 v[136:139], v33 offset:528
    ds_read_b128 v[108:111], v33 offset:4864
    ds_read_b128 v[140:143], v33 offset:768
    ds_read_b128 v[112:115], v33 offset:4880
    ds_read_b128 v[144:147], v33 offset:784
    s_waitcnt lgkmcnt(15)
    v_pk_mul_f32 v[52:53], v[52:53], v[84:85]
    v_pk_mul_f32 v[54:55], v[54:55], v[86:87]
    s_waitcnt lgkmcnt(13)
    v_pk_mul_f32 v[56:57], v[56:57], v[88:89]
    v_pk_mul_f32 v[58:59], v[58:59], v[90:91]
    v_cvt_pk_bf16_f32 v31, v52, v53
    v_lshlrev_b32 v52, 16, v31
    v_and_b32 v53, 0xffff0000, v31
    v_cvt_pk_bf16_f32 v31, v54, v55
    v_lshlrev_b32 v54, 16, v31
    v_and_b32 v55, 0xffff0000, v31
    v_cvt_pk_bf16_f32 v31, v56, v57
    v_lshlrev_b32 v56, 16, v31
    v_and_b32 v57, 0xffff0000, v31
    v_cvt_pk_bf16_f32 v31, v58, v59
    v_lshlrev_b32 v58, 16, v31
    v_and_b32 v59, 0xffff0000, v31
    v_pk_add_f32 v[52:53], v[52:53], v[116:117]
    v_pk_add_f32 v[54:55], v[54:55], v[118:119]
    s_waitcnt lgkmcnt(12)
    v_pk_add_f32 v[56:57], v[56:57], v[120:121]
    v_pk_add_f32 v[58:59], v[58:59], v[122:123]
    v_cvt_pk_bf16_f32 v36, v52, v53
    v_cvt_pk_bf16_f32 v37, v54, v55
    v_cvt_pk_bf16_f32 v38, v56, v57
    v_cvt_pk_bf16_f32 v39, v58, v59
    s_add_u32 s24, s23, 0
    buffer_store_dwordx4 v[36:39], v23, s[8:11], s24 offen sc1
    s_waitcnt lgkmcnt(11)
    v_pk_mul_f32 v[60:61], v[60:61], v[92:93]
    v_pk_mul_f32 v[62:63], v[62:63], v[94:95]
    s_waitcnt lgkmcnt(9)
    v_pk_mul_f32 v[64:65], v[64:65], v[96:97]
    v_pk_mul_f32 v[66:67], v[66:67], v[98:99]
    v_cvt_pk_bf16_f32 v31, v60, v61
    v_lshlrev_b32 v60, 16, v31
    v_and_b32 v61, 0xffff0000, v31
    v_cvt_pk_bf16_f32 v31, v62, v63
    v_lshlrev_b32 v62, 16, v31
    v_and_b32 v63, 0xffff0000, v31
    v_cvt_pk_bf16_f32 v31, v64, v65
    v_lshlrev_b32 v64, 16, v31
    v_and_b32 v65, 0xffff0000, v31
    v_cvt_pk_bf16_f32 v31, v66, v67
    v_lshlrev_b32 v66, 16, v31
    v_and_b32 v67, 0xffff0000, v31
    v_pk_add_f32 v[60:61], v[60:61], v[124:125]
    v_pk_add_f32 v[62:63], v[62:63], v[126:127]
    s_waitcnt lgkmcnt(8)
    v_pk_add_f32 v[64:65], v[64:65], v[128:129]
    v_pk_add_f32 v[66:67], v[66:67], v[130:131]
    v_cvt_pk_bf16_f32 v40, v60, v61
    v_cvt_pk_bf16_f32 v41, v62, v63
    v_cvt_pk_bf16_f32 v42, v64, v65
    v_cvt_pk_bf16_f32 v43, v66, v67
    s_add_u32 s24, s23, 2048
    buffer_store_dwordx4 v[40:43], v23, s[8:11], s24 offen sc1
    s_waitcnt lgkmcnt(7)
    v_pk_mul_f32 v[68:69], v[68:69], v[100:101]
    v_pk_mul_f32 v[70:71], v[70:71], v[102:103]
    s_waitcnt lgkmcnt(5)
    v_pk_mul_f32 v[72:73], v[72:73], v[104:105]
    v_pk_mul_f32 v[74:75], v[74:75], v[106:107]
    v_cvt_pk_bf16_f32 v31, v68, v69
    v_lshlrev_b32 v68, 16, v31
    v_and_b32 v69, 0xffff0000, v31
    v_cvt_pk_bf16_f32 v31, v70, v71
    v_lshlrev_b32 v70, 16, v31
    v_and_b32 v71, 0xffff0000, v31
    v_cvt_pk_bf16_f32 v31, v72, v73
    v_lshlrev_b32 v72, 16, v31
    v_and_b32 v73, 0xffff0000, v31
    v_cvt_pk_bf16_f32 v31, v74, v75
    v_lshlrev_b32 v74, 16, v31
    v_and_b32 v75, 0xffff0000, v31
    v_pk_add_f32 v[68:69], v[68:69], v[132:133]
    v_pk_add_f32 v[70:71], v[70:71], v[134:135]
    s_waitcnt lgkmcnt(4)
    v_pk_add_f32 v[72:73], v[72:73], v[136:137]
    v_pk_add_f32 v[74:75], v[74:75], v[138:139]
    v_cvt_pk_bf16_f32 v44, v68, v69
    v_cvt_pk_bf16_f32 v45, v70, v71
    v_cvt_pk_bf16_f32 v46, v72, v73
    v_cvt_pk_bf16_f32 v47, v74, v75
    s_add_u32 s24, s23, 4096
    buffer_store_dwordx4 v[44:47], v23, s[8:11], s24 offen sc1
    s_waitcnt lgkmcnt(3)
    v_pk_mul_f32 v[76:77], v[76:77], v[108:109]
    v_pk_mul_f32 v[78:79], v[78:79], v[110:111]
    s_waitcnt lgkmcnt(1)
    v_pk_mul_f32 v[80:81], v[80:81], v[112:113]
    v_pk_mul_f32 v[82:83], v[82:83], v[114:115]
    v_cvt_pk_bf16_f32 v31, v76, v77
    v_lshlrev_b32 v76, 16, v31
    v_and_b32 v77, 0xffff0000, v31
    v_cvt_pk_bf16_f32 v31, v78, v79
    v_lshlrev_b32 v78, 16, v31
    v_and_b32 v79, 0xffff0000, v31
    v_cvt_pk_bf16_f32 v31, v80, v81
    v_lshlrev_b32 v80, 16, v31
    v_and_b32 v81, 0xffff0000, v31
    v_cvt_pk_bf16_f32 v31, v82, v83
    v_lshlrev_b32 v82, 16, v31
    v_and_b32 v83, 0xffff0000, v31
    v_pk_add_f32 v[76:77], v[76:77], v[140:141]
    v_pk_add_f32 v[78:79], v[78:79], v[142:143]
    s_waitcnt lgkmcnt(0)
    v_pk_add_f32 v[80:81], v[80:81], v[144:145]
    v_pk_add_f32 v[82:83], v[82:83], v[146:147]
    v_cvt_pk_bf16_f32 v48, v76, v77
    v_cvt_pk_bf16_f32 v49, v78, v79
    v_cvt_pk_bf16_f32 v50, v80, v81
    v_cvt_pk_bf16_f32 v51, v82, v83
    s_add_u32 s24, s23, 6144
    buffer_store_dwordx4 v[48:51], v23, s[8:11], s24 offen sc1
    s_lshl_b32 s26, s2, 7
    s_lshl_b32 s27, s3, 2
    s_add_u32 s26, s26, s27
    s_add_u32 s26, s26, 0x510000
    v_mov_b32 v24, s14
    s_waitcnt vmcnt(0)
    s_mov_b64 exec, 1
    buffer_store_dword v24, v25, s[8:11], s26 offen sc1
    s_mov_b64 exec, -1
    s_add_u32 s22, s16, 0x0
    s_add_u32 m0, s17, 0x0
    s_nop 0
    buffer_load_dwordx4 v2, s[4:7], s22 offen lds
    s_add_u32 s22, s16, 0x8000
    s_add_u32 m0, s17, 0x400
    s_nop 0
    buffer_load_dwordx4 v2, s[4:7], s22 offen lds
    s_add_u32 s22, s16, 0x10000
    s_add_u32 m0, s17, 0x800
    s_nop 0
    buffer_load_dwordx4 v16, s[4:7], s22 offen lds
    s_add_u32 s22, s16, 0x18000
    s_add_u32 m0, s17, 0xc00
    s_nop 0
    buffer_load_dwordx4 v16, s[4:7], s22 offen lds
    s_add_u32 s22, s16, 0x80000
    s_add_u32 m0, s17, 0x4000
    s_nop 0
    buffer_load_dwordx4 v2, s[4:7], s22 offen lds
    s_add_u32 s22, s16, 0x88000
    s_add_u32 m0, s17, 0x4400
    s_nop 0
    buffer_load_dwordx4 v2, s[4:7], s22 offen lds
    s_add_u32 s22, s16, 0x90000
    s_add_u32 m0, s17, 0x4800
    s_nop 0
    buffer_load_dwordx4 v16, s[4:7], s22 offen lds
    s_add_u32 s22, s16, 0x98000
    s_add_u32 m0, s17, 0x4c00
    s_nop 0
    buffer_load_dwordx4 v16, s[4:7], s22 offen lds
    s_add_u32 s22, s16, 0x100000
    s_add_u32 m0, s17, 0x8000
    s_nop 0
    buffer_load_dwordx4 v2, s[4:7], s22 offen lds
    s_add_u32 s22, s16, 0x108000
    s_add_u32 m0, s17, 0x8400
    s_nop 0
    buffer_load_dwordx4 v2, s[4:7], s22 offen lds
    s_add_u32 s22, s16, 0x110000
    s_add_u32 m0, s17, 0x8800
    s_nop 0
    buffer_load_dwordx4 v16, s[4:7], s22 offen lds
    s_add_u32 s22, s16, 0x118000
    s_add_u32 m0, s17, 0x8c00
    s_nop 0
    buffer_load_dwordx4 v16, s[4:7], s22 offen lds
    s_barrier
    s_lshl_b32 s26, s13, 5
    s_lshl_b32 s25, s3, 2
    s_add_u32 s26, s26, s25
    v_bfe_u32 v9, v0, 2, 2
    v_lshlrev_b32 v9, 7, v9
    v_and_b32 v10, 3, v0
    v_lshl_add_u32 v9, v10, 2, v9
    s_lshl_b32 s26, s26, 7
    s_add_u32 s26, s26, 0x510000
    s_mov_b32 s27, 0
fz_hAp:
    buffer_load_dword v10, v9, s[8:11], s26 offen sc1
    s_waitcnt vmcnt(0)
    v_cmp_ne_u32 vcc, s14, v10
    s_add_u32 s27, s27, 1
    s_cmp_ge_u32 s27, 65536
    s_cbranch_scc1 fz_hAg
    s_cbranch_vccz fz_hAg
    s_sleep 4
    s_branch fz_hAp
fz_hAg:
    s_mov_b32 s23, 0x0
    buffer_load_dwordx4 v[204:207], v4, s[8:11], s23 offen offset:0 sc1
    s_mov_b32 s23, 0x8000
    buffer_load_dwordx4 v[208:211], v4, s[8:11], s23 offen offset:0 sc1
    s_mov_b32 s23, 0x0
    buffer_load_dwordx4 v[212:215], v4, s[8:11], s23 offen offset:1024 sc1
    s_mov_b32 s23, 0x8000
    buffer_load_dwordx4 v[216:219], v4, s[8:11], s23 offen offset:1024 sc1
    s_barrier
    ds_read_b64_tr_b16 v[84:85], v3 offset:0
    ds_read_b64_tr_b16 v[86:87], v3 offset:1024
    ds_read_b64_tr_b16 v[88:89], v15 offset:32
    ds_read_b64_tr_b16 v[90:91], v15 offset:1056
    ds_read_b64_tr_b16 v[92:93], v3 offset:256
    ds_read_b64_tr_b16 v[94:95], v3 offset:1280
    ds_read_b64_tr_b16 v[96:97], v15 offset:288
    ds_read_b64_tr_b16 v[98:99], v15 offset:1312
    s_waitcnt vmcnt(3) lgkmcnt(6)
    v_mfma_f32_16x16x32_bf16 v[20:23], v[84:87], v[204:207], 0
    s_mov_b32 s23, 0x800
    buffer_load_dwordx4 v[220:223], v4, s[8:11], s23 offen offset:0 sc1
    ds_read_b64_tr_b16 v[100:101], v3 offset:512
    s_waitcnt vmcnt(3)
    v_mfma_f32_16x16x32_bf16 v[24:27], v[84:87], v[208:211], 0
    ds_read_b64_tr_b16 v[102:103], v3 offset:1536
    s_waitcnt lgkmcnt(6)
    v_mfma_f32_16x16x32_bf16 v[28:31], v[88:91], v[204:207], 0
    s_mov_b32 s23, 0x8800
    buffer_load_dwordx4 v[224:227], v4, s[8:11], s23 offen offset:0 sc1
    ds_read_b64_tr_b16 v[104:105], v15 offset:544
    v_mfma_f32_16x16x32_bf16 v[32:35], v[88:91], v[208:211], 0
    ds_read_b64_tr_b16 v[106:107], v15 offset:1568
    s_waitcnt lgkmcnt(6)
    v_mfma_f32_16x16x32_bf16 v[36:39], v[92:95], v[204:207], 0
    s_mov_b32 s23, 0x800
    buffer_load_dwordx4 v[228:231], v4, s[8:11], s23 offen offset:1024 sc1
    ds_read_b64_tr_b16 v[84:85], v3 offset:768
    v_mfma_f32_16x16x32_bf16 v[40:43], v[92:95], v[208:211], 0
    ds_read_b64_tr_b16 v[86:87], v3 offset:1792
    s_waitcnt lgkmcnt(6)
    v_mfma_f32_16x16x32_bf16 v[44:47], v[96:99], v[204:207], 0
    s_mov_b32 s23, 0x8800
    buffer_load_dwordx4 v[232:235], v4, s[8:11], s23 offen offset:1024 sc1
    ds_read_b64_tr_b16 v[88:89], v15 offset:800
    v_mfma_f32_16x16x32_bf16 v[48:51], v[96:99], v[208:211], 0
    ds_read_b64_tr_b16 v[90:91], v15 offset:1824
    s_mov_b32 s23, 0x1000
    buffer_load_dwordx4 v[140:143], v4, s[8:11], s23 offen offset:0 sc1
    s_waitcnt lgkmcnt(6)
    v_mfma_f32_16x16x32_bf16 v[52:55], v[100:103], v[204:207], 0
    ds_read_b64_tr_b16 v[92:93], v3 offset:8192
    v_mfma_f32_16x16x32_bf16 v[56:59], v[100:103], v[208:211], 0
    ds_read_b64_tr_b16 v[94:95], v3 offset:9216
    s_waitcnt lgkmcnt(6)
    v_mfma_f32_16x16x32_bf16 v[60:63], v[104:107], v[204:207], 0
    ds_read_b64_tr_b16 v[96:97], v15 offset:8224
    v_mfma_f32_16x16x32_bf16 v[64:67], v[104:107], v[208:211], 0
    ds_read_b64_tr_b16 v[98:99], v15 offset:9248
    s_waitcnt lgkmcnt(6)
    v_mfma_f32_16x16x32_bf16 v[68:71], v[84:87], v[204:207], 0
    ds_read_b64_tr_b16 v[100:101], v3 offset:8448
    v_mfma_f32_16x16x32_bf16 v[72:75], v[84:87], v[208:211], 0
    ds_read_b64_tr_b16 v[102:103], v3 offset:9472
    s_waitcnt lgkmcnt(6)
    v_mfma_f32_16x16x32_bf16 v[76:79], v[88:91], v[204:207], 0
    ds_read_b64_tr_b16 v[104:105], v15 offset:8480
    v_mfma_f32_16x16x32_bf16 v[80:83], v[88:91], v[208:211], 0
    ds_read_b64_tr_b16 v[106:107], v15 offset:9504
    s_mov_b32 s23, 0x9000
    buffer_load_dwordx4 v[144:147], v4, s[8:11], s23 offen offset:0 sc1
    s_waitcnt vmcnt(7) lgkmcnt(6)
    v_mfma_f32_16x16x32_bf16 v[20:23], v[92:95], v[212:215], v[20:23]
    ds_read_b64_tr_b16 v[84:85], v3 offset:8704
    s_waitcnt vmcnt(6)
    v_mfma_f32_16x16x32_bf16 v[24:27], v[92:95], v[216:219], v[24:27]
    ds_read_b64_tr_b16 v[86:87], v3 offset:9728
    s_waitcnt lgkmcnt(6)
    v_mfma_f32_16x16x32_bf16 v[28:31], v[96:99], v[212:215], v[28:31]
    ds_read_b64_tr_b16 v[88:89], v15 offset:8736
    v_mfma_f32_16x16x32_bf16 v[32:35], v[96:99], v[216:219], v[32:35]
    ds_read_b64_tr_b16 v[90:91], v15 offset:9760
    s_waitcnt lgkmcnt(6)
    v_mfma_f32_16x16x32_bf16 v[36:39], v[100:103], v[212:215], v[36:39]
    ds_read_b64_tr_b16 v[92:93], v3 offset:8960
    v_mfma_f32_16x16x32_bf16 v[40:43], v[100:103], v[216:219], v[40:43]
    ds_read_b64_tr_b16 v[94:95], v3 offset:9984
    s_waitcnt lgkmcnt(6)
    v_mfma_f32_16x16x32_bf16 v[44:47], v[104:107], v[212:215], v[44:47]
    ds_read_b64_tr_b16 v[96:97], v15 offset:8992
    v_mfma_f32_16x16x32_bf16 v[48:51], v[104:107], v[216:219], v[48:51]
    ds_read_b64_tr_b16 v[98:99], v15 offset:10016
    s_mov_b32 s23, 0x1000
    buffer_load_dwordx4 v[148:151], v4, s[8:11], s23 offen offset:1024 sc1
    s_waitcnt lgkmcnt(6)
    v_mfma_f32_16x16x32_bf16 v[52:55], v[84:87], v[212:215], v[52:55]
    v_mfma_f32_16x16x32_bf16 v[56:59], v[84:87], v[216:219], v[56:59]
    s_barrier
    ds_read_b64_tr_b16 v[100:101], v3 offset:16384
    ds_read_b64_tr_b16 v[102:103], v3 offset:17408
    s_waitcnt lgkmcnt(6)
    v_mfma_f32_16x16x32_bf16 v[60:63], v[88:91], v[212:215], v[60:63]
    ds_read_b64_tr_b16 v[104:105], v15 offset:16416
    v_mfma_f32_16x16x32_bf16 v[64:67], v[88:91], v[216:219], v[64:67]
    s_add_u32 s22, s16, 0x180000
    s_add_u32 m0, s17, 0xc000
    s_nop 0
    buffer_load_dwordx4 v2, s[4:7], s22 offen lds
    ds_read_b64_tr_b16 v[106:107], v15 offset:17440
    s_waitcnt lgkmcnt(6)
    v_mfma_f32_16x16x32_bf16 v[68:71], v[92:95], v[212:215], v[68:71]
    ds_read_b64_tr_b16 v[84:85], v3 offset:16640
    v_mfma_f32_16x16x32_bf16 v[72:75], v[92:95], v[216:219], v[72:75]
    ds_read_b64_tr_b16 v[86:87], v3 offset:17664
    s_waitcnt lgkmcnt(6)
    v_mfma_f32_16x16x32_bf16 v[76:79], v[96:99], v[212:215], v[76:79]
    ds_read_b64_tr_b16 v[88:89], v15 offset:16672
    v_mfma_f32_16x16x32_bf16 v[80:83], v[96:99], v[216:219], v[80:83]
    ds_read_b64_tr_b16 v[90:91], v15 offset:17696
    s_mov_b32 s23, 0x9000
    buffer_load_dwordx4 v[152:155], v4, s[8:11], s23 offen offset:1024 sc1
    s_waitcnt vmcnt(8) lgkmcnt(6)
    v_mfma_f32_16x16x32_bf16 v[20:23], v[100:103], v[220:223], v[20:23]
    ds_read_b64_tr_b16 v[92:93], v3 offset:16896
    s_waitcnt vmcnt(7)
    v_mfma_f32_16x16x32_bf16 v[24:27], v[100:103], v[224:227], v[24:27]
    ds_read_b64_tr_b16 v[94:95], v3 offset:17920
    s_waitcnt lgkmcnt(6)
    v_mfma_f32_16x16x32_bf16 v[28:31], v[104:107], v[220:223], v[28:31]
    ds_read_b64_tr_b16 v[96:97], v15 offset:16928
    v_mfma_f32_16x16x32_bf16 v[32:35], v[104:107], v[224:227], v[32:35]
    s_add_u32 s22, s16, 0x188000
    s_add_u32 m0, s17, 0xc400
    s_nop 0
    buffer_load_dwordx4 v2, s[4:7], s22 offen lds
    ds_read_b64_tr_b16 v[98:99], v15 offset:17952
    s_waitcnt lgkmcnt(6)
    v_mfma_f32_16x16x32_bf16 v[36:39], v[84:87], v[220:223], v[36:39]
    ds_read_b64_tr_b16 v[100:101], v3 offset:17152
    v_mfma_f32_16x16x32_bf16 v[40:43], v[84:87], v[224:227], v[40:43]
    ds_read_b64_tr_b16 v[102:103], v3 offset:18176
    s_waitcnt lgkmcnt(6)
    v_mfma_f32_16x16x32_bf16 v[44:47], v[88:91], v[220:223], v[44:47]
    ds_read_b64_tr_b16 v[104:105], v15 offset:17184
    v_mfma_f32_16x16x32_bf16 v[48:51], v[88:91], v[224:227], v[48:51]
    ds_read_b64_tr_b16 v[106:107], v15 offset:18208
    s_mov_b32 s23, 0x1800
    buffer_load_dwordx4 v[204:207], v4, s[8:11], s23 offen offset:0 sc1
    s_waitcnt lgkmcnt(6)
    v_mfma_f32_16x16x32_bf16 v[52:55], v[92:95], v[220:223], v[52:55]
    ds_read_b64_tr_b16 v[84:85], v3 offset:24576
    v_mfma_f32_16x16x32_bf16 v[56:59], v[92:95], v[224:227], v[56:59]
    ds_read_b64_tr_b16 v[86:87], v3 offset:25600
    s_waitcnt lgkmcnt(6)
    v_mfma_f32_16x16x32_bf16 v[60:63], v[96:99], v[220:223], v[60:63]
    ds_read_b64_tr_b16 v[88:89], v15 offset:24608
    v_mfma_f32_16x16x32_bf16 v[64:67], v[96:99], v[224:227], v[64:67]
    s_add_u32 s22, s16, 0x190000
    s_add_u32 m0, s17, 0xc800
    s_nop 0
    buffer_load_dwordx4 v16, s[4:7], s22 offen lds
    ds_read_b64_tr_b16 v[90:91], v15 offset:25632
    s_waitcnt lgkmcnt(6)
    v_mfma_f32_16x16x32_bf16 v[68:71], v[100:103], v[220:223], v[68:71]
    ds_read_b64_tr_b16 v[92:93], v3 offset:24832
    v_mfma_f32_16x16x32_bf16 v[72:75], v[100:103], v[224:227], v[72:75]
    ds_read_b64_tr_b16 v[94:95], v3 offset:25856
    s_waitcnt lgkmcnt(6)
    v_mfma_f32_16x16x32_bf16 v[76:79], v[104:107], v[220:223], v[76:79]
    ds_read_b64_tr_b16 v[96:97], v15 offset:24864
    v_mfma_f32_16x16x32_bf16 v[80:83], v[104:107], v[224:227], v[80:83]
    ds_read_b64_tr_b16 v[98:99], v15 offset:25888
    s_mov_b32 s23, 0x9800
    buffer_load_dwordx4 v[208:211], v4, s[8:11], s23 offen offset:0 sc1
    s_waitcnt vmcnt(10) lgkmcnt(6)
    v_mfma_f32_16x16x32_bf16 v[20:23], v[84:87], v[228:231], v[20:23]
    ds_read_b64_tr_b16 v[100:101], v3 offset:25088
    s_waitcnt vmcnt(9)
    v_mfma_f32_16x16x32_bf16 v[24:27], v[84:87], v[232:235], v[24:27]
    ds_read_b64_tr_b16 v[102:103], v3 offset:26112
    s_waitcnt lgkmcnt(6)
    v_mfma_f32_16x16x32_bf16 v[28:31], v[88:91], v[228:231], v[28:31]
    ds_read_b64_tr_b16 v[104:105], v15 offset:25120
    v_mfma_f32_16x16x32_bf16 v[32:35], v[88:91], v[232:235], v[32:35]
    s_add_u32 s22, s16, 0x198000
    s_add_u32 m0, s17, 0xcc00
    s_nop 0
    buffer_load_dwordx4 v16, s[4:7], s22 offen lds
    ds_read_b64_tr_b16 v[106:107], v15 offset:26144
    s_waitcnt lgkmcnt(6)
    v_mfma_f32_16x16x32_bf16 v[36:39], v[92:95], v[228:231], v[36:39]
    ds_read_b64_tr_b16 v[84:85], v3 offset:25344
    v_mfma_f32_16x16x32_bf16 v[40:43], v[92:95], v[232:235], v[40:43]
    ds_read_b64_tr_b16 v[86:87], v3 offset:26368
    s_waitcnt lgkmcnt(6)
    v_mfma_f32_16x16x32_bf16 v[44:47], v[96:99], v[228:231], v[44:47]
    ds_read_b64_tr_b16 v[88:89], v15 offset:25376
    v_mfma_f32_16x16x32_bf16 v[48:51], v[96:99], v[232:235], v[48:51]
    ds_read_b64_tr_b16 v[90:91], v15 offset:26400
    s_mov_b32 s23, 0x1800
    buffer_load_dwordx4 v[212:215], v4, s[8:11], s23 offen offset:1024 sc1
    s_waitcnt lgkmcnt(6)
    v_mfma_f32_16x16x32_bf16 v[52:55], v[100:103], v[228:231], v[52:55]
    v_mfma_f32_16x16x32_bf16 v[56:59], v[100:103], v[232:235], v[56:59]
    s_barrier
    ds_read_b64_tr_b16 v[92:93], v3 offset:32768
    ds_read_b64_tr_b16 v[94:95], v3 offset:33792
    s_waitcnt lgkmcnt(6)
    v_mfma_f32_16x16x32_bf16 v[60:63], v[104:107], v[228:231], v[60:63]
    ds_read_b64_tr_b16 v[96:97], v15 offset:32800
    v_mfma_f32_16x16x32_bf16 v[64:67], v[104:107], v[232:235], v[64:67]
    s_add_u32 s22, s16, 0x200000
    s_add_u32 m0, s17, 0x0
    s_nop 0
    buffer_load_dwordx4 v2, s[4:7], s22 offen lds
    ds_read_b64_tr_b16 v[98:99], v15 offset:33824
    s_waitcnt lgkmcnt(6)
    v_mfma_f32_16x16x32_bf16 v[68:71], v[84:87], v[228:231], v[68:71]
    ds_read_b64_tr_b16 v[100:101], v3 offset:33024
    v_mfma_f32_16x16x32_bf16 v[72:75], v[84:87], v[232:235], v[72:75]
    ds_read_b64_tr_b16 v[102:103], v3 offset:34048
    s_waitcnt lgkmcnt(6)
    v_mfma_f32_16x16x32_bf16 v[76:79], v[88:91], v[228:231], v[76:79]
    ds_read_b64_tr_b16 v[104:105], v15 offset:33056
    v_mfma_f32_16x16x32_bf16 v[80:83], v[88:91], v[232:235], v[80:83]
    ds_read_b64_tr_b16 v[106:107], v15 offset:34080
    s_mov_b32 s23, 0x9800
    buffer_load_dwordx4 v[216:219], v4, s[8:11], s23 offen offset:1024 sc1
    s_waitcnt vmcnt(12) lgkmcnt(6)
    v_mfma_f32_16x16x32_bf16 v[20:23], v[92:95], v[140:143], v[20:23]
    ds_read_b64_tr_b16 v[84:85], v3 offset:33280
    s_waitcnt vmcnt(11)
    v_mfma_f32_16x16x32_bf16 v[24:27], v[92:95], v[144:147], v[24:27]
    ds_read_b64_tr_b16 v[86:87], v3 offset:34304
    s_waitcnt lgkmcnt(6)
    v_mfma_f32_16x16x32_bf16 v[28:31], v[96:99], v[140:143], v[28:31]
    ds_read_b64_tr_b16 v[88:89], v15 offset:33312
    v_mfma_f32_16x16x32_bf16 v[32:35], v[96:99], v[144:147], v[32:35]
    s_add_u32 s22, s16, 0x208000
    s_add_u32 m0, s17, 0x400
    s_nop 0
    buffer_load_dwordx4 v2, s[4:7], s22 offen lds
    ds_read_b64_tr_b16 v[90:91], v15 offset:34336
    s_waitcnt lgkmcnt(6)
    v_mfma_f32_16x16x32_bf16 v[36:39], v[100:103], v[140:143], v[36:39]
    ds_read_b64_tr_b16 v[92:93], v3 offset:33536
    v_mfma_f32_16x16x32_bf16 v[40:43], v[100:103], v[144:147], v[40:43]
    ds_read_b64_tr_b16 v[94:95], v3 offset:34560
    s_waitcnt lgkmcnt(6)
    v_mfma_f32_16x16x32_bf16 v[44:47], v[104:107], v[140:143], v[44:47]
    ds_read_b64_tr_b16 v[96:97], v15 offset:33568
    v_mfma_f32_16x16x32_bf16 v[48:51], v[104:107], v[144:147], v[48:51]
    ds_read_b64_tr_b16 v[98:99], v15 offset:34592
    s_mov_b32 s23, 0x2000
    buffer_load_dwordx4 v[220:223], v4, s[8:11], s23 offen offset:0 sc1
    s_waitcnt lgkmcnt(6)
    v_mfma_f32_16x16x32_bf16 v[52:55], v[84:87], v[140:143], v[52:55]
    ds_read_b64_tr_b16 v[100:101], v3 offset:40960
    v_mfma_f32_16x16x32_bf16 v[56:59], v[84:87], v[144:147], v[56:59]
    ds_read_b64_tr_b16 v[102:103], v3 offset:41984
    s_waitcnt lgkmcnt(6)
    v_mfma_f32_16x16x32_bf16 v[60:63], v[88:91], v[140:143], v[60:63]
    ds_read_b64_tr_b16 v[104:105], v15 offset:40992
    v_mfma_f32_16x16x32_bf16 v[64:67], v[88:91], v[144:147], v[64:67]
    s_add_u32 s22, s16, 0x210000
    s_add_u32 m0, s17, 0x800
    s_nop 0
    buffer_load_dwordx4 v16, s[4:7], s22 offen lds
    ds_read_b64_tr_b16 v[106:107], v15 offset:42016
    s_waitcnt lgkmcnt(6)
    v_mfma_f32_16x16x32_bf16 v[68:71], v[92:95], v[140:143], v[68:71]
    ds_read_b64_tr_b16 v[84:85], v3 offset:41216
    v_mfma_f32_16x16x32_bf16 v[72:75], v[92:95], v[144:147], v[72:75]
    ds_read_b64_tr_b16 v[86:87], v3 offset:42240
    s_waitcnt lgkmcnt(6)
    v_mfma_f32_16x16x32_bf16 v[76:79], v[96:99], v[140:143], v[76:79]
    ds_read_b64_tr_b16 v[88:89], v15 offset:41248
    v_mfma_f32_16x16x32_bf16 v[80:83], v[96:99], v[144:147], v[80:83]
    ds_read_b64_tr_b16 v[90:91], v15 offset:42272
    s_mov_b32 s23, 0xa000
    buffer_load_dwordx4 v[224:227], v4, s[8:11], s23 offen offset:0 sc1
    s_waitcnt vmcnt(14) lgkmcnt(6)
    v_mfma_f32_16x16x32_bf16 v[20:23], v[100:103], v[148:151], v[20:23]
    ds_read_b64_tr_b16 v[92:93], v3 offset:41472
    s_waitcnt vmcnt(12)
    v_mfma_f32_16x16x32_bf16 v[24:27], v[100:103], v[152:155], v[24:27]
    ds_read_b64_tr_b16 v[94:95], v3 offset:42496
    s_waitcnt lgkmcnt(6)
    v_mfma_f32_16x16x32_bf16 v[28:31], v[104:107], v[148:151], v[28:31]
    ds_read_b64_tr_b16 v[96:97], v15 offset:41504
    v_mfma_f32_16x16x32_bf16 v[32:35], v[104:107], v[152:155], v[32:35]
    s_add_u32 s22, s16, 0x218000
    s_add_u32 m0, s17, 0xc00
    s_nop 0
    buffer_load_dwordx4 v16, s[4:7], s22 offen lds
    ds_read_b64_tr_b16 v[98:99], v15 offset:42528
    s_waitcnt lgkmcnt(6)
    v_mfma_f32_16x16x32_bf16 v[36:39], v[84:87], v[148:151], v[36:39]
    ds_read_b64_tr_b16 v[100:101], v3 offset:41728
    v_mfma_f32_16x16x32_bf16 v[40:43], v[84:87], v[152:155], v[40:43]
    ds_read_b64_tr_b16 v[102:103], v3 offset:42752
    s_waitcnt lgkmcnt(6)
    v_mfma_f32_16x16x32_bf16 v[44:47], v[88:91], v[148:151], v[44:47]
    ds_read_b64_tr_b16 v[104:105], v15 offset:41760
    v_mfma_f32_16x16x32_bf16 v[48:51], v[88:91], v[152:155], v[48:51]
    ds_read_b64_tr_b16 v[106:107], v15 offset:42784
    s_mov_b32 s23, 0x2000
    buffer_load_dwordx4 v[228:231], v4, s[8:11], s23 offen offset:1024 sc1
    s_waitcnt lgkmcnt(6)
    v_mfma_f32_16x16x32_bf16 v[52:55], v[92:95], v[148:151], v[52:55]
    v_mfma_f32_16x16x32_bf16 v[56:59], v[92:95], v[152:155], v[56:59]
    s_waitcnt vmcnt(9)
    s_barrier
    ds_read_b64_tr_b16 v[84:85], v3 offset:49152
    ds_read_b64_tr_b16 v[86:87], v3 offset:50176
    s_waitcnt lgkmcnt(6)
    v_mfma_f32_16x16x32_bf16 v[60:63], v[96:99], v[148:151], v[60:63]
    ds_read_b64_tr_b16 v[88:89], v15 offset:49184
    v_mfma_f32_16x16x32_bf16 v[64:67], v[96:99], v[152:155], v[64:67]
    s_add_u32 s22, s16, 0x280000
    s_add_u32 m0, s17, 0x4000
    s_nop 0
    buffer_load_dwordx4 v2, s[4:7], s22 offen lds
    ds_read_b64_tr_b16 v[90:91], v15 offset:50208
    s_waitcnt lgkmcnt(6)
    v_mfma_f32_16x16x32_bf16 v[68:71], v[100:103], v[148:151], v[68:71]
    ds_read_b64_tr_b16 v[92:93], v3 offset:49408
    v_mfma_f32_16x16x32_bf16 v[72:75], v[100:103], v[152:155], v[72:75]
    ds_read_b64_tr_b16 v[94:95], v3 offset:50432
    s_waitcnt lgkmcnt(6)
    v_mfma_f32_16x16x32_bf16 v[76:79], v[104:107], v[148:151], v[76:79]
    ds_read_b64_tr_b16 v[96:97], v15 offset:49440
    v_mfma_f32_16x16x32_bf16 v[80:83], v[104:107], v[152:155], v[80:83]
    ds_read_b64_tr_b16 v[98:99], v15 offset:50464
    s_mov_b32 s23, 0xa000
    buffer_load_dwordx4 v[232:235], v4, s[8:11], s23 offen offset:1024 sc1
    s_waitcnt lgkmcnt(6)
    v_mfma_f32_16x16x32_bf16 v[20:23], v[84:87], v[204:207], v[20:23]
    ds_read_b64_tr_b16 v[100:101], v3 offset:49664
    v_mfma_f32_16x16x32_bf16 v[24:27], v[84:87], v[208:211], v[24:27]
    ds_read_b64_tr_b16 v[102:103], v3 offset:50688
    s_waitcnt lgkmcnt(6)
    v_mfma_f32_16x16x32_bf16 v[28:31], v[88:91], v[204:207], v[28:31]
    ds_read_b64_tr_b16 v[104:105], v15 offset:49696
    v_mfma_f32_16x16x32_bf16 v[32:35], v[88:91], v[208:211], v[32:35]
    s_add_u32 s22, s16, 0x288000
    s_add_u32 m0, s17, 0x4400
    s_nop 0
    buffer_load_dwordx4 v2, s[4:7], s22 offen lds
    ds_read_b64_tr_b16 v[106:107], v15 offset:50720
    s_waitcnt lgkmcnt(6)
    v_mfma_f32_16x16x32_bf16 v[36:39], v[92:95], v[204:207], v[36:39]
    ds_read_b64_tr_b16 v[84:85], v3 offset:49920
    v_mfma_f32_16x16x32_bf16 v[40:43], v[92:95], v[208:211], v[40:43]
    ds_read_b64_tr_b16 v[86:87], v3 offset:50944
    s_waitcnt lgkmcnt(6)
    v_mfma_f32_16x16x32_bf16 v[44:47], v[96:99], v[204:207], v[44:47]
    ds_read_b64_tr_b16 v[88:89], v15 offset:49952
    v_mfma_f32_16x16x32_bf16 v[48:51], v[96:99], v[208:211], v[48:51]
    ds_read_b64_tr_b16 v[90:91], v15 offset:50976
    s_mov_b32 s23, 0x2800
    buffer_load_dwordx4 v[140:143], v4, s[8:11], s23 offen offset:0 sc1
    s_waitcnt lgkmcnt(6)
    v_mfma_f32_16x16x32_bf16 v[52:55], v[100:103], v[204:207], v[52:55]
    ds_read_b64_tr_b16 v[92:93], v3 offset:57344
    v_mfma_f32_16x16x32_bf16 v[56:59], v[100:103], v[208:211], v[56:59]
    ds_read_b64_tr_b16 v[94:95], v3 offset:58368
    s_waitcnt lgkmcnt(6)
    v_mfma_f32_16x16x32_bf16 v[60:63], v[104:107], v[204:207], v[60:63]
    ds_read_b64_tr_b16 v[96:97], v15 offset:57376
    v_mfma_f32_16x16x32_bf16 v[64:67], v[104:107], v[208:211], v[64:67]
    s_add_u32 s22, s16, 0x290000
    s_add_u32 m0, s17, 0x4800
    s_nop 0
    buffer_load_dwordx4 v16, s[4:7], s22 offen lds
    ds_read_b64_tr_b16 v[98:99], v15 offset:58400
    s_waitcnt lgkmcnt(6)
    v_mfma_f32_16x16x32_bf16 v[68:71], v[84:87], v[204:207], v[68:71]
    ds_read_b64_tr_b16 v[100:101], v3 offset:57600
    v_mfma_f32_16x16x32_bf16 v[72:75], v[84:87], v[208:211], v[72:75]
    ds_read_b64_tr_b16 v[102:103], v3 offset:58624
    s_waitcnt lgkmcnt(6)
    v_mfma_f32_16x16x32_bf16 v[76:79], v[88:91], v[204:207], v[76:79]
    ds_read_b64_tr_b16 v[104:105], v15 offset:57632
    v_mfma_f32_16x16x32_bf16 v[80:83], v[88:91], v[208:211], v[80:83]
    ds_read_b64_tr_b16 v[106:107], v15 offset:58656
    s_mov_b32 s23, 0xa800
    buffer_load_dwordx4 v[144:147], v4, s[8:11], s23 offen offset:0 sc1
    s_waitcnt vmcnt(14) lgkmcnt(6)
    v_mfma_f32_16x16x32_bf16 v[20:23], v[92:95], v[212:215], v[20:23]
    ds_read_b64_tr_b16 v[84:85], v3 offset:57856
    s_waitcnt vmcnt(12)
    v_mfma_f32_16x16x32_bf16 v[24:27], v[92:95], v[216:219], v[24:27]
    ds_read_b64_tr_b16 v[86:87], v3 offset:58880
    s_waitcnt lgkmcnt(6)
    v_mfma_f32_16x16x32_bf16 v[28:31], v[96:99], v[212:215], v[28:31]
    ds_read_b64_tr_b16 v[88:89], v15 offset:57888
    v_mfma_f32_16x16x32_bf16 v[32:35], v[96:99], v[216:219], v[32:35]
    s_add_u32 s22, s16, 0x298000
    s_add_u32 m0, s17, 0x4c00
    s_nop 0
    buffer_load_dwordx4 v16, s[4:7], s22 offen lds
    ds_read_b64_tr_b16 v[90:91], v15 offset:58912
    s_waitcnt lgkmcnt(6)
    v_mfma_f32_16x16x32_bf16 v[36:39], v[100:103], v[212:215], v[36:39]
    ds_read_b64_tr_b16 v[92:93], v3 offset:58112
    v_mfma_f32_16x16x32_bf16 v[40:43], v[100:103], v[216:219], v[40:43]
    ds_read_b64_tr_b16 v[94:95], v3 offset:59136
    s_waitcnt lgkmcnt(6)
    v_mfma_f32_16x16x32_bf16 v[44:47], v[104:107], v[212:215], v[44:47]
    ds_read_b64_tr_b16 v[96:97], v15 offset:58144
    v_mfma_f32_16x16x32_bf16 v[48:51], v[104:107], v[216:219], v[48:51]
    ds_read_b64_tr_b16 v[98:99], v15 offset:59168
    s_mov_b32 s23, 0x2800
    buffer_load_dwordx4 v[148:151], v4, s[8:11], s23 offen offset:1024 sc1
    s_waitcnt lgkmcnt(6)
    v_mfma_f32_16x16x32_bf16 v[52:55], v[84:87], v[212:215], v[52:55]
    v_mfma_f32_16x16x32_bf16 v[56:59], v[84:87], v[216:219], v[56:59]
    s_waitcnt vmcnt(9)
    s_barrier
    ds_read_b64_tr_b16 v[100:101], v3 offset:0
    ds_read_b64_tr_b16 v[102:103], v3 offset:1024
    s_waitcnt lgkmcnt(6)
    v_mfma_f32_16x16x32_bf16 v[60:63], v[88:91], v[212:215], v[60:63]
    ds_read_b64_tr_b16 v[104:105], v15 offset:32
    v_mfma_f32_16x16x32_bf16 v[64:67], v[88:91], v[216:219], v[64:67]
    s_add_u32 s22, s16, 0x300000
    s_add_u32 m0, s17, 0x8000
    s_nop 0
    buffer_load_dwordx4 v2, s[4:7], s22 offen lds
    ds_read_b64_tr_b16 v[106:107], v15 offset:1056
    s_waitcnt lgkmcnt(6)
    v_mfma_f32_16x16x32_bf16 v[68:71], v[92:95], v[212:215], v[68:71]
    ds_read_b64_tr_b16 v[84:85], v3 offset:256
    v_mfma_f32_16x16x32_bf16 v[72:75], v[92:95], v[216:219], v[72:75]
    ds_read_b64_tr_b16 v[86:87], v3 offset:1280
    s_waitcnt lgkmcnt(6)
    v_mfma_f32_16x16x32_bf16 v[76:79], v[96:99], v[212:215], v[76:79]
    ds_read_b64_tr_b16 v[88:89], v15 offset:288
    v_mfma_f32_16x16x32_bf16 v[80:83], v[96:99], v[216:219], v[80:83]
    ds_read_b64_tr_b16 v[90:91], v15 offset:1312
    s_mov_b32 s23, 0xa800
    buffer_load_dwordx4 v[152:155], v4, s[8:11], s23 offen offset:1024 sc1
    s_waitcnt lgkmcnt(6)
    v_mfma_f32_16x16x32_bf16 v[20:23], v[100:103], v[220:223], v[20:23]
    ds_read_b64_tr_b16 v[92:93], v3 offset:512
    v_mfma_f32_16x16x32_bf16 v[24:27], v[100:103], v[224:227], v[24:27]
    ds_read_b64_tr_b16 v[94:95], v3 offset:1536
    s_waitcnt lgkmcnt(6)
    v_mfma_f32_16x16x32_bf16 v[28:31], v[104:107], v[220:223], v[28:31]
    ds_read_b64_tr_b16 v[96:97], v15 offset:544
    v_mfma_f32_16x16x32_bf16 v[32:35], v[104:107], v[224:227], v[32:35]
    s_add_u32 s22, s16, 0x308000
    s_add_u32 m0, s17, 0x8400
    s_nop 0
    buffer_load_dwordx4 v2, s[4:7], s22 offen lds
    ds_read_b64_tr_b16 v[98:99], v15 offset:1568
    s_waitcnt lgkmcnt(6)
    v_mfma_f32_16x16x32_bf16 v[36:39], v[84:87], v[220:223], v[36:39]
    ds_read_b64_tr_b16 v[100:101], v3 offset:768
    v_mfma_f32_16x16x32_bf16 v[40:43], v[84:87], v[224:227], v[40:43]
    ds_read_b64_tr_b16 v[102:103], v3 offset:1792
    s_waitcnt lgkmcnt(6)
    v_mfma_f32_16x16x32_bf16 v[44:47], v[88:91], v[220:223], v[44:47]
    ds_read_b64_tr_b16 v[104:105], v15 offset:800
    v_mfma_f32_16x16x32_bf16 v[48:51], v[88:91], v[224:227], v[48:51]
    ds_read_b64_tr_b16 v[106:107], v15 offset:1824
    s_mov_b32 s23, 0x3000
    buffer_load_dwordx4 v[204:207], v4, s[8:11], s23 offen offset:0 sc1
    s_waitcnt lgkmcnt(6)
    v_mfma_f32_16x16x32_bf16 v[52:55], v[92:95], v[220:223], v[52:55]
    ds_read_b64_tr_b16 v[84:85], v3 offset:8192
    v_mfma_f32_16x16x32_bf16 v[56:59], v[92:95], v[224:227], v[56:59]
    ds_read_b64_tr_b16 v[86:87], v3 offset:9216
    s_waitcnt lgkmcnt(6)
    v_mfma_f32_16x16x32_bf16 v[60:63], v[96:99], v[220:223], v[60:63]
    ds_read_b64_tr_b16 v[88:89], v15 offset:8224
    v_mfma_f32_16x16x32_bf16 v[64:67], v[96:99], v[224:227], v[64:67]
    s_add_u32 s22, s16, 0x310000
    s_add_u32 m0, s17, 0x8800
    s_nop 0
    buffer_load_dwordx4 v16, s[4:7], s22 offen lds
    ds_read_b64_tr_b16 v[90:91], v15 offset:9248
    s_waitcnt lgkmcnt(6)
    v_mfma_f32_16x16x32_bf16 v[68:71], v[100:103], v[220:223], v[68:71]
    ds_read_b64_tr_b16 v[92:93], v3 offset:8448
    v_mfma_f32_16x16x32_bf16 v[72:75], v[100:103], v[224:227], v[72:75]
    ds_read_b64_tr_b16 v[94:95], v3 offset:9472
    s_waitcnt lgkmcnt(6)
    v_mfma_f32_16x16x32_bf16 v[76:79], v[104:107], v[220:223], v[76:79]
    ds_read_b64_tr_b16 v[96:97], v15 offset:8480
    v_mfma_f32_16x16x32_bf16 v[80:83], v[104:107], v[224:227], v[80:83]
    ds_read_b64_tr_b16 v[98:99], v15 offset:9504
    s_mov_b32 s23, 0xb000
    buffer_load_dwordx4 v[208:211], v4, s[8:11], s23 offen offset:0 sc1
    s_waitcnt vmcnt(14) lgkmcnt(6)
    v_mfma_f32_16x16x32_bf16 v[20:23], v[84:87], v[228:231], v[20:23]
    ds_read_b64_tr_b16 v[100:101], v3 offset:8704
    s_waitcnt vmcnt(12)
    v_mfma_f32_16x16x32_bf16 v[24:27], v[84:87], v[232:235], v[24:27]
    ds_read_b64_tr_b16 v[102:103], v3 offset:9728
    s_waitcnt lgkmcnt(6)
    v_mfma_f32_16x16x32_bf16 v[28:31], v[88:91], v[228:231], v[28:31]
    ds_read_b64_tr_b16 v[104:105], v15 offset:8736
    v_mfma_f32_16x16x32_bf16 v[32:35], v[88:91], v[232:235], v[32:35]
    s_add_u32 s22, s16, 0x318000
    s_add_u32 m0, s17, 0x8c00
    s_nop 0
    buffer_load_dwordx4 v16, s[4:7], s22 offen lds
    ds_read_b64_tr_b16 v[106:107], v15 offset:9760
    s_waitcnt lgkmcnt(6)
    v_mfma_f32_16x16x32_bf16 v[36:39], v[92:95], v[228:231], v[36:39]
    ds_read_b64_tr_b16 v[84:85], v3 offset:8960
    v_mfma_f32_16x16x32_bf16 v[40:43], v[92:95], v[232:235], v[40:43]
    ds_read_b64_tr_b16 v[86:87], v3 offset:9984
    s_waitcnt lgkmcnt(6)
    v_mfma_f32_16x16x32_bf16 v[44:47], v[96:99], v[228:231], v[44:47]
    ds_read_b64_tr_b16 v[88:89], v15 offset:8992
    v_mfma_f32_16x16x32_bf16 v[48:51], v[96:99], v[232:235], v[48:51]
    ds_read_b64_tr_b16 v[90:91], v15 offset:10016
    s_mov_b32 s23, 0x3000
    buffer_load_dwordx4 v[212:215], v4, s[8:11], s23 offen offset:1024 sc1
    s_waitcnt lgkmcnt(6)
    v_mfma_f32_16x16x32_bf16 v[52:55], v[100:103], v[228:231], v[52:55]
    v_mfma_f32_16x16x32_bf16 v[56:59], v[100:103], v[232:235], v[56:59]
    s_waitcnt vmcnt(9)
    s_barrier
    ds_read_b64_tr_b16 v[92:93], v3 offset:16384
    ds_read_b64_tr_b16 v[94:95], v3 offset:17408
    s_waitcnt lgkmcnt(6)
    v_mfma_f32_16x16x32_bf16 v[60:63], v[104:107], v[228:231], v[60:63]
    ds_read_b64_tr_b16 v[96:97], v15 offset:16416
    v_mfma_f32_16x16x32_bf16 v[64:67], v[104:107], v[232:235], v[64:67]
    s_add_u32 s22, s16, 0x380000
    s_add_u32 m0, s17, 0xc000
    s_nop 0
    buffer_load_dwordx4 v2, s[4:7], s22 offen lds
    ds_read_b64_tr_b16 v[98:99], v15 offset:17440
    s_waitcnt lgkmcnt(6)
    v_mfma_f32_16x16x32_bf16 v[68:71], v[84:87], v[228:231], v[68:71]
    ds_read_b64_tr_b16 v[100:101], v3 offset:16640
    v_mfma_f32_16x16x32_bf16 v[72:75], v[84:87], v[232:235], v[72:75]
    ds_read_b64_tr_b16 v[102:103], v3 offset:17664
    s_waitcnt lgkmcnt(6)
    v_mfma_f32_16x16x32_bf16 v[76:79], v[88:91], v[228:231], v[76:79]
    ds_read_b64_tr_b16 v[104:105], v15 offset:16672
    v_mfma_f32_16x16x32_bf16 v[80:83], v[88:91], v[232:235], v[80:83]
    ds_read_b64_tr_b16 v[106:107], v15 offset:17696
    s_mov_b32 s23, 0xb000
    buffer_load_dwordx4 v[216:219], v4, s[8:11], s23 offen offset:1024 sc1
    s_waitcnt lgkmcnt(6)
    v_mfma_f32_16x16x32_bf16 v[20:23], v[92:95], v[140:143], v[20:23]
    ds_read_b64_tr_b16 v[84:85], v3 offset:16896
    v_mfma_f32_16x16x32_bf16 v[24:27], v[92:95], v[144:147], v[24:27]
    ds_read_b64_tr_b16 v[86:87], v3 offset:17920
    s_waitcnt lgkmcnt(6)
    v_mfma_f32_16x16x32_bf16 v[28:31], v[96:99], v[140:143], v[28:31]
    ds_read_b64_tr_b16 v[88:89], v15 offset:16928
    v_mfma_f32_16x16x32_bf16 v[32:35], v[96:99], v[144:147], v[32:35]
    s_add_u32 s22, s16, 0x388000
    s_add_u32 m0, s17, 0xc400
    s_nop 0
    buffer_load_dwordx4 v2, s[4:7], s22 offen lds
    ds_read_b64_tr_b16 v[90:91], v15 offset:17952
    s_waitcnt lgkmcnt(6)
    v_mfma_f32_16x16x32_bf16 v[36:39], v[100:103], v[140:143], v[36:39]
    ds_read_b64_tr_b16 v[92:93], v3 offset:17152
    v_mfma_f32_16x16x32_bf16 v[40:43], v[100:103], v[144:147], v[40:43]
    ds_read_b64_tr_b16 v[94:95], v3 offset:18176
    s_waitcnt lgkmcnt(6)
    v_mfma_f32_16x16x32_bf16 v[44:47], v[104:107], v[140:143], v[44:47]
    ds_read_b64_tr_b16 v[96:97], v15 offset:17184
    v_mfma_f32_16x16x32_bf16 v[48:51], v[104:107], v[144:147], v[48:51]
    ds_read_b64_tr_b16 v[98:99], v15 offset:18208
    s_mov_b32 s23, 0x3800
    buffer_load_dwordx4 v[220:223], v4, s[8:11], s23 offen offset:0 sc1
    s_waitcnt lgkmcnt(6)
    v_mfma_f32_16x16x32_bf16 v[52:55], v[84:87], v[140:143], v[52:55]
    ds_read_b64_tr_b16 v[100:101], v3 offset:24576
    v_mfma_f32_16x16x32_bf16 v[56:59], v[84:87], v[144:147], v[56:59]
    ds_read_b64_tr_b16 v[102:103], v3 offset:25600
    s_waitcnt lgkmcnt(6)
    v_mfma_f32_16x16x32_bf16 v[60:63], v[88:91], v[140:143], v[60:63]
    ds_read_b64_tr_b16 v[104:105], v15 offset:24608
    v_mfma_f32_16x16x32_bf16 v[64:67], v[88:91], v[144:147], v[64:67]
    s_add_u32 s22, s16, 0x390000
    s_add_u32 m0, s17, 0xc800
    s_nop 0
    buffer_load_dwordx4 v16, s[4:7], s22 offen lds
    ds_read_b64_tr_b16 v[106:107], v15 offset:25632
    s_waitcnt lgkmcnt(6)
    v_mfma_f32_16x16x32_bf16 v[68:71], v[92:95], v[140:143], v[68:71]
    ds_read_b64_tr_b16 v[84:85], v3 offset:24832
    v_mfma_f32_16x16x32_bf16 v[72:75], v[92:95], v[144:147], v[72:75]
    ds_read_b64_tr_b16 v[86:87], v3 offset:25856
    s_waitcnt lgkmcnt(6)
    v_mfma_f32_16x16x32_bf16 v[76:79], v[96:99], v[140:143], v[76:79]
    ds_read_b64_tr_b16 v[88:89], v15 offset:24864
    v_mfma_f32_16x16x32_bf16 v[80:83], v[96:99], v[144:147], v[80:83]
    ds_read_b64_tr_b16 v[90:91], v15 offset:25888
    s_mov_b32 s23, 0xb800
    buffer_load_dwordx4 v[224:227], v4, s[8:11], s23 offen offset:0 sc1
    s_waitcnt vmcnt(14) lgkmcnt(6)
    v_mfma_f32_16x16x32_bf16 v[20:23], v[100:103], v[148:151], v[20:23]
    ds_read_b64_tr_b16 v[92:93], v3 offset:25088
    s_waitcnt vmcnt(12)
    v_mfma_f32_16x16x32_bf16 v[24:27], v[100:103], v[152:155], v[24:27]
    ds_read_b64_tr_b16 v[94:95], v3 offset:26112
    s_waitcnt lgkmcnt(6)
    v_mfma_f32_16x16x32_bf16 v[28:31], v[104:107], v[148:151], v[28:31]
    ds_read_b64_tr_b16 v[96:97], v15 offset:25120
    v_mfma_f32_16x16x32_bf16 v[32:35], v[104:107], v[152:155], v[32:35]
    s_add_u32 s22, s16, 0x398000
    s_add_u32 m0, s17, 0xcc00
    s_nop 0
    buffer_load_dwordx4 v16, s[4:7], s22 offen lds
    ds_read_b64_tr_b16 v[98:99], v15 offset:26144
    s_waitcnt lgkmcnt(6)
    v_mfma_f32_16x16x32_bf16 v[36:39], v[84:87], v[148:151], v[36:39]
    ds_read_b64_tr_b16 v[100:101], v3 offset:25344
    v_mfma_f32_16x16x32_bf16 v[40:43], v[84:87], v[152:155], v[40:43]
    ds_read_b64_tr_b16 v[102:103], v3 offset:26368
    s_waitcnt lgkmcnt(6)
    v_mfma_f32_16x16x32_bf16 v[44:47], v[88:91], v[148:151], v[44:47]
    ds_read_b64_tr_b16 v[104:105], v15 offset:25376
    v_mfma_f32_16x16x32_bf16 v[48:51], v[88:91], v[152:155], v[48:51]
    ds_read_b64_tr_b16 v[106:107], v15 offset:26400
    s_mov_b32 s23, 0x3800
    buffer_load_dwordx4 v[228:231], v4, s[8:11], s23 offen offset:1024 sc1
    s_waitcnt lgkmcnt(6)
    v_mfma_f32_16x16x32_bf16 v[52:55], v[92:95], v[148:151], v[52:55]
    v_mfma_f32_16x16x32_bf16 v[56:59], v[92:95], v[152:155], v[56:59]
    s_waitcnt vmcnt(9)
    s_barrier
    ds_read_b64_tr_b16 v[84:85], v3 offset:32768
    ds_read_b64_tr_b16 v[86:87], v3 offset:33792
    s_waitcnt lgkmcnt(6)
    v_mfma_f32_16x16x32_bf16 v[60:63], v[96:99], v[148:151], v[60:63]
    ds_read_b64_tr_b16 v[88:89], v15 offset:32800
    v_mfma_f32_16x16x32_bf16 v[64:67], v[96:99], v[152:155], v[64:67]
    s_add_u32 s22, s16, 0x400000
    s_add_u32 m0, s17, 0x0
    s_nop 0
    buffer_load_dwordx4 v2, s[4:7], s22 offen lds
    ds_read_b64_tr_b16 v[90:91], v15 offset:33824
    s_waitcnt lgkmcnt(6)
    v_mfma_f32_16x16x32_bf16 v[68:71], v[100:103], v[148:151], v[68:71]
    ds_read_b64_tr_b16 v[92:93], v3 offset:33024
    v_mfma_f32_16x16x32_bf16 v[72:75], v[100:103], v[152:155], v[72:75]
    ds_read_b64_tr_b16 v[94:95], v3 offset:34048
    s_waitcnt lgkmcnt(6)
    v_mfma_f32_16x16x32_bf16 v[76:79], v[104:107], v[148:151], v[76:79]
    ds_read_b64_tr_b16 v[96:97], v15 offset:33056
    v_mfma_f32_16x16x32_bf16 v[80:83], v[104:107], v[152:155], v[80:83]
    ds_read_b64_tr_b16 v[98:99], v15 offset:34080
    s_mov_b32 s23, 0xb800
    buffer_load_dwordx4 v[232:235], v4, s[8:11], s23 offen offset:1024 sc1
    s_waitcnt lgkmcnt(6)
    v_mfma_f32_16x16x32_bf16 v[20:23], v[84:87], v[204:207], v[20:23]
    ds_read_b64_tr_b16 v[100:101], v3 offset:33280
    v_mfma_f32_16x16x32_bf16 v[24:27], v[84:87], v[208:211], v[24:27]
    ds_read_b64_tr_b16 v[102:103], v3 offset:34304
    s_waitcnt lgkmcnt(6)
    v_mfma_f32_16x16x32_bf16 v[28:31], v[88:91], v[204:207], v[28:31]
    ds_read_b64_tr_b16 v[104:105], v15 offset:33312
    v_mfma_f32_16x16x32_bf16 v[32:35], v[88:91], v[208:211], v[32:35]
    s_add_u32 s22, s16, 0x408000
    s_add_u32 m0, s17, 0x400
    s_nop 0
    buffer_load_dwordx4 v2, s[4:7], s22 offen lds
    ds_read_b64_tr_b16 v[106:107], v15 offset:34336
    s_waitcnt lgkmcnt(6)
    v_mfma_f32_16x16x32_bf16 v[36:39], v[92:95], v[204:207], v[36:39]
    ds_read_b64_tr_b16 v[84:85], v3 offset:33536
    v_mfma_f32_16x16x32_bf16 v[40:43], v[92:95], v[208:211], v[40:43]
    ds_read_b64_tr_b16 v[86:87], v3 offset:34560
    s_waitcnt lgkmcnt(6)
    v_mfma_f32_16x16x32_bf16 v[44:47], v[96:99], v[204:207], v[44:47]
    ds_read_b64_tr_b16 v[88:89], v15 offset:33568
    v_mfma_f32_16x16x32_bf16 v[48:51], v[96:99], v[208:211], v[48:51]
    ds_read_b64_tr_b16 v[90:91], v15 offset:34592
    s_mov_b32 s23, 0x4000
    buffer_load_dwordx4 v[140:143], v4, s[8:11], s23 offen offset:0 sc1
    s_waitcnt lgkmcnt(6)
    v_mfma_f32_16x16x32_bf16 v[52:55], v[100:103], v[204:207], v[52:55]
    ds_read_b64_tr_b16 v[92:93], v3 offset:40960
    v_mfma_f32_16x16x32_bf16 v[56:59], v[100:103], v[208:211], v[56:59]
    ds_read_b64_tr_b16 v[94:95], v3 offset:41984
    s_waitcnt lgkmcnt(6)
    v_mfma_f32_16x16x32_bf16 v[60:63], v[104:107], v[204:207], v[60:63]
    ds_read_b64_tr_b16 v[96:97], v15 offset:40992
    v_mfma_f32_16x16x32_bf16 v[64:67], v[104:107], v[208:211], v[64:67]
    s_add_u32 s22, s16, 0x410000
    s_add_u32 m0, s17, 0x800
    s_nop 0
    buffer_load_dwordx4 v16, s[4:7], s22 offen lds
    ds_read_b64_tr_b16 v[98:99], v15 offset:42016
    s_waitcnt lgkmcnt(6)
    v_mfma_f32_16x16x32_bf16 v[68:71], v[84:87], v[204:207], v[68:71]
    ds_read_b64_tr_b16 v[100:101], v3 offset:41216
    v_mfma_f32_16x16x32_bf16 v[72:75], v[84:87], v[208:211], v[72:75]
    ds_read_b64_tr_b16 v[102:103], v3 offset:42240
    s_waitcnt lgkmcnt(6)
    v_mfma_f32_16x16x32_bf16 v[76:79], v[88:91], v[204:207], v[76:79]
    ds_read_b64_tr_b16 v[104:105], v15 offset:41248
    v_mfma_f32_16x16x32_bf16 v[80:83], v[88:91], v[208:211], v[80:83]
    ds_read_b64_tr_b16 v[106:107], v15 offset:42272
    s_mov_b32 s23, 0xc000
    buffer_load_dwordx4 v[144:147], v4, s[8:11], s23 offen offset:0 sc1
    s_waitcnt vmcnt(14) lgkmcnt(6)
    v_mfma_f32_16x16x32_bf16 v[20:23], v[92:95], v[212:215], v[20:23]
    ds_read_b64_tr_b16 v[84:85], v3 offset:41472
    s_waitcnt vmcnt(12)
    v_mfma_f32_16x16x32_bf16 v[24:27], v[92:95], v[216:219], v[24:27]
    ds_read_b64_tr_b16 v[86:87], v3 offset:42496
    s_waitcnt lgkmcnt(6)
    v_mfma_f32_16x16x32_bf16 v[28:31], v[96:99], v[212:215], v[28:31]
    ds_read_b64_tr_b16 v[88:89], v15 offset:41504
    v_mfma_f32_16x16x32_bf16 v[32:35], v[96:99], v[216:219], v[32:35]
    s_add_u32 s22, s16, 0x418000
    s_add_u32 m0, s17, 0xc00
    s_nop 0
    buffer_load_dwordx4 v16, s[4:7], s22 offen lds
    ds_read_b64_tr_b16 v[90:91], v15 offset:42528
    s_waitcnt lgkmcnt(6)
    v_mfma_f32_16x16x32_bf16 v[36:39], v[100:103], v[212:215], v[36:39]
    ds_read_b64_tr_b16 v[92:93], v3 offset:41728
    v_mfma_f32_16x16x32_bf16 v[40:43], v[100:103], v[216:219], v[40:43]
    ds_read_b64_tr_b16 v[94:95], v3 offset:42752
    s_waitcnt lgkmcnt(6)
    v_mfma_f32_16x16x32_bf16 v[44:47], v[104:107], v[212:215], v[44:47]
    ds_read_b64_tr_b16 v[96:97], v15 offset:41760
    v_mfma_f32_16x16x32_bf16 v[48:51], v[104:107], v[216:219], v[48:51]
    ds_read_b64_tr_b16 v[98:99], v15 offset:42784
    s_mov_b32 s23, 0x4000
    buffer_load_dwordx4 v[148:151], v4, s[8:11], s23 offen offset:1024 sc1
    s_waitcnt lgkmcnt(6)
    v_mfma_f32_16x16x32_bf16 v[52:55], v[84:87], v[212:215], v[52:55]
    v_mfma_f32_16x16x32_bf16 v[56:59], v[84:87], v[216:219], v[56:59]
    s_waitcnt vmcnt(9)
    s_barrier
    ds_read_b64_tr_b16 v[100:101], v3 offset:49152
    ds_read_b64_tr_b16 v[102:103], v3 offset:50176
    s_waitcnt lgkmcnt(6)
    v_mfma_f32_16x16x32_bf16 v[60:63], v[88:91], v[212:215], v[60:63]
    ds_read_b64_tr_b16 v[104:105], v15 offset:49184
    v_mfma_f32_16x16x32_bf16 v[64:67], v[88:91], v[216:219], v[64:67]
    s_add_u32 s22, s16, 0x480000
    s_add_u32 m0, s17, 0x4000
    s_nop 0
    buffer_load_dwordx4 v2, s[4:7], s22 offen lds
    ds_read_b64_tr_b16 v[106:107], v15 offset:50208
    s_waitcnt lgkmcnt(6)
    v_mfma_f32_16x16x32_bf16 v[68:71], v[92:95], v[212:215], v[68:71]
    ds_read_b64_tr_b16 v[84:85], v3 offset:49408
    v_mfma_f32_16x16x32_bf16 v[72:75], v[92:95], v[216:219], v[72:75]
    ds_read_b64_tr_b16 v[86:87], v3 offset:50432
    s_waitcnt lgkmcnt(6)
    v_mfma_f32_16x16x32_bf16 v[76:79], v[96:99], v[212:215], v[76:79]
    ds_read_b64_tr_b16 v[88:89], v15 offset:49440
    v_mfma_f32_16x16x32_bf16 v[80:83], v[96:99], v[216:219], v[80:83]
    ds_read_b64_tr_b16 v[90:91], v15 offset:50464
    s_mov_b32 s23, 0xc000
    buffer_load_dwordx4 v[152:155], v4, s[8:11], s23 offen offset:1024 sc1
    s_waitcnt lgkmcnt(6)
    v_mfma_f32_16x16x32_bf16 v[20:23], v[100:103], v[220:223], v[20:23]
    ds_read_b64_tr_b16 v[92:93], v3 offset:49664
    v_mfma_f32_16x16x32_bf16 v[24:27], v[100:103], v[224:227], v[24:27]
    ds_read_b64_tr_b16 v[94:95], v3 offset:50688
    s_waitcnt lgkmcnt(6)
    v_mfma_f32_16x16x32_bf16 v[28:31], v[104:107], v[220:223], v[28:31]
    ds_read_b64_tr_b16 v[96:97], v15 offset:49696
    v_mfma_f32_16x16x32_bf16 v[32:35], v[104:107], v[224:227], v[32:35]
    s_add_u32 s22, s16, 0x488000
    s_add_u32 m0, s17, 0x4400
    s_nop 0
    buffer_load_dwordx4 v2, s[4:7], s22 offen lds
    ds_read_b64_tr_b16 v[98:99], v15 offset:50720
    s_waitcnt lgkmcnt(6)
    v_mfma_f32_16x16x32_bf16 v[36:39], v[84:87], v[220:223], v[36:39]
    ds_read_b64_tr_b16 v[100:101], v3 offset:49920
    v_mfma_f32_16x16x32_bf16 v[40:43], v[84:87], v[224:227], v[40:43]
    ds_read_b64_tr_b16 v[102:103], v3 offset:50944
    s_waitcnt lgkmcnt(6)
    v_mfma_f32_16x16x32_bf16 v[44:47], v[88:91], v[220:223], v[44:47]
    ds_read_b64_tr_b16 v[104:105], v15 offset:49952
    v_mfma_f32_16x16x32_bf16 v[48:51], v[88:91], v[224:227], v[48:51]
    ds_read_b64_tr_b16 v[106:107], v15 offset:50976
    s_mov_b32 s23, 0x4800
    buffer_load_dwordx4 v[204:207], v4, s[8:11], s23 offen offset:0 sc1
    s_waitcnt lgkmcnt(6)
    v_mfma_f32_16x16x32_bf16 v[52:55], v[92:95], v[220:223], v[52:55]
    ds_read_b64_tr_b16 v[84:85], v3 offset:57344
    v_mfma_f32_16x16x32_bf16 v[56:59], v[92:95], v[224:227], v[56:59]
    ds_read_b64_tr_b16 v[86:87], v3 offset:58368
    s_waitcnt lgkmcnt(6)
    v_mfma_f32_16x16x32_bf16 v[60:63], v[96:99], v[220:223], v[60:63]
    ds_read_b64_tr_b16 v[88:89], v15 offset:57376
    v_mfma_f32_16x16x32_bf16 v[64:67], v[96:99], v[224:227], v[64:67]
    s_add_u32 s22, s16, 0x490000
    s_add_u32 m0, s17, 0x4800
    s_nop 0
    buffer_load_dwordx4 v16, s[4:7], s22 offen lds
    ds_read_b64_tr_b16 v[90:91], v15 offset:58400
    s_waitcnt lgkmcnt(6)
    v_mfma_f32_16x16x32_bf16 v[68:71], v[100:103], v[220:223], v[68:71]
    ds_read_b64_tr_b16 v[92:93], v3 offset:57600
    v_mfma_f32_16x16x32_bf16 v[72:75], v[100:103], v[224:227], v[72:75]
    ds_read_b64_tr_b16 v[94:95], v3 offset:58624
    s_waitcnt lgkmcnt(6)
    v_mfma_f32_16x16x32_bf16 v[76:79], v[104:107], v[220:223], v[76:79]
    ds_read_b64_tr_b16 v[96:97], v15 offset:57632
    v_mfma_f32_16x16x32_bf16 v[80:83], v[104:107], v[224:227], v[80:83]
    ds_read_b64_tr_b16 v[98:99], v15 offset:58656
    s_mov_b32 s23, 0xc800
    buffer_load_dwordx4 v[208:211], v4, s[8:11], s23 offen offset:0 sc1
    s_waitcnt vmcnt(14) lgkmcnt(6)
    v_mfma_f32_16x16x32_bf16 v[20:23], v[84:87], v[228:231], v[20:23]
    ds_read_b64_tr_b16 v[100:101], v3 offset:57856
    s_waitcnt vmcnt(12)
    v_mfma_f32_16x16x32_bf16 v[24:27], v[84:87], v[232:235], v[24:27]
    ds_read_b64_tr_b16 v[102:103], v3 offset:58880
    s_waitcnt lgkmcnt(6)
    v_mfma_f32_16x16x32_bf16 v[28:31], v[88:91], v[228:231], v[28:31]
    ds_read_b64_tr_b16 v[104:105], v15 offset:57888
    v_mfma_f32_16x16x32_bf16 v[32:35], v[88:91], v[232:235], v[32:35]
    s_add_u32 s22, s16, 0x498000
    s_add_u32 m0, s17, 0x4c00
    s_nop 0
    buffer_load_dwordx4 v16, s[4:7], s22 offen lds
    ds_read_b64_tr_b16 v[106:107], v15 offset:58912
    s_waitcnt lgkmcnt(6)
    v_mfma_f32_16x16x32_bf16 v[36:39], v[92:95], v[228:231], v[36:39]
    ds_read_b64_tr_b16 v[84:85], v3 offset:58112
    v_mfma_f32_16x16x32_bf16 v[40:43], v[92:95], v[232:235], v[40:43]
    ds_read_b64_tr_b16 v[86:87], v3 offset:59136
    s_waitcnt lgkmcnt(6)
    v_mfma_f32_16x16x32_bf16 v[44:47], v[96:99], v[228:231], v[44:47]
    ds_read_b64_tr_b16 v[88:89], v15 offset:58144
    v_mfma_f32_16x16x32_bf16 v[48:51], v[96:99], v[232:235], v[48:51]
    ds_read_b64_tr_b16 v[90:91], v15 offset:59168
    s_mov_b32 s23, 0x4800
    buffer_load_dwordx4 v[212:215], v4, s[8:11], s23 offen offset:1024 sc1
    s_waitcnt lgkmcnt(6)
    v_mfma_f32_16x16x32_bf16 v[52:55], v[100:103], v[228:231], v[52:55]
    v_mfma_f32_16x16x32_bf16 v[56:59], v[100:103], v[232:235], v[56:59]
    s_waitcnt vmcnt(9)
    s_barrier
    ds_read_b64_tr_b16 v[92:93], v3 offset:0
    ds_read_b64_tr_b16 v[94:95], v3 offset:1024
    s_waitcnt lgkmcnt(6)
    v_mfma_f32_16x16x32_bf16 v[60:63], v[104:107], v[228:231], v[60:63]
    ds_read_b64_tr_b16 v[96:97], v15 offset:32
    v_mfma_f32_16x16x32_bf16 v[64:67], v[104:107], v[232:235], v[64:67]
    s_add_u32 s22, s16, 0x500000
    s_add_u32 m0, s17, 0x8000
    s_nop 0
    buffer_load_dwordx4 v2, s[4:7], s22 offen lds
    ds_read_b64_tr_b16 v[98:99], v15 offset:1056
    s_waitcnt lgkmcnt(6)
    v_mfma_f32_16x16x32_bf16 v[68:71], v[84:87], v[228:231], v[68:71]
    ds_read_b64_tr_b16 v[100:101], v3 offset:256
    v_mfma_f32_16x16x32_bf16 v[72:75], v[84:87], v[232:235], v[72:75]
    ds_read_b64_tr_b16 v[102:103], v3 offset:1280
    s_waitcnt lgkmcnt(6)
    v_mfma_f32_16x16x32_bf16 v[76:79], v[88:91], v[228:231], v[76:79]
    ds_read_b64_tr_b16 v[104:105], v15 offset:288
    v_mfma_f32_16x16x32_bf16 v[80:83], v[88:91], v[232:235], v[80:83]
    ds_read_b64_tr_b16 v[106:107], v15 offset:1312
    s_mov_b32 s23, 0xc800
    buffer_load_dwordx4 v[216:219], v4, s[8:11], s23 offen offset:1024 sc1
    s_waitcnt lgkmcnt(6)
    v_mfma_f32_16x16x32_bf16 v[20:23], v[92:95], v[140:143], v[20:23]
    ds_read_b64_tr_b16 v[84:85], v3 offset:512
    v_mfma_f32_16x16x32_bf16 v[24:27], v[92:95], v[144:147], v[24:27]
    ds_read_b64_tr_b16 v[86:87], v3 offset:1536
    s_waitcnt lgkmcnt(6)
    v_mfma_f32_16x16x32_bf16 v[28:31], v[96:99], v[140:143], v[28:31]
    ds_read_b64_tr_b16 v[88:89], v15 offset:544
    v_mfma_f32_16x16x32_bf16 v[32:35], v[96:99], v[144:147], v[32:35]
    s_add_u32 s22, s16, 0x508000
    s_add_u32 m0, s17, 0x8400
    s_nop 0
    buffer_load_dwordx4 v2, s[4:7], s22 offen lds
    ds_read_b64_tr_b16 v[90:91], v15 offset:1568
    s_waitcnt lgkmcnt(6)
    v_mfma_f32_16x16x32_bf16 v[36:39], v[100:103], v[140:143], v[36:39]
    ds_read_b64_tr_b16 v[92:93], v3 offset:768
    v_mfma_f32_16x16x32_bf16 v[40:43], v[100:103], v[144:147], v[40:43]
    ds_read_b64_tr_b16 v[94:95], v3 offset:1792
    s_waitcnt lgkmcnt(6)
    v_mfma_f32_16x16x32_bf16 v[44:47], v[104:107], v[140:143], v[44:47]
    ds_read_b64_tr_b16 v[96:97], v15 offset:800
    v_mfma_f32_16x16x32_bf16 v[48:51], v[104:107], v[144:147], v[48:51]
    ds_read_b64_tr_b16 v[98:99], v15 offset:1824
    s_mov_b32 s23, 0x5000
    buffer_load_dwordx4 v[220:223], v4, s[8:11], s23 offen offset:0 sc1
    s_waitcnt lgkmcnt(6)
    v_mfma_f32_16x16x32_bf16 v[52:55], v[84:87], v[140:143], v[52:55]
    ds_read_b64_tr_b16 v[100:101], v3 offset:8192
    v_mfma_f32_16x16x32_bf16 v[56:59], v[84:87], v[144:147], v[56:59]
    ds_read_b64_tr_b16 v[102:103], v3 offset:9216
    s_waitcnt lgkmcnt(6)
    v_mfma_f32_16x16x32_bf16 v[60:63], v[88:91], v[140:143], v[60:63]
    ds_read_b64_tr_b16 v[104:105], v15 offset:8224
    v_mfma_f32_16x16x32_bf16 v[64:67], v[88:91], v[144:147], v[64:67]
    s_add_u32 s22, s16, 0x510000
    s_add_u32 m0, s17, 0x8800
    s_nop 0
    buffer_load_dwordx4 v16, s[4:7], s22 offen lds
    ds_read_b64_tr_b16 v[106:107], v15 offset:9248
    s_waitcnt lgkmcnt(6)
    v_mfma_f32_16x16x32_bf16 v[68:71], v[92:95], v[140:143], v[68:71]
    ds_read_b64_tr_b16 v[84:85], v3 offset:8448
    v_mfma_f32_16x16x32_bf16 v[72:75], v[92:95], v[144:147], v[72:75]
    ds_read_b64_tr_b16 v[86:87], v3 offset:9472
    s_waitcnt lgkmcnt(6)
    v_mfma_f32_16x16x32_bf16 v[76:79], v[96:99], v[140:143], v[76:79]
    ds_read_b64_tr_b16 v[88:89], v15 offset:8480
    v_mfma_f32_16x16x32_bf16 v[80:83], v[96:99], v[144:147], v[80:83]
    ds_read_b64_tr_b16 v[90:91], v15 offset:9504
    s_mov_b32 s23, 0xd000
    buffer_load_dwordx4 v[224:227], v4, s[8:11], s23 offen offset:0 sc1
    s_waitcnt vmcnt(14) lgkmcnt(6)
    v_mfma_f32_16x16x32_bf16 v[20:23], v[100:103], v[148:151], v[20:23]
    ds_read_b64_tr_b16 v[92:93], v3 offset:8704
    s_waitcnt vmcnt(12)
    v_mfma_f32_16x16x32_bf16 v[24:27], v[100:103], v[152:155], v[24:27]
    ds_read_b64_tr_b16 v[94:95], v3 offset:9728
    s_waitcnt lgkmcnt(6)
    v_mfma_f32_16x16x32_bf16 v[28:31], v[104:107], v[148:151], v[28:31]
    ds_read_b64_tr_b16 v[96:97], v15 offset:8736
    v_mfma_f32_16x16x32_bf16 v[32:35], v[104:107], v[152:155], v[32:35]
    s_add_u32 s22, s16, 0x518000
    s_add_u32 m0, s17, 0x8c00
    s_nop 0
    buffer_load_dwordx4 v16, s[4:7], s22 offen lds
    ds_read_b64_tr_b16 v[98:99], v15 offset:9760
    s_waitcnt lgkmcnt(6)
    v_mfma_f32_16x16x32_bf16 v[36:39], v[84:87], v[148:151], v[36:39]
    ds_read_b64_tr_b16 v[100:101], v3 offset:8960
    v_mfma_f32_16x16x32_bf16 v[40:43], v[84:87], v[152:155], v[40:43]
    ds_read_b64_tr_b16 v[102:103], v3 offset:9984
    s_waitcnt lgkmcnt(6)
    v_mfma_f32_16x16x32_bf16 v[44:47], v[88:91], v[148:151], v[44:47]
    ds_read_b64_tr_b16 v[104:105], v15 offset:8992
    v_mfma_f32_16x16x32_bf16 v[48:51], v[88:91], v[152:155], v[48:51]
    ds_read_b64_tr_b16 v[106:107], v15 offset:10016
    s_mov_b32 s23, 0x5000
    buffer_load_dwordx4 v[228:231], v4, s[8:11], s23 offen offset:1024 sc1
    s_waitcnt lgkmcnt(6)
    v_mfma_f32_16x16x32_bf16 v[52:55], v[92:95], v[148:151], v[52:55]
    v_mfma_f32_16x16x32_bf16 v[56:59], v[92:95], v[152:155], v[56:59]
    s_waitcnt vmcnt(9)
    s_barrier
    ds_read_b64_tr_b16 v[84:85], v3 offset:16384
    ds_read_b64_tr_b16 v[86:87], v3 offset:17408
    s_waitcnt lgkmcnt(6)
    v_mfma_f32_16x16x32_bf16 v[60:63], v[96:99], v[148:151], v[60:63]
    ds_read_b64_tr_b16 v[88:89], v15 offset:16416
    v_mfma_f32_16x16x32_bf16 v[64:67], v[96:99], v[152:155], v[64:67]
    s_add_u32 s22, s16, 0x580000
    s_add_u32 m0, s17, 0xc000
    s_nop 0
    buffer_load_dwordx4 v2, s[4:7], s22 offen lds
    ds_read_b64_tr_b16 v[90:91], v15 offset:17440
    s_waitcnt lgkmcnt(6)
    v_mfma_f32_16x16x32_bf16 v[68:71], v[100:103], v[148:151], v[68:71]
    ds_read_b64_tr_b16 v[92:93], v3 offset:16640
    v_mfma_f32_16x16x32_bf16 v[72:75], v[100:103], v[152:155], v[72:75]
    ds_read_b64_tr_b16 v[94:95], v3 offset:17664
    s_waitcnt lgkmcnt(6)
    v_mfma_f32_16x16x32_bf16 v[76:79], v[104:107], v[148:151], v[76:79]
    ds_read_b64_tr_b16 v[96:97], v15 offset:16672
    v_mfma_f32_16x16x32_bf16 v[80:83], v[104:107], v[152:155], v[80:83]
    ds_read_b64_tr_b16 v[98:99], v15 offset:17696
    s_mov_b32 s23, 0xd000
    buffer_load_dwordx4 v[232:235], v4, s[8:11], s23 offen offset:1024 sc1
    s_waitcnt lgkmcnt(6)
    v_mfma_f32_16x16x32_bf16 v[20:23], v[84:87], v[204:207], v[20:23]
    ds_read_b64_tr_b16 v[100:101], v3 offset:16896
    v_mfma_f32_16x16x32_bf16 v[24:27], v[84:87], v[208:211], v[24:27]
    ds_read_b64_tr_b16 v[102:103], v3 offset:17920
    s_waitcnt lgkmcnt(6)
    v_mfma_f32_16x16x32_bf16 v[28:31], v[88:91], v[204:207], v[28:31]
    ds_read_b64_tr_b16 v[104:105], v15 offset:16928
    v_mfma_f32_16x16x32_bf16 v[32:35], v[88:91], v[208:211], v[32:35]
    s_add_u32 s22, s16, 0x588000
    s_add_u32 m0, s17, 0xc400
    s_nop 0
    buffer_load_dwordx4 v2, s[4:7], s22 offen lds
    ds_read_b64_tr_b16 v[106:107], v15 offset:17952
    s_waitcnt lgkmcnt(6)
    v_mfma_f32_16x16x32_bf16 v[36:39], v[92:95], v[204:207], v[36:39]
    ds_read_b64_tr_b16 v[84:85], v3 offset:17152
    v_mfma_f32_16x16x32_bf16 v[40:43], v[92:95], v[208:211], v[40:43]
    ds_read_b64_tr_b16 v[86:87], v3 offset:18176
    s_waitcnt lgkmcnt(6)
    v_mfma_f32_16x16x32_bf16 v[44:47], v[96:99], v[204:207], v[44:47]
    ds_read_b64_tr_b16 v[88:89], v15 offset:17184
    v_mfma_f32_16x16x32_bf16 v[48:51], v[96:99], v[208:211], v[48:51]
    ds_read_b64_tr_b16 v[90:91], v15 offset:18208
    s_mov_b32 s23, 0x5800
    buffer_load_dwordx4 v[140:143], v4, s[8:11], s23 offen offset:0 sc1
    s_waitcnt lgkmcnt(6)
    v_mfma_f32_16x16x32_bf16 v[52:55], v[100:103], v[204:207], v[52:55]
    ds_read_b64_tr_b16 v[92:93], v3 offset:24576
    v_mfma_f32_16x16x32_bf16 v[56:59], v[100:103], v[208:211], v[56:59]
    ds_read_b64_tr_b16 v[94:95], v3 offset:25600
    s_waitcnt lgkmcnt(6)
    v_mfma_f32_16x16x32_bf16 v[60:63], v[104:107], v[204:207], v[60:63]
    ds_read_b64_tr_b16 v[96:97], v15 offset:24608
    v_mfma_f32_16x16x32_bf16 v[64:67], v[104:107], v[208:211], v[64:67]
    s_add_u32 s22, s16, 0x590000
    s_add_u32 m0, s17, 0xc800
    s_nop 0
    buffer_load_dwordx4 v16, s[4:7], s22 offen lds
    ds_read_b64_tr_b16 v[98:99], v15 offset:25632
    s_waitcnt lgkmcnt(6)
    v_mfma_f32_16x16x32_bf16 v[68:71], v[84:87], v[204:207], v[68:71]
    ds_read_b64_tr_b16 v[100:101], v3 offset:24832
    v_mfma_f32_16x16x32_bf16 v[72:75], v[84:87], v[208:211], v[72:75]
    ds_read_b64_tr_b16 v[102:103], v3 offset:25856
    s_waitcnt lgkmcnt(6)
    v_mfma_f32_16x16x32_bf16 v[76:79], v[88:91], v[204:207], v[76:79]
    ds_read_b64_tr_b16 v[104:105], v15 offset:24864
    v_mfma_f32_16x16x32_bf16 v[80:83], v[88:91], v[208:211], v[80:83]
    ds_read_b64_tr_b16 v[106:107], v15 offset:25888
    s_mov_b32 s23, 0xd800
    buffer_load_dwordx4 v[144:147], v4, s[8:11], s23 offen offset:0 sc1
    s_waitcnt vmcnt(14) lgkmcnt(6)
    v_mfma_f32_16x16x32_bf16 v[20:23], v[92:95], v[212:215], v[20:23]
    ds_read_b64_tr_b16 v[84:85], v3 offset:25088
    s_waitcnt vmcnt(12)
    v_mfma_f32_16x16x32_bf16 v[24:27], v[92:95], v[216:219], v[24:27]
    ds_read_b64_tr_b16 v[86:87], v3 offset:26112
    s_waitcnt lgkmcnt(6)
    v_mfma_f32_16x16x32_bf16 v[28:31], v[96:99], v[212:215], v[28:31]
    ds_read_b64_tr_b16 v[88:89], v15 offset:25120
    v_mfma_f32_16x16x32_bf16 v[32:35], v[96:99], v[216:219], v[32:35]
    s_add_u32 s22, s16, 0x598000
    s_add_u32 m0, s17, 0xcc00
    s_nop 0
    buffer_load_dwordx4 v16, s[4:7], s22 offen lds
    ds_read_b64_tr_b16 v[90:91], v15 offset:26144
    s_waitcnt lgkmcnt(6)
    v_mfma_f32_16x16x32_bf16 v[36:39], v[100:103], v[212:215], v[36:39]
    ds_read_b64_tr_b16 v[92:93], v3 offset:25344
    v_mfma_f32_16x16x32_bf16 v[40:43], v[100:103], v[216:219], v[40:43]
    ds_read_b64_tr_b16 v[94:95], v3 offset:26368
    s_waitcnt lgkmcnt(6)
    v_mfma_f32_16x16x32_bf16 v[44:47], v[104:107], v[212:215], v[44:47]
    ds_read_b64_tr_b16 v[96:97], v15 offset:25376
    v_mfma_f32_16x16x32_bf16 v[48:51], v[104:107], v[216:219], v[48:51]
    ds_read_b64_tr_b16 v[98:99], v15 offset:26400
    s_mov_b32 s23, 0x5800
    buffer_load_dwordx4 v[148:151], v4, s[8:11], s23 offen offset:1024 sc1
    s_waitcnt lgkmcnt(6)
    v_mfma_f32_16x16x32_bf16 v[52:55], v[84:87], v[212:215], v[52:55]
    v_mfma_f32_16x16x32_bf16 v[56:59], v[84:87], v[216:219], v[56:59]
    s_waitcnt vmcnt(9)
    s_barrier
    ds_read_b64_tr_b16 v[100:101], v3 offset:32768
    ds_read_b64_tr_b16 v[102:103], v3 offset:33792
    s_waitcnt lgkmcnt(6)
    v_mfma_f32_16x16x32_bf16 v[60:63], v[88:91], v[212:215], v[60:63]
    ds_read_b64_tr_b16 v[104:105], v15 offset:32800
    v_mfma_f32_16x16x32_bf16 v[64:67], v[88:91], v[216:219], v[64:67]
    s_add_u32 s22, s16, 0x600000
    s_add_u32 m0, s17, 0x0
    s_nop 0
    buffer_load_dwordx4 v2, s[4:7], s22 offen lds
    ds_read_b64_tr_b16 v[106:107], v15 offset:33824
    s_waitcnt lgkmcnt(6)
    v_mfma_f32_16x16x32_bf16 v[68:71], v[92:95], v[212:215], v[68:71]
    ds_read_b64_tr_b16 v[84:85], v3 offset:33024
    v_mfma_f32_16x16x32_bf16 v[72:75], v[92:95], v[216:219], v[72:75]
    ds_read_b64_tr_b16 v[86:87], v3 offset:34048
    s_waitcnt lgkmcnt(6)
    v_mfma_f32_16x16x32_bf16 v[76:79], v[96:99], v[212:215], v[76:79]
    ds_read_b64_tr_b16 v[88:89], v15 offset:33056
    v_mfma_f32_16x16x32_bf16 v[80:83], v[96:99], v[216:219], v[80:83]
    ds_read_b64_tr_b16 v[90:91], v15 offset:34080
    s_mov_b32 s23, 0xd800
    buffer_load_dwordx4 v[152:155], v4, s[8:11], s23 offen offset:1024 sc1
    s_waitcnt lgkmcnt(6)
    v_mfma_f32_16x16x32_bf16 v[20:23], v[100:103], v[220:223], v[20:23]
    ds_read_b64_tr_b16 v[92:93], v3 offset:33280
    v_mfma_f32_16x16x32_bf16 v[24:27], v[100:103], v[224:227], v[24:27]
    ds_read_b64_tr_b16 v[94:95], v3 offset:34304
    s_waitcnt lgkmcnt(6)
    v_mfma_f32_16x16x32_bf16 v[28:31], v[104:107], v[220:223], v[28:31]
    ds_read_b64_tr_b16 v[96:97], v15 offset:33312
    v_mfma_f32_16x16x32_bf16 v[32:35], v[104:107], v[224:227], v[32:35]
    s_add_u32 s22, s16, 0x608000
    s_add_u32 m0, s17, 0x400
    s_nop 0
    buffer_load_dwordx4 v2, s[4:7], s22 offen lds
    ds_read_b64_tr_b16 v[98:99], v15 offset:34336
    s_waitcnt lgkmcnt(6)
    v_mfma_f32_16x16x32_bf16 v[36:39], v[84:87], v[220:223], v[36:39]
    ds_read_b64_tr_b16 v[100:101], v3 offset:33536
    v_mfma_f32_16x16x32_bf16 v[40:43], v[84:87], v[224:227], v[40:43]
    ds_read_b64_tr_b16 v[102:103], v3 offset:34560
    s_waitcnt lgkmcnt(6)
    v_mfma_f32_16x16x32_bf16 v[44:47], v[88:91], v[220:223], v[44:47]
    ds_read_b64_tr_b16 v[104:105], v15 offset:33568
    v_mfma_f32_16x16x32_bf16 v[48:51], v[88:91], v[224:227], v[48:51]
    ds_read_b64_tr_b16 v[106:107], v15 offset:34592
    s_mov_b32 s23, 0x6000
    buffer_load_dwordx4 v[204:207], v4, s[8:11], s23 offen offset:0 sc1
    s_waitcnt lgkmcnt(6)
    v_mfma_f32_16x16x32_bf16 v[52:55], v[92:95], v[220:223], v[52:55]
    ds_read_b64_tr_b16 v[84:85], v3 offset:40960
    v_mfma_f32_16x16x32_bf16 v[56:59], v[92:95], v[224:227], v[56:59]
    ds_read_b64_tr_b16 v[86:87], v3 offset:41984
    s_waitcnt lgkmcnt(6)
    v_mfma_f32_16x16x32_bf16 v[60:63], v[96:99], v[220:223], v[60:63]
    ds_read_b64_tr_b16 v[88:89], v15 offset:40992
    v_mfma_f32_16x16x32_bf16 v[64:67], v[96:99], v[224:227], v[64:67]
    s_add_u32 s22, s16, 0x610000
    s_add_u32 m0, s17, 0x800
    s_nop 0
    buffer_load_dwordx4 v16, s[4:7], s22 offen lds
    ds_read_b64_tr_b16 v[90:91], v15 offset:42016
    s_waitcnt lgkmcnt(6)
    v_mfma_f32_16x16x32_bf16 v[68:71], v[100:103], v[220:223], v[68:71]
    ds_read_b64_tr_b16 v[92:93], v3 offset:41216
    v_mfma_f32_16x16x32_bf16 v[72:75], v[100:103], v[224:227], v[72:75]
    ds_read_b64_tr_b16 v[94:95], v3 offset:42240
    s_waitcnt lgkmcnt(6)
    v_mfma_f32_16x16x32_bf16 v[76:79], v[104:107], v[220:223], v[76:79]
    ds_read_b64_tr_b16 v[96:97], v15 offset:41248
    v_mfma_f32_16x16x32_bf16 v[80:83], v[104:107], v[224:227], v[80:83]
    ds_read_b64_tr_b16 v[98:99], v15 offset:42272
    s_mov_b32 s23, 0xe000
    buffer_load_dwordx4 v[208:211], v4, s[8:11], s23 offen offset:0 sc1
    s_waitcnt vmcnt(14) lgkmcnt(6)
    v_mfma_f32_16x16x32_bf16 v[20:23], v[84:87], v[228:231], v[20:23]
    ds_read_b64_tr_b16 v[100:101], v3 offset:41472
    s_waitcnt vmcnt(12)
    v_mfma_f32_16x16x32_bf16 v[24:27], v[84:87], v[232:235], v[24:27]
    ds_read_b64_tr_b16 v[102:103], v3 offset:42496
    s_waitcnt lgkmcnt(6)
    v_mfma_f32_16x16x32_bf16 v[28:31], v[88:91], v[228:231], v[28:31]
    ds_read_b64_tr_b16 v[104:105], v15 offset:41504
    v_mfma_f32_16x16x32_bf16 v[32:35], v[88:91], v[232:235], v[32:35]
    s_add_u32 s22, s16, 0x618000
    s_add_u32 m0, s17, 0xc00
    s_nop 0
    buffer_load_dwordx4 v16, s[4:7], s22 offen lds
    ds_read_b64_tr_b16 v[106:107], v15 offset:42528
    s_waitcnt lgkmcnt(6)
    v_mfma_f32_16x16x32_bf16 v[36:39], v[92:95], v[228:231], v[36:39]
    ds_read_b64_tr_b16 v[84:85], v3 offset:41728
    v_mfma_f32_16x16x32_bf16 v[40:43], v[92:95], v[232:235], v[40:43]
    ds_read_b64_tr_b16 v[86:87], v3 offset:42752
    s_waitcnt lgkmcnt(6)
    v_mfma_f32_16x16x32_bf16 v[44:47], v[96:99], v[228:231], v[44:47]
    ds_read_b64_tr_b16 v[88:89], v15 offset:41760
    v_mfma_f32_16x16x32_bf16 v[48:51], v[96:99], v[232:235], v[48:51]
    ds_read_b64_tr_b16 v[90:91], v15 offset:42784
    s_mov_b32 s23, 0x6000
    buffer_load_dwordx4 v[212:215], v4, s[8:11], s23 offen offset:1024 sc1
    s_waitcnt lgkmcnt(6)
    v_mfma_f32_16x16x32_bf16 v[52:55], v[100:103], v[228:231], v[52:55]
    v_mfma_f32_16x16x32_bf16 v[56:59], v[100:103], v[232:235], v[56:59]
    s_waitcnt vmcnt(9)
    s_barrier
    ds_read_b64_tr_b16 v[92:93], v3 offset:49152
    ds_read_b64_tr_b16 v[94:95], v3 offset:50176
    s_waitcnt lgkmcnt(6)
    v_mfma_f32_16x16x32_bf16 v[60:63], v[104:107], v[228:231], v[60:63]
    s_lshr_b32 s26, s12, 3
    s_lshl_b32 s26, s26, 10
    s_add_u32 s62, s26, 0x530000
    buffer_load_dword v17, v1, s[8:11], s62 offen offset:0 sc1
    buffer_load_dword v18, v1, s[8:11], s62 offen offset:4 sc1
    buffer_load_dword v19, v1, s[8:11], s62 offen offset:8 sc1
    buffer_load_dword v6, v1, s[8:11], s62 offen offset:12 sc1
    ds_read_b64_tr_b16 v[96:97], v15 offset:49184
    v_mfma_f32_16x16x32_bf16 v[64:67], v[104:107], v[232:235], v[64:67]
    s_add_u32 s22, s16, 0x680000
    s_add_u32 m0, s17, 0x4000
    s_nop 0
    buffer_load_dwordx4 v2, s[4:7], s22 offen lds
    ds_read_b64_tr_b16 v[98:99], v15 offset:50208
    s_waitcnt lgkmcnt(6)
    v_mfma_f32_16x16x32_bf16 v[68:71], v[84:87], v[228:231], v[68:71]
    ds_read_b64_tr_b16 v[100:101], v3 offset:49408
    v_mfma_f32_16x16x32_bf16 v[72:75], v[84:87], v[232:235], v[72:75]
    ds_read_b64_tr_b16 v[102:103], v3 offset:50432
    s_waitcnt lgkmcnt(6)
    v_mfma_f32_16x16x32_bf16 v[76:79], v[88:91], v[228:231], v[76:79]
    ds_read_b64_tr_b16 v[104:105], v15 offset:49440
    v_mfma_f32_16x16x32_bf16 v[80:83], v[88:91], v[232:235], v[80:83]
    ds_read_b64_tr_b16 v[106:107], v15 offset:50464
    s_mov_b32 s23, 0xe000
    buffer_load_dwordx4 v[216:219], v4, s[8:11], s23 offen offset:1024 sc1
    s_waitcnt lgkmcnt(6)
    v_mfma_f32_16x16x32_bf16 v[20:23], v[92:95], v[140:143], v[20:23]
    ds_read_b64_tr_b16 v[84:85], v3 offset:49664
    v_mfma_f32_16x16x32_bf16 v[24:27], v[92:95], v[144:147], v[24:27]
    ds_read_b64_tr_b16 v[86:87], v3 offset:50688
    s_waitcnt lgkmcnt(6)
    v_mfma_f32_16x16x32_bf16 v[28:31], v[96:99], v[140:143], v[28:31]
    ds_read_b64_tr_b16 v[88:89], v15 offset:49696
    v_mfma_f32_16x16x32_bf16 v[32:35], v[96:99], v[144:147], v[32:35]
    s_add_u32 s22, s16, 0x688000
    s_add_u32 m0, s17, 0x4400
    s_nop 0
    buffer_load_dwordx4 v2, s[4:7], s22 offen lds
    ds_read_b64_tr_b16 v[90:91], v15 offset:50720
    s_waitcnt lgkmcnt(6)
    v_mfma_f32_16x16x32_bf16 v[36:39], v[100:103], v[140:143], v[36:39]
    ds_read_b64_tr_b16 v[92:93], v3 offset:49920
    v_mfma_f32_16x16x32_bf16 v[40:43], v[100:103], v[144:147], v[40:43]
    ds_read_b64_tr_b16 v[94:95], v3 offset:50944
    s_waitcnt lgkmcnt(6)
    v_mfma_f32_16x16x32_bf16 v[44:47], v[104:107], v[140:143], v[44:47]
    ds_read_b64_tr_b16 v[96:97], v15 offset:49952
    v_mfma_f32_16x16x32_bf16 v[48:51], v[104:107], v[144:147], v[48:51]
    ds_read_b64_tr_b16 v[98:99], v15 offset:50976
    s_mov_b32 s23, 0x6800
    buffer_load_dwordx4 v[220:223], v4, s[8:11], s23 offen offset:0 sc1
    s_waitcnt lgkmcnt(6)
    v_mfma_f32_16x16x32_bf16 v[52:55], v[84:87], v[140:143], v[52:55]
    ds_read_b64_tr_b16 v[100:101], v3 offset:57344
    v_mfma_f32_16x16x32_bf16 v[56:59], v[84:87], v[144:147], v[56:59]
    ds_read_b64_tr_b16 v[102:103], v3 offset:58368
    s_waitcnt lgkmcnt(6)
    v_mfma_f32_16x16x32_bf16 v[60:63], v[88:91], v[140:143], v[60:63]
    ds_read_b64_tr_b16 v[104:105], v15 offset:57376
    v_mfma_f32_16x16x32_bf16 v[64:67], v[88:91], v[144:147], v[64:67]
    s_add_u32 s22, s16, 0x690000
    s_add_u32 m0, s17, 0x4800
    s_nop 0
    buffer_load_dwordx4 v16, s[4:7], s22 offen lds
    ds_read_b64_tr_b16 v[106:107], v15 offset:58400
    s_waitcnt lgkmcnt(6)
    v_mfma_f32_16x16x32_bf16 v[68:71], v[92:95], v[140:143], v[68:71]
    ds_read_b64_tr_b16 v[84:85], v3 offset:57600
    v_mfma_f32_16x16x32_bf16 v[72:75], v[92:95], v[144:147], v[72:75]
    ds_read_b64_tr_b16 v[86:87], v3 offset:58624
    s_waitcnt lgkmcnt(6)
    v_mfma_f32_16x16x32_bf16 v[76:79], v[96:99], v[140:143], v[76:79]
    ds_read_b64_tr_b16 v[88:89], v15 offset:57632
    v_mfma_f32_16x16x32_bf16 v[80:83], v[96:99], v[144:147], v[80:83]
    ds_read_b64_tr_b16 v[90:91], v15 offset:58656
    s_mov_b32 s23, 0xe800
    buffer_load_dwordx4 v[224:227], v4, s[8:11], s23 offen offset:0 sc1
    s_waitcnt vmcnt(18) lgkmcnt(6)
    v_mfma_f32_16x16x32_bf16 v[20:23], v[100:103], v[148:151], v[20:23]
    ds_read_b64_tr_b16 v[92:93], v3 offset:57856
    s_waitcnt vmcnt(16)
    v_mfma_f32_16x16x32_bf16 v[24:27], v[100:103], v[152:155], v[24:27]
    ds_read_b64_tr_b16 v[94:95], v3 offset:58880
    s_waitcnt lgkmcnt(6)
    v_mfma_f32_16x16x32_bf16 v[28:31], v[104:107], v[148:151], v[28:31]
    ds_read_b64_tr_b16 v[96:97], v15 offset:57888
    v_mfma_f32_16x16x32_bf16 v[32:35], v[104:107], v[152:155], v[32:35]
    s_add_u32 s22, s16, 0x698000
    s_add_u32 m0, s17, 0x4c00
    s_nop 0
    buffer_load_dwordx4 v16, s[4:7], s22 offen lds
    ds_read_b64_tr_b16 v[98:99], v15 offset:58912
    s_waitcnt lgkmcnt(6)
    v_mfma_f32_16x16x32_bf16 v[36:39], v[84:87], v[148:151], v[36:39]
    ds_read_b64_tr_b16 v[100:101], v3 offset:58112
    v_mfma_f32_16x16x32_bf16 v[40:43], v[84:87], v[152:155], v[40:43]
    ds_read_b64_tr_b16 v[102:103], v3 offset:59136
    s_waitcnt lgkmcnt(6)
    v_mfma_f32_16x16x32_bf16 v[44:47], v[88:91], v[148:151], v[44:47]
    ds_read_b64_tr_b16 v[104:105], v15 offset:58144
    v_mfma_f32_16x16x32_bf16 v[48:51], v[88:91], v[152:155], v[48:51]
    ds_read_b64_tr_b16 v[106:107], v15 offset:59168
    s_mov_b32 s23, 0x6800
    buffer_load_dwordx4 v[228:231], v4, s[8:11], s23 offen offset:1024 sc1
    s_waitcnt lgkmcnt(6)
    v_mfma_f32_16x16x32_bf16 v[52:55], v[92:95], v[148:151], v[52:55]
    v_mfma_f32_16x16x32_bf16 v[56:59], v[92:95], v[152:155], v[56:59]
    s_waitcnt vmcnt(13)
    s_barrier
    ds_read_b64_tr_b16 v[84:85], v3 offset:0
    ds_read_b64_tr_b16 v[86:87], v3 offset:1024
    s_waitcnt lgkmcnt(6)
    v_mfma_f32_16x16x32_bf16 v[60:63], v[96:99], v[148:151], v[60:63]
    ds_read_b64_tr_b16 v[88:89], v15 offset:32
    v_mfma_f32_16x16x32_bf16 v[64:67], v[96:99], v[152:155], v[64:67]
    s_add_u32 s22, s16, 0x700000
    s_add_u32 m0, s17, 0x8000
    s_nop 0
    buffer_load_dwordx4 v2, s[4:7], s22 offen lds
    ds_read_b64_tr_b16 v[90:91], v15 offset:1056
    s_waitcnt lgkmcnt(6)
    v_mfma_f32_16x16x32_bf16 v[68:71], v[100:103], v[148:151], v[68:71]
    ds_read_b64_tr_b16 v[92:93], v3 offset:256
    v_mfma_f32_16x16x32_bf16 v[72:75], v[100:103], v[152:155], v[72:75]
    ds_read_b64_tr_b16 v[94:95], v3 offset:1280
    s_waitcnt lgkmcnt(6)
    v_mfma_f32_16x16x32_bf16 v[76:79], v[104:107], v[148:151], v[76:79]
    ds_read_b64_tr_b16 v[96:97], v15 offset:288
    v_mfma_f32_16x16x32_bf16 v[80:83], v[104:107], v[152:155], v[80:83]
    ds_read_b64_tr_b16 v[98:99], v15 offset:1312
    s_mov_b32 s23, 0xe800
    buffer_load_dwordx4 v[232:235], v4, s[8:11], s23 offen offset:1024 sc1
    s_waitcnt lgkmcnt(6)
    v_mfma_f32_16x16x32_bf16 v[20:23], v[84:87], v[204:207], v[20:23]
    ds_read_b64_tr_b16 v[100:101], v3 offset:512
    v_mfma_f32_16x16x32_bf16 v[24:27], v[84:87], v[208:211], v[24:27]
    ds_read_b64_tr_b16 v[102:103], v3 offset:1536
    s_waitcnt lgkmcnt(6)
    v_mfma_f32_16x16x32_bf16 v[28:31], v[88:91], v[204:207], v[28:31]
    ds_read_b64_tr_b16 v[104:105], v15 offset:544
    v_mfma_f32_16x16x32_bf16 v[32:35], v[88:91], v[208:211], v[32:35]
    s_add_u32 s22, s16, 0x708000
    s_add_u32 m0, s17, 0x8400
    s_nop 0
    buffer_load_dwordx4 v2, s[4:7], s22 offen lds
    ds_read_b64_tr_b16 v[106:107], v15 offset:1568
    s_waitcnt lgkmcnt(6)
    v_mfma_f32_16x16x32_bf16 v[36:39], v[92:95], v[204:207], v[36:39]
    ds_read_b64_tr_b16 v[84:85], v3 offset:768
    v_mfma_f32_16x16x32_bf16 v[40:43], v[92:95], v[208:211], v[40:43]
    ds_read_b64_tr_b16 v[86:87], v3 offset:1792
    s_waitcnt lgkmcnt(6)
    v_mfma_f32_16x16x32_bf16 v[44:47], v[96:99], v[204:207], v[44:47]
    ds_read_b64_tr_b16 v[88:89], v15 offset:800
    v_mfma_f32_16x16x32_bf16 v[48:51], v[96:99], v[208:211], v[48:51]
    ds_read_b64_tr_b16 v[90:91], v15 offset:1824
    s_mov_b32 s23, 0x7000
    buffer_load_dwordx4 v[140:143], v4, s[8:11], s23 offen offset:0 sc1
    s_waitcnt lgkmcnt(6)
    v_mfma_f32_16x16x32_bf16 v[52:55], v[100:103], v[204:207], v[52:55]
    ds_read_b64_tr_b16 v[92:93], v3 offset:8192
    v_mfma_f32_16x16x32_bf16 v[56:59], v[100:103], v[208:211], v[56:59]
    ds_read_b64_tr_b16 v[94:95], v3 offset:9216
    s_waitcnt lgkmcnt(6)
    v_mfma_f32_16x16x32_bf16 v[60:63], v[104:107], v[204:207], v[60:63]
    ds_read_b64_tr_b16 v[96:97], v15 offset:8224
    v_mfma_f32_16x16x32_bf16 v[64:67], v[104:107], v[208:211], v[64:67]
    s_add_u32 s22, s16, 0x710000
    s_add_u32 m0, s17, 0x8800
    s_nop 0
    buffer_load_dwordx4 v16, s[4:7], s22 offen lds
    ds_read_b64_tr_b16 v[98:99], v15 offset:9248
    s_waitcnt lgkmcnt(6)
    v_mfma_f32_16x16x32_bf16 v[68:71], v[84:87], v[204:207], v[68:71]
    ds_read_b64_tr_b16 v[100:101], v3 offset:8448
    v_mfma_f32_16x16x32_bf16 v[72:75], v[84:87], v[208:211], v[72:75]
    ds_read_b64_tr_b16 v[102:103], v3 offset:9472
    s_waitcnt lgkmcnt(6)
    v_mfma_f32_16x16x32_bf16 v[76:79], v[88:91], v[204:207], v[76:79]
    ds_read_b64_tr_b16 v[104:105], v15 offset:8480
    v_mfma_f32_16x16x32_bf16 v[80:83], v[88:91], v[208:211], v[80:83]
    ds_read_b64_tr_b16 v[106:107], v15 offset:9504
    s_mov_b32 s23, 0xf000
    buffer_load_dwordx4 v[144:147], v4, s[8:11], s23 offen offset:0 sc1
    s_waitcnt vmcnt(18) lgkmcnt(6)
    v_mfma_f32_16x16x32_bf16 v[20:23], v[92:95], v[212:215], v[20:23]
    ds_read_b64_tr_b16 v[84:85], v3 offset:8704
    s_waitcnt vmcnt(12)
    v_mfma_f32_16x16x32_bf16 v[24:27], v[92:95], v[216:219], v[24:27]
    ds_read_b64_tr_b16 v[86:87], v3 offset:9728
    s_waitcnt lgkmcnt(6)
    v_mfma_f32_16x16x32_bf16 v[28:31], v[96:99], v[212:215], v[28:31]
    ds_read_b64_tr_b16 v[88:89], v15 offset:8736
    v_mfma_f32_16x16x32_bf16 v[32:35], v[96:99], v[216:219], v[32:35]
    s_add_u32 s22, s16, 0x718000
    s_add_u32 m0, s17, 0x8c00
    s_nop 0
    buffer_load_dwordx4 v16, s[4:7], s22 offen lds
    ds_read_b64_tr_b16 v[90:91], v15 offset:9760
    s_waitcnt lgkmcnt(6)
    v_mfma_f32_16x16x32_bf16 v[36:39], v[100:103], v[212:215], v[36:39]
    ds_read_b64_tr_b16 v[92:93], v3 offset:8960
    v_mfma_f32_16x16x32_bf16 v[40:43], v[100:103], v[216:219], v[40:43]
    ds_read_b64_tr_b16 v[94:95], v3 offset:9984
    s_waitcnt lgkmcnt(6)
    v_mfma_f32_16x16x32_bf16 v[44:47], v[104:107], v[212:215], v[44:47]
    ds_read_b64_tr_b16 v[96:97], v15 offset:8992
    v_mfma_f32_16x16x32_bf16 v[48:51], v[104:107], v[216:219], v[48:51]
    ds_read_b64_tr_b16 v[98:99], v15 offset:10016
    s_mov_b32 s23, 0x7000
    buffer_load_dwordx4 v[148:151], v4, s[8:11], s23 offen offset:1024 sc1
    s_waitcnt lgkmcnt(6)
    v_mfma_f32_16x16x32_bf16 v[52:55], v[84:87], v[212:215], v[52:55]
    v_mfma_f32_16x16x32_bf16 v[56:59], v[84:87], v[216:219], v[56:59]
    s_waitcnt vmcnt(9)
    s_barrier
    ds_read_b64_tr_b16 v[100:101], v3 offset:16384
    ds_read_b64_tr_b16 v[102:103], v3 offset:17408
    s_waitcnt lgkmcnt(6)
    v_mfma_f32_16x16x32_bf16 v[60:63], v[88:91], v[212:215], v[60:63]
    ds_read_b64_tr_b16 v[104:105], v15 offset:16416
    v_mfma_f32_16x16x32_bf16 v[64:67], v[88:91], v[216:219], v[64:67]
    s_add_u32 s22, s16, 0x780000
    s_add_u32 m0, s17, 0xc000
    s_nop 0
    buffer_load_dwordx4 v2, s[4:7], s22 offen lds
    ds_read_b64_tr_b16 v[106:107], v15 offset:17440
    s_waitcnt lgkmcnt(6)
    v_mfma_f32_16x16x32_bf16 v[68:71], v[92:95], v[212:215], v[68:71]
    ds_read_b64_tr_b16 v[84:85], v3 offset:16640
    v_mfma_f32_16x16x32_bf16 v[72:75], v[92:95], v[216:219], v[72:75]
    ds_read_b64_tr_b16 v[86:87], v3 offset:17664
    s_waitcnt lgkmcnt(6)
    v_mfma_f32_16x16x32_bf16 v[76:79], v[96:99], v[212:215], v[76:79]
    ds_read_b64_tr_b16 v[88:89], v15 offset:16672
    v_mfma_f32_16x16x32_bf16 v[80:83], v[96:99], v[216:219], v[80:83]
    ds_read_b64_tr_b16 v[90:91], v15 offset:17696
    s_mov_b32 s23, 0xf000
    buffer_load_dwordx4 v[152:155], v4, s[8:11], s23 offen offset:1024 sc1
    s_waitcnt lgkmcnt(6)
    v_mfma_f32_16x16x32_bf16 v[20:23], v[100:103], v[220:223], v[20:23]
    ds_read_b64_tr_b16 v[92:93], v3 offset:16896
    v_mfma_f32_16x16x32_bf16 v[24:27], v[100:103], v[224:227], v[24:27]
    ds_read_b64_tr_b16 v[94:95], v3 offset:17920
    s_waitcnt lgkmcnt(6)
    v_mfma_f32_16x16x32_bf16 v[28:31], v[104:107], v[220:223], v[28:31]
    ds_read_b64_tr_b16 v[96:97], v15 offset:16928
    v_mfma_f32_16x16x32_bf16 v[32:35], v[104:107], v[224:227], v[32:35]
    s_add_u32 s22, s16, 0x788000
    s_add_u32 m0, s17, 0xc400
    s_nop 0
    buffer_load_dwordx4 v2, s[4:7], s22 offen lds
    ds_read_b64_tr_b16 v[98:99], v15 offset:17952
    s_waitcnt lgkmcnt(6)
    v_mfma_f32_16x16x32_bf16 v[36:39], v[84:87], v[220:223], v[36:39]
    ds_read_b64_tr_b16 v[100:101], v3 offset:17152
    v_mfma_f32_16x16x32_bf16 v[40:43], v[84:87], v[224:227], v[40:43]
    ds_read_b64_tr_b16 v[102:103], v3 offset:18176
    s_waitcnt lgkmcnt(6)
    v_mfma_f32_16x16x32_bf16 v[44:47], v[88:91], v[220:223], v[44:47]
    ds_read_b64_tr_b16 v[104:105], v15 offset:17184
    v_mfma_f32_16x16x32_bf16 v[48:51], v[88:91], v[224:227], v[48:51]
    ds_read_b64_tr_b16 v[106:107], v15 offset:18208
    s_mov_b32 s23, 0x7800
    buffer_load_dwordx4 v[204:207], v4, s[8:11], s23 offen offset:0 sc1
    s_waitcnt lgkmcnt(6)
    v_mfma_f32_16x16x32_bf16 v[52:55], v[92:95], v[220:223], v[52:55]
    ds_read_b64_tr_b16 v[84:85], v3 offset:24576
    v_mfma_f32_16x16x32_bf16 v[56:59], v[92:95], v[224:227], v[56:59]
    ds_read_b64_tr_b16 v[86:87], v3 offset:25600
    s_waitcnt lgkmcnt(6)
    v_mfma_f32_16x16x32_bf16 v[60:63], v[96:99], v[220:223], v[60:63]
    ds_read_b64_tr_b16 v[88:89], v15 offset:24608
    v_mfma_f32_16x16x32_bf16 v[64:67], v[96:99], v[224:227], v[64:67]
    s_add_u32 s22, s16, 0x790000
    s_add_u32 m0, s17, 0xc800
    s_nop 0
    buffer_load_dwordx4 v16, s[4:7], s22 offen lds
    ds_read_b64_tr_b16 v[90:91], v15 offset:25632
    s_waitcnt lgkmcnt(6)
    v_mfma_f32_16x16x32_bf16 v[68:71], v[100:103], v[220:223], v[68:71]
    ds_read_b64_tr_b16 v[92:93], v3 offset:24832
    v_mfma_f32_16x16x32_bf16 v[72:75], v[100:103], v[224:227], v[72:75]
    ds_read_b64_tr_b16 v[94:95], v3 offset:25856
    s_waitcnt lgkmcnt(6)
    v_mfma_f32_16x16x32_bf16 v[76:79], v[104:107], v[220:223], v[76:79]
    ds_read_b64_tr_b16 v[96:97], v15 offset:24864
    v_mfma_f32_16x16x32_bf16 v[80:83], v[104:107], v[224:227], v[80:83]
    ds_read_b64_tr_b16 v[98:99], v15 offset:25888
    s_mov_b32 s23, 0xf800
    buffer_load_dwordx4 v[208:211], v4, s[8:11], s23 offen offset:0 sc1
    s_waitcnt vmcnt(14) lgkmcnt(6)
    v_mfma_f32_16x16x32_bf16 v[20:23], v[84:87], v[228:231], v[20:23]
    ds_read_b64_tr_b16 v[100:101], v3 offset:25088
    s_waitcnt vmcnt(12)
    v_mfma_f32_16x16x32_bf16 v[24:27], v[84:87], v[232:235], v[24:27]
    ds_read_b64_tr_b16 v[102:103], v3 offset:26112
    s_waitcnt lgkmcnt(6)
    v_mfma_f32_16x16x32_bf16 v[28:31], v[88:91], v[228:231], v[28:31]
    ds_read_b64_tr_b16 v[104:105], v15 offset:25120
    v_mfma_f32_16x16x32_bf16 v[32:35], v[88:91], v[232:235], v[32:35]
    s_add_u32 s22, s16, 0x798000
    s_add_u32 m0, s17, 0xcc00
    s_nop 0
    buffer_load_dwordx4 v16, s[4:7], s22 offen lds
    ds_read_b64_tr_b16 v[106:107], v15 offset:26144
    s_waitcnt lgkmcnt(6)
    v_mfma_f32_16x16x32_bf16 v[36:39], v[92:95], v[228:231], v[36:39]
    ds_read_b64_tr_b16 v[84:85], v3 offset:25344
    v_mfma_f32_16x16x32_bf16 v[40:43], v[92:95], v[232:235], v[40:43]
    ds_read_b64_tr_b16 v[86:87], v3 offset:26368
    s_waitcnt lgkmcnt(6)
    v_mfma_f32_16x16x32_bf16 v[44:47], v[96:99], v[228:231], v[44:47]
    ds_read_b64_tr_b16 v[88:89], v15 offset:25376
    v_mfma_f32_16x16x32_bf16 v[48:51], v[96:99], v[232:235], v[48:51]
    ds_read_b64_tr_b16 v[90:91], v15 offset:26400
    s_mov_b32 s23, 0x7800
    buffer_load_dwordx4 v[212:215], v4, s[8:11], s23 offen offset:1024 sc1
    s_waitcnt lgkmcnt(6)
    v_mfma_f32_16x16x32_bf16 v[52:55], v[100:103], v[228:231], v[52:55]
    v_mfma_f32_16x16x32_bf16 v[56:59], v[100:103], v[232:235], v[56:59]
    s_waitcnt vmcnt(9)
    s_barrier
    v_xor_b32 v17, s14, v17
    v_xor_b32 v18, s14, v18
    v_xor_b32 v19, s14, v19
    v_xor_b32 v6, s14, v6
    v_or3_b32 v17, v17, v18, v19
    v_or_b32 v17, v17, v6
    v_cmp_ne_u32 vcc, 0, v17
    s_cbranch_vccz fz_kvg
    s_mov_b32 s27, 0
fz_kvp:
    buffer_load_dword v17, v1, s[8:11], s62 offen offset:0 sc1
    buffer_load_dword v18, v1, s[8:11], s62 offen offset:4 sc1
    buffer_load_dword v19, v1, s[8:11], s62 offen offset:8 sc1
    buffer_load_dword v6, v1, s[8:11], s62 offen offset:12 sc1
    s_waitcnt vmcnt(0)
    v_xor_b32 v17, s14, v17
    v_xor_b32 v18, s14, v18
    v_xor_b32 v19, s14, v19
    v_xor_b32 v6, s14, v6
    v_or3_b32 v17, v17, v18, v19
    v_or_b32 v17, v17, v6
    v_cmp_ne_u32 vcc, 0, v17
    s_add_u32 s27, s27, 1
    s_cmp_ge_u32 s27, 65536
    s_nop 4
    s_cbranch_scc1 fz_kvg
    s_cbranch_vccnz fz_kvp
fz_kvg:
    ds_read_b64_tr_b16 v[92:93], v3 offset:32768
    ds_read_b64_tr_b16 v[94:95], v3 offset:33792
    s_waitcnt lgkmcnt(6)
    v_mfma_f32_16x16x32_bf16 v[60:63], v[104:107], v[228:231], v[60:63]
    ds_read_b64_tr_b16 v[96:97], v15 offset:32800
    v_mfma_f32_16x16x32_bf16 v[64:67], v[104:107], v[232:235], v[64:67]
    s_add_u32 s22, s17, 0x0
    s_add_u32 m0, s17, 0x10000
    s_nop 0
    buffer_load_dwordx4 v5, s[8:11], s22 offen sc1 lds
    ds_read_b64_tr_b16 v[98:99], v15 offset:33824
    s_waitcnt lgkmcnt(6)
    v_mfma_f32_16x16x32_bf16 v[68:71], v[84:87], v[228:231], v[68:71]
    ds_read_b64_tr_b16 v[100:101], v3 offset:33024
    v_mfma_f32_16x16x32_bf16 v[72:75], v[84:87], v[232:235], v[72:75]
    ds_read_b64_tr_b16 v[102:103], v3 offset:34048
    s_waitcnt lgkmcnt(6)
    v_mfma_f32_16x16x32_bf16 v[76:79], v[88:91], v[228:231], v[76:79]
    ds_read_b64_tr_b16 v[104:105], v15 offset:33056
    v_mfma_f32_16x16x32_bf16 v[80:83], v[88:91], v[232:235], v[80:83]
    ds_read_b64_tr_b16 v[106:107], v15 offset:34080
    s_mov_b32 s23, 0xf800
    buffer_load_dwordx4 v[216:219], v4, s[8:11], s23 offen offset:1024 sc1
    s_waitcnt lgkmcnt(6)
    v_mfma_f32_16x16x32_bf16 v[20:23], v[92:95], v[140:143], v[20:23]
    ds_read_b64_tr_b16 v[84:85], v3 offset:33280
    v_mfma_f32_16x16x32_bf16 v[24:27], v[92:95], v[144:147], v[24:27]
    ds_read_b64_tr_b16 v[86:87], v3 offset:34304
    s_waitcnt lgkmcnt(6)
    v_mfma_f32_16x16x32_bf16 v[28:31], v[96:99], v[140:143], v[28:31]
    ds_read_b64_tr_b16 v[88:89], v15 offset:33312
    v_mfma_f32_16x16x32_bf16 v[32:35], v[96:99], v[144:147], v[32:35]
    s_add_u32 s22, s17, 0x400
    s_add_u32 m0, s17, 0x10400
    s_nop 0
    buffer_load_dwordx4 v5, s[8:11], s22 offen sc1 lds
    ds_read_b64_tr_b16 v[90:91], v15 offset:34336
    s_waitcnt lgkmcnt(6)
    v_mfma_f32_16x16x32_bf16 v[36:39], v[100:103], v[140:143], v[36:39]
    ds_read_b64_tr_b16 v[92:93], v3 offset:33536
    v_mfma_f32_16x16x32_bf16 v[40:43], v[100:103], v[144:147], v[40:43]
    ds_read_b64_tr_b16 v[94:95], v3 offset:34560
    s_waitcnt lgkmcnt(6)
    v_mfma_f32_16x16x32_bf16 v[44:47], v[104:107], v[140:143], v[44:47]
    ds_read_b64_tr_b16 v[96:97], v15 offset:33568
    v_mfma_f32_16x16x32_bf16 v[48:51], v[104:107], v[144:147], v[48:51]
    ds_read_b64_tr_b16 v[98:99], v15 offset:34592
    s_waitcnt lgkmcnt(6)
    v_mfma_f32_16x16x32_bf16 v[52:55], v[84:87], v[140:143], v[52:55]
    ds_read_b64_tr_b16 v[100:101], v3 offset:40960
    v_mfma_f32_16x16x32_bf16 v[56:59], v[84:87], v[144:147], v[56:59]
    ds_read_b64_tr_b16 v[102:103], v3 offset:41984
    s_waitcnt lgkmcnt(6)
    v_mfma_f32_16x16x32_bf16 v[60:63], v[88:91], v[140:143], v[60:63]
    ds_read_b64_tr_b16 v[104:105], v15 offset:40992
    v_mfma_f32_16x16x32_bf16 v[64:67], v[88:91], v[144:147], v[64:67]
    s_add_u32 s22, s17, 0x800
    s_add_u32 m0, s17, 0x10800
    s_nop 0
    buffer_load_dwordx4 v5, s[8:11], s22 offen sc1 lds
    ds_read_b64_tr_b16 v[106:107], v15 offset:42016
    s_waitcnt lgkmcnt(6)
    v_mfma_f32_16x16x32_bf16 v[68:71], v[92:95], v[140:143], v[68:71]
    ds_read_b64_tr_b16 v[84:85], v3 offset:41216
    v_mfma_f32_16x16x32_bf16 v[72:75], v[92:95], v[144:147], v[72:75]
    ds_read_b64_tr_b16 v[86:87], v3 offset:42240
    s_waitcnt lgkmcnt(6)
    v_mfma_f32_16x16x32_bf16 v[76:79], v[96:99], v[140:143], v[76:79]
    ds_read_b64_tr_b16 v[88:89], v15 offset:41248
    v_mfma_f32_16x16x32_bf16 v[80:83], v[96:99], v[144:147], v[80:83]
    ds_read_b64_tr_b16 v[90:91], v15 offset:42272
    s_waitcnt vmcnt(12) lgkmcnt(6)
    v_mfma_f32_16x16x32_bf16 v[20:23], v[100:103], v[148:151], v[20:23]
    ds_read_b64_tr_b16 v[92:93], v3 offset:41472
    s_waitcnt vmcnt(10)
    v_mfma_f32_16x16x32_bf16 v[24:27], v[100:103], v[152:155], v[24:27]
    ds_read_b64_tr_b16 v[94:95], v3 offset:42496
    s_add_u32 s22, s17, 0x8000
    s_add_u32 m0, s17, 0x18000
    s_nop 0
    buffer_load_dwordx4 v5, s[8:11], s22 offen sc1 lds
    s_waitcnt lgkmcnt(6)
    v_mfma_f32_16x16x32_bf16 v[28:31], v[104:107], v[148:151], v[28:31]
    ds_read_b64_tr_b16 v[96:97], v15 offset:41504
    v_mfma_f32_16x16x32_bf16 v[32:35], v[104:107], v[152:155], v[32:35]
    s_add_u32 s22, s17, 0xc00
    s_add_u32 m0, s17, 0x10c00
    s_nop 0
    buffer_load_dwordx4 v5, s[8:11], s22 offen sc1 lds
    ds_read_b64_tr_b16 v[98:99], v15 offset:42528
    s_add_u32 s22, s17, 0x8400
    s_add_u32 m0, s17, 0x18400
    s_nop 0
    buffer_load_dwordx4 v5, s[8:11], s22 offen sc1 lds
    s_waitcnt lgkmcnt(6)
    v_mfma_f32_16x16x32_bf16 v[36:39], v[84:87], v[148:151], v[36:39]
    ds_read_b64_tr_b16 v[100:101], v3 offset:41728
    v_mfma_f32_16x16x32_bf16 v[40:43], v[84:87], v[152:155], v[40:43]
    ds_read_b64_tr_b16 v[102:103], v3 offset:42752
    s_add_u32 s22, s17, 0x8800
    s_add_u32 m0, s17, 0x18800
    s_nop 0
    buffer_load_dwordx4 v5, s[8:11], s22 offen sc1 lds
    s_waitcnt lgkmcnt(6)
    v_mfma_f32_16x16x32_bf16 v[44:47], v[88:91], v[148:151], v[44:47]
    ds_read_b64_tr_b16 v[104:105], v15 offset:41760
    v_mfma_f32_16x16x32_bf16 v[48:51], v[88:91], v[152:155], v[48:51]
    ds_read_b64_tr_b16 v[106:107], v15 offset:42784
    s_add_u32 s22, s17, 0x8c00
    s_add_u32 m0, s17, 0x18c00
    s_nop 0
    buffer_load_dwordx4 v5, s[8:11], s22 offen sc1 lds
    s_waitcnt lgkmcnt(6)
    v_mfma_f32_16x16x32_bf16 v[52:55], v[92:95], v[148:151], v[52:55]
    v_mfma_f32_16x16x32_bf16 v[56:59], v[92:95], v[152:155], v[56:59]
    s_waitcnt vmcnt(10)
    s_barrier
    ds_read_b64_tr_b16 v[84:85], v3 offset:49152
    ds_read_b64_tr_b16 v[86:87], v3 offset:50176
    s_add_u32 s22, s17, 0xc000
    s_add_u32 m0, s17, 0x1c000
    s_nop 0
    buffer_load_dwordx4 v5, s[8:11], s22 offen sc1 lds
    s_waitcnt lgkmcnt(6)
    v_mfma_f32_16x16x32_bf16 v[60:63], v[96:99], v[148:151], v[60:63]
    ds_read_b64_tr_b16 v[88:89], v15 offset:49184
    v_mfma_f32_16x16x32_bf16 v[64:67], v[96:99], v[152:155], v[64:67]
    s_add_u32 s22, s17, 0x4000
    s_add_u32 m0, s17, 0x14000
    s_nop 0
    buffer_load_dwordx4 v5, s[8:11], s22 offen sc1 lds
    ds_read_b64_tr_b16 v[90:91], v15 offset:50208
    s_add_u32 s22, s17, 0xc400
    s_add_u32 m0, s17, 0x1c400
    s_nop 0
    buffer_load_dwordx4 v5, s[8:11], s22 offen sc1 lds
    s_waitcnt lgkmcnt(6)
    v_mfma_f32_16x16x32_bf16 v[68:71], v[100:103], v[148:151], v[68:71]
    ds_read_b64_tr_b16 v[92:93], v3 offset:49408
    v_mfma_f32_16x16x32_bf16 v[72:75], v[100:103], v[152:155], v[72:75]
    ds_read_b64_tr_b16 v[94:95], v3 offset:50432
    s_add_u32 s22, s17, 0xc800
    s_add_u32 m0, s17, 0x1c800
    s_nop 0
    buffer_load_dwordx4 v5, s[8:11], s22 offen sc1 lds
    s_waitcnt lgkmcnt(6)
    v_mfma_f32_16x16x32_bf16 v[76:79], v[104:107], v[148:151], v[76:79]
    ds_read_b64_tr_b16 v[96:97], v15 offset:49440
    v_mfma_f32_16x16x32_bf16 v[80:83], v[104:107], v[152:155], v[80:83]
    ds_read_b64_tr_b16 v[98:99], v15 offset:50464
    s_add_u32 s22, s17, 0xcc00
    s_add_u32 m0, s17, 0x1cc00
    s_nop 0
    buffer_load_dwordx4 v5, s[8:11], s22 offen sc1 lds
    s_waitcnt lgkmcnt(6)
    v_mfma_f32_16x16x32_bf16 v[20:23], v[84:87], v[204:207], v[20:23]
    ds_read_b64_tr_b16 v[100:101], v3 offset:49664
    v_mfma_f32_16x16x32_bf16 v[24:27], v[84:87], v[208:211], v[24:27]
    ds_read_b64_tr_b16 v[102:103], v3 offset:50688
    s_waitcnt lgkmcnt(6)
    v_mfma_f32_16x16x32_bf16 v[28:31], v[88:91], v[204:207], v[28:31]
    ds_read_b64_tr_b16 v[104:105], v15 offset:49696
    v_mfma_f32_16x16x32_bf16 v[32:35], v[88:91], v[208:211], v[32:35]
    s_add_u32 s22, s17, 0x4400
    s_add_u32 m0, s17, 0x14400
    s_nop 0
    buffer_load_dwordx4 v5, s[8:11], s22 offen sc1 lds
    ds_read_b64_tr_b16 v[106:107], v15 offset:50720
    s_waitcnt lgkmcnt(6)
    v_mfma_f32_16x16x32_bf16 v[36:39], v[92:95], v[204:207], v[36:39]
    ds_read_b64_tr_b16 v[84:85], v3 offset:49920
    v_mfma_f32_16x16x32_bf16 v[40:43], v[92:95], v[208:211], v[40:43]
    ds_read_b64_tr_b16 v[86:87], v3 offset:50944
    s_waitcnt lgkmcnt(6)
    v_mfma_f32_16x16x32_bf16 v[44:47], v[96:99], v[204:207], v[44:47]
    ds_read_b64_tr_b16 v[88:89], v15 offset:49952
    v_mfma_f32_16x16x32_bf16 v[48:51], v[96:99], v[208:211], v[48:51]
    ds_read_b64_tr_b16 v[90:91], v15 offset:50976
    s_waitcnt lgkmcnt(6)
    v_mfma_f32_16x16x32_bf16 v[52:55], v[100:103], v[204:207], v[52:55]
    ds_read_b64_tr_b16 v[92:93], v3 offset:57344
    v_mfma_f32_16x16x32_bf16 v[56:59], v[100:103], v[208:211], v[56:59]
    ds_read_b64_tr_b16 v[94:95], v3 offset:58368
    s_waitcnt lgkmcnt(6)
    v_mfma_f32_16x16x32_bf16 v[60:63], v[104:107], v[204:207], v[60:63]
    ds_read_b64_tr_b16 v[96:97], v15 offset:57376
    v_mfma_f32_16x16x32_bf16 v[64:67], v[104:107], v[208:211], v[64:67]
    s_add_u32 s22, s17, 0x4800
    s_add_u32 m0, s17, 0x14800
    s_nop 0
    buffer_load_dwordx4 v5, s[8:11], s22 offen sc1 lds
    ds_read_b64_tr_b16 v[98:99], v15 offset:58400
    s_waitcnt lgkmcnt(6)
    v_mfma_f32_16x16x32_bf16 v[68:71], v[84:87], v[204:207], v[68:71]
    ds_read_b64_tr_b16 v[100:101], v3 offset:57600
    v_mfma_f32_16x16x32_bf16 v[72:75], v[84:87], v[208:211], v[72:75]
    ds_read_b64_tr_b16 v[102:103], v3 offset:58624
    s_waitcnt lgkmcnt(6)
    v_mfma_f32_16x16x32_bf16 v[76:79], v[88:91], v[204:207], v[76:79]
    ds_read_b64_tr_b16 v[104:105], v15 offset:57632
    v_mfma_f32_16x16x32_bf16 v[80:83], v[88:91], v[208:211], v[80:83]
    ds_read_b64_tr_b16 v[106:107], v15 offset:58656
    s_waitcnt vmcnt(16) lgkmcnt(6)
    v_mfma_f32_16x16x32_bf16 v[20:23], v[92:95], v[212:215], v[20:23]
    ds_read_b64_tr_b16 v[84:85], v3 offset:57856
    s_waitcnt vmcnt(14)
    v_mfma_f32_16x16x32_bf16 v[24:27], v[92:95], v[216:219], v[24:27]
    ds_read_b64_tr_b16 v[86:87], v3 offset:58880
    s_add_u32 s22, s17, 0x10000
    s_add_u32 m0, s17, 0x20000
    s_nop 0
    buffer_load_dwordx4 v5, s[8:11], s22 offen sc1 lds
    s_waitcnt lgkmcnt(6)
    v_mfma_f32_16x16x32_bf16 v[28:31], v[96:99], v[212:215], v[28:31]
    ds_read_b64_tr_b16 v[88:89], v15 offset:57888
    v_mfma_f32_16x16x32_bf16 v[32:35], v[96:99], v[216:219], v[32:35]
    s_add_u32 s22, s17, 0x4c00
    s_add_u32 m0, s17, 0x14c00
    s_nop 0
    buffer_load_dwordx4 v5, s[8:11], s22 offen sc1 lds
    ds_read_b64_tr_b16 v[90:91], v15 offset:58912
    s_add_u32 s22, s17, 0x10400
    s_add_u32 m0, s17, 0x20400
    s_nop 0
    buffer_load_dwordx4 v5, s[8:11], s22 offen sc1 lds
    s_waitcnt lgkmcnt(6)
    v_mfma_f32_16x16x32_bf16 v[36:39], v[100:103], v[212:215], v[36:39]
    ds_read_b64_tr_b16 v[92:93], v3 offset:58112
    v_mfma_f32_16x16x32_bf16 v[40:43], v[100:103], v[216:219], v[40:43]
    ds_read_b64_tr_b16 v[94:95], v3 offset:59136
    s_add_u32 s22, s17, 0x10800
    s_add_u32 m0, s17, 0x20800
    s_nop 0
    buffer_load_dwordx4 v5, s[8:11], s22 offen sc1 lds
    s_waitcnt lgkmcnt(6)
    v_mfma_f32_16x16x32_bf16 v[44:47], v[104:107], v[212:215], v[44:47]
    ds_read_b64_tr_b16 v[96:97], v15 offset:58144
    v_mfma_f32_16x16x32_bf16 v[48:51], v[104:107], v[216:219], v[48:51]
    ds_read_b64_tr_b16 v[98:99], v15 offset:59168
    s_add_u32 s22, s17, 0x10c00
    s_add_u32 m0, s17, 0x20c00
    s_nop 0
    buffer_load_dwordx4 v5, s[8:11], s22 offen sc1 lds
    s_waitcnt lgkmcnt(6)
    v_mfma_f32_16x16x32_bf16 v[52:55], v[84:87], v[212:215], v[52:55]
    v_mfma_f32_16x16x32_bf16 v[56:59], v[84:87], v[216:219], v[56:59]
    s_add_u32 s22, s17, 0x14000
    s_add_u32 m0, s17, 0x24000
    s_nop 0
    buffer_load_dwordx4 v5, s[8:11], s22 offen sc1 lds
    s_waitcnt lgkmcnt(4)
    v_mfma_f32_16x16x32_bf16 v[60:63], v[88:91], v[212:215], v[60:63]
    v_mfma_f32_16x16x32_bf16 v[64:67], v[88:91], v[216:219], v[64:67]
    s_add_u32 s22, s17, 0x14400
    s_add_u32 m0, s17, 0x24400
    s_nop 0
    buffer_load_dwordx4 v5, s[8:11], s22 offen sc1 lds
    s_waitcnt lgkmcnt(2)
    v_mfma_f32_16x16x32_bf16 v[68:71], v[92:95], v[212:215], v[68:71]
    v_mfma_f32_16x16x32_bf16 v[72:75], v[92:95], v[216:219], v[72:75]
    s_add_u32 s22, s17, 0x14800
    s_add_u32 m0, s17, 0x24800
    s_nop 0
    buffer_load_dwordx4 v5, s[8:11], s22 offen sc1 lds
    s_waitcnt lgkmcnt(0)
    v_mfma_f32_16x16x32_bf16 v[76:79], v[96:99], v[212:215], v[76:79]
    v_mfma_f32_16x16x32_bf16 v[80:83], v[96:99], v[216:219], v[80:83]
    s_add_u32 s22, s17, 0x14c00
    s_add_u32 m0, s17, 0x24c00
    s_nop 0
    buffer_load_dwordx4 v5, s[8:11], s22 offen sc1 lds
    s_mov_b32 s24, 0x3e0293ee
    v_cvt_pk_bf16_f32 v108, v20, v21
    v_cvt_pk_bf16_f32 v109, v22, v23
    v_cvt_pk_bf16_f32 v124, v24, v25
    v_cvt_pk_bf16_f32 v125, v26, v27
    v_cvt_pk_bf16_f32 v110, v28, v29
    v_cvt_pk_bf16_f32 v111, v30, v31
    v_cvt_pk_bf16_f32 v126, v32, v33
    v_cvt_pk_bf16_f32 v127, v34, v35
    v_cvt_pk_bf16_f32 v112, v36, v37
    v_cvt_pk_bf16_f32 v113, v38, v39
    v_cvt_pk_bf16_f32 v128, v40, v41
    v_cvt_pk_bf16_f32 v129, v42, v43
    v_cvt_pk_bf16_f32 v114, v44, v45
    v_cvt_pk_bf16_f32 v115, v46, v47
    v_cvt_pk_bf16_f32 v130, v48, v49
    v_cvt_pk_bf16_f32 v131, v50, v51
    v_cvt_pk_bf16_f32 v116, v52, v53
    v_cvt_pk_bf16_f32 v117, v54, v55
    v_cvt_pk_bf16_f32 v132, v56, v57
    v_cvt_pk_bf16_f32 v133, v58, v59
    v_cvt_pk_bf16_f32 v118, v60, v61
    v_cvt_pk_bf16_f32 v119, v62, v63
    v_cvt_pk_bf16_f32 v134, v64, v65
    v_cvt_pk_bf16_f32 v135, v66, v67
    v_cvt_pk_bf16_f32 v120, v68, v69
    v_cvt_pk_bf16_f32 v121, v70, v71
    v_cvt_pk_bf16_f32 v136, v72, v73
    v_cvt_pk_bf16_f32 v137, v74, v75
    v_cvt_pk_bf16_f32 v122, v76, v77
    v_cvt_pk_bf16_f32 v123, v78, v79
    v_cvt_pk_bf16_f32 v138, v80, v81
    v_cvt_pk_bf16_f32 v139, v82, v83
    v_add_u32 v2, 0x10000, v1
    v_add_u32 v3, 0x20000, v1
    s_and_b32 s62, s12, 24
    s_and_b32 s19, s12, 7
    s_lshl_b32 s20, s19, 2
    s_lshr_b32 s20, 0x54732160, s20
    s_and_b32 s20, s20, 7
    s_lshl_b32 s20, s20, 2
    s_bfm_b32 s21, s20, 0
    s_and_b32 s22, s21, 0x51764320
    s_lshl_b32 s22, s22, 4
    s_lshl_b32 s21, s21, 4
    s_or_b32 s21, s21, 15
    s_andn2_b32 s21, 0x51764320, s21
    s_or_b32 s42, s21, s22
    s_or_b32 s42, s42, s19
    s_add_u32 s19, s12, 1
    s_and_b32 s19, s19, 7
    s_lshl_b32 s19, s19, 8
    s_add_u32 s4, s40, s19
    s_addc_u32 s5, s41, 0
    s_sub_u32 s6, 0x800000, s19
    s_mov_b32 s7, 0x20000
    s_lshl_b32 s16, s3, 15
    v_bfe_u32 v9, v0, 2, 2
    v_lshrrev_b32 v10, 4, v0
    v_and_b32 v11, 3, v0
    v_lshlrev_b32 v17, 6, v10
    v_lshl_add_u32 v17, v11, 4, v17
    v_lshl_add_u32 v17, v9, 11, v17
    v_xor_b32 v18, 32, v17
    s_waitcnt vmcnt(19)
    s_barrier
    ds_read_b128 v[84:87], v2 offset:0
    ds_read_b128 v[88:91], v2 offset:1024
    ds_read_b128 v[92:95], v2 offset:2048
    ds_read_b128 v[96:99], v2 offset:3072
    s_waitcnt lgkmcnt(3)
    v_mfma_f32_16x16x32_bf16 v[140:143], v[84:87], v[108:111], 0
    v_mfma_f32_16x16x32_bf16 v[144:147], v[84:87], v[124:127], 0
    ds_read_b128 v[100:103], v2 offset:4096
    s_waitcnt lgkmcnt(3)
    v_mfma_f32_16x16x32_bf16 v[148:151], v[88:91], v[108:111], 0
    v_mfma_f32_16x16x32_bf16 v[152:155], v[88:91], v[124:127], 0
    ds_read_b128 v[104:107], v2 offset:5120
    s_waitcnt lgkmcnt(3)
    v_mfma_f32_16x16x32_bf16 v[140:143], v[92:95], v[112:115], v[140:143]
    v_mfma_f32_16x16x32_bf16 v[144:147], v[92:95], v[128:131], v[144:147]
    ds_read_b128 v[84:87], v2 offset:6144
    s_waitcnt lgkmcnt(3)
    v_mfma_f32_16x16x32_bf16 v[148:151], v[96:99], v[112:115], v[148:151]
    v_mfma_f32_16x16x32_bf16 v[152:155], v[96:99], v[128:131], v[152:155]
    ds_read_b128 v[88:91], v2 offset:7168
    s_waitcnt lgkmcnt(3)
    v_mfma_f32_16x16x32_bf16 v[140:143], v[100:103], v[116:119], v[140:143]
    v_mfma_f32_16x16x32_bf16 v[144:147], v[100:103], v[132:135], v[144:147]
    s_waitcnt vmcnt(7)
    s_barrier
    ds_read_b128 v[92:95], v2 offset:16384
    s_waitcnt lgkmcnt(3)
    v_mfma_f32_16x16x32_bf16 v[148:151], v[104:107], v[116:119], v[148:151]
    v_mfma_f32_16x16x32_bf16 v[152:155], v[104:107], v[132:135], v[152:155]
    ds_read_b128 v[96:99], v2 offset:17408
    s_waitcnt lgkmcnt(3)
    v_mfma_f32_16x16x32_bf16 v[140:143], v[84:87], v[120:123], v[140:143]
    v_mfma_f32_16x16x32_bf16 v[144:147], v[84:87], v[136:139], v[144:147]
    ds_read_b128 v[100:103], v2 offset:18432
    s_waitcnt lgkmcnt(3)
    v_mfma_f32_16x16x32_bf16 v[148:151], v[88:91], v[120:123], v[148:151]
    v_mfma_f32_16x16x32_bf16 v[152:155], v[88:91], v[136:139], v[152:155]
    ds_read_b128 v[104:107], v2 offset:19456
    s_waitcnt lgkmcnt(3)
    v_mfma_f32_16x16x32_bf16 v[156:159], v[92:95], v[108:111], 0
    v_mfma_f32_16x16x32_bf16 v[160:163], v[92:95], v[124:127], 0
    ds_read_b128 v[84:87], v2 offset:20480
    s_waitcnt lgkmcnt(3)
    v_mfma_f32_16x16x32_bf16 v[164:167], v[96:99], v[108:111], 0
    v_mfma_f32_16x16x32_bf16 v[168:171], v[96:99], v[124:127], 0
    ds_read_b128 v[88:91], v2 offset:21504
    s_waitcnt lgkmcnt(3)
    v_mfma_f32_16x16x32_bf16 v[156:159], v[100:103], v[112:115], v[156:159]
    v_mfma_f32_16x16x32_bf16 v[160:163], v[100:103], v[128:131], v[160:163]
    ds_read_b128 v[92:95], v2 offset:22528
    s_waitcnt lgkmcnt(3)
    v_mfma_f32_16x16x32_bf16 v[164:167], v[104:107], v[112:115], v[164:167]
    v_max3_f32 v9, v140, v141, v142
    v_mfma_f32_16x16x32_bf16 v[168:171], v[104:107], v[128:131], v[168:171]
    ds_read_b128 v[96:99], v2 offset:23552
    v_max3_f32 v9, v9, v143, v148
    s_waitcnt lgkmcnt(3)
    v_mfma_f32_16x16x32_bf16 v[156:159], v[84:87], v[116:119], v[156:159]
    v_max3_f32 v9, v9, v149, v150
    v_mfma_f32_16x16x32_bf16 v[160:163], v[84:87], v[132:135], v[160:163]
    s_barrier
    s_setprio 3
    ds_read_b128 v[100:103], v2 offset:32768
    v_max_f32 v9, v9, v151
    s_waitcnt lgkmcnt(3)
    v_mfma_f32_16x16x32_bf16 v[164:167], v[88:91], v[116:119], v[164:167]
    v_max3_f32 v10, v144, v145, v146
    v_mfma_f32_16x16x32_bf16 v[168:171], v[88:91], v[132:135], v[168:171]
    ds_read_b128 v[104:107], v2 offset:33792
    v_max3_f32 v10, v10, v147, v152
    s_waitcnt lgkmcnt(3)
    v_mfma_f32_16x16x32_bf16 v[156:159], v[92:95], v[120:123], v[156:159]
    v_max3_f32 v10, v10, v153, v154
    v_mfma_f32_16x16x32_bf16 v[160:163], v[92:95], v[136:139], v[160:163]
    ds_read_b128 v[84:87], v2 offset:34816
    v_max_f32 v10, v10, v155
    s_waitcnt lgkmcnt(3)
    v_mfma_f32_16x16x32_bf16 v[164:167], v[96:99], v[120:123], v[164:167]
    v_mfma_f32_16x16x32_bf16 v[168:171], v[96:99], v[136:139], v[168:171]
    ds_read_b128 v[88:91], v2 offset:35840
    v_max3_f32 v9, v9, v156, v157
    v_max3_f32 v9, v9, v158, v159
    s_nop 3
    v_max3_f32 v9, v9, v164, v165
    v_max3_f32 v9, v9, v166, v167
    v_max3_f32 v10, v10, v160, v161
    v_max3_f32 v10, v10, v162, v163
    v_max3_f32 v10, v10, v168, v169
    v_max3_f32 v10, v10, v170, v171
    v_mov_b32 v11, v9
    v_mov_b32 v12, v10
    s_nop 0
    v_permlane16_swap_b32 v9, v11
    v_permlane16_swap_b32 v10, v12
    v_max_f32 v9, v9, v11
    v_max_f32 v10, v10, v12
    v_mov_b32 v11, v9
    v_mov_b32 v12, v10
    s_nop 0
    v_permlane32_swap_b32 v9, v11
    v_permlane32_swap_b32 v10, v12
    v_max_f32 v9, v9, v11
    v_max_f32 v10, v10, v12
    v_sub_f32 v172, 0, v9
    v_sub_f32 v173, 0, v9
    v_sub_f32 v174, 0, v9
    v_sub_f32 v175, 0, v9
    v_sub_f32 v176, 0, v10
    v_sub_f32 v177, 0, v10
    v_sub_f32 v178, 0, v10
    v_sub_f32 v179, 0, v10
    v_add_f32 v140, v140, v172
    v_add_f32 v141, v141, v172
    v_exp_f32 v140, v140
    v_exp_f32 v141, v141
    s_nop 0
    v_add_f32 v15, v140, v141
    v_cvt_pk_bf16_f32 v188, v140, v141
    v_add_f32 v142, v142, v172
    v_add_f32 v143, v143, v172
    v_exp_f32 v142, v142
    v_exp_f32 v143, v143
    v_add_f32 v15, v15, v142
    v_add_f32 v15, v15, v143
    v_cvt_pk_bf16_f32 v189, v142, v143
    v_add_f32 v144, v144, v176
    v_add_f32 v145, v145, v176
    v_exp_f32 v144, v144
    v_exp_f32 v145, v145
    s_nop 0
    v_add_f32 v16, v144, v145
    v_cvt_pk_bf16_f32 v192, v144, v145
    v_add_f32 v146, v146, v176
    v_add_f32 v147, v147, v176
    v_exp_f32 v146, v146
    v_exp_f32 v147, v147
    v_add_f32 v16, v16, v146
    v_add_f32 v16, v16, v147
    v_cvt_pk_bf16_f32 v193, v146, v147
    v_add_f32 v148, v148, v172
    v_add_f32 v149, v149, v172
    v_exp_f32 v148, v148
    v_exp_f32 v149, v149
    v_add_f32 v15, v15, v148
    v_add_f32 v15, v15, v149
    v_cvt_pk_bf16_f32 v190, v148, v149
    v_add_f32 v150, v150, v172
    v_add_f32 v151, v151, v172
    v_exp_f32 v150, v150
    v_exp_f32 v151, v151
    v_add_f32 v15, v15, v150
    v_add_f32 v15, v15, v151
    v_cvt_pk_bf16_f32 v191, v150, v151
    v_add_f32 v152, v152, v176
    v_add_f32 v153, v153, v176
    v_exp_f32 v152, v152
    v_exp_f32 v153, v153
    v_add_f32 v16, v16, v152
    v_add_f32 v16, v16, v153
    v_cvt_pk_bf16_f32 v194, v152, v153
    v_add_f32 v154, v154, v176
    v_add_f32 v155, v155, v176
    v_exp_f32 v154, v154
    v_exp_f32 v155, v155
    v_add_f32 v16, v16, v154
    v_add_f32 v16, v16, v155
    v_cvt_pk_bf16_f32 v195, v154, v155
    s_waitcnt lgkmcnt(3)
    v_mfma_f32_16x16x32_bf16 v[140:143], v[100:103], v[108:111], v[172:175]
    v_add_f32 v156, v156, v172
    v_add_f32 v157, v157, v172
    v_mfma_f32_16x16x32_bf16 v[144:147], v[100:103], v[124:127], v[176:179]
    ds_read_b128 v[92:95], v2 offset:36864
    v_exp_f32 v156, v156
    v_exp_f32 v157, v157
    s_waitcnt lgkmcnt(3)
    v_mfma_f32_16x16x32_bf16 v[148:151], v[104:107], v[108:111], v[172:175]
    v_add_f32 v15, v15, v156
    v_add_f32 v15, v15, v157
    v_mfma_f32_16x16x32_bf16 v[152:155], v[104:107], v[124:127], v[176:179]
    ds_read_b128 v[96:99], v2 offset:37888
    v_cvt_pk_bf16_f32 v196, v156, v157
    s_waitcnt lgkmcnt(3)
    v_mfma_f32_16x16x32_bf16 v[140:143], v[84:87], v[112:115], v[140:143]
    v_add_f32 v158, v158, v172
    v_add_f32 v159, v159, v172
    v_mfma_f32_16x16x32_bf16 v[144:147], v[84:87], v[128:131], v[144:147]
    ds_read_b128 v[100:103], v2 offset:38912
    v_exp_f32 v158, v158
    v_exp_f32 v159, v159
    s_waitcnt lgkmcnt(3)
    v_mfma_f32_16x16x32_bf16 v[148:151], v[88:91], v[112:115], v[148:151]
    v_add_f32 v15, v15, v158
    v_add_f32 v15, v15, v159
    v_mfma_f32_16x16x32_bf16 v[152:155], v[88:91], v[128:131], v[152:155]
    ds_read_b128 v[104:107], v2 offset:39936
    v_cvt_pk_bf16_f32 v197, v158, v159
    s_waitcnt lgkmcnt(3)
    v_mfma_f32_16x16x32_bf16 v[140:143], v[92:95], v[116:119], v[140:143]
    v_add_f32 v160, v160, v176
    v_add_f32 v161, v161, v176
    v_mfma_f32_16x16x32_bf16 v[144:147], v[92:95], v[132:135], v[144:147]
    ds_read_b128 v[84:87], v2 offset:8192
    v_exp_f32 v160, v160
    v_exp_f32 v161, v161
    s_waitcnt lgkmcnt(3)
    v_mfma_f32_16x16x32_bf16 v[148:151], v[96:99], v[116:119], v[148:151]
    v_add_f32 v16, v16, v160
    v_add_f32 v16, v16, v161
    v_mfma_f32_16x16x32_bf16 v[152:155], v[96:99], v[132:135], v[152:155]
    ds_read_b128 v[88:91], v2 offset:9216
    v_cvt_pk_bf16_f32 v200, v160, v161
    s_waitcnt lgkmcnt(3)
    v_mfma_f32_16x16x32_bf16 v[140:143], v[100:103], v[120:123], v[140:143]
    v_add_f32 v162, v162, v176
    v_add_f32 v163, v163, v176
    v_mfma_f32_16x16x32_bf16 v[144:147], v[100:103], v[136:139], v[144:147]
    ds_read_b128 v[92:95], v2 offset:10240
    v_exp_f32 v162, v162
    v_exp_f32 v163, v163
    s_waitcnt lgkmcnt(3)
    v_mfma_f32_16x16x32_bf16 v[148:151], v[104:107], v[120:123], v[148:151]
    v_add_f32 v16, v16, v162
    v_add_f32 v16, v16, v163
    v_mfma_f32_16x16x32_bf16 v[152:155], v[104:107], v[136:139], v[152:155]
    ds_read_b128 v[96:99], v2 offset:11264
    v_cvt_pk_bf16_f32 v201, v162, v163
    s_waitcnt lgkmcnt(3)
    v_mfma_f32_16x16x32_bf16 v[20:23], v[84:87], v[188:191], 0
    v_add_f32 v164, v164, v172
    v_add_f32 v165, v165, v172
    v_mfma_f32_16x16x32_bf16 v[24:27], v[84:87], v[192:195], 0
    ds_read_b128 v[100:103], v2 offset:12288
    v_exp_f32 v164, v164
    v_exp_f32 v165, v165
    s_waitcnt lgkmcnt(3)
    v_mfma_f32_16x16x32_bf16 v[28:31], v[88:91], v[188:191], 0
    v_add_f32 v15, v15, v164
    v_add_f32 v15, v15, v165
    v_mfma_f32_16x16x32_bf16 v[32:35], v[88:91], v[192:195], 0
    ds_read_b128 v[104:107], v2 offset:13312
    v_cvt_pk_bf16_f32 v198, v164, v165
    s_waitcnt lgkmcnt(3)
    v_mfma_f32_16x16x32_bf16 v[36:39], v[92:95], v[188:191], 0
    v_add_f32 v166, v166, v172
    v_add_f32 v167, v167, v172
    v_mfma_f32_16x16x32_bf16 v[40:43], v[92:95], v[192:195], 0
    ds_read_b128 v[84:87], v2 offset:14336
    v_exp_f32 v166, v166
    v_exp_f32 v167, v167
    s_waitcnt lgkmcnt(3)
    v_mfma_f32_16x16x32_bf16 v[44:47], v[96:99], v[188:191], 0
    v_add_f32 v15, v15, v166
    v_add_f32 v15, v15, v167
    v_mfma_f32_16x16x32_bf16 v[48:51], v[96:99], v[192:195], 0
    ds_read_b128 v[88:91], v2 offset:15360
    v_cvt_pk_bf16_f32 v199, v166, v167
    s_waitcnt lgkmcnt(3)
    v_mfma_f32_16x16x32_bf16 v[52:55], v[100:103], v[188:191], 0
    v_add_f32 v168, v168, v176
    v_add_f32 v169, v169, v176
    v_mfma_f32_16x16x32_bf16 v[56:59], v[100:103], v[192:195], 0
    s_barrier
    ds_read_b128 v[92:95], v2 offset:49152
    v_exp_f32 v168, v168
    v_exp_f32 v169, v169
    s_waitcnt lgkmcnt(3)
    v_mfma_f32_16x16x32_bf16 v[60:63], v[104:107], v[188:191], 0
    v_add_f32 v16, v16, v168
    v_add_f32 v16, v16, v169
    v_mfma_f32_16x16x32_bf16 v[64:67], v[104:107], v[192:195], 0
    ds_read_b128 v[96:99], v2 offset:50176
    v_cvt_pk_bf16_f32 v202, v168, v169
    s_waitcnt lgkmcnt(3)
    v_mfma_f32_16x16x32_bf16 v[68:71], v[84:87], v[188:191], 0
    v_add_f32 v170, v170, v176
    v_add_f32 v171, v171, v176
    v_mfma_f32_16x16x32_bf16 v[72:75], v[84:87], v[192:195], 0
    ds_read_b128 v[100:103], v2 offset:51200
    v_exp_f32 v170, v170
    v_exp_f32 v171, v171
    s_waitcnt lgkmcnt(3)
    v_mfma_f32_16x16x32_bf16 v[76:79], v[88:91], v[188:191], 0
    v_add_f32 v16, v16, v170
    v_add_f32 v16, v16, v171
    v_mfma_f32_16x16x32_bf16 v[80:83], v[88:91], v[192:195], 0
    ds_read_b128 v[104:107], v2 offset:52224
    v_cvt_pk_bf16_f32 v203, v170, v171
    s_waitcnt lgkmcnt(3)
    v_mfma_f32_16x16x32_bf16 v[156:159], v[92:95], v[108:111], v[172:175]
    v_exp_f32 v140, v140
    v_exp_f32 v141, v141
    v_mfma_f32_16x16x32_bf16 v[160:163], v[92:95], v[124:127], v[176:179]
    ds_read_b128 v[84:87], v2 offset:53248
    v_add_f32 v15, v15, v140
    s_waitcnt lgkmcnt(3)
    v_mfma_f32_16x16x32_bf16 v[164:167], v[96:99], v[108:111], v[172:175]
    v_add_f32 v15, v15, v141
    v_mfma_f32_16x16x32_bf16 v[168:171], v[96:99], v[124:127], v[176:179]
    ds_read_b128 v[88:91], v2 offset:54272
    v_cvt_pk_bf16_f32 v188, v140, v141
    s_waitcnt lgkmcnt(3)
    v_mfma_f32_16x16x32_bf16 v[156:159], v[100:103], v[112:115], v[156:159]
    v_exp_f32 v142, v142
    v_exp_f32 v143, v143
    v_mfma_f32_16x16x32_bf16 v[160:163], v[100:103], v[128:131], v[160:163]
    ds_read_b128 v[92:95], v2 offset:55296
    v_add_f32 v15, v15, v142
    s_waitcnt lgkmcnt(3)
    v_mfma_f32_16x16x32_bf16 v[164:167], v[104:107], v[112:115], v[164:167]
    v_add_f32 v15, v15, v143
    v_mfma_f32_16x16x32_bf16 v[168:171], v[104:107], v[128:131], v[168:171]
    ds_read_b128 v[96:99], v2 offset:56320
    v_cvt_pk_bf16_f32 v189, v142, v143
    s_waitcnt lgkmcnt(3)
    v_mfma_f32_16x16x32_bf16 v[156:159], v[84:87], v[116:119], v[156:159]
    v_exp_f32 v144, v144
    v_exp_f32 v145, v145
    v_mfma_f32_16x16x32_bf16 v[160:163], v[84:87], v[132:135], v[160:163]
    ds_read_b128 v[100:103], v2 offset:24576
    v_add_f32 v16, v16, v144
    s_waitcnt lgkmcnt(3)
    v_mfma_f32_16x16x32_bf16 v[164:167], v[88:91], v[116:119], v[164:167]
    v_add_f32 v16, v16, v145
    v_mfma_f32_16x16x32_bf16 v[168:171], v[88:91], v[132:135], v[168:171]
    ds_read_b128 v[104:107], v2 offset:25600
    v_cvt_pk_bf16_f32 v192, v144, v145
    s_waitcnt lgkmcnt(3)
    v_mfma_f32_16x16x32_bf16 v[156:159], v[92:95], v[120:123], v[156:159]
    v_exp_f32 v146, v146
    v_exp_f32 v147, v147
    v_mfma_f32_16x16x32_bf16 v[160:163], v[92:95], v[136:139], v[160:163]
    ds_read_b128 v[84:87], v2 offset:26624
    v_add_f32 v16, v16, v146
    s_waitcnt lgkmcnt(3)
    v_mfma_f32_16x16x32_bf16 v[164:167], v[96:99], v[120:123], v[164:167]
    v_add_f32 v16, v16, v147
    v_mfma_f32_16x16x32_bf16 v[168:171], v[96:99], v[136:139], v[168:171]
    ds_read_b128 v[88:91], v2 offset:27648
    v_cvt_pk_bf16_f32 v193, v146, v147
    s_waitcnt lgkmcnt(3)
    v_mfma_f32_16x16x32_bf16 v[20:23], v[100:103], v[196:199], v[20:23]
    v_exp_f32 v148, v148
    v_exp_f32 v149, v149
    v_mfma_f32_16x16x32_bf16 v[24:27], v[100:103], v[200:203], v[24:27]
    ds_read_b128 v[92:95], v2 offset:28672
    v_add_f32 v15, v15, v148
    s_waitcnt lgkmcnt(3)
    v_mfma_f32_16x16x32_bf16 v[28:31], v[104:107], v[196:199], v[28:31]
    v_add_f32 v15, v15, v149
    v_mfma_f32_16x16x32_bf16 v[32:35], v[104:107], v[200:203], v[32:35]
    ds_read_b128 v[96:99], v2 offset:29696
    v_cvt_pk_bf16_f32 v190, v148, v149
    s_waitcnt lgkmcnt(3)
    v_mfma_f32_16x16x32_bf16 v[36:39], v[84:87], v[196:199], v[36:39]
    v_exp_f32 v150, v150
    v_exp_f32 v151, v151
    v_mfma_f32_16x16x32_bf16 v[40:43], v[84:87], v[200:203], v[40:43]
    ds_read_b128 v[100:103], v2 offset:30720
    v_add_f32 v15, v15, v150
    s_waitcnt lgkmcnt(3)
    v_mfma_f32_16x16x32_bf16 v[44:47], v[88:91], v[196:199], v[44:47]
    v_add_f32 v15, v15, v151
    v_mfma_f32_16x16x32_bf16 v[48:51], v[88:91], v[200:203], v[48:51]
    ds_read_b128 v[104:107], v2 offset:31744
    v_cvt_pk_bf16_f32 v191, v150, v151
    s_waitcnt lgkmcnt(3)
    v_mfma_f32_16x16x32_bf16 v[52:55], v[92:95], v[196:199], v[52:55]
    v_exp_f32 v152, v152
    v_exp_f32 v153, v153
    v_mfma_f32_16x16x32_bf16 v[56:59], v[92:95], v[200:203], v[56:59]
    s_waitcnt vmcnt(4)
    s_barrier
    ds_read_b128 v[84:87], v3 offset:0
    v_add_f32 v16, v16, v152
    s_waitcnt lgkmcnt(3)
    v_mfma_f32_16x16x32_bf16 v[60:63], v[96:99], v[196:199], v[60:63]
    v_add_f32 v16, v16, v153
    v_mfma_f32_16x16x32_bf16 v[64:67], v[96:99], v[200:203], v[64:67]
    s_add_u32 s22, s17, 0x18000
    s_add_u32 m0, s17, 0x10000
    s_nop 0
    buffer_load_dwordx4 v5, s[8:11], s22 offen sc1 lds
    ds_read_b128 v[88:91], v3 offset:1024
    v_cvt_pk_bf16_f32 v194, v152, v153
    s_waitcnt lgkmcnt(3)
    v_mfma_f32_16x16x32_bf16 v[68:71], v[100:103], v[196:199], v[68:71]
    v_exp_f32 v154, v154
    v_exp_f32 v155, v155
    v_mfma_f32_16x16x32_bf16 v[72:75], v[100:103], v[200:203], v[72:75]
    ds_read_b128 v[92:95], v3 offset:2048
    v_add_f32 v16, v16, v154
    s_waitcnt lgkmcnt(3)
    v_mfma_f32_16x16x32_bf16 v[76:79], v[104:107], v[196:199], v[76:79]
    v_add_f32 v16, v16, v155
    v_mfma_f32_16x16x32_bf16 v[80:83], v[104:107], v[200:203], v[80:83]
    s_add_u32 s22, s17, 0x18400
    s_add_u32 m0, s17, 0x10400
    s_nop 0
    buffer_load_dwordx4 v5, s[8:11], s22 offen sc1 lds
    ds_read_b128 v[96:99], v3 offset:3072
    v_cvt_pk_bf16_f32 v195, v154, v155
    s_waitcnt lgkmcnt(3)
    v_mfma_f32_16x16x32_bf16 v[140:143], v[84:87], v[108:111], v[172:175]
    v_exp_f32 v156, v156
    v_exp_f32 v157, v157
    v_mfma_f32_16x16x32_bf16 v[144:147], v[84:87], v[124:127], v[176:179]
    ds_read_b128 v[100:103], v3 offset:4096
    v_add_f32 v15, v15, v156
    s_waitcnt lgkmcnt(3)
    v_mfma_f32_16x16x32_bf16 v[148:151], v[88:91], v[108:111], v[172:175]
    v_add_f32 v15, v15, v157
    v_mfma_f32_16x16x32_bf16 v[152:155], v[88:91], v[124:127], v[176:179]
    s_add_u32 s22, s17, 0x18800
    s_add_u32 m0, s17, 0x10800
    s_nop 0
    buffer_load_dwordx4 v5, s[8:11], s22 offen sc1 lds
    ds_read_b128 v[104:107], v3 offset:5120
    v_cvt_pk_bf16_f32 v196, v156, v157
    s_waitcnt lgkmcnt(3)
    v_mfma_f32_16x16x32_bf16 v[140:143], v[92:95], v[112:115], v[140:143]
    v_exp_f32 v158, v158
    v_exp_f32 v159, v159
    v_mfma_f32_16x16x32_bf16 v[144:147], v[92:95], v[128:131], v[144:147]
    ds_read_b128 v[84:87], v3 offset:6144
    v_add_f32 v15, v15, v158
    s_waitcnt lgkmcnt(3)
    v_mfma_f32_16x16x32_bf16 v[148:151], v[96:99], v[112:115], v[148:151]
    v_add_f32 v15, v15, v159
    v_mfma_f32_16x16x32_bf16 v[152:155], v[96:99], v[128:131], v[152:155]
    s_add_u32 s22, s17, 0x18c00
    s_add_u32 m0, s17, 0x10c00
    s_nop 0
    buffer_load_dwordx4 v5, s[8:11], s22 offen sc1 lds
    ds_read_b128 v[88:91], v3 offset:7168
    v_cvt_pk_bf16_f32 v197, v158, v159
    s_waitcnt lgkmcnt(3)
    v_mfma_f32_16x16x32_bf16 v[140:143], v[100:103], v[116:119], v[140:143]
    v_exp_f32 v160, v160
    v_exp_f32 v161, v161
    v_mfma_f32_16x16x32_bf16 v[144:147], v[100:103], v[132:135], v[144:147]
    ds_read_b128 v[92:95], v2 offset:40960
    v_add_f32 v16, v16, v160
    s_waitcnt lgkmcnt(3)
    v_mfma_f32_16x16x32_bf16 v[148:151], v[104:107], v[116:119], v[148:151]
    v_add_f32 v16, v16, v161
    v_mfma_f32_16x16x32_bf16 v[152:155], v[104:107], v[132:135], v[152:155]
    ds_read_b128 v[96:99], v2 offset:41984
    v_cvt_pk_bf16_f32 v200, v160, v161
    s_waitcnt lgkmcnt(3)
    v_mfma_f32_16x16x32_bf16 v[140:143], v[84:87], v[120:123], v[140:143]
    v_exp_f32 v162, v162
    v_exp_f32 v163, v163
    v_mfma_f32_16x16x32_bf16 v[144:147], v[84:87], v[136:139], v[144:147]
    ds_read_b128 v[100:103], v2 offset:43008
    v_add_f32 v16, v16, v162
    s_waitcnt lgkmcnt(3)
    v_mfma_f32_16x16x32_bf16 v[148:151], v[88:91], v[120:123], v[148:151]
    v_add_f32 v16, v16, v163
    v_mfma_f32_16x16x32_bf16 v[152:155], v[88:91], v[136:139], v[152:155]
    ds_read_b128 v[104:107], v2 offset:44032
    v_cvt_pk_bf16_f32 v201, v162, v163
    s_waitcnt lgkmcnt(3)
    v_mfma_f32_16x16x32_bf16 v[20:23], v[92:95], v[188:191], v[20:23]
    v_exp_f32 v164, v164
    v_exp_f32 v165, v165
    v_mfma_f32_16x16x32_bf16 v[24:27], v[92:95], v[192:195], v[24:27]
    ds_read_b128 v[84:87], v2 offset:45056
    v_add_f32 v15, v15, v164
    s_waitcnt lgkmcnt(3)
    v_mfma_f32_16x16x32_bf16 v[28:31], v[96:99], v[188:191], v[28:31]
    v_add_f32 v15, v15, v165
    v_mfma_f32_16x16x32_bf16 v[32:35], v[96:99], v[192:195], v[32:35]
    ds_read_b128 v[88:91], v2 offset:46080
    v_cvt_pk_bf16_f32 v198, v164, v165
    s_waitcnt lgkmcnt(3)
    v_mfma_f32_16x16x32_bf16 v[36:39], v[100:103], v[188:191], v[36:39]
    v_exp_f32 v166, v166
    v_exp_f32 v167, v167
    v_mfma_f32_16x16x32_bf16 v[40:43], v[100:103], v[192:195], v[40:43]
    ds_read_b128 v[92:95], v2 offset:47104
    v_add_f32 v15, v15, v166
    s_waitcnt lgkmcnt(3)
    v_mfma_f32_16x16x32_bf16 v[44:47], v[104:107], v[188:191], v[44:47]
    v_add_f32 v15, v15, v167
    v_mfma_f32_16x16x32_bf16 v[48:51], v[104:107], v[192:195], v[48:51]
    ds_read_b128 v[96:99], v2 offset:48128
    v_cvt_pk_bf16_f32 v199, v166, v167
    v_lshrrev_b32 v6, 3, v8
    v_and_b32 v7, 7, v8
    s_mov_b64 s[64:65], s[50:51]
    s_mov_b32 s66, 0x700000
    s_mov_b32 s67, 0x20000
    v_mul_u32_u24 v19, 14336, v6
    v_lshl_add_u32 v19, v7, 4, v19
    s_and_b32 s24, s2, 7
    s_lshl_b32 s24, s24, 1
    s_lshr_b32 s26, s2, 7
    s_add_u32 s24, s24, s26
    s_mul_i32 s24, s24, 458752
    s_bfe_u32 s25, s2, 0x40003
    s_lshl_b32 s25, s25, 7
    s_add_u32 s24, s24, s25
    s_waitcnt lgkmcnt(3)
    v_mfma_f32_16x16x32_bf16 v[52:55], v[84:87], v[188:191], v[52:55]
    v_exp_f32 v168, v168
    v_exp_f32 v169, v169
    v_mfma_f32_16x16x32_bf16 v[56:59], v[84:87], v[192:195], v[56:59]
    s_waitcnt vmcnt(4)
    s_barrier
    ds_read_b128 v[100:103], v3 offset:16384
    v_add_f32 v16, v16, v168
    s_add_u32 s25, s24, 0
    buffer_load_dwordx4 v[204:207], v19, s[64:67], s25 offen
    s_waitcnt lgkmcnt(3)
    v_mfma_f32_16x16x32_bf16 v[60:63], v[88:91], v[188:191], v[60:63]
    v_add_f32 v16, v16, v169
    v_mfma_f32_16x16x32_bf16 v[64:67], v[88:91], v[192:195], v[64:67]
    s_add_u32 s22, s17, 0x1c000
    s_add_u32 m0, s17, 0x14000
    s_nop 0
    buffer_load_dwordx4 v5, s[8:11], s22 offen sc1 lds
    ds_read_b128 v[104:107], v3 offset:17408
    v_cvt_pk_bf16_f32 v202, v168, v169
    s_waitcnt lgkmcnt(3)
    v_mfma_f32_16x16x32_bf16 v[68:71], v[92:95], v[188:191], v[68:71]
    v_exp_f32 v170, v170
    v_exp_f32 v171, v171
    v_mfma_f32_16x16x32_bf16 v[72:75], v[92:95], v[192:195], v[72:75]
    ds_read_b128 v[84:87], v3 offset:18432
    v_add_f32 v16, v16, v170
    s_waitcnt lgkmcnt(3)
    v_mfma_f32_16x16x32_bf16 v[76:79], v[96:99], v[188:191], v[76:79]
    v_add_f32 v16, v16, v171
    v_mfma_f32_16x16x32_bf16 v[80:83], v[96:99], v[192:195], v[80:83]
    s_add_u32 s22, s17, 0x1c400
    s_add_u32 m0, s17, 0x14400
    s_nop 0
    buffer_load_dwordx4 v5, s[8:11], s22 offen sc1 lds
    ds_read_b128 v[88:91], v3 offset:19456
    v_cvt_pk_bf16_f32 v203, v170, v171
    s_waitcnt lgkmcnt(3)
    v_mfma_f32_16x16x32_bf16 v[156:159], v[100:103], v[108:111], v[172:175]
    v_exp_f32 v140, v140
    v_exp_f32 v141, v141
    v_mfma_f32_16x16x32_bf16 v[160:163], v[100:103], v[124:127], v[176:179]
    ds_read_b128 v[92:95], v3 offset:20480
    v_add_f32 v15, v15, v140
    s_waitcnt lgkmcnt(3)
    v_mfma_f32_16x16x32_bf16 v[164:167], v[104:107], v[108:111], v[172:175]
    v_add_f32 v15, v15, v141
    v_mfma_f32_16x16x32_bf16 v[168:171], v[104:107], v[124:127], v[176:179]
    s_add_u32 s22, s17, 0x1c800
    s_add_u32 m0, s17, 0x14800
    s_nop 0
    buffer_load_dwordx4 v5, s[8:11], s22 offen sc1 lds
    ds_read_b128 v[96:99], v3 offset:21504
    v_cvt_pk_bf16_f32 v188, v140, v141
    s_add_u32 s25, s24, 2048
    buffer_load_dwordx4 v[208:211], v19, s[64:67], s25 offen
    s_waitcnt lgkmcnt(3)
    v_mfma_f32_16x16x32_bf16 v[156:159], v[84:87], v[112:115], v[156:159]
    v_exp_f32 v142, v142
    v_exp_f32 v143, v143
    v_mfma_f32_16x16x32_bf16 v[160:163], v[84:87], v[128:131], v[160:163]
    ds_read_b128 v[100:103], v3 offset:22528
    v_add_f32 v15, v15, v142
    s_waitcnt lgkmcnt(3)
    v_mfma_f32_16x16x32_bf16 v[164:167], v[88:91], v[112:115], v[164:167]
    v_add_f32 v15, v15, v143
    v_mfma_f32_16x16x32_bf16 v[168:171], v[88:91], v[128:131], v[168:171]
    s_add_u32 s22, s17, 0x1cc00
    s_add_u32 m0, s17, 0x14c00
    s_nop 0
    buffer_load_dwordx4 v5, s[8:11], s22 offen sc1 lds
    ds_read_b128 v[104:107], v3 offset:23552
    v_cvt_pk_bf16_f32 v189, v142, v143
    s_waitcnt lgkmcnt(3)
    v_mfma_f32_16x16x32_bf16 v[156:159], v[92:95], v[116:119], v[156:159]
    v_exp_f32 v144, v144
    v_exp_f32 v145, v145
    v_mfma_f32_16x16x32_bf16 v[160:163], v[92:95], v[132:135], v[160:163]
    ds_read_b128 v[84:87], v2 offset:57344
    v_add_f32 v16, v16, v144
    s_waitcnt lgkmcnt(3)
    v_mfma_f32_16x16x32_bf16 v[164:167], v[96:99], v[116:119], v[164:167]
    v_add_f32 v16, v16, v145
    v_mfma_f32_16x16x32_bf16 v[168:171], v[96:99], v[132:135], v[168:171]
    ds_read_b128 v[88:91], v2 offset:58368
    v_cvt_pk_bf16_f32 v192, v144, v145
    s_waitcnt lgkmcnt(3)
    v_mfma_f32_16x16x32_bf16 v[156:159], v[100:103], v[120:123], v[156:159]
    v_exp_f32 v146, v146
    v_exp_f32 v147, v147
    v_mfma_f32_16x16x32_bf16 v[160:163], v[100:103], v[136:139], v[160:163]
    ds_read_b128 v[92:95], v2 offset:59392
    v_add_f32 v16, v16, v146
    s_waitcnt lgkmcnt(3)
    v_mfma_f32_16x16x32_bf16 v[164:167], v[104:107], v[120:123], v[164:167]
    v_add_f32 v16, v16, v147
    v_mfma_f32_16x16x32_bf16 v[168:171], v[104:107], v[136:139], v[168:171]
    ds_read_b128 v[96:99], v2 offset:60416
    v_cvt_pk_bf16_f32 v193, v146, v147
    s_add_u32 s25, s24, 4096
    buffer_load_dwordx4 v[212:215], v19, s[64:67], s25 offen
    s_waitcnt lgkmcnt(3)
    v_mfma_f32_16x16x32_bf16 v[20:23], v[84:87], v[196:199], v[20:23]
    v_exp_f32 v148, v148
    v_exp_f32 v149, v149
    v_mfma_f32_16x16x32_bf16 v[24:27], v[84:87], v[200:203], v[24:27]
    ds_read_b128 v[100:103], v2 offset:61440
    v_add_f32 v15, v15, v148
    s_waitcnt lgkmcnt(3)
    v_mfma_f32_16x16x32_bf16 v[28:31], v[88:91], v[196:199], v[28:31]
    v_add_f32 v15, v15, v149
    v_mfma_f32_16x16x32_bf16 v[32:35], v[88:91], v[200:203], v[32:35]
    ds_read_b128 v[104:107], v2 offset:62464
    v_cvt_pk_bf16_f32 v190, v148, v149
    s_waitcnt lgkmcnt(3)
    v_mfma_f32_16x16x32_bf16 v[36:39], v[92:95], v[196:199], v[36:39]
    v_exp_f32 v150, v150
    v_exp_f32 v151, v151
    v_mfma_f32_16x16x32_bf16 v[40:43], v[92:95], v[200:203], v[40:43]
    ds_read_b128 v[84:87], v2 offset:63488
    v_add_f32 v15, v15, v150
    s_waitcnt lgkmcnt(3)
    v_mfma_f32_16x16x32_bf16 v[44:47], v[96:99], v[196:199], v[44:47]
    v_add_f32 v15, v15, v151
    v_mfma_f32_16x16x32_bf16 v[48:51], v[96:99], v[200:203], v[48:51]
    ds_read_b128 v[88:91], v2 offset:64512
    v_cvt_pk_bf16_f32 v191, v150, v151
    s_waitcnt lgkmcnt(3)
    v_mfma_f32_16x16x32_bf16 v[52:55], v[100:103], v[196:199], v[52:55]
    v_exp_f32 v152, v152
    v_exp_f32 v153, v153
    v_mfma_f32_16x16x32_bf16 v[56:59], v[100:103], v[200:203], v[56:59]
    s_waitcnt vmcnt(7)
    s_barrier
    ds_read_b128 v[92:95], v2 offset:0
    v_add_f32 v16, v16, v152
    s_waitcnt lgkmcnt(3)
    v_mfma_f32_16x16x32_bf16 v[60:63], v[104:107], v[196:199], v[60:63]
    v_add_f32 v16, v16, v153
    v_mfma_f32_16x16x32_bf16 v[64:67], v[104:107], v[200:203], v[64:67]
    s_add_u32 s22, s17, 0x20000
    s_add_u32 m0, s17, 0x18000
    s_nop 0
    buffer_load_dwordx4 v5, s[8:11], s22 offen sc1 lds
    ds_read_b128 v[96:99], v2 offset:1024
    v_cvt_pk_bf16_f32 v194, v152, v153
    s_add_u32 s25, s24, 6144
    buffer_load_dwordx4 v[216:219], v19, s[64:67], s25 offen
    s_waitcnt lgkmcnt(3)
    v_mfma_f32_16x16x32_bf16 v[68:71], v[84:87], v[196:199], v[68:71]
    v_exp_f32 v154, v154
    v_exp_f32 v155, v155
    v_mfma_f32_16x16x32_bf16 v[72:75], v[84:87], v[200:203], v[72:75]
    ds_read_b128 v[100:103], v2 offset:2048
    v_add_f32 v16, v16, v154
    s_waitcnt lgkmcnt(3)
    v_mfma_f32_16x16x32_bf16 v[76:79], v[88:91], v[196:199], v[76:79]
    v_add_f32 v16, v16, v155
    v_mfma_f32_16x16x32_bf16 v[80:83], v[88:91], v[200:203], v[80:83]
    s_add_u32 s22, s17, 0x20400
    s_add_u32 m0, s17, 0x18400
    s_nop 0
    buffer_load_dwordx4 v5, s[8:11], s22 offen sc1 lds
    ds_read_b128 v[104:107], v2 offset:3072
    v_cvt_pk_bf16_f32 v195, v154, v155
    s_waitcnt lgkmcnt(3)
    v_mfma_f32_16x16x32_bf16 v[140:143], v[92:95], v[108:111], v[172:175]
    v_exp_f32 v156, v156
    v_exp_f32 v157, v157
    v_mfma_f32_16x16x32_bf16 v[144:147], v[92:95], v[124:127], v[176:179]
    ds_read_b128 v[84:87], v2 offset:4096
    v_add_f32 v15, v15, v156
    s_waitcnt lgkmcnt(3)
    v_mfma_f32_16x16x32_bf16 v[148:151], v[96:99], v[108:111], v[172:175]
    v_add_f32 v15, v15, v157
    v_mfma_f32_16x16x32_bf16 v[152:155], v[96:99], v[124:127], v[176:179]
    s_add_u32 s22, s17, 0x20800
    s_add_u32 m0, s17, 0x18800
    s_nop 0
    buffer_load_dwordx4 v5, s[8:11], s22 offen sc1 lds
    ds_read_b128 v[88:91], v2 offset:5120
    v_cvt_pk_bf16_f32 v196, v156, v157
    s_waitcnt lgkmcnt(3)
    v_mfma_f32_16x16x32_bf16 v[140:143], v[100:103], v[112:115], v[140:143]
    v_exp_f32 v158, v158
    v_exp_f32 v159, v159
    v_mfma_f32_16x16x32_bf16 v[144:147], v[100:103], v[128:131], v[144:147]
    ds_read_b128 v[92:95], v2 offset:6144
    v_add_f32 v15, v15, v158
    s_add_u32 s25, s24, 8192
    buffer_load_dwordx4 v[220:223], v19, s[64:67], s25 offen
    s_waitcnt lgkmcnt(3)
    v_mfma_f32_16x16x32_bf16 v[148:151], v[104:107], v[112:115], v[148:151]
    v_add_f32 v15, v15, v159
    v_mfma_f32_16x16x32_bf16 v[152:155], v[104:107], v[128:131], v[152:155]
    s_add_u32 s22, s17, 0x20c00
    s_add_u32 m0, s17, 0x18c00
    s_nop 0
    buffer_load_dwordx4 v5, s[8:11], s22 offen sc1 lds
    ds_read_b128 v[96:99], v2 offset:7168
    v_cvt_pk_bf16_f32 v197, v158, v159
    s_waitcnt lgkmcnt(3)
    v_mfma_f32_16x16x32_bf16 v[140:143], v[84:87], v[116:119], v[140:143]
    v_exp_f32 v160, v160
    v_exp_f32 v161, v161
    v_mfma_f32_16x16x32_bf16 v[144:147], v[84:87], v[132:135], v[144:147]
    ds_read_b128 v[100:103], v3 offset:8192
    v_add_f32 v16, v16, v160
    s_waitcnt lgkmcnt(3)
    v_mfma_f32_16x16x32_bf16 v[148:151], v[88:91], v[116:119], v[148:151]
    v_add_f32 v16, v16, v161
    v_mfma_f32_16x16x32_bf16 v[152:155], v[88:91], v[132:135], v[152:155]
    ds_read_b128 v[104:107], v3 offset:9216
    v_cvt_pk_bf16_f32 v200, v160, v161
    s_waitcnt lgkmcnt(3)
    v_mfma_f32_16x16x32_bf16 v[140:143], v[92:95], v[120:123], v[140:143]
    v_exp_f32 v162, v162
    v_exp_f32 v163, v163
    v_mfma_f32_16x16x32_bf16 v[144:147], v[92:95], v[136:139], v[144:147]
    ds_read_b128 v[84:87], v3 offset:10240
    v_add_f32 v16, v16, v162
    s_waitcnt lgkmcnt(3)
    v_mfma_f32_16x16x32_bf16 v[148:151], v[96:99], v[120:123], v[148:151]
    v_add_f32 v16, v16, v163
    v_mfma_f32_16x16x32_bf16 v[152:155], v[96:99], v[136:139], v[152:155]
    ds_read_b128 v[88:91], v3 offset:11264
    v_cvt_pk_bf16_f32 v201, v162, v163
    s_waitcnt lgkmcnt(3)
    v_mfma_f32_16x16x32_bf16 v[20:23], v[100:103], v[188:191], v[20:23]
    v_exp_f32 v164, v164
    v_exp_f32 v165, v165
    v_mfma_f32_16x16x32_bf16 v[24:27], v[100:103], v[192:195], v[24:27]
    ds_read_b128 v[92:95], v3 offset:12288
    v_add_f32 v15, v15, v164
    s_add_u32 s25, s24, 10240
    buffer_load_dwordx4 v[224:227], v19, s[64:67], s25 offen
    s_waitcnt lgkmcnt(3)
    v_mfma_f32_16x16x32_bf16 v[28:31], v[104:107], v[188:191], v[28:31]
    v_add_f32 v15, v15, v165
    v_mfma_f32_16x16x32_bf16 v[32:35], v[104:107], v[192:195], v[32:35]
    ds_read_b128 v[96:99], v3 offset:13312
    v_cvt_pk_bf16_f32 v198, v164, v165
    s_waitcnt lgkmcnt(3)
    v_mfma_f32_16x16x32_bf16 v[36:39], v[84:87], v[188:191], v[36:39]
    v_exp_f32 v166, v166
    v_exp_f32 v167, v167
    v_mfma_f32_16x16x32_bf16 v[40:43], v[84:87], v[192:195], v[40:43]
    ds_read_b128 v[100:103], v3 offset:14336
    v_add_f32 v15, v15, v166
    s_waitcnt lgkmcnt(3)
    v_mfma_f32_16x16x32_bf16 v[44:47], v[88:91], v[188:191], v[44:47]
    v_add_f32 v15, v15, v167
    v_mfma_f32_16x16x32_bf16 v[48:51], v[88:91], v[192:195], v[48:51]
    ds_read_b128 v[104:107], v3 offset:15360
    v_cvt_pk_bf16_f32 v199, v166, v167
    s_waitcnt lgkmcnt(3)
    v_mfma_f32_16x16x32_bf16 v[52:55], v[92:95], v[188:191], v[52:55]
    v_exp_f32 v168, v168
    v_exp_f32 v169, v169
    v_mfma_f32_16x16x32_bf16 v[56:59], v[92:95], v[192:195], v[56:59]
    s_waitcnt vmcnt(8)
    s_barrier
    ds_read_b128 v[84:87], v2 offset:16384
    v_add_f32 v16, v16, v168
    s_waitcnt lgkmcnt(3)
    v_mfma_f32_16x16x32_bf16 v[60:63], v[96:99], v[188:191], v[60:63]
    v_add_f32 v16, v16, v169
    v_mfma_f32_16x16x32_bf16 v[64:67], v[96:99], v[192:195], v[64:67]
    s_add_u32 s22, s17, 0x24000
    s_add_u32 m0, s17, 0x1c000
    s_nop 0
    buffer_load_dwordx4 v5, s[8:11], s22 offen sc1 lds
    ds_read_b128 v[88:91], v2 offset:17408
    v_cvt_pk_bf16_f32 v202, v168, v169
    s_waitcnt lgkmcnt(3)
    v_mfma_f32_16x16x32_bf16 v[68:71], v[100:103], v[188:191], v[68:71]
    v_exp_f32 v170, v170
    v_exp_f32 v171, v171
    v_mfma_f32_16x16x32_bf16 v[72:75], v[100:103], v[192:195], v[72:75]
    ds_read_b128 v[92:95], v2 offset:18432
    v_add_f32 v16, v16, v170
    s_add_u32 s25, s24, 12288
    buffer_load_dwordx4 v[228:231], v19, s[64:67], s25 offen
    s_waitcnt lgkmcnt(3)
    v_mfma_f32_16x16x32_bf16 v[76:79], v[104:107], v[188:191], v[76:79]
    v_add_f32 v16, v16, v171
    v_mfma_f32_16x16x32_bf16 v[80:83], v[104:107], v[192:195], v[80:83]
    s_add_u32 s22, s17, 0x24400
    s_add_u32 m0, s17, 0x1c400
    s_nop 0
    buffer_load_dwordx4 v5, s[8:11], s22 offen sc1 lds
    ds_read_b128 v[96:99], v2 offset:19456
    v_cvt_pk_bf16_f32 v203, v170, v171
    s_waitcnt lgkmcnt(3)
    v_mfma_f32_16x16x32_bf16 v[156:159], v[84:87], v[108:111], v[172:175]
    v_exp_f32 v140, v140
    v_exp_f32 v141, v141
    v_mfma_f32_16x16x32_bf16 v[160:163], v[84:87], v[124:127], v[176:179]
    ds_read_b128 v[100:103], v2 offset:20480
    v_add_f32 v15, v15, v140
    s_waitcnt lgkmcnt(3)
    v_mfma_f32_16x16x32_bf16 v[164:167], v[88:91], v[108:111], v[172:175]
    v_add_f32 v15, v15, v141
    v_mfma_f32_16x16x32_bf16 v[168:171], v[88:91], v[124:127], v[176:179]
    s_add_u32 s22, s17, 0x24800
    s_add_u32 m0, s17, 0x1c800
    s_nop 0
    buffer_load_dwordx4 v5, s[8:11], s22 offen sc1 lds
    ds_read_b128 v[104:107], v2 offset:21504
    v_cvt_pk_bf16_f32 v188, v140, v141
    s_waitcnt lgkmcnt(3)
    v_mfma_f32_16x16x32_bf16 v[156:159], v[92:95], v[112:115], v[156:159]
    v_exp_f32 v142, v142
    v_exp_f32 v143, v143
    v_mfma_f32_16x16x32_bf16 v[160:163], v[92:95], v[128:131], v[160:163]
    ds_read_b128 v[84:87], v2 offset:22528
    v_add_f32 v15, v15, v142
    s_waitcnt lgkmcnt(3)
    v_mfma_f32_16x16x32_bf16 v[164:167], v[96:99], v[112:115], v[164:167]
    v_add_f32 v15, v15, v143
    v_mfma_f32_16x16x32_bf16 v[168:171], v[96:99], v[128:131], v[168:171]
    s_add_u32 s22, s17, 0x24c00
    s_add_u32 m0, s17, 0x1cc00
    s_nop 0
    buffer_load_dwordx4 v5, s[8:11], s22 offen sc1 lds
    ds_read_b128 v[88:91], v2 offset:23552
    v_cvt_pk_bf16_f32 v189, v142, v143
    s_waitcnt lgkmcnt(3)
    v_mfma_f32_16x16x32_bf16 v[156:159], v[100:103], v[116:119], v[156:159]
    v_exp_f32 v144, v144
    v_exp_f32 v145, v145
    v_mfma_f32_16x16x32_bf16 v[160:163], v[100:103], v[132:135], v[160:163]
    ds_read_b128 v[92:95], v3 offset:24576
    v_add_f32 v16, v16, v144
    s_waitcnt lgkmcnt(3)
    v_mfma_f32_16x16x32_bf16 v[164:167], v[104:107], v[116:119], v[164:167]
    v_add_f32 v16, v16, v145
    v_mfma_f32_16x16x32_bf16 v[168:171], v[104:107], v[132:135], v[168:171]
    ds_read_b128 v[96:99], v3 offset:25600
    v_cvt_pk_bf16_f32 v192, v144, v145
    s_waitcnt lgkmcnt(3)
    v_mfma_f32_16x16x32_bf16 v[156:159], v[84:87], v[120:123], v[156:159]
    v_exp_f32 v146, v146
    v_exp_f32 v147, v147
    v_mfma_f32_16x16x32_bf16 v[160:163], v[84:87], v[136:139], v[160:163]
    ds_read_b128 v[100:103], v3 offset:26624
    v_add_f32 v16, v16, v146
    s_waitcnt lgkmcnt(3)
    v_mfma_f32_16x16x32_bf16 v[164:167], v[88:91], v[120:123], v[164:167]
    v_add_f32 v16, v16, v147
    v_mfma_f32_16x16x32_bf16 v[168:171], v[88:91], v[136:139], v[168:171]
    ds_read_b128 v[104:107], v3 offset:27648
    v_cvt_pk_bf16_f32 v193, v146, v147
    s_waitcnt lgkmcnt(3)
    v_mfma_f32_16x16x32_bf16 v[20:23], v[92:95], v[196:199], v[20:23]
    v_exp_f32 v148, v148
    v_exp_f32 v149, v149
    v_mfma_f32_16x16x32_bf16 v[24:27], v[92:95], v[200:203], v[24:27]
    ds_read_b128 v[84:87], v3 offset:28672
    v_add_f32 v15, v15, v148
    s_waitcnt lgkmcnt(3)
    v_mfma_f32_16x16x32_bf16 v[28:31], v[96:99], v[196:199], v[28:31]
    v_add_f32 v15, v15, v149
    v_mfma_f32_16x16x32_bf16 v[32:35], v[96:99], v[200:203], v[32:35]
    ds_read_b128 v[88:91], v3 offset:29696
    v_cvt_pk_bf16_f32 v190, v148, v149
    s_waitcnt lgkmcnt(3)
    v_mfma_f32_16x16x32_bf16 v[36:39], v[100:103], v[196:199], v[36:39]
    v_exp_f32 v150, v150
    v_exp_f32 v151, v151
    v_mfma_f32_16x16x32_bf16 v[40:43], v[100:103], v[200:203], v[40:43]
    ds_read_b128 v[92:95], v3 offset:30720
    v_add_f32 v15, v15, v150
    s_waitcnt lgkmcnt(3)
    v_mfma_f32_16x16x32_bf16 v[44:47], v[104:107], v[196:199], v[44:47]
    v_add_f32 v15, v15, v151
    v_mfma_f32_16x16x32_bf16 v[48:51], v[104:107], v[200:203], v[48:51]
    ds_read_b128 v[96:99], v3 offset:31744
    v_cvt_pk_bf16_f32 v191, v150, v151
    s_waitcnt lgkmcnt(3)
    v_mfma_f32_16x16x32_bf16 v[52:55], v[84:87], v[196:199], v[52:55]
    v_exp_f32 v152, v152
    v_exp_f32 v153, v153
    v_mfma_f32_16x16x32_bf16 v[56:59], v[84:87], v[200:203], v[56:59]
    s_waitcnt vmcnt(6)
    s_barrier
    ds_read_b128 v[100:103], v2 offset:32768
    v_add_f32 v16, v16, v152
    s_waitcnt lgkmcnt(3)
    v_mfma_f32_16x16x32_bf16 v[60:63], v[88:91], v[196:199], v[60:63]
    v_add_f32 v16, v16, v153
    v_mfma_f32_16x16x32_bf16 v[64:67], v[88:91], v[200:203], v[64:67]
    s_add_u32 s22, s17, 0x28000
    s_add_u32 m0, s17, 0x20000
    s_nop 0
    buffer_load_dwordx4 v5, s[8:11], s22 offen sc1 lds
    ds_read_b128 v[104:107], v2 offset:33792
    v_cvt_pk_bf16_f32 v194, v152, v153
    s_waitcnt lgkmcnt(3)
    v_mfma_f32_16x16x32_bf16 v[68:71], v[92:95], v[196:199], v[68:71]
    v_exp_f32 v154, v154
    v_exp_f32 v155, v155
    v_mfma_f32_16x16x32_bf16 v[72:75], v[92:95], v[200:203], v[72:75]
    ds_read_b128 v[84:87], v2 offset:34816
    v_add_f32 v16, v16, v154
    s_waitcnt lgkmcnt(3)
    v_mfma_f32_16x16x32_bf16 v[76:79], v[96:99], v[196:199], v[76:79]
    v_add_f32 v16, v16, v155
    v_mfma_f32_16x16x32_bf16 v[80:83], v[96:99], v[200:203], v[80:83]
    s_add_u32 s22, s17, 0x28400
    s_add_u32 m0, s17, 0x20400
    s_nop 0
    buffer_load_dwordx4 v5, s[8:11], s22 offen sc1 lds
    ds_read_b128 v[88:91], v2 offset:35840
    v_cvt_pk_bf16_f32 v195, v154, v155
    s_waitcnt lgkmcnt(3)
    v_mfma_f32_16x16x32_bf16 v[140:143], v[100:103], v[108:111], v[172:175]
    v_exp_f32 v156, v156
    v_exp_f32 v157, v157
    v_mfma_f32_16x16x32_bf16 v[144:147], v[100:103], v[124:127], v[176:179]
    ds_read_b128 v[92:95], v2 offset:36864
    v_add_f32 v15, v15, v156
    s_waitcnt lgkmcnt(3)
    v_mfma_f32_16x16x32_bf16 v[148:151], v[104:107], v[108:111], v[172:175]
    v_add_f32 v15, v15, v157
    v_mfma_f32_16x16x32_bf16 v[152:155], v[104:107], v[124:127], v[176:179]
    s_add_u32 s22, s17, 0x28800
    s_add_u32 m0, s17, 0x20800
    s_nop 0
    buffer_load_dwordx4 v5, s[8:11], s22 offen sc1 lds
    ds_read_b128 v[96:99], v2 offset:37888
    v_cvt_pk_bf16_f32 v196, v156, v157
    s_waitcnt lgkmcnt(3)
    v_mfma_f32_16x16x32_bf16 v[140:143], v[84:87], v[112:115], v[140:143]
    v_exp_f32 v158, v158
    v_exp_f32 v159, v159
    v_mfma_f32_16x16x32_bf16 v[144:147], v[84:87], v[128:131], v[144:147]
    ds_read_b128 v[100:103], v2 offset:38912
    v_add_f32 v15, v15, v158
    s_waitcnt lgkmcnt(3)
    v_mfma_f32_16x16x32_bf16 v[148:151], v[88:91], v[112:115], v[148:151]
    v_add_f32 v15, v15, v159
    v_mfma_f32_16x16x32_bf16 v[152:155], v[88:91], v[128:131], v[152:155]
    s_add_u32 s22, s17, 0x28c00
    s_add_u32 m0, s17, 0x20c00
    s_nop 0
    buffer_load_dwordx4 v5, s[8:11], s22 offen sc1 lds
    ds_read_b128 v[104:107], v2 offset:39936
    v_cvt_pk_bf16_f32 v197, v158, v159
    s_waitcnt lgkmcnt(3)
    v_mfma_f32_16x16x32_bf16 v[140:143], v[92:95], v[116:119], v[140:143]
    v_exp_f32 v160, v160
    v_exp_f32 v161, v161
    v_mfma_f32_16x16x32_bf16 v[144:147], v[92:95], v[132:135], v[144:147]
    ds_read_b128 v[84:87], v2 offset:8192
    v_add_f32 v16, v16, v160
    s_waitcnt lgkmcnt(3)
    v_mfma_f32_16x16x32_bf16 v[148:151], v[96:99], v[116:119], v[148:151]
    v_add_f32 v16, v16, v161
    v_mfma_f32_16x16x32_bf16 v[152:155], v[96:99], v[132:135], v[152:155]
    ds_read_b128 v[88:91], v2 offset:9216
    v_cvt_pk_bf16_f32 v200, v160, v161
    s_waitcnt lgkmcnt(3)
    v_mfma_f32_16x16x32_bf16 v[140:143], v[100:103], v[120:123], v[140:143]
    v_exp_f32 v162, v162
    v_exp_f32 v163, v163
    v_mfma_f32_16x16x32_bf16 v[144:147], v[100:103], v[136:139], v[144:147]
    ds_read_b128 v[92:95], v2 offset:10240
    v_add_f32 v16, v16, v162
    s_waitcnt lgkmcnt(3)
    v_mfma_f32_16x16x32_bf16 v[148:151], v[104:107], v[120:123], v[148:151]
    v_add_f32 v16, v16, v163
    v_mfma_f32_16x16x32_bf16 v[152:155], v[104:107], v[136:139], v[152:155]
    ds_read_b128 v[96:99], v2 offset:11264
    v_cvt_pk_bf16_f32 v201, v162, v163
    s_waitcnt lgkmcnt(3)
    v_mfma_f32_16x16x32_bf16 v[20:23], v[84:87], v[188:191], v[20:23]
    v_exp_f32 v164, v164
    v_exp_f32 v165, v165
    v_mfma_f32_16x16x32_bf16 v[24:27], v[84:87], v[192:195], v[24:27]
    ds_read_b128 v[100:103], v2 offset:12288
    v_add_f32 v15, v15, v164
    s_waitcnt lgkmcnt(3)
    v_mfma_f32_16x16x32_bf16 v[28:31], v[88:91], v[188:191], v[28:31]
    v_add_f32 v15, v15, v165
    v_mfma_f32_16x16x32_bf16 v[32:35], v[88:91], v[192:195], v[32:35]
    ds_read_b128 v[104:107], v2 offset:13312
    v_cvt_pk_bf16_f32 v198, v164, v165
    s_waitcnt lgkmcnt(3)
    v_mfma_f32_16x16x32_bf16 v[36:39], v[92:95], v[188:191], v[36:39]
    v_exp_f32 v166, v166
    v_exp_f32 v167, v167
    v_mfma_f32_16x16x32_bf16 v[40:43], v[92:95], v[192:195], v[40:43]
    ds_read_b128 v[84:87], v2 offset:14336
    v_add_f32 v15, v15, v166
    s_waitcnt lgkmcnt(3)
    v_mfma_f32_16x16x32_bf16 v[44:47], v[96:99], v[188:191], v[44:47]
    v_add_f32 v15, v15, v167
    v_mfma_f32_16x16x32_bf16 v[48:51], v[96:99], v[192:195], v[48:51]
    ds_read_b128 v[88:91], v2 offset:15360
    v_cvt_pk_bf16_f32 v199, v166, v167
    s_waitcnt lgkmcnt(3)
    v_mfma_f32_16x16x32_bf16 v[52:55], v[100:103], v[188:191], v[52:55]
    v_exp_f32 v168, v168
    v_exp_f32 v169, v169
    v_mfma_f32_16x16x32_bf16 v[56:59], v[100:103], v[192:195], v[56:59]
    s_waitcnt vmcnt(4)
    s_barrier
    ds_read_b128 v[92:95], v2 offset:49152
    v_add_f32 v16, v16, v168
    s_waitcnt lgkmcnt(3)
    v_mfma_f32_16x16x32_bf16 v[60:63], v[104:107], v[188:191], v[60:63]
    v_add_f32 v16, v16, v169
    v_mfma_f32_16x16x32_bf16 v[64:67], v[104:107], v[192:195], v[64:67]
    s_add_u32 s22, s17, 0x2c000
    s_add_u32 m0, s17, 0x24000
    s_nop 0
    buffer_load_dwordx4 v5, s[8:11], s22 offen sc1 lds
    ds_read_b128 v[96:99], v2 offset:50176
    v_cvt_pk_bf16_f32 v202, v168, v169
    s_waitcnt lgkmcnt(3)
    v_mfma_f32_16x16x32_bf16 v[68:71], v[84:87], v[188:191], v[68:71]
    v_exp_f32 v170, v170
    v_exp_f32 v171, v171
    v_mfma_f32_16x16x32_bf16 v[72:75], v[84:87], v[192:195], v[72:75]
    ds_read_b128 v[100:103], v2 offset:51200
    v_add_f32 v16, v16, v170
    s_waitcnt lgkmcnt(3)
    v_mfma_f32_16x16x32_bf16 v[76:79], v[88:91], v[188:191], v[76:79]
    v_add_f32 v16, v16, v171
    v_mfma_f32_16x16x32_bf16 v[80:83], v[88:91], v[192:195], v[80:83]
    s_add_u32 s22, s17, 0x2c400
    s_add_u32 m0, s17, 0x24400
    s_nop 0
    buffer_load_dwordx4 v5, s[8:11], s22 offen sc1 lds
    ds_read_b128 v[104:107], v2 offset:52224
    v_cvt_pk_bf16_f32 v203, v170, v171
    s_waitcnt lgkmcnt(3)
    v_mfma_f32_16x16x32_bf16 v[156:159], v[92:95], v[108:111], v[172:175]
    v_exp_f32 v140, v140
    v_exp_f32 v141, v141
    v_mfma_f32_16x16x32_bf16 v[160:163], v[92:95], v[124:127], v[176:179]
    ds_read_b128 v[84:87], v2 offset:53248
    v_add_f32 v15, v15, v140
    s_waitcnt lgkmcnt(3)
    v_mfma_f32_16x16x32_bf16 v[164:167], v[96:99], v[108:111], v[172:175]
    v_add_f32 v15, v15, v141
    v_mfma_f32_16x16x32_bf16 v[168:171], v[96:99], v[124:127], v[176:179]
    s_add_u32 s22, s17, 0x2c800
    s_add_u32 m0, s17, 0x24800
    s_nop 0
    buffer_load_dwordx4 v5, s[8:11], s22 offen sc1 lds
    ds_read_b128 v[88:91], v2 offset:54272
    v_cvt_pk_bf16_f32 v188, v140, v141
    s_waitcnt lgkmcnt(3)
    v_mfma_f32_16x16x32_bf16 v[156:159], v[100:103], v[112:115], v[156:159]
    v_exp_f32 v142, v142
    v_exp_f32 v143, v143
    v_mfma_f32_16x16x32_bf16 v[160:163], v[100:103], v[128:131], v[160:163]
    ds_read_b128 v[92:95], v2 offset:55296
    v_add_f32 v15, v15, v142
    s_waitcnt lgkmcnt(3)
    v_mfma_f32_16x16x32_bf16 v[164:167], v[104:107], v[112:115], v[164:167]
    v_add_f32 v15, v15, v143
    v_mfma_f32_16x16x32_bf16 v[168:171], v[104:107], v[128:131], v[168:171]
    s_add_u32 s22, s17, 0x2cc00
    s_add_u32 m0, s17, 0x24c00
    s_nop 0
    buffer_load_dwordx4 v5, s[8:11], s22 offen sc1 lds
    ds_read_b128 v[96:99], v2 offset:56320
    v_cvt_pk_bf16_f32 v189, v142, v143
    s_waitcnt lgkmcnt(3)
    v_mfma_f32_16x16x32_bf16 v[156:159], v[84:87], v[116:119], v[156:159]
    v_exp_f32 v144, v144
    v_exp_f32 v145, v145
    v_mfma_f32_16x16x32_bf16 v[160:163], v[84:87], v[132:135], v[160:163]
    ds_read_b128 v[100:103], v2 offset:24576
    v_add_f32 v16, v16, v144
    s_waitcnt lgkmcnt(3)
    v_mfma_f32_16x16x32_bf16 v[164:167], v[88:91], v[116:119], v[164:167]
    v_add_f32 v16, v16, v145
    v_mfma_f32_16x16x32_bf16 v[168:171], v[88:91], v[132:135], v[168:171]
    ds_read_b128 v[104:107], v2 offset:25600
    v_cvt_pk_bf16_f32 v192, v144, v145
    s_waitcnt lgkmcnt(3)
    v_mfma_f32_16x16x32_bf16 v[156:159], v[92:95], v[120:123], v[156:159]
    v_exp_f32 v146, v146
    v_exp_f32 v147, v147
    v_mfma_f32_16x16x32_bf16 v[160:163], v[92:95], v[136:139], v[160:163]
    ds_read_b128 v[84:87], v2 offset:26624
    v_add_f32 v16, v16, v146
    s_waitcnt lgkmcnt(3)
    v_mfma_f32_16x16x32_bf16 v[164:167], v[96:99], v[120:123], v[164:167]
    v_add_f32 v16, v16, v147
    v_mfma_f32_16x16x32_bf16 v[168:171], v[96:99], v[136:139], v[168:171]
    ds_read_b128 v[88:91], v2 offset:27648
    v_cvt_pk_bf16_f32 v193, v146, v147
    s_waitcnt lgkmcnt(3)
    v_mfma_f32_16x16x32_bf16 v[20:23], v[100:103], v[196:199], v[20:23]
    v_exp_f32 v148, v148
    v_exp_f32 v149, v149
    v_mfma_f32_16x16x32_bf16 v[24:27], v[100:103], v[200:203], v[24:27]
    ds_read_b128 v[92:95], v2 offset:28672
    v_add_f32 v15, v15, v148
    s_waitcnt lgkmcnt(3)
    v_mfma_f32_16x16x32_bf16 v[28:31], v[104:107], v[196:199], v[28:31]
    v_add_f32 v15, v15, v149
    v_mfma_f32_16x16x32_bf16 v[32:35], v[104:107], v[200:203], v[32:35]
    ds_read_b128 v[96:99], v2 offset:29696
    v_cvt_pk_bf16_f32 v190, v148, v149
    s_waitcnt lgkmcnt(3)
    v_mfma_f32_16x16x32_bf16 v[36:39], v[84:87], v[196:199], v[36:39]
    v_exp_f32 v150, v150
    v_exp_f32 v151, v151
    v_mfma_f32_16x16x32_bf16 v[40:43], v[84:87], v[200:203], v[40:43]
    ds_read_b128 v[100:103], v2 offset:30720
    v_add_f32 v15, v15, v150
    s_waitcnt lgkmcnt(3)
    v_mfma_f32_16x16x32_bf16 v[44:47], v[88:91], v[196:199], v[44:47]
    v_add_f32 v15, v15, v151
    v_mfma_f32_16x16x32_bf16 v[48:51], v[88:91], v[200:203], v[48:51]
    ds_read_b128 v[104:107], v2 offset:31744
    v_cvt_pk_bf16_f32 v191, v150, v151
    s_waitcnt lgkmcnt(3)
    v_mfma_f32_16x16x32_bf16 v[52:55], v[92:95], v[196:199], v[52:55]
    v_exp_f32 v152, v152
    v_exp_f32 v153, v153
    v_mfma_f32_16x16x32_bf16 v[56:59], v[92:95], v[200:203], v[56:59]
    s_waitcnt vmcnt(4)
    s_barrier
    ds_read_b128 v[84:87], v3 offset:0
    v_add_f32 v16, v16, v152
    s_waitcnt lgkmcnt(3)
    v_mfma_f32_16x16x32_bf16 v[60:63], v[96:99], v[196:199], v[60:63]
    v_add_f32 v16, v16, v153
    v_mfma_f32_16x16x32_bf16 v[64:67], v[96:99], v[200:203], v[64:67]
    s_add_u32 s22, s17, 0x30000
    s_add_u32 m0, s17, 0x10000
    s_nop 0
    buffer_load_dwordx4 v5, s[8:11], s22 offen sc1 lds
    ds_read_b128 v[88:91], v3 offset:1024
    v_cvt_pk_bf16_f32 v194, v152, v153
    s_waitcnt lgkmcnt(3)
    v_mfma_f32_16x16x32_bf16 v[68:71], v[100:103], v[196:199], v[68:71]
    v_exp_f32 v154, v154
    v_exp_f32 v155, v155
    v_mfma_f32_16x16x32_bf16 v[72:75], v[100:103], v[200:203], v[72:75]
    ds_read_b128 v[92:95], v3 offset:2048
    v_add_f32 v16, v16, v154
    s_waitcnt lgkmcnt(3)
    v_mfma_f32_16x16x32_bf16 v[76:79], v[104:107], v[196:199], v[76:79]
    v_add_f32 v16, v16, v155
    v_mfma_f32_16x16x32_bf16 v[80:83], v[104:107], v[200:203], v[80:83]
    s_add_u32 s22, s17, 0x30400
    s_add_u32 m0, s17, 0x10400
    s_nop 0
    buffer_load_dwordx4 v5, s[8:11], s22 offen sc1 lds
    ds_read_b128 v[96:99], v3 offset:3072
    v_cvt_pk_bf16_f32 v195, v154, v155
    s_waitcnt lgkmcnt(3)
    v_mfma_f32_16x16x32_bf16 v[140:143], v[84:87], v[108:111], v[172:175]
    v_exp_f32 v156, v156
    v_exp_f32 v157, v157
    v_mfma_f32_16x16x32_bf16 v[144:147], v[84:87], v[124:127], v[176:179]
    ds_read_b128 v[100:103], v3 offset:4096
    v_add_f32 v15, v15, v156
    s_waitcnt lgkmcnt(3)
    v_mfma_f32_16x16x32_bf16 v[148:151], v[88:91], v[108:111], v[172:175]
    v_add_f32 v15, v15, v157
    v_mfma_f32_16x16x32_bf16 v[152:155], v[88:91], v[124:127], v[176:179]
    s_add_u32 s22, s17, 0x30800
    s_add_u32 m0, s17, 0x10800
    s_nop 0
    buffer_load_dwordx4 v5, s[8:11], s22 offen sc1 lds
    ds_read_b128 v[104:107], v3 offset:5120
    v_cvt_pk_bf16_f32 v196, v156, v157
    s_waitcnt lgkmcnt(3)
    v_mfma_f32_16x16x32_bf16 v[140:143], v[92:95], v[112:115], v[140:143]
    v_exp_f32 v158, v158
    v_exp_f32 v159, v159
    v_mfma_f32_16x16x32_bf16 v[144:147], v[92:95], v[128:131], v[144:147]
    ds_read_b128 v[84:87], v3 offset:6144
    v_add_f32 v15, v15, v158
    s_waitcnt lgkmcnt(3)
    v_mfma_f32_16x16x32_bf16 v[148:151], v[96:99], v[112:115], v[148:151]
    v_add_f32 v15, v15, v159
    v_mfma_f32_16x16x32_bf16 v[152:155], v[96:99], v[128:131], v[152:155]
    s_add_u32 s22, s17, 0x30c00
    s_add_u32 m0, s17, 0x10c00
    s_nop 0
    buffer_load_dwordx4 v5, s[8:11], s22 offen sc1 lds
    ds_read_b128 v[88:91], v3 offset:7168
    v_cvt_pk_bf16_f32 v197, v158, v159
    s_waitcnt lgkmcnt(3)
    v_mfma_f32_16x16x32_bf16 v[140:143], v[100:103], v[116:119], v[140:143]
    v_exp_f32 v160, v160
    v_exp_f32 v161, v161
    v_mfma_f32_16x16x32_bf16 v[144:147], v[100:103], v[132:135], v[144:147]
    ds_read_b128 v[92:95], v2 offset:40960
    v_add_f32 v16, v16, v160
    s_waitcnt lgkmcnt(3)
    v_mfma_f32_16x16x32_bf16 v[148:151], v[104:107], v[116:119], v[148:151]
    v_add_f32 v16, v16, v161
    v_mfma_f32_16x16x32_bf16 v[152:155], v[104:107], v[132:135], v[152:155]
    ds_read_b128 v[96:99], v2 offset:41984
    v_cvt_pk_bf16_f32 v200, v160, v161
    s_waitcnt lgkmcnt(3)
    v_mfma_f32_16x16x32_bf16 v[140:143], v[84:87], v[120:123], v[140:143]
    v_exp_f32 v162, v162
    v_exp_f32 v163, v163
    v_mfma_f32_16x16x32_bf16 v[144:147], v[84:87], v[136:139], v[144:147]
    ds_read_b128 v[100:103], v2 offset:43008
    v_add_f32 v16, v16, v162
    s_waitcnt lgkmcnt(3)
    v_mfma_f32_16x16x32_bf16 v[148:151], v[88:91], v[120:123], v[148:151]
    v_add_f32 v16, v16, v163
    v_mfma_f32_16x16x32_bf16 v[152:155], v[88:91], v[136:139], v[152:155]
    ds_read_b128 v[104:107], v2 offset:44032
    v_cvt_pk_bf16_f32 v201, v162, v163
    s_waitcnt lgkmcnt(3)
    v_mfma_f32_16x16x32_bf16 v[20:23], v[92:95], v[188:191], v[20:23]
    v_exp_f32 v164, v164
    v_exp_f32 v165, v165
    v_mfma_f32_16x16x32_bf16 v[24:27], v[92:95], v[192:195], v[24:27]
    ds_read_b128 v[84:87], v2 offset:45056
    v_add_f32 v15, v15, v164
    s_waitcnt lgkmcnt(3)
    v_mfma_f32_16x16x32_bf16 v[28:31], v[96:99], v[188:191], v[28:31]
    v_add_f32 v15, v15, v165
    v_mfma_f32_16x16x32_bf16 v[32:35], v[96:99], v[192:195], v[32:35]
    ds_read_b128 v[88:91], v2 offset:46080
    v_cvt_pk_bf16_f32 v198, v164, v165
    s_waitcnt lgkmcnt(3)
    v_mfma_f32_16x16x32_bf16 v[36:39], v[100:103], v[188:191], v[36:39]
    v_exp_f32 v166, v166
    v_exp_f32 v167, v167
    v_mfma_f32_16x16x32_bf16 v[40:43], v[100:103], v[192:195], v[40:43]
    ds_read_b128 v[92:95], v2 offset:47104
    v_add_f32 v15, v15, v166
    s_waitcnt lgkmcnt(3)
    v_mfma_f32_16x16x32_bf16 v[44:47], v[104:107], v[188:191], v[44:47]
    v_add_f32 v15, v15, v167
    v_mfma_f32_16x16x32_bf16 v[48:51], v[104:107], v[192:195], v[48:51]
    ds_read_b128 v[96:99], v2 offset:48128
    v_cvt_pk_bf16_f32 v199, v166, v167
    s_waitcnt lgkmcnt(3)
    v_mfma_f32_16x16x32_bf16 v[52:55], v[84:87], v[188:191], v[52:55]
    v_exp_f32 v168, v168
    v_exp_f32 v169, v169
    v_mfma_f32_16x16x32_bf16 v[56:59], v[84:87], v[192:195], v[56:59]
    s_waitcnt vmcnt(4)
    s_barrier
    ds_read_b128 v[100:103], v3 offset:16384
    v_add_f32 v16, v16, v168
    s_waitcnt lgkmcnt(3)
    v_mfma_f32_16x16x32_bf16 v[60:63], v[88:91], v[188:191], v[60:63]
    v_add_f32 v16, v16, v169
    v_mfma_f32_16x16x32_bf16 v[64:67], v[88:91], v[192:195], v[64:67]
    s_add_u32 s22, s17, 0x34000
    s_add_u32 m0, s17, 0x14000
    s_nop 0
    buffer_load_dwordx4 v5, s[8:11], s22 offen sc1 lds
    ds_read_b128 v[104:107], v3 offset:17408
    v_cvt_pk_bf16_f32 v202, v168, v169
    s_waitcnt lgkmcnt(3)
    v_mfma_f32_16x16x32_bf16 v[68:71], v[92:95], v[188:191], v[68:71]
    v_exp_f32 v170, v170
    v_exp_f32 v171, v171
    v_mfma_f32_16x16x32_bf16 v[72:75], v[92:95], v[192:195], v[72:75]
    ds_read_b128 v[84:87], v3 offset:18432
    v_add_f32 v16, v16, v170
    s_waitcnt lgkmcnt(3)
    v_mfma_f32_16x16x32_bf16 v[76:79], v[96:99], v[188:191], v[76:79]
    v_add_f32 v16, v16, v171
    v_mfma_f32_16x16x32_bf16 v[80:83], v[96:99], v[192:195], v[80:83]
    s_add_u32 s22, s17, 0x34400
    s_add_u32 m0, s17, 0x14400
    s_nop 0
    buffer_load_dwordx4 v5, s[8:11], s22 offen sc1 lds
    ds_read_b128 v[88:91], v3 offset:19456
    v_cvt_pk_bf16_f32 v203, v170, v171
    s_waitcnt lgkmcnt(3)
    v_mfma_f32_16x16x32_bf16 v[156:159], v[100:103], v[108:111], v[172:175]
    v_exp_f32 v140, v140
    v_exp_f32 v141, v141
    v_mfma_f32_16x16x32_bf16 v[160:163], v[100:103], v[124:127], v[176:179]
    ds_read_b128 v[92:95], v3 offset:20480
    v_add_f32 v15, v15, v140
    s_waitcnt lgkmcnt(3)
    v_mfma_f32_16x16x32_bf16 v[164:167], v[104:107], v[108:111], v[172:175]
    v_add_f32 v15, v15, v141
    v_mfma_f32_16x16x32_bf16 v[168:171], v[104:107], v[124:127], v[176:179]
    s_add_u32 s22, s17, 0x34800
    s_add_u32 m0, s17, 0x14800
    s_nop 0
    buffer_load_dwordx4 v5, s[8:11], s22 offen sc1 lds
    ds_read_b128 v[96:99], v3 offset:21504
    v_cvt_pk_bf16_f32 v188, v140, v141
    s_waitcnt lgkmcnt(3)
    v_mfma_f32_16x16x32_bf16 v[156:159], v[84:87], v[112:115], v[156:159]
    v_exp_f32 v142, v142
    v_exp_f32 v143, v143
    v_mfma_f32_16x16x32_bf16 v[160:163], v[84:87], v[128:131], v[160:163]
    ds_read_b128 v[100:103], v3 offset:22528
    v_add_f32 v15, v15, v142
    s_waitcnt lgkmcnt(3)
    v_mfma_f32_16x16x32_bf16 v[164:167], v[88:91], v[112:115], v[164:167]
    v_add_f32 v15, v15, v143
    v_mfma_f32_16x16x32_bf16 v[168:171], v[88:91], v[128:131], v[168:171]
    s_add_u32 s22, s17, 0x34c00
    s_add_u32 m0, s17, 0x14c00
    s_nop 0
    buffer_load_dwordx4 v5, s[8:11], s22 offen sc1 lds
    ds_read_b128 v[104:107], v3 offset:23552
    v_cvt_pk_bf16_f32 v189, v142, v143
    s_waitcnt lgkmcnt(3)
    v_mfma_f32_16x16x32_bf16 v[156:159], v[92:95], v[116:119], v[156:159]
    v_exp_f32 v144, v144
    v_exp_f32 v145, v145
    v_mfma_f32_16x16x32_bf16 v[160:163], v[92:95], v[132:135], v[160:163]
    ds_read_b128 v[84:87], v2 offset:57344
    v_add_f32 v16, v16, v144
    s_waitcnt lgkmcnt(3)
    v_mfma_f32_16x16x32_bf16 v[164:167], v[96:99], v[116:119], v[164:167]
    v_add_f32 v16, v16, v145
    v_mfma_f32_16x16x32_bf16 v[168:171], v[96:99], v[132:135], v[168:171]
    ds_read_b128 v[88:91], v2 offset:58368
    v_cvt_pk_bf16_f32 v192, v144, v145
    s_waitcnt lgkmcnt(3)
    v_mfma_f32_16x16x32_bf16 v[156:159], v[100:103], v[120:123], v[156:159]
    v_exp_f32 v146, v146
    v_exp_f32 v147, v147
    v_mfma_f32_16x16x32_bf16 v[160:163], v[100:103], v[136:139], v[160:163]
    ds_read_b128 v[92:95], v2 offset:59392
    v_add_f32 v16, v16, v146
    s_waitcnt lgkmcnt(3)
    v_mfma_f32_16x16x32_bf16 v[164:167], v[104:107], v[120:123], v[164:167]
    v_add_f32 v16, v16, v147
    v_mfma_f32_16x16x32_bf16 v[168:171], v[104:107], v[136:139], v[168:171]
    ds_read_b128 v[96:99], v2 offset:60416
    v_cvt_pk_bf16_f32 v193, v146, v147
    s_waitcnt lgkmcnt(3)
    v_mfma_f32_16x16x32_bf16 v[20:23], v[84:87], v[196:199], v[20:23]
    v_exp_f32 v148, v148
    v_exp_f32 v149, v149
    v_mfma_f32_16x16x32_bf16 v[24:27], v[84:87], v[200:203], v[24:27]
    ds_read_b128 v[100:103], v2 offset:61440
    v_add_f32 v15, v15, v148
    s_waitcnt lgkmcnt(3)
    v_mfma_f32_16x16x32_bf16 v[28:31], v[88:91], v[196:199], v[28:31]
    v_add_f32 v15, v15, v149
    v_mfma_f32_16x16x32_bf16 v[32:35], v[88:91], v[200:203], v[32:35]
    ds_read_b128 v[104:107], v2 offset:62464
    v_cvt_pk_bf16_f32 v190, v148, v149
    s_waitcnt lgkmcnt(3)
    v_mfma_f32_16x16x32_bf16 v[36:39], v[92:95], v[196:199], v[36:39]
    v_exp_f32 v150, v150
    v_exp_f32 v151, v151
    v_mfma_f32_16x16x32_bf16 v[40:43], v[92:95], v[200:203], v[40:43]
    ds_read_b128 v[84:87], v2 offset:63488
    v_add_f32 v15, v15, v150
    s_waitcnt lgkmcnt(3)
    v_mfma_f32_16x16x32_bf16 v[44:47], v[96:99], v[196:199], v[44:47]
    v_add_f32 v15, v15, v151
    v_mfma_f32_16x16x32_bf16 v[48:51], v[96:99], v[200:203], v[48:51]
    ds_read_b128 v[88:91], v2 offset:64512
    v_cvt_pk_bf16_f32 v191, v150, v151
    s_waitcnt lgkmcnt(3)
    v_mfma_f32_16x16x32_bf16 v[52:55], v[100:103], v[196:199], v[52:55]
    v_exp_f32 v152, v152
    v_exp_f32 v153, v153
    v_mfma_f32_16x16x32_bf16 v[56:59], v[100:103], v[200:203], v[56:59]
    s_waitcnt vmcnt(4)
    s_barrier
    ds_read_b128 v[92:95], v2 offset:0
    v_add_f32 v16, v16, v152
    s_waitcnt lgkmcnt(3)
    v_mfma_f32_16x16x32_bf16 v[60:63], v[104:107], v[196:199], v[60:63]
    v_add_f32 v16, v16, v153
    v_mfma_f32_16x16x32_bf16 v[64:67], v[104:107], v[200:203], v[64:67]
    s_add_u32 s22, s17, 0x38000
    s_add_u32 m0, s17, 0x18000
    s_nop 0
    buffer_load_dwordx4 v5, s[8:11], s22 offen sc1 lds
    ds_read_b128 v[96:99], v2 offset:1024
    v_cvt_pk_bf16_f32 v194, v152, v153
    s_waitcnt lgkmcnt(3)
    v_mfma_f32_16x16x32_bf16 v[68:71], v[84:87], v[196:199], v[68:71]
    v_exp_f32 v154, v154
    v_exp_f32 v155, v155
    v_mfma_f32_16x16x32_bf16 v[72:75], v[84:87], v[200:203], v[72:75]
    ds_read_b128 v[100:103], v2 offset:2048
    v_add_f32 v16, v16, v154
    s_waitcnt lgkmcnt(3)
    v_mfma_f32_16x16x32_bf16 v[76:79], v[88:91], v[196:199], v[76:79]
    v_add_f32 v16, v16, v155
    v_mfma_f32_16x16x32_bf16 v[80:83], v[88:91], v[200:203], v[80:83]
    s_add_u32 s22, s17, 0x38400
    s_add_u32 m0, s17, 0x18400
    s_nop 0
    buffer_load_dwordx4 v5, s[8:11], s22 offen sc1 lds
    ds_read_b128 v[104:107], v2 offset:3072
    v_cvt_pk_bf16_f32 v195, v154, v155
    s_waitcnt lgkmcnt(3)
    v_mfma_f32_16x16x32_bf16 v[140:143], v[92:95], v[108:111], v[172:175]
    v_exp_f32 v156, v156
    v_exp_f32 v157, v157
    v_mfma_f32_16x16x32_bf16 v[144:147], v[92:95], v[124:127], v[176:179]
    ds_read_b128 v[84:87], v2 offset:4096
    v_add_f32 v15, v15, v156
    s_waitcnt lgkmcnt(3)
    v_mfma_f32_16x16x32_bf16 v[148:151], v[96:99], v[108:111], v[172:175]
    v_add_f32 v15, v15, v157
    v_mfma_f32_16x16x32_bf16 v[152:155], v[96:99], v[124:127], v[176:179]
    s_add_u32 s22, s17, 0x38800
    s_add_u32 m0, s17, 0x18800
    s_nop 0
    buffer_load_dwordx4 v5, s[8:11], s22 offen sc1 lds
    ds_read_b128 v[88:91], v2 offset:5120
    v_cvt_pk_bf16_f32 v196, v156, v157
    s_waitcnt lgkmcnt(3)
    v_mfma_f32_16x16x32_bf16 v[140:143], v[100:103], v[112:115], v[140:143]
    v_exp_f32 v158, v158
    v_exp_f32 v159, v159
    v_mfma_f32_16x16x32_bf16 v[144:147], v[100:103], v[128:131], v[144:147]
    ds_read_b128 v[92:95], v2 offset:6144
    v_add_f32 v15, v15, v158
    s_waitcnt lgkmcnt(3)
    v_mfma_f32_16x16x32_bf16 v[148:151], v[104:107], v[112:115], v[148:151]
    v_add_f32 v15, v15, v159
    v_mfma_f32_16x16x32_bf16 v[152:155], v[104:107], v[128:131], v[152:155]
    s_add_u32 s22, s17, 0x38c00
    s_add_u32 m0, s17, 0x18c00
    s_nop 0
    buffer_load_dwordx4 v5, s[8:11], s22 offen sc1 lds
    ds_read_b128 v[96:99], v2 offset:7168
    v_cvt_pk_bf16_f32 v197, v158, v159
    s_waitcnt lgkmcnt(3)
    v_mfma_f32_16x16x32_bf16 v[140:143], v[84:87], v[116:119], v[140:143]
    v_exp_f32 v160, v160
    v_exp_f32 v161, v161
    v_mfma_f32_16x16x32_bf16 v[144:147], v[84:87], v[132:135], v[144:147]
    ds_read_b128 v[100:103], v3 offset:8192
    v_add_f32 v16, v16, v160
    s_waitcnt lgkmcnt(3)
    v_mfma_f32_16x16x32_bf16 v[148:151], v[88:91], v[116:119], v[148:151]
    v_add_f32 v16, v16, v161
    v_mfma_f32_16x16x32_bf16 v[152:155], v[88:91], v[132:135], v[152:155]
    ds_read_b128 v[104:107], v3 offset:9216
    v_cvt_pk_bf16_f32 v200, v160, v161
    s_waitcnt lgkmcnt(3)
    v_mfma_f32_16x16x32_bf16 v[140:143], v[92:95], v[120:123], v[140:143]
    v_exp_f32 v162, v162
    v_exp_f32 v163, v163
    v_mfma_f32_16x16x32_bf16 v[144:147], v[92:95], v[136:139], v[144:147]
    ds_read_b128 v[84:87], v3 offset:10240
    v_add_f32 v16, v16, v162
    s_waitcnt lgkmcnt(3)
    v_mfma_f32_16x16x32_bf16 v[148:151], v[96:99], v[120:123], v[148:151]
    v_add_f32 v16, v16, v163
    v_mfma_f32_16x16x32_bf16 v[152:155], v[96:99], v[136:139], v[152:155]
    ds_read_b128 v[88:91], v3 offset:11264
    v_cvt_pk_bf16_f32 v201, v162, v163
    s_waitcnt lgkmcnt(3)
    v_mfma_f32_16x16x32_bf16 v[20:23], v[100:103], v[188:191], v[20:23]
    v_exp_f32 v164, v164
    v_exp_f32 v165, v165
    v_mfma_f32_16x16x32_bf16 v[24:27], v[100:103], v[192:195], v[24:27]
    ds_read_b128 v[92:95], v3 offset:12288
    v_add_f32 v15, v15, v164
    s_waitcnt lgkmcnt(3)
    v_mfma_f32_16x16x32_bf16 v[28:31], v[104:107], v[188:191], v[28:31]
    v_add_f32 v15, v15, v165
    v_mfma_f32_16x16x32_bf16 v[32:35], v[104:107], v[192:195], v[32:35]
    ds_read_b128 v[96:99], v3 offset:13312
    v_cvt_pk_bf16_f32 v198, v164, v165
    s_waitcnt lgkmcnt(3)
    v_mfma_f32_16x16x32_bf16 v[36:39], v[84:87], v[188:191], v[36:39]
    v_exp_f32 v166, v166
    v_exp_f32 v167, v167
    v_mfma_f32_16x16x32_bf16 v[40:43], v[84:87], v[192:195], v[40:43]
    ds_read_b128 v[100:103], v3 offset:14336
    v_add_f32 v15, v15, v166
    s_waitcnt lgkmcnt(3)
    v_mfma_f32_16x16x32_bf16 v[44:47], v[88:91], v[188:191], v[44:47]
    v_add_f32 v15, v15, v167
    v_mfma_f32_16x16x32_bf16 v[48:51], v[88:91], v[192:195], v[48:51]
    ds_read_b128 v[104:107], v3 offset:15360
    v_cvt_pk_bf16_f32 v199, v166, v167
    s_waitcnt lgkmcnt(3)
    v_mfma_f32_16x16x32_bf16 v[52:55], v[92:95], v[188:191], v[52:55]
    v_exp_f32 v168, v168
    v_exp_f32 v169, v169
    v_mfma_f32_16x16x32_bf16 v[56:59], v[92:95], v[192:195], v[56:59]
    s_waitcnt vmcnt(4)
    s_barrier
    ds_read_b128 v[84:87], v2 offset:16384
    v_add_f32 v16, v16, v168
    s_waitcnt lgkmcnt(3)
    v_mfma_f32_16x16x32_bf16 v[60:63], v[96:99], v[188:191], v[60:63]
    v_add_f32 v16, v16, v169
    v_mfma_f32_16x16x32_bf16 v[64:67], v[96:99], v[192:195], v[64:67]
    s_add_u32 s22, s17, 0x3c000
    s_add_u32 m0, s17, 0x1c000
    s_nop 0
    buffer_load_dwordx4 v5, s[8:11], s22 offen sc1 lds
    ds_read_b128 v[88:91], v2 offset:17408
    v_cvt_pk_bf16_f32 v202, v168, v169
    s_waitcnt lgkmcnt(3)
    v_mfma_f32_16x16x32_bf16 v[68:71], v[100:103], v[188:191], v[68:71]
    v_exp_f32 v170, v170
    v_exp_f32 v171, v171
    v_mfma_f32_16x16x32_bf16 v[72:75], v[100:103], v[192:195], v[72:75]
    ds_read_b128 v[92:95], v2 offset:18432
    v_add_f32 v16, v16, v170
    s_waitcnt lgkmcnt(3)
    v_mfma_f32_16x16x32_bf16 v[76:79], v[104:107], v[188:191], v[76:79]
    v_add_f32 v16, v16, v171
    v_mfma_f32_16x16x32_bf16 v[80:83], v[104:107], v[192:195], v[80:83]
    s_add_u32 s22, s17, 0x3c400
    s_add_u32 m0, s17, 0x1c400
    s_nop 0
    buffer_load_dwordx4 v5, s[8:11], s22 offen sc1 lds
    ds_read_b128 v[96:99], v2 offset:19456
    v_cvt_pk_bf16_f32 v203, v170, v171
    s_waitcnt lgkmcnt(3)
    v_mfma_f32_16x16x32_bf16 v[156:159], v[84:87], v[108:111], v[172:175]
    v_exp_f32 v140, v140
    v_exp_f32 v141, v141
    v_mfma_f32_16x16x32_bf16 v[160:163], v[84:87], v[124:127], v[176:179]
    ds_read_b128 v[100:103], v2 offset:20480
    v_add_f32 v15, v15, v140
    s_waitcnt lgkmcnt(3)
    v_mfma_f32_16x16x32_bf16 v[164:167], v[88:91], v[108:111], v[172:175]
    v_add_f32 v15, v15, v141
    v_mfma_f32_16x16x32_bf16 v[168:171], v[88:91], v[124:127], v[176:179]
    s_add_u32 s22, s17, 0x3c800
    s_add_u32 m0, s17, 0x1c800
    s_nop 0
    buffer_load_dwordx4 v5, s[8:11], s22 offen sc1 lds
    ds_read_b128 v[104:107], v2 offset:21504
    v_cvt_pk_bf16_f32 v188, v140, v141
    s_waitcnt lgkmcnt(3)
    v_mfma_f32_16x16x32_bf16 v[156:159], v[92:95], v[112:115], v[156:159]
    v_exp_f32 v142, v142
    v_exp_f32 v143, v143
    v_mfma_f32_16x16x32_bf16 v[160:163], v[92:95], v[128:131], v[160:163]
    ds_read_b128 v[84:87], v2 offset:22528
    v_add_f32 v15, v15, v142
    s_waitcnt lgkmcnt(3)
    v_mfma_f32_16x16x32_bf16 v[164:167], v[96:99], v[112:115], v[164:167]
    v_add_f32 v15, v15, v143
    v_mfma_f32_16x16x32_bf16 v[168:171], v[96:99], v[128:131], v[168:171]
    s_add_u32 s22, s17, 0x3cc00
    s_add_u32 m0, s17, 0x1cc00
    s_nop 0
    buffer_load_dwordx4 v5, s[8:11], s22 offen sc1 lds
    ds_read_b128 v[88:91], v2 offset:23552
    v_cvt_pk_bf16_f32 v189, v142, v143
    s_waitcnt lgkmcnt(3)
    v_mfma_f32_16x16x32_bf16 v[156:159], v[100:103], v[116:119], v[156:159]
    v_exp_f32 v144, v144
    v_exp_f32 v145, v145
    v_mfma_f32_16x16x32_bf16 v[160:163], v[100:103], v[132:135], v[160:163]
    ds_read_b128 v[92:95], v3 offset:24576
    v_add_f32 v16, v16, v144
    s_waitcnt lgkmcnt(3)
    v_mfma_f32_16x16x32_bf16 v[164:167], v[104:107], v[116:119], v[164:167]
    v_add_f32 v16, v16, v145
    v_mfma_f32_16x16x32_bf16 v[168:171], v[104:107], v[132:135], v[168:171]
    ds_read_b128 v[96:99], v3 offset:25600
    v_cvt_pk_bf16_f32 v192, v144, v145
    s_waitcnt lgkmcnt(3)
    v_mfma_f32_16x16x32_bf16 v[156:159], v[84:87], v[120:123], v[156:159]
    v_exp_f32 v146, v146
    v_exp_f32 v147, v147
    v_mfma_f32_16x16x32_bf16 v[160:163], v[84:87], v[136:139], v[160:163]
    ds_read_b128 v[100:103], v3 offset:26624
    v_add_f32 v16, v16, v146
    s_waitcnt lgkmcnt(3)
    v_mfma_f32_16x16x32_bf16 v[164:167], v[88:91], v[120:123], v[164:167]
    v_add_f32 v16, v16, v147
    v_mfma_f32_16x16x32_bf16 v[168:171], v[88:91], v[136:139], v[168:171]
    ds_read_b128 v[104:107], v3 offset:27648
    v_cvt_pk_bf16_f32 v193, v146, v147
    s_waitcnt lgkmcnt(3)
    v_mfma_f32_16x16x32_bf16 v[20:23], v[92:95], v[196:199], v[20:23]
    v_exp_f32 v148, v148
    v_exp_f32 v149, v149
    v_mfma_f32_16x16x32_bf16 v[24:27], v[92:95], v[200:203], v[24:27]
    ds_read_b128 v[84:87], v3 offset:28672
    v_add_f32 v15, v15, v148
    s_waitcnt lgkmcnt(3)
    v_mfma_f32_16x16x32_bf16 v[28:31], v[96:99], v[196:199], v[28:31]
    v_add_f32 v15, v15, v149
    v_mfma_f32_16x16x32_bf16 v[32:35], v[96:99], v[200:203], v[32:35]
    ds_read_b128 v[88:91], v3 offset:29696
    v_cvt_pk_bf16_f32 v190, v148, v149
    s_waitcnt lgkmcnt(3)
    v_mfma_f32_16x16x32_bf16 v[36:39], v[100:103], v[196:199], v[36:39]
    v_exp_f32 v150, v150
    v_exp_f32 v151, v151
    v_mfma_f32_16x16x32_bf16 v[40:43], v[100:103], v[200:203], v[40:43]
    ds_read_b128 v[92:95], v3 offset:30720
    v_add_f32 v15, v15, v150
    s_waitcnt lgkmcnt(3)
    v_mfma_f32_16x16x32_bf16 v[44:47], v[104:107], v[196:199], v[44:47]
    v_add_f32 v15, v15, v151
    v_mfma_f32_16x16x32_bf16 v[48:51], v[104:107], v[200:203], v[48:51]
    ds_read_b128 v[96:99], v3 offset:31744
    v_cvt_pk_bf16_f32 v191, v150, v151
    s_waitcnt lgkmcnt(3)
    v_mfma_f32_16x16x32_bf16 v[52:55], v[84:87], v[196:199], v[52:55]
    v_exp_f32 v152, v152
    v_exp_f32 v153, v153
    v_mfma_f32_16x16x32_bf16 v[56:59], v[84:87], v[200:203], v[56:59]
    s_waitcnt vmcnt(4)
    s_barrier
    ds_read_b128 v[100:103], v2 offset:32768
    v_add_f32 v16, v16, v152
    s_waitcnt lgkmcnt(3)
    v_mfma_f32_16x16x32_bf16 v[60:63], v[88:91], v[196:199], v[60:63]
    v_add_f32 v16, v16, v153
    v_mfma_f32_16x16x32_bf16 v[64:67], v[88:91], v[200:203], v[64:67]
    ds_read_b128 v[104:107], v2 offset:33792
    v_cvt_pk_bf16_f32 v194, v152, v153
    s_waitcnt lgkmcnt(3)
    v_mfma_f32_16x16x32_bf16 v[68:71], v[92:95], v[196:199], v[68:71]
    v_exp_f32 v154, v154
    v_exp_f32 v155, v155
    v_mfma_f32_16x16x32_bf16 v[72:75], v[92:95], v[200:203], v[72:75]
    ds_read_b128 v[84:87], v2 offset:34816
    v_add_f32 v16, v16, v154
    s_waitcnt lgkmcnt(3)
    v_mfma_f32_16x16x32_bf16 v[76:79], v[96:99], v[196:199], v[76:79]
    v_add_f32 v16, v16, v155
    v_mfma_f32_16x16x32_bf16 v[80:83], v[96:99], v[200:203], v[80:83]
    ds_read_b128 v[88:91], v2 offset:35840
    v_cvt_pk_bf16_f32 v195, v154, v155
    s_waitcnt lgkmcnt(3)
    v_mfma_f32_16x16x32_bf16 v[140:143], v[100:103], v[108:111], v[172:175]
    v_exp_f32 v156, v156
    v_exp_f32 v157, v157
    v_mfma_f32_16x16x32_bf16 v[144:147], v[100:103], v[124:127], v[176:179]
    ds_read_b128 v[92:95], v2 offset:36864
    v_add_f32 v15, v15, v156
    s_waitcnt lgkmcnt(3)
    v_mfma_f32_16x16x32_bf16 v[148:151], v[104:107], v[108:111], v[172:175]
    v_add_f32 v15, v15, v157
    v_mfma_f32_16x16x32_bf16 v[152:155], v[104:107], v[124:127], v[176:179]
    ds_read_b128 v[96:99], v2 offset:37888
    v_cvt_pk_bf16_f32 v196, v156, v157
    s_waitcnt lgkmcnt(3)
    v_mfma_f32_16x16x32_bf16 v[140:143], v[84:87], v[112:115], v[140:143]
    v_exp_f32 v158, v158
    v_exp_f32 v159, v159
    v_mfma_f32_16x16x32_bf16 v[144:147], v[84:87], v[128:131], v[144:147]
    ds_read_b128 v[100:103], v2 offset:38912
    v_add_f32 v15, v15, v158
    s_waitcnt lgkmcnt(3)
    v_mfma_f32_16x16x32_bf16 v[148:151], v[88:91], v[112:115], v[148:151]
    v_add_f32 v15, v15, v159
    v_mfma_f32_16x16x32_bf16 v[152:155], v[88:91], v[128:131], v[152:155]
    ds_read_b128 v[104:107], v2 offset:39936
    v_cvt_pk_bf16_f32 v197, v158, v159
    s_waitcnt lgkmcnt(3)
    v_mfma_f32_16x16x32_bf16 v[140:143], v[92:95], v[116:119], v[140:143]
    v_exp_f32 v160, v160
    v_exp_f32 v161, v161
    v_mfma_f32_16x16x32_bf16 v[144:147], v[92:95], v[132:135], v[144:147]
    ds_read_b128 v[84:87], v2 offset:8192
    v_add_f32 v16, v16, v160
    s_waitcnt lgkmcnt(3)
    v_mfma_f32_16x16x32_bf16 v[148:151], v[96:99], v[116:119], v[148:151]
    v_add_f32 v16, v16, v161
    v_mfma_f32_16x16x32_bf16 v[152:155], v[96:99], v[132:135], v[152:155]
    ds_read_b128 v[88:91], v2 offset:9216
    v_cvt_pk_bf16_f32 v200, v160, v161
    s_bfe_u32 s22, s42, 0x30000
    s_or_b32 s22, s22, s62
    s_lshl_b32 s22, s22, 18
    s_add_u32 s22, s22, s16
    s_add_u32 s22, s22, 0x0
    s_add_u32 m0, s17, 0x0
    s_nop 0
    buffer_load_dwordx4 v17, s[4:7], s22 offen lds
    s_waitcnt lgkmcnt(3)
    v_mfma_f32_16x16x32_bf16 v[140:143], v[100:103], v[120:123], v[140:143]
    v_exp_f32 v162, v162
    v_exp_f32 v163, v163
    v_mfma_f32_16x16x32_bf16 v[144:147], v[100:103], v[136:139], v[144:147]
    ds_read_b128 v[92:95], v2 offset:10240
    v_add_f32 v16, v16, v162
    s_waitcnt lgkmcnt(3)
    v_mfma_f32_16x16x32_bf16 v[148:151], v[104:107], v[120:123], v[148:151]
    v_add_f32 v16, v16, v163
    v_mfma_f32_16x16x32_bf16 v[152:155], v[104:107], v[136:139], v[152:155]
    ds_read_b128 v[96:99], v2 offset:11264
    v_cvt_pk_bf16_f32 v201, v162, v163
    s_bfe_u32 s22, s42, 0x30000
    s_or_b32 s22, s22, s62
    s_lshl_b32 s22, s22, 18
    s_add_u32 s22, s22, s16
    s_add_u32 s22, s22, 0x2000
    s_add_u32 m0, s17, 0x400
    s_nop 0
    buffer_load_dwordx4 v18, s[4:7], s22 offen lds
    s_waitcnt lgkmcnt(3)
    v_mfma_f32_16x16x32_bf16 v[20:23], v[84:87], v[188:191], v[20:23]
    v_exp_f32 v164, v164
    v_exp_f32 v165, v165
    v_mfma_f32_16x16x32_bf16 v[24:27], v[84:87], v[192:195], v[24:27]
    ds_read_b128 v[100:103], v2 offset:12288
    v_add_f32 v15, v15, v164
    s_waitcnt lgkmcnt(3)
    v_mfma_f32_16x16x32_bf16 v[28:31], v[88:91], v[188:191], v[28:31]
    v_add_f32 v15, v15, v165
    v_mfma_f32_16x16x32_bf16 v[32:35], v[88:91], v[192:195], v[32:35]
    ds_read_b128 v[104:107], v2 offset:13312
    v_cvt_pk_bf16_f32 v198, v164, v165
    s_bfe_u32 s22, s42, 0x30000
    s_or_b32 s22, s22, s62
    s_lshl_b32 s22, s22, 18
    s_add_u32 s22, s22, s16
    s_add_u32 s22, s22, 0x4000
    s_add_u32 m0, s17, 0x800
    s_nop 0
    buffer_load_dwordx4 v17, s[4:7], s22 offen lds
    s_waitcnt lgkmcnt(3)
    v_mfma_f32_16x16x32_bf16 v[36:39], v[92:95], v[188:191], v[36:39]
    v_exp_f32 v166, v166
    v_exp_f32 v167, v167
    v_mfma_f32_16x16x32_bf16 v[40:43], v[92:95], v[192:195], v[40:43]
    ds_read_b128 v[84:87], v2 offset:14336
    v_add_f32 v15, v15, v166
    s_waitcnt lgkmcnt(3)
    v_mfma_f32_16x16x32_bf16 v[44:47], v[96:99], v[188:191], v[44:47]
    v_add_f32 v15, v15, v167
    v_mfma_f32_16x16x32_bf16 v[48:51], v[96:99], v[192:195], v[48:51]
    ds_read_b128 v[88:91], v2 offset:15360
    v_cvt_pk_bf16_f32 v199, v166, v167
    s_bfe_u32 s22, s42, 0x30000
    s_or_b32 s22, s22, s62
    s_lshl_b32 s22, s22, 18
    s_add_u32 s22, s22, s16
    s_add_u32 s22, s22, 0x6000
    s_add_u32 m0, s17, 0xc00
    s_nop 0
    buffer_load_dwordx4 v18, s[4:7], s22 offen lds
    s_waitcnt lgkmcnt(3)
    v_mfma_f32_16x16x32_bf16 v[52:55], v[100:103], v[188:191], v[52:55]
    v_exp_f32 v168, v168
    v_exp_f32 v169, v169
    v_mfma_f32_16x16x32_bf16 v[56:59], v[100:103], v[192:195], v[56:59]
    s_waitcnt vmcnt(4)
    s_barrier
    ds_read_b128 v[92:95], v2 offset:49152
    v_add_f32 v16, v16, v168
    s_waitcnt lgkmcnt(3)
    v_mfma_f32_16x16x32_bf16 v[60:63], v[104:107], v[188:191], v[60:63]
    v_add_f32 v16, v16, v169
    v_mfma_f32_16x16x32_bf16 v[64:67], v[104:107], v[192:195], v[64:67]
    ds_read_b128 v[96:99], v2 offset:50176
    v_cvt_pk_bf16_f32 v202, v168, v169
    s_waitcnt lgkmcnt(3)
    v_mfma_f32_16x16x32_bf16 v[68:71], v[84:87], v[188:191], v[68:71]
    v_exp_f32 v170, v170
    v_exp_f32 v171, v171
    v_mfma_f32_16x16x32_bf16 v[72:75], v[84:87], v[192:195], v[72:75]
    ds_read_b128 v[100:103], v2 offset:51200
    v_add_f32 v16, v16, v170
    s_waitcnt lgkmcnt(3)
    v_mfma_f32_16x16x32_bf16 v[76:79], v[88:91], v[188:191], v[76:79]
    v_add_f32 v16, v16, v171
    v_mfma_f32_16x16x32_bf16 v[80:83], v[88:91], v[192:195], v[80:83]
    ds_read_b128 v[104:107], v2 offset:52224
    v_cvt_pk_bf16_f32 v203, v170, v171
    s_waitcnt lgkmcnt(3)
    v_mfma_f32_16x16x32_bf16 v[156:159], v[92:95], v[108:111], v[172:175]
    v_exp_f32 v140, v140
    v_exp_f32 v141, v141
    v_mfma_f32_16x16x32_bf16 v[160:163], v[92:95], v[124:127], v[176:179]
    ds_read_b128 v[84:87], v2 offset:53248
    v_add_f32 v15, v15, v140
    v_lshlrev_b32 v6, 4, v8
    s_mov_b64 s[68:69], s[44:45]
    s_mov_b32 s70, 0x800
    s_mov_b32 s71, 0x20000
    v_lshlrev_b32 v7, 3, v8
    buffer_load_dwordx2 v[186:187], v7, s[68:71], 0 offen
    s_mov_b32 s26, 0xa20000
    buffer_load_dwordx4 v[236:239], v6, s[8:11], s26 offen sc1
    s_mov_b32 s26, 0xa21000
    buffer_load_dwordx4 v[240:243], v6, s[8:11], s26 offen sc1
    s_mov_b32 s26, 0xa22000
    buffer_load_dwordx4 v[244:247], v6, s[8:11], s26 offen sc1
    s_mov_b32 s26, 0xa23000
    buffer_load_dwordx4 v[248:251], v6, s[8:11], s26 offen sc1
    s_waitcnt lgkmcnt(3)
    v_mfma_f32_16x16x32_bf16 v[164:167], v[96:99], v[108:111], v[172:175]
    v_add_f32 v15, v15, v141
    v_mfma_f32_16x16x32_bf16 v[168:171], v[96:99], v[124:127], v[176:179]
    ds_read_b128 v[88:91], v2 offset:54272
    v_cvt_pk_bf16_f32 v188, v140, v141
    s_waitcnt lgkmcnt(3)
    v_mfma_f32_16x16x32_bf16 v[156:159], v[100:103], v[112:115], v[156:159]
    v_exp_f32 v142, v142
    v_exp_f32 v143, v143
    v_mfma_f32_16x16x32_bf16 v[160:163], v[100:103], v[128:131], v[160:163]
    ds_read_b128 v[92:95], v2 offset:55296
    v_add_f32 v15, v15, v142
    s_waitcnt lgkmcnt(3)
    v_mfma_f32_16x16x32_bf16 v[164:167], v[104:107], v[112:115], v[164:167]
    v_add_f32 v15, v15, v143
    v_mfma_f32_16x16x32_bf16 v[168:171], v[104:107], v[128:131], v[168:171]
    ds_read_b128 v[96:99], v2 offset:56320
    v_cvt_pk_bf16_f32 v189, v142, v143
    s_waitcnt lgkmcnt(3)
    v_mfma_f32_16x16x32_bf16 v[156:159], v[84:87], v[116:119], v[156:159]
    v_exp_f32 v144, v144
    v_exp_f32 v145, v145
    v_mfma_f32_16x16x32_bf16 v[160:163], v[84:87], v[132:135], v[160:163]
    ds_read_b128 v[100:103], v2 offset:24576
    v_add_f32 v16, v16, v144
    s_waitcnt lgkmcnt(3)
    v_mfma_f32_16x16x32_bf16 v[164:167], v[88:91], v[116:119], v[164:167]
    v_add_f32 v16, v16, v145
    v_mfma_f32_16x16x32_bf16 v[168:171], v[88:91], v[132:135], v[168:171]
    ds_read_b128 v[104:107], v2 offset:25600
    v_cvt_pk_bf16_f32 v192, v144, v145
    s_bfe_u32 s22, s42, 0x30000
    s_or_b32 s22, s22, s62
    s_lshl_b32 s22, s22, 18
    s_add_u32 s22, s22, s16
    s_add_u32 s22, s22, 0x20000
    s_add_u32 m0, s17, 0x4000
    s_nop 0
    buffer_load_dwordx4 v17, s[4:7], s22 offen lds
    s_waitcnt lgkmcnt(3)
    v_mfma_f32_16x16x32_bf16 v[156:159], v[92:95], v[120:123], v[156:159]
    v_exp_f32 v146, v146
    v_exp_f32 v147, v147
    v_mfma_f32_16x16x32_bf16 v[160:163], v[92:95], v[136:139], v[160:163]
    ds_read_b128 v[84:87], v2 offset:26624
    v_add_f32 v16, v16, v146
    s_waitcnt lgkmcnt(3)
    v_mfma_f32_16x16x32_bf16 v[164:167], v[96:99], v[120:123], v[164:167]
    v_add_f32 v16, v16, v147
    v_mfma_f32_16x16x32_bf16 v[168:171], v[96:99], v[136:139], v[168:171]
    ds_read_b128 v[88:91], v2 offset:27648
    v_cvt_pk_bf16_f32 v193, v146, v147
    s_bfe_u32 s22, s42, 0x30000
    s_or_b32 s22, s22, s62
    s_lshl_b32 s22, s22, 18
    s_add_u32 s22, s22, s16
    s_add_u32 s22, s22, 0x22000
    s_add_u32 m0, s17, 0x4400
    s_nop 0
    buffer_load_dwordx4 v18, s[4:7], s22 offen lds
    s_waitcnt lgkmcnt(3)
    v_mfma_f32_16x16x32_bf16 v[20:23], v[100:103], v[196:199], v[20:23]
    v_exp_f32 v148, v148
    v_exp_f32 v149, v149
    v_mfma_f32_16x16x32_bf16 v[24:27], v[100:103], v[200:203], v[24:27]
    ds_read_b128 v[92:95], v2 offset:28672
    v_add_f32 v15, v15, v148
    s_waitcnt lgkmcnt(3)
    v_mfma_f32_16x16x32_bf16 v[28:31], v[104:107], v[196:199], v[28:31]
    v_add_f32 v15, v15, v149
    v_mfma_f32_16x16x32_bf16 v[32:35], v[104:107], v[200:203], v[32:35]
    ds_read_b128 v[96:99], v2 offset:29696
    v_cvt_pk_bf16_f32 v190, v148, v149
    s_bfe_u32 s22, s42, 0x30000
    s_or_b32 s22, s22, s62
    s_lshl_b32 s22, s22, 18
    s_add_u32 s22, s22, s16
    s_add_u32 s22, s22, 0x24000
    s_add_u32 m0, s17, 0x4800
    s_nop 0
    buffer_load_dwordx4 v17, s[4:7], s22 offen lds
    s_waitcnt lgkmcnt(3)
    v_mfma_f32_16x16x32_bf16 v[36:39], v[84:87], v[196:199], v[36:39]
    v_exp_f32 v150, v150
    v_exp_f32 v151, v151
    v_mfma_f32_16x16x32_bf16 v[40:43], v[84:87], v[200:203], v[40:43]
    ds_read_b128 v[100:103], v2 offset:30720
    v_add_f32 v15, v15, v150
    s_waitcnt lgkmcnt(3)
    v_mfma_f32_16x16x32_bf16 v[44:47], v[88:91], v[196:199], v[44:47]
    v_add_f32 v15, v15, v151
    v_mfma_f32_16x16x32_bf16 v[48:51], v[88:91], v[200:203], v[48:51]
    ds_read_b128 v[104:107], v2 offset:31744
    v_cvt_pk_bf16_f32 v191, v150, v151
    s_bfe_u32 s22, s42, 0x30000
    s_or_b32 s22, s22, s62
    s_lshl_b32 s22, s22, 18
    s_add_u32 s22, s22, s16
    s_add_u32 s22, s22, 0x26000
    s_add_u32 m0, s17, 0x4c00
    s_nop 0
    buffer_load_dwordx4 v18, s[4:7], s22 offen lds
    s_waitcnt lgkmcnt(3)
    v_mfma_f32_16x16x32_bf16 v[52:55], v[92:95], v[196:199], v[52:55]
    v_exp_f32 v152, v152
    v_exp_f32 v153, v153
    v_mfma_f32_16x16x32_bf16 v[56:59], v[92:95], v[200:203], v[56:59]
    ds_read_b128 v[84:87], v2 offset:40960
    v_add_f32 v16, v16, v152
    s_waitcnt lgkmcnt(3)
    v_mfma_f32_16x16x32_bf16 v[60:63], v[96:99], v[196:199], v[60:63]
    v_add_f32 v16, v16, v153
    v_mfma_f32_16x16x32_bf16 v[64:67], v[96:99], v[200:203], v[64:67]
    ds_read_b128 v[88:91], v2 offset:41984
    v_cvt_pk_bf16_f32 v194, v152, v153
    s_waitcnt lgkmcnt(3)
    v_mfma_f32_16x16x32_bf16 v[68:71], v[100:103], v[196:199], v[68:71]
    v_exp_f32 v154, v154
    v_exp_f32 v155, v155
    v_mfma_f32_16x16x32_bf16 v[72:75], v[100:103], v[200:203], v[72:75]
    ds_read_b128 v[92:95], v2 offset:43008
    v_add_f32 v16, v16, v154
    s_waitcnt lgkmcnt(3)
    v_mfma_f32_16x16x32_bf16 v[76:79], v[104:107], v[196:199], v[76:79]
    v_add_f32 v16, v16, v155
    v_mfma_f32_16x16x32_bf16 v[80:83], v[104:107], v[200:203], v[80:83]
    ds_read_b128 v[96:99], v2 offset:44032
    v_cvt_pk_bf16_f32 v195, v154, v155
    s_waitcnt lgkmcnt(3)
    v_mfma_f32_16x16x32_bf16 v[20:23], v[84:87], v[188:191], v[20:23]
    v_exp_f32 v156, v156
    v_exp_f32 v157, v157
    v_add_f32 v15, v15, v156
    v_mfma_f32_16x16x32_bf16 v[24:27], v[84:87], v[192:195], v[24:27]
    ds_read_b128 v[100:103], v2 offset:45056
    v_add_f32 v15, v15, v157
    v_cvt_pk_bf16_f32 v196, v156, v157
    s_waitcnt vmcnt(7)
    v_min3_u32 v13, v236, v237, v238
    s_waitcnt vmcnt(6)
    v_min3_u32 v13, v13, v239, v240
    v_min3_u32 v13, v13, v241, v242
    s_waitcnt vmcnt(5)
    v_min3_u32 v13, v13, v243, v244
    v_min3_u32 v13, v13, v245, v246
    s_waitcnt vmcnt(4)
    v_min3_u32 v13, v13, v247, v248
    v_min3_u32 v13, v13, v249, v250
    v_min_u32 v13, v13, v251
    v_cmp_eq_u32 vcc, 0, v13
    s_cbranch_vccz fz_mfg
    s_mov_b32 s27, 0
fz_mfp:
    s_mov_b32 s26, 0xa20000
    buffer_load_dwordx4 v[236:239], v6, s[8:11], s26 offen sc1
    s_mov_b32 s26, 0xa21000
    buffer_load_dwordx4 v[240:243], v6, s[8:11], s26 offen sc1
    s_mov_b32 s26, 0xa22000
    buffer_load_dwordx4 v[244:247], v6, s[8:11], s26 offen sc1
    s_mov_b32 s26, 0xa23000
    buffer_load_dwordx4 v[248:251], v6, s[8:11], s26 offen sc1
    s_waitcnt vmcnt(0)
    v_min3_u32 v13, v236, v237, v238
    v_min3_u32 v13, v13, v239, v240
    v_min3_u32 v13, v13, v241, v242
    v_min3_u32 v13, v13, v243, v244
    v_min3_u32 v13, v13, v245, v246
    v_min3_u32 v13, v13, v247, v248
    v_min3_u32 v13, v13, v249, v250
    v_min_u32 v13, v13, v251
    v_cmp_eq_u32 vcc, 0, v13
    s_add_u32 s27, s27, 1
    s_cmp_ge_u32 s27, 65536
    s_nop 4
    s_cbranch_scc1 fz_mfg
    s_cbranch_vccnz fz_mfp
fz_mfg:
    s_mov_b32 s26, 0x07060302
    v_perm_b32 v180, v241, v240, s26
    v_perm_b32 v181, v243, v242, s26
    v_perm_b32 v182, v245, v244, s26
    v_perm_b32 v183, v247, v246, s26
    v_perm_b32 v184, v249, v248, s26
    v_perm_b32 v185, v251, v250, s26
    v_add_u32 v7, 0x20000, v7
    ds_write_b64 v7, v[180:181] offset:0
    ds_write_b64 v7, v[182:183] offset:2048
    ds_write_b64 v7, v[184:185] offset:4096
    ds_write_b64 v7, v[186:187] offset:6144
    v_and_b32 v236, 0xffff0000, v236
    v_and_b32 v237, 0xffff0000, v237
    v_and_b32 v238, 0xffff0000, v238
    v_and_b32 v239, 0xffff0000, v239
    v_add_u32 v6, 0x22000, v6
    ds_write_b128 v6, v[236:239]
    s_waitcnt lgkmcnt(0)
    v_mfma_f32_16x16x32_bf16 v[28:31], v[88:91], v[188:191], v[28:31]
    v_exp_f32 v158, v158
    v_exp_f32 v159, v159
    v_add_f32 v15, v15, v158
    v_mfma_f32_16x16x32_bf16 v[32:35], v[88:91], v[192:195], v[32:35]
    ds_read_b128 v[104:107], v2 offset:46080
    v_add_f32 v15, v15, v159
    v_cvt_pk_bf16_f32 v197, v158, v159
    v_mfma_f32_16x16x32_bf16 v[36:39], v[92:95], v[188:191], v[36:39]
    v_exp_f32 v160, v160
    v_exp_f32 v161, v161
    v_add_f32 v16, v16, v160
    v_mfma_f32_16x16x32_bf16 v[40:43], v[92:95], v[192:195], v[40:43]
    ds_read_b128 v[84:87], v2 offset:47104
    v_add_f32 v16, v16, v161
    v_cvt_pk_bf16_f32 v200, v160, v161
    v_mfma_f32_16x16x32_bf16 v[44:47], v[96:99], v[188:191], v[44:47]
    v_exp_f32 v162, v162
    v_exp_f32 v163, v163
    v_add_f32 v16, v16, v162
    v_mfma_f32_16x16x32_bf16 v[48:51], v[96:99], v[192:195], v[48:51]
    ds_read_b128 v[88:91], v2 offset:48128
    v_add_f32 v16, v16, v163
    v_cvt_pk_bf16_f32 v201, v162, v163
    v_mfma_f32_16x16x32_bf16 v[52:55], v[100:103], v[188:191], v[52:55]
    v_exp_f32 v164, v164
    v_exp_f32 v165, v165
    v_add_f32 v15, v15, v164
    v_mfma_f32_16x16x32_bf16 v[56:59], v[100:103], v[192:195], v[56:59]
    ds_read_b128 v[92:95], v2 offset:57344
    v_add_f32 v15, v15, v165
    v_cvt_pk_bf16_f32 v198, v164, v165
    s_waitcnt lgkmcnt(3)
    v_mfma_f32_16x16x32_bf16 v[60:63], v[104:107], v[188:191], v[60:63]
    v_exp_f32 v166, v166
    v_exp_f32 v167, v167
    v_add_f32 v15, v15, v166
    v_mfma_f32_16x16x32_bf16 v[64:67], v[104:107], v[192:195], v[64:67]
    ds_read_b128 v[96:99], v2 offset:58368
    v_add_f32 v15, v15, v167
    v_cvt_pk_bf16_f32 v199, v166, v167
    s_bfe_u32 s22, s42, 0x30004
    s_or_b32 s22, s22, s62
    s_lshl_b32 s22, s22, 18
    s_add_u32 s22, s22, s16
    s_add_u32 s22, s22, 0x0
    s_add_u32 m0, s17, 0x8000
    s_nop 0
    buffer_load_dwordx4 v17, s[4:7], s22 offen lds
    s_waitcnt lgkmcnt(3)
    v_mfma_f32_16x16x32_bf16 v[68:71], v[84:87], v[188:191], v[68:71]
    v_exp_f32 v168, v168
    v_exp_f32 v169, v169
    v_add_f32 v16, v16, v168
    v_mfma_f32_16x16x32_bf16 v[72:75], v[84:87], v[192:195], v[72:75]
    ds_read_b128 v[100:103], v2 offset:59392
    v_add_f32 v16, v16, v169
    v_cvt_pk_bf16_f32 v202, v168, v169
    s_waitcnt lgkmcnt(3)
    v_mfma_f32_16x16x32_bf16 v[76:79], v[88:91], v[188:191], v[76:79]
    v_exp_f32 v170, v170
    v_exp_f32 v171, v171
    v_add_f32 v16, v16, v170
    v_mfma_f32_16x16x32_bf16 v[80:83], v[88:91], v[192:195], v[80:83]
    ds_read_b128 v[104:107], v2 offset:60416
    v_add_f32 v16, v16, v171
    v_cvt_pk_bf16_f32 v203, v170, v171
    s_bfe_u32 s22, s42, 0x30004
    s_or_b32 s22, s22, s62
    s_lshl_b32 s22, s22, 18
    s_add_u32 s22, s22, s16
    s_add_u32 s22, s22, 0x2000
    s_add_u32 m0, s17, 0x8400
    s_nop 0
    buffer_load_dwordx4 v18, s[4:7], s22 offen lds
    s_waitcnt lgkmcnt(3)
    v_mfma_f32_16x16x32_bf16 v[20:23], v[92:95], v[196:199], v[20:23]
    v_mfma_f32_16x16x32_bf16 v[24:27], v[92:95], v[200:203], v[24:27]
    ds_read_b128 v[84:87], v2 offset:61440
    s_waitcnt lgkmcnt(3)
    v_mfma_f32_16x16x32_bf16 v[28:31], v[96:99], v[196:199], v[28:31]
    v_mfma_f32_16x16x32_bf16 v[32:35], v[96:99], v[200:203], v[32:35]
    ds_read_b128 v[88:91], v2 offset:62464
    s_bfe_u32 s22, s42, 0x30004
    s_or_b32 s22, s22, s62
    s_lshl_b32 s22, s22, 18
    s_add_u32 s22, s22, s16
    s_add_u32 s22, s22, 0x4000
    s_add_u32 m0, s17, 0x8800
    s_nop 0
    buffer_load_dwordx4 v17, s[4:7], s22 offen lds
    s_waitcnt lgkmcnt(3)
    v_mfma_f32_16x16x32_bf16 v[36:39], v[100:103], v[196:199], v[36:39]
    v_mfma_f32_16x16x32_bf16 v[40:43], v[100:103], v[200:203], v[40:43]
    ds_read_b128 v[92:95], v2 offset:63488
    s_waitcnt lgkmcnt(3)
    v_mfma_f32_16x16x32_bf16 v[44:47], v[104:107], v[196:199], v[44:47]
    v_mfma_f32_16x16x32_bf16 v[48:51], v[104:107], v[200:203], v[48:51]
    ds_read_b128 v[96:99], v2 offset:64512
    s_bfe_u32 s22, s42, 0x30004
    s_or_b32 s22, s22, s62
    s_lshl_b32 s22, s22, 18
    s_add_u32 s22, s22, s16
    s_add_u32 s22, s22, 0x6000
    s_add_u32 m0, s17, 0x8c00
    s_nop 0
    buffer_load_dwordx4 v18, s[4:7], s22 offen lds
    s_waitcnt lgkmcnt(3)
    v_mfma_f32_16x16x32_bf16 v[52:55], v[84:87], v[196:199], v[52:55]
    v_mfma_f32_16x16x32_bf16 v[56:59], v[84:87], v[200:203], v[56:59]
    s_waitcnt lgkmcnt(2)
    v_mfma_f32_16x16x32_bf16 v[60:63], v[88:91], v[196:199], v[60:63]
    v_mfma_f32_16x16x32_bf16 v[64:67], v[88:91], v[200:203], v[64:67]
    s_waitcnt lgkmcnt(1)
    v_mfma_f32_16x16x32_bf16 v[68:71], v[92:95], v[196:199], v[68:71]
    v_mfma_f32_16x16x32_bf16 v[72:75], v[92:95], v[200:203], v[72:75]
    s_waitcnt lgkmcnt(0)
    v_mfma_f32_16x16x32_bf16 v[76:79], v[96:99], v[196:199], v[76:79]
    v_mfma_f32_16x16x32_bf16 v[80:83], v[96:99], v[200:203], v[80:83]
    s_branch fz_chk
fz_roleB:
    s_and_b32 s20, s2, 7
    s_lshl_b32 s20, s20, 3
    s_bfe_u32 s21, s2, 0x30003
    s_add_u32 s20, s20, s21
    s_lshr_b32 s21, s2, 6
    v_lshrrev_b32 v31, 2, v8
    v_mul_u32_u24 v28, 49152, v31
    v_and_b32 v32, 3, v8
    v_lshl_add_u32 v28, v32, 4, v28
    v_lshlrev_b32 v29, 3, v31
    s_mul_i32 s22, s21, 3145728
    s_lshl_b32 s23, s20, 6
    s_add_u32 s22, s22, s23
    s_lshl_b32 s24, s21, 9
    v_mov_b32 v24, 0
    v_mov_b32 v25, 0
    v_mov_b32 v26, 0
    v_mov_b32 v27, 0
    v_lshlrev_b32 v33, 3, v8
    s_lshl_b32 s26, s2, 11
    s_add_u32 s26, s26, 0xa00000
    s_sub_u32 s19, s3, 4
    v_mov_b32 v39, 0x20200
    ds_write_b32 v39, v24
    s_waitcnt lgkmcnt(0)
    s_mov_b64 s[8:9], s[60:61]
    s_mov_b64 s[64:65], s[52:53]
    s_mov_b32 s66, 0x800
    s_mov_b32 s67, 0x20000
    s_mov_b64 s[68:69], s[54:55]
    s_mov_b32 s70, 0xc00000
    s_mov_b32 s71, 0x20000
    s_mov_b64 s[4:5], s[38:39]
    s_mov_b32 s6, 0x800000
    s_mov_b32 s7, 0x20000
    buffer_store_dwordx2 v[24:25], v33, s[8:11], s26 offen sc1
    buffer_load_dwordx2 v[60:61], v29, s[64:67], s24 offen
    s_add_u32 s25, s22, 0
    buffer_load_dwordx4 v[44:47], v28, s[68:71], s25 offen
    s_add_u32 s25, s22, 12288
    buffer_load_dwordx4 v[48:51], v28, s[68:71], s25 offen
    s_add_u32 s25, s22, 24576
    buffer_load_dwordx4 v[52:55], v28, s[68:71], s25 offen
    s_add_u32 s25, s22, 36864
    buffer_load_dwordx4 v[56:59], v28, s[68:71], s25 offen
    s_mov_b32 s27, 0x570000
    buffer_load_dword v20, v24, s[8:11], s27 offen sc1
    s_cmp_lg_u32 s3, 4
    s_cbranch_scc1 fz_ncp
    s_getpc_b64 s[22:23]
fz_pc:
    s_add_u32 s22, s22, fz_start-fz_pc
    s_addc_u32 s23, s23, -1
    s_lshr_b32 s24, s2, 3
    s_lshl_b32 s24, s24, 12
    v_lshl_add_u32 v35, v0, 7, s24
    v_min_u32 v35, fz_end-fz_start, v35
    s_mov_b64 exec, 0xffffffff
    global_load_dword v7, v35, s[22:23]
    s_mov_b64 exec, -1
fz_ncp:
    s_barrier
    v_lshrrev_b32 v34, 4, v0
    s_waitcnt vmcnt(5)
    v_lshlrev_b32 v62, 16, v61
    v_and_b32 v63, 0xffff0000, v61
    v_and_b32 v61, 0xffff0000, v60
    v_lshlrev_b32 v60, 16, v60
    v_mul_f32 v72, 0xbfb8aa3b, v60
    v_exp_f32 v72, v72
    s_nop 0
    v_add_f32 v72, 1.0, v72
    v_rcp_f32 v72, v72
    s_nop 0
    v_mul_f32 v60, v60, v72
    v_mul_f32 v73, 0xbfb8aa3b, v61
    v_exp_f32 v73, v73
    s_nop 0
    v_add_f32 v73, 1.0, v73
    v_rcp_f32 v73, v73
    s_nop 0
    v_mul_f32 v61, v61, v73
    v_mul_f32 v74, 0xbfb8aa3b, v62
    v_exp_f32 v74, v74
    s_nop 0
    v_add_f32 v74, 1.0, v74
    v_rcp_f32 v74, v74
    s_nop 0
    v_mul_f32 v62, v62, v74
    v_mul_f32 v75, 0xbfb8aa3b, v63
    v_exp_f32 v75, v75
    s_nop 0
    v_add_f32 v75, 1.0, v75
    v_rcp_f32 v75, v75
    s_nop 0
    v_mul_f32 v63, v63, v75
    v_cvt_pk_bf16_f32 v72, v60, v61
    v_lshlrev_b32 v60, 16, v72
    v_and_b32 v61, 0xffff0000, v72
    v_cvt_pk_bf16_f32 v73, v62, v63
    v_lshlrev_b32 v62, 16, v73
    v_and_b32 v63, 0xffff0000, v73
    s_waitcnt vmcnt(4)
    v_lshlrev_b32 v72, 16, v44
    v_and_b32 v73, 0xffff0000, v44
    v_lshlrev_b32 v74, 16, v45
    v_and_b32 v75, 0xffff0000, v45
    v_lshlrev_b32 v76, 16, v46
    v_and_b32 v77, 0xffff0000, v46
    v_lshlrev_b32 v78, 16, v47
    v_and_b32 v79, 0xffff0000, v47
    v_mul_f32 v64, v60, v72
    v_mul_f32 v65, v60, v73
    v_mul_f32 v66, v60, v74
    v_mul_f32 v67, v60, v75
    v_mul_f32 v68, v60, v76
    v_mul_f32 v69, v60, v77
    v_mul_f32 v70, v60, v78
    v_mul_f32 v71, v60, v79
    s_waitcnt vmcnt(3)
    v_lshlrev_b32 v72, 16, v48
    v_and_b32 v73, 0xffff0000, v48
    v_lshlrev_b32 v74, 16, v49
    v_and_b32 v75, 0xffff0000, v49
    v_lshlrev_b32 v76, 16, v50
    v_and_b32 v77, 0xffff0000, v50
    v_lshlrev_b32 v78, 16, v51
    v_and_b32 v79, 0xffff0000, v51
    v_fmac_f32 v64, v61, v72
    v_fmac_f32 v65, v61, v73
    v_fmac_f32 v66, v61, v74
    v_fmac_f32 v67, v61, v75
    v_fmac_f32 v68, v61, v76
    v_fmac_f32 v69, v61, v77
    v_fmac_f32 v70, v61, v78
    v_fmac_f32 v71, v61, v79
    s_waitcnt vmcnt(2)
    v_lshlrev_b32 v72, 16, v52
    v_and_b32 v73, 0xffff0000, v52
    v_lshlrev_b32 v74, 16, v53
    v_and_b32 v75, 0xffff0000, v53
    v_lshlrev_b32 v76, 16, v54
    v_and_b32 v77, 0xffff0000, v54
    v_lshlrev_b32 v78, 16, v55
    v_and_b32 v79, 0xffff0000, v55
    v_fmac_f32 v64, v62, v72
    v_fmac_f32 v65, v62, v73
    v_fmac_f32 v66, v62, v74
    v_fmac_f32 v67, v62, v75
    v_fmac_f32 v68, v62, v76
    v_fmac_f32 v69, v62, v77
    v_fmac_f32 v70, v62, v78
    v_fmac_f32 v71, v62, v79
    s_waitcnt vmcnt(1)
    v_lshlrev_b32 v72, 16, v56
    v_and_b32 v73, 0xffff0000, v56
    v_lshlrev_b32 v74, 16, v57
    v_and_b32 v75, 0xffff0000, v57
    v_lshlrev_b32 v76, 16, v58
    v_and_b32 v77, 0xffff0000, v58
    v_lshlrev_b32 v78, 16, v59
    v_and_b32 v79, 0xffff0000, v59
    v_fmac_f32 v64, v63, v72
    v_fmac_f32 v65, v63, v73
    v_fmac_f32 v66, v63, v74
    v_fmac_f32 v67, v63, v75
    v_fmac_f32 v68, v63, v76
    v_fmac_f32 v69, v63, v77
    v_fmac_f32 v70, v63, v78
    v_fmac_f32 v71, v63, v79
    v_permlane32_swap_b32 v64, v68
    v_permlane32_swap_b32 v65, v69
    v_permlane32_swap_b32 v66, v70
    v_permlane32_swap_b32 v67, v71
    v_add_f32 v64, v64, v68
    v_add_f32 v65, v65, v69
    v_add_f32 v66, v66, v70
    v_add_f32 v67, v67, v71
    s_nop 0
    v_permlane16_swap_b32 v64, v66
    v_permlane16_swap_b32 v65, v67
    v_add_f32 v64, v64, v66
    v_add_f32 v65, v65, v67
    s_nop 0
    v_add_f32_dpp v64, v64, v64 row_ror:8 row_mask:0xf bank_mask:0xf
    v_add_f32_dpp v65, v65, v65 row_ror:8 row_mask:0xf bank_mask:0xf
    s_nop 0
    v_add_f32_dpp v64, v64, v64 row_ror:4 row_mask:0xf bank_mask:0xf
    v_add_f32_dpp v65, v65, v65 row_ror:4 row_mask:0xf bank_mask:0xf
    v_lshlrev_b32 v36, 5, v32
    v_lshl_add_u32 v36, v34, 3, v36
    s_lshl_b32 s26, s19, 7
    s_add_u32 s26, s26, 0x20000
    v_add_u32 v36, s26, v36
    ds_write_b64 v36, v[64:65]
    v_mov_b32 v40, 1
    s_mov_b64 exec, 1
    ds_add_rtn_u32 v40, v39, v40
    s_mov_b64 exec, -1
    s_waitcnt vmcnt(0)
    v_readfirstlane_b32 s14, v20
    s_add_u32 s14, s14, 1
    v_add_u32 v37, 0x20000, v1
    s_waitcnt lgkmcnt(0)
    v_readfirstlane_b32 s26, v40
    s_cmp_lg_u32 s26, 3
    s_cbranch_scc1 fz_np
    ds_read_b128 v[80:83], v37 offset:0
    ds_read_b128 v[84:87], v37 offset:128
    ds_read_b128 v[88:91], v37 offset:256
    ds_read_b128 v[92:95], v37 offset:384
    v_mov_b32 v30, 0xff
    s_lshl_b32 s26, s21, 13
    s_lshl_b32 s27, s20, 7
    s_add_u32 s26, s26, s27
    s_add_u32 s26, s26, 0x500000
    s_waitcnt lgkmcnt(2)
    v_pk_add_f32 v[80:81], v[80:81], v[84:85]
    v_pk_add_f32 v[82:83], v[82:83], v[86:87]
    s_waitcnt lgkmcnt(0)
    v_pk_add_f32 v[88:89], v[88:89], v[92:93]
    v_pk_add_f32 v[90:91], v[90:91], v[94:95]
    v_pk_add_f32 v[80:81], v[80:81], v[88:89]
    v_pk_add_f32 v[82:83], v[82:83], v[90:91]
    v_bfi_b32 v80, v30, s14, v80
    s_lshr_b32 s27, s14, 8
    v_bfi_b32 v81, v30, s27, v81
    s_lshr_b32 s27, s14, 16
    v_bfi_b32 v82, v30, s27, v82
    s_lshr_b32 s27, s14, 24
    v_bfi_b32 v83, v30, s27, v83
    s_mov_b64 exec, 0xff
    buffer_store_dwordx4 v[80:83], v1, s[8:11], s26 offen sc1
    s_mov_b64 exec, -1
    s_waitcnt vmcnt(0)
fz_np:
    s_waitcnt vmcnt(0)
    s_barrier
    v_lshlrev_b32 v38, 4, v8
    s_mov_b32 s24, 0x0c0c0400
    s_mov_b32 s25, 0x04000c0c
    s_mov_b32 s27, 0
fz_gp:
    s_mov_b32 s21, 0x500000
    buffer_load_dwordx4 v[96:99], v38, s[8:11], s21 offen sc1
    s_mov_b32 s21, 0x501000
    buffer_load_dwordx4 v[100:103], v38, s[8:11], s21 offen sc1
    s_mov_b32 s21, 0x502000
    buffer_load_dwordx4 v[104:107], v38, s[8:11], s21 offen sc1
    s_mov_b32 s21, 0x503000
    buffer_load_dwordx4 v[108:111], v38, s[8:11], s21 offen sc1
    s_mov_b32 s21, 0x504000
    buffer_load_dwordx4 v[112:115], v38, s[8:11], s21 offen sc1
    s_mov_b32 s21, 0x505000
    buffer_load_dwordx4 v[116:119], v38, s[8:11], s21 offen sc1
    s_mov_b32 s21, 0x506000
    buffer_load_dwordx4 v[120:123], v38, s[8:11], s21 offen sc1
    s_mov_b32 s21, 0x507000
    buffer_load_dwordx4 v[124:127], v38, s[8:11], s21 offen sc1
    s_waitcnt vmcnt(7)
    v_perm_b32 v36, v97, v96, s24
    v_perm_b32 v37, v99, v98, s25
    v_or_b32 v36, v36, v37
    v_xor_b32 v35, s14, v36
    s_waitcnt vmcnt(6)
    v_perm_b32 v36, v101, v100, s24
    v_perm_b32 v37, v103, v102, s25
    v_or_b32 v36, v36, v37
    v_xor_b32 v36, s14, v36
    v_or_b32 v35, v35, v36
    s_waitcnt vmcnt(5)
    v_perm_b32 v36, v105, v104, s24
    v_perm_b32 v37, v107, v106, s25
    v_or_b32 v36, v36, v37
    v_xor_b32 v36, s14, v36
    v_or_b32 v35, v35, v36
    s_waitcnt vmcnt(4)
    v_perm_b32 v36, v109, v108, s24
    v_perm_b32 v37, v111, v110, s25
    v_or_b32 v36, v36, v37
    v_xor_b32 v36, s14, v36
    v_or_b32 v35, v35, v36
    s_waitcnt vmcnt(3)
    v_perm_b32 v36, v113, v112, s24
    v_perm_b32 v37, v115, v114, s25
    v_or_b32 v36, v36, v37
    v_xor_b32 v36, s14, v36
    v_or_b32 v35, v35, v36
    s_waitcnt vmcnt(2)
    v_perm_b32 v36, v117, v116, s24
    v_perm_b32 v37, v119, v118, s25
    v_or_b32 v36, v36, v37
    v_xor_b32 v36, s14, v36
    v_or_b32 v35, v35, v36
    s_waitcnt vmcnt(1)
    v_perm_b32 v36, v121, v120, s24
    v_perm_b32 v37, v123, v122, s25
    v_or_b32 v36, v36, v37
    v_xor_b32 v36, s14, v36
    v_or_b32 v35, v35, v36
    s_waitcnt vmcnt(0)
    v_perm_b32 v36, v125, v124, s24
    v_perm_b32 v37, v127, v126, s25
    v_or_b32 v36, v36, v37
    v_xor_b32 v36, s14, v36
    v_or_b32 v35, v35, v36
    v_cmp_ne_u32 vcc, 0, v35
    s_add_u32 s27, s27, 1
    s_cmp_ge_u32 s27, 65536
    s_cbranch_scc1 fz_gg
    s_cbranch_vccz fz_gg
    s_sleep 1
    s_branch fz_gp
fz_gg:
    v_and_b32 v96, 0xffffff00, v96
    v_and_b32 v97, 0xffffff00, v97
    v_and_b32 v98, 0xffffff00, v98
    v_and_b32 v99, 0xffffff00, v99
    v_and_b32 v100, 0xffffff00, v100
    v_and_b32 v101, 0xffffff00, v101
    v_and_b32 v102, 0xffffff00, v102
    v_and_b32 v103, 0xffffff00, v103
    v_and_b32 v104, 0xffffff00, v104
    v_and_b32 v105, 0xffffff00, v105
    v_and_b32 v106, 0xffffff00, v106
    v_and_b32 v107, 0xffffff00, v107
    v_and_b32 v108, 0xffffff00, v108
    v_and_b32 v109, 0xffffff00, v109
    v_and_b32 v110, 0xffffff00, v110
    v_and_b32 v111, 0xffffff00, v111
    v_and_b32 v112, 0xffffff00, v112
    v_and_b32 v113, 0xffffff00, v113
    v_and_b32 v114, 0xffffff00, v114
    v_and_b32 v115, 0xffffff00, v115
    v_and_b32 v116, 0xffffff00, v116
    v_and_b32 v117, 0xffffff00, v117
    v_and_b32 v118, 0xffffff00, v118
    v_and_b32 v119, 0xffffff00, v119
    v_and_b32 v120, 0xffffff00, v120
    v_and_b32 v121, 0xffffff00, v121
    v_and_b32 v122, 0xffffff00, v122
    v_and_b32 v123, 0xffffff00, v123
    v_and_b32 v124, 0xffffff00, v124
    v_and_b32 v125, 0xffffff00, v125
    v_and_b32 v126, 0xffffff00, v126
    v_and_b32 v127, 0xffffff00, v127
    v_pk_add_f32 v[96:97], v[96:97], v[112:113]
    v_pk_add_f32 v[98:99], v[98:99], v[114:115]
    v_pk_add_f32 v[100:101], v[100:101], v[116:117]
    v_pk_add_f32 v[102:103], v[102:103], v[118:119]
    v_pk_add_f32 v[104:105], v[104:105], v[120:121]
    v_pk_add_f32 v[106:107], v[106:107], v[122:123]
    v_pk_add_f32 v[108:109], v[108:109], v[124:125]
    v_pk_add_f32 v[110:111], v[110:111], v[126:127]
    v_pk_add_f32 v[96:97], v[96:97], v[104:105]
    v_pk_add_f32 v[98:99], v[98:99], v[106:107]
    v_pk_add_f32 v[100:101], v[100:101], v[108:109]
    v_pk_add_f32 v[102:103], v[102:103], v[110:111]
    v_cvt_pk_bf16_f32 v31, v96, v97
    v_lshlrev_b32 v96, 16, v31
    v_and_b32 v97, 0xffff0000, v31
    v_cvt_pk_bf16_f32 v31, v98, v99
    v_lshlrev_b32 v98, 16, v31
    v_and_b32 v99, 0xffff0000, v31
    v_cvt_pk_bf16_f32 v31, v100, v101
    v_lshlrev_b32 v100, 16, v31
    v_and_b32 v101, 0xffff0000, v31
    v_cvt_pk_bf16_f32 v31, v102, v103
    v_lshlrev_b32 v102, 16, v31
    v_and_b32 v103, 0xffff0000, v31
    v_add_f32 v100, 1.0, v100
    v_add_f32 v101, 1.0, v101
    v_add_f32 v102, 1.0, v102
    v_add_f32 v103, 1.0, v103
    v_cvt_pk_bf16_f32 v31, v100, v101
    v_lshlrev_b32 v100, 16, v31
    v_and_b32 v101, 0xffff0000, v31
    v_cvt_pk_bf16_f32 v31, v102, v103
    v_lshlrev_b32 v102, 16, v31
    v_and_b32 v103, 0xffff0000, v31
    v_add_u32 v38, 0x21000, v38
    ds_write_b128 v38, v[96:99]
    ds_write_b128 v38, v[100:103] offset:4096
    s_waitcnt lgkmcnt(0)
    s_barrier
    s_barrier
    s_lshl_b32 s26, s13, 5
    s_lshl_b32 s25, s3, 2
    s_add_u32 s26, s26, s25
    v_bfe_u32 v9, v0, 2, 2
    v_lshlrev_b32 v9, 7, v9
    v_and_b32 v10, 3, v0
    v_lshl_add_u32 v9, v10, 2, v9
    s_lshl_b32 s26, s26, 7
    s_add_u32 s26, s26, 0x510000
    s_mov_b32 s27, 0
fz_hBp:
    buffer_load_dword v10, v9, s[8:11], s26 offen sc1
    s_waitcnt vmcnt(0)
    v_cmp_ne_u32 vcc, s14, v10
    s_add_u32 s27, s27, 1
    s_cmp_ge_u32 s27, 65536
    s_cbranch_scc1 fz_hBg
    s_cbranch_vccz fz_hBg
    s_sleep 4
    s_branch fz_hBp
fz_hBg:
    s_mov_b32 s23, 0x0
    buffer_load_dwordx4 v[204:207], v4, s[8:11], s23 offen offset:0 sc1
    s_mov_b32 s23, 0x8000
    buffer_load_dwordx4 v[208:211], v4, s[8:11], s23 offen offset:0 sc1
    s_mov_b32 s23, 0x0
    buffer_load_dwordx4 v[212:215], v4, s[8:11], s23 offen offset:1024 sc1
    s_mov_b32 s23, 0x8000
    buffer_load_dwordx4 v[216:219], v4, s[8:11], s23 offen offset:1024 sc1
    s_barrier
    ds_read_b64_tr_b16 v[84:85], v3 offset:0
    ds_read_b64_tr_b16 v[86:87], v3 offset:1024
    ds_read_b64_tr_b16 v[88:89], v15 offset:32
    ds_read_b64_tr_b16 v[90:91], v15 offset:1056
    ds_read_b64_tr_b16 v[92:93], v3 offset:256
    ds_read_b64_tr_b16 v[94:95], v3 offset:1280
    ds_read_b64_tr_b16 v[96:97], v15 offset:288
    ds_read_b64_tr_b16 v[98:99], v15 offset:1312
    s_waitcnt vmcnt(3) lgkmcnt(6)
    v_mfma_f32_16x16x32_bf16 v[20:23], v[84:87], v[204:207], 0
    s_mov_b32 s23, 0x800
    buffer_load_dwordx4 v[220:223], v4, s[8:11], s23 offen offset:0 sc1
    ds_read_b64_tr_b16 v[100:101], v3 offset:512
    s_sub_u32 s26, s3, 4
    s_lshl_b32 s26, s26, 3
    v_add_u32 v17, s26, v0
    v_lshrrev_b32 v18, 4, v17
    v_lshlrev_b32 v18, 13, v18
    v_and_b32 v17, 15, v17
    v_lshl_add_u32 v17, v17, 7, v18
    s_lshr_b32 s26, s2, 3
    s_lshl_b32 s26, s26, 14
    s_and_b32 s27, s2, 3
    s_lshl_b32 s27, s27, 11
    s_add_u32 s26, s26, s27
    v_add_u32 v17, s26, v17
    v_cmp_gt_u32 vcc, 8, v0
    v_bfrev_b32 v18, -2
    s_nop 0
    v_cndmask_b32 v17, v18, v17, vcc
    s_mov_b64 s[68:69], s[38:39]
    s_mov_b32 s70, 0x800000
    s_mov_b32 s71, 0x20000
    s_waitcnt vmcnt(3)
    v_mfma_f32_16x16x32_bf16 v[24:27], v[84:87], v[208:211], 0
    ds_read_b64_tr_b16 v[102:103], v3 offset:1536
    s_mov_b32 s26, 0x180000
    buffer_load_dword v18, v17, s[68:71], s26 offen
    s_waitcnt lgkmcnt(6)
    v_mfma_f32_16x16x32_bf16 v[28:31], v[88:91], v[204:207], 0
    s_mov_b32 s23, 0x8800
    buffer_load_dwordx4 v[224:227], v4, s[8:11], s23 offen offset:0 sc1
    ds_read_b64_tr_b16 v[104:105], v15 offset:544
    v_mfma_f32_16x16x32_bf16 v[32:35], v[88:91], v[208:211], 0
    ds_read_b64_tr_b16 v[106:107], v15 offset:1568
    s_mov_b32 s23, 0x1000
    buffer_load_dwordx4 v[140:143], v4, s[8:11], s23 offen offset:0 sc1
    s_waitcnt lgkmcnt(6)
    v_mfma_f32_16x16x32_bf16 v[36:39], v[92:95], v[204:207], 0
    s_mov_b32 s23, 0x800
    buffer_load_dwordx4 v[228:231], v4, s[8:11], s23 offen offset:1024 sc1
    ds_read_b64_tr_b16 v[84:85], v3 offset:768
    v_mfma_f32_16x16x32_bf16 v[40:43], v[92:95], v[208:211], 0
    ds_read_b64_tr_b16 v[86:87], v3 offset:1792
    s_waitcnt lgkmcnt(6)
    v_mfma_f32_16x16x32_bf16 v[44:47], v[96:99], v[204:207], 0
    s_mov_b32 s23, 0x8800
    buffer_load_dwordx4 v[232:235], v4, s[8:11], s23 offen offset:1024 sc1
    ds_read_b64_tr_b16 v[88:89], v15 offset:800
    v_mfma_f32_16x16x32_bf16 v[48:51], v[96:99], v[208:211], 0
    ds_read_b64_tr_b16 v[90:91], v15 offset:1824
    s_mov_b32 s26, 0x200000
    buffer_load_dword v18, v17, s[68:71], s26 offen
    s_waitcnt lgkmcnt(6)
    v_mfma_f32_16x16x32_bf16 v[52:55], v[100:103], v[204:207], 0
    ds_read_b64_tr_b16 v[92:93], v3 offset:8192
    v_mfma_f32_16x16x32_bf16 v[56:59], v[100:103], v[208:211], 0
    ds_read_b64_tr_b16 v[94:95], v3 offset:9216
    s_waitcnt lgkmcnt(6)
    v_mfma_f32_16x16x32_bf16 v[60:63], v[104:107], v[204:207], 0
    ds_read_b64_tr_b16 v[96:97], v15 offset:8224
    v_mfma_f32_16x16x32_bf16 v[64:67], v[104:107], v[208:211], 0
    ds_read_b64_tr_b16 v[98:99], v15 offset:9248
    s_mov_b32 s23, 0x9000
    buffer_load_dwordx4 v[144:147], v4, s[8:11], s23 offen offset:0 sc1
    s_waitcnt lgkmcnt(6)
    v_mfma_f32_16x16x32_bf16 v[68:71], v[84:87], v[204:207], 0
    ds_read_b64_tr_b16 v[100:101], v3 offset:8448
    v_mfma_f32_16x16x32_bf16 v[72:75], v[84:87], v[208:211], 0
    ds_read_b64_tr_b16 v[102:103], v3 offset:9472
    s_waitcnt lgkmcnt(6)
    v_mfma_f32_16x16x32_bf16 v[76:79], v[88:91], v[204:207], 0
    ds_read_b64_tr_b16 v[104:105], v15 offset:8480
    v_mfma_f32_16x16x32_bf16 v[80:83], v[88:91], v[208:211], 0
    ds_read_b64_tr_b16 v[106:107], v15 offset:9504
    s_waitcnt vmcnt(9) lgkmcnt(6)
    v_mfma_f32_16x16x32_bf16 v[20:23], v[92:95], v[212:215], v[20:23]
    ds_read_b64_tr_b16 v[84:85], v3 offset:8704
    s_waitcnt vmcnt(8)
    v_mfma_f32_16x16x32_bf16 v[24:27], v[92:95], v[216:219], v[24:27]
    ds_read_b64_tr_b16 v[86:87], v3 offset:9728
    s_waitcnt lgkmcnt(6)
    v_mfma_f32_16x16x32_bf16 v[28:31], v[96:99], v[212:215], v[28:31]
    ds_read_b64_tr_b16 v[88:89], v15 offset:8736
    v_mfma_f32_16x16x32_bf16 v[32:35], v[96:99], v[216:219], v[32:35]
    ds_read_b64_tr_b16 v[90:91], v15 offset:9760
    s_mov_b32 s23, 0x1000
    buffer_load_dwordx4 v[148:151], v4, s[8:11], s23 offen offset:1024 sc1
    s_waitcnt lgkmcnt(6)
    v_mfma_f32_16x16x32_bf16 v[36:39], v[100:103], v[212:215], v[36:39]
    ds_read_b64_tr_b16 v[92:93], v3 offset:8960
    v_mfma_f32_16x16x32_bf16 v[40:43], v[100:103], v[216:219], v[40:43]
    ds_read_b64_tr_b16 v[94:95], v3 offset:9984
    s_waitcnt lgkmcnt(6)
    v_mfma_f32_16x16x32_bf16 v[44:47], v[104:107], v[212:215], v[44:47]
    ds_read_b64_tr_b16 v[96:97], v15 offset:8992
    v_mfma_f32_16x16x32_bf16 v[48:51], v[104:107], v[216:219], v[48:51]
    ds_read_b64_tr_b16 v[98:99], v15 offset:10016
    s_waitcnt lgkmcnt(6)
    v_mfma_f32_16x16x32_bf16 v[52:55], v[84:87], v[212:215], v[52:55]
    v_mfma_f32_16x16x32_bf16 v[56:59], v[84:87], v[216:219], v[56:59]
    s_barrier
    ds_read_b64_tr_b16 v[100:101], v3 offset:16384
    ds_read_b64_tr_b16 v[102:103], v3 offset:17408
    s_waitcnt lgkmcnt(6)
    v_mfma_f32_16x16x32_bf16 v[60:63], v[88:91], v[212:215], v[60:63]
    ds_read_b64_tr_b16 v[104:105], v15 offset:16416
    v_mfma_f32_16x16x32_bf16 v[64:67], v[88:91], v[216:219], v[64:67]
    ds_read_b64_tr_b16 v[106:107], v15 offset:17440
    s_mov_b32 s23, 0x9000
    buffer_load_dwordx4 v[152:155], v4, s[8:11], s23 offen offset:1024 sc1
    s_waitcnt lgkmcnt(6)
    v_mfma_f32_16x16x32_bf16 v[68:71], v[92:95], v[212:215], v[68:71]
    ds_read_b64_tr_b16 v[84:85], v3 offset:16640
    v_mfma_f32_16x16x32_bf16 v[72:75], v[92:95], v[216:219], v[72:75]
    ds_read_b64_tr_b16 v[86:87], v3 offset:17664
    s_waitcnt lgkmcnt(6)
    v_mfma_f32_16x16x32_bf16 v[76:79], v[96:99], v[212:215], v[76:79]
    ds_read_b64_tr_b16 v[88:89], v15 offset:16672
    v_mfma_f32_16x16x32_bf16 v[80:83], v[96:99], v[216:219], v[80:83]
    ds_read_b64_tr_b16 v[90:91], v15 offset:17696
    s_waitcnt vmcnt(9) lgkmcnt(6)
    v_mfma_f32_16x16x32_bf16 v[20:23], v[100:103], v[220:223], v[20:23]
    ds_read_b64_tr_b16 v[92:93], v3 offset:16896
    s_waitcnt vmcnt(7)
    v_mfma_f32_16x16x32_bf16 v[24:27], v[100:103], v[224:227], v[24:27]
    ds_read_b64_tr_b16 v[94:95], v3 offset:17920
    s_sub_u32 s19, s3, 4
    s_lshl_b32 s25, s2, 2
    s_add_u32 s63, s25, s19
    s_lshr_b32 s20, s63, 8
    s_bfe_u32 s21, s63, 0x40004
    s_and_b32 s24, s63, 15
    s_lshl_b32 s20, s20, 19
    s_lshl_b32 s21, s21, 13
    s_add_u32 s20, s20, s21
    s_add_u32 s20, s20, 393216
    v_and_b32 v168, 15, v0
    v_lshrrev_b32 v169, 4, v0
    s_mov_b64 s[28:29], s[34:35]
    s_mov_b32 s30, 0x200000
    s_mov_b32 s31, 0x20000
    s_cmp_lt_u32 s24, 8
    s_cselect_b32 s30, s30, 0
    v_lshlrev_b32 v170, 8, v168
    v_lshl_add_u32 v170, v169, 3, v170
    s_and_b32 s26, s24, 1
    s_lshl_b32 s26, s26, 12
    s_add_u32 s21, s20, s26
    s_bfe_u32 s26, s24, 0x20001
    s_lshl_b32 s26, s26, 6
    s_add_u32 s21, s21, s26
    buffer_load_dwordx2 v[156:157], v170, s[28:31], s21 offen
    buffer_load_dwordx2 v[158:159], v170, s[28:31], s21 offen offset:32
    s_mov_b64 s[64:65], s[36:37]
    s_mov_b32 s66, 0x200000
    s_mov_b32 s67, 0x20000
    s_cmp_ge_u32 s24, 8
    s_cselect_b32 s66, s66, 0
    s_and_b32 s26, s24, 7
    s_lshl_b32 s26, s26, 5
    s_add_u32 s20, s20, s26
    s_add_u32 s26, s20, 4096
    v_lshlrev_b32 v171, 10, v169
    v_lshl_add_u32 v171, v168, 1, v171
    buffer_load_ushort v160, v171, s[64:67], s20 offen offset:0
    buffer_load_ushort v161, v171, s[64:67], s20 offen offset:256
    buffer_load_ushort v162, v171, s[64:67], s20 offen offset:512
    buffer_load_ushort v163, v171, s[64:67], s20 offen offset:768
    buffer_load_ushort v164, v171, s[64:67], s26 offen offset:0
    buffer_load_ushort v165, v171, s[64:67], s26 offen offset:256
    buffer_load_ushort v166, v171, s[64:67], s26 offen offset:512
    buffer_load_ushort v167, v171, s[64:67], s26 offen offset:768
    s_waitcnt lgkmcnt(6)
    v_mfma_f32_16x16x32_bf16 v[28:31], v[104:107], v[220:223], v[28:31]
    ds_read_b64_tr_b16 v[96:97], v15 offset:16928
    v_mfma_f32_16x16x32_bf16 v[32:35], v[104:107], v[224:227], v[32:35]
    ds_read_b64_tr_b16 v[98:99], v15 offset:17952
    s_mov_b32 s23, 0x1800
    buffer_load_dwordx4 v[204:207], v4, s[8:11], s23 offen offset:0 sc1
    s_waitcnt lgkmcnt(6)
    v_mfma_f32_16x16x32_bf16 v[36:39], v[84:87], v[220:223], v[36:39]
    ds_read_b64_tr_b16 v[100:101], v3 offset:17152
    v_mfma_f32_16x16x32_bf16 v[40:43], v[84:87], v[224:227], v[40:43]
    ds_read_b64_tr_b16 v[102:103], v3 offset:18176
    s_waitcnt lgkmcnt(6)
    v_mfma_f32_16x16x32_bf16 v[44:47], v[88:91], v[220:223], v[44:47]
    ds_read_b64_tr_b16 v[104:105], v15 offset:17184
    v_mfma_f32_16x16x32_bf16 v[48:51], v[88:91], v[224:227], v[48:51]
    ds_read_b64_tr_b16 v[106:107], v15 offset:18208
    s_mov_b32 s26, 0x280000
    buffer_load_dword v18, v17, s[68:71], s26 offen
    s_waitcnt lgkmcnt(6)
    v_mfma_f32_16x16x32_bf16 v[52:55], v[92:95], v[220:223], v[52:55]
    ds_read_b64_tr_b16 v[84:85], v3 offset:24576
    v_mfma_f32_16x16x32_bf16 v[56:59], v[92:95], v[224:227], v[56:59]
    ds_read_b64_tr_b16 v[86:87], v3 offset:25600
    s_waitcnt lgkmcnt(6)
    v_mfma_f32_16x16x32_bf16 v[60:63], v[96:99], v[220:223], v[60:63]
    ds_read_b64_tr_b16 v[88:89], v15 offset:24608
    v_mfma_f32_16x16x32_bf16 v[64:67], v[96:99], v[224:227], v[64:67]
    ds_read_b64_tr_b16 v[90:91], v15 offset:25632
    s_mov_b32 s23, 0x9800
    buffer_load_dwordx4 v[208:211], v4, s[8:11], s23 offen offset:0 sc1
    s_waitcnt lgkmcnt(6)
    v_mfma_f32_16x16x32_bf16 v[68:71], v[100:103], v[220:223], v[68:71]
    ds_read_b64_tr_b16 v[92:93], v3 offset:24832
    v_mfma_f32_16x16x32_bf16 v[72:75], v[100:103], v[224:227], v[72:75]
    ds_read_b64_tr_b16 v[94:95], v3 offset:25856
    s_waitcnt lgkmcnt(6)
    v_mfma_f32_16x16x32_bf16 v[76:79], v[104:107], v[220:223], v[76:79]
    ds_read_b64_tr_b16 v[96:97], v15 offset:24864
    v_mfma_f32_16x16x32_bf16 v[80:83], v[104:107], v[224:227], v[80:83]
    ds_read_b64_tr_b16 v[98:99], v15 offset:25888
    s_waitcnt vmcnt(18) lgkmcnt(6)
    v_mfma_f32_16x16x32_bf16 v[20:23], v[84:87], v[228:231], v[20:23]
    ds_read_b64_tr_b16 v[100:101], v3 offset:25088
    s_waitcnt vmcnt(17)
    v_mfma_f32_16x16x32_bf16 v[24:27], v[84:87], v[232:235], v[24:27]
    ds_read_b64_tr_b16 v[102:103], v3 offset:26112
    s_waitcnt lgkmcnt(6)
    v_mfma_f32_16x16x32_bf16 v[28:31], v[88:91], v[228:231], v[28:31]
    ds_read_b64_tr_b16 v[104:105], v15 offset:25120
    v_mfma_f32_16x16x32_bf16 v[32:35], v[88:91], v[232:235], v[32:35]
    ds_read_b64_tr_b16 v[106:107], v15 offset:26144
    s_mov_b32 s23, 0x1800
    buffer_load_dwordx4 v[212:215], v4, s[8:11], s23 offen offset:1024 sc1
    s_waitcnt lgkmcnt(6)
    v_mfma_f32_16x16x32_bf16 v[36:39], v[92:95], v[228:231], v[36:39]
    ds_read_b64_tr_b16 v[84:85], v3 offset:25344
    v_mfma_f32_16x16x32_bf16 v[40:43], v[92:95], v[232:235], v[40:43]
    ds_read_b64_tr_b16 v[86:87], v3 offset:26368
    s_waitcnt lgkmcnt(6)
    v_mfma_f32_16x16x32_bf16 v[44:47], v[96:99], v[228:231], v[44:47]
    ds_read_b64_tr_b16 v[88:89], v15 offset:25376
    v_mfma_f32_16x16x32_bf16 v[48:51], v[96:99], v[232:235], v[48:51]
    ds_read_b64_tr_b16 v[90:91], v15 offset:26400
    s_waitcnt lgkmcnt(6)
    v_mfma_f32_16x16x32_bf16 v[52:55], v[100:103], v[228:231], v[52:55]
    v_mfma_f32_16x16x32_bf16 v[56:59], v[100:103], v[232:235], v[56:59]
    s_barrier
    ds_read_b64_tr_b16 v[92:93], v3 offset:32768
    ds_read_b64_tr_b16 v[94:95], v3 offset:33792
    s_waitcnt lgkmcnt(6)
    v_mfma_f32_16x16x32_bf16 v[60:63], v[104:107], v[228:231], v[60:63]
    ds_read_b64_tr_b16 v[96:97], v15 offset:32800
    v_mfma_f32_16x16x32_bf16 v[64:67], v[104:107], v[232:235], v[64:67]
    ds_read_b64_tr_b16 v[98:99], v15 offset:33824
    s_mov_b32 s23, 0x9800
    buffer_load_dwordx4 v[216:219], v4, s[8:11], s23 offen offset:1024 sc1
    s_waitcnt lgkmcnt(6)
    v_mfma_f32_16x16x32_bf16 v[68:71], v[84:87], v[228:231], v[68:71]
    ds_read_b64_tr_b16 v[100:101], v3 offset:33024
    v_mfma_f32_16x16x32_bf16 v[72:75], v[84:87], v[232:235], v[72:75]
    ds_read_b64_tr_b16 v[102:103], v3 offset:34048
    s_waitcnt lgkmcnt(6)
    v_mfma_f32_16x16x32_bf16 v[76:79], v[88:91], v[228:231], v[76:79]
    ds_read_b64_tr_b16 v[104:105], v15 offset:33056
    v_mfma_f32_16x16x32_bf16 v[80:83], v[88:91], v[232:235], v[80:83]
    ds_read_b64_tr_b16 v[106:107], v15 offset:34080
    s_waitcnt lgkmcnt(6)
    v_mfma_f32_16x16x32_bf16 v[20:23], v[92:95], v[140:143], v[20:23]
    ds_read_b64_tr_b16 v[84:85], v3 offset:33280
    s_waitcnt vmcnt(17)
    v_mfma_f32_16x16x32_bf16 v[24:27], v[92:95], v[144:147], v[24:27]
    ds_read_b64_tr_b16 v[86:87], v3 offset:34304
    s_waitcnt lgkmcnt(6)
    v_mfma_f32_16x16x32_bf16 v[28:31], v[96:99], v[140:143], v[28:31]
    ds_read_b64_tr_b16 v[88:89], v15 offset:33312
    v_mfma_f32_16x16x32_bf16 v[32:35], v[96:99], v[144:147], v[32:35]
    ds_read_b64_tr_b16 v[90:91], v15 offset:34336
    s_mov_b32 s23, 0x2000
    buffer_load_dwordx4 v[220:223], v4, s[8:11], s23 offen offset:0 sc1
    s_waitcnt lgkmcnt(6)
    v_mfma_f32_16x16x32_bf16 v[36:39], v[100:103], v[140:143], v[36:39]
    ds_read_b64_tr_b16 v[92:93], v3 offset:33536
    v_mfma_f32_16x16x32_bf16 v[40:43], v[100:103], v[144:147], v[40:43]
    ds_read_b64_tr_b16 v[94:95], v3 offset:34560
    s_waitcnt lgkmcnt(6)
    v_mfma_f32_16x16x32_bf16 v[44:47], v[104:107], v[140:143], v[44:47]
    ds_read_b64_tr_b16 v[96:97], v15 offset:33568
    v_mfma_f32_16x16x32_bf16 v[48:51], v[104:107], v[144:147], v[48:51]
    ds_read_b64_tr_b16 v[98:99], v15 offset:34592
    s_mov_b32 s26, 0x300000
    buffer_load_dword v18, v17, s[68:71], s26 offen
    s_waitcnt lgkmcnt(6)
    v_mfma_f32_16x16x32_bf16 v[52:55], v[84:87], v[140:143], v[52:55]
    ds_read_b64_tr_b16 v[100:101], v3 offset:40960
    v_mfma_f32_16x16x32_bf16 v[56:59], v[84:87], v[144:147], v[56:59]
    ds_read_b64_tr_b16 v[102:103], v3 offset:41984
    s_waitcnt lgkmcnt(6)
    v_mfma_f32_16x16x32_bf16 v[60:63], v[88:91], v[140:143], v[60:63]
    ds_read_b64_tr_b16 v[104:105], v15 offset:40992
    v_mfma_f32_16x16x32_bf16 v[64:67], v[88:91], v[144:147], v[64:67]
    ds_read_b64_tr_b16 v[106:107], v15 offset:42016
    s_mov_b32 s23, 0xa000
    buffer_load_dwordx4 v[224:227], v4, s[8:11], s23 offen offset:0 sc1
    s_waitcnt lgkmcnt(6)
    v_mfma_f32_16x16x32_bf16 v[68:71], v[92:95], v[140:143], v[68:71]
    ds_read_b64_tr_b16 v[84:85], v3 offset:41216
    v_mfma_f32_16x16x32_bf16 v[72:75], v[92:95], v[144:147], v[72:75]
    ds_read_b64_tr_b16 v[86:87], v3 offset:42240
    s_waitcnt lgkmcnt(6)
    v_mfma_f32_16x16x32_bf16 v[76:79], v[96:99], v[140:143], v[76:79]
    ds_read_b64_tr_b16 v[88:89], v15 offset:41248
    v_mfma_f32_16x16x32_bf16 v[80:83], v[96:99], v[144:147], v[80:83]
    ds_read_b64_tr_b16 v[90:91], v15 offset:42272
    s_waitcnt vmcnt(19) lgkmcnt(6)
    v_mfma_f32_16x16x32_bf16 v[20:23], v[100:103], v[148:151], v[20:23]
    ds_read_b64_tr_b16 v[92:93], v3 offset:41472
    s_waitcnt vmcnt(18)
    v_mfma_f32_16x16x32_bf16 v[24:27], v[100:103], v[152:155], v[24:27]
    ds_read_b64_tr_b16 v[94:95], v3 offset:42496
    s_waitcnt lgkmcnt(6)
    v_mfma_f32_16x16x32_bf16 v[28:31], v[104:107], v[148:151], v[28:31]
    ds_read_b64_tr_b16 v[96:97], v15 offset:41504
    v_mfma_f32_16x16x32_bf16 v[32:35], v[104:107], v[152:155], v[32:35]
    ds_read_b64_tr_b16 v[98:99], v15 offset:42528
    s_mov_b32 s23, 0x2000
    buffer_load_dwordx4 v[228:231], v4, s[8:11], s23 offen offset:1024 sc1
    s_waitcnt lgkmcnt(6)
    v_mfma_f32_16x16x32_bf16 v[36:39], v[84:87], v[148:151], v[36:39]
    ds_read_b64_tr_b16 v[100:101], v3 offset:41728
    v_mfma_f32_16x16x32_bf16 v[40:43], v[84:87], v[152:155], v[40:43]
    ds_read_b64_tr_b16 v[102:103], v3 offset:42752
    s_waitcnt lgkmcnt(6)
    v_mfma_f32_16x16x32_bf16 v[44:47], v[88:91], v[148:151], v[44:47]
    ds_read_b64_tr_b16 v[104:105], v15 offset:41760
    v_mfma_f32_16x16x32_bf16 v[48:51], v[88:91], v[152:155], v[48:51]
    ds_read_b64_tr_b16 v[106:107], v15 offset:42784
    s_waitcnt lgkmcnt(6)
    v_mfma_f32_16x16x32_bf16 v[52:55], v[92:95], v[148:151], v[52:55]
    v_mfma_f32_16x16x32_bf16 v[56:59], v[92:95], v[152:155], v[56:59]
    s_barrier
    ds_read_b64_tr_b16 v[84:85], v3 offset:49152
    ds_read_b64_tr_b16 v[86:87], v3 offset:50176
    s_waitcnt lgkmcnt(6)
    v_mfma_f32_16x16x32_bf16 v[60:63], v[96:99], v[148:151], v[60:63]
    ds_read_b64_tr_b16 v[88:89], v15 offset:49184
    v_mfma_f32_16x16x32_bf16 v[64:67], v[96:99], v[152:155], v[64:67]
    ds_read_b64_tr_b16 v[90:91], v15 offset:50208
    s_mov_b32 s23, 0xa000
    buffer_load_dwordx4 v[232:235], v4, s[8:11], s23 offen offset:1024 sc1
    s_waitcnt lgkmcnt(6)
    v_mfma_f32_16x16x32_bf16 v[68:71], v[100:103], v[148:151], v[68:71]
    ds_read_b64_tr_b16 v[92:93], v3 offset:49408
    v_mfma_f32_16x16x32_bf16 v[72:75], v[100:103], v[152:155], v[72:75]
    ds_read_b64_tr_b16 v[94:95], v3 offset:50432
    s_waitcnt lgkmcnt(6)
    v_mfma_f32_16x16x32_bf16 v[76:79], v[104:107], v[148:151], v[76:79]
    ds_read_b64_tr_b16 v[96:97], v15 offset:49440
    v_mfma_f32_16x16x32_bf16 v[80:83], v[104:107], v[152:155], v[80:83]
    ds_read_b64_tr_b16 v[98:99], v15 offset:50464
    s_waitcnt vmcnt(9) lgkmcnt(6)
    v_mfma_f32_16x16x32_bf16 v[20:23], v[84:87], v[204:207], v[20:23]
    ds_read_b64_tr_b16 v[100:101], v3 offset:49664
    s_waitcnt vmcnt(7)
    v_mfma_f32_16x16x32_bf16 v[24:27], v[84:87], v[208:211], v[24:27]
    ds_read_b64_tr_b16 v[102:103], v3 offset:50688
    s_mov_b32 s26, 0x3e0293ee
    v_lshlrev_b32 v168, 16, v156
    v_and_b32 v169, 0xffff0000, v156
    v_mul_f32 v168, s26, v168
    v_mul_f32 v169, s26, v169
    v_cvt_pk_bf16_f32 v156, v168, v169
    v_lshlrev_b32 v170, 16, v157
    v_and_b32 v171, 0xffff0000, v157
    v_mul_f32 v170, s26, v170
    v_mul_f32 v171, s26, v171
    v_cvt_pk_bf16_f32 v157, v170, v171
    v_lshlrev_b32 v168, 16, v158
    v_and_b32 v169, 0xffff0000, v158
    v_mul_f32 v168, s26, v168
    v_mul_f32 v169, s26, v169
    v_cvt_pk_bf16_f32 v158, v168, v169
    v_lshlrev_b32 v170, 16, v159
    v_and_b32 v171, 0xffff0000, v159
    v_mul_f32 v170, s26, v170
    v_mul_f32 v171, s26, v171
    v_cvt_pk_bf16_f32 v159, v170, v171
    v_lshl_or_b32 v160, v161, 16, v160
    v_or_b32 v156, v156, v160
    v_lshl_or_b32 v162, v163, 16, v162
    v_or_b32 v157, v157, v162
    v_lshl_or_b32 v164, v165, 16, v164
    v_or_b32 v158, v158, v164
    v_lshl_or_b32 v166, v167, 16, v166
    v_or_b32 v159, v159, v166
    s_lshl_b32 s27, s63, 10
    s_add_u32 s27, s27, 0x400000
    buffer_store_dwordx4 v[156:159], v1, s[8:11], s27 offen sc1
    s_waitcnt lgkmcnt(6)
    v_mfma_f32_16x16x32_bf16 v[28:31], v[88:91], v[204:207], v[28:31]
    ds_read_b64_tr_b16 v[104:105], v15 offset:49696
    v_mfma_f32_16x16x32_bf16 v[32:35], v[88:91], v[208:211], v[32:35]
    ds_read_b64_tr_b16 v[106:107], v15 offset:50720
    s_mov_b32 s23, 0x2800
    buffer_load_dwordx4 v[140:143], v4, s[8:11], s23 offen offset:0 sc1
    s_waitcnt lgkmcnt(6)
    v_mfma_f32_16x16x32_bf16 v[36:39], v[92:95], v[204:207], v[36:39]
    ds_read_b64_tr_b16 v[84:85], v3 offset:49920
    v_mfma_f32_16x16x32_bf16 v[40:43], v[92:95], v[208:211], v[40:43]
    ds_read_b64_tr_b16 v[86:87], v3 offset:50944
    s_waitcnt lgkmcnt(6)
    v_mfma_f32_16x16x32_bf16 v[44:47], v[96:99], v[204:207], v[44:47]
    ds_read_b64_tr_b16 v[88:89], v15 offset:49952
    v_mfma_f32_16x16x32_bf16 v[48:51], v[96:99], v[208:211], v[48:51]
    ds_read_b64_tr_b16 v[90:91], v15 offset:50976
    s_mov_b32 s26, 0x380000
    buffer_load_dword v18, v17, s[68:71], s26 offen
    s_waitcnt lgkmcnt(6)
    v_mfma_f32_16x16x32_bf16 v[52:55], v[100:103], v[204:207], v[52:55]
    ds_read_b64_tr_b16 v[92:93], v3 offset:57344
    v_mfma_f32_16x16x32_bf16 v[56:59], v[100:103], v[208:211], v[56:59]
    ds_read_b64_tr_b16 v[94:95], v3 offset:58368
    s_waitcnt lgkmcnt(6)
    v_mfma_f32_16x16x32_bf16 v[60:63], v[104:107], v[204:207], v[60:63]
    ds_read_b64_tr_b16 v[96:97], v15 offset:57376
    v_mfma_f32_16x16x32_bf16 v[64:67], v[104:107], v[208:211], v[64:67]
    ds_read_b64_tr_b16 v[98:99], v15 offset:58400
    s_mov_b32 s23, 0xa800
    buffer_load_dwordx4 v[144:147], v4, s[8:11], s23 offen offset:0 sc1
    s_waitcnt lgkmcnt(6)
    v_mfma_f32_16x16x32_bf16 v[68:71], v[84:87], v[204:207], v[68:71]
    ds_read_b64_tr_b16 v[100:101], v3 offset:57600
    v_mfma_f32_16x16x32_bf16 v[72:75], v[84:87], v[208:211], v[72:75]
    ds_read_b64_tr_b16 v[102:103], v3 offset:58624
    s_waitcnt lgkmcnt(6)
    v_mfma_f32_16x16x32_bf16 v[76:79], v[88:91], v[204:207], v[76:79]
    ds_read_b64_tr_b16 v[104:105], v15 offset:57632
    v_mfma_f32_16x16x32_bf16 v[80:83], v[88:91], v[208:211], v[80:83]
    ds_read_b64_tr_b16 v[106:107], v15 offset:58656
    s_waitcnt vmcnt(10) lgkmcnt(6)
    v_mfma_f32_16x16x32_bf16 v[20:23], v[92:95], v[212:215], v[20:23]
    ds_read_b64_tr_b16 v[84:85], v3 offset:57856
    s_waitcnt vmcnt(9)
    v_mfma_f32_16x16x32_bf16 v[24:27], v[92:95], v[216:219], v[24:27]
    ds_read_b64_tr_b16 v[86:87], v3 offset:58880
    s_waitcnt lgkmcnt(6)
    v_mfma_f32_16x16x32_bf16 v[28:31], v[96:99], v[212:215], v[28:31]
    ds_read_b64_tr_b16 v[88:89], v15 offset:57888
    v_mfma_f32_16x16x32_bf16 v[32:35], v[96:99], v[216:219], v[32:35]
    ds_read_b64_tr_b16 v[90:91], v15 offset:58912
    s_mov_b32 s23, 0x2800
    buffer_load_dwordx4 v[148:151], v4, s[8:11], s23 offen offset:1024 sc1
    s_waitcnt lgkmcnt(6)
    v_mfma_f32_16x16x32_bf16 v[36:39], v[100:103], v[212:215], v[36:39]
    ds_read_b64_tr_b16 v[92:93], v3 offset:58112
    v_mfma_f32_16x16x32_bf16 v[40:43], v[100:103], v[216:219], v[40:43]
    ds_read_b64_tr_b16 v[94:95], v3 offset:59136
    s_waitcnt lgkmcnt(6)
    v_mfma_f32_16x16x32_bf16 v[44:47], v[104:107], v[212:215], v[44:47]
    ds_read_b64_tr_b16 v[96:97], v15 offset:58144
    v_mfma_f32_16x16x32_bf16 v[48:51], v[104:107], v[216:219], v[48:51]
    ds_read_b64_tr_b16 v[98:99], v15 offset:59168
    s_waitcnt lgkmcnt(6)
    v_mfma_f32_16x16x32_bf16 v[52:55], v[84:87], v[212:215], v[52:55]
    v_mfma_f32_16x16x32_bf16 v[56:59], v[84:87], v[216:219], v[56:59]
    s_barrier
    ds_read_b64_tr_b16 v[100:101], v3 offset:0
    ds_read_b64_tr_b16 v[102:103], v3 offset:1024
    s_waitcnt lgkmcnt(6)
    v_mfma_f32_16x16x32_bf16 v[60:63], v[88:91], v[212:215], v[60:63]
    ds_read_b64_tr_b16 v[104:105], v15 offset:32
    v_mfma_f32_16x16x32_bf16 v[64:67], v[88:91], v[216:219], v[64:67]
    ds_read_b64_tr_b16 v[106:107], v15 offset:1056
    s_mov_b32 s23, 0xa800
    buffer_load_dwordx4 v[152:155], v4, s[8:11], s23 offen offset:1024 sc1
    s_waitcnt lgkmcnt(6)
    v_mfma_f32_16x16x32_bf16 v[68:71], v[92:95], v[212:215], v[68:71]
    ds_read_b64_tr_b16 v[84:85], v3 offset:256
    v_mfma_f32_16x16x32_bf16 v[72:75], v[92:95], v[216:219], v[72:75]
    ds_read_b64_tr_b16 v[86:87], v3 offset:1280
    s_waitcnt lgkmcnt(6)
    v_mfma_f32_16x16x32_bf16 v[76:79], v[96:99], v[212:215], v[76:79]
    ds_read_b64_tr_b16 v[88:89], v15 offset:288
    v_mfma_f32_16x16x32_bf16 v[80:83], v[96:99], v[216:219], v[80:83]
    ds_read_b64_tr_b16 v[90:91], v15 offset:1312
    s_waitcnt vmcnt(10) lgkmcnt(6)
    v_mfma_f32_16x16x32_bf16 v[20:23], v[100:103], v[220:223], v[20:23]
    ds_read_b64_tr_b16 v[92:93], v3 offset:512
    s_waitcnt vmcnt(8)
    v_mfma_f32_16x16x32_bf16 v[24:27], v[100:103], v[224:227], v[24:27]
    ds_read_b64_tr_b16 v[94:95], v3 offset:1536
    s_waitcnt lgkmcnt(6)
    v_mfma_f32_16x16x32_bf16 v[28:31], v[104:107], v[220:223], v[28:31]
    ds_read_b64_tr_b16 v[96:97], v15 offset:544
    v_mfma_f32_16x16x32_bf16 v[32:35], v[104:107], v[224:227], v[32:35]
    ds_read_b64_tr_b16 v[98:99], v15 offset:1568
    s_mov_b32 s23, 0x3000
    buffer_load_dwordx4 v[204:207], v4, s[8:11], s23 offen offset:0 sc1
    s_waitcnt lgkmcnt(6)
    v_mfma_f32_16x16x32_bf16 v[36:39], v[84:87], v[220:223], v[36:39]
    ds_read_b64_tr_b16 v[100:101], v3 offset:768
    v_mfma_f32_16x16x32_bf16 v[40:43], v[84:87], v[224:227], v[40:43]
    ds_read_b64_tr_b16 v[102:103], v3 offset:1792
    s_waitcnt lgkmcnt(6)
    v_mfma_f32_16x16x32_bf16 v[44:47], v[88:91], v[220:223], v[44:47]
    ds_read_b64_tr_b16 v[104:105], v15 offset:800
    v_mfma_f32_16x16x32_bf16 v[48:51], v[88:91], v[224:227], v[48:51]
    ds_read_b64_tr_b16 v[106:107], v15 offset:1824
    s_mov_b32 s26, 0x400000
    buffer_load_dword v18, v17, s[68:71], s26 offen
    s_waitcnt lgkmcnt(6)
    v_mfma_f32_16x16x32_bf16 v[52:55], v[92:95], v[220:223], v[52:55]
    ds_read_b64_tr_b16 v[84:85], v3 offset:8192
    v_mfma_f32_16x16x32_bf16 v[56:59], v[92:95], v[224:227], v[56:59]
    ds_read_b64_tr_b16 v[86:87], v3 offset:9216
    s_waitcnt lgkmcnt(6)
    v_mfma_f32_16x16x32_bf16 v[60:63], v[96:99], v[220:223], v[60:63]
    ds_read_b64_tr_b16 v[88:89], v15 offset:8224
    v_mfma_f32_16x16x32_bf16 v[64:67], v[96:99], v[224:227], v[64:67]
    ds_read_b64_tr_b16 v[90:91], v15 offset:9248
    s_mov_b32 s23, 0xb000
    buffer_load_dwordx4 v[208:211], v4, s[8:11], s23 offen offset:0 sc1
    s_waitcnt lgkmcnt(6)
    v_mfma_f32_16x16x32_bf16 v[68:71], v[100:103], v[220:223], v[68:71]
    ds_read_b64_tr_b16 v[92:93], v3 offset:8448
    v_mfma_f32_16x16x32_bf16 v[72:75], v[100:103], v[224:227], v[72:75]
    ds_read_b64_tr_b16 v[94:95], v3 offset:9472
    s_waitcnt lgkmcnt(6)
    v_mfma_f32_16x16x32_bf16 v[76:79], v[104:107], v[220:223], v[76:79]
    ds_read_b64_tr_b16 v[96:97], v15 offset:8480
    v_mfma_f32_16x16x32_bf16 v[80:83], v[104:107], v[224:227], v[80:83]
    ds_read_b64_tr_b16 v[98:99], v15 offset:9504
    s_waitcnt vmcnt(10) lgkmcnt(6)
    v_mfma_f32_16x16x32_bf16 v[20:23], v[84:87], v[228:231], v[20:23]
    ds_read_b64_tr_b16 v[100:101], v3 offset:8704
    s_waitcnt vmcnt(9)
    v_mfma_f32_16x16x32_bf16 v[24:27], v[84:87], v[232:235], v[24:27]
    ds_read_b64_tr_b16 v[102:103], v3 offset:9728
    s_waitcnt lgkmcnt(6)
    v_mfma_f32_16x16x32_bf16 v[28:31], v[88:91], v[228:231], v[28:31]
    ds_read_b64_tr_b16 v[104:105], v15 offset:8736
    v_mfma_f32_16x16x32_bf16 v[32:35], v[88:91], v[232:235], v[32:35]
    ds_read_b64_tr_b16 v[106:107], v15 offset:9760
    s_mov_b32 s23, 0x3000
    buffer_load_dwordx4 v[212:215], v4, s[8:11], s23 offen offset:1024 sc1
    s_waitcnt lgkmcnt(6)
    v_mfma_f32_16x16x32_bf16 v[36:39], v[92:95], v[228:231], v[36:39]
    ds_read_b64_tr_b16 v[84:85], v3 offset:8960
    v_mfma_f32_16x16x32_bf16 v[40:43], v[92:95], v[232:235], v[40:43]
    ds_read_b64_tr_b16 v[86:87], v3 offset:9984
    s_waitcnt lgkmcnt(6)
    v_mfma_f32_16x16x32_bf16 v[44:47], v[96:99], v[228:231], v[44:47]
    ds_read_b64_tr_b16 v[88:89], v15 offset:8992
    v_mfma_f32_16x16x32_bf16 v[48:51], v[96:99], v[232:235], v[48:51]
    ds_read_b64_tr_b16 v[90:91], v15 offset:10016
    s_waitcnt lgkmcnt(6)
    v_mfma_f32_16x16x32_bf16 v[52:55], v[100:103], v[228:231], v[52:55]
    v_mfma_f32_16x16x32_bf16 v[56:59], v[100:103], v[232:235], v[56:59]
    s_barrier
    ds_read_b64_tr_b16 v[92:93], v3 offset:16384
    ds_read_b64_tr_b16 v[94:95], v3 offset:17408
    s_waitcnt lgkmcnt(6)
    v_mfma_f32_16x16x32_bf16 v[60:63], v[104:107], v[228:231], v[60:63]
    ds_read_b64_tr_b16 v[96:97], v15 offset:16416
    v_mfma_f32_16x16x32_bf16 v[64:67], v[104:107], v[232:235], v[64:67]
    ds_read_b64_tr_b16 v[98:99], v15 offset:17440
    s_mov_b32 s23, 0xb000
    buffer_load_dwordx4 v[216:219], v4, s[8:11], s23 offen offset:1024 sc1
    s_waitcnt lgkmcnt(6)
    v_mfma_f32_16x16x32_bf16 v[68:71], v[84:87], v[228:231], v[68:71]
    ds_read_b64_tr_b16 v[100:101], v3 offset:16640
    v_mfma_f32_16x16x32_bf16 v[72:75], v[84:87], v[232:235], v[72:75]
    ds_read_b64_tr_b16 v[102:103], v3 offset:17664
    s_waitcnt lgkmcnt(6)
    v_mfma_f32_16x16x32_bf16 v[76:79], v[88:91], v[228:231], v[76:79]
    ds_read_b64_tr_b16 v[104:105], v15 offset:16672
    v_mfma_f32_16x16x32_bf16 v[80:83], v[88:91], v[232:235], v[80:83]
    ds_read_b64_tr_b16 v[106:107], v15 offset:17696
    s_waitcnt vmcnt(9) lgkmcnt(6)
    v_mfma_f32_16x16x32_bf16 v[20:23], v[92:95], v[140:143], v[20:23]
    ds_read_b64_tr_b16 v[84:85], v3 offset:16896
    s_waitcnt vmcnt(7)
    v_mfma_f32_16x16x32_bf16 v[24:27], v[92:95], v[144:147], v[24:27]
    ds_read_b64_tr_b16 v[86:87], v3 offset:17920
    s_lshl_b32 s26, s63, 2
    s_add_u32 s26, s26, 0x530000
    v_mov_b32 v168, s14
    v_mov_b32 v169, 0
    s_mov_b64 exec, 1
    buffer_store_dword v168, v169, s[8:11], s26 offen sc1
    s_mov_b64 exec, -1
    s_nop 3
    s_waitcnt lgkmcnt(6)
    v_mfma_f32_16x16x32_bf16 v[28:31], v[96:99], v[140:143], v[28:31]
    ds_read_b64_tr_b16 v[88:89], v15 offset:16928
    v_mfma_f32_16x16x32_bf16 v[32:35], v[96:99], v[144:147], v[32:35]
    ds_read_b64_tr_b16 v[90:91], v15 offset:17952
    s_mov_b32 s23, 0x3800
    buffer_load_dwordx4 v[220:223], v4, s[8:11], s23 offen offset:0 sc1
    s_waitcnt lgkmcnt(6)
    v_mfma_f32_16x16x32_bf16 v[36:39], v[100:103], v[140:143], v[36:39]
    ds_read_b64_tr_b16 v[92:93], v3 offset:17152
    v_mfma_f32_16x16x32_bf16 v[40:43], v[100:103], v[144:147], v[40:43]
    ds_read_b64_tr_b16 v[94:95], v3 offset:18176
    s_waitcnt lgkmcnt(6)
    v_mfma_f32_16x16x32_bf16 v[44:47], v[104:107], v[140:143], v[44:47]
    ds_read_b64_tr_b16 v[96:97], v15 offset:17184
    v_mfma_f32_16x16x32_bf16 v[48:51], v[104:107], v[144:147], v[48:51]
    ds_read_b64_tr_b16 v[98:99], v15 offset:18208
    s_mov_b32 s26, 0x480000
    buffer_load_dword v18, v17, s[68:71], s26 offen
    s_waitcnt lgkmcnt(6)
    v_mfma_f32_16x16x32_bf16 v[52:55], v[84:87], v[140:143], v[52:55]
    ds_read_b64_tr_b16 v[100:101], v3 offset:24576
    v_mfma_f32_16x16x32_bf16 v[56:59], v[84:87], v[144:147], v[56:59]
    ds_read_b64_tr_b16 v[102:103], v3 offset:25600
    s_waitcnt lgkmcnt(6)
    v_mfma_f32_16x16x32_bf16 v[60:63], v[88:91], v[140:143], v[60:63]
    ds_read_b64_tr_b16 v[104:105], v15 offset:24608
    v_mfma_f32_16x16x32_bf16 v[64:67], v[88:91], v[144:147], v[64:67]
    ds_read_b64_tr_b16 v[106:107], v15 offset:25632
    s_mov_b32 s23, 0xb800
    buffer_load_dwordx4 v[224:227], v4, s[8:11], s23 offen offset:0 sc1
    s_waitcnt lgkmcnt(6)
    v_mfma_f32_16x16x32_bf16 v[68:71], v[92:95], v[140:143], v[68:71]
    ds_read_b64_tr_b16 v[84:85], v3 offset:24832
    v_mfma_f32_16x16x32_bf16 v[72:75], v[92:95], v[144:147], v[72:75]
    ds_read_b64_tr_b16 v[86:87], v3 offset:25856
    s_waitcnt lgkmcnt(6)
    v_mfma_f32_16x16x32_bf16 v[76:79], v[96:99], v[140:143], v[76:79]
    ds_read_b64_tr_b16 v[88:89], v15 offset:24864
    v_mfma_f32_16x16x32_bf16 v[80:83], v[96:99], v[144:147], v[80:83]
    ds_read_b64_tr_b16 v[90:91], v15 offset:25888
    s_waitcnt vmcnt(10) lgkmcnt(6)
    v_mfma_f32_16x16x32_bf16 v[20:23], v[100:103], v[148:151], v[20:23]
    ds_read_b64_tr_b16 v[92:93], v3 offset:25088
    s_waitcnt vmcnt(9)
    v_mfma_f32_16x16x32_bf16 v[24:27], v[100:103], v[152:155], v[24:27]
    ds_read_b64_tr_b16 v[94:95], v3 offset:26112
    s_waitcnt lgkmcnt(6)
    v_mfma_f32_16x16x32_bf16 v[28:31], v[104:107], v[148:151], v[28:31]
    ds_read_b64_tr_b16 v[96:97], v15 offset:25120
    v_mfma_f32_16x16x32_bf16 v[32:35], v[104:107], v[152:155], v[32:35]
    ds_read_b64_tr_b16 v[98:99], v15 offset:26144
    s_mov_b32 s23, 0x3800
    buffer_load_dwordx4 v[228:231], v4, s[8:11], s23 offen offset:1024 sc1
    s_waitcnt lgkmcnt(6)
    v_mfma_f32_16x16x32_bf16 v[36:39], v[84:87], v[148:151], v[36:39]
    ds_read_b64_tr_b16 v[100:101], v3 offset:25344
    v_mfma_f32_16x16x32_bf16 v[40:43], v[84:87], v[152:155], v[40:43]
    ds_read_b64_tr_b16 v[102:103], v3 offset:26368
    s_waitcnt lgkmcnt(6)
    v_mfma_f32_16x16x32_bf16 v[44:47], v[88:91], v[148:151], v[44:47]
    ds_read_b64_tr_b16 v[104:105], v15 offset:25376
    v_mfma_f32_16x16x32_bf16 v[48:51], v[88:91], v[152:155], v[48:51]
    ds_read_b64_tr_b16 v[106:107], v15 offset:26400
    s_waitcnt lgkmcnt(6)
    v_mfma_f32_16x16x32_bf16 v[52:55], v[92:95], v[148:151], v[52:55]
    v_mfma_f32_16x16x32_bf16 v[56:59], v[92:95], v[152:155], v[56:59]
    s_barrier
    ds_read_b64_tr_b16 v[84:85], v3 offset:32768
    ds_read_b64_tr_b16 v[86:87], v3 offset:33792
    s_waitcnt lgkmcnt(6)
    v_mfma_f32_16x16x32_bf16 v[60:63], v[96:99], v[148:151], v[60:63]
    ds_read_b64_tr_b16 v[88:89], v15 offset:32800
    v_mfma_f32_16x16x32_bf16 v[64:67], v[96:99], v[152:155], v[64:67]
    ds_read_b64_tr_b16 v[90:91], v15 offset:33824
    s_mov_b32 s23, 0xb800
    buffer_load_dwordx4 v[232:235], v4, s[8:11], s23 offen offset:1024 sc1
    s_waitcnt lgkmcnt(6)
    v_mfma_f32_16x16x32_bf16 v[68:71], v[100:103], v[148:151], v[68:71]
    ds_read_b64_tr_b16 v[92:93], v3 offset:33024
    v_mfma_f32_16x16x32_bf16 v[72:75], v[100:103], v[152:155], v[72:75]
    ds_read_b64_tr_b16 v[94:95], v3 offset:34048
    s_waitcnt lgkmcnt(6)
    v_mfma_f32_16x16x32_bf16 v[76:79], v[104:107], v[148:151], v[76:79]
    ds_read_b64_tr_b16 v[96:97], v15 offset:33056
    v_mfma_f32_16x16x32_bf16 v[80:83], v[104:107], v[152:155], v[80:83]
    ds_read_b64_tr_b16 v[98:99], v15 offset:34080
    s_waitcnt vmcnt(10) lgkmcnt(6)
    v_mfma_f32_16x16x32_bf16 v[20:23], v[84:87], v[204:207], v[20:23]
    ds_read_b64_tr_b16 v[100:101], v3 offset:33280
    s_waitcnt vmcnt(8)
    v_mfma_f32_16x16x32_bf16 v[24:27], v[84:87], v[208:211], v[24:27]
    ds_read_b64_tr_b16 v[102:103], v3 offset:34304
    s_waitcnt lgkmcnt(6)
    v_mfma_f32_16x16x32_bf16 v[28:31], v[88:91], v[204:207], v[28:31]
    ds_read_b64_tr_b16 v[104:105], v15 offset:33312
    v_mfma_f32_16x16x32_bf16 v[32:35], v[88:91], v[208:211], v[32:35]
    ds_read_b64_tr_b16 v[106:107], v15 offset:34336
    s_mov_b32 s23, 0x4000
    buffer_load_dwordx4 v[140:143], v4, s[8:11], s23 offen offset:0 sc1
    s_waitcnt lgkmcnt(6)
    v_mfma_f32_16x16x32_bf16 v[36:39], v[92:95], v[204:207], v[36:39]
    ds_read_b64_tr_b16 v[84:85], v3 offset:33536
    v_mfma_f32_16x16x32_bf16 v[40:43], v[92:95], v[208:211], v[40:43]
    ds_read_b64_tr_b16 v[86:87], v3 offset:34560
    s_waitcnt lgkmcnt(6)
    v_mfma_f32_16x16x32_bf16 v[44:47], v[96:99], v[204:207], v[44:47]
    ds_read_b64_tr_b16 v[88:89], v15 offset:33568
    v_mfma_f32_16x16x32_bf16 v[48:51], v[96:99], v[208:211], v[48:51]
    ds_read_b64_tr_b16 v[90:91], v15 offset:34592
    s_mov_b32 s26, 0x500000
    buffer_load_dword v18, v17, s[68:71], s26 offen
    s_waitcnt lgkmcnt(6)
    v_mfma_f32_16x16x32_bf16 v[52:55], v[100:103], v[204:207], v[52:55]
    ds_read_b64_tr_b16 v[92:93], v3 offset:40960
    v_mfma_f32_16x16x32_bf16 v[56:59], v[100:103], v[208:211], v[56:59]
    ds_read_b64_tr_b16 v[94:95], v3 offset:41984
    s_waitcnt lgkmcnt(6)
    v_mfma_f32_16x16x32_bf16 v[60:63], v[104:107], v[204:207], v[60:63]
    ds_read_b64_tr_b16 v[96:97], v15 offset:40992
    v_mfma_f32_16x16x32_bf16 v[64:67], v[104:107], v[208:211], v[64:67]
    ds_read_b64_tr_b16 v[98:99], v15 offset:42016
    s_mov_b32 s23, 0xc000
    buffer_load_dwordx4 v[144:147], v4, s[8:11], s23 offen offset:0 sc1
    s_waitcnt lgkmcnt(6)
    v_mfma_f32_16x16x32_bf16 v[68:71], v[84:87], v[204:207], v[68:71]
    ds_read_b64_tr_b16 v[100:101], v3 offset:41216
    v_mfma_f32_16x16x32_bf16 v[72:75], v[84:87], v[208:211], v[72:75]
    ds_read_b64_tr_b16 v[102:103], v3 offset:42240
    s_waitcnt lgkmcnt(6)
    v_mfma_f32_16x16x32_bf16 v[76:79], v[88:91], v[204:207], v[76:79]
    ds_read_b64_tr_b16 v[104:105], v15 offset:41248
    v_mfma_f32_16x16x32_bf16 v[80:83], v[88:91], v[208:211], v[80:83]
    ds_read_b64_tr_b16 v[106:107], v15 offset:42272
    s_waitcnt vmcnt(10) lgkmcnt(6)
    v_mfma_f32_16x16x32_bf16 v[20:23], v[92:95], v[212:215], v[20:23]
    ds_read_b64_tr_b16 v[84:85], v3 offset:41472
    s_waitcnt vmcnt(9)
    v_mfma_f32_16x16x32_bf16 v[24:27], v[92:95], v[216:219], v[24:27]
    ds_read_b64_tr_b16 v[86:87], v3 offset:42496
    s_waitcnt lgkmcnt(6)
    v_mfma_f32_16x16x32_bf16 v[28:31], v[96:99], v[212:215], v[28:31]
    ds_read_b64_tr_b16 v[88:89], v15 offset:41504
    v_mfma_f32_16x16x32_bf16 v[32:35], v[96:99], v[216:219], v[32:35]
    ds_read_b64_tr_b16 v[90:91], v15 offset:42528
    s_mov_b32 s23, 0x4000
    buffer_load_dwordx4 v[148:151], v4, s[8:11], s23 offen offset:1024 sc1
    s_waitcnt lgkmcnt(6)
    v_mfma_f32_16x16x32_bf16 v[36:39], v[100:103], v[212:215], v[36:39]
    ds_read_b64_tr_b16 v[92:93], v3 offset:41728
    v_mfma_f32_16x16x32_bf16 v[40:43], v[100:103], v[216:219], v[40:43]
    ds_read_b64_tr_b16 v[94:95], v3 offset:42752
    s_waitcnt lgkmcnt(6)
    v_mfma_f32_16x16x32_bf16 v[44:47], v[104:107], v[212:215], v[44:47]
    ds_read_b64_tr_b16 v[96:97], v15 offset:41760
    v_mfma_f32_16x16x32_bf16 v[48:51], v[104:107], v[216:219], v[48:51]
    ds_read_b64_tr_b16 v[98:99], v15 offset:42784
    s_waitcnt lgkmcnt(6)
    v_mfma_f32_16x16x32_bf16 v[52:55], v[84:87], v[212:215], v[52:55]
    v_mfma_f32_16x16x32_bf16 v[56:59], v[84:87], v[216:219], v[56:59]
    s_barrier
    ds_read_b64_tr_b16 v[100:101], v3 offset:49152
    ds_read_b64_tr_b16 v[102:103], v3 offset:50176
    s_waitcnt lgkmcnt(6)
    v_mfma_f32_16x16x32_bf16 v[60:63], v[88:91], v[212:215], v[60:63]
    ds_read_b64_tr_b16 v[104:105], v15 offset:49184
    v_mfma_f32_16x16x32_bf16 v[64:67], v[88:91], v[216:219], v[64:67]
    ds_read_b64_tr_b16 v[106:107], v15 offset:50208
    s_mov_b32 s23, 0xc000
    buffer_load_dwordx4 v[152:155], v4, s[8:11], s23 offen offset:1024 sc1
    s_waitcnt lgkmcnt(6)
    v_mfma_f32_16x16x32_bf16 v[68:71], v[92:95], v[212:215], v[68:71]
    ds_read_b64_tr_b16 v[84:85], v3 offset:49408
    v_mfma_f32_16x16x32_bf16 v[72:75], v[92:95], v[216:219], v[72:75]
    ds_read_b64_tr_b16 v[86:87], v3 offset:50432
    s_waitcnt lgkmcnt(6)
    v_mfma_f32_16x16x32_bf16 v[76:79], v[96:99], v[212:215], v[76:79]
    ds_read_b64_tr_b16 v[88:89], v15 offset:49440
    v_mfma_f32_16x16x32_bf16 v[80:83], v[96:99], v[216:219], v[80:83]
    ds_read_b64_tr_b16 v[90:91], v15 offset:50464
    s_waitcnt vmcnt(9) lgkmcnt(6)
    v_mfma_f32_16x16x32_bf16 v[20:23], v[100:103], v[220:223], v[20:23]
    ds_read_b64_tr_b16 v[92:93], v3 offset:49664
    s_waitcnt vmcnt(7)
    v_mfma_f32_16x16x32_bf16 v[24:27], v[100:103], v[224:227], v[24:27]
    ds_read_b64_tr_b16 v[94:95], v3 offset:50688
    s_waitcnt lgkmcnt(6)
    v_mfma_f32_16x16x32_bf16 v[28:31], v[104:107], v[220:223], v[28:31]
    ds_read_b64_tr_b16 v[96:97], v15 offset:49696
    v_mfma_f32_16x16x32_bf16 v[32:35], v[104:107], v[224:227], v[32:35]
    ds_read_b64_tr_b16 v[98:99], v15 offset:50720
    s_mov_b32 s23, 0x4800
    buffer_load_dwordx4 v[204:207], v4, s[8:11], s23 offen offset:0 sc1
    s_waitcnt lgkmcnt(6)
    v_mfma_f32_16x16x32_bf16 v[36:39], v[84:87], v[220:223], v[36:39]
    ds_read_b64_tr_b16 v[100:101], v3 offset:49920
    v_mfma_f32_16x16x32_bf16 v[40:43], v[84:87], v[224:227], v[40:43]
    ds_read_b64_tr_b16 v[102:103], v3 offset:50944
    s_waitcnt lgkmcnt(6)
    v_mfma_f32_16x16x32_bf16 v[44:47], v[88:91], v[220:223], v[44:47]
    ds_read_b64_tr_b16 v[104:105], v15 offset:49952
    v_mfma_f32_16x16x32_bf16 v[48:51], v[88:91], v[224:227], v[48:51]
    ds_read_b64_tr_b16 v[106:107], v15 offset:50976
    s_mov_b32 s26, 0x580000
    buffer_load_dword v18, v17, s[68:71], s26 offen
    s_waitcnt lgkmcnt(6)
    v_mfma_f32_16x16x32_bf16 v[52:55], v[92:95], v[220:223], v[52:55]
    ds_read_b64_tr_b16 v[84:85], v3 offset:57344
    v_mfma_f32_16x16x32_bf16 v[56:59], v[92:95], v[224:227], v[56:59]
    ds_read_b64_tr_b16 v[86:87], v3 offset:58368
    s_waitcnt lgkmcnt(6)
    v_mfma_f32_16x16x32_bf16 v[60:63], v[96:99], v[220:223], v[60:63]
    ds_read_b64_tr_b16 v[88:89], v15 offset:57376
    v_mfma_f32_16x16x32_bf16 v[64:67], v[96:99], v[224:227], v[64:67]
    ds_read_b64_tr_b16 v[90:91], v15 offset:58400
    s_mov_b32 s23, 0xc800
    buffer_load_dwordx4 v[208:211], v4, s[8:11], s23 offen offset:0 sc1
    s_waitcnt lgkmcnt(6)
    v_mfma_f32_16x16x32_bf16 v[68:71], v[100:103], v[220:223], v[68:71]
    ds_read_b64_tr_b16 v[92:93], v3 offset:57600
    v_mfma_f32_16x16x32_bf16 v[72:75], v[100:103], v[224:227], v[72:75]
    ds_read_b64_tr_b16 v[94:95], v3 offset:58624
    s_waitcnt lgkmcnt(6)
    v_mfma_f32_16x16x32_bf16 v[76:79], v[104:107], v[220:223], v[76:79]
    ds_read_b64_tr_b16 v[96:97], v15 offset:57632
    v_mfma_f32_16x16x32_bf16 v[80:83], v[104:107], v[224:227], v[80:83]
    ds_read_b64_tr_b16 v[98:99], v15 offset:58656
    s_waitcnt vmcnt(9) lgkmcnt(6)
    v_mfma_f32_16x16x32_bf16 v[20:23], v[84:87], v[228:231], v[20:23]
    ds_read_b64_tr_b16 v[100:101], v3 offset:57856
    s_waitcnt vmcnt(8)
    v_mfma_f32_16x16x32_bf16 v[24:27], v[84:87], v[232:235], v[24:27]
    ds_read_b64_tr_b16 v[102:103], v3 offset:58880
    s_waitcnt lgkmcnt(6)
    v_mfma_f32_16x16x32_bf16 v[28:31], v[88:91], v[228:231], v[28:31]
    ds_read_b64_tr_b16 v[104:105], v15 offset:57888
    v_mfma_f32_16x16x32_bf16 v[32:35], v[88:91], v[232:235], v[32:35]
    ds_read_b64_tr_b16 v[106:107], v15 offset:58912
    s_mov_b32 s23, 0x4800
    buffer_load_dwordx4 v[212:215], v4, s[8:11], s23 offen offset:1024 sc1
    s_waitcnt lgkmcnt(6)
    v_mfma_f32_16x16x32_bf16 v[36:39], v[92:95], v[228:231], v[36:39]
    ds_read_b64_tr_b16 v[84:85], v3 offset:58112
    v_mfma_f32_16x16x32_bf16 v[40:43], v[92:95], v[232:235], v[40:43]
    ds_read_b64_tr_b16 v[86:87], v3 offset:59136
    s_waitcnt lgkmcnt(6)
    v_mfma_f32_16x16x32_bf16 v[44:47], v[96:99], v[228:231], v[44:47]
    ds_read_b64_tr_b16 v[88:89], v15 offset:58144
    v_mfma_f32_16x16x32_bf16 v[48:51], v[96:99], v[232:235], v[48:51]
    ds_read_b64_tr_b16 v[90:91], v15 offset:59168
    s_waitcnt lgkmcnt(6)
    v_mfma_f32_16x16x32_bf16 v[52:55], v[100:103], v[228:231], v[52:55]
    v_mfma_f32_16x16x32_bf16 v[56:59], v[100:103], v[232:235], v[56:59]
    s_barrier
    ds_read_b64_tr_b16 v[92:93], v3 offset:0
    ds_read_b64_tr_b16 v[94:95], v3 offset:1024
    s_waitcnt lgkmcnt(6)
    v_mfma_f32_16x16x32_bf16 v[60:63], v[104:107], v[228:231], v[60:63]
    ds_read_b64_tr_b16 v[96:97], v15 offset:32
    v_mfma_f32_16x16x32_bf16 v[64:67], v[104:107], v[232:235], v[64:67]
    ds_read_b64_tr_b16 v[98:99], v15 offset:1056
    s_mov_b32 s23, 0xc800
    buffer_load_dwordx4 v[216:219], v4, s[8:11], s23 offen offset:1024 sc1
    s_waitcnt lgkmcnt(6)
    v_mfma_f32_16x16x32_bf16 v[68:71], v[84:87], v[228:231], v[68:71]
    ds_read_b64_tr_b16 v[100:101], v3 offset:256
    v_mfma_f32_16x16x32_bf16 v[72:75], v[84:87], v[232:235], v[72:75]
    ds_read_b64_tr_b16 v[102:103], v3 offset:1280
    s_waitcnt lgkmcnt(6)
    v_mfma_f32_16x16x32_bf16 v[76:79], v[88:91], v[228:231], v[76:79]
    ds_read_b64_tr_b16 v[104:105], v15 offset:288
    v_mfma_f32_16x16x32_bf16 v[80:83], v[88:91], v[232:235], v[80:83]
    ds_read_b64_tr_b16 v[106:107], v15 offset:1312
    s_waitcnt vmcnt(9) lgkmcnt(6)
    v_mfma_f32_16x16x32_bf16 v[20:23], v[92:95], v[140:143], v[20:23]
    ds_read_b64_tr_b16 v[84:85], v3 offset:512
    s_waitcnt vmcnt(7)
    v_mfma_f32_16x16x32_bf16 v[24:27], v[92:95], v[144:147], v[24:27]
    ds_read_b64_tr_b16 v[86:87], v3 offset:1536
    s_waitcnt lgkmcnt(6)
    v_mfma_f32_16x16x32_bf16 v[28:31], v[96:99], v[140:143], v[28:31]
    ds_read_b64_tr_b16 v[88:89], v15 offset:544
    v_mfma_f32_16x16x32_bf16 v[32:35], v[96:99], v[144:147], v[32:35]
    ds_read_b64_tr_b16 v[90:91], v15 offset:1568
    s_mov_b32 s23, 0x5000
    buffer_load_dwordx4 v[220:223], v4, s[8:11], s23 offen offset:0 sc1
    s_waitcnt lgkmcnt(6)
    v_mfma_f32_16x16x32_bf16 v[36:39], v[100:103], v[140:143], v[36:39]
    ds_read_b64_tr_b16 v[92:93], v3 offset:768
    v_mfma_f32_16x16x32_bf16 v[40:43], v[100:103], v[144:147], v[40:43]
    ds_read_b64_tr_b16 v[94:95], v3 offset:1792
    s_waitcnt lgkmcnt(6)
    v_mfma_f32_16x16x32_bf16 v[44:47], v[104:107], v[140:143], v[44:47]
    ds_read_b64_tr_b16 v[96:97], v15 offset:800
    v_mfma_f32_16x16x32_bf16 v[48:51], v[104:107], v[144:147], v[48:51]
    ds_read_b64_tr_b16 v[98:99], v15 offset:1824
    s_mov_b32 s26, 0x600000
    buffer_load_dword v18, v17, s[68:71], s26 offen
    s_waitcnt lgkmcnt(6)
    v_mfma_f32_16x16x32_bf16 v[52:55], v[84:87], v[140:143], v[52:55]
    ds_read_b64_tr_b16 v[100:101], v3 offset:8192
    v_mfma_f32_16x16x32_bf16 v[56:59], v[84:87], v[144:147], v[56:59]
    ds_read_b64_tr_b16 v[102:103], v3 offset:9216
    s_waitcnt lgkmcnt(6)
    v_mfma_f32_16x16x32_bf16 v[60:63], v[88:91], v[140:143], v[60:63]
    ds_read_b64_tr_b16 v[104:105], v15 offset:8224
    v_mfma_f32_16x16x32_bf16 v[64:67], v[88:91], v[144:147], v[64:67]
    ds_read_b64_tr_b16 v[106:107], v15 offset:9248
    s_mov_b32 s23, 0xd000
    buffer_load_dwordx4 v[224:227], v4, s[8:11], s23 offen offset:0 sc1
    s_waitcnt lgkmcnt(6)
    v_mfma_f32_16x16x32_bf16 v[68:71], v[92:95], v[140:143], v[68:71]
    ds_read_b64_tr_b16 v[84:85], v3 offset:8448
    v_mfma_f32_16x16x32_bf16 v[72:75], v[92:95], v[144:147], v[72:75]
    ds_read_b64_tr_b16 v[86:87], v3 offset:9472
    s_waitcnt lgkmcnt(6)
    v_mfma_f32_16x16x32_bf16 v[76:79], v[96:99], v[140:143], v[76:79]
    ds_read_b64_tr_b16 v[88:89], v15 offset:8480
    v_mfma_f32_16x16x32_bf16 v[80:83], v[96:99], v[144:147], v[80:83]
    ds_read_b64_tr_b16 v[90:91], v15 offset:9504
    s_waitcnt vmcnt(9) lgkmcnt(6)
    v_mfma_f32_16x16x32_bf16 v[20:23], v[100:103], v[148:151], v[20:23]
    ds_read_b64_tr_b16 v[92:93], v3 offset:8704
    s_waitcnt vmcnt(8)
    v_mfma_f32_16x16x32_bf16 v[24:27], v[100:103], v[152:155], v[24:27]
    ds_read_b64_tr_b16 v[94:95], v3 offset:9728
    s_waitcnt lgkmcnt(6)
    v_mfma_f32_16x16x32_bf16 v[28:31], v[104:107], v[148:151], v[28:31]
    ds_read_b64_tr_b16 v[96:97], v15 offset:8736
    v_mfma_f32_16x16x32_bf16 v[32:35], v[104:107], v[152:155], v[32:35]
    ds_read_b64_tr_b16 v[98:99], v15 offset:9760
    s_mov_b32 s23, 0x5000
    buffer_load_dwordx4 v[228:231], v4, s[8:11], s23 offen offset:1024 sc1
    s_waitcnt lgkmcnt(6)
    v_mfma_f32_16x16x32_bf16 v[36:39], v[84:87], v[148:151], v[36:39]
    ds_read_b64_tr_b16 v[100:101], v3 offset:8960
    v_mfma_f32_16x16x32_bf16 v[40:43], v[84:87], v[152:155], v[40:43]
    ds_read_b64_tr_b16 v[102:103], v3 offset:9984
    s_waitcnt lgkmcnt(6)
    v_mfma_f32_16x16x32_bf16 v[44:47], v[88:91], v[148:151], v[44:47]
    ds_read_b64_tr_b16 v[104:105], v15 offset:8992
    v_mfma_f32_16x16x32_bf16 v[48:51], v[88:91], v[152:155], v[48:51]
    ds_read_b64_tr_b16 v[106:107], v15 offset:10016
    s_waitcnt lgkmcnt(6)
    v_mfma_f32_16x16x32_bf16 v[52:55], v[92:95], v[148:151], v[52:55]
    v_mfma_f32_16x16x32_bf16 v[56:59], v[92:95], v[152:155], v[56:59]
    s_barrier
    ds_read_b64_tr_b16 v[84:85], v3 offset:16384
    ds_read_b64_tr_b16 v[86:87], v3 offset:17408
    s_waitcnt lgkmcnt(6)
    v_mfma_f32_16x16x32_bf16 v[60:63], v[96:99], v[148:151], v[60:63]
    ds_read_b64_tr_b16 v[88:89], v15 offset:16416
    v_mfma_f32_16x16x32_bf16 v[64:67], v[96:99], v[152:155], v[64:67]
    ds_read_b64_tr_b16 v[90:91], v15 offset:17440
    s_mov_b32 s23, 0xd000
    buffer_load_dwordx4 v[232:235], v4, s[8:11], s23 offen offset:1024 sc1
    s_waitcnt lgkmcnt(6)
    v_mfma_f32_16x16x32_bf16 v[68:71], v[100:103], v[148:151], v[68:71]
    ds_read_b64_tr_b16 v[92:93], v3 offset:16640
    v_mfma_f32_16x16x32_bf16 v[72:75], v[100:103], v[152:155], v[72:75]
    ds_read_b64_tr_b16 v[94:95], v3 offset:17664
    s_waitcnt lgkmcnt(6)
    v_mfma_f32_16x16x32_bf16 v[76:79], v[104:107], v[148:151], v[76:79]
    ds_read_b64_tr_b16 v[96:97], v15 offset:16672
    v_mfma_f32_16x16x32_bf16 v[80:83], v[104:107], v[152:155], v[80:83]
    ds_read_b64_tr_b16 v[98:99], v15 offset:17696
    s_waitcnt vmcnt(9) lgkmcnt(6)
    v_mfma_f32_16x16x32_bf16 v[20:23], v[84:87], v[204:207], v[20:23]
    ds_read_b64_tr_b16 v[100:101], v3 offset:16896
    s_waitcnt vmcnt(7)
    v_mfma_f32_16x16x32_bf16 v[24:27], v[84:87], v[208:211], v[24:27]
    ds_read_b64_tr_b16 v[102:103], v3 offset:17920
    s_waitcnt lgkmcnt(6)
    v_mfma_f32_16x16x32_bf16 v[28:31], v[88:91], v[204:207], v[28:31]
    ds_read_b64_tr_b16 v[104:105], v15 offset:16928
    v_mfma_f32_16x16x32_bf16 v[32:35], v[88:91], v[208:211], v[32:35]
    ds_read_b64_tr_b16 v[106:107], v15 offset:17952
    s_mov_b32 s23, 0x5800
    buffer_load_dwordx4 v[140:143], v4, s[8:11], s23 offen offset:0 sc1
    s_waitcnt lgkmcnt(6)
    v_mfma_f32_16x16x32_bf16 v[36:39], v[92:95], v[204:207], v[36:39]
    ds_read_b64_tr_b16 v[84:85], v3 offset:17152
    v_mfma_f32_16x16x32_bf16 v[40:43], v[92:95], v[208:211], v[40:43]
    ds_read_b64_tr_b16 v[86:87], v3 offset:18176
    s_waitcnt lgkmcnt(6)
    v_mfma_f32_16x16x32_bf16 v[44:47], v[96:99], v[204:207], v[44:47]
    ds_read_b64_tr_b16 v[88:89], v15 offset:17184
    v_mfma_f32_16x16x32_bf16 v[48:51], v[96:99], v[208:211], v[48:51]
    ds_read_b64_tr_b16 v[90:91], v15 offset:18208
    s_mov_b32 s26, 0x680000
    buffer_load_dword v18, v17, s[68:71], s26 offen
    s_waitcnt lgkmcnt(6)
    v_mfma_f32_16x16x32_bf16 v[52:55], v[100:103], v[204:207], v[52:55]
    ds_read_b64_tr_b16 v[92:93], v3 offset:24576
    v_mfma_f32_16x16x32_bf16 v[56:59], v[100:103], v[208:211], v[56:59]
    ds_read_b64_tr_b16 v[94:95], v3 offset:25600
    s_waitcnt lgkmcnt(6)
    v_mfma_f32_16x16x32_bf16 v[60:63], v[104:107], v[204:207], v[60:63]
    ds_read_b64_tr_b16 v[96:97], v15 offset:24608
    v_mfma_f32_16x16x32_bf16 v[64:67], v[104:107], v[208:211], v[64:67]
    ds_read_b64_tr_b16 v[98:99], v15 offset:25632
    s_mov_b32 s23, 0xd800
    buffer_load_dwordx4 v[144:147], v4, s[8:11], s23 offen offset:0 sc1
    s_waitcnt lgkmcnt(6)
    v_mfma_f32_16x16x32_bf16 v[68:71], v[84:87], v[204:207], v[68:71]
    ds_read_b64_tr_b16 v[100:101], v3 offset:24832
    v_mfma_f32_16x16x32_bf16 v[72:75], v[84:87], v[208:211], v[72:75]
    ds_read_b64_tr_b16 v[102:103], v3 offset:25856
    s_waitcnt lgkmcnt(6)
    v_mfma_f32_16x16x32_bf16 v[76:79], v[88:91], v[204:207], v[76:79]
    ds_read_b64_tr_b16 v[104:105], v15 offset:24864
    v_mfma_f32_16x16x32_bf16 v[80:83], v[88:91], v[208:211], v[80:83]
    ds_read_b64_tr_b16 v[106:107], v15 offset:25888
    s_waitcnt vmcnt(9) lgkmcnt(6)
    v_mfma_f32_16x16x32_bf16 v[20:23], v[92:95], v[212:215], v[20:23]
    ds_read_b64_tr_b16 v[84:85], v3 offset:25088
    s_waitcnt vmcnt(8)
    v_mfma_f32_16x16x32_bf16 v[24:27], v[92:95], v[216:219], v[24:27]
    ds_read_b64_tr_b16 v[86:87], v3 offset:26112
    s_waitcnt lgkmcnt(6)
    v_mfma_f32_16x16x32_bf16 v[28:31], v[96:99], v[212:215], v[28:31]
    ds_read_b64_tr_b16 v[88:89], v15 offset:25120
    v_mfma_f32_16x16x32_bf16 v[32:35], v[96:99], v[216:219], v[32:35]
    ds_read_b64_tr_b16 v[90:91], v15 offset:26144
    s_mov_b32 s23, 0x5800
    buffer_load_dwordx4 v[148:151], v4, s[8:11], s23 offen offset:1024 sc1
    s_waitcnt lgkmcnt(6)
    v_mfma_f32_16x16x32_bf16 v[36:39], v[100:103], v[212:215], v[36:39]
    ds_read_b64_tr_b16 v[92:93], v3 offset:25344
    v_mfma_f32_16x16x32_bf16 v[40:43], v[100:103], v[216:219], v[40:43]
    ds_read_b64_tr_b16 v[94:95], v3 offset:26368
    s_waitcnt lgkmcnt(6)
    v_mfma_f32_16x16x32_bf16 v[44:47], v[104:107], v[212:215], v[44:47]
    ds_read_b64_tr_b16 v[96:97], v15 offset:25376
    v_mfma_f32_16x16x32_bf16 v[48:51], v[104:107], v[216:219], v[48:51]
    ds_read_b64_tr_b16 v[98:99], v15 offset:26400
    s_waitcnt lgkmcnt(6)
    v_mfma_f32_16x16x32_bf16 v[52:55], v[84:87], v[212:215], v[52:55]
    v_mfma_f32_16x16x32_bf16 v[56:59], v[84:87], v[216:219], v[56:59]
    s_barrier
    ds_read_b64_tr_b16 v[100:101], v3 offset:32768
    ds_read_b64_tr_b16 v[102:103], v3 offset:33792
    s_waitcnt lgkmcnt(6)
    v_mfma_f32_16x16x32_bf16 v[60:63], v[88:91], v[212:215], v[60:63]
    ds_read_b64_tr_b16 v[104:105], v15 offset:32800
    v_mfma_f32_16x16x32_bf16 v[64:67], v[88:91], v[216:219], v[64:67]
    ds_read_b64_tr_b16 v[106:107], v15 offset:33824
    s_mov_b32 s23, 0xd800
    buffer_load_dwordx4 v[152:155], v4, s[8:11], s23 offen offset:1024 sc1
    s_waitcnt lgkmcnt(6)
    v_mfma_f32_16x16x32_bf16 v[68:71], v[92:95], v[212:215], v[68:71]
    ds_read_b64_tr_b16 v[84:85], v3 offset:33024
    v_mfma_f32_16x16x32_bf16 v[72:75], v[92:95], v[216:219], v[72:75]
    ds_read_b64_tr_b16 v[86:87], v3 offset:34048
    s_waitcnt lgkmcnt(6)
    v_mfma_f32_16x16x32_bf16 v[76:79], v[96:99], v[212:215], v[76:79]
    ds_read_b64_tr_b16 v[88:89], v15 offset:33056
    v_mfma_f32_16x16x32_bf16 v[80:83], v[96:99], v[216:219], v[80:83]
    ds_read_b64_tr_b16 v[90:91], v15 offset:34080
    s_waitcnt vmcnt(9) lgkmcnt(6)
    v_mfma_f32_16x16x32_bf16 v[20:23], v[100:103], v[220:223], v[20:23]
    ds_read_b64_tr_b16 v[92:93], v3 offset:33280
    s_waitcnt vmcnt(7)
    v_mfma_f32_16x16x32_bf16 v[24:27], v[100:103], v[224:227], v[24:27]
    ds_read_b64_tr_b16 v[94:95], v3 offset:34304
    s_waitcnt lgkmcnt(6)
    v_mfma_f32_16x16x32_bf16 v[28:31], v[104:107], v[220:223], v[28:31]
    ds_read_b64_tr_b16 v[96:97], v15 offset:33312
    v_mfma_f32_16x16x32_bf16 v[32:35], v[104:107], v[224:227], v[32:35]
    ds_read_b64_tr_b16 v[98:99], v15 offset:34336
    s_mov_b32 s23, 0x6000
    buffer_load_dwordx4 v[204:207], v4, s[8:11], s23 offen offset:0 sc1
    s_waitcnt lgkmcnt(6)
    v_mfma_f32_16x16x32_bf16 v[36:39], v[84:87], v[220:223], v[36:39]
    ds_read_b64_tr_b16 v[100:101], v3 offset:33536
    v_mfma_f32_16x16x32_bf16 v[40:43], v[84:87], v[224:227], v[40:43]
    ds_read_b64_tr_b16 v[102:103], v3 offset:34560
    s_waitcnt lgkmcnt(6)
    v_mfma_f32_16x16x32_bf16 v[44:47], v[88:91], v[220:223], v[44:47]
    ds_read_b64_tr_b16 v[104:105], v15 offset:33568
    v_mfma_f32_16x16x32_bf16 v[48:51], v[88:91], v[224:227], v[48:51]
    ds_read_b64_tr_b16 v[106:107], v15 offset:34592
    s_mov_b32 s26, 0x700000
    buffer_load_dword v18, v17, s[68:71], s26 offen
    s_waitcnt lgkmcnt(6)
    v_mfma_f32_16x16x32_bf16 v[52:55], v[92:95], v[220:223], v[52:55]
    ds_read_b64_tr_b16 v[84:85], v3 offset:40960
    v_mfma_f32_16x16x32_bf16 v[56:59], v[92:95], v[224:227], v[56:59]
    ds_read_b64_tr_b16 v[86:87], v3 offset:41984
    s_waitcnt lgkmcnt(6)
    v_mfma_f32_16x16x32_bf16 v[60:63], v[96:99], v[220:223], v[60:63]
    ds_read_b64_tr_b16 v[88:89], v15 offset:40992
    v_mfma_f32_16x16x32_bf16 v[64:67], v[96:99], v[224:227], v[64:67]
    ds_read_b64_tr_b16 v[90:91], v15 offset:42016
    s_mov_b32 s23, 0xe000
    buffer_load_dwordx4 v[208:211], v4, s[8:11], s23 offen offset:0 sc1
    s_waitcnt lgkmcnt(6)
    v_mfma_f32_16x16x32_bf16 v[68:71], v[100:103], v[220:223], v[68:71]
    ds_read_b64_tr_b16 v[92:93], v3 offset:41216
    v_mfma_f32_16x16x32_bf16 v[72:75], v[100:103], v[224:227], v[72:75]
    ds_read_b64_tr_b16 v[94:95], v3 offset:42240
    s_waitcnt lgkmcnt(6)
    v_mfma_f32_16x16x32_bf16 v[76:79], v[104:107], v[220:223], v[76:79]
    ds_read_b64_tr_b16 v[96:97], v15 offset:41248
    v_mfma_f32_16x16x32_bf16 v[80:83], v[104:107], v[224:227], v[80:83]
    ds_read_b64_tr_b16 v[98:99], v15 offset:42272
    s_waitcnt vmcnt(9) lgkmcnt(6)
    v_mfma_f32_16x16x32_bf16 v[20:23], v[84:87], v[228:231], v[20:23]
    ds_read_b64_tr_b16 v[100:101], v3 offset:41472
    s_waitcnt vmcnt(8)
    v_mfma_f32_16x16x32_bf16 v[24:27], v[84:87], v[232:235], v[24:27]
    ds_read_b64_tr_b16 v[102:103], v3 offset:42496
    s_waitcnt lgkmcnt(6)
    v_mfma_f32_16x16x32_bf16 v[28:31], v[88:91], v[228:231], v[28:31]
    ds_read_b64_tr_b16 v[104:105], v15 offset:41504
    v_mfma_f32_16x16x32_bf16 v[32:35], v[88:91], v[232:235], v[32:35]
    ds_read_b64_tr_b16 v[106:107], v15 offset:42528
    s_mov_b32 s23, 0x6000
    buffer_load_dwordx4 v[212:215], v4, s[8:11], s23 offen offset:1024 sc1
    s_waitcnt lgkmcnt(6)
    v_mfma_f32_16x16x32_bf16 v[36:39], v[92:95], v[228:231], v[36:39]
    ds_read_b64_tr_b16 v[84:85], v3 offset:41728
    v_mfma_f32_16x16x32_bf16 v[40:43], v[92:95], v[232:235], v[40:43]
    ds_read_b64_tr_b16 v[86:87], v3 offset:42752
    s_waitcnt lgkmcnt(6)
    v_mfma_f32_16x16x32_bf16 v[44:47], v[96:99], v[228:231], v[44:47]
    ds_read_b64_tr_b16 v[88:89], v15 offset:41760
    v_mfma_f32_16x16x32_bf16 v[48:51], v[96:99], v[232:235], v[48:51]
    ds_read_b64_tr_b16 v[90:91], v15 offset:42784
    s_waitcnt lgkmcnt(6)
    v_mfma_f32_16x16x32_bf16 v[52:55], v[100:103], v[228:231], v[52:55]
    v_mfma_f32_16x16x32_bf16 v[56:59], v[100:103], v[232:235], v[56:59]
    s_barrier
    ds_read_b64_tr_b16 v[92:93], v3 offset:49152
    ds_read_b64_tr_b16 v[94:95], v3 offset:50176
    s_waitcnt lgkmcnt(6)
    v_mfma_f32_16x16x32_bf16 v[60:63], v[104:107], v[228:231], v[60:63]
    ds_read_b64_tr_b16 v[96:97], v15 offset:49184
    v_mfma_f32_16x16x32_bf16 v[64:67], v[104:107], v[232:235], v[64:67]
    ds_read_b64_tr_b16 v[98:99], v15 offset:50208
    s_mov_b32 s23, 0xe000
    buffer_load_dwordx4 v[216:219], v4, s[8:11], s23 offen offset:1024 sc1
    s_waitcnt lgkmcnt(6)
    v_mfma_f32_16x16x32_bf16 v[68:71], v[84:87], v[228:231], v[68:71]
    ds_read_b64_tr_b16 v[100:101], v3 offset:49408
    v_mfma_f32_16x16x32_bf16 v[72:75], v[84:87], v[232:235], v[72:75]
    ds_read_b64_tr_b16 v[102:103], v3 offset:50432
    s_waitcnt lgkmcnt(6)
    v_mfma_f32_16x16x32_bf16 v[76:79], v[88:91], v[228:231], v[76:79]
    ds_read_b64_tr_b16 v[104:105], v15 offset:49440
    v_mfma_f32_16x16x32_bf16 v[80:83], v[88:91], v[232:235], v[80:83]
    ds_read_b64_tr_b16 v[106:107], v15 offset:50464
    s_waitcnt vmcnt(9) lgkmcnt(6)
    v_mfma_f32_16x16x32_bf16 v[20:23], v[92:95], v[140:143], v[20:23]
    ds_read_b64_tr_b16 v[84:85], v3 offset:49664
    s_waitcnt vmcnt(7)
    v_mfma_f32_16x16x32_bf16 v[24:27], v[92:95], v[144:147], v[24:27]
    ds_read_b64_tr_b16 v[86:87], v3 offset:50688
    s_waitcnt lgkmcnt(6)
    v_mfma_f32_16x16x32_bf16 v[28:31], v[96:99], v[140:143], v[28:31]
    ds_read_b64_tr_b16 v[88:89], v15 offset:49696
    v_mfma_f32_16x16x32_bf16 v[32:35], v[96:99], v[144:147], v[32:35]
    ds_read_b64_tr_b16 v[90:91], v15 offset:50720
    s_mov_b32 s23, 0x6800
    buffer_load_dwordx4 v[220:223], v4, s[8:11], s23 offen offset:0 sc1
    s_waitcnt lgkmcnt(6)
    v_mfma_f32_16x16x32_bf16 v[36:39], v[100:103], v[140:143], v[36:39]
    ds_read_b64_tr_b16 v[92:93], v3 offset:49920
    v_mfma_f32_16x16x32_bf16 v[40:43], v[100:103], v[144:147], v[40:43]
    ds_read_b64_tr_b16 v[94:95], v3 offset:50944
    s_waitcnt lgkmcnt(6)
    v_mfma_f32_16x16x32_bf16 v[44:47], v[104:107], v[140:143], v[44:47]
    ds_read_b64_tr_b16 v[96:97], v15 offset:49952
    v_mfma_f32_16x16x32_bf16 v[48:51], v[104:107], v[144:147], v[48:51]
    ds_read_b64_tr_b16 v[98:99], v15 offset:50976
    s_mov_b32 s26, 0x780000
    buffer_load_dword v18, v17, s[68:71], s26 offen
    s_waitcnt lgkmcnt(6)
    v_mfma_f32_16x16x32_bf16 v[52:55], v[84:87], v[140:143], v[52:55]
    ds_read_b64_tr_b16 v[100:101], v3 offset:57344
    v_mfma_f32_16x16x32_bf16 v[56:59], v[84:87], v[144:147], v[56:59]
    ds_read_b64_tr_b16 v[102:103], v3 offset:58368
    s_waitcnt lgkmcnt(6)
    v_mfma_f32_16x16x32_bf16 v[60:63], v[88:91], v[140:143], v[60:63]
    ds_read_b64_tr_b16 v[104:105], v15 offset:57376
    v_mfma_f32_16x16x32_bf16 v[64:67], v[88:91], v[144:147], v[64:67]
    ds_read_b64_tr_b16 v[106:107], v15 offset:58400
    s_mov_b32 s23, 0xe800
    buffer_load_dwordx4 v[224:227], v4, s[8:11], s23 offen offset:0 sc1
    s_waitcnt lgkmcnt(6)
    v_mfma_f32_16x16x32_bf16 v[68:71], v[92:95], v[140:143], v[68:71]
    ds_read_b64_tr_b16 v[84:85], v3 offset:57600
    v_mfma_f32_16x16x32_bf16 v[72:75], v[92:95], v[144:147], v[72:75]
    ds_read_b64_tr_b16 v[86:87], v3 offset:58624
    s_waitcnt lgkmcnt(6)
    v_mfma_f32_16x16x32_bf16 v[76:79], v[96:99], v[140:143], v[76:79]
    ds_read_b64_tr_b16 v[88:89], v15 offset:57632
    v_mfma_f32_16x16x32_bf16 v[80:83], v[96:99], v[144:147], v[80:83]
    ds_read_b64_tr_b16 v[90:91], v15 offset:58656
    s_waitcnt vmcnt(9) lgkmcnt(6)
    v_mfma_f32_16x16x32_bf16 v[20:23], v[100:103], v[148:151], v[20:23]
    ds_read_b64_tr_b16 v[92:93], v3 offset:57856
    s_waitcnt vmcnt(8)
    v_mfma_f32_16x16x32_bf16 v[24:27], v[100:103], v[152:155], v[24:27]
    ds_read_b64_tr_b16 v[94:95], v3 offset:58880
    s_waitcnt lgkmcnt(6)
    v_mfma_f32_16x16x32_bf16 v[28:31], v[104:107], v[148:151], v[28:31]
    ds_read_b64_tr_b16 v[96:97], v15 offset:57888
    v_mfma_f32_16x16x32_bf16 v[32:35], v[104:107], v[152:155], v[32:35]
    ds_read_b64_tr_b16 v[98:99], v15 offset:58912
    s_mov_b32 s23, 0x6800
    buffer_load_dwordx4 v[228:231], v4, s[8:11], s23 offen offset:1024 sc1
    s_waitcnt lgkmcnt(6)
    v_mfma_f32_16x16x32_bf16 v[36:39], v[84:87], v[148:151], v[36:39]
    ds_read_b64_tr_b16 v[100:101], v3 offset:58112
    v_mfma_f32_16x16x32_bf16 v[40:43], v[84:87], v[152:155], v[40:43]
    ds_read_b64_tr_b16 v[102:103], v3 offset:59136
    s_waitcnt lgkmcnt(6)
    v_mfma_f32_16x16x32_bf16 v[44:47], v[88:91], v[148:151], v[44:47]
    ds_read_b64_tr_b16 v[104:105], v15 offset:58144
    v_mfma_f32_16x16x32_bf16 v[48:51], v[88:91], v[152:155], v[48:51]
    ds_read_b64_tr_b16 v[106:107], v15 offset:59168
    s_waitcnt lgkmcnt(6)
    v_mfma_f32_16x16x32_bf16 v[52:55], v[92:95], v[148:151], v[52:55]
    v_mfma_f32_16x16x32_bf16 v[56:59], v[92:95], v[152:155], v[56:59]
    s_barrier
    ds_read_b64_tr_b16 v[84:85], v3 offset:0
    ds_read_b64_tr_b16 v[86:87], v3 offset:1024
    s_waitcnt lgkmcnt(6)
    v_mfma_f32_16x16x32_bf16 v[60:63], v[96:99], v[148:151], v[60:63]
    ds_read_b64_tr_b16 v[88:89], v15 offset:32
    v_mfma_f32_16x16x32_bf16 v[64:67], v[96:99], v[152:155], v[64:67]
    ds_read_b64_tr_b16 v[90:91], v15 offset:1056
    s_mov_b32 s23, 0xe800
    buffer_load_dwordx4 v[232:235], v4, s[8:11], s23 offen offset:1024 sc1
    s_waitcnt lgkmcnt(6)
    v_mfma_f32_16x16x32_bf16 v[68:71], v[100:103], v[148:151], v[68:71]
    ds_read_b64_tr_b16 v[92:93], v3 offset:256
    v_mfma_f32_16x16x32_bf16 v[72:75], v[100:103], v[152:155], v[72:75]
    ds_read_b64_tr_b16 v[94:95], v3 offset:1280
    s_waitcnt lgkmcnt(6)
    v_mfma_f32_16x16x32_bf16 v[76:79], v[104:107], v[148:151], v[76:79]
    ds_read_b64_tr_b16 v[96:97], v15 offset:288
    v_mfma_f32_16x16x32_bf16 v[80:83], v[104:107], v[152:155], v[80:83]
    ds_read_b64_tr_b16 v[98:99], v15 offset:1312
    s_waitcnt vmcnt(9) lgkmcnt(6)
    v_mfma_f32_16x16x32_bf16 v[20:23], v[84:87], v[204:207], v[20:23]
    ds_read_b64_tr_b16 v[100:101], v3 offset:512
    s_waitcnt vmcnt(7)
    v_mfma_f32_16x16x32_bf16 v[24:27], v[84:87], v[208:211], v[24:27]
    ds_read_b64_tr_b16 v[102:103], v3 offset:1536
    s_waitcnt lgkmcnt(6)
    v_mfma_f32_16x16x32_bf16 v[28:31], v[88:91], v[204:207], v[28:31]
    ds_read_b64_tr_b16 v[104:105], v15 offset:544
    v_mfma_f32_16x16x32_bf16 v[32:35], v[88:91], v[208:211], v[32:35]
    ds_read_b64_tr_b16 v[106:107], v15 offset:1568
    s_mov_b32 s23, 0x7000
    buffer_load_dwordx4 v[140:143], v4, s[8:11], s23 offen offset:0 sc1
    s_waitcnt lgkmcnt(6)
    v_mfma_f32_16x16x32_bf16 v[36:39], v[92:95], v[204:207], v[36:39]
    ds_read_b64_tr_b16 v[84:85], v3 offset:768
    v_mfma_f32_16x16x32_bf16 v[40:43], v[92:95], v[208:211], v[40:43]
    ds_read_b64_tr_b16 v[86:87], v3 offset:1792
    s_waitcnt lgkmcnt(6)
    v_mfma_f32_16x16x32_bf16 v[44:47], v[96:99], v[204:207], v[44:47]
    ds_read_b64_tr_b16 v[88:89], v15 offset:800
    v_mfma_f32_16x16x32_bf16 v[48:51], v[96:99], v[208:211], v[48:51]
    ds_read_b64_tr_b16 v[90:91], v15 offset:1824
    s_waitcnt lgkmcnt(6)
    v_mfma_f32_16x16x32_bf16 v[52:55], v[100:103], v[204:207], v[52:55]
    ds_read_b64_tr_b16 v[92:93], v3 offset:8192
    v_mfma_f32_16x16x32_bf16 v[56:59], v[100:103], v[208:211], v[56:59]
    ds_read_b64_tr_b16 v[94:95], v3 offset:9216
    s_waitcnt lgkmcnt(6)
    v_mfma_f32_16x16x32_bf16 v[60:63], v[104:107], v[204:207], v[60:63]
    ds_read_b64_tr_b16 v[96:97], v15 offset:8224
    v_mfma_f32_16x16x32_bf16 v[64:67], v[104:107], v[208:211], v[64:67]
    ds_read_b64_tr_b16 v[98:99], v15 offset:9248
    s_mov_b32 s23, 0xf000
    buffer_load_dwordx4 v[144:147], v4, s[8:11], s23 offen offset:0 sc1
    s_waitcnt lgkmcnt(6)
    v_mfma_f32_16x16x32_bf16 v[68:71], v[84:87], v[204:207], v[68:71]
    ds_read_b64_tr_b16 v[100:101], v3 offset:8448
    v_mfma_f32_16x16x32_bf16 v[72:75], v[84:87], v[208:211], v[72:75]
    ds_read_b64_tr_b16 v[102:103], v3 offset:9472
    s_waitcnt lgkmcnt(6)
    v_mfma_f32_16x16x32_bf16 v[76:79], v[88:91], v[204:207], v[76:79]
    ds_read_b64_tr_b16 v[104:105], v15 offset:8480
    v_mfma_f32_16x16x32_bf16 v[80:83], v[88:91], v[208:211], v[80:83]
    ds_read_b64_tr_b16 v[106:107], v15 offset:9504
    s_waitcnt vmcnt(8) lgkmcnt(6)
    v_mfma_f32_16x16x32_bf16 v[20:23], v[92:95], v[212:215], v[20:23]
    ds_read_b64_tr_b16 v[84:85], v3 offset:8704
    s_waitcnt vmcnt(7)
    v_mfma_f32_16x16x32_bf16 v[24:27], v[92:95], v[216:219], v[24:27]
    ds_read_b64_tr_b16 v[86:87], v3 offset:9728
    s_waitcnt lgkmcnt(6)
    v_mfma_f32_16x16x32_bf16 v[28:31], v[96:99], v[212:215], v[28:31]
    ds_read_b64_tr_b16 v[88:89], v15 offset:8736
    v_mfma_f32_16x16x32_bf16 v[32:35], v[96:99], v[216:219], v[32:35]
    ds_read_b64_tr_b16 v[90:91], v15 offset:9760
    s_mov_b32 s23, 0x7000
    buffer_load_dwordx4 v[148:151], v4, s[8:11], s23 offen offset:1024 sc1
    s_waitcnt lgkmcnt(6)
    v_mfma_f32_16x16x32_bf16 v[36:39], v[100:103], v[212:215], v[36:39]
    ds_read_b64_tr_b16 v[92:93], v3 offset:8960
    v_mfma_f32_16x16x32_bf16 v[40:43], v[100:103], v[216:219], v[40:43]
    ds_read_b64_tr_b16 v[94:95], v3 offset:9984
    s_waitcnt lgkmcnt(6)
    v_mfma_f32_16x16x32_bf16 v[44:47], v[104:107], v[212:215], v[44:47]
    ds_read_b64_tr_b16 v[96:97], v15 offset:8992
    v_mfma_f32_16x16x32_bf16 v[48:51], v[104:107], v[216:219], v[48:51]
    ds_read_b64_tr_b16 v[98:99], v15 offset:10016
    s_waitcnt lgkmcnt(6)
    v_mfma_f32_16x16x32_bf16 v[52:55], v[84:87], v[212:215], v[52:55]
    v_mfma_f32_16x16x32_bf16 v[56:59], v[84:87], v[216:219], v[56:59]
    s_barrier
    ds_read_b64_tr_b16 v[100:101], v3 offset:16384
    ds_read_b64_tr_b16 v[102:103], v3 offset:17408
    s_waitcnt lgkmcnt(6)
    v_mfma_f32_16x16x32_bf16 v[60:63], v[88:91], v[212:215], v[60:63]
    ds_read_b64_tr_b16 v[104:105], v15 offset:16416
    v_mfma_f32_16x16x32_bf16 v[64:67], v[88:91], v[216:219], v[64:67]
    ds_read_b64_tr_b16 v[106:107], v15 offset:17440
    s_mov_b32 s23, 0xf000
    buffer_load_dwordx4 v[152:155], v4, s[8:11], s23 offen offset:1024 sc1
    s_waitcnt lgkmcnt(6)
    v_mfma_f32_16x16x32_bf16 v[68:71], v[92:95], v[212:215], v[68:71]
    ds_read_b64_tr_b16 v[84:85], v3 offset:16640
    v_mfma_f32_16x16x32_bf16 v[72:75], v[92:95], v[216:219], v[72:75]
    ds_read_b64_tr_b16 v[86:87], v3 offset:17664
    s_waitcnt lgkmcnt(6)
    v_mfma_f32_16x16x32_bf16 v[76:79], v[96:99], v[212:215], v[76:79]
    ds_read_b64_tr_b16 v[88:89], v15 offset:16672
    v_mfma_f32_16x16x32_bf16 v[80:83], v[96:99], v[216:219], v[80:83]
    ds_read_b64_tr_b16 v[90:91], v15 offset:17696
    s_waitcnt vmcnt(8) lgkmcnt(6)
    v_mfma_f32_16x16x32_bf16 v[20:23], v[100:103], v[220:223], v[20:23]
    ds_read_b64_tr_b16 v[92:93], v3 offset:16896
    s_waitcnt vmcnt(6)
    v_mfma_f32_16x16x32_bf16 v[24:27], v[100:103], v[224:227], v[24:27]
    ds_read_b64_tr_b16 v[94:95], v3 offset:17920
    s_waitcnt lgkmcnt(6)
    v_mfma_f32_16x16x32_bf16 v[28:31], v[104:107], v[220:223], v[28:31]
    ds_read_b64_tr_b16 v[96:97], v15 offset:16928
    v_mfma_f32_16x16x32_bf16 v[32:35], v[104:107], v[224:227], v[32:35]
    ds_read_b64_tr_b16 v[98:99], v15 offset:17952
    s_mov_b32 s23, 0x7800
    buffer_load_dwordx4 v[204:207], v4, s[8:11], s23 offen offset:0 sc1
    s_waitcnt lgkmcnt(6)
    v_mfma_f32_16x16x32_bf16 v[36:39], v[84:87], v[220:223], v[36:39]
    ds_read_b64_tr_b16 v[100:101], v3 offset:17152
    v_mfma_f32_16x16x32_bf16 v[40:43], v[84:87], v[224:227], v[40:43]
    ds_read_b64_tr_b16 v[102:103], v3 offset:18176
    s_waitcnt lgkmcnt(6)
    v_mfma_f32_16x16x32_bf16 v[44:47], v[88:91], v[220:223], v[44:47]
    ds_read_b64_tr_b16 v[104:105], v15 offset:17184
    v_mfma_f32_16x16x32_bf16 v[48:51], v[88:91], v[224:227], v[48:51]
    ds_read_b64_tr_b16 v[106:107], v15 offset:18208
    s_waitcnt lgkmcnt(6)
    v_mfma_f32_16x16x32_bf16 v[52:55], v[92:95], v[220:223], v[52:55]
    ds_read_b64_tr_b16 v[84:85], v3 offset:24576
    v_mfma_f32_16x16x32_bf16 v[56:59], v[92:95], v[224:227], v[56:59]
    ds_read_b64_tr_b16 v[86:87], v3 offset:25600
    s_waitcnt lgkmcnt(6)
    v_mfma_f32_16x16x32_bf16 v[60:63], v[96:99], v[220:223], v[60:63]
    ds_read_b64_tr_b16 v[88:89], v15 offset:24608
    v_mfma_f32_16x16x32_bf16 v[64:67], v[96:99], v[224:227], v[64:67]
    ds_read_b64_tr_b16 v[90:91], v15 offset:25632
    s_mov_b32 s23, 0xf800
    buffer_load_dwordx4 v[208:211], v4, s[8:11], s23 offen offset:0 sc1
    s_waitcnt lgkmcnt(6)
    v_mfma_f32_16x16x32_bf16 v[68:71], v[100:103], v[220:223], v[68:71]
    ds_read_b64_tr_b16 v[92:93], v3 offset:24832
    v_mfma_f32_16x16x32_bf16 v[72:75], v[100:103], v[224:227], v[72:75]
    ds_read_b64_tr_b16 v[94:95], v3 offset:25856
    s_waitcnt lgkmcnt(6)
    v_mfma_f32_16x16x32_bf16 v[76:79], v[104:107], v[220:223], v[76:79]
    ds_read_b64_tr_b16 v[96:97], v15 offset:24864
    v_mfma_f32_16x16x32_bf16 v[80:83], v[104:107], v[224:227], v[80:83]
    ds_read_b64_tr_b16 v[98:99], v15 offset:25888
    s_waitcnt vmcnt(7) lgkmcnt(6)
    v_mfma_f32_16x16x32_bf16 v[20:23], v[84:87], v[228:231], v[20:23]
    ds_read_b64_tr_b16 v[100:101], v3 offset:25088
    s_waitcnt vmcnt(6)
    v_mfma_f32_16x16x32_bf16 v[24:27], v[84:87], v[232:235], v[24:27]
    ds_read_b64_tr_b16 v[102:103], v3 offset:26112
    s_waitcnt lgkmcnt(6)
    v_mfma_f32_16x16x32_bf16 v[28:31], v[88:91], v[228:231], v[28:31]
    ds_read_b64_tr_b16 v[104:105], v15 offset:25120
    v_mfma_f32_16x16x32_bf16 v[32:35], v[88:91], v[232:235], v[32:35]
    ds_read_b64_tr_b16 v[106:107], v15 offset:26144
    s_mov_b32 s23, 0x7800
    buffer_load_dwordx4 v[212:215], v4, s[8:11], s23 offen offset:1024 sc1
    s_waitcnt lgkmcnt(6)
    v_mfma_f32_16x16x32_bf16 v[36:39], v[92:95], v[228:231], v[36:39]
    ds_read_b64_tr_b16 v[84:85], v3 offset:25344
    v_mfma_f32_16x16x32_bf16 v[40:43], v[92:95], v[232:235], v[40:43]
    ds_read_b64_tr_b16 v[86:87], v3 offset:26368
    s_waitcnt lgkmcnt(6)
    v_mfma_f32_16x16x32_bf16 v[44:47], v[96:99], v[228:231], v[44:47]
    ds_read_b64_tr_b16 v[88:89], v15 offset:25376
    v_mfma_f32_16x16x32_bf16 v[48:51], v[96:99], v[232:235], v[48:51]
    ds_read_b64_tr_b16 v[90:91], v15 offset:26400
    s_waitcnt lgkmcnt(6)
    v_mfma_f32_16x16x32_bf16 v[52:55], v[100:103], v[228:231], v[52:55]
    v_mfma_f32_16x16x32_bf16 v[56:59], v[100:103], v[232:235], v[56:59]
    s_barrier
    ds_read_b64_tr_b16 v[92:93], v3 offset:32768
    ds_read_b64_tr_b16 v[94:95], v3 offset:33792
    s_waitcnt lgkmcnt(6)
    v_mfma_f32_16x16x32_bf16 v[60:63], v[104:107], v[228:231], v[60:63]
    ds_read_b64_tr_b16 v[96:97], v15 offset:32800
    v_mfma_f32_16x16x32_bf16 v[64:67], v[104:107], v[232:235], v[64:67]
    ds_read_b64_tr_b16 v[98:99], v15 offset:33824
    s_mov_b32 s23, 0xf800
    buffer_load_dwordx4 v[216:219], v4, s[8:11], s23 offen offset:1024 sc1
    s_waitcnt lgkmcnt(6)
    v_mfma_f32_16x16x32_bf16 v[68:71], v[84:87], v[228:231], v[68:71]
    ds_read_b64_tr_b16 v[100:101], v3 offset:33024
    v_mfma_f32_16x16x32_bf16 v[72:75], v[84:87], v[232:235], v[72:75]
    ds_read_b64_tr_b16 v[102:103], v3 offset:34048
    s_waitcnt lgkmcnt(6)
    v_mfma_f32_16x16x32_bf16 v[76:79], v[88:91], v[228:231], v[76:79]
    ds_read_b64_tr_b16 v[104:105], v15 offset:33056
    v_mfma_f32_16x16x32_bf16 v[80:83], v[88:91], v[232:235], v[80:83]
    ds_read_b64_tr_b16 v[106:107], v15 offset:34080
    s_waitcnt vmcnt(7) lgkmcnt(6)
    v_mfma_f32_16x16x32_bf16 v[20:23], v[92:95], v[140:143], v[20:23]
    ds_read_b64_tr_b16 v[84:85], v3 offset:33280
    s_waitcnt vmcnt(6)
    v_mfma_f32_16x16x32_bf16 v[24:27], v[92:95], v[144:147], v[24:27]
    ds_read_b64_tr_b16 v[86:87], v3 offset:34304
    s_waitcnt lgkmcnt(6)
    v_mfma_f32_16x16x32_bf16 v[28:31], v[96:99], v[140:143], v[28:31]
    ds_read_b64_tr_b16 v[88:89], v15 offset:33312
    v_mfma_f32_16x16x32_bf16 v[32:35], v[96:99], v[144:147], v[32:35]
    ds_read_b64_tr_b16 v[90:91], v15 offset:34336
    s_waitcnt lgkmcnt(6)
    v_mfma_f32_16x16x32_bf16 v[36:39], v[100:103], v[140:143], v[36:39]
    ds_read_b64_tr_b16 v[92:93], v3 offset:33536
    v_mfma_f32_16x16x32_bf16 v[40:43], v[100:103], v[144:147], v[40:43]
    ds_read_b64_tr_b16 v[94:95], v3 offset:34560
    s_waitcnt lgkmcnt(6)
    v_mfma_f32_16x16x32_bf16 v[44:47], v[104:107], v[140:143], v[44:47]
    ds_read_b64_tr_b16 v[96:97], v15 offset:33568
    v_mfma_f32_16x16x32_bf16 v[48:51], v[104:107], v[144:147], v[48:51]
    ds_read_b64_tr_b16 v[98:99], v15 offset:34592
    s_waitcnt lgkmcnt(6)
    v_mfma_f32_16x16x32_bf16 v[52:55], v[84:87], v[140:143], v[52:55]
    ds_read_b64_tr_b16 v[100:101], v3 offset:40960
    v_mfma_f32_16x16x32_bf16 v[56:59], v[84:87], v[144:147], v[56:59]
    ds_read_b64_tr_b16 v[102:103], v3 offset:41984
    s_waitcnt lgkmcnt(6)
    v_mfma_f32_16x16x32_bf16 v[60:63], v[88:91], v[140:143], v[60:63]
    ds_read_b64_tr_b16 v[104:105], v15 offset:40992
    v_mfma_f32_16x16x32_bf16 v[64:67], v[88:91], v[144:147], v[64:67]
    ds_read_b64_tr_b16 v[106:107], v15 offset:42016
    s_waitcnt lgkmcnt(6)
    v_mfma_f32_16x16x32_bf16 v[68:71], v[92:95], v[140:143], v[68:71]
    ds_read_b64_tr_b16 v[84:85], v3 offset:41216
    v_mfma_f32_16x16x32_bf16 v[72:75], v[92:95], v[144:147], v[72:75]
    ds_read_b64_tr_b16 v[86:87], v3 offset:42240
    s_waitcnt lgkmcnt(6)
    v_mfma_f32_16x16x32_bf16 v[76:79], v[96:99], v[140:143], v[76:79]
    ds_read_b64_tr_b16 v[88:89], v15 offset:41248
    v_mfma_f32_16x16x32_bf16 v[80:83], v[96:99], v[144:147], v[80:83]
    ds_read_b64_tr_b16 v[90:91], v15 offset:42272
    s_waitcnt vmcnt(5) lgkmcnt(6)
    v_mfma_f32_16x16x32_bf16 v[20:23], v[100:103], v[148:151], v[20:23]
    ds_read_b64_tr_b16 v[92:93], v3 offset:41472
    s_waitcnt vmcnt(4)
    v_mfma_f32_16x16x32_bf16 v[24:27], v[100:103], v[152:155], v[24:27]
    ds_read_b64_tr_b16 v[94:95], v3 offset:42496
    s_waitcnt lgkmcnt(6)
    v_mfma_f32_16x16x32_bf16 v[28:31], v[104:107], v[148:151], v[28:31]
    ds_read_b64_tr_b16 v[96:97], v15 offset:41504
    v_mfma_f32_16x16x32_bf16 v[32:35], v[104:107], v[152:155], v[32:35]
    ds_read_b64_tr_b16 v[98:99], v15 offset:42528
    s_waitcnt lgkmcnt(6)
    v_mfma_f32_16x16x32_bf16 v[36:39], v[84:87], v[148:151], v[36:39]
    ds_read_b64_tr_b16 v[100:101], v3 offset:41728
    v_mfma_f32_16x16x32_bf16 v[40:43], v[84:87], v[152:155], v[40:43]
    ds_read_b64_tr_b16 v[102:103], v3 offset:42752
    s_waitcnt lgkmcnt(6)
    v_mfma_f32_16x16x32_bf16 v[44:47], v[88:91], v[148:151], v[44:47]
    ds_read_b64_tr_b16 v[104:105], v15 offset:41760
    v_mfma_f32_16x16x32_bf16 v[48:51], v[88:91], v[152:155], v[48:51]
    ds_read_b64_tr_b16 v[106:107], v15 offset:42784
    s_waitcnt lgkmcnt(6)
    v_mfma_f32_16x16x32_bf16 v[52:55], v[92:95], v[148:151], v[52:55]
    v_mfma_f32_16x16x32_bf16 v[56:59], v[92:95], v[152:155], v[56:59]
    s_barrier
    ds_read_b64_tr_b16 v[84:85], v3 offset:49152
    ds_read_b64_tr_b16 v[86:87], v3 offset:50176
    s_waitcnt lgkmcnt(6)
    v_mfma_f32_16x16x32_bf16 v[60:63], v[96:99], v[148:151], v[60:63]
    ds_read_b64_tr_b16 v[88:89], v15 offset:49184
    v_mfma_f32_16x16x32_bf16 v[64:67], v[96:99], v[152:155], v[64:67]
    ds_read_b64_tr_b16 v[90:91], v15 offset:50208
    s_waitcnt lgkmcnt(6)
    v_mfma_f32_16x16x32_bf16 v[68:71], v[100:103], v[148:151], v[68:71]
    ds_read_b64_tr_b16 v[92:93], v3 offset:49408
    v_mfma_f32_16x16x32_bf16 v[72:75], v[100:103], v[152:155], v[72:75]
    ds_read_b64_tr_b16 v[94:95], v3 offset:50432
    s_waitcnt lgkmcnt(6)
    v_mfma_f32_16x16x32_bf16 v[76:79], v[104:107], v[148:151], v[76:79]
    ds_read_b64_tr_b16 v[96:97], v15 offset:49440
    v_mfma_f32_16x16x32_bf16 v[80:83], v[104:107], v[152:155], v[80:83]
    ds_read_b64_tr_b16 v[98:99], v15 offset:50464
    s_waitcnt vmcnt(3) lgkmcnt(6)
    v_mfma_f32_16x16x32_bf16 v[20:23], v[84:87], v[204:207], v[20:23]
    ds_read_b64_tr_b16 v[100:101], v3 offset:49664
    s_waitcnt vmcnt(2)
    v_mfma_f32_16x16x32_bf16 v[24:27], v[84:87], v[208:211], v[24:27]
    ds_read_b64_tr_b16 v[102:103], v3 offset:50688
    s_waitcnt lgkmcnt(6)
    v_mfma_f32_16x16x32_bf16 v[28:31], v[88:91], v[204:207], v[28:31]
    ds_read_b64_tr_b16 v[104:105], v15 offset:49696
    v_mfma_f32_16x16x32_bf16 v[32:35], v[88:91], v[208:211], v[32:35]
    ds_read_b64_tr_b16 v[106:107], v15 offset:50720
    s_waitcnt lgkmcnt(6)
    v_mfma_f32_16x16x32_bf16 v[36:39], v[92:95], v[204:207], v[36:39]
    ds_read_b64_tr_b16 v[84:85], v3 offset:49920
    v_mfma_f32_16x16x32_bf16 v[40:43], v[92:95], v[208:211], v[40:43]
    ds_read_b64_tr_b16 v[86:87], v3 offset:50944
    s_waitcnt lgkmcnt(6)
    v_mfma_f32_16x16x32_bf16 v[44:47], v[96:99], v[204:207], v[44:47]
    ds_read_b64_tr_b16 v[88:89], v15 offset:49952
    v_mfma_f32_16x16x32_bf16 v[48:51], v[96:99], v[208:211], v[48:51]
    ds_read_b64_tr_b16 v[90:91], v15 offset:50976
    s_waitcnt lgkmcnt(6)
    v_mfma_f32_16x16x32_bf16 v[52:55], v[100:103], v[204:207], v[52:55]
    ds_read_b64_tr_b16 v[92:93], v3 offset:57344
    v_mfma_f32_16x16x32_bf16 v[56:59], v[100:103], v[208:211], v[56:59]
    ds_read_b64_tr_b16 v[94:95], v3 offset:58368
    s_waitcnt lgkmcnt(6)
    v_mfma_f32_16x16x32_bf16 v[60:63], v[104:107], v[204:207], v[60:63]
    ds_read_b64_tr_b16 v[96:97], v15 offset:57376
    v_mfma_f32_16x16x32_bf16 v[64:67], v[104:107], v[208:211], v[64:67]
    ds_read_b64_tr_b16 v[98:99], v15 offset:58400
    s_waitcnt lgkmcnt(6)
    v_mfma_f32_16x16x32_bf16 v[68:71], v[84:87], v[204:207], v[68:71]
    ds_read_b64_tr_b16 v[100:101], v3 offset:57600
    v_mfma_f32_16x16x32_bf16 v[72:75], v[84:87], v[208:211], v[72:75]
    ds_read_b64_tr_b16 v[102:103], v3 offset:58624
    s_waitcnt lgkmcnt(6)
    v_mfma_f32_16x16x32_bf16 v[76:79], v[88:91], v[204:207], v[76:79]
    ds_read_b64_tr_b16 v[104:105], v15 offset:57632
    v_mfma_f32_16x16x32_bf16 v[80:83], v[88:91], v[208:211], v[80:83]
    ds_read_b64_tr_b16 v[106:107], v15 offset:58656
    s_waitcnt vmcnt(1) lgkmcnt(6)
    v_mfma_f32_16x16x32_bf16 v[20:23], v[92:95], v[212:215], v[20:23]
    ds_read_b64_tr_b16 v[84:85], v3 offset:57856
    s_waitcnt vmcnt(0)
    v_mfma_f32_16x16x32_bf16 v[24:27], v[92:95], v[216:219], v[24:27]
    ds_read_b64_tr_b16 v[86:87], v3 offset:58880
    s_waitcnt lgkmcnt(6)
    v_mfma_f32_16x16x32_bf16 v[28:31], v[96:99], v[212:215], v[28:31]
    ds_read_b64_tr_b16 v[88:89], v15 offset:57888
    v_mfma_f32_16x16x32_bf16 v[32:35], v[96:99], v[216:219], v[32:35]
    ds_read_b64_tr_b16 v[90:91], v15 offset:58912
    s_waitcnt lgkmcnt(6)
    v_mfma_f32_16x16x32_bf16 v[36:39], v[100:103], v[212:215], v[36:39]
    ds_read_b64_tr_b16 v[92:93], v3 offset:58112
    v_mfma_f32_16x16x32_bf16 v[40:43], v[100:103], v[216:219], v[40:43]
    ds_read_b64_tr_b16 v[94:95], v3 offset:59136
    s_waitcnt lgkmcnt(6)
    v_mfma_f32_16x16x32_bf16 v[44:47], v[104:107], v[212:215], v[44:47]
    ds_read_b64_tr_b16 v[96:97], v15 offset:58144
    v_mfma_f32_16x16x32_bf16 v[48:51], v[104:107], v[216:219], v[48:51]
    ds_read_b64_tr_b16 v[98:99], v15 offset:59168
    s_waitcnt lgkmcnt(6)
    v_mfma_f32_16x16x32_bf16 v[52:55], v[84:87], v[212:215], v[52:55]
    v_mfma_f32_16x16x32_bf16 v[56:59], v[84:87], v[216:219], v[56:59]
    s_waitcnt lgkmcnt(4)
    v_mfma_f32_16x16x32_bf16 v[60:63], v[88:91], v[212:215], v[60:63]
    v_mfma_f32_16x16x32_bf16 v[64:67], v[88:91], v[216:219], v[64:67]
    s_waitcnt lgkmcnt(2)
    v_mfma_f32_16x16x32_bf16 v[68:71], v[92:95], v[212:215], v[68:71]
    v_mfma_f32_16x16x32_bf16 v[72:75], v[92:95], v[216:219], v[72:75]
    s_waitcnt lgkmcnt(0)
    v_mfma_f32_16x16x32_bf16 v[76:79], v[96:99], v[212:215], v[76:79]
    v_mfma_f32_16x16x32_bf16 v[80:83], v[96:99], v[216:219], v[80:83]
    s_mov_b32 s24, 0x3e0293ee
    v_cvt_pk_bf16_f32 v108, v20, v21
    v_cvt_pk_bf16_f32 v109, v22, v23
    v_cvt_pk_bf16_f32 v124, v24, v25
    v_cvt_pk_bf16_f32 v125, v26, v27
    v_cvt_pk_bf16_f32 v110, v28, v29
    v_cvt_pk_bf16_f32 v111, v30, v31
    v_cvt_pk_bf16_f32 v126, v32, v33
    v_cvt_pk_bf16_f32 v127, v34, v35
    v_cvt_pk_bf16_f32 v112, v36, v37
    v_cvt_pk_bf16_f32 v113, v38, v39
    v_cvt_pk_bf16_f32 v128, v40, v41
    v_cvt_pk_bf16_f32 v129, v42, v43
    v_cvt_pk_bf16_f32 v114, v44, v45
    v_cvt_pk_bf16_f32 v115, v46, v47
    v_cvt_pk_bf16_f32 v130, v48, v49
    v_cvt_pk_bf16_f32 v131, v50, v51
    v_cvt_pk_bf16_f32 v116, v52, v53
    v_cvt_pk_bf16_f32 v117, v54, v55
    v_cvt_pk_bf16_f32 v132, v56, v57
    v_cvt_pk_bf16_f32 v133, v58, v59
    v_cvt_pk_bf16_f32 v118, v60, v61
    v_cvt_pk_bf16_f32 v119, v62, v63
    v_cvt_pk_bf16_f32 v134, v64, v65
    v_cvt_pk_bf16_f32 v135, v66, v67
    v_cvt_pk_bf16_f32 v120, v68, v69
    v_cvt_pk_bf16_f32 v121, v70, v71
    v_cvt_pk_bf16_f32 v136, v72, v73
    v_cvt_pk_bf16_f32 v137, v74, v75
    v_cvt_pk_bf16_f32 v122, v76, v77
    v_cvt_pk_bf16_f32 v123, v78, v79
    v_cvt_pk_bf16_f32 v138, v80, v81
    v_cvt_pk_bf16_f32 v139, v82, v83
    v_add_u32 v2, 0x10000, v1
    v_add_u32 v3, 0x20000, v1
    s_barrier
    ds_read_b128 v[84:87], v2 offset:0
    ds_read_b128 v[88:91], v2 offset:1024
    ds_read_b128 v[92:95], v2 offset:2048
    ds_read_b128 v[96:99], v2 offset:3072
    s_waitcnt lgkmcnt(3)
    v_mfma_f32_16x16x32_bf16 v[140:143], v[84:87], v[108:111], 0
    v_mfma_f32_16x16x32_bf16 v[144:147], v[84:87], v[124:127], 0
    ds_read_b128 v[100:103], v2 offset:4096
    s_waitcnt lgkmcnt(3)
    v_mfma_f32_16x16x32_bf16 v[148:151], v[88:91], v[108:111], 0
    v_mfma_f32_16x16x32_bf16 v[152:155], v[88:91], v[124:127], 0
    ds_read_b128 v[104:107], v2 offset:5120
    s_mov_b64 s[64:65], s[52:53]
    s_mov_b32 s66, 0x800
    s_mov_b32 s67, 0x20000
    s_mov_b64 s[68:69], s[54:55]
    s_mov_b32 s70, 0xc00000
    s_mov_b32 s71, 0x20000
    s_and_b32 s100, s2, 7
    s_lshl_b32 s100, s100, 5
    s_lshr_b32 s26, s2, 3
    s_add_u32 s100, s100, s26
    v_lshrrev_b32 v13, 1, v8
    v_lshlrev_b32 v14, 4, v13
    buffer_load_dwordx4 v[244:247], v14, s[64:67], 0 offen
    s_mov_b32 s26, 98304
    v_mul_lo_u32 v13, s26, v13
    v_and_b32 v14, 1, v8
    v_lshl_add_u32 v13, v14, 4, v13
    s_lshl_b32 s25, s100, 5
    s_add_u32 s25, s25, 4096
    s_waitcnt lgkmcnt(3)
    v_mfma_f32_16x16x32_bf16 v[140:143], v[92:95], v[112:115], v[140:143]
    v_mfma_f32_16x16x32_bf16 v[144:147], v[92:95], v[128:131], v[144:147]
    ds_read_b128 v[84:87], v2 offset:6144
    s_waitcnt lgkmcnt(3)
    v_mfma_f32_16x16x32_bf16 v[148:151], v[96:99], v[112:115], v[148:151]
    v_mfma_f32_16x16x32_bf16 v[152:155], v[96:99], v[128:131], v[152:155]
    ds_read_b128 v[88:91], v2 offset:7168
    s_add_u32 s26, s25, 0
    buffer_load_dwordx4 v[204:207], v13, s[68:71], s26 offen
    s_waitcnt lgkmcnt(3)
    v_mfma_f32_16x16x32_bf16 v[140:143], v[100:103], v[116:119], v[140:143]
    v_mfma_f32_16x16x32_bf16 v[144:147], v[100:103], v[132:135], v[144:147]
    s_barrier
    ds_read_b128 v[92:95], v2 offset:16384
    s_waitcnt lgkmcnt(3)
    v_mfma_f32_16x16x32_bf16 v[148:151], v[104:107], v[116:119], v[148:151]
    v_mfma_f32_16x16x32_bf16 v[152:155], v[104:107], v[132:135], v[152:155]
    ds_read_b128 v[96:99], v2 offset:17408
    s_add_u32 s26, s25, 12288
    buffer_load_dwordx4 v[208:211], v13, s[68:71], s26 offen
    s_waitcnt lgkmcnt(3)
    v_mfma_f32_16x16x32_bf16 v[140:143], v[84:87], v[120:123], v[140:143]
    v_mfma_f32_16x16x32_bf16 v[144:147], v[84:87], v[136:139], v[144:147]
    ds_read_b128 v[100:103], v2 offset:18432
    s_waitcnt lgkmcnt(3)
    v_mfma_f32_16x16x32_bf16 v[148:151], v[88:91], v[120:123], v[148:151]
    v_mfma_f32_16x16x32_bf16 v[152:155], v[88:91], v[136:139], v[152:155]
    ds_read_b128 v[104:107], v2 offset:19456
    s_add_u32 s26, s25, 24576
    buffer_load_dwordx4 v[212:215], v13, s[68:71], s26 offen
    s_waitcnt lgkmcnt(3)
    v_mfma_f32_16x16x32_bf16 v[156:159], v[92:95], v[108:111], 0
    v_mfma_f32_16x16x32_bf16 v[160:163], v[92:95], v[124:127], 0
    ds_read_b128 v[84:87], v2 offset:20480
    s_waitcnt lgkmcnt(3)
    v_mfma_f32_16x16x32_bf16 v[164:167], v[96:99], v[108:111], 0
    v_mfma_f32_16x16x32_bf16 v[168:171], v[96:99], v[124:127], 0
    ds_read_b128 v[88:91], v2 offset:21504
    s_add_u32 s26, s25, 36864
    buffer_load_dwordx4 v[216:219], v13, s[68:71], s26 offen
    s_waitcnt lgkmcnt(3)
    v_mfma_f32_16x16x32_bf16 v[156:159], v[100:103], v[112:115], v[156:159]
    v_mfma_f32_16x16x32_bf16 v[160:163], v[100:103], v[128:131], v[160:163]
    ds_read_b128 v[92:95], v2 offset:22528
    s_waitcnt lgkmcnt(3)
    v_mfma_f32_16x16x32_bf16 v[164:167], v[104:107], v[112:115], v[164:167]
    v_max3_f32 v9, v140, v141, v142
    v_mfma_f32_16x16x32_bf16 v[168:171], v[104:107], v[128:131], v[168:171]
    ds_read_b128 v[96:99], v2 offset:23552
    v_max3_f32 v9, v9, v143, v148
    s_add_u32 s26, s25, 49152
    buffer_load_dwordx4 v[220:223], v13, s[68:71], s26 offen
    s_waitcnt lgkmcnt(3)
    v_mfma_f32_16x16x32_bf16 v[156:159], v[84:87], v[116:119], v[156:159]
    v_max3_f32 v9, v9, v149, v150
    v_mfma_f32_16x16x32_bf16 v[160:163], v[84:87], v[132:135], v[160:163]
    s_barrier
    ds_read_b128 v[100:103], v2 offset:32768
    v_max_f32 v9, v9, v151
    s_waitcnt lgkmcnt(3)
    v_mfma_f32_16x16x32_bf16 v[164:167], v[88:91], v[116:119], v[164:167]
    v_max3_f32 v10, v144, v145, v146
    v_mfma_f32_16x16x32_bf16 v[168:171], v[88:91], v[132:135], v[168:171]
    ds_read_b128 v[104:107], v2 offset:33792
    v_max3_f32 v10, v10, v147, v152
    s_add_u32 s26, s25, 61440
    buffer_load_dwordx4 v[224:227], v13, s[68:71], s26 offen
    s_waitcnt lgkmcnt(3)
    v_mfma_f32_16x16x32_bf16 v[156:159], v[92:95], v[120:123], v[156:159]
    v_max3_f32 v10, v10, v153, v154
    v_mfma_f32_16x16x32_bf16 v[160:163], v[92:95], v[136:139], v[160:163]
    ds_read_b128 v[84:87], v2 offset:34816
    v_max_f32 v10, v10, v155
    s_waitcnt lgkmcnt(3)
    v_mfma_f32_16x16x32_bf16 v[164:167], v[96:99], v[120:123], v[164:167]
    v_mfma_f32_16x16x32_bf16 v[168:171], v[96:99], v[136:139], v[168:171]
    ds_read_b128 v[88:91], v2 offset:35840
    v_max3_f32 v9, v9, v156, v157
    v_max3_f32 v9, v9, v158, v159
    s_nop 3
    v_max3_f32 v9, v9, v164, v165
    v_max3_f32 v9, v9, v166, v167
    v_max3_f32 v10, v10, v160, v161
    v_max3_f32 v10, v10, v162, v163
    v_max3_f32 v10, v10, v168, v169
    v_max3_f32 v10, v10, v170, v171
    v_mov_b32 v11, v9
    v_mov_b32 v12, v10
    s_nop 0
    v_permlane16_swap_b32 v9, v11
    v_permlane16_swap_b32 v10, v12
    v_max_f32 v9, v9, v11
    v_max_f32 v10, v10, v12
    v_mov_b32 v11, v9
    v_mov_b32 v12, v10
    s_nop 0
    v_permlane32_swap_b32 v9, v11
    v_permlane32_swap_b32 v10, v12
    v_max_f32 v9, v9, v11
    v_max_f32 v10, v10, v12
    v_sub_f32 v172, 0, v9
    v_sub_f32 v173, 0, v9
    v_sub_f32 v174, 0, v9
    v_sub_f32 v175, 0, v9
    v_sub_f32 v176, 0, v10
    v_sub_f32 v177, 0, v10
    v_sub_f32 v178, 0, v10
    v_sub_f32 v179, 0, v10
    v_add_f32 v140, v140, v172
    v_add_f32 v141, v141, v172
    v_exp_f32 v140, v140
    v_exp_f32 v141, v141
    s_nop 0
    v_add_f32 v15, v140, v141
    v_cvt_pk_bf16_f32 v188, v140, v141
    v_add_f32 v142, v142, v172
    v_add_f32 v143, v143, v172
    v_exp_f32 v142, v142
    v_exp_f32 v143, v143
    v_add_f32 v15, v15, v142
    v_add_f32 v15, v15, v143
    v_cvt_pk_bf16_f32 v189, v142, v143
    v_add_f32 v144, v144, v176
    v_add_f32 v145, v145, v176
    v_exp_f32 v144, v144
    v_exp_f32 v145, v145
    s_nop 0
    v_add_f32 v16, v144, v145
    v_cvt_pk_bf16_f32 v192, v144, v145
    v_add_f32 v146, v146, v176
    v_add_f32 v147, v147, v176
    v_exp_f32 v146, v146
    v_exp_f32 v147, v147
    v_add_f32 v16, v16, v146
    v_add_f32 v16, v16, v147
    v_cvt_pk_bf16_f32 v193, v146, v147
    v_add_f32 v148, v148, v172
    v_add_f32 v149, v149, v172
    v_exp_f32 v148, v148
    v_exp_f32 v149, v149
    v_add_f32 v15, v15, v148
    v_add_f32 v15, v15, v149
    v_cvt_pk_bf16_f32 v190, v148, v149
    v_add_f32 v150, v150, v172
    v_add_f32 v151, v151, v172
    v_exp_f32 v150, v150
    v_exp_f32 v151, v151
    v_add_f32 v15, v15, v150
    v_add_f32 v15, v15, v151
    v_cvt_pk_bf16_f32 v191, v150, v151
    v_add_f32 v152, v152, v176
    v_add_f32 v153, v153, v176
    v_exp_f32 v152, v152
    v_exp_f32 v153, v153
    v_add_f32 v16, v16, v152
    v_add_f32 v16, v16, v153
    v_cvt_pk_bf16_f32 v194, v152, v153
    v_add_f32 v154, v154, v176
    v_add_f32 v155, v155, v176
    v_exp_f32 v154, v154
    v_exp_f32 v155, v155
    v_add_f32 v16, v16, v154
    v_add_f32 v16, v16, v155
    v_cvt_pk_bf16_f32 v195, v154, v155
    s_add_u32 s26, s25, 73728
    buffer_load_dwordx4 v[228:231], v13, s[68:71], s26 offen
    s_waitcnt lgkmcnt(3)
    v_mfma_f32_16x16x32_bf16 v[140:143], v[100:103], v[108:111], v[172:175]
    v_add_f32 v156, v156, v172
    v_add_f32 v157, v157, v172
    v_mfma_f32_16x16x32_bf16 v[144:147], v[100:103], v[124:127], v[176:179]
    ds_read_b128 v[92:95], v2 offset:36864
    v_exp_f32 v156, v156
    v_exp_f32 v157, v157
    s_waitcnt lgkmcnt(3)
    v_mfma_f32_16x16x32_bf16 v[148:151], v[104:107], v[108:111], v[172:175]
    v_add_f32 v15, v15, v156
    v_add_f32 v15, v15, v157
    v_mfma_f32_16x16x32_bf16 v[152:155], v[104:107], v[124:127], v[176:179]
    ds_read_b128 v[96:99], v2 offset:37888
    v_cvt_pk_bf16_f32 v196, v156, v157
    s_add_u32 s26, s25, 86016
    buffer_load_dwordx4 v[232:235], v13, s[68:71], s26 offen
    s_waitcnt lgkmcnt(3)
    v_mfma_f32_16x16x32_bf16 v[140:143], v[84:87], v[112:115], v[140:143]
    v_add_f32 v158, v158, v172
    v_add_f32 v159, v159, v172
    v_mfma_f32_16x16x32_bf16 v[144:147], v[84:87], v[128:131], v[144:147]
    ds_read_b128 v[100:103], v2 offset:38912
    v_exp_f32 v158, v158
    v_exp_f32 v159, v159
    s_waitcnt lgkmcnt(3)
    v_mfma_f32_16x16x32_bf16 v[148:151], v[88:91], v[112:115], v[148:151]
    v_add_f32 v15, v15, v158
    v_add_f32 v15, v15, v159
    v_mfma_f32_16x16x32_bf16 v[152:155], v[88:91], v[128:131], v[152:155]
    ds_read_b128 v[104:107], v2 offset:39936
    v_cvt_pk_bf16_f32 v197, v158, v159
    s_waitcnt lgkmcnt(3)
    v_mfma_f32_16x16x32_bf16 v[140:143], v[92:95], v[116:119], v[140:143]
    v_add_f32 v160, v160, v176
    v_add_f32 v161, v161, v176
    v_mfma_f32_16x16x32_bf16 v[144:147], v[92:95], v[132:135], v[144:147]
    ds_read_b128 v[84:87], v2 offset:8192
    v_exp_f32 v160, v160
    v_exp_f32 v161, v161
    s_waitcnt lgkmcnt(3)
    v_mfma_f32_16x16x32_bf16 v[148:151], v[96:99], v[116:119], v[148:151]
    v_add_f32 v16, v16, v160
    v_add_f32 v16, v16, v161
    v_mfma_f32_16x16x32_bf16 v[152:155], v[96:99], v[132:135], v[152:155]
    ds_read_b128 v[88:91], v2 offset:9216
    v_cvt_pk_bf16_f32 v200, v160, v161
    s_waitcnt lgkmcnt(3)
    v_mfma_f32_16x16x32_bf16 v[140:143], v[100:103], v[120:123], v[140:143]
    v_add_f32 v162, v162, v176
    v_add_f32 v163, v163, v176
    v_mfma_f32_16x16x32_bf16 v[144:147], v[100:103], v[136:139], v[144:147]
    ds_read_b128 v[92:95], v2 offset:10240
    v_exp_f32 v162, v162
    v_exp_f32 v163, v163
    s_waitcnt lgkmcnt(3)
    v_mfma_f32_16x16x32_bf16 v[148:151], v[104:107], v[120:123], v[148:151]
    v_add_f32 v16, v16, v162
    v_add_f32 v16, v16, v163
    v_mfma_f32_16x16x32_bf16 v[152:155], v[104:107], v[136:139], v[152:155]
    ds_read_b128 v[96:99], v2 offset:11264
    v_cvt_pk_bf16_f32 v201, v162, v163
    s_waitcnt lgkmcnt(3)
    v_mfma_f32_16x16x32_bf16 v[20:23], v[84:87], v[188:191], 0
    v_add_f32 v164, v164, v172
    v_add_f32 v165, v165, v172
    v_mfma_f32_16x16x32_bf16 v[24:27], v[84:87], v[192:195], 0
    ds_read_b128 v[100:103], v2 offset:12288
    v_exp_f32 v164, v164
    v_exp_f32 v165, v165
    s_waitcnt lgkmcnt(3)
    v_mfma_f32_16x16x32_bf16 v[28:31], v[88:91], v[188:191], 0
    v_add_f32 v15, v15, v164
    v_add_f32 v15, v15, v165
    v_mfma_f32_16x16x32_bf16 v[32:35], v[88:91], v[192:195], 0
    ds_read_b128 v[104:107], v2 offset:13312
    v_cvt_pk_bf16_f32 v198, v164, v165
    s_waitcnt lgkmcnt(3)
    v_mfma_f32_16x16x32_bf16 v[36:39], v[92:95], v[188:191], 0
    v_add_f32 v166, v166, v172
    v_add_f32 v167, v167, v172
    v_mfma_f32_16x16x32_bf16 v[40:43], v[92:95], v[192:195], 0
    ds_read_b128 v[84:87], v2 offset:14336
    v_exp_f32 v166, v166
    v_exp_f32 v167, v167
    s_waitcnt lgkmcnt(3)
    v_mfma_f32_16x16x32_bf16 v[44:47], v[96:99], v[188:191], 0
    v_add_f32 v15, v15, v166
    v_add_f32 v15, v15, v167
    v_mfma_f32_16x16x32_bf16 v[48:51], v[96:99], v[192:195], 0
    ds_read_b128 v[88:91], v2 offset:15360
    v_cvt_pk_bf16_f32 v199, v166, v167
    s_waitcnt lgkmcnt(3)
    v_mfma_f32_16x16x32_bf16 v[52:55], v[100:103], v[188:191], 0
    v_add_f32 v168, v168, v176
    v_add_f32 v169, v169, v176
    v_mfma_f32_16x16x32_bf16 v[56:59], v[100:103], v[192:195], 0
    s_barrier
    ds_read_b128 v[92:95], v2 offset:49152
    v_exp_f32 v168, v168
    v_exp_f32 v169, v169
    s_waitcnt lgkmcnt(3)
    v_mfma_f32_16x16x32_bf16 v[60:63], v[104:107], v[188:191], 0
    v_add_f32 v16, v16, v168
    v_add_f32 v16, v16, v169
    v_mfma_f32_16x16x32_bf16 v[64:67], v[104:107], v[192:195], 0
    ds_read_b128 v[96:99], v2 offset:50176
    v_cvt_pk_bf16_f32 v202, v168, v169
    s_waitcnt lgkmcnt(3)
    v_mfma_f32_16x16x32_bf16 v[68:71], v[84:87], v[188:191], 0
    v_add_f32 v170, v170, v176
    v_add_f32 v171, v171, v176
    v_mfma_f32_16x16x32_bf16 v[72:75], v[84:87], v[192:195], 0
    ds_read_b128 v[100:103], v2 offset:51200
    v_exp_f32 v170, v170
    v_exp_f32 v171, v171
    s_waitcnt lgkmcnt(3)
    v_mfma_f32_16x16x32_bf16 v[76:79], v[88:91], v[188:191], 0
    v_add_f32 v16, v16, v170
    v_add_f32 v16, v16, v171
    v_mfma_f32_16x16x32_bf16 v[80:83], v[88:91], v[192:195], 0
    ds_read_b128 v[104:107], v2 offset:52224
    v_cvt_pk_bf16_f32 v203, v170, v171
    s_waitcnt lgkmcnt(3)
    v_mfma_f32_16x16x32_bf16 v[156:159], v[92:95], v[108:111], v[172:175]
    v_exp_f32 v140, v140
    v_exp_f32 v141, v141
    v_mfma_f32_16x16x32_bf16 v[160:163], v[92:95], v[124:127], v[176:179]
    ds_read_b128 v[84:87], v2 offset:53248
    v_add_f32 v15, v15, v140
    s_waitcnt lgkmcnt(3)
    v_mfma_f32_16x16x32_bf16 v[164:167], v[96:99], v[108:111], v[172:175]
    v_add_f32 v15, v15, v141
    v_mfma_f32_16x16x32_bf16 v[168:171], v[96:99], v[124:127], v[176:179]
    ds_read_b128 v[88:91], v2 offset:54272
    v_cvt_pk_bf16_f32 v188, v140, v141
    s_waitcnt lgkmcnt(3)
    v_mfma_f32_16x16x32_bf16 v[156:159], v[100:103], v[112:115], v[156:159]
    v_exp_f32 v142, v142
    v_exp_f32 v143, v143
    v_mfma_f32_16x16x32_bf16 v[160:163], v[100:103], v[128:131], v[160:163]
    ds_read_b128 v[92:95], v2 offset:55296
    v_add_f32 v15, v15, v142
    s_waitcnt lgkmcnt(3)
    v_mfma_f32_16x16x32_bf16 v[164:167], v[104:107], v[112:115], v[164:167]
    v_add_f32 v15, v15, v143
    v_mfma_f32_16x16x32_bf16 v[168:171], v[104:107], v[128:131], v[168:171]
    ds_read_b128 v[96:99], v2 offset:56320
    v_cvt_pk_bf16_f32 v189, v142, v143
    s_waitcnt lgkmcnt(3)
    v_mfma_f32_16x16x32_bf16 v[156:159], v[84:87], v[116:119], v[156:159]
    v_exp_f32 v144, v144
    v_exp_f32 v145, v145
    v_mfma_f32_16x16x32_bf16 v[160:163], v[84:87], v[132:135], v[160:163]
    ds_read_b128 v[100:103], v2 offset:24576
    v_add_f32 v16, v16, v144
    s_waitcnt lgkmcnt(3)
    v_mfma_f32_16x16x32_bf16 v[164:167], v[88:91], v[116:119], v[164:167]
    v_add_f32 v16, v16, v145
    v_mfma_f32_16x16x32_bf16 v[168:171], v[88:91], v[132:135], v[168:171]
    ds_read_b128 v[104:107], v2 offset:25600
    v_cvt_pk_bf16_f32 v192, v144, v145
    s_waitcnt lgkmcnt(3)
    v_mfma_f32_16x16x32_bf16 v[156:159], v[92:95], v[120:123], v[156:159]
    v_exp_f32 v146, v146
    v_exp_f32 v147, v147
    v_mfma_f32_16x16x32_bf16 v[160:163], v[92:95], v[136:139], v[160:163]
    ds_read_b128 v[84:87], v2 offset:26624
    v_add_f32 v16, v16, v146
    s_waitcnt lgkmcnt(3)
    v_mfma_f32_16x16x32_bf16 v[164:167], v[96:99], v[120:123], v[164:167]
    v_add_f32 v16, v16, v147
    v_mfma_f32_16x16x32_bf16 v[168:171], v[96:99], v[136:139], v[168:171]
    ds_read_b128 v[88:91], v2 offset:27648
    v_cvt_pk_bf16_f32 v193, v146, v147
    s_waitcnt lgkmcnt(3)
    v_mfma_f32_16x16x32_bf16 v[20:23], v[100:103], v[196:199], v[20:23]
    v_exp_f32 v148, v148
    v_exp_f32 v149, v149
    v_mfma_f32_16x16x32_bf16 v[24:27], v[100:103], v[200:203], v[24:27]
    ds_read_b128 v[92:95], v2 offset:28672
    v_add_f32 v15, v15, v148
    s_waitcnt lgkmcnt(3)
    v_mfma_f32_16x16x32_bf16 v[28:31], v[104:107], v[196:199], v[28:31]
    v_add_f32 v15, v15, v149
    v_mfma_f32_16x16x32_bf16 v[32:35], v[104:107], v[200:203], v[32:35]
    ds_read_b128 v[96:99], v2 offset:29696
    v_cvt_pk_bf16_f32 v190, v148, v149
    s_waitcnt lgkmcnt(3)
    v_mfma_f32_16x16x32_bf16 v[36:39], v[84:87], v[196:199], v[36:39]
    v_exp_f32 v150, v150
    v_exp_f32 v151, v151
    v_mfma_f32_16x16x32_bf16 v[40:43], v[84:87], v[200:203], v[40:43]
    ds_read_b128 v[100:103], v2 offset:30720
    v_add_f32 v15, v15, v150
    s_waitcnt lgkmcnt(3)
    v_mfma_f32_16x16x32_bf16 v[44:47], v[88:91], v[196:199], v[44:47]
    v_add_f32 v15, v15, v151
    v_mfma_f32_16x16x32_bf16 v[48:51], v[88:91], v[200:203], v[48:51]
    ds_read_b128 v[104:107], v2 offset:31744
    v_cvt_pk_bf16_f32 v191, v150, v151
    s_waitcnt lgkmcnt(3)
    v_mfma_f32_16x16x32_bf16 v[52:55], v[92:95], v[196:199], v[52:55]
    v_exp_f32 v152, v152
    v_exp_f32 v153, v153
    v_mfma_f32_16x16x32_bf16 v[56:59], v[92:95], v[200:203], v[56:59]
    s_barrier
    ds_read_b128 v[84:87], v3 offset:0
    v_add_f32 v16, v16, v152
    s_waitcnt lgkmcnt(3)
    v_mfma_f32_16x16x32_bf16 v[60:63], v[96:99], v[196:199], v[60:63]
    v_add_f32 v16, v16, v153
    v_mfma_f32_16x16x32_bf16 v[64:67], v[96:99], v[200:203], v[64:67]
    ds_read_b128 v[88:91], v3 offset:1024
    v_cvt_pk_bf16_f32 v194, v152, v153
    s_waitcnt lgkmcnt(3)
    v_mfma_f32_16x16x32_bf16 v[68:71], v[100:103], v[196:199], v[68:71]
    v_exp_f32 v154, v154
    v_exp_f32 v155, v155
    v_mfma_f32_16x16x32_bf16 v[72:75], v[100:103], v[200:203], v[72:75]
    ds_read_b128 v[92:95], v3 offset:2048
    v_add_f32 v16, v16, v154
    s_waitcnt lgkmcnt(3)
    v_mfma_f32_16x16x32_bf16 v[76:79], v[104:107], v[196:199], v[76:79]
    v_add_f32 v16, v16, v155
    v_mfma_f32_16x16x32_bf16 v[80:83], v[104:107], v[200:203], v[80:83]
    ds_read_b128 v[96:99], v3 offset:3072
    v_cvt_pk_bf16_f32 v195, v154, v155
    s_waitcnt lgkmcnt(3)
    v_mfma_f32_16x16x32_bf16 v[140:143], v[84:87], v[108:111], v[172:175]
    v_exp_f32 v156, v156
    v_exp_f32 v157, v157
    v_mfma_f32_16x16x32_bf16 v[144:147], v[84:87], v[124:127], v[176:179]
    ds_read_b128 v[100:103], v3 offset:4096
    v_add_f32 v15, v15, v156
    s_waitcnt lgkmcnt(3)
    v_mfma_f32_16x16x32_bf16 v[148:151], v[88:91], v[108:111], v[172:175]
    v_add_f32 v15, v15, v157
    v_mfma_f32_16x16x32_bf16 v[152:155], v[88:91], v[124:127], v[176:179]
    ds_read_b128 v[104:107], v3 offset:5120
    v_cvt_pk_bf16_f32 v196, v156, v157
    s_waitcnt lgkmcnt(3)
    v_mfma_f32_16x16x32_bf16 v[140:143], v[92:95], v[112:115], v[140:143]
    v_exp_f32 v158, v158
    v_exp_f32 v159, v159
    v_mfma_f32_16x16x32_bf16 v[144:147], v[92:95], v[128:131], v[144:147]
    ds_read_b128 v[84:87], v3 offset:6144
    v_add_f32 v15, v15, v158
    s_waitcnt lgkmcnt(3)
    v_mfma_f32_16x16x32_bf16 v[148:151], v[96:99], v[112:115], v[148:151]
    v_add_f32 v15, v15, v159
    v_mfma_f32_16x16x32_bf16 v[152:155], v[96:99], v[128:131], v[152:155]
    ds_read_b128 v[88:91], v3 offset:7168
    v_cvt_pk_bf16_f32 v197, v158, v159
    s_waitcnt lgkmcnt(3)
    v_mfma_f32_16x16x32_bf16 v[140:143], v[100:103], v[116:119], v[140:143]
    v_exp_f32 v160, v160
    v_exp_f32 v161, v161
    v_mfma_f32_16x16x32_bf16 v[144:147], v[100:103], v[132:135], v[144:147]
    ds_read_b128 v[92:95], v2 offset:40960
    v_add_f32 v16, v16, v160
    s_waitcnt lgkmcnt(3)
    v_mfma_f32_16x16x32_bf16 v[148:151], v[104:107], v[116:119], v[148:151]
    v_add_f32 v16, v16, v161
    v_mfma_f32_16x16x32_bf16 v[152:155], v[104:107], v[132:135], v[152:155]
    ds_read_b128 v[96:99], v2 offset:41984
    v_cvt_pk_bf16_f32 v200, v160, v161
    s_waitcnt lgkmcnt(3)
    v_mfma_f32_16x16x32_bf16 v[140:143], v[84:87], v[120:123], v[140:143]
    v_exp_f32 v162, v162
    v_exp_f32 v163, v163
    v_mfma_f32_16x16x32_bf16 v[144:147], v[84:87], v[136:139], v[144:147]
    ds_read_b128 v[100:103], v2 offset:43008
    v_add_f32 v16, v16, v162
    s_waitcnt lgkmcnt(3)
    v_mfma_f32_16x16x32_bf16 v[148:151], v[88:91], v[120:123], v[148:151]
    v_add_f32 v16, v16, v163
    v_mfma_f32_16x16x32_bf16 v[152:155], v[88:91], v[136:139], v[152:155]
    ds_read_b128 v[104:107], v2 offset:44032
    v_cvt_pk_bf16_f32 v201, v162, v163
    s_waitcnt lgkmcnt(3)
    v_mfma_f32_16x16x32_bf16 v[20:23], v[92:95], v[188:191], v[20:23]
    v_exp_f32 v164, v164
    v_exp_f32 v165, v165
    v_mfma_f32_16x16x32_bf16 v[24:27], v[92:95], v[192:195], v[24:27]
    ds_read_b128 v[84:87], v2 offset:45056
    v_add_f32 v15, v15, v164
    s_waitcnt lgkmcnt(3)
    v_mfma_f32_16x16x32_bf16 v[28:31], v[96:99], v[188:191], v[28:31]
    v_add_f32 v15, v15, v165
    v_mfma_f32_16x16x32_bf16 v[32:35], v[96:99], v[192:195], v[32:35]
    ds_read_b128 v[88:91], v2 offset:46080
    v_cvt_pk_bf16_f32 v198, v164, v165
    s_waitcnt lgkmcnt(3)
    v_mfma_f32_16x16x32_bf16 v[36:39], v[100:103], v[188:191], v[36:39]
    v_exp_f32 v166, v166
    v_exp_f32 v167, v167
    v_mfma_f32_16x16x32_bf16 v[40:43], v[100:103], v[192:195], v[40:43]
    ds_read_b128 v[92:95], v2 offset:47104
    v_add_f32 v15, v15, v166
    s_waitcnt lgkmcnt(3)
    v_mfma_f32_16x16x32_bf16 v[44:47], v[104:107], v[188:191], v[44:47]
    v_add_f32 v15, v15, v167
    v_mfma_f32_16x16x32_bf16 v[48:51], v[104:107], v[192:195], v[48:51]
    ds_read_b128 v[96:99], v2 offset:48128
    v_cvt_pk_bf16_f32 v199, v166, v167
    s_waitcnt lgkmcnt(3)
    v_mfma_f32_16x16x32_bf16 v[52:55], v[84:87], v[188:191], v[52:55]
    v_exp_f32 v168, v168
    v_exp_f32 v169, v169
    v_mfma_f32_16x16x32_bf16 v[56:59], v[84:87], v[192:195], v[56:59]
    s_barrier
    ds_read_b128 v[100:103], v3 offset:16384
    v_add_f32 v16, v16, v168
    s_waitcnt lgkmcnt(3)
    v_mfma_f32_16x16x32_bf16 v[60:63], v[88:91], v[188:191], v[60:63]
    v_add_f32 v16, v16, v169
    v_mfma_f32_16x16x32_bf16 v[64:67], v[88:91], v[192:195], v[64:67]
    ds_read_b128 v[104:107], v3 offset:17408
    v_cvt_pk_bf16_f32 v202, v168, v169
    s_waitcnt lgkmcnt(3)
    v_mfma_f32_16x16x32_bf16 v[68:71], v[92:95], v[188:191], v[68:71]
    v_exp_f32 v170, v170
    v_exp_f32 v171, v171
    v_mfma_f32_16x16x32_bf16 v[72:75], v[92:95], v[192:195], v[72:75]
    ds_read_b128 v[84:87], v3 offset:18432
    v_add_f32 v16, v16, v170
    s_waitcnt lgkmcnt(3)
    v_mfma_f32_16x16x32_bf16 v[76:79], v[96:99], v[188:191], v[76:79]
    v_add_f32 v16, v16, v171
    v_mfma_f32_16x16x32_bf16 v[80:83], v[96:99], v[192:195], v[80:83]
    ds_read_b128 v[88:91], v3 offset:19456
    v_cvt_pk_bf16_f32 v203, v170, v171
    s_waitcnt lgkmcnt(3)
    v_mfma_f32_16x16x32_bf16 v[156:159], v[100:103], v[108:111], v[172:175]
    v_exp_f32 v140, v140
    v_exp_f32 v141, v141
    v_mfma_f32_16x16x32_bf16 v[160:163], v[100:103], v[124:127], v[176:179]
    ds_read_b128 v[92:95], v3 offset:20480
    v_add_f32 v15, v15, v140
    s_waitcnt vmcnt(8)
    v_lshlrev_b32 v236, 16, v244
    v_and_b32 v237, 0xffff0000, v244
    v_lshlrev_b32 v238, 16, v245
    v_and_b32 v239, 0xffff0000, v245
    v_lshlrev_b32 v240, 16, v246
    v_and_b32 v241, 0xffff0000, v246
    v_lshlrev_b32 v242, 16, v247
    s_waitcnt lgkmcnt(3)
    v_mfma_f32_16x16x32_bf16 v[164:167], v[104:107], v[108:111], v[172:175]
    v_add_f32 v15, v15, v141
    v_mfma_f32_16x16x32_bf16 v[168:171], v[104:107], v[124:127], v[176:179]
    ds_read_b128 v[96:99], v3 offset:21504
    v_cvt_pk_bf16_f32 v188, v140, v141
    v_and_b32 v243, 0xffff0000, v247
    v_mul_f32 v4, 0xbfb8aa3b, v236
    v_exp_f32 v4, v4
    s_nop 0
    v_add_f32 v4, 1.0, v4
    v_rcp_f32 v4, v4
    s_nop 0
    v_mul_f32 v236, v236, v4
    v_mul_f32 v10, 0xbfb8aa3b, v237
    s_waitcnt lgkmcnt(3)
    v_mfma_f32_16x16x32_bf16 v[156:159], v[84:87], v[112:115], v[156:159]
    v_exp_f32 v142, v142
    v_exp_f32 v143, v143
    v_mfma_f32_16x16x32_bf16 v[160:163], v[84:87], v[128:131], v[160:163]
    ds_read_b128 v[100:103], v3 offset:22528
    v_add_f32 v15, v15, v142
    v_exp_f32 v10, v10
    s_nop 0
    v_add_f32 v10, 1.0, v10
    v_rcp_f32 v10, v10
    s_nop 0
    v_mul_f32 v237, v237, v10
    v_mul_f32 v5, 0xbfb8aa3b, v238
    v_exp_f32 v5, v5
    s_nop 0
    v_add_f32 v5, 1.0, v5
    s_waitcnt lgkmcnt(3)
    v_mfma_f32_16x16x32_bf16 v[164:167], v[88:91], v[112:115], v[164:167]
    v_add_f32 v15, v15, v143
    v_mfma_f32_16x16x32_bf16 v[168:171], v[88:91], v[128:131], v[168:171]
    ds_read_b128 v[104:107], v3 offset:23552
    v_cvt_pk_bf16_f32 v189, v142, v143
    v_rcp_f32 v5, v5
    s_nop 0
    v_mul_f32 v238, v238, v5
    v_mul_f32 v12, 0xbfb8aa3b, v239
    v_exp_f32 v12, v12
    s_nop 0
    v_add_f32 v12, 1.0, v12
    v_rcp_f32 v12, v12
    s_nop 0
    v_mul_f32 v239, v239, v12
    s_waitcnt lgkmcnt(3)
    v_mfma_f32_16x16x32_bf16 v[156:159], v[92:95], v[116:119], v[156:159]
    v_exp_f32 v144, v144
    v_exp_f32 v145, v145
    v_mfma_f32_16x16x32_bf16 v[160:163], v[92:95], v[132:135], v[160:163]
    ds_read_b128 v[84:87], v2 offset:57344
    v_add_f32 v16, v16, v144
    v_mul_f32 v4, 0xbfb8aa3b, v240
    v_exp_f32 v4, v4
    s_nop 0
    v_add_f32 v4, 1.0, v4
    v_rcp_f32 v4, v4
    s_nop 0
    v_mul_f32 v240, v240, v4
    v_mul_f32 v10, 0xbfb8aa3b, v241
    v_exp_f32 v10, v10
    s_waitcnt lgkmcnt(3)
    v_mfma_f32_16x16x32_bf16 v[164:167], v[96:99], v[116:119], v[164:167]
    v_add_f32 v16, v16, v145
    v_mfma_f32_16x16x32_bf16 v[168:171], v[96:99], v[132:135], v[168:171]
    ds_read_b128 v[88:91], v2 offset:58368
    v_cvt_pk_bf16_f32 v192, v144, v145
    v_add_f32 v10, 1.0, v10
    v_rcp_f32 v10, v10
    s_nop 0
    v_mul_f32 v241, v241, v10
    v_mul_f32 v5, 0xbfb8aa3b, v242
    v_exp_f32 v5, v5
    s_nop 0
    v_add_f32 v5, 1.0, v5
    v_rcp_f32 v5, v5
    s_and_b32 s26, s12, 24
    s_lshl_b32 s26, s26, 18
    s_lshr_b32 s27, s2, 3
    s_lshl_b32 s27, s27, 16
    s_add_u32 s26, s26, s27
    v_lshrrev_b32 v17, 6, v8
    v_lshlrev_b32 v17, 10, v17
    v_lshl_add_u32 v17, v0, 7, v17
    v_add_u32 v17, s26, v17
    v_cmp_gt_u32 vcc, 8, v0
    v_bfrev_b32 v18, -2
    s_nop 0
    v_cndmask_b32 v17, v18, v17, vcc
    s_waitcnt lgkmcnt(3)
    v_mfma_f32_16x16x32_bf16 v[156:159], v[100:103], v[120:123], v[156:159]
    v_exp_f32 v146, v146
    v_exp_f32 v147, v147
    v_mfma_f32_16x16x32_bf16 v[160:163], v[100:103], v[136:139], v[160:163]
    ds_read_b128 v[92:95], v2 offset:59392
    v_add_f32 v16, v16, v146
    v_mul_f32 v242, v242, v5
    v_mul_f32 v12, 0xbfb8aa3b, v243
    v_exp_f32 v12, v12
    s_nop 0
    v_add_f32 v12, 1.0, v12
    v_rcp_f32 v12, v12
    s_nop 0
    v_mul_f32 v243, v243, v12
    s_mov_b64 s[20:21], s[40:41]
    s_mov_b32 s22, 0x800000
    s_mov_b32 s23, 0x20000
    s_mov_b32 s26, 0x0
    buffer_load_dword v18, v17, s[20:23], s26 offen
    s_waitcnt lgkmcnt(3)
    v_mfma_f32_16x16x32_bf16 v[164:167], v[104:107], v[120:123], v[164:167]
    v_add_f32 v16, v16, v147
    v_mfma_f32_16x16x32_bf16 v[168:171], v[104:107], v[136:139], v[168:171]
    ds_read_b128 v[96:99], v2 offset:60416
    v_cvt_pk_bf16_f32 v193, v146, v147
    v_cvt_pk_bf16_f32 v4, v236, v237
    v_lshlrev_b32 v236, 16, v4
    v_and_b32 v237, 0xffff0000, v4
    v_cvt_pk_bf16_f32 v4, v238, v239
    v_lshlrev_b32 v238, 16, v4
    v_and_b32 v239, 0xffff0000, v4
    v_cvt_pk_bf16_f32 v4, v240, v241
    s_waitcnt lgkmcnt(3)
    v_mfma_f32_16x16x32_bf16 v[20:23], v[84:87], v[196:199], v[20:23]
    v_exp_f32 v148, v148
    v_exp_f32 v149, v149
    v_mfma_f32_16x16x32_bf16 v[24:27], v[84:87], v[200:203], v[24:27]
    ds_read_b128 v[100:103], v2 offset:61440
    v_add_f32 v15, v15, v148
    v_lshlrev_b32 v240, 16, v4
    v_and_b32 v241, 0xffff0000, v4
    v_cvt_pk_bf16_f32 v4, v242, v243
    v_lshlrev_b32 v242, 16, v4
    v_and_b32 v243, 0xffff0000, v4
    s_waitcnt vmcnt(8)
    v_lshlrev_b32 v4, 16, v204
    v_and_b32 v10, 0xffff0000, v204
    s_waitcnt lgkmcnt(3)
    v_mfma_f32_16x16x32_bf16 v[28:31], v[88:91], v[196:199], v[28:31]
    v_add_f32 v15, v15, v149
    v_mfma_f32_16x16x32_bf16 v[32:35], v[88:91], v[200:203], v[32:35]
    ds_read_b128 v[104:107], v2 offset:62464
    v_cvt_pk_bf16_f32 v190, v148, v149
    v_lshlrev_b32 v5, 16, v205
    v_and_b32 v12, 0xffff0000, v205
    v_mul_f32 v244, v236, v4
    v_mul_f32 v245, v236, v10
    v_mul_f32 v246, v236, v5
    v_mul_f32 v247, v236, v12
    v_lshlrev_b32 v4, 16, v206
    s_mov_b64 s[20:21], s[40:41]
    s_mov_b32 s22, 0x800000
    s_mov_b32 s23, 0x20000
    s_mov_b32 s26, 0x1000
    buffer_load_dword v18, v17, s[20:23], s26 offen
    s_waitcnt lgkmcnt(3)
    v_mfma_f32_16x16x32_bf16 v[36:39], v[92:95], v[196:199], v[36:39]
    v_exp_f32 v150, v150
    v_exp_f32 v151, v151
    v_mfma_f32_16x16x32_bf16 v[40:43], v[92:95], v[200:203], v[40:43]
    ds_read_b128 v[84:87], v2 offset:63488
    v_add_f32 v15, v15, v150
    v_and_b32 v10, 0xffff0000, v206
    v_lshlrev_b32 v5, 16, v207
    v_and_b32 v12, 0xffff0000, v207
    v_mul_f32 v248, v236, v4
    v_mul_f32 v249, v236, v10
    v_mul_f32 v250, v236, v5
    v_mul_f32 v251, v236, v12
    s_waitcnt lgkmcnt(3)
    v_mfma_f32_16x16x32_bf16 v[44:47], v[96:99], v[196:199], v[44:47]
    v_add_f32 v15, v15, v151
    v_mfma_f32_16x16x32_bf16 v[48:51], v[96:99], v[200:203], v[48:51]
    ds_read_b128 v[88:91], v2 offset:64512
    v_cvt_pk_bf16_f32 v191, v150, v151
    s_waitcnt vmcnt(8)
    v_lshlrev_b32 v4, 16, v208
    v_and_b32 v10, 0xffff0000, v208
    v_lshlrev_b32 v5, 16, v209
    v_and_b32 v12, 0xffff0000, v209
    v_fmac_f32 v244, v237, v4
    v_fmac_f32 v245, v237, v10
    v_fmac_f32 v246, v237, v5
    s_waitcnt lgkmcnt(3)
    v_mfma_f32_16x16x32_bf16 v[52:55], v[100:103], v[196:199], v[52:55]
    v_exp_f32 v152, v152
    v_exp_f32 v153, v153
    v_mfma_f32_16x16x32_bf16 v[56:59], v[100:103], v[200:203], v[56:59]
    s_barrier
    ds_read_b128 v[92:95], v2 offset:0
    v_add_f32 v16, v16, v152
    v_fmac_f32 v247, v237, v12
    v_lshlrev_b32 v4, 16, v210
    v_and_b32 v10, 0xffff0000, v210
    v_lshlrev_b32 v5, 16, v211
    v_and_b32 v12, 0xffff0000, v211
    v_fmac_f32 v248, v237, v4
    s_mov_b64 s[20:21], s[40:41]
    s_mov_b32 s22, 0x800000
    s_mov_b32 s23, 0x20000
    s_mov_b32 s26, 0x2000
    buffer_load_dword v18, v17, s[20:23], s26 offen
    s_waitcnt lgkmcnt(3)
    v_mfma_f32_16x16x32_bf16 v[60:63], v[104:107], v[196:199], v[60:63]
    v_add_f32 v16, v16, v153
    v_mfma_f32_16x16x32_bf16 v[64:67], v[104:107], v[200:203], v[64:67]
    ds_read_b128 v[96:99], v2 offset:1024
    v_cvt_pk_bf16_f32 v194, v152, v153
    v_fmac_f32 v249, v237, v10
    v_fmac_f32 v250, v237, v5
    v_fmac_f32 v251, v237, v12
    s_waitcnt vmcnt(8)
    v_lshlrev_b32 v4, 16, v212
    v_and_b32 v10, 0xffff0000, v212
    v_lshlrev_b32 v5, 16, v213
    v_and_b32 v12, 0xffff0000, v213
    s_waitcnt lgkmcnt(3)
    v_mfma_f32_16x16x32_bf16 v[68:71], v[84:87], v[196:199], v[68:71]
    v_exp_f32 v154, v154
    v_exp_f32 v155, v155
    v_mfma_f32_16x16x32_bf16 v[72:75], v[84:87], v[200:203], v[72:75]
    ds_read_b128 v[100:103], v2 offset:2048
    v_add_f32 v16, v16, v154
    v_fmac_f32 v244, v238, v4
    v_fmac_f32 v245, v238, v10
    v_fmac_f32 v246, v238, v5
    v_fmac_f32 v247, v238, v12
    v_lshlrev_b32 v4, 16, v214
    v_and_b32 v10, 0xffff0000, v214
    v_lshlrev_b32 v5, 16, v215
    s_waitcnt lgkmcnt(3)
    v_mfma_f32_16x16x32_bf16 v[76:79], v[88:91], v[196:199], v[76:79]
    v_add_f32 v16, v16, v155
    v_mfma_f32_16x16x32_bf16 v[80:83], v[88:91], v[200:203], v[80:83]
    ds_read_b128 v[104:107], v2 offset:3072
    v_cvt_pk_bf16_f32 v195, v154, v155
    v_and_b32 v12, 0xffff0000, v215
    v_fmac_f32 v248, v238, v4
    v_fmac_f32 v249, v238, v10
    v_fmac_f32 v250, v238, v5
    v_fmac_f32 v251, v238, v12
    s_waitcnt vmcnt(7)
    v_lshlrev_b32 v4, 16, v216
    v_and_b32 v10, 0xffff0000, v216
    s_waitcnt lgkmcnt(3)
    v_mfma_f32_16x16x32_bf16 v[140:143], v[92:95], v[108:111], v[172:175]
    v_exp_f32 v156, v156
    v_exp_f32 v157, v157
    v_mfma_f32_16x16x32_bf16 v[144:147], v[92:95], v[124:127], v[176:179]
    ds_read_b128 v[84:87], v2 offset:4096
    v_add_f32 v15, v15, v156
    v_lshlrev_b32 v5, 16, v217
    v_and_b32 v12, 0xffff0000, v217
    v_fmac_f32 v244, v239, v4
    v_fmac_f32 v245, v239, v10
    v_fmac_f32 v246, v239, v5
    v_fmac_f32 v247, v239, v12
    v_lshlrev_b32 v4, 16, v218
    s_mov_b64 s[20:21], s[40:41]
    s_mov_b32 s22, 0x800000
    s_mov_b32 s23, 0x20000
    s_mov_b32 s26, 0x3000
    buffer_load_dword v18, v17, s[20:23], s26 offen
    s_waitcnt lgkmcnt(3)
    v_mfma_f32_16x16x32_bf16 v[148:151], v[96:99], v[108:111], v[172:175]
    v_add_f32 v15, v15, v157
    v_mfma_f32_16x16x32_bf16 v[152:155], v[96:99], v[124:127], v[176:179]
    ds_read_b128 v[88:91], v2 offset:5120
    v_cvt_pk_bf16_f32 v196, v156, v157
    v_and_b32 v10, 0xffff0000, v218
    v_lshlrev_b32 v5, 16, v219
    v_and_b32 v12, 0xffff0000, v219
    v_fmac_f32 v248, v239, v4
    v_fmac_f32 v249, v239, v10
    v_fmac_f32 v250, v239, v5
    v_fmac_f32 v251, v239, v12
    s_waitcnt lgkmcnt(3)
    v_mfma_f32_16x16x32_bf16 v[140:143], v[100:103], v[112:115], v[140:143]
    v_exp_f32 v158, v158
    v_exp_f32 v159, v159
    v_mfma_f32_16x16x32_bf16 v[144:147], v[100:103], v[128:131], v[144:147]
    ds_read_b128 v[92:95], v2 offset:6144
    v_add_f32 v15, v15, v158
    s_waitcnt vmcnt(7)
    v_lshlrev_b32 v4, 16, v220
    v_and_b32 v10, 0xffff0000, v220
    v_lshlrev_b32 v5, 16, v221
    v_and_b32 v12, 0xffff0000, v221
    v_fmac_f32 v244, v240, v4
    v_fmac_f32 v245, v240, v10
    s_waitcnt lgkmcnt(3)
    v_mfma_f32_16x16x32_bf16 v[148:151], v[104:107], v[112:115], v[148:151]
    v_add_f32 v15, v15, v159
    v_mfma_f32_16x16x32_bf16 v[152:155], v[104:107], v[128:131], v[152:155]
    ds_read_b128 v[96:99], v2 offset:7168
    v_cvt_pk_bf16_f32 v197, v158, v159
    v_fmac_f32 v246, v240, v5
    v_fmac_f32 v247, v240, v12
    v_lshlrev_b32 v4, 16, v222
    v_and_b32 v10, 0xffff0000, v222
    v_lshlrev_b32 v5, 16, v223
    v_and_b32 v12, 0xffff0000, v223
    v_fmac_f32 v248, v240, v4
    s_mov_b64 s[20:21], s[40:41]
    s_mov_b32 s22, 0x800000
    s_mov_b32 s23, 0x20000
    s_mov_b32 s26, 0x4000
    buffer_load_dword v18, v17, s[20:23], s26 offen
    s_waitcnt lgkmcnt(3)
    v_mfma_f32_16x16x32_bf16 v[140:143], v[84:87], v[116:119], v[140:143]
    v_exp_f32 v160, v160
    v_exp_f32 v161, v161
    v_mfma_f32_16x16x32_bf16 v[144:147], v[84:87], v[132:135], v[144:147]
    ds_read_b128 v[100:103], v3 offset:8192
    v_add_f32 v16, v16, v160
    v_fmac_f32 v249, v240, v10
    v_fmac_f32 v250, v240, v5
    v_fmac_f32 v251, v240, v12
    s_waitcnt vmcnt(7)
    v_lshlrev_b32 v4, 16, v224
    v_and_b32 v10, 0xffff0000, v224
    v_lshlrev_b32 v5, 16, v225
    v_and_b32 v12, 0xffff0000, v225
    s_waitcnt lgkmcnt(3)
    v_mfma_f32_16x16x32_bf16 v[148:151], v[88:91], v[116:119], v[148:151]
    v_add_f32 v16, v16, v161
    v_mfma_f32_16x16x32_bf16 v[152:155], v[88:91], v[132:135], v[152:155]
    ds_read_b128 v[104:107], v3 offset:9216
    v_cvt_pk_bf16_f32 v200, v160, v161
    v_fmac_f32 v244, v241, v4
    v_fmac_f32 v245, v241, v10
    v_fmac_f32 v246, v241, v5
    v_fmac_f32 v247, v241, v12
    v_lshlrev_b32 v4, 16, v226
    v_and_b32 v10, 0xffff0000, v226
    v_lshlrev_b32 v5, 16, v227
    s_waitcnt lgkmcnt(3)
    v_mfma_f32_16x16x32_bf16 v[140:143], v[92:95], v[120:123], v[140:143]
    v_exp_f32 v162, v162
    v_exp_f32 v163, v163
    v_mfma_f32_16x16x32_bf16 v[144:147], v[92:95], v[136:139], v[144:147]
    ds_read_b128 v[84:87], v3 offset:10240
    v_add_f32 v16, v16, v162
    v_and_b32 v12, 0xffff0000, v227
    v_fmac_f32 v248, v241, v4
    v_fmac_f32 v249, v241, v10
    v_fmac_f32 v250, v241, v5
    v_fmac_f32 v251, v241, v12
    s_waitcnt vmcnt(6)
    v_lshlrev_b32 v4, 16, v228
    v_and_b32 v10, 0xffff0000, v228
    s_waitcnt lgkmcnt(3)
    v_mfma_f32_16x16x32_bf16 v[148:151], v[96:99], v[120:123], v[148:151]
    v_add_f32 v16, v16, v163
    v_mfma_f32_16x16x32_bf16 v[152:155], v[96:99], v[136:139], v[152:155]
    ds_read_b128 v[88:91], v3 offset:11264
    v_cvt_pk_bf16_f32 v201, v162, v163
    v_lshlrev_b32 v5, 16, v229
    v_and_b32 v12, 0xffff0000, v229
    v_fmac_f32 v244, v242, v4
    v_fmac_f32 v245, v242, v10
    v_fmac_f32 v246, v242, v5
    v_fmac_f32 v247, v242, v12
    v_lshlrev_b32 v4, 16, v230
    s_mov_b64 s[20:21], s[40:41]
    s_mov_b32 s22, 0x800000
    s_mov_b32 s23, 0x20000
    s_mov_b32 s26, 0x5000
    buffer_load_dword v18, v17, s[20:23], s26 offen
    s_waitcnt lgkmcnt(3)
    v_mfma_f32_16x16x32_bf16 v[20:23], v[100:103], v[188:191], v[20:23]
    v_exp_f32 v164, v164
    v_exp_f32 v165, v165
    v_mfma_f32_16x16x32_bf16 v[24:27], v[100:103], v[192:195], v[24:27]
    ds_read_b128 v[92:95], v3 offset:12288
    v_add_f32 v15, v15, v164
    v_and_b32 v10, 0xffff0000, v230
    v_lshlrev_b32 v5, 16, v231
    v_and_b32 v12, 0xffff0000, v231
    v_fmac_f32 v248, v242, v4
    v_fmac_f32 v249, v242, v10
    v_fmac_f32 v250, v242, v5
    s_waitcnt lgkmcnt(3)
    v_mfma_f32_16x16x32_bf16 v[28:31], v[104:107], v[188:191], v[28:31]
    v_add_f32 v15, v15, v165
    v_mfma_f32_16x16x32_bf16 v[32:35], v[104:107], v[192:195], v[32:35]
    ds_read_b128 v[96:99], v3 offset:13312
    v_cvt_pk_bf16_f32 v198, v164, v165
    v_fmac_f32 v251, v242, v12
    s_waitcnt vmcnt(6)
    v_lshlrev_b32 v4, 16, v232
    v_and_b32 v10, 0xffff0000, v232
    v_lshlrev_b32 v5, 16, v233
    v_and_b32 v12, 0xffff0000, v233
    v_fmac_f32 v244, v243, v4
    v_fmac_f32 v245, v243, v10
    s_waitcnt lgkmcnt(3)
    v_mfma_f32_16x16x32_bf16 v[36:39], v[84:87], v[188:191], v[36:39]
    v_exp_f32 v166, v166
    v_exp_f32 v167, v167
    v_mfma_f32_16x16x32_bf16 v[40:43], v[84:87], v[192:195], v[40:43]
    ds_read_b128 v[100:103], v3 offset:14336
    v_add_f32 v15, v15, v166
    v_fmac_f32 v246, v243, v5
    v_fmac_f32 v247, v243, v12
    v_lshlrev_b32 v4, 16, v234
    v_and_b32 v10, 0xffff0000, v234
    v_lshlrev_b32 v5, 16, v235
    v_and_b32 v12, 0xffff0000, v235
    v_fmac_f32 v248, v243, v4
    s_mov_b64 s[20:21], s[40:41]
    s_mov_b32 s22, 0x800000
    s_mov_b32 s23, 0x20000
    s_mov_b32 s26, 0x6000
    buffer_load_dword v18, v17, s[20:23], s26 offen
    s_waitcnt lgkmcnt(3)
    v_mfma_f32_16x16x32_bf16 v[44:47], v[88:91], v[188:191], v[44:47]
    v_add_f32 v15, v15, v167
    v_mfma_f32_16x16x32_bf16 v[48:51], v[88:91], v[192:195], v[48:51]
    ds_read_b128 v[104:107], v3 offset:15360
    v_cvt_pk_bf16_f32 v199, v166, v167
    v_fmac_f32 v249, v243, v10
    v_fmac_f32 v250, v243, v5
    v_fmac_f32 v251, v243, v12
    v_permlane32_swap_b32 v244, v248
    v_permlane32_swap_b32 v245, v249
    v_permlane32_swap_b32 v246, v250
    v_permlane32_swap_b32 v247, v251
    s_waitcnt lgkmcnt(3)
    v_mfma_f32_16x16x32_bf16 v[52:55], v[92:95], v[188:191], v[52:55]
    v_exp_f32 v168, v168
    v_exp_f32 v169, v169
    v_mfma_f32_16x16x32_bf16 v[56:59], v[92:95], v[192:195], v[56:59]
    s_barrier
    ds_read_b128 v[84:87], v2 offset:16384
    v_add_f32 v16, v16, v168
    v_add_f32 v244, v244, v248
    v_add_f32 v245, v245, v249
    v_add_f32 v246, v246, v250
    v_add_f32 v247, v247, v251
    s_nop 0
    v_permlane16_swap_b32 v244, v246
    v_permlane16_swap_b32 v245, v247
    v_add_f32 v244, v244, v246
    s_waitcnt lgkmcnt(3)
    v_mfma_f32_16x16x32_bf16 v[60:63], v[96:99], v[188:191], v[60:63]
    v_add_f32 v16, v16, v169
    v_mfma_f32_16x16x32_bf16 v[64:67], v[96:99], v[192:195], v[64:67]
    ds_read_b128 v[88:91], v2 offset:17408
    v_cvt_pk_bf16_f32 v202, v168, v169
    v_add_f32 v245, v245, v247
    v_add_f32_dpp v244, v244, v244 row_ror:8 row_mask:0xf bank_mask:0xf
    s_nop 0
    v_add_f32_dpp v245, v245, v245 row_ror:8 row_mask:0xf bank_mask:0xf
    v_add_f32_dpp v244, v244, v244 row_ror:4 row_mask:0xf bank_mask:0xf
    s_nop 0
    v_add_f32_dpp v245, v245, v245 row_ror:4 row_mask:0xf bank_mask:0xf
    v_add_f32_dpp v244, v244, v244 row_ror:2 row_mask:0xf bank_mask:0xf
    s_nop 0
    v_add_f32_dpp v245, v245, v245 row_ror:2 row_mask:0xf bank_mask:0xf
    s_waitcnt lgkmcnt(3)
    v_mfma_f32_16x16x32_bf16 v[68:71], v[100:103], v[188:191], v[68:71]
    v_exp_f32 v170, v170
    v_exp_f32 v171, v171
    v_mfma_f32_16x16x32_bf16 v[72:75], v[100:103], v[192:195], v[72:75]
    ds_read_b128 v[92:95], v2 offset:18432
    v_add_f32 v16, v16, v170
    v_lshrrev_b32 v13, 6, v8
    v_lshlrev_b32 v13, 6, v13
    v_lshl_add_u32 v13, v14, 5, v13
    v_bfe_u32 v14, v8, 4, 2
    v_lshl_add_u32 v13, v14, 3, v13
    ds_write_b64 v13, v[244:245] offset:49152
    s_mov_b64 s[20:21], s[40:41]
    s_mov_b32 s22, 0x800000
    s_mov_b32 s23, 0x20000
    s_mov_b32 s26, 0x7000
    buffer_load_dword v18, v17, s[20:23], s26 offen
    s_waitcnt lgkmcnt(4)
    v_mfma_f32_16x16x32_bf16 v[76:79], v[104:107], v[188:191], v[76:79]
    v_add_f32 v16, v16, v171
    v_mfma_f32_16x16x32_bf16 v[80:83], v[104:107], v[192:195], v[80:83]
    ds_read_b128 v[96:99], v2 offset:19456
    v_cvt_pk_bf16_f32 v203, v170, v171
    s_waitcnt lgkmcnt(4)
    v_mfma_f32_16x16x32_bf16 v[156:159], v[84:87], v[108:111], v[172:175]
    v_exp_f32 v140, v140
    v_exp_f32 v141, v141
    v_mfma_f32_16x16x32_bf16 v[160:163], v[84:87], v[124:127], v[176:179]
    ds_read_b128 v[100:103], v2 offset:20480
    v_add_f32 v15, v15, v140
    s_waitcnt lgkmcnt(4)
    v_mfma_f32_16x16x32_bf16 v[164:167], v[88:91], v[108:111], v[172:175]
    v_add_f32 v15, v15, v141
    v_mfma_f32_16x16x32_bf16 v[168:171], v[88:91], v[124:127], v[176:179]
    ds_read_b128 v[104:107], v2 offset:21504
    v_cvt_pk_bf16_f32 v188, v140, v141
    s_mov_b64 s[20:21], s[40:41]
    s_mov_b32 s22, 0x800000
    s_mov_b32 s23, 0x20000
    s_mov_b32 s26, 0x8000
    buffer_load_dword v18, v17, s[20:23], s26 offen
    s_waitcnt lgkmcnt(4)
    v_mfma_f32_16x16x32_bf16 v[156:159], v[92:95], v[112:115], v[156:159]
    v_exp_f32 v142, v142
    v_exp_f32 v143, v143
    v_mfma_f32_16x16x32_bf16 v[160:163], v[92:95], v[128:131], v[160:163]
    ds_read_b128 v[84:87], v2 offset:22528
    v_add_f32 v15, v15, v142
    s_waitcnt lgkmcnt(3)
    v_mfma_f32_16x16x32_bf16 v[164:167], v[96:99], v[112:115], v[164:167]
    v_add_f32 v15, v15, v143
    v_mfma_f32_16x16x32_bf16 v[168:171], v[96:99], v[128:131], v[168:171]
    ds_read_b128 v[88:91], v2 offset:23552
    v_cvt_pk_bf16_f32 v189, v142, v143
    s_waitcnt lgkmcnt(0)
    v_mfma_f32_16x16x32_bf16 v[156:159], v[100:103], v[116:119], v[156:159]
    v_exp_f32 v144, v144
    v_exp_f32 v145, v145
    v_mfma_f32_16x16x32_bf16 v[160:163], v[100:103], v[132:135], v[160:163]
    ds_read_b128 v[92:95], v3 offset:24576
    v_add_f32 v16, v16, v144
    s_mov_b64 s[20:21], s[40:41]
    s_mov_b32 s22, 0x800000
    s_mov_b32 s23, 0x20000
    s_mov_b32 s26, 0x9000
    buffer_load_dword v18, v17, s[20:23], s26 offen
    v_mfma_f32_16x16x32_bf16 v[164:167], v[104:107], v[116:119], v[164:167]
    v_add_f32 v16, v16, v145
    v_mfma_f32_16x16x32_bf16 v[168:171], v[104:107], v[132:135], v[168:171]
    ds_read_b128 v[96:99], v3 offset:25600
    v_cvt_pk_bf16_f32 v192, v144, v145
    v_mfma_f32_16x16x32_bf16 v[156:159], v[84:87], v[120:123], v[156:159]
    v_exp_f32 v146, v146
    v_exp_f32 v147, v147
    v_mfma_f32_16x16x32_bf16 v[160:163], v[84:87], v[136:139], v[160:163]
    ds_read_b128 v[100:103], v3 offset:26624
    v_add_f32 v16, v16, v146
    v_mfma_f32_16x16x32_bf16 v[164:167], v[88:91], v[120:123], v[164:167]
    v_add_f32 v16, v16, v147
    v_mfma_f32_16x16x32_bf16 v[168:171], v[88:91], v[136:139], v[168:171]
    ds_read_b128 v[104:107], v3 offset:27648
    v_cvt_pk_bf16_f32 v193, v146, v147
    s_waitcnt lgkmcnt(3)
    v_mfma_f32_16x16x32_bf16 v[20:23], v[92:95], v[196:199], v[20:23]
    v_exp_f32 v148, v148
    v_exp_f32 v149, v149
    v_mfma_f32_16x16x32_bf16 v[24:27], v[92:95], v[200:203], v[24:27]
    ds_read_b128 v[84:87], v3 offset:28672
    v_add_f32 v15, v15, v148
    s_mov_b64 s[20:21], s[40:41]
    s_mov_b32 s22, 0x800000
    s_mov_b32 s23, 0x20000
    s_mov_b32 s26, 0xa000
    buffer_load_dword v18, v17, s[20:23], s26 offen
    s_waitcnt lgkmcnt(3)
    v_mfma_f32_16x16x32_bf16 v[28:31], v[96:99], v[196:199], v[28:31]
    v_add_f32 v15, v15, v149
    v_mfma_f32_16x16x32_bf16 v[32:35], v[96:99], v[200:203], v[32:35]
    ds_read_b128 v[88:91], v3 offset:29696
    v_cvt_pk_bf16_f32 v190, v148, v149
    s_waitcnt lgkmcnt(3)
    v_mfma_f32_16x16x32_bf16 v[36:39], v[100:103], v[196:199], v[36:39]
    v_exp_f32 v150, v150
    v_exp_f32 v151, v151
    v_mfma_f32_16x16x32_bf16 v[40:43], v[100:103], v[200:203], v[40:43]
    ds_read_b128 v[92:95], v3 offset:30720
    v_add_f32 v15, v15, v150
    s_waitcnt lgkmcnt(3)
    v_mfma_f32_16x16x32_bf16 v[44:47], v[104:107], v[196:199], v[44:47]
    v_add_f32 v15, v15, v151
    v_mfma_f32_16x16x32_bf16 v[48:51], v[104:107], v[200:203], v[48:51]
    ds_read_b128 v[96:99], v3 offset:31744
    v_cvt_pk_bf16_f32 v191, v150, v151
    s_mov_b64 s[20:21], s[40:41]
    s_mov_b32 s22, 0x800000
    s_mov_b32 s23, 0x20000
    s_mov_b32 s26, 0xb000
    buffer_load_dword v18, v17, s[20:23], s26 offen
    s_waitcnt lgkmcnt(3)
    v_mfma_f32_16x16x32_bf16 v[52:55], v[84:87], v[196:199], v[52:55]
    v_exp_f32 v152, v152
    v_exp_f32 v153, v153
    v_mfma_f32_16x16x32_bf16 v[56:59], v[84:87], v[200:203], v[56:59]
    s_barrier
    ds_read_b128 v[100:103], v2 offset:32768
    v_add_f32 v16, v16, v152
    s_waitcnt lgkmcnt(3)
    v_mfma_f32_16x16x32_bf16 v[60:63], v[88:91], v[196:199], v[60:63]
    v_add_f32 v16, v16, v153
    v_mfma_f32_16x16x32_bf16 v[64:67], v[88:91], v[200:203], v[64:67]
    ds_read_b128 v[104:107], v2 offset:33792
    v_cvt_pk_bf16_f32 v194, v152, v153
    s_waitcnt lgkmcnt(3)
    v_mfma_f32_16x16x32_bf16 v[68:71], v[92:95], v[196:199], v[68:71]
    v_exp_f32 v154, v154
    v_exp_f32 v155, v155
    v_mfma_f32_16x16x32_bf16 v[72:75], v[92:95], v[200:203], v[72:75]
    ds_read_b128 v[84:87], v2 offset:34816
    v_add_f32 v16, v16, v154
    s_waitcnt lgkmcnt(3)
    v_mfma_f32_16x16x32_bf16 v[76:79], v[96:99], v[196:199], v[76:79]
    v_add_f32 v16, v16, v155
    v_mfma_f32_16x16x32_bf16 v[80:83], v[96:99], v[200:203], v[80:83]
    ds_read_b128 v[88:91], v2 offset:35840
    v_cvt_pk_bf16_f32 v195, v154, v155
    s_mov_b64 s[20:21], s[40:41]
    s_mov_b32 s22, 0x800000
    s_mov_b32 s23, 0x20000
    s_mov_b32 s26, 0xc000
    buffer_load_dword v18, v17, s[20:23], s26 offen
    s_waitcnt lgkmcnt(3)
    v_mfma_f32_16x16x32_bf16 v[140:143], v[100:103], v[108:111], v[172:175]
    v_exp_f32 v156, v156
    v_exp_f32 v157, v157
    v_mfma_f32_16x16x32_bf16 v[144:147], v[100:103], v[124:127], v[176:179]
    ds_read_b128 v[92:95], v2 offset:36864
    v_add_f32 v15, v15, v156
    s_waitcnt lgkmcnt(3)
    v_mfma_f32_16x16x32_bf16 v[148:151], v[104:107], v[108:111], v[172:175]
    v_add_f32 v15, v15, v157
    v_mfma_f32_16x16x32_bf16 v[152:155], v[104:107], v[124:127], v[176:179]
    ds_read_b128 v[96:99], v2 offset:37888
    v_cvt_pk_bf16_f32 v196, v156, v157
    s_waitcnt lgkmcnt(3)
    v_mfma_f32_16x16x32_bf16 v[140:143], v[84:87], v[112:115], v[140:143]
    v_exp_f32 v158, v158
    v_exp_f32 v159, v159
    v_mfma_f32_16x16x32_bf16 v[144:147], v[84:87], v[128:131], v[144:147]
    ds_read_b128 v[100:103], v2 offset:38912
    v_add_f32 v15, v15, v158
    v_and_b32 v13, 15, v0
    v_lshlrev_b32 v13, 2, v13
    ds_read_b32 v244, v13 offset:49152
    ds_read_b32 v245, v13 offset:49216
    ds_read_b32 v246, v13 offset:49280
    ds_read_b32 v247, v13 offset:49344
    s_mov_b64 s[20:21], s[40:41]
    s_mov_b32 s22, 0x800000
    s_mov_b32 s23, 0x20000
    s_mov_b32 s26, 0xd000
    buffer_load_dword v18, v17, s[20:23], s26 offen
    s_waitcnt lgkmcnt(7)
    v_mfma_f32_16x16x32_bf16 v[148:151], v[88:91], v[112:115], v[148:151]
    v_add_f32 v15, v15, v159
    v_mfma_f32_16x16x32_bf16 v[152:155], v[88:91], v[128:131], v[152:155]
    ds_read_b128 v[104:107], v2 offset:39936
    v_cvt_pk_bf16_f32 v197, v158, v159
    s_waitcnt lgkmcnt(7)
    v_mfma_f32_16x16x32_bf16 v[140:143], v[92:95], v[116:119], v[140:143]
    v_exp_f32 v160, v160
    v_exp_f32 v161, v161
    v_mfma_f32_16x16x32_bf16 v[144:147], v[92:95], v[132:135], v[144:147]
    ds_read_b128 v[84:87], v2 offset:8192
    v_add_f32 v16, v16, v160
    s_waitcnt lgkmcnt(7)
    v_mfma_f32_16x16x32_bf16 v[148:151], v[96:99], v[116:119], v[148:151]
    v_add_f32 v16, v16, v161
    v_mfma_f32_16x16x32_bf16 v[152:155], v[96:99], v[132:135], v[152:155]
    ds_read_b128 v[88:91], v2 offset:9216
    v_cvt_pk_bf16_f32 v200, v160, v161
    s_waitcnt lgkmcnt(7)
    v_mfma_f32_16x16x32_bf16 v[140:143], v[100:103], v[120:123], v[140:143]
    v_exp_f32 v162, v162
    v_exp_f32 v163, v163
    v_mfma_f32_16x16x32_bf16 v[144:147], v[100:103], v[136:139], v[144:147]
    ds_read_b128 v[92:95], v2 offset:10240
    v_add_f32 v16, v16, v162
    s_mov_b64 s[20:21], s[40:41]
    s_mov_b32 s22, 0x800000
    s_mov_b32 s23, 0x20000
    s_mov_b32 s26, 0xe000
    buffer_load_dword v18, v17, s[20:23], s26 offen
    s_waitcnt lgkmcnt(3)
    v_mfma_f32_16x16x32_bf16 v[148:151], v[104:107], v[120:123], v[148:151]
    v_add_f32 v16, v16, v163
    v_mfma_f32_16x16x32_bf16 v[152:155], v[104:107], v[136:139], v[152:155]
    ds_read_b128 v[96:99], v2 offset:11264
    v_cvt_pk_bf16_f32 v201, v162, v163
    s_waitcnt lgkmcnt(3)
    v_mfma_f32_16x16x32_bf16 v[20:23], v[84:87], v[188:191], v[20:23]
    v_exp_f32 v164, v164
    v_exp_f32 v165, v165
    v_mfma_f32_16x16x32_bf16 v[24:27], v[84:87], v[192:195], v[24:27]
    ds_read_b128 v[100:103], v2 offset:12288
    v_add_f32 v15, v15, v164
    v_add_f32 v244, v244, v246
    v_add_f32 v245, v245, v247
    v_add_f32 v244, v244, v245
    v_cvt_pk_bf16_f32 v244, v244, v244
    v_lshlrev_b32 v244, 16, v244
    s_lshr_b32 s26, s100, 6
    s_cmp_eq_u32 s26, 2
    s_cselect_b32 s26, 1.0, 0
    v_add_f32 v244, s26, v244
    v_cvt_pk_bf16_f32 v244, v244, v244
    v_lshlrev_b32 v244, 16, v244
    v_or_b32 v244, 1, v244
    s_lshl_b32 s26, s100, 6
    s_add_u32 s26, s26, 0xa20000
    s_cmp_eq_u32 s3, 4
    s_cselect_b32 s26, s26, 0x7ffffff0
    s_mov_b64 exec, 0xffff
    buffer_store_dword v244, v13, s[8:11], s26 offen sc1
    s_mov_b64 exec, -1
    s_nop 3
    s_waitcnt lgkmcnt(3)
    v_mfma_f32_16x16x32_bf16 v[28:31], v[88:91], v[188:191], v[28:31]
    v_add_f32 v15, v15, v165
    v_mfma_f32_16x16x32_bf16 v[32:35], v[88:91], v[192:195], v[32:35]
    ds_read_b128 v[104:107], v2 offset:13312
    v_cvt_pk_bf16_f32 v198, v164, v165
    s_mov_b64 s[20:21], s[40:41]
    s_mov_b32 s22, 0x800000
    s_mov_b32 s23, 0x20000
    s_mov_b32 s26, 0xf000
    buffer_load_dword v18, v17, s[20:23], s26 offen
    s_waitcnt lgkmcnt(3)
    v_mfma_f32_16x16x32_bf16 v[36:39], v[92:95], v[188:191], v[36:39]
    v_exp_f32 v166, v166
    v_exp_f32 v167, v167
    v_mfma_f32_16x16x32_bf16 v[40:43], v[92:95], v[192:195], v[40:43]
    ds_read_b128 v[84:87], v2 offset:14336
    v_add_f32 v15, v15, v166
    s_waitcnt lgkmcnt(3)
    v_mfma_f32_16x16x32_bf16 v[44:47], v[96:99], v[188:191], v[44:47]
    v_add_f32 v15, v15, v167
    v_mfma_f32_16x16x32_bf16 v[48:51], v[96:99], v[192:195], v[48:51]
    ds_read_b128 v[88:91], v2 offset:15360
    v_cvt_pk_bf16_f32 v199, v166, v167
    v_lshrrev_b32 v6, 3, v8
    v_and_b32 v7, 7, v8
    s_bfe_u32 s25, s2, 0x10002
    s_mul_i32 s25, s25, 28
    s_lshr_b32 s26, s2, 3
    s_add_u32 s25, s25, s26
    s_lshl_b32 s25, s25, 7
    s_bfe_u32 s24, s2, 0x10001
    s_mul_i32 s24, s24, 3670016
    s_add_u32 s24, s24, s25
    s_mov_b32 s26, 114688
    v_mul_lo_u32 v19, s26, v6
    v_lshl_add_u32 v19, v7, 4, v19
    s_bitcmp0_b32 s2, 0
    s_cselect_b32 s64, s46, s48
    s_cselect_b32 s65, s47, s49
    s_cmp_lt_u32 s2, 224
    s_cselect_b32 s66, 0x700000, 0
    s_mov_b32 s67, 0x20000
    s_waitcnt lgkmcnt(3)
    v_mfma_f32_16x16x32_bf16 v[52:55], v[100:103], v[188:191], v[52:55]
    v_exp_f32 v168, v168
    v_exp_f32 v169, v169
    v_mfma_f32_16x16x32_bf16 v[56:59], v[100:103], v[192:195], v[56:59]
    s_barrier
    ds_read_b128 v[92:95], v2 offset:49152
    v_add_f32 v16, v16, v168
    s_add_u32 s25, s24, 0
    buffer_load_dwordx4 v[204:207], v19, s[64:67], s25 offen
    s_waitcnt lgkmcnt(3)
    v_mfma_f32_16x16x32_bf16 v[60:63], v[104:107], v[188:191], v[60:63]
    v_add_f32 v16, v16, v169
    v_mfma_f32_16x16x32_bf16 v[64:67], v[104:107], v[192:195], v[64:67]
    ds_read_b128 v[96:99], v2 offset:50176
    v_cvt_pk_bf16_f32 v202, v168, v169
    s_waitcnt lgkmcnt(3)
    v_mfma_f32_16x16x32_bf16 v[68:71], v[84:87], v[188:191], v[68:71]
    v_exp_f32 v170, v170
    v_exp_f32 v171, v171
    v_mfma_f32_16x16x32_bf16 v[72:75], v[84:87], v[192:195], v[72:75]
    ds_read_b128 v[100:103], v2 offset:51200
    v_add_f32 v16, v16, v170
    s_waitcnt lgkmcnt(3)
    v_mfma_f32_16x16x32_bf16 v[76:79], v[88:91], v[188:191], v[76:79]
    v_add_f32 v16, v16, v171
    v_mfma_f32_16x16x32_bf16 v[80:83], v[88:91], v[192:195], v[80:83]
    ds_read_b128 v[104:107], v2 offset:52224
    v_cvt_pk_bf16_f32 v203, v170, v171
    s_waitcnt lgkmcnt(3)
    v_mfma_f32_16x16x32_bf16 v[156:159], v[92:95], v[108:111], v[172:175]
    v_exp_f32 v140, v140
    v_exp_f32 v141, v141
    v_mfma_f32_16x16x32_bf16 v[160:163], v[92:95], v[124:127], v[176:179]
    ds_read_b128 v[84:87], v2 offset:53248
    v_add_f32 v15, v15, v140
    s_add_u32 s25, s24, 7168
    buffer_load_dwordx4 v[208:211], v19, s[64:67], s25 offen
    s_waitcnt lgkmcnt(3)
    v_mfma_f32_16x16x32_bf16 v[164:167], v[96:99], v[108:111], v[172:175]
    v_add_f32 v15, v15, v141
    v_mfma_f32_16x16x32_bf16 v[168:171], v[96:99], v[124:127], v[176:179]
    ds_read_b128 v[88:91], v2 offset:54272
    v_cvt_pk_bf16_f32 v188, v140, v141
    s_waitcnt lgkmcnt(3)
    v_mfma_f32_16x16x32_bf16 v[156:159], v[100:103], v[112:115], v[156:159]
    v_exp_f32 v142, v142
    v_exp_f32 v143, v143
    v_mfma_f32_16x16x32_bf16 v[160:163], v[100:103], v[128:131], v[160:163]
    ds_read_b128 v[92:95], v2 offset:55296
    v_add_f32 v15, v15, v142
    s_waitcnt lgkmcnt(3)
    v_mfma_f32_16x16x32_bf16 v[164:167], v[104:107], v[112:115], v[164:167]
    v_add_f32 v15, v15, v143
    v_mfma_f32_16x16x32_bf16 v[168:171], v[104:107], v[128:131], v[168:171]
    ds_read_b128 v[96:99], v2 offset:56320
    v_cvt_pk_bf16_f32 v189, v142, v143
    s_waitcnt lgkmcnt(3)
    v_mfma_f32_16x16x32_bf16 v[156:159], v[84:87], v[116:119], v[156:159]
    v_exp_f32 v144, v144
    v_exp_f32 v145, v145
    v_mfma_f32_16x16x32_bf16 v[160:163], v[84:87], v[132:135], v[160:163]
    ds_read_b128 v[100:103], v2 offset:24576
    v_add_f32 v16, v16, v144
    s_add_u32 s25, s24, 14336
    buffer_load_dwordx4 v[212:215], v19, s[64:67], s25 offen
    s_waitcnt lgkmcnt(3)
    v_mfma_f32_16x16x32_bf16 v[164:167], v[88:91], v[116:119], v[164:167]
    v_add_f32 v16, v16, v145
    v_mfma_f32_16x16x32_bf16 v[168:171], v[88:91], v[132:135], v[168:171]
    ds_read_b128 v[104:107], v2 offset:25600
    v_cvt_pk_bf16_f32 v192, v144, v145
    s_waitcnt lgkmcnt(3)
    v_mfma_f32_16x16x32_bf16 v[156:159], v[92:95], v[120:123], v[156:159]
    v_exp_f32 v146, v146
    v_exp_f32 v147, v147
    v_mfma_f32_16x16x32_bf16 v[160:163], v[92:95], v[136:139], v[160:163]
    ds_read_b128 v[84:87], v2 offset:26624
    v_add_f32 v16, v16, v146
    s_waitcnt lgkmcnt(3)
    v_mfma_f32_16x16x32_bf16 v[164:167], v[96:99], v[120:123], v[164:167]
    v_add_f32 v16, v16, v147
    v_mfma_f32_16x16x32_bf16 v[168:171], v[96:99], v[136:139], v[168:171]
    ds_read_b128 v[88:91], v2 offset:27648
    v_cvt_pk_bf16_f32 v193, v146, v147
    s_waitcnt lgkmcnt(3)
    v_mfma_f32_16x16x32_bf16 v[20:23], v[100:103], v[196:199], v[20:23]
    v_exp_f32 v148, v148
    v_exp_f32 v149, v149
    v_mfma_f32_16x16x32_bf16 v[24:27], v[100:103], v[200:203], v[24:27]
    ds_read_b128 v[92:95], v2 offset:28672
    v_add_f32 v15, v15, v148
    s_waitcnt lgkmcnt(3)
    v_mfma_f32_16x16x32_bf16 v[28:31], v[104:107], v[196:199], v[28:31]
    v_add_f32 v15, v15, v149
    v_mfma_f32_16x16x32_bf16 v[32:35], v[104:107], v[200:203], v[32:35]
    ds_read_b128 v[96:99], v2 offset:29696
    v_cvt_pk_bf16_f32 v190, v148, v149
    s_add_u32 s25, s24, 21504
    buffer_load_dwordx4 v[216:219], v19, s[64:67], s25 offen
    s_waitcnt lgkmcnt(3)
    v_mfma_f32_16x16x32_bf16 v[36:39], v[84:87], v[196:199], v[36:39]
    v_exp_f32 v150, v150
    v_exp_f32 v151, v151
    v_mfma_f32_16x16x32_bf16 v[40:43], v[84:87], v[200:203], v[40:43]
    ds_read_b128 v[100:103], v2 offset:30720
    v_add_f32 v15, v15, v150
    s_waitcnt lgkmcnt(3)
    v_mfma_f32_16x16x32_bf16 v[44:47], v[88:91], v[196:199], v[44:47]
    v_add_f32 v15, v15, v151
    v_mfma_f32_16x16x32_bf16 v[48:51], v[88:91], v[200:203], v[48:51]
    ds_read_b128 v[104:107], v2 offset:31744
    v_cvt_pk_bf16_f32 v191, v150, v151
    s_waitcnt lgkmcnt(3)
    v_mfma_f32_16x16x32_bf16 v[52:55], v[92:95], v[196:199], v[52:55]
    v_exp_f32 v152, v152
    v_exp_f32 v153, v153
    v_mfma_f32_16x16x32_bf16 v[56:59], v[92:95], v[200:203], v[56:59]
    s_barrier
    ds_read_b128 v[84:87], v3 offset:0
    v_add_f32 v16, v16, v152
    s_waitcnt lgkmcnt(3)
    v_mfma_f32_16x16x32_bf16 v[60:63], v[96:99], v[196:199], v[60:63]
    v_add_f32 v16, v16, v153
    v_mfma_f32_16x16x32_bf16 v[64:67], v[96:99], v[200:203], v[64:67]
    ds_read_b128 v[88:91], v3 offset:1024
    v_cvt_pk_bf16_f32 v194, v152, v153
    s_add_u32 s25, s24, 28672
    buffer_load_dwordx4 v[220:223], v19, s[64:67], s25 offen
    s_waitcnt lgkmcnt(3)
    v_mfma_f32_16x16x32_bf16 v[68:71], v[100:103], v[196:199], v[68:71]
    v_exp_f32 v154, v154
    v_exp_f32 v155, v155
    v_mfma_f32_16x16x32_bf16 v[72:75], v[100:103], v[200:203], v[72:75]
    ds_read_b128 v[92:95], v3 offset:2048
    v_add_f32 v16, v16, v154
    s_waitcnt lgkmcnt(3)
    v_mfma_f32_16x16x32_bf16 v[76:79], v[104:107], v[196:199], v[76:79]
    v_add_f32 v16, v16, v155
    v_mfma_f32_16x16x32_bf16 v[80:83], v[104:107], v[200:203], v[80:83]
    ds_read_b128 v[96:99], v3 offset:3072
    v_cvt_pk_bf16_f32 v195, v154, v155
    s_waitcnt lgkmcnt(3)
    v_mfma_f32_16x16x32_bf16 v[140:143], v[84:87], v[108:111], v[172:175]
    v_exp_f32 v156, v156
    v_exp_f32 v157, v157
    v_mfma_f32_16x16x32_bf16 v[144:147], v[84:87], v[124:127], v[176:179]
    ds_read_b128 v[100:103], v3 offset:4096
    v_add_f32 v15, v15, v156
    s_waitcnt lgkmcnt(3)
    v_mfma_f32_16x16x32_bf16 v[148:151], v[88:91], v[108:111], v[172:175]
    v_add_f32 v15, v15, v157
    v_mfma_f32_16x16x32_bf16 v[152:155], v[88:91], v[124:127], v[176:179]
    ds_read_b128 v[104:107], v3 offset:5120
    v_cvt_pk_bf16_f32 v196, v156, v157
    s_waitcnt lgkmcnt(3)
    v_mfma_f32_16x16x32_bf16 v[140:143], v[92:95], v[112:115], v[140:143]
    v_exp_f32 v158, v158
    v_exp_f32 v159, v159
    v_mfma_f32_16x16x32_bf16 v[144:147], v[92:95], v[128:131], v[144:147]
    ds_read_b128 v[84:87], v3 offset:6144
    v_add_f32 v15, v15, v158
    s_add_u32 s25, s24, 35840
    buffer_load_dwordx4 v[224:227], v19, s[64:67], s25 offen
    s_waitcnt lgkmcnt(3)
    v_mfma_f32_16x16x32_bf16 v[148:151], v[96:99], v[112:115], v[148:151]
    v_add_f32 v15, v15, v159
    v_mfma_f32_16x16x32_bf16 v[152:155], v[96:99], v[128:131], v[152:155]
    ds_read_b128 v[88:91], v3 offset:7168
    v_cvt_pk_bf16_f32 v197, v158, v159
    s_waitcnt lgkmcnt(3)
    v_mfma_f32_16x16x32_bf16 v[140:143], v[100:103], v[116:119], v[140:143]
    v_exp_f32 v160, v160
    v_exp_f32 v161, v161
    v_mfma_f32_16x16x32_bf16 v[144:147], v[100:103], v[132:135], v[144:147]
    ds_read_b128 v[92:95], v2 offset:40960
    v_add_f32 v16, v16, v160
    s_waitcnt lgkmcnt(3)
    v_mfma_f32_16x16x32_bf16 v[148:151], v[104:107], v[116:119], v[148:151]
    v_add_f32 v16, v16, v161
    v_mfma_f32_16x16x32_bf16 v[152:155], v[104:107], v[132:135], v[152:155]
    ds_read_b128 v[96:99], v2 offset:41984
    v_cvt_pk_bf16_f32 v200, v160, v161
    s_waitcnt lgkmcnt(3)
    v_mfma_f32_16x16x32_bf16 v[140:143], v[84:87], v[120:123], v[140:143]
    v_exp_f32 v162, v162
    v_exp_f32 v163, v163
    v_mfma_f32_16x16x32_bf16 v[144:147], v[84:87], v[136:139], v[144:147]
    ds_read_b128 v[100:103], v2 offset:43008
    v_add_f32 v16, v16, v162
    s_add_u32 s25, s24, 43008
    buffer_load_dwordx4 v[228:231], v19, s[64:67], s25 offen
    s_waitcnt lgkmcnt(3)
    v_mfma_f32_16x16x32_bf16 v[148:151], v[88:91], v[120:123], v[148:151]
    v_add_f32 v16, v16, v163
    v_mfma_f32_16x16x32_bf16 v[152:155], v[88:91], v[136:139], v[152:155]
    ds_read_b128 v[104:107], v2 offset:44032
    v_cvt_pk_bf16_f32 v201, v162, v163
    s_waitcnt lgkmcnt(3)
    v_mfma_f32_16x16x32_bf16 v[20:23], v[92:95], v[188:191], v[20:23]
    v_exp_f32 v164, v164
    v_exp_f32 v165, v165
    v_mfma_f32_16x16x32_bf16 v[24:27], v[92:95], v[192:195], v[24:27]
    ds_read_b128 v[84:87], v2 offset:45056
    v_add_f32 v15, v15, v164
    s_waitcnt lgkmcnt(3)
    v_mfma_f32_16x16x32_bf16 v[28:31], v[96:99], v[188:191], v[28:31]
    v_add_f32 v15, v15, v165
    v_mfma_f32_16x16x32_bf16 v[32:35], v[96:99], v[192:195], v[32:35]
    ds_read_b128 v[88:91], v2 offset:46080
    v_cvt_pk_bf16_f32 v198, v164, v165
    s_waitcnt lgkmcnt(3)
    v_mfma_f32_16x16x32_bf16 v[36:39], v[100:103], v[188:191], v[36:39]
    v_exp_f32 v166, v166
    v_exp_f32 v167, v167
    v_mfma_f32_16x16x32_bf16 v[40:43], v[100:103], v[192:195], v[40:43]
    ds_read_b128 v[92:95], v2 offset:47104
    v_add_f32 v15, v15, v166
    s_add_u32 s25, s24, 50176
    buffer_load_dwordx4 v[232:235], v19, s[64:67], s25 offen
    s_waitcnt lgkmcnt(3)
    v_mfma_f32_16x16x32_bf16 v[44:47], v[104:107], v[188:191], v[44:47]
    v_add_f32 v15, v15, v167
    v_mfma_f32_16x16x32_bf16 v[48:51], v[104:107], v[192:195], v[48:51]
    ds_read_b128 v[96:99], v2 offset:48128
    v_cvt_pk_bf16_f32 v199, v166, v167
    s_waitcnt lgkmcnt(3)
    v_mfma_f32_16x16x32_bf16 v[52:55], v[84:87], v[188:191], v[52:55]
    v_exp_f32 v168, v168
    v_exp_f32 v169, v169
    v_mfma_f32_16x16x32_bf16 v[56:59], v[84:87], v[192:195], v[56:59]
    s_barrier
    ds_read_b128 v[100:103], v3 offset:16384
    v_add_f32 v16, v16, v168
    s_waitcnt lgkmcnt(3)
    v_mfma_f32_16x16x32_bf16 v[60:63], v[88:91], v[188:191], v[60:63]
    v_add_f32 v16, v16, v169
    v_mfma_f32_16x16x32_bf16 v[64:67], v[88:91], v[192:195], v[64:67]
    ds_read_b128 v[104:107], v3 offset:17408
    v_cvt_pk_bf16_f32 v202, v168, v169
    s_waitcnt lgkmcnt(3)
    v_mfma_f32_16x16x32_bf16 v[68:71], v[92:95], v[188:191], v[68:71]
    v_exp_f32 v170, v170
    v_exp_f32 v171, v171
    v_mfma_f32_16x16x32_bf16 v[72:75], v[92:95], v[192:195], v[72:75]
    ds_read_b128 v[84:87], v3 offset:18432
    v_add_f32 v16, v16, v170
    s_waitcnt lgkmcnt(3)
    v_mfma_f32_16x16x32_bf16 v[76:79], v[96:99], v[188:191], v[76:79]
    v_add_f32 v16, v16, v171
    v_mfma_f32_16x16x32_bf16 v[80:83], v[96:99], v[192:195], v[80:83]
    ds_read_b128 v[88:91], v3 offset:19456
    v_cvt_pk_bf16_f32 v203, v170, v171
    s_add_u32 s25, s24, 57344
    buffer_load_dwordx4 v[236:239], v19, s[64:67], s25 offen
    s_waitcnt lgkmcnt(3)
    v_mfma_f32_16x16x32_bf16 v[156:159], v[100:103], v[108:111], v[172:175]
    v_exp_f32 v140, v140
    v_exp_f32 v141, v141
    v_mfma_f32_16x16x32_bf16 v[160:163], v[100:103], v[124:127], v[176:179]
    ds_read_b128 v[92:95], v3 offset:20480
    v_add_f32 v15, v15, v140
    s_waitcnt lgkmcnt(3)
    v_mfma_f32_16x16x32_bf16 v[164:167], v[104:107], v[108:111], v[172:175]
    v_add_f32 v15, v15, v141
    v_mfma_f32_16x16x32_bf16 v[168:171], v[104:107], v[124:127], v[176:179]
    ds_read_b128 v[96:99], v3 offset:21504
    v_cvt_pk_bf16_f32 v188, v140, v141
    s_waitcnt lgkmcnt(3)
    v_mfma_f32_16x16x32_bf16 v[156:159], v[84:87], v[112:115], v[156:159]
    v_exp_f32 v142, v142
    v_exp_f32 v143, v143
    v_mfma_f32_16x16x32_bf16 v[160:163], v[84:87], v[128:131], v[160:163]
    ds_read_b128 v[100:103], v3 offset:22528
    v_add_f32 v15, v15, v142
    s_waitcnt lgkmcnt(3)
    v_mfma_f32_16x16x32_bf16 v[164:167], v[88:91], v[112:115], v[164:167]
    v_add_f32 v15, v15, v143
    v_mfma_f32_16x16x32_bf16 v[168:171], v[88:91], v[128:131], v[168:171]
    ds_read_b128 v[104:107], v3 offset:23552
    v_cvt_pk_bf16_f32 v189, v142, v143
    s_add_u32 s25, s24, 64512
    buffer_load_dwordx4 v[240:243], v19, s[64:67], s25 offen
    s_waitcnt lgkmcnt(3)
    v_mfma_f32_16x16x32_bf16 v[156:159], v[92:95], v[116:119], v[156:159]
    v_exp_f32 v144, v144
    v_exp_f32 v145, v145
    v_mfma_f32_16x16x32_bf16 v[160:163], v[92:95], v[132:135], v[160:163]
    ds_read_b128 v[84:87], v2 offset:57344
    v_add_f32 v16, v16, v144
    s_waitcnt lgkmcnt(3)
    v_mfma_f32_16x16x32_bf16 v[164:167], v[96:99], v[116:119], v[164:167]
    v_add_f32 v16, v16, v145
    v_mfma_f32_16x16x32_bf16 v[168:171], v[96:99], v[132:135], v[168:171]
    ds_read_b128 v[88:91], v2 offset:58368
    v_cvt_pk_bf16_f32 v192, v144, v145
    s_waitcnt lgkmcnt(3)
    v_mfma_f32_16x16x32_bf16 v[156:159], v[100:103], v[120:123], v[156:159]
    v_exp_f32 v146, v146
    v_exp_f32 v147, v147
    v_mfma_f32_16x16x32_bf16 v[160:163], v[100:103], v[136:139], v[160:163]
    ds_read_b128 v[92:95], v2 offset:59392
    v_add_f32 v16, v16, v146
    s_waitcnt lgkmcnt(3)
    v_mfma_f32_16x16x32_bf16 v[164:167], v[104:107], v[120:123], v[164:167]
    v_add_f32 v16, v16, v147
    v_mfma_f32_16x16x32_bf16 v[168:171], v[104:107], v[136:139], v[168:171]
    ds_read_b128 v[96:99], v2 offset:60416
    v_cvt_pk_bf16_f32 v193, v146, v147
    s_waitcnt lgkmcnt(3)
    v_mfma_f32_16x16x32_bf16 v[20:23], v[84:87], v[196:199], v[20:23]
    v_exp_f32 v148, v148
    v_exp_f32 v149, v149
    v_mfma_f32_16x16x32_bf16 v[24:27], v[84:87], v[200:203], v[24:27]
    ds_read_b128 v[100:103], v2 offset:61440
    v_add_f32 v15, v15, v148
    s_add_u32 s25, s24, 71680
    buffer_load_dwordx4 v[244:247], v19, s[64:67], s25 offen
    s_waitcnt lgkmcnt(3)
    v_mfma_f32_16x16x32_bf16 v[28:31], v[88:91], v[196:199], v[28:31]
    v_add_f32 v15, v15, v149
    v_mfma_f32_16x16x32_bf16 v[32:35], v[88:91], v[200:203], v[32:35]
    ds_read_b128 v[104:107], v2 offset:62464
    v_cvt_pk_bf16_f32 v190, v148, v149
    s_waitcnt lgkmcnt(3)
    v_mfma_f32_16x16x32_bf16 v[36:39], v[92:95], v[196:199], v[36:39]
    v_exp_f32 v150, v150
    v_exp_f32 v151, v151
    v_mfma_f32_16x16x32_bf16 v[40:43], v[92:95], v[200:203], v[40:43]
    ds_read_b128 v[84:87], v2 offset:63488
    v_add_f32 v15, v15, v150
    s_waitcnt lgkmcnt(3)
    v_mfma_f32_16x16x32_bf16 v[44:47], v[96:99], v[196:199], v[44:47]
    v_add_f32 v15, v15, v151
    v_mfma_f32_16x16x32_bf16 v[48:51], v[96:99], v[200:203], v[48:51]
    ds_read_b128 v[88:91], v2 offset:64512
    v_cvt_pk_bf16_f32 v191, v150, v151
    s_waitcnt lgkmcnt(3)
    v_mfma_f32_16x16x32_bf16 v[52:55], v[100:103], v[196:199], v[52:55]
    v_exp_f32 v152, v152
    v_exp_f32 v153, v153
    v_mfma_f32_16x16x32_bf16 v[56:59], v[100:103], v[200:203], v[56:59]
    s_barrier
    ds_read_b128 v[92:95], v2 offset:0
    v_add_f32 v16, v16, v152
    s_add_u32 s25, s24, 78848
    buffer_load_dwordx4 v[248:251], v19, s[64:67], s25 offen
    s_waitcnt lgkmcnt(3)
    v_mfma_f32_16x16x32_bf16 v[60:63], v[104:107], v[196:199], v[60:63]
    v_add_f32 v16, v16, v153
    v_mfma_f32_16x16x32_bf16 v[64:67], v[104:107], v[200:203], v[64:67]
    ds_read_b128 v[96:99], v2 offset:1024
    v_cvt_pk_bf16_f32 v194, v152, v153
    s_waitcnt lgkmcnt(3)
    v_mfma_f32_16x16x32_bf16 v[68:71], v[84:87], v[196:199], v[68:71]
    v_exp_f32 v154, v154
    v_exp_f32 v155, v155
    v_mfma_f32_16x16x32_bf16 v[72:75], v[84:87], v[200:203], v[72:75]
    ds_read_b128 v[100:103], v2 offset:2048
    v_add_f32 v16, v16, v154
    s_waitcnt lgkmcnt(3)
    v_mfma_f32_16x16x32_bf16 v[76:79], v[88:91], v[196:199], v[76:79]
    v_add_f32 v16, v16, v155
    v_mfma_f32_16x16x32_bf16 v[80:83], v[88:91], v[200:203], v[80:83]
    ds_read_b128 v[104:107], v2 offset:3072
    v_cvt_pk_bf16_f32 v195, v154, v155
    s_waitcnt lgkmcnt(3)
    v_mfma_f32_16x16x32_bf16 v[140:143], v[92:95], v[108:111], v[172:175]
    v_exp_f32 v156, v156
    v_exp_f32 v157, v157
    v_mfma_f32_16x16x32_bf16 v[144:147], v[92:95], v[124:127], v[176:179]
    ds_read_b128 v[84:87], v2 offset:4096
    v_add_f32 v15, v15, v156
    s_add_u32 s25, s24, 86016
    buffer_load_dwordx4 v[252:255], v19, s[64:67], s25 offen
    s_waitcnt lgkmcnt(3)
    v_mfma_f32_16x16x32_bf16 v[148:151], v[96:99], v[108:111], v[172:175]
    v_add_f32 v15, v15, v157
    v_mfma_f32_16x16x32_bf16 v[152:155], v[96:99], v[124:127], v[176:179]
    ds_read_b128 v[88:91], v2 offset:5120
    v_cvt_pk_bf16_f32 v196, v156, v157
    s_waitcnt lgkmcnt(3)
    v_mfma_f32_16x16x32_bf16 v[140:143], v[100:103], v[112:115], v[140:143]
    v_exp_f32 v158, v158
    v_exp_f32 v159, v159
    v_mfma_f32_16x16x32_bf16 v[144:147], v[100:103], v[128:131], v[144:147]
    ds_read_b128 v[92:95], v2 offset:6144
    v_add_f32 v15, v15, v158
    s_waitcnt lgkmcnt(3)
    v_mfma_f32_16x16x32_bf16 v[148:151], v[104:107], v[112:115], v[148:151]
    v_add_f32 v15, v15, v159
    v_mfma_f32_16x16x32_bf16 v[152:155], v[104:107], v[128:131], v[152:155]
    ds_read_b128 v[96:99], v2 offset:7168
    v_cvt_pk_bf16_f32 v197, v158, v159
    s_waitcnt lgkmcnt(3)
    v_mfma_f32_16x16x32_bf16 v[140:143], v[84:87], v[116:119], v[140:143]
    v_exp_f32 v160, v160
    v_exp_f32 v161, v161
    v_mfma_f32_16x16x32_bf16 v[144:147], v[84:87], v[132:135], v[144:147]
    ds_read_b128 v[100:103], v3 offset:8192
    v_add_f32 v16, v16, v160
    s_waitcnt lgkmcnt(3)
    v_mfma_f32_16x16x32_bf16 v[148:151], v[88:91], v[116:119], v[148:151]
    v_add_f32 v16, v16, v161
    v_mfma_f32_16x16x32_bf16 v[152:155], v[88:91], v[132:135], v[152:155]
    ds_read_b128 v[104:107], v3 offset:9216
    v_cvt_pk_bf16_f32 v200, v160, v161
    s_add_u32 s25, s24, 93184
    buffer_load_dwordx4 v[180:183], v19, s[64:67], s25 offen
    s_waitcnt lgkmcnt(3)
    v_mfma_f32_16x16x32_bf16 v[140:143], v[92:95], v[120:123], v[140:143]
    v_exp_f32 v162, v162
    v_exp_f32 v163, v163
    v_mfma_f32_16x16x32_bf16 v[144:147], v[92:95], v[136:139], v[144:147]
    ds_read_b128 v[84:87], v3 offset:10240
    v_add_f32 v16, v16, v162
    s_waitcnt lgkmcnt(3)
    v_mfma_f32_16x16x32_bf16 v[148:151], v[96:99], v[120:123], v[148:151]
    v_add_f32 v16, v16, v163
    v_mfma_f32_16x16x32_bf16 v[152:155], v[96:99], v[136:139], v[152:155]
    ds_read_b128 v[88:91], v3 offset:11264
    v_cvt_pk_bf16_f32 v201, v162, v163
    s_waitcnt lgkmcnt(3)
    v_mfma_f32_16x16x32_bf16 v[20:23], v[100:103], v[188:191], v[20:23]
    v_exp_f32 v164, v164
    v_exp_f32 v165, v165
    v_mfma_f32_16x16x32_bf16 v[24:27], v[100:103], v[192:195], v[24:27]
    ds_read_b128 v[92:95], v3 offset:12288
    v_add_f32 v15, v15, v164
    s_waitcnt lgkmcnt(3)
    v_mfma_f32_16x16x32_bf16 v[28:31], v[104:107], v[188:191], v[28:31]
    v_add_f32 v15, v15, v165
    v_mfma_f32_16x16x32_bf16 v[32:35], v[104:107], v[192:195], v[32:35]
    ds_read_b128 v[96:99], v3 offset:13312
    v_cvt_pk_bf16_f32 v198, v164, v165
    s_add_u32 s25, s24, 100352
    buffer_load_dwordx4 v[184:187], v19, s[64:67], s25 offen
    s_waitcnt lgkmcnt(3)
    v_mfma_f32_16x16x32_bf16 v[36:39], v[84:87], v[188:191], v[36:39]
    v_exp_f32 v166, v166
    v_exp_f32 v167, v167
    v_mfma_f32_16x16x32_bf16 v[40:43], v[84:87], v[192:195], v[40:43]
    ds_read_b128 v[100:103], v3 offset:14336
    v_add_f32 v15, v15, v166
    s_waitcnt lgkmcnt(3)
    v_mfma_f32_16x16x32_bf16 v[44:47], v[88:91], v[188:191], v[44:47]
    v_add_f32 v15, v15, v167
    v_mfma_f32_16x16x32_bf16 v[48:51], v[88:91], v[192:195], v[48:51]
    ds_read_b128 v[104:107], v3 offset:15360
    v_cvt_pk_bf16_f32 v199, v166, v167
    s_waitcnt lgkmcnt(3)
    v_mfma_f32_16x16x32_bf16 v[52:55], v[92:95], v[188:191], v[52:55]
    v_exp_f32 v168, v168
    v_exp_f32 v169, v169
    v_mfma_f32_16x16x32_bf16 v[56:59], v[92:95], v[192:195], v[56:59]
    s_barrier
    ds_read_b128 v[84:87], v2 offset:16384
    v_add_f32 v16, v16, v168
    s_waitcnt lgkmcnt(3)
    v_mfma_f32_16x16x32_bf16 v[60:63], v[96:99], v[188:191], v[60:63]
    v_add_f32 v16, v16, v169
    v_mfma_f32_16x16x32_bf16 v[64:67], v[96:99], v[192:195], v[64:67]
    ds_read_b128 v[88:91], v2 offset:17408
    v_cvt_pk_bf16_f32 v202, v168, v169
    s_waitcnt lgkmcnt(3)
    v_mfma_f32_16x16x32_bf16 v[68:71], v[100:103], v[188:191], v[68:71]
    v_exp_f32 v170, v170
    v_exp_f32 v171, v171
    v_mfma_f32_16x16x32_bf16 v[72:75], v[100:103], v[192:195], v[72:75]
    ds_read_b128 v[92:95], v2 offset:18432
    v_add_f32 v16, v16, v170
    s_waitcnt lgkmcnt(3)
    v_mfma_f32_16x16x32_bf16 v[76:79], v[104:107], v[188:191], v[76:79]
    v_add_f32 v16, v16, v171
    v_mfma_f32_16x16x32_bf16 v[80:83], v[104:107], v[192:195], v[80:83]
    ds_read_b128 v[96:99], v2 offset:19456
    v_cvt_pk_bf16_f32 v203, v170, v171
    s_waitcnt lgkmcnt(3)
    v_mfma_f32_16x16x32_bf16 v[156:159], v[84:87], v[108:111], v[172:175]
    v_exp_f32 v140, v140
    v_exp_f32 v141, v141
    v_mfma_f32_16x16x32_bf16 v[160:163], v[84:87], v[124:127], v[176:179]
    ds_read_b128 v[100:103], v2 offset:20480
    v_add_f32 v15, v15, v140
    s_waitcnt lgkmcnt(3)
    v_mfma_f32_16x16x32_bf16 v[164:167], v[88:91], v[108:111], v[172:175]
    v_add_f32 v15, v15, v141
    v_mfma_f32_16x16x32_bf16 v[168:171], v[88:91], v[124:127], v[176:179]
    ds_read_b128 v[104:107], v2 offset:21504
    v_cvt_pk_bf16_f32 v188, v140, v141
    s_waitcnt lgkmcnt(3)
    v_mfma_f32_16x16x32_bf16 v[156:159], v[92:95], v[112:115], v[156:159]
    v_exp_f32 v142, v142
    v_exp_f32 v143, v143
    v_mfma_f32_16x16x32_bf16 v[160:163], v[92:95], v[128:131], v[160:163]
    ds_read_b128 v[84:87], v2 offset:22528
    v_add_f32 v15, v15, v142
    s_waitcnt lgkmcnt(3)
    v_mfma_f32_16x16x32_bf16 v[164:167], v[96:99], v[112:115], v[164:167]
    v_add_f32 v15, v15, v143
    v_mfma_f32_16x16x32_bf16 v[168:171], v[96:99], v[128:131], v[168:171]
    ds_read_b128 v[88:91], v2 offset:23552
    v_cvt_pk_bf16_f32 v189, v142, v143
    s_waitcnt lgkmcnt(3)
    v_mfma_f32_16x16x32_bf16 v[156:159], v[100:103], v[116:119], v[156:159]
    v_exp_f32 v144, v144
    v_exp_f32 v145, v145
    v_mfma_f32_16x16x32_bf16 v[160:163], v[100:103], v[132:135], v[160:163]
    ds_read_b128 v[92:95], v3 offset:24576
    v_add_f32 v16, v16, v144
    s_waitcnt lgkmcnt(3)
    v_mfma_f32_16x16x32_bf16 v[164:167], v[104:107], v[116:119], v[164:167]
    v_add_f32 v16, v16, v145
    v_mfma_f32_16x16x32_bf16 v[168:171], v[104:107], v[132:135], v[168:171]
    ds_read_b128 v[96:99], v3 offset:25600
    v_cvt_pk_bf16_f32 v192, v144, v145
    s_waitcnt lgkmcnt(3)
    v_mfma_f32_16x16x32_bf16 v[156:159], v[84:87], v[120:123], v[156:159]
    v_exp_f32 v146, v146
    v_exp_f32 v147, v147
    v_mfma_f32_16x16x32_bf16 v[160:163], v[84:87], v[136:139], v[160:163]
    ds_read_b128 v[100:103], v3 offset:26624
    v_add_f32 v16, v16, v146
    s_waitcnt lgkmcnt(3)
    v_mfma_f32_16x16x32_bf16 v[164:167], v[88:91], v[120:123], v[164:167]
    v_add_f32 v16, v16, v147
    v_mfma_f32_16x16x32_bf16 v[168:171], v[88:91], v[136:139], v[168:171]
    ds_read_b128 v[104:107], v3 offset:27648
    v_cvt_pk_bf16_f32 v193, v146, v147
    s_waitcnt lgkmcnt(3)
    v_mfma_f32_16x16x32_bf16 v[20:23], v[92:95], v[196:199], v[20:23]
    v_exp_f32 v148, v148
    v_exp_f32 v149, v149
    v_mfma_f32_16x16x32_bf16 v[24:27], v[92:95], v[200:203], v[24:27]
    ds_read_b128 v[84:87], v3 offset:28672
    v_add_f32 v15, v15, v148
    s_waitcnt lgkmcnt(3)
    v_mfma_f32_16x16x32_bf16 v[28:31], v[96:99], v[196:199], v[28:31]
    v_add_f32 v15, v15, v149
    v_mfma_f32_16x16x32_bf16 v[32:35], v[96:99], v[200:203], v[32:35]
    ds_read_b128 v[88:91], v3 offset:29696
    v_cvt_pk_bf16_f32 v190, v148, v149
    s_waitcnt lgkmcnt(3)
    v_mfma_f32_16x16x32_bf16 v[36:39], v[100:103], v[196:199], v[36:39]
    v_exp_f32 v150, v150
    v_exp_f32 v151, v151
    v_mfma_f32_16x16x32_bf16 v[40:43], v[100:103], v[200:203], v[40:43]
    ds_read_b128 v[92:95], v3 offset:30720
    v_add_f32 v15, v15, v150
    s_waitcnt lgkmcnt(3)
    v_mfma_f32_16x16x32_bf16 v[44:47], v[104:107], v[196:199], v[44:47]
    v_add_f32 v15, v15, v151
    v_mfma_f32_16x16x32_bf16 v[48:51], v[104:107], v[200:203], v[48:51]
    ds_read_b128 v[96:99], v3 offset:31744
    v_cvt_pk_bf16_f32 v191, v150, v151
    s_waitcnt lgkmcnt(3)
    v_mfma_f32_16x16x32_bf16 v[52:55], v[84:87], v[196:199], v[52:55]
    v_exp_f32 v152, v152
    v_exp_f32 v153, v153
    v_mfma_f32_16x16x32_bf16 v[56:59], v[84:87], v[200:203], v[56:59]
    s_barrier
    ds_read_b128 v[100:103], v2 offset:32768
    v_add_f32 v16, v16, v152
    s_waitcnt lgkmcnt(3)
    v_mfma_f32_16x16x32_bf16 v[60:63], v[88:91], v[196:199], v[60:63]
    v_add_f32 v16, v16, v153
    v_mfma_f32_16x16x32_bf16 v[64:67], v[88:91], v[200:203], v[64:67]
    ds_read_b128 v[104:107], v2 offset:33792
    v_cvt_pk_bf16_f32 v194, v152, v153
    s_waitcnt lgkmcnt(3)
    v_mfma_f32_16x16x32_bf16 v[68:71], v[92:95], v[196:199], v[68:71]
    v_exp_f32 v154, v154
    v_exp_f32 v155, v155
    v_mfma_f32_16x16x32_bf16 v[72:75], v[92:95], v[200:203], v[72:75]
    ds_read_b128 v[84:87], v2 offset:34816
    v_add_f32 v16, v16, v154
    s_waitcnt lgkmcnt(3)
    v_mfma_f32_16x16x32_bf16 v[76:79], v[96:99], v[196:199], v[76:79]
    v_add_f32 v16, v16, v155
    v_mfma_f32_16x16x32_bf16 v[80:83], v[96:99], v[200:203], v[80:83]
    ds_read_b128 v[88:91], v2 offset:35840
    v_cvt_pk_bf16_f32 v195, v154, v155
    s_waitcnt lgkmcnt(3)
    v_mfma_f32_16x16x32_bf16 v[140:143], v[100:103], v[108:111], v[172:175]
    v_exp_f32 v156, v156
    v_exp_f32 v157, v157
    v_mfma_f32_16x16x32_bf16 v[144:147], v[100:103], v[124:127], v[176:179]
    ds_read_b128 v[92:95], v2 offset:36864
    v_add_f32 v15, v15, v156
    s_waitcnt lgkmcnt(3)
    v_mfma_f32_16x16x32_bf16 v[148:151], v[104:107], v[108:111], v[172:175]
    v_add_f32 v15, v15, v157
    v_mfma_f32_16x16x32_bf16 v[152:155], v[104:107], v[124:127], v[176:179]
    ds_read_b128 v[96:99], v2 offset:37888
    v_cvt_pk_bf16_f32 v196, v156, v157
    s_waitcnt lgkmcnt(3)
    v_mfma_f32_16x16x32_bf16 v[140:143], v[84:87], v[112:115], v[140:143]
    v_exp_f32 v158, v158
    v_exp_f32 v159, v159
    v_mfma_f32_16x16x32_bf16 v[144:147], v[84:87], v[128:131], v[144:147]
    ds_read_b128 v[100:103], v2 offset:38912
    v_add_f32 v15, v15, v158
    s_waitcnt lgkmcnt(3)
    v_mfma_f32_16x16x32_bf16 v[148:151], v[88:91], v[112:115], v[148:151]
    v_add_f32 v15, v15, v159
    v_mfma_f32_16x16x32_bf16 v[152:155], v[88:91], v[128:131], v[152:155]
    ds_read_b128 v[104:107], v2 offset:39936
    v_cvt_pk_bf16_f32 v197, v158, v159
    s_waitcnt lgkmcnt(3)
    v_mfma_f32_16x16x32_bf16 v[140:143], v[92:95], v[116:119], v[140:143]
    v_exp_f32 v160, v160
    v_exp_f32 v161, v161
    v_mfma_f32_16x16x32_bf16 v[144:147], v[92:95], v[132:135], v[144:147]
    ds_read_b128 v[84:87], v2 offset:8192
    v_add_f32 v16, v16, v160
    s_waitcnt lgkmcnt(3)
    v_mfma_f32_16x16x32_bf16 v[148:151], v[96:99], v[116:119], v[148:151]
    v_add_f32 v16, v16, v161
    v_mfma_f32_16x16x32_bf16 v[152:155], v[96:99], v[132:135], v[152:155]
    ds_read_b128 v[88:91], v2 offset:9216
    v_cvt_pk_bf16_f32 v200, v160, v161
    s_waitcnt lgkmcnt(3)
    v_mfma_f32_16x16x32_bf16 v[140:143], v[100:103], v[120:123], v[140:143]
    v_exp_f32 v162, v162
    v_exp_f32 v163, v163
    v_mfma_f32_16x16x32_bf16 v[144:147], v[100:103], v[136:139], v[144:147]
    ds_read_b128 v[92:95], v2 offset:10240
    v_add_f32 v16, v16, v162
    s_waitcnt lgkmcnt(3)
    v_mfma_f32_16x16x32_bf16 v[148:151], v[104:107], v[120:123], v[148:151]
    v_add_f32 v16, v16, v163
    v_mfma_f32_16x16x32_bf16 v[152:155], v[104:107], v[136:139], v[152:155]
    ds_read_b128 v[96:99], v2 offset:11264
    v_cvt_pk_bf16_f32 v201, v162, v163
    s_waitcnt lgkmcnt(3)
    v_mfma_f32_16x16x32_bf16 v[20:23], v[84:87], v[188:191], v[20:23]
    v_exp_f32 v164, v164
    v_exp_f32 v165, v165
    v_mfma_f32_16x16x32_bf16 v[24:27], v[84:87], v[192:195], v[24:27]
    ds_read_b128 v[100:103], v2 offset:12288
    v_add_f32 v15, v15, v164
    s_waitcnt lgkmcnt(3)
    v_mfma_f32_16x16x32_bf16 v[28:31], v[88:91], v[188:191], v[28:31]
    v_add_f32 v15, v15, v165
    v_mfma_f32_16x16x32_bf16 v[32:35], v[88:91], v[192:195], v[32:35]
    ds_read_b128 v[104:107], v2 offset:13312
    v_cvt_pk_bf16_f32 v198, v164, v165
    s_waitcnt lgkmcnt(3)
    v_mfma_f32_16x16x32_bf16 v[36:39], v[92:95], v[188:191], v[36:39]
    v_exp_f32 v166, v166
    v_exp_f32 v167, v167
    v_mfma_f32_16x16x32_bf16 v[40:43], v[92:95], v[192:195], v[40:43]
    ds_read_b128 v[84:87], v2 offset:14336
    v_add_f32 v15, v15, v166
    s_waitcnt lgkmcnt(3)
    v_mfma_f32_16x16x32_bf16 v[44:47], v[96:99], v[188:191], v[44:47]
    v_add_f32 v15, v15, v167
    v_mfma_f32_16x16x32_bf16 v[48:51], v[96:99], v[192:195], v[48:51]
    ds_read_b128 v[88:91], v2 offset:15360
    v_cvt_pk_bf16_f32 v199, v166, v167
    s_waitcnt lgkmcnt(3)
    v_mfma_f32_16x16x32_bf16 v[52:55], v[100:103], v[188:191], v[52:55]
    v_exp_f32 v168, v168
    v_exp_f32 v169, v169
    v_mfma_f32_16x16x32_bf16 v[56:59], v[100:103], v[192:195], v[56:59]
    s_barrier
    ds_read_b128 v[92:95], v2 offset:49152
    v_add_f32 v16, v16, v168
    s_waitcnt lgkmcnt(3)
    v_mfma_f32_16x16x32_bf16 v[60:63], v[104:107], v[188:191], v[60:63]
    v_add_f32 v16, v16, v169
    v_mfma_f32_16x16x32_bf16 v[64:67], v[104:107], v[192:195], v[64:67]
    ds_read_b128 v[96:99], v2 offset:50176
    v_cvt_pk_bf16_f32 v202, v168, v169
    s_waitcnt lgkmcnt(3)
    v_mfma_f32_16x16x32_bf16 v[68:71], v[84:87], v[188:191], v[68:71]
    v_exp_f32 v170, v170
    v_exp_f32 v171, v171
    v_mfma_f32_16x16x32_bf16 v[72:75], v[84:87], v[192:195], v[72:75]
    ds_read_b128 v[100:103], v2 offset:51200
    v_add_f32 v16, v16, v170
    s_waitcnt lgkmcnt(3)
    v_mfma_f32_16x16x32_bf16 v[76:79], v[88:91], v[188:191], v[76:79]
    v_add_f32 v16, v16, v171
    v_mfma_f32_16x16x32_bf16 v[80:83], v[88:91], v[192:195], v[80:83]
    ds_read_b128 v[104:107], v2 offset:52224
    v_cvt_pk_bf16_f32 v203, v170, v171
    s_waitcnt lgkmcnt(3)
    v_mfma_f32_16x16x32_bf16 v[156:159], v[92:95], v[108:111], v[172:175]
    v_exp_f32 v140, v140
    v_exp_f32 v141, v141
    v_mfma_f32_16x16x32_bf16 v[160:163], v[92:95], v[124:127], v[176:179]
    ds_read_b128 v[84:87], v2 offset:53248
    v_add_f32 v15, v15, v140
    s_waitcnt lgkmcnt(3)
    v_mfma_f32_16x16x32_bf16 v[164:167], v[96:99], v[108:111], v[172:175]
    v_add_f32 v15, v15, v141
    v_mfma_f32_16x16x32_bf16 v[168:171], v[96:99], v[124:127], v[176:179]
    ds_read_b128 v[88:91], v2 offset:54272
    v_cvt_pk_bf16_f32 v188, v140, v141
    s_waitcnt lgkmcnt(3)
    v_mfma_f32_16x16x32_bf16 v[156:159], v[100:103], v[112:115], v[156:159]
    v_exp_f32 v142, v142
    v_exp_f32 v143, v143
    v_mfma_f32_16x16x32_bf16 v[160:163], v[100:103], v[128:131], v[160:163]
    ds_read_b128 v[92:95], v2 offset:55296
    v_add_f32 v15, v15, v142
    s_waitcnt lgkmcnt(3)
    v_mfma_f32_16x16x32_bf16 v[164:167], v[104:107], v[112:115], v[164:167]
    v_add_f32 v15, v15, v143
    v_mfma_f32_16x16x32_bf16 v[168:171], v[104:107], v[128:131], v[168:171]
    ds_read_b128 v[96:99], v2 offset:56320
    v_cvt_pk_bf16_f32 v189, v142, v143
    s_waitcnt lgkmcnt(3)
    v_mfma_f32_16x16x32_bf16 v[156:159], v[84:87], v[116:119], v[156:159]
    v_exp_f32 v144, v144
    v_exp_f32 v145, v145
    v_mfma_f32_16x16x32_bf16 v[160:163], v[84:87], v[132:135], v[160:163]
    ds_read_b128 v[100:103], v2 offset:24576
    v_add_f32 v16, v16, v144
    s_waitcnt lgkmcnt(3)
    v_mfma_f32_16x16x32_bf16 v[164:167], v[88:91], v[116:119], v[164:167]
    v_add_f32 v16, v16, v145
    v_mfma_f32_16x16x32_bf16 v[168:171], v[88:91], v[132:135], v[168:171]
    ds_read_b128 v[104:107], v2 offset:25600
    v_cvt_pk_bf16_f32 v192, v144, v145
    s_waitcnt lgkmcnt(3)
    v_mfma_f32_16x16x32_bf16 v[156:159], v[92:95], v[120:123], v[156:159]
    v_exp_f32 v146, v146
    v_exp_f32 v147, v147
    v_mfma_f32_16x16x32_bf16 v[160:163], v[92:95], v[136:139], v[160:163]
    ds_read_b128 v[84:87], v2 offset:26624
    v_add_f32 v16, v16, v146
    s_waitcnt lgkmcnt(3)
    v_mfma_f32_16x16x32_bf16 v[164:167], v[96:99], v[120:123], v[164:167]
    v_add_f32 v16, v16, v147
    v_mfma_f32_16x16x32_bf16 v[168:171], v[96:99], v[136:139], v[168:171]
    ds_read_b128 v[88:91], v2 offset:27648
    v_cvt_pk_bf16_f32 v193, v146, v147
    s_waitcnt lgkmcnt(3)
    v_mfma_f32_16x16x32_bf16 v[20:23], v[100:103], v[196:199], v[20:23]
    v_exp_f32 v148, v148
    v_exp_f32 v149, v149
    v_mfma_f32_16x16x32_bf16 v[24:27], v[100:103], v[200:203], v[24:27]
    ds_read_b128 v[92:95], v2 offset:28672
    v_add_f32 v15, v15, v148
    s_waitcnt lgkmcnt(3)
    v_mfma_f32_16x16x32_bf16 v[28:31], v[104:107], v[196:199], v[28:31]
    v_add_f32 v15, v15, v149
    v_mfma_f32_16x16x32_bf16 v[32:35], v[104:107], v[200:203], v[32:35]
    ds_read_b128 v[96:99], v2 offset:29696
    v_cvt_pk_bf16_f32 v190, v148, v149
    s_waitcnt lgkmcnt(3)
    v_mfma_f32_16x16x32_bf16 v[36:39], v[84:87], v[196:199], v[36:39]
    v_exp_f32 v150, v150
    v_exp_f32 v151, v151
    v_mfma_f32_16x16x32_bf16 v[40:43], v[84:87], v[200:203], v[40:43]
    ds_read_b128 v[100:103], v2 offset:30720
    v_add_f32 v15, v15, v150
    s_waitcnt lgkmcnt(3)
    v_mfma_f32_16x16x32_bf16 v[44:47], v[88:91], v[196:199], v[44:47]
    v_add_f32 v15, v15, v151
    v_mfma_f32_16x16x32_bf16 v[48:51], v[88:91], v[200:203], v[48:51]
    ds_read_b128 v[104:107], v2 offset:31744
    v_cvt_pk_bf16_f32 v191, v150, v151
    s_waitcnt lgkmcnt(3)
    v_mfma_f32_16x16x32_bf16 v[52:55], v[92:95], v[196:199], v[52:55]
    v_exp_f32 v152, v152
    v_exp_f32 v153, v153
    v_mfma_f32_16x16x32_bf16 v[56:59], v[92:95], v[200:203], v[56:59]
    ds_read_b128 v[84:87], v2 offset:40960
    v_add_f32 v16, v16, v152
    s_waitcnt lgkmcnt(3)
    v_mfma_f32_16x16x32_bf16 v[60:63], v[96:99], v[196:199], v[60:63]
    v_add_f32 v16, v16, v153
    v_mfma_f32_16x16x32_bf16 v[64:67], v[96:99], v[200:203], v[64:67]
    ds_read_b128 v[88:91], v2 offset:41984
    v_cvt_pk_bf16_f32 v194, v152, v153
    s_waitcnt lgkmcnt(3)
    v_mfma_f32_16x16x32_bf16 v[68:71], v[100:103], v[196:199], v[68:71]
    v_exp_f32 v154, v154
    v_exp_f32 v155, v155
    v_mfma_f32_16x16x32_bf16 v[72:75], v[100:103], v[200:203], v[72:75]
    ds_read_b128 v[92:95], v2 offset:43008
    v_add_f32 v16, v16, v154
    s_waitcnt lgkmcnt(3)
    v_mfma_f32_16x16x32_bf16 v[76:79], v[104:107], v[196:199], v[76:79]
    v_add_f32 v16, v16, v155
    v_mfma_f32_16x16x32_bf16 v[80:83], v[104:107], v[200:203], v[80:83]
    ds_read_b128 v[96:99], v2 offset:44032
    v_cvt_pk_bf16_f32 v195, v154, v155
    s_waitcnt lgkmcnt(3)
    v_mfma_f32_16x16x32_bf16 v[20:23], v[84:87], v[188:191], v[20:23]
    v_exp_f32 v156, v156
    v_exp_f32 v157, v157
    v_add_f32 v15, v15, v156
    v_mfma_f32_16x16x32_bf16 v[24:27], v[84:87], v[192:195], v[24:27]
    ds_read_b128 v[100:103], v2 offset:45056
    v_add_f32 v15, v15, v157
    v_cvt_pk_bf16_f32 v196, v156, v157
    s_waitcnt lgkmcnt(3)
    v_mfma_f32_16x16x32_bf16 v[28:31], v[88:91], v[188:191], v[28:31]
    v_exp_f32 v158, v158
    v_exp_f32 v159, v159
    v_add_f32 v15, v15, v158
    v_mfma_f32_16x16x32_bf16 v[32:35], v[88:91], v[192:195], v[32:35]
    ds_read_b128 v[104:107], v2 offset:46080
    v_add_f32 v15, v15, v159
    v_cvt_pk_bf16_f32 v197, v158, v159
    s_waitcnt lgkmcnt(3)
    v_mfma_f32_16x16x32_bf16 v[36:39], v[92:95], v[188:191], v[36:39]
    v_exp_f32 v160, v160
    v_exp_f32 v161, v161
    v_add_f32 v16, v16, v160
    v_mfma_f32_16x16x32_bf16 v[40:43], v[92:95], v[192:195], v[40:43]
    ds_read_b128 v[84:87], v2 offset:47104
    v_add_f32 v16, v16, v161
    v_cvt_pk_bf16_f32 v200, v160, v161
    s_waitcnt lgkmcnt(3)
    v_mfma_f32_16x16x32_bf16 v[44:47], v[96:99], v[188:191], v[44:47]
    v_exp_f32 v162, v162
    v_exp_f32 v163, v163
    v_add_f32 v16, v16, v162
    v_mfma_f32_16x16x32_bf16 v[48:51], v[96:99], v[192:195], v[48:51]
    ds_read_b128 v[88:91], v2 offset:48128
    v_add_f32 v16, v16, v163
    v_cvt_pk_bf16_f32 v201, v162, v163
    s_waitcnt lgkmcnt(3)
    v_mfma_f32_16x16x32_bf16 v[52:55], v[100:103], v[188:191], v[52:55]
    v_exp_f32 v164, v164
    v_exp_f32 v165, v165
    v_add_f32 v15, v15, v164
    v_mfma_f32_16x16x32_bf16 v[56:59], v[100:103], v[192:195], v[56:59]
    ds_read_b128 v[92:95], v2 offset:57344
    v_add_f32 v15, v15, v165
    v_cvt_pk_bf16_f32 v198, v164, v165
    s_waitcnt lgkmcnt(3)
    v_mfma_f32_16x16x32_bf16 v[60:63], v[104:107], v[188:191], v[60:63]
    v_exp_f32 v166, v166
    v_exp_f32 v167, v167
    v_add_f32 v15, v15, v166
    v_mfma_f32_16x16x32_bf16 v[64:67], v[104:107], v[192:195], v[64:67]
    ds_read_b128 v[96:99], v2 offset:58368
    v_add_f32 v15, v15, v167
    v_cvt_pk_bf16_f32 v199, v166, v167
    s_waitcnt lgkmcnt(3)
    v_mfma_f32_16x16x32_bf16 v[68:71], v[84:87], v[188:191], v[68:71]
    v_exp_f32 v168, v168
    v_exp_f32 v169, v169
    v_add_f32 v16, v16, v168
    v_mfma_f32_16x16x32_bf16 v[72:75], v[84:87], v[192:195], v[72:75]
    ds_read_b128 v[100:103], v2 offset:59392
    v_add_f32 v16, v16, v169
    v_cvt_pk_bf16_f32 v202, v168, v169
    s_waitcnt lgkmcnt(3)
    v_mfma_f32_16x16x32_bf16 v[76:79], v[88:91], v[188:191], v[76:79]
    v_exp_f32 v170, v170
    v_exp_f32 v171, v171
    v_add_f32 v16, v16, v170
    v_mfma_f32_16x16x32_bf16 v[80:83], v[88:91], v[192:195], v[80:83]
    ds_read_b128 v[104:107], v2 offset:60416
    v_add_f32 v16, v16, v171
    v_cvt_pk_bf16_f32 v203, v170, v171
    s_waitcnt lgkmcnt(3)
    v_mfma_f32_16x16x32_bf16 v[20:23], v[92:95], v[196:199], v[20:23]
    v_mfma_f32_16x16x32_bf16 v[24:27], v[92:95], v[200:203], v[24:27]
    ds_read_b128 v[84:87], v2 offset:61440
    s_waitcnt lgkmcnt(3)
    v_mfma_f32_16x16x32_bf16 v[28:31], v[96:99], v[196:199], v[28:31]
    v_mfma_f32_16x16x32_bf16 v[32:35], v[96:99], v[200:203], v[32:35]
    ds_read_b128 v[88:91], v2 offset:62464
    s_waitcnt lgkmcnt(3)
    v_mfma_f32_16x16x32_bf16 v[36:39], v[100:103], v[196:199], v[36:39]
    v_mfma_f32_16x16x32_bf16 v[40:43], v[100:103], v[200:203], v[40:43]
    ds_read_b128 v[92:95], v2 offset:63488
    s_waitcnt lgkmcnt(3)
    v_mfma_f32_16x16x32_bf16 v[44:47], v[104:107], v[196:199], v[44:47]
    v_mfma_f32_16x16x32_bf16 v[48:51], v[104:107], v[200:203], v[48:51]
    ds_read_b128 v[96:99], v2 offset:64512
    s_waitcnt lgkmcnt(3)
    v_mfma_f32_16x16x32_bf16 v[52:55], v[84:87], v[196:199], v[52:55]
    v_mfma_f32_16x16x32_bf16 v[56:59], v[84:87], v[200:203], v[56:59]
    s_waitcnt lgkmcnt(2)
    v_mfma_f32_16x16x32_bf16 v[60:63], v[88:91], v[196:199], v[60:63]
    v_mfma_f32_16x16x32_bf16 v[64:67], v[88:91], v[200:203], v[64:67]
    s_waitcnt lgkmcnt(1)
    v_mfma_f32_16x16x32_bf16 v[68:71], v[92:95], v[196:199], v[68:71]
    v_mfma_f32_16x16x32_bf16 v[72:75], v[92:95], v[200:203], v[72:75]
    s_waitcnt lgkmcnt(0)
    v_mfma_f32_16x16x32_bf16 v[76:79], v[96:99], v[196:199], v[76:79]
    v_mfma_f32_16x16x32_bf16 v[80:83], v[96:99], v[200:203], v[80:83]
fz_chk:
    s_setprio 0
    v_mov_b32 v9, v15
    v_mov_b32 v11, v16
    s_nop 0
    v_permlane16_swap_b32 v15, v9
    v_permlane16_swap_b32 v16, v11
    v_add_f32 v15, v15, v9
    v_add_f32 v16, v16, v11
    v_mov_b32 v9, v15
    v_mov_b32 v11, v16
    s_nop 0
    v_permlane32_swap_b32 v15, v9
    v_permlane32_swap_b32 v16, v11
    v_add_f32 v15, v15, v9
    v_add_f32 v16, v16, v11
    v_max3_f32 v10, |v20|, |v21|, v15
    v_max3_f32 v12, |v22|, |v23|, v16
    v_max3_f32 v10, |v24|, |v25|, v10
    v_max3_f32 v12, |v26|, |v27|, v12
    v_max3_f32 v10, |v28|, |v29|, v10
    v_max3_f32 v12, |v30|, |v31|, v12
    v_max3_f32 v10, |v32|, |v33|, v10
    v_max3_f32 v12, |v34|, |v35|, v12
    v_max3_f32 v10, |v36|, |v37|, v10
    v_max3_f32 v12, |v38|, |v39|, v12
    v_max3_f32 v10, |v40|, |v41|, v10
    v_max3_f32 v12, |v42|, |v43|, v12
    v_max3_f32 v10, |v44|, |v45|, v10
    v_max3_f32 v12, |v46|, |v47|, v12
    v_max3_f32 v10, |v48|, |v49|, v10
    v_max3_f32 v12, |v50|, |v51|, v12
    v_max3_f32 v10, |v52|, |v53|, v10
    v_max3_f32 v12, |v54|, |v55|, v12
    v_max3_f32 v10, |v56|, |v57|, v10
    v_max3_f32 v12, |v58|, |v59|, v12
    v_max3_f32 v10, |v60|, |v61|, v10
    v_max3_f32 v12, |v62|, |v63|, v12
    v_max3_f32 v10, |v64|, |v65|, v10
    v_max3_f32 v12, |v66|, |v67|, v12
    v_max3_f32 v10, |v68|, |v69|, v10
    v_max3_f32 v12, |v70|, |v71|, v12
    v_max3_f32 v10, |v72|, |v73|, v10
    v_max3_f32 v12, |v74|, |v75|, v12
    v_max3_f32 v10, |v76|, |v77|, v10
    v_max3_f32 v12, |v78|, |v79|, v12
    v_max3_f32 v10, |v80|, |v81|, v10
    v_max3_f32 v12, |v82|, |v83|, v12
    v_max_f32 v10, v10, v12
    s_mov_b32 s26, 0x7b800000
    v_cmp_ngt_f32 vcc, s26, v10
    v_cmp_u_f32 s[26:27], v15, v16
    s_or_b64 vcc, vcc, s[26:27]
    s_cbranch_vccnz fz_slow
fz_epi:
    s_cmp_lt_u32 s3, 4
    s_cbranch_scc1 fz_nw15
    s_add_u32 s25, s24, 107520
    buffer_load_dwordx4 v[172:175], v19, s[64:67], s25 offen
fz_nw15:
    v_rcp_f32 v10, v15
    v_rcp_f32 v12, v16
    s_lshl_b32 s19, s13, 3
    s_add_u32 s19, s19, s3
    s_mul_i32 s20, s19, 262144
    s_lshl_b32 s25, s12, 12
    s_add_u32 s20, s20, s25
    s_add_u32 s20, s20, 0x1000000
    s_add_u32 s25, s20, 131072
    v_pk_mul_f32 v[148:149], v[20:21], v[10:11] op_sel_hi:[1,0]
    v_pk_mul_f32 v[150:151], v[22:23], v[10:11] op_sel_hi:[1,0]
    v_pk_mul_f32 v[152:153], v[28:29], v[10:11] op_sel_hi:[1,0]
    v_pk_mul_f32 v[154:155], v[30:31], v[10:11] op_sel_hi:[1,0]
    v_cvt_pk_bf16_f32 v108, v148, v149
    v_cvt_pk_bf16_f32 v109, v150, v151
    v_cvt_pk_bf16_f32 v110, v152, v153
    v_cvt_pk_bf16_f32 v111, v154, v155
    buffer_store_dwordx4 v[108:111], v1, s[8:11], s20 offen offset:0 sc1
    v_pk_mul_f32 v[164:165], v[24:25], v[12:13] op_sel_hi:[1,0]
    v_pk_mul_f32 v[166:167], v[26:27], v[12:13] op_sel_hi:[1,0]
    v_pk_mul_f32 v[168:169], v[32:33], v[12:13] op_sel_hi:[1,0]
    v_pk_mul_f32 v[170:171], v[34:35], v[12:13] op_sel_hi:[1,0]
    v_cvt_pk_bf16_f32 v124, v164, v165
    v_cvt_pk_bf16_f32 v125, v166, v167
    v_cvt_pk_bf16_f32 v126, v168, v169
    v_cvt_pk_bf16_f32 v127, v170, v171
    buffer_store_dwordx4 v[124:127], v1, s[8:11], s25 offen offset:0 sc1
    v_pk_mul_f32 v[148:149], v[36:37], v[10:11] op_sel_hi:[1,0]
    v_pk_mul_f32 v[150:151], v[38:39], v[10:11] op_sel_hi:[1,0]
    v_pk_mul_f32 v[152:153], v[44:45], v[10:11] op_sel_hi:[1,0]
    v_pk_mul_f32 v[154:155], v[46:47], v[10:11] op_sel_hi:[1,0]
    v_cvt_pk_bf16_f32 v112, v148, v149
    v_cvt_pk_bf16_f32 v113, v150, v151
    v_cvt_pk_bf16_f32 v114, v152, v153
    v_cvt_pk_bf16_f32 v115, v154, v155
    buffer_store_dwordx4 v[112:115], v1, s[8:11], s20 offen offset:1024 sc1
    v_pk_mul_f32 v[164:165], v[40:41], v[12:13] op_sel_hi:[1,0]
    v_pk_mul_f32 v[166:167], v[42:43], v[12:13] op_sel_hi:[1,0]
    v_pk_mul_f32 v[168:169], v[48:49], v[12:13] op_sel_hi:[1,0]
    v_pk_mul_f32 v[170:171], v[50:51], v[12:13] op_sel_hi:[1,0]
    v_cvt_pk_bf16_f32 v128, v164, v165
    v_cvt_pk_bf16_f32 v129, v166, v167
    v_cvt_pk_bf16_f32 v130, v168, v169
    v_cvt_pk_bf16_f32 v131, v170, v171
    buffer_store_dwordx4 v[128:131], v1, s[8:11], s25 offen offset:1024 sc1
    v_pk_mul_f32 v[148:149], v[52:53], v[10:11] op_sel_hi:[1,0]
    v_pk_mul_f32 v[150:151], v[54:55], v[10:11] op_sel_hi:[1,0]
    v_pk_mul_f32 v[152:153], v[60:61], v[10:11] op_sel_hi:[1,0]
    v_pk_mul_f32 v[154:155], v[62:63], v[10:11] op_sel_hi:[1,0]
    v_cvt_pk_bf16_f32 v116, v148, v149
    v_cvt_pk_bf16_f32 v117, v150, v151
    v_cvt_pk_bf16_f32 v118, v152, v153
    v_cvt_pk_bf16_f32 v119, v154, v155
    buffer_store_dwordx4 v[116:119], v1, s[8:11], s20 offen offset:2048 sc1
    v_pk_mul_f32 v[164:165], v[56:57], v[12:13] op_sel_hi:[1,0]
    v_pk_mul_f32 v[166:167], v[58:59], v[12:13] op_sel_hi:[1,0]
    v_pk_mul_f32 v[168:169], v[64:65], v[12:13] op_sel_hi:[1,0]
    v_pk_mul_f32 v[170:171], v[66:67], v[12:13] op_sel_hi:[1,0]
    v_cvt_pk_bf16_f32 v132, v164, v165
    v_cvt_pk_bf16_f32 v133, v166, v167
    v_cvt_pk_bf16_f32 v134, v168, v169
    v_cvt_pk_bf16_f32 v135, v170, v171
    buffer_store_dwordx4 v[132:135], v1, s[8:11], s25 offen offset:2048 sc1
    v_pk_mul_f32 v[148:149], v[68:69], v[10:11] op_sel_hi:[1,0]
    v_pk_mul_f32 v[150:151], v[70:71], v[10:11] op_sel_hi:[1,0]
    v_pk_mul_f32 v[152:153], v[76:77], v[10:11] op_sel_hi:[1,0]
    v_pk_mul_f32 v[154:155], v[78:79], v[10:11] op_sel_hi:[1,0]
    v_cvt_pk_bf16_f32 v120, v148, v149
    v_cvt_pk_bf16_f32 v121, v150, v151
    v_cvt_pk_bf16_f32 v122, v152, v153
    v_cvt_pk_bf16_f32 v123, v154, v155
    buffer_store_dwordx4 v[120:123], v1, s[8:11], s20 offen offset:3072 sc1
    v_pk_mul_f32 v[164:165], v[72:73], v[12:13] op_sel_hi:[1,0]
    v_pk_mul_f32 v[166:167], v[74:75], v[12:13] op_sel_hi:[1,0]
    v_pk_mul_f32 v[168:169], v[80:81], v[12:13] op_sel_hi:[1,0]
    v_pk_mul_f32 v[170:171], v[82:83], v[12:13] op_sel_hi:[1,0]
    v_cvt_pk_bf16_f32 v136, v164, v165
    v_cvt_pk_bf16_f32 v137, v166, v167
    v_cvt_pk_bf16_f32 v138, v168, v169
    v_cvt_pk_bf16_f32 v139, v170, v171
    buffer_store_dwordx4 v[136:139], v1, s[8:11], s25 offen offset:3072 sc1
    s_cmp_ge_u32 s3, 4
    s_cbranch_scc1 fz_p3B
    v_bfe_u32 v9, v0, 2, 2
    v_lshrrev_b32 v10, 4, v0
    v_and_b32 v11, 3, v0
    v_lshlrev_b32 v3, 10, v10
    v_lshl_add_u32 v3, v9, 6, v3
    v_lshl_add_u32 v3, v11, 3, v3
    v_bfe_u32 v12, v0, 4, 1
    v_lshlrev_b32 v12, 5, v12
    v_sub_u32 v2, v3, v12
    v_add_u32 v3, v3, v12
    s_lshl_b32 s19, s13, 3
    s_add_u32 s19, s19, s3
    s_mul_i32 s19, s19, 262144
    v_add_u32 v4, s19, v1
    s_and_b32 s62, s12, 24
    s_and_b32 s19, s12, 7
    s_lshl_b32 s20, s19, 2
    s_lshr_b32 s20, 0x54732160, s20
    s_and_b32 s20, s20, 7
    s_lshl_b32 s20, s20, 2
    s_bfm_b32 s21, s20, 0
    s_and_b32 s22, s21, 0x51764320
    s_lshl_b32 s22, s22, 4
    s_lshl_b32 s21, s21, 4
    s_or_b32 s21, s21, 15
    s_andn2_b32 s21, 0x51764320, s21
    s_or_b32 s42, s21, s22
    s_or_b32 s42, s42, s19
    s_bfe_u32 s96, s2, 0x10002
    s_mul_i32 s96, s96, 28
    s_lshr_b32 s26, s2, 3
    s_add_u32 s96, s96, s26
    s_and_b32 s97, s2, 1
    s_bfe_u32 s98, s2, 0x10001
    s_bfe_u32 s99, s2, 0x40003
    s_and_b32 s100, s2, 7
    s_lshl_b32 s100, s100, 1
    s_lshr_b32 s26, s2, 7
    s_add_u32 s100, s100, s26
    v_lshrrev_b32 v9, 4, v0
    v_lshlrev_b32 v13, 4, v9
    s_add_u32 s19, s12, 1
    s_and_b32 s19, s19, 7
    s_lshl_b32 s26, s19, 9
    s_add_u32 s26, s26, 0x22000
    v_add_u32 v13, s26, v13
    v_and_b32 v14, 15, v0
    v_lshlrev_b32 v14, 6, v14
    v_lshl_add_u32 v14, v9, 4, v14
    s_lshr_b32 s18, s12, 3
    s_lshl_b32 s18, s18, 22
    s_lshl_b32 s26, s13, 3
    s_add_u32 s26, s26, s3
    s_lshl_b32 s26, s26, 16
    s_add_u32 s18, s18, s26
    s_lshl_b32 s19, s19, 12
    s_add_u32 s18, s18, s19
    s_add_u32 s18, s18, 0x2000000
    s_add_u32 s19, s18, 0x8000
    v_add_u32 v15, 0x10000, v3
    v_add_u32 v16, 0x10000, v2
    s_lshl_b32 s26, s13, 3
    s_add_u32 s26, s26, s3
    s_lshl_b32 s26, s26, 2
    s_lshr_b32 s27, s12, 3
    s_add_u32 s26, s26, s27
    s_lshl_b32 s26, s26, 7
    s_add_u32 s20, s26, 0x540000
    s_and_b32 s27, s12, 7
    s_lshl_b32 s27, s27, 2
    s_add_u32 s26, s20, s27
    v_mov_b32 v9, s14
    v_mov_b32 v10, 0
    s_waitcnt vmcnt(0)
    s_mov_b64 exec, 1
    buffer_store_dword v9, v10, s[8:11], s26 offen sc1
    s_mov_b64 exec, -1
    s_waitcnt lgkmcnt(0)
    s_barrier
    ds_read_b64_tr_b16 v[84:85], v3 offset:0
    ds_read_b64_tr_b16 v[86:87], v3 offset:4096
    ds_read_b64_tr_b16 v[88:89], v2 offset:32
    ds_read_b64_tr_b16 v[90:91], v2 offset:4128
    ds_read_b64_tr_b16 v[92:93], v3 offset:256
    ds_read_b64_tr_b16 v[94:95], v3 offset:4352
    ds_read_b64_tr_b16 v[96:97], v2 offset:288
    ds_read_b64_tr_b16 v[98:99], v2 offset:4384
    s_waitcnt lgkmcnt(6)
    v_mfma_f32_16x16x32_bf16 v[20:23], v[84:87], v[108:111], 0
    ds_read_b64_tr_b16 v[100:101], v3 offset:512
    v_mfma_f32_16x16x32_bf16 v[24:27], v[84:87], v[124:127], 0
    s_bfe_u32 s22, s42, 0x30004
    s_or_b32 s22, s22, s62
    s_lshl_b32 s22, s22, 18
    s_add_u32 s22, s22, s16
    s_add_u32 s22, s22, 0x20000
    s_add_u32 m0, s17, 0xc000
    s_nop 0
    buffer_load_dwordx4 v17, s[4:7], s22 offen lds
    ds_read_b64_tr_b16 v[102:103], v3 offset:4608
    s_waitcnt lgkmcnt(6)
    v_mfma_f32_16x16x32_bf16 v[28:31], v[88:91], v[108:111], 0
    ds_read_b64_tr_b16 v[104:105], v2 offset:544
    v_mfma_f32_16x16x32_bf16 v[32:35], v[88:91], v[124:127], 0
    ds_read_b64_tr_b16 v[106:107], v2 offset:4640
    s_waitcnt lgkmcnt(6)
    v_mfma_f32_16x16x32_bf16 v[36:39], v[92:95], v[108:111], 0
    s_bfe_u32 s22, s42, 0x30004
    s_or_b32 s22, s22, s62
    s_lshl_b32 s22, s22, 18
    s_add_u32 s22, s22, s16
    s_add_u32 s22, s22, 0x22000
    s_add_u32 m0, s17, 0xc400
    s_nop 0
    buffer_load_dwordx4 v18, s[4:7], s22 offen lds
    ds_read_b64_tr_b16 v[84:85], v3 offset:768
    v_mfma_f32_16x16x32_bf16 v[40:43], v[92:95], v[124:127], 0
    ds_read_b64_tr_b16 v[86:87], v3 offset:4864
    s_waitcnt lgkmcnt(6)
    v_mfma_f32_16x16x32_bf16 v[44:47], v[96:99], v[108:111], 0
    ds_read_b64_tr_b16 v[88:89], v2 offset:800
    v_mfma_f32_16x16x32_bf16 v[48:51], v[96:99], v[124:127], 0
    s_bfe_u32 s22, s42, 0x30004
    s_or_b32 s22, s22, s62
    s_lshl_b32 s22, s22, 18
    s_add_u32 s22, s22, s16
    s_add_u32 s22, s22, 0x24000
    s_add_u32 m0, s17, 0xc800
    s_nop 0
    buffer_load_dwordx4 v17, s[4:7], s22 offen lds
    ds_read_b64_tr_b16 v[90:91], v2 offset:4896
    s_waitcnt lgkmcnt(6)
    v_mfma_f32_16x16x32_bf16 v[52:55], v[100:103], v[108:111], 0
    ds_read_b64_tr_b16 v[92:93], v3 offset:8192
    v_mfma_f32_16x16x32_bf16 v[56:59], v[100:103], v[124:127], 0
    ds_read_b64_tr_b16 v[94:95], v3 offset:12288
    s_waitcnt lgkmcnt(6)
    v_mfma_f32_16x16x32_bf16 v[60:63], v[104:107], v[108:111], 0
    s_bfe_u32 s22, s42, 0x30004
    s_or_b32 s22, s22, s62
    s_lshl_b32 s22, s22, 18
    s_add_u32 s22, s22, s16
    s_add_u32 s22, s22, 0x26000
    s_add_u32 m0, s17, 0xcc00
    s_nop 0
    buffer_load_dwordx4 v18, s[4:7], s22 offen lds
    ds_read_b64_tr_b16 v[96:97], v2 offset:8224
    v_mfma_f32_16x16x32_bf16 v[64:67], v[104:107], v[124:127], 0
    ds_read_b64_tr_b16 v[98:99], v2 offset:12320
    s_waitcnt lgkmcnt(6)
    v_mfma_f32_16x16x32_bf16 v[68:71], v[84:87], v[108:111], 0
    ds_read_b64_tr_b16 v[100:101], v3 offset:8448
    v_mfma_f32_16x16x32_bf16 v[72:75], v[84:87], v[124:127], 0
    s_bfe_u32 s22, s42, 0x30008
    s_or_b32 s22, s22, s62
    s_lshl_b32 s22, s22, 18
    s_add_u32 s22, s22, s16
    s_add_u32 s22, s22, 0x0
    s_add_u32 m0, s17, 0x10000
    s_nop 0
    buffer_load_dwordx4 v17, s[4:7], s22 offen lds
    ds_read_b64_tr_b16 v[102:103], v3 offset:12544
    s_waitcnt lgkmcnt(6)
    v_mfma_f32_16x16x32_bf16 v[76:79], v[88:91], v[108:111], 0
    ds_read_b64_tr_b16 v[104:105], v2 offset:8480
    v_mfma_f32_16x16x32_bf16 v[80:83], v[88:91], v[124:127], 0
    ds_read_b64_tr_b16 v[106:107], v2 offset:12576
    s_waitcnt lgkmcnt(6)
    v_mfma_f32_16x16x32_bf16 v[20:23], v[92:95], v[112:115], v[20:23]
    s_bfe_u32 s22, s42, 0x30008
    s_or_b32 s22, s22, s62
    s_lshl_b32 s22, s22, 18
    s_add_u32 s22, s22, s16
    s_add_u32 s22, s22, 0x2000
    s_add_u32 m0, s17, 0x10400
    s_nop 0
    buffer_load_dwordx4 v18, s[4:7], s22 offen lds
    ds_read_b64_tr_b16 v[84:85], v3 offset:8704
    v_mfma_f32_16x16x32_bf16 v[24:27], v[92:95], v[128:131], v[24:27]
    ds_read_b64_tr_b16 v[86:87], v3 offset:12800
    s_waitcnt lgkmcnt(6)
    v_mfma_f32_16x16x32_bf16 v[28:31], v[96:99], v[112:115], v[28:31]
    ds_read_b64_tr_b16 v[88:89], v2 offset:8736
    v_mfma_f32_16x16x32_bf16 v[32:35], v[96:99], v[128:131], v[32:35]
    s_bfe_u32 s22, s42, 0x30008
    s_or_b32 s22, s22, s62
    s_lshl_b32 s22, s22, 18
    s_add_u32 s22, s22, s16
    s_add_u32 s22, s22, 0x4000
    s_add_u32 m0, s17, 0x10800
    s_nop 0
    buffer_load_dwordx4 v17, s[4:7], s22 offen lds
    ds_read_b64_tr_b16 v[90:91], v2 offset:12832
    s_waitcnt lgkmcnt(6)
    v_mfma_f32_16x16x32_bf16 v[36:39], v[100:103], v[112:115], v[36:39]
    ds_read_b64_tr_b16 v[92:93], v3 offset:8960
    v_mfma_f32_16x16x32_bf16 v[40:43], v[100:103], v[128:131], v[40:43]
    ds_read_b64_tr_b16 v[94:95], v3 offset:13056
    s_waitcnt lgkmcnt(6)
    v_mfma_f32_16x16x32_bf16 v[44:47], v[104:107], v[112:115], v[44:47]
    s_bfe_u32 s22, s42, 0x30008
    s_or_b32 s22, s22, s62
    s_lshl_b32 s22, s22, 18
    s_add_u32 s22, s22, s16
    s_add_u32 s22, s22, 0x6000
    s_add_u32 m0, s17, 0x10c00
    s_nop 0
    buffer_load_dwordx4 v18, s[4:7], s22 offen lds
    ds_read_b64_tr_b16 v[96:97], v2 offset:8992
    v_mfma_f32_16x16x32_bf16 v[48:51], v[104:107], v[128:131], v[48:51]
    ds_read_b64_tr_b16 v[98:99], v2 offset:13088
    s_waitcnt lgkmcnt(6)
    v_mfma_f32_16x16x32_bf16 v[52:55], v[84:87], v[112:115], v[52:55]
    v_mfma_f32_16x16x32_bf16 v[56:59], v[84:87], v[128:131], v[56:59]
    s_bfe_u32 s22, s42, 0x30008
    s_or_b32 s22, s22, s62
    s_lshl_b32 s22, s22, 18
    s_add_u32 s22, s22, s16
    s_add_u32 s22, s22, 0x20000
    s_add_u32 m0, s17, 0x14000
    s_nop 0
    buffer_load_dwordx4 v17, s[4:7], s22 offen lds
    s_barrier
    ds_read_b64_tr_b16 v[100:101], v3 offset:16384
    ds_read_b64_tr_b16 v[102:103], v3 offset:20480
    s_waitcnt lgkmcnt(6)
    v_mfma_f32_16x16x32_bf16 v[60:63], v[88:91], v[112:115], v[60:63]
    ds_read_b64_tr_b16 v[104:105], v2 offset:16416
    v_mfma_f32_16x16x32_bf16 v[64:67], v[88:91], v[128:131], v[64:67]
    s_bfe_u32 s22, s42, 0x3000c
    s_or_b32 s22, s22, s62
    s_lshl_b32 s22, s22, 18
    s_add_u32 s22, s22, s16
    s_add_u32 s22, s22, 0x0
    s_add_u32 m0, s17, 0x18000
    s_nop 0
    buffer_load_dwordx4 v17, s[4:7], s22 offen lds
    ds_read_b64_tr_b16 v[106:107], v2 offset:20512
    s_waitcnt lgkmcnt(6)
    v_mfma_f32_16x16x32_bf16 v[68:71], v[92:95], v[112:115], v[68:71]
    s_bfe_u32 s22, s42, 0x30008
    s_or_b32 s22, s22, s62
    s_lshl_b32 s22, s22, 18
    s_add_u32 s22, s22, s16
    s_add_u32 s22, s22, 0x22000
    s_add_u32 m0, s17, 0x14400
    s_nop 0
    buffer_load_dwordx4 v18, s[4:7], s22 offen lds
    ds_read_b64_tr_b16 v[84:85], v3 offset:16640
    v_mfma_f32_16x16x32_bf16 v[72:75], v[92:95], v[128:131], v[72:75]
    ds_read_b64_tr_b16 v[86:87], v3 offset:20736
    s_waitcnt lgkmcnt(6)
    v_mfma_f32_16x16x32_bf16 v[76:79], v[96:99], v[112:115], v[76:79]
    ds_read_b64_tr_b16 v[88:89], v2 offset:16672
    v_mfma_f32_16x16x32_bf16 v[80:83], v[96:99], v[128:131], v[80:83]
    s_bfe_u32 s22, s42, 0x30008
    s_or_b32 s22, s22, s62
    s_lshl_b32 s22, s22, 18
    s_add_u32 s22, s22, s16
    s_add_u32 s22, s22, 0x24000
    s_add_u32 m0, s17, 0x14800
    s_nop 0
    buffer_load_dwordx4 v17, s[4:7], s22 offen lds
    ds_read_b64_tr_b16 v[90:91], v2 offset:20768
    s_waitcnt lgkmcnt(6)
    v_mfma_f32_16x16x32_bf16 v[20:23], v[100:103], v[116:119], v[20:23]
    ds_read_b64_tr_b16 v[92:93], v3 offset:16896
    v_mfma_f32_16x16x32_bf16 v[24:27], v[100:103], v[132:135], v[24:27]
    ds_read_b64_tr_b16 v[94:95], v3 offset:20992
    s_waitcnt lgkmcnt(6)
    v_mfma_f32_16x16x32_bf16 v[28:31], v[104:107], v[116:119], v[28:31]
    s_bfe_u32 s22, s42, 0x30008
    s_or_b32 s22, s22, s62
    s_lshl_b32 s22, s22, 18
    s_add_u32 s22, s22, s16
    s_add_u32 s22, s22, 0x26000
    s_add_u32 m0, s17, 0x14c00
    s_nop 0
    buffer_load_dwordx4 v18, s[4:7], s22 offen lds
    ds_read_b64_tr_b16 v[96:97], v2 offset:16928
    v_mfma_f32_16x16x32_bf16 v[32:35], v[104:107], v[132:135], v[32:35]
    s_bfe_u32 s22, s42, 0x3000c
    s_or_b32 s22, s22, s62
    s_lshl_b32 s22, s22, 18
    s_add_u32 s22, s22, s16
    s_add_u32 s22, s22, 0x2000
    s_add_u32 m0, s17, 0x18400
    s_nop 0
    buffer_load_dwordx4 v18, s[4:7], s22 offen lds
    ds_read_b64_tr_b16 v[98:99], v2 offset:21024
    s_waitcnt lgkmcnt(6)
    v_mfma_f32_16x16x32_bf16 v[36:39], v[84:87], v[116:119], v[36:39]
    ds_read_b64_tr_b16 v[100:101], v3 offset:17152
    v_mfma_f32_16x16x32_bf16 v[40:43], v[84:87], v[132:135], v[40:43]
    ds_read_b64_tr_b16 v[102:103], v3 offset:21248
    s_waitcnt lgkmcnt(6)
    v_mfma_f32_16x16x32_bf16 v[44:47], v[88:91], v[116:119], v[44:47]
    ds_read_b64_tr_b16 v[104:105], v2 offset:17184
    v_mfma_f32_16x16x32_bf16 v[48:51], v[88:91], v[132:135], v[48:51]
    ds_read_b64_tr_b16 v[106:107], v2 offset:21280
    s_waitcnt lgkmcnt(6)
    v_mfma_f32_16x16x32_bf16 v[52:55], v[92:95], v[116:119], v[52:55]
    ds_read_b64_tr_b16 v[84:85], v3 offset:24576
    v_mfma_f32_16x16x32_bf16 v[56:59], v[92:95], v[132:135], v[56:59]
    ds_read_b64_tr_b16 v[86:87], v3 offset:28672
    s_waitcnt lgkmcnt(6)
    v_mfma_f32_16x16x32_bf16 v[60:63], v[96:99], v[116:119], v[60:63]
    ds_read_b64_tr_b16 v[88:89], v2 offset:24608
    v_mfma_f32_16x16x32_bf16 v[64:67], v[96:99], v[132:135], v[64:67]
    s_bfe_u32 s22, s42, 0x3000c
    s_or_b32 s22, s22, s62
    s_lshl_b32 s22, s22, 18
    s_add_u32 s22, s22, s16
    s_add_u32 s22, s22, 0x4000
    s_add_u32 m0, s17, 0x18800
    s_nop 0
    buffer_load_dwordx4 v17, s[4:7], s22 offen lds
    ds_read_b64_tr_b16 v[90:91], v2 offset:28704
    s_waitcnt lgkmcnt(6)
    v_mfma_f32_16x16x32_bf16 v[68:71], v[100:103], v[116:119], v[68:71]
    ds_read_b64_tr_b16 v[92:93], v3 offset:24832
    v_mfma_f32_16x16x32_bf16 v[72:75], v[100:103], v[132:135], v[72:75]
    ds_read_b64_tr_b16 v[94:95], v3 offset:28928
    s_waitcnt lgkmcnt(6)
    v_mfma_f32_16x16x32_bf16 v[76:79], v[104:107], v[116:119], v[76:79]
    ds_read_b64_tr_b16 v[96:97], v2 offset:24864
    v_mfma_f32_16x16x32_bf16 v[80:83], v[104:107], v[132:135], v[80:83]
    ds_read_b64_tr_b16 v[98:99], v2 offset:28960
    s_waitcnt lgkmcnt(6)
    v_mfma_f32_16x16x32_bf16 v[20:23], v[84:87], v[120:123], v[20:23]
    ds_read_b64_tr_b16 v[100:101], v3 offset:25088
    v_mfma_f32_16x16x32_bf16 v[24:27], v[84:87], v[136:139], v[24:27]
    ds_read_b64_tr_b16 v[102:103], v3 offset:29184
    s_waitcnt lgkmcnt(6)
    v_mfma_f32_16x16x32_bf16 v[28:31], v[88:91], v[120:123], v[28:31]
    ds_read_b64_tr_b16 v[104:105], v2 offset:25120
    v_mfma_f32_16x16x32_bf16 v[32:35], v[88:91], v[136:139], v[32:35]
    s_bfe_u32 s22, s42, 0x3000c
    s_or_b32 s22, s22, s62
    s_lshl_b32 s22, s22, 18
    s_add_u32 s22, s22, s16
    s_add_u32 s22, s22, 0x6000
    s_add_u32 m0, s17, 0x18c00
    s_nop 0
    buffer_load_dwordx4 v18, s[4:7], s22 offen lds
    ds_read_b64_tr_b16 v[106:107], v2 offset:29216
    s_waitcnt lgkmcnt(6)
    v_mfma_f32_16x16x32_bf16 v[36:39], v[92:95], v[120:123], v[36:39]
    ds_read_b64_tr_b16 v[84:85], v3 offset:25344
    v_mfma_f32_16x16x32_bf16 v[40:43], v[92:95], v[136:139], v[40:43]
    ds_read_b64_tr_b16 v[86:87], v3 offset:29440
    s_waitcnt lgkmcnt(6)
    v_mfma_f32_16x16x32_bf16 v[44:47], v[96:99], v[120:123], v[44:47]
    ds_read_b64_tr_b16 v[88:89], v2 offset:25376
    v_mfma_f32_16x16x32_bf16 v[48:51], v[96:99], v[136:139], v[48:51]
    ds_read_b64_tr_b16 v[90:91], v2 offset:29472
    s_waitcnt lgkmcnt(6)
    v_mfma_f32_16x16x32_bf16 v[52:55], v[100:103], v[120:123], v[52:55]
    v_mfma_f32_16x16x32_bf16 v[56:59], v[100:103], v[136:139], v[56:59]
    s_barrier
    ds_read_b64_tr_b16 v[92:93], v3 offset:32768
    ds_read_b64_tr_b16 v[94:95], v3 offset:36864
    s_waitcnt lgkmcnt(6)
    v_mfma_f32_16x16x32_bf16 v[60:63], v[104:107], v[120:123], v[60:63]
    ds_read_b64_tr_b16 v[96:97], v2 offset:32800
    v_mfma_f32_16x16x32_bf16 v[64:67], v[104:107], v[136:139], v[64:67]
    s_bfe_u32 s22, s42, 0x3000c
    s_or_b32 s22, s22, s62
    s_lshl_b32 s22, s22, 18
    s_add_u32 s22, s22, s16
    s_add_u32 s22, s22, 0x20000
    s_add_u32 m0, s17, 0x1c000
    s_nop 0
    buffer_load_dwordx4 v17, s[4:7], s22 offen lds
    ds_read_b64_tr_b16 v[98:99], v2 offset:36896
    s_waitcnt lgkmcnt(6)
    v_mfma_f32_16x16x32_bf16 v[68:71], v[84:87], v[120:123], v[68:71]
    ds_read_b64_tr_b16 v[100:101], v3 offset:33024
    v_mfma_f32_16x16x32_bf16 v[72:75], v[84:87], v[136:139], v[72:75]
    ds_read_b64_tr_b16 v[102:103], v3 offset:37120
    s_waitcnt lgkmcnt(6)
    v_mfma_f32_16x16x32_bf16 v[76:79], v[88:91], v[120:123], v[76:79]
    ds_read_b64_tr_b16 v[104:105], v2 offset:33056
    v_mfma_f32_16x16x32_bf16 v[80:83], v[88:91], v[136:139], v[80:83]
    ds_read_b64_tr_b16 v[106:107], v2 offset:37152
    v_and_b32 v9, 7, v0
    v_lshlrev_b32 v9, 2, v9
    s_mov_b32 s27, 0
fz_oAp:
    buffer_load_dword v10, v9, s[8:11], s20 offen sc1
    s_waitcnt vmcnt(0)
    v_cmp_ne_u32 vcc, s14, v10
    s_and_b32 vcc_lo, vcc_lo, 0xdd
    s_mov_b32 vcc_hi, 0
    s_add_u32 s27, s27, 1
    s_cmp_ge_u32 s27, 65536
    s_cbranch_scc1 fz_oAg
    s_cbranch_vccz fz_oAg
    s_sleep 1
    s_branch fz_oAp
fz_oAg:
    s_bfe_u32 s21, s42, 0x30004
    s_or_b32 s21, s21, s62
    s_lshl_b32 s21, s21, 12
    s_add_u32 s23, s21, 0x1000000
    buffer_load_dwordx4 v[140:143], v4, s[8:11], s23 offen offset:0 sc1
    s_add_u32 s23, s21, 0x1020000
    buffer_load_dwordx4 v[144:147], v4, s[8:11], s23 offen offset:0 sc1
    s_add_u32 s23, s21, 0x1000000
    buffer_load_dwordx4 v[148:151], v4, s[8:11], s23 offen offset:1024 sc1
    s_add_u32 s23, s21, 0x1020000
    buffer_load_dwordx4 v[152:155], v4, s[8:11], s23 offen offset:1024 sc1
    s_add_u32 s23, s21, 0x1000800
    buffer_load_dwordx4 v[156:159], v4, s[8:11], s23 offen offset:0 sc1
    s_add_u32 s23, s21, 0x1020800
    buffer_load_dwordx4 v[160:163], v4, s[8:11], s23 offen offset:0 sc1
    s_add_u32 s23, s21, 0x1000800
    buffer_load_dwordx4 v[164:167], v4, s[8:11], s23 offen offset:1024 sc1
    s_add_u32 s23, s21, 0x1020800
    buffer_load_dwordx4 v[168:171], v4, s[8:11], s23 offen offset:1024 sc1
    s_bfe_u32 s21, s42, 0x30008
    s_or_b32 s21, s21, s62
    s_lshl_b32 s21, s21, 12
    s_add_u32 s23, s21, 0x1000000
    buffer_load_dwordx4 v[188:191], v4, s[8:11], s23 offen offset:0 sc1
    s_add_u32 s23, s21, 0x1020000
    buffer_load_dwordx4 v[192:195], v4, s[8:11], s23 offen offset:0 sc1
    s_add_u32 s23, s21, 0x1000000
    buffer_load_dwordx4 v[196:199], v4, s[8:11], s23 offen offset:1024 sc1
    s_add_u32 s23, s21, 0x1020000
    buffer_load_dwordx4 v[200:203], v4, s[8:11], s23 offen offset:1024 sc1
    s_waitcnt vmcnt(11) lgkmcnt(6)
    v_mfma_f32_16x16x32_bf16 v[20:23], v[92:95], v[140:143], v[20:23]
    ds_read_b64_tr_b16 v[84:85], v3 offset:33280
    s_waitcnt vmcnt(10)
    v_mfma_f32_16x16x32_bf16 v[24:27], v[92:95], v[144:147], v[24:27]
    ds_read_b64_tr_b16 v[86:87], v3 offset:37376
    s_waitcnt lgkmcnt(6)
    v_mfma_f32_16x16x32_bf16 v[28:31], v[96:99], v[140:143], v[28:31]
    ds_read_b64_tr_b16 v[88:89], v2 offset:33312
    v_mfma_f32_16x16x32_bf16 v[32:35], v[96:99], v[144:147], v[32:35]
    s_bfe_u32 s22, s42, 0x3000c
    s_or_b32 s22, s22, s62
    s_lshl_b32 s22, s22, 18
    s_add_u32 s22, s22, s16
    s_add_u32 s22, s22, 0x22000
    s_add_u32 m0, s17, 0x1c400
    s_nop 0
    buffer_load_dwordx4 v18, s[4:7], s22 offen lds
    ds_read_b64_tr_b16 v[90:91], v2 offset:37408
    s_waitcnt lgkmcnt(6)
    v_mfma_f32_16x16x32_bf16 v[36:39], v[100:103], v[140:143], v[36:39]
    ds_read_b64_tr_b16 v[92:93], v3 offset:33536
    v_mfma_f32_16x16x32_bf16 v[40:43], v[100:103], v[144:147], v[40:43]
    ds_read_b64_tr_b16 v[94:95], v3 offset:37632
    s_waitcnt lgkmcnt(6)
    v_mfma_f32_16x16x32_bf16 v[44:47], v[104:107], v[140:143], v[44:47]
    ds_read_b64_tr_b16 v[96:97], v2 offset:33568
    v_mfma_f32_16x16x32_bf16 v[48:51], v[104:107], v[144:147], v[48:51]
    ds_read_b64_tr_b16 v[98:99], v2 offset:37664
    s_add_u32 s23, s21, 0x1000800
    buffer_load_dwordx4 v[108:111], v4, s[8:11], s23 offen offset:0 sc1
    s_waitcnt lgkmcnt(6)
    v_mfma_f32_16x16x32_bf16 v[52:55], v[84:87], v[140:143], v[52:55]
    ds_read_b64_tr_b16 v[100:101], v3 offset:40960
    v_mfma_f32_16x16x32_bf16 v[56:59], v[84:87], v[144:147], v[56:59]
    ds_read_b64_tr_b16 v[102:103], v3 offset:45056
    s_waitcnt lgkmcnt(6)
    v_mfma_f32_16x16x32_bf16 v[60:63], v[88:91], v[140:143], v[60:63]
    ds_read_b64_tr_b16 v[104:105], v2 offset:40992
    v_mfma_f32_16x16x32_bf16 v[64:67], v[88:91], v[144:147], v[64:67]
    s_bfe_u32 s22, s42, 0x3000c
    s_or_b32 s22, s22, s62
    s_lshl_b32 s22, s22, 18
    s_add_u32 s22, s22, s16
    s_add_u32 s22, s22, 0x24000
    s_add_u32 m0, s17, 0x1c800
    s_nop 0
    buffer_load_dwordx4 v17, s[4:7], s22 offen lds
    ds_read_b64_tr_b16 v[106:107], v2 offset:45088
    s_waitcnt lgkmcnt(6)
    v_mfma_f32_16x16x32_bf16 v[68:71], v[92:95], v[140:143], v[68:71]
    ds_read_b64_tr_b16 v[84:85], v3 offset:41216
    v_mfma_f32_16x16x32_bf16 v[72:75], v[92:95], v[144:147], v[72:75]
    ds_read_b64_tr_b16 v[86:87], v3 offset:45312
    s_waitcnt lgkmcnt(6)
    v_mfma_f32_16x16x32_bf16 v[76:79], v[96:99], v[140:143], v[76:79]
    ds_read_b64_tr_b16 v[88:89], v2 offset:41248
    v_mfma_f32_16x16x32_bf16 v[80:83], v[96:99], v[144:147], v[80:83]
    ds_read_b64_tr_b16 v[90:91], v2 offset:45344
    s_add_u32 s23, s21, 0x1020800
    buffer_load_dwordx4 v[112:115], v4, s[8:11], s23 offen offset:0 sc1
    s_waitcnt vmcnt(13) lgkmcnt(6)
    v_mfma_f32_16x16x32_bf16 v[20:23], v[100:103], v[148:151], v[20:23]
    ds_read_b64_tr_b16 v[92:93], v3 offset:41472
    s_waitcnt vmcnt(12)
    v_mfma_f32_16x16x32_bf16 v[24:27], v[100:103], v[152:155], v[24:27]
    ds_read_b64_tr_b16 v[94:95], v3 offset:45568
    s_waitcnt lgkmcnt(6)
    v_mfma_f32_16x16x32_bf16 v[28:31], v[104:107], v[148:151], v[28:31]
    ds_read_b64_tr_b16 v[96:97], v2 offset:41504
    v_mfma_f32_16x16x32_bf16 v[32:35], v[104:107], v[152:155], v[32:35]
    s_bfe_u32 s22, s42, 0x3000c
    s_or_b32 s22, s22, s62
    s_lshl_b32 s22, s22, 18
    s_add_u32 s22, s22, s16
    s_add_u32 s22, s22, 0x26000
    s_add_u32 m0, s17, 0x1cc00
    s_nop 0
    buffer_load_dwordx4 v18, s[4:7], s22 offen lds
    ds_read_b64_tr_b16 v[98:99], v2 offset:45600
    s_waitcnt lgkmcnt(6)
    v_mfma_f32_16x16x32_bf16 v[36:39], v[84:87], v[148:151], v[36:39]
    ds_read_b64_tr_b16 v[100:101], v3 offset:41728
    v_mfma_f32_16x16x32_bf16 v[40:43], v[84:87], v[152:155], v[40:43]
    ds_read_b64_tr_b16 v[102:103], v3 offset:45824
    s_waitcnt lgkmcnt(6)
    v_mfma_f32_16x16x32_bf16 v[44:47], v[88:91], v[148:151], v[44:47]
    ds_read_b64_tr_b16 v[104:105], v2 offset:41760
    v_mfma_f32_16x16x32_bf16 v[48:51], v[88:91], v[152:155], v[48:51]
    ds_read_b64_tr_b16 v[106:107], v2 offset:45856
    s_add_u32 s23, s21, 0x1000800
    buffer_load_dwordx4 v[116:119], v4, s[8:11], s23 offen offset:1024 sc1
    s_waitcnt lgkmcnt(6)
    v_mfma_f32_16x16x32_bf16 v[52:55], v[92:95], v[148:151], v[52:55]
    v_mfma_f32_16x16x32_bf16 v[56:59], v[92:95], v[152:155], v[56:59]
    s_barrier
    ds_read_b64_tr_b16 v[84:85], v3 offset:49152
    ds_read_b64_tr_b16 v[86:87], v3 offset:53248
    s_waitcnt lgkmcnt(6)
    v_mfma_f32_16x16x32_bf16 v[60:63], v[96:99], v[148:151], v[60:63]
    ds_read_b64_tr_b16 v[88:89], v2 offset:49184
    v_mfma_f32_16x16x32_bf16 v[64:67], v[96:99], v[152:155], v[64:67]
    s_bfe_u32 s22, s42, 0x30010
    s_or_b32 s22, s22, s62
    s_lshl_b32 s22, s22, 18
    s_add_u32 s22, s22, s16
    s_add_u32 s22, s22, 0x0
    s_add_u32 m0, s17, 0x0
    s_nop 0
    buffer_load_dwordx4 v17, s[4:7], s22 offen lds
    ds_read_b64_tr_b16 v[90:91], v2 offset:53280
    s_waitcnt lgkmcnt(6)
    v_mfma_f32_16x16x32_bf16 v[68:71], v[100:103], v[148:151], v[68:71]
    ds_read_b64_tr_b16 v[92:93], v3 offset:49408
    v_mfma_f32_16x16x32_bf16 v[72:75], v[100:103], v[152:155], v[72:75]
    ds_read_b64_tr_b16 v[94:95], v3 offset:53504
    s_waitcnt lgkmcnt(6)
    v_mfma_f32_16x16x32_bf16 v[76:79], v[104:107], v[148:151], v[76:79]
    ds_read_b64_tr_b16 v[96:97], v2 offset:49440
    v_mfma_f32_16x16x32_bf16 v[80:83], v[104:107], v[152:155], v[80:83]
    ds_read_b64_tr_b16 v[98:99], v2 offset:53536
    s_add_u32 s23, s21, 0x1020800
    buffer_load_dwordx4 v[120:123], v4, s[8:11], s23 offen offset:1024 sc1
    s_waitcnt vmcnt(15) lgkmcnt(6)
    v_mfma_f32_16x16x32_bf16 v[20:23], v[84:87], v[156:159], v[20:23]
    ds_read_b64_tr_b16 v[100:101], v3 offset:49664
    s_waitcnt vmcnt(14)
    v_mfma_f32_16x16x32_bf16 v[24:27], v[84:87], v[160:163], v[24:27]
    ds_read_b64_tr_b16 v[102:103], v3 offset:53760
    s_waitcnt lgkmcnt(6)
    v_mfma_f32_16x16x32_bf16 v[28:31], v[88:91], v[156:159], v[28:31]
    ds_read_b64_tr_b16 v[104:105], v2 offset:49696
    v_mfma_f32_16x16x32_bf16 v[32:35], v[88:91], v[160:163], v[32:35]
    s_bfe_u32 s22, s42, 0x30010
    s_or_b32 s22, s22, s62
    s_lshl_b32 s22, s22, 18
    s_add_u32 s22, s22, s16
    s_add_u32 s22, s22, 0x2000
    s_add_u32 m0, s17, 0x400
    s_nop 0
    buffer_load_dwordx4 v18, s[4:7], s22 offen lds
    ds_read_b64_tr_b16 v[106:107], v2 offset:53792
    s_waitcnt lgkmcnt(6)
    v_mfma_f32_16x16x32_bf16 v[36:39], v[92:95], v[156:159], v[36:39]
    ds_read_b64_tr_b16 v[84:85], v3 offset:49920
    v_mfma_f32_16x16x32_bf16 v[40:43], v[92:95], v[160:163], v[40:43]
    ds_read_b64_tr_b16 v[86:87], v3 offset:54016
    s_waitcnt lgkmcnt(6)
    v_mfma_f32_16x16x32_bf16 v[44:47], v[96:99], v[156:159], v[44:47]
    ds_read_b64_tr_b16 v[88:89], v2 offset:49952
    v_mfma_f32_16x16x32_bf16 v[48:51], v[96:99], v[160:163], v[48:51]
    ds_read_b64_tr_b16 v[90:91], v2 offset:54048
    s_bfe_u32 s21, s42, 0x3000c
    s_or_b32 s21, s21, s62
    s_lshl_b32 s21, s21, 12
    s_add_u32 s23, s21, 0x1000000
    buffer_load_dwordx4 v[140:143], v4, s[8:11], s23 offen offset:0 sc1
    s_waitcnt lgkmcnt(6)
    v_mfma_f32_16x16x32_bf16 v[52:55], v[100:103], v[156:159], v[52:55]
    ds_read_b64_tr_b16 v[92:93], v3 offset:57344
    v_mfma_f32_16x16x32_bf16 v[56:59], v[100:103], v[160:163], v[56:59]
    ds_read_b64_tr_b16 v[94:95], v3 offset:61440
    s_waitcnt lgkmcnt(6)
    v_mfma_f32_16x16x32_bf16 v[60:63], v[104:107], v[156:159], v[60:63]
    ds_read_b64_tr_b16 v[96:97], v2 offset:57376
    v_mfma_f32_16x16x32_bf16 v[64:67], v[104:107], v[160:163], v[64:67]
    s_bfe_u32 s22, s42, 0x30010
    s_or_b32 s22, s22, s62
    s_lshl_b32 s22, s22, 18
    s_add_u32 s22, s22, s16
    s_add_u32 s22, s22, 0x4000
    s_add_u32 m0, s17, 0x800
    s_nop 0
    buffer_load_dwordx4 v17, s[4:7], s22 offen lds
    ds_read_b64_tr_b16 v[98:99], v2 offset:61472
    s_waitcnt lgkmcnt(6)
    v_mfma_f32_16x16x32_bf16 v[68:71], v[84:87], v[156:159], v[68:71]
    ds_read_b64_tr_b16 v[100:101], v3 offset:57600
    v_mfma_f32_16x16x32_bf16 v[72:75], v[84:87], v[160:163], v[72:75]
    ds_read_b64_tr_b16 v[102:103], v3 offset:61696
    s_waitcnt lgkmcnt(6)
    v_mfma_f32_16x16x32_bf16 v[76:79], v[88:91], v[156:159], v[76:79]
    ds_read_b64_tr_b16 v[104:105], v2 offset:57632
    v_mfma_f32_16x16x32_bf16 v[80:83], v[88:91], v[160:163], v[80:83]
    ds_read_b64_tr_b16 v[106:107], v2 offset:61728
    s_add_u32 s23, s21, 0x1020000
    buffer_load_dwordx4 v[144:147], v4, s[8:11], s23 offen offset:0 sc1
    s_waitcnt vmcnt(17) lgkmcnt(6)
    v_mfma_f32_16x16x32_bf16 v[20:23], v[92:95], v[164:167], v[20:23]
    ds_read_b64_tr_b16 v[84:85], v3 offset:57856
    s_waitcnt vmcnt(16)
    v_mfma_f32_16x16x32_bf16 v[24:27], v[92:95], v[168:171], v[24:27]
    ds_read_b64_tr_b16 v[86:87], v3 offset:61952
    s_waitcnt lgkmcnt(6)
    v_mfma_f32_16x16x32_bf16 v[28:31], v[96:99], v[164:167], v[28:31]
    ds_read_b64_tr_b16 v[88:89], v2 offset:57888
    v_mfma_f32_16x16x32_bf16 v[32:35], v[96:99], v[168:171], v[32:35]
    s_bfe_u32 s22, s42, 0x30010
    s_or_b32 s22, s22, s62
    s_lshl_b32 s22, s22, 18
    s_add_u32 s22, s22, s16
    s_add_u32 s22, s22, 0x6000
    s_add_u32 m0, s17, 0xc00
    s_nop 0
    buffer_load_dwordx4 v18, s[4:7], s22 offen lds
    ds_read_b64_tr_b16 v[90:91], v2 offset:61984
    s_waitcnt lgkmcnt(6)
    v_mfma_f32_16x16x32_bf16 v[36:39], v[100:103], v[164:167], v[36:39]
    ds_read_b64_tr_b16 v[92:93], v3 offset:58112
    v_mfma_f32_16x16x32_bf16 v[40:43], v[100:103], v[168:171], v[40:43]
    ds_read_b64_tr_b16 v[94:95], v3 offset:62208
    s_waitcnt lgkmcnt(6)
    v_mfma_f32_16x16x32_bf16 v[44:47], v[104:107], v[164:167], v[44:47]
    ds_read_b64_tr_b16 v[96:97], v2 offset:58144
    v_mfma_f32_16x16x32_bf16 v[48:51], v[104:107], v[168:171], v[48:51]
    ds_read_b64_tr_b16 v[98:99], v2 offset:62240
    s_add_u32 s23, s21, 0x1000000
    buffer_load_dwordx4 v[148:151], v4, s[8:11], s23 offen offset:1024 sc1
    s_waitcnt lgkmcnt(6)
    v_mfma_f32_16x16x32_bf16 v[52:55], v[84:87], v[164:167], v[52:55]
    v_mfma_f32_16x16x32_bf16 v[56:59], v[84:87], v[168:171], v[56:59]
    s_barrier
    ds_read_b64_tr_b16 v[100:101], v15 offset:0
    ds_read_b64_tr_b16 v[102:103], v15 offset:4096
    s_waitcnt lgkmcnt(6)
    v_mfma_f32_16x16x32_bf16 v[60:63], v[88:91], v[164:167], v[60:63]
    ds_read_b64_tr_b16 v[104:105], v16 offset:32
    v_mfma_f32_16x16x32_bf16 v[64:67], v[88:91], v[168:171], v[64:67]
    s_bfe_u32 s22, s42, 0x30010
    s_or_b32 s22, s22, s62
    s_lshl_b32 s22, s22, 18
    s_add_u32 s22, s22, s16
    s_add_u32 s22, s22, 0x20000
    s_add_u32 m0, s17, 0x4000
    s_nop 0
    buffer_load_dwordx4 v17, s[4:7], s22 offen lds
    ds_read_b64_tr_b16 v[106:107], v16 offset:4128
    s_waitcnt lgkmcnt(6)
    v_mfma_f32_16x16x32_bf16 v[68:71], v[92:95], v[164:167], v[68:71]
    ds_read_b64_tr_b16 v[84:85], v15 offset:256
    v_mfma_f32_16x16x32_bf16 v[72:75], v[92:95], v[168:171], v[72:75]
    ds_read_b64_tr_b16 v[86:87], v15 offset:4352
    s_waitcnt lgkmcnt(6)
    v_mfma_f32_16x16x32_bf16 v[76:79], v[96:99], v[164:167], v[76:79]
    ds_read_b64_tr_b16 v[88:89], v16 offset:288
    v_mfma_f32_16x16x32_bf16 v[80:83], v[96:99], v[168:171], v[80:83]
    ds_read_b64_tr_b16 v[90:91], v16 offset:4384
    s_add_u32 s23, s21, 0x1020000
    buffer_load_dwordx4 v[152:155], v4, s[8:11], s23 offen offset:1024 sc1
    s_waitcnt vmcnt(19) lgkmcnt(6)
    v_mfma_f32_16x16x32_bf16 v[20:23], v[100:103], v[188:191], v[20:23]
    ds_read_b64_tr_b16 v[92:93], v15 offset:512
    s_waitcnt vmcnt(18)
    v_mfma_f32_16x16x32_bf16 v[24:27], v[100:103], v[192:195], v[24:27]
    ds_read_b64_tr_b16 v[94:95], v15 offset:4608
    s_waitcnt lgkmcnt(6)
    v_mfma_f32_16x16x32_bf16 v[28:31], v[104:107], v[188:191], v[28:31]
    ds_read_b64_tr_b16 v[96:97], v16 offset:544
    v_mfma_f32_16x16x32_bf16 v[32:35], v[104:107], v[192:195], v[32:35]
    s_bfe_u32 s22, s42, 0x30010
    s_or_b32 s22, s22, s62
    s_lshl_b32 s22, s22, 18
    s_add_u32 s22, s22, s16
    s_add_u32 s22, s22, 0x22000
    s_add_u32 m0, s17, 0x4400
    s_nop 0
    buffer_load_dwordx4 v18, s[4:7], s22 offen lds
    ds_read_b64_tr_b16 v[98:99], v16 offset:4640
    s_waitcnt lgkmcnt(6)
    v_mfma_f32_16x16x32_bf16 v[36:39], v[84:87], v[188:191], v[36:39]
    ds_read_b64_tr_b16 v[100:101], v15 offset:768
    v_mfma_f32_16x16x32_bf16 v[40:43], v[84:87], v[192:195], v[40:43]
    ds_read_b64_tr_b16 v[102:103], v15 offset:4864
    s_waitcnt lgkmcnt(6)
    v_mfma_f32_16x16x32_bf16 v[44:47], v[88:91], v[188:191], v[44:47]
    ds_read_b64_tr_b16 v[104:105], v16 offset:800
    v_mfma_f32_16x16x32_bf16 v[48:51], v[88:91], v[192:195], v[48:51]
    ds_read_b64_tr_b16 v[106:107], v16 offset:4896
    s_add_u32 s23, s21, 0x1000800
    buffer_load_dwordx4 v[156:159], v4, s[8:11], s23 offen offset:0 sc1
    s_waitcnt lgkmcnt(6)
    v_mfma_f32_16x16x32_bf16 v[52:55], v[92:95], v[188:191], v[52:55]
    ds_read_b64_tr_b16 v[84:85], v15 offset:8192
    v_mfma_f32_16x16x32_bf16 v[56:59], v[92:95], v[192:195], v[56:59]
    ds_read_b64_tr_b16 v[86:87], v15 offset:12288
    s_waitcnt lgkmcnt(6)
    v_mfma_f32_16x16x32_bf16 v[60:63], v[96:99], v[188:191], v[60:63]
    ds_read_b64_tr_b16 v[88:89], v16 offset:8224
    v_mfma_f32_16x16x32_bf16 v[64:67], v[96:99], v[192:195], v[64:67]
    s_bfe_u32 s22, s42, 0x30010
    s_or_b32 s22, s22, s62
    s_lshl_b32 s22, s22, 18
    s_add_u32 s22, s22, s16
    s_add_u32 s22, s22, 0x24000
    s_add_u32 m0, s17, 0x4800
    s_nop 0
    buffer_load_dwordx4 v17, s[4:7], s22 offen lds
    ds_read_b64_tr_b16 v[90:91], v16 offset:12320
    s_waitcnt lgkmcnt(6)
    v_mfma_f32_16x16x32_bf16 v[68:71], v[100:103], v[188:191], v[68:71]
    ds_read_b64_tr_b16 v[92:93], v15 offset:8448
    v_mfma_f32_16x16x32_bf16 v[72:75], v[100:103], v[192:195], v[72:75]
    ds_read_b64_tr_b16 v[94:95], v15 offset:12544
    s_waitcnt lgkmcnt(6)
    v_mfma_f32_16x16x32_bf16 v[76:79], v[104:107], v[188:191], v[76:79]
    ds_read_b64_tr_b16 v[96:97], v16 offset:8480
    v_mfma_f32_16x16x32_bf16 v[80:83], v[104:107], v[192:195], v[80:83]
    ds_read_b64_tr_b16 v[98:99], v16 offset:12576
    s_add_u32 s23, s21, 0x1020800
    buffer_load_dwordx4 v[160:163], v4, s[8:11], s23 offen offset:0 sc1
    s_waitcnt vmcnt(21) lgkmcnt(6)
    v_mfma_f32_16x16x32_bf16 v[20:23], v[84:87], v[196:199], v[20:23]
    ds_read_b64_tr_b16 v[100:101], v15 offset:8704
    s_waitcnt vmcnt(20)
    v_mfma_f32_16x16x32_bf16 v[24:27], v[84:87], v[200:203], v[24:27]
    ds_read_b64_tr_b16 v[102:103], v15 offset:12800
    s_waitcnt lgkmcnt(6)
    v_mfma_f32_16x16x32_bf16 v[28:31], v[88:91], v[196:199], v[28:31]
    ds_read_b64_tr_b16 v[104:105], v16 offset:8736
    v_mfma_f32_16x16x32_bf16 v[32:35], v[88:91], v[200:203], v[32:35]
    s_bfe_u32 s22, s42, 0x30010
    s_or_b32 s22, s22, s62
    s_lshl_b32 s22, s22, 18
    s_add_u32 s22, s22, s16
    s_add_u32 s22, s22, 0x26000
    s_add_u32 m0, s17, 0x4c00
    s_nop 0
    buffer_load_dwordx4 v18, s[4:7], s22 offen lds
    ds_read_b64_tr_b16 v[106:107], v16 offset:12832
    s_waitcnt lgkmcnt(6)
    v_mfma_f32_16x16x32_bf16 v[36:39], v[92:95], v[196:199], v[36:39]
    ds_read_b64_tr_b16 v[84:85], v15 offset:8960
    v_mfma_f32_16x16x32_bf16 v[40:43], v[92:95], v[200:203], v[40:43]
    ds_read_b64_tr_b16 v[86:87], v15 offset:13056
    s_waitcnt lgkmcnt(6)
    v_mfma_f32_16x16x32_bf16 v[44:47], v[96:99], v[196:199], v[44:47]
    ds_read_b64_tr_b16 v[88:89], v16 offset:8992
    v_mfma_f32_16x16x32_bf16 v[48:51], v[96:99], v[200:203], v[48:51]
    ds_read_b64_tr_b16 v[90:91], v16 offset:13088
    s_add_u32 s23, s21, 0x1000800
    buffer_load_dwordx4 v[164:167], v4, s[8:11], s23 offen offset:1024 sc1
    s_waitcnt lgkmcnt(6)
    v_mfma_f32_16x16x32_bf16 v[52:55], v[100:103], v[196:199], v[52:55]
    v_mfma_f32_16x16x32_bf16 v[56:59], v[100:103], v[200:203], v[56:59]
    s_barrier
    ds_read_b64_tr_b16 v[92:93], v15 offset:16384
    ds_read_b64_tr_b16 v[94:95], v15 offset:20480
    s_waitcnt lgkmcnt(6)
    v_mfma_f32_16x16x32_bf16 v[60:63], v[104:107], v[196:199], v[60:63]
    ds_read_b64_tr_b16 v[96:97], v16 offset:16416
    v_mfma_f32_16x16x32_bf16 v[64:67], v[104:107], v[200:203], v[64:67]
    s_bfe_u32 s22, s42, 0x30014
    s_or_b32 s22, s22, s62
    s_lshl_b32 s22, s22, 18
    s_add_u32 s22, s22, s16
    s_add_u32 s22, s22, 0x0
    s_add_u32 m0, s17, 0x8000
    s_nop 0
    buffer_load_dwordx4 v17, s[4:7], s22 offen lds
    ds_read_b64_tr_b16 v[98:99], v16 offset:20512
    s_waitcnt lgkmcnt(6)
    v_mfma_f32_16x16x32_bf16 v[68:71], v[84:87], v[196:199], v[68:71]
    ds_read_b64_tr_b16 v[100:101], v15 offset:16640
    v_mfma_f32_16x16x32_bf16 v[72:75], v[84:87], v[200:203], v[72:75]
    ds_read_b64_tr_b16 v[102:103], v15 offset:20736
    s_waitcnt lgkmcnt(6)
    v_mfma_f32_16x16x32_bf16 v[76:79], v[88:91], v[196:199], v[76:79]
    ds_read_b64_tr_b16 v[104:105], v16 offset:16672
    v_mfma_f32_16x16x32_bf16 v[80:83], v[88:91], v[200:203], v[80:83]
    ds_read_b64_tr_b16 v[106:107], v16 offset:20768
    s_add_u32 s23, s21, 0x1020800
    buffer_load_dwordx4 v[168:171], v4, s[8:11], s23 offen offset:1024 sc1
    s_waitcnt vmcnt(22) lgkmcnt(6)
    v_mfma_f32_16x16x32_bf16 v[20:23], v[92:95], v[108:111], v[20:23]
    ds_read_b64_tr_b16 v[84:85], v15 offset:16896
    s_waitcnt vmcnt(20)
    v_mfma_f32_16x16x32_bf16 v[24:27], v[92:95], v[112:115], v[24:27]
    ds_read_b64_tr_b16 v[86:87], v15 offset:20992
    s_waitcnt lgkmcnt(6)
    v_mfma_f32_16x16x32_bf16 v[28:31], v[96:99], v[108:111], v[28:31]
    ds_read_b64_tr_b16 v[88:89], v16 offset:16928
    v_mfma_f32_16x16x32_bf16 v[32:35], v[96:99], v[112:115], v[32:35]
    s_bfe_u32 s22, s42, 0x30014
    s_or_b32 s22, s22, s62
    s_lshl_b32 s22, s22, 18
    s_add_u32 s22, s22, s16
    s_add_u32 s22, s22, 0x2000
    s_add_u32 m0, s17, 0x8400
    s_nop 0
    buffer_load_dwordx4 v18, s[4:7], s22 offen lds
    ds_read_b64_tr_b16 v[90:91], v16 offset:21024
    s_waitcnt lgkmcnt(6)
    v_mfma_f32_16x16x32_bf16 v[36:39], v[100:103], v[108:111], v[36:39]
    ds_read_b64_tr_b16 v[92:93], v15 offset:17152
    v_mfma_f32_16x16x32_bf16 v[40:43], v[100:103], v[112:115], v[40:43]
    ds_read_b64_tr_b16 v[94:95], v15 offset:21248
    s_waitcnt lgkmcnt(6)
    v_mfma_f32_16x16x32_bf16 v[44:47], v[104:107], v[108:111], v[44:47]
    ds_read_b64_tr_b16 v[96:97], v16 offset:17184
    v_mfma_f32_16x16x32_bf16 v[48:51], v[104:107], v[112:115], v[48:51]
    ds_read_b64_tr_b16 v[98:99], v16 offset:21280
    s_bfe_u32 s21, s42, 0x30010
    s_or_b32 s21, s21, s62
    s_lshl_b32 s21, s21, 12
    s_add_u32 s23, s21, 0x1000000
    buffer_load_dwordx4 v[188:191], v4, s[8:11], s23 offen offset:0 sc1
    s_waitcnt lgkmcnt(6)
    v_mfma_f32_16x16x32_bf16 v[52:55], v[84:87], v[108:111], v[52:55]
    ds_read_b64_tr_b16 v[100:101], v15 offset:24576
    v_mfma_f32_16x16x32_bf16 v[56:59], v[84:87], v[112:115], v[56:59]
    ds_read_b64_tr_b16 v[102:103], v15 offset:28672
    s_waitcnt lgkmcnt(6)
    v_mfma_f32_16x16x32_bf16 v[60:63], v[88:91], v[108:111], v[60:63]
    ds_read_b64_tr_b16 v[104:105], v16 offset:24608
    v_mfma_f32_16x16x32_bf16 v[64:67], v[88:91], v[112:115], v[64:67]
    s_bfe_u32 s22, s42, 0x30014
    s_or_b32 s22, s22, s62
    s_lshl_b32 s22, s22, 18
    s_add_u32 s22, s22, s16
    s_add_u32 s22, s22, 0x4000
    s_add_u32 m0, s17, 0x8800
    s_nop 0
    buffer_load_dwordx4 v17, s[4:7], s22 offen lds
    ds_read_b64_tr_b16 v[106:107], v16 offset:28704
    s_waitcnt lgkmcnt(6)
    v_mfma_f32_16x16x32_bf16 v[68:71], v[92:95], v[108:111], v[68:71]
    ds_read_b64_tr_b16 v[84:85], v15 offset:24832
    v_mfma_f32_16x16x32_bf16 v[72:75], v[92:95], v[112:115], v[72:75]
    ds_read_b64_tr_b16 v[86:87], v15 offset:28928
    s_waitcnt lgkmcnt(6)
    v_mfma_f32_16x16x32_bf16 v[76:79], v[96:99], v[108:111], v[76:79]
    ds_read_b64_tr_b16 v[88:89], v16 offset:24864
    v_mfma_f32_16x16x32_bf16 v[80:83], v[96:99], v[112:115], v[80:83]
    ds_read_b64_tr_b16 v[90:91], v16 offset:28960
    s_add_u32 s23, s21, 0x1020000
    buffer_load_dwordx4 v[192:195], v4, s[8:11], s23 offen offset:0 sc1
    s_waitcnt vmcnt(22) lgkmcnt(6)
    v_mfma_f32_16x16x32_bf16 v[20:23], v[100:103], v[116:119], v[20:23]
    ds_read_b64_tr_b16 v[92:93], v15 offset:25088
    s_waitcnt vmcnt(20)
    v_mfma_f32_16x16x32_bf16 v[24:27], v[100:103], v[120:123], v[24:27]
    ds_read_b64_tr_b16 v[94:95], v15 offset:29184
    s_waitcnt lgkmcnt(6)
    v_mfma_f32_16x16x32_bf16 v[28:31], v[104:107], v[116:119], v[28:31]
    ds_read_b64_tr_b16 v[96:97], v16 offset:25120
    v_mfma_f32_16x16x32_bf16 v[32:35], v[104:107], v[120:123], v[32:35]
    s_bfe_u32 s22, s42, 0x30014
    s_or_b32 s22, s22, s62
    s_lshl_b32 s22, s22, 18
    s_add_u32 s22, s22, s16
    s_add_u32 s22, s22, 0x6000
    s_add_u32 m0, s17, 0x8c00
    s_nop 0
    buffer_load_dwordx4 v18, s[4:7], s22 offen lds
    ds_read_b64_tr_b16 v[98:99], v16 offset:29216
    s_waitcnt lgkmcnt(6)
    v_mfma_f32_16x16x32_bf16 v[36:39], v[84:87], v[116:119], v[36:39]
    ds_read_b64_tr_b16 v[100:101], v15 offset:25344
    v_mfma_f32_16x16x32_bf16 v[40:43], v[84:87], v[120:123], v[40:43]
    ds_read_b64_tr_b16 v[102:103], v15 offset:29440
    s_waitcnt lgkmcnt(6)
    v_mfma_f32_16x16x32_bf16 v[44:47], v[88:91], v[116:119], v[44:47]
    ds_read_b64_tr_b16 v[104:105], v16 offset:25376
    v_mfma_f32_16x16x32_bf16 v[48:51], v[88:91], v[120:123], v[48:51]
    ds_read_b64_tr_b16 v[106:107], v16 offset:29472
    s_add_u32 s23, s21, 0x1000000
    buffer_load_dwordx4 v[196:199], v4, s[8:11], s23 offen offset:1024 sc1
    s_waitcnt lgkmcnt(6)
    v_mfma_f32_16x16x32_bf16 v[52:55], v[92:95], v[116:119], v[52:55]
    v_mfma_f32_16x16x32_bf16 v[56:59], v[92:95], v[120:123], v[56:59]
    s_barrier
    ds_read_b64_tr_b16 v[84:85], v15 offset:32768
    ds_read_b64_tr_b16 v[86:87], v15 offset:36864
    s_waitcnt lgkmcnt(6)
    v_mfma_f32_16x16x32_bf16 v[60:63], v[96:99], v[116:119], v[60:63]
    ds_read_b64_tr_b16 v[88:89], v16 offset:32800
    v_mfma_f32_16x16x32_bf16 v[64:67], v[96:99], v[120:123], v[64:67]
    s_bfe_u32 s22, s42, 0x30014
    s_or_b32 s22, s22, s62
    s_lshl_b32 s22, s22, 18
    s_add_u32 s22, s22, s16
    s_add_u32 s22, s22, 0x20000
    s_add_u32 m0, s17, 0xc000
    s_nop 0
    buffer_load_dwordx4 v17, s[4:7], s22 offen lds
    ds_read_b64_tr_b16 v[90:91], v16 offset:36896
    s_waitcnt lgkmcnt(6)
    v_mfma_f32_16x16x32_bf16 v[68:71], v[100:103], v[116:119], v[68:71]
    ds_read_b64_tr_b16 v[92:93], v15 offset:33024
    v_mfma_f32_16x16x32_bf16 v[72:75], v[100:103], v[120:123], v[72:75]
    ds_read_b64_tr_b16 v[94:95], v15 offset:37120
    s_waitcnt lgkmcnt(6)
    v_mfma_f32_16x16x32_bf16 v[76:79], v[104:107], v[116:119], v[76:79]
    ds_read_b64_tr_b16 v[96:97], v16 offset:33056
    v_mfma_f32_16x16x32_bf16 v[80:83], v[104:107], v[120:123], v[80:83]
    ds_read_b64_tr_b16 v[98:99], v16 offset:37152
    s_add_u32 s23, s21, 0x1020000
    buffer_load_dwordx4 v[200:203], v4, s[8:11], s23 offen offset:1024 sc1
    s_waitcnt vmcnt(22) lgkmcnt(6)
    v_mfma_f32_16x16x32_bf16 v[20:23], v[84:87], v[140:143], v[20:23]
    ds_read_b64_tr_b16 v[100:101], v15 offset:33280
    s_waitcnt vmcnt(20)
    v_mfma_f32_16x16x32_bf16 v[24:27], v[84:87], v[144:147], v[24:27]
    ds_read_b64_tr_b16 v[102:103], v15 offset:37376
    s_waitcnt lgkmcnt(6)
    v_mfma_f32_16x16x32_bf16 v[28:31], v[88:91], v[140:143], v[28:31]
    ds_read_b64_tr_b16 v[104:105], v16 offset:33312
    v_mfma_f32_16x16x32_bf16 v[32:35], v[88:91], v[144:147], v[32:35]
    s_bfe_u32 s22, s42, 0x30014
    s_or_b32 s22, s22, s62
    s_lshl_b32 s22, s22, 18
    s_add_u32 s22, s22, s16
    s_add_u32 s22, s22, 0x22000
    s_add_u32 m0, s17, 0xc400
    s_nop 0
    buffer_load_dwordx4 v18, s[4:7], s22 offen lds
    ds_read_b64_tr_b16 v[106:107], v16 offset:37408
    s_waitcnt lgkmcnt(6)
    v_mfma_f32_16x16x32_bf16 v[36:39], v[92:95], v[140:143], v[36:39]
    ds_read_b64_tr_b16 v[84:85], v15 offset:33536
    v_mfma_f32_16x16x32_bf16 v[40:43], v[92:95], v[144:147], v[40:43]
    ds_read_b64_tr_b16 v[86:87], v15 offset:37632
    s_waitcnt lgkmcnt(6)
    v_mfma_f32_16x16x32_bf16 v[44:47], v[96:99], v[140:143], v[44:47]
    ds_read_b64_tr_b16 v[88:89], v16 offset:33568
    v_mfma_f32_16x16x32_bf16 v[48:51], v[96:99], v[144:147], v[48:51]
    ds_read_b64_tr_b16 v[90:91], v16 offset:37664
    s_add_u32 s23, s21, 0x1000800
    buffer_load_dwordx4 v[108:111], v4, s[8:11], s23 offen offset:0 sc1
    s_waitcnt lgkmcnt(6)
    v_mfma_f32_16x16x32_bf16 v[52:55], v[100:103], v[140:143], v[52:55]
    ds_read_b64_tr_b16 v[92:93], v15 offset:40960
    v_mfma_f32_16x16x32_bf16 v[56:59], v[100:103], v[144:147], v[56:59]
    ds_read_b64_tr_b16 v[94:95], v15 offset:45056
    s_waitcnt lgkmcnt(6)
    v_mfma_f32_16x16x32_bf16 v[60:63], v[104:107], v[140:143], v[60:63]
    ds_read_b64_tr_b16 v[96:97], v16 offset:40992
    v_mfma_f32_16x16x32_bf16 v[64:67], v[104:107], v[144:147], v[64:67]
    s_bfe_u32 s22, s42, 0x30014
    s_or_b32 s22, s22, s62
    s_lshl_b32 s22, s22, 18
    s_add_u32 s22, s22, s16
    s_add_u32 s22, s22, 0x24000
    s_add_u32 m0, s17, 0xc800
    s_nop 0
    buffer_load_dwordx4 v17, s[4:7], s22 offen lds
    ds_read_b64_tr_b16 v[98:99], v16 offset:45088
    s_waitcnt lgkmcnt(6)
    v_mfma_f32_16x16x32_bf16 v[68:71], v[84:87], v[140:143], v[68:71]
    ds_read_b64_tr_b16 v[100:101], v15 offset:41216
    v_mfma_f32_16x16x32_bf16 v[72:75], v[84:87], v[144:147], v[72:75]
    ds_read_b64_tr_b16 v[102:103], v15 offset:45312
    s_waitcnt lgkmcnt(6)
    v_mfma_f32_16x16x32_bf16 v[76:79], v[88:91], v[140:143], v[76:79]
    ds_read_b64_tr_b16 v[104:105], v16 offset:41248
    v_mfma_f32_16x16x32_bf16 v[80:83], v[88:91], v[144:147], v[80:83]
    ds_read_b64_tr_b16 v[106:107], v16 offset:45344
    s_add_u32 s23, s21, 0x1020800
    buffer_load_dwordx4 v[112:115], v4, s[8:11], s23 offen offset:0 sc1
    s_waitcnt vmcnt(22) lgkmcnt(6)
    v_mfma_f32_16x16x32_bf16 v[20:23], v[92:95], v[148:151], v[20:23]
    ds_read_b64_tr_b16 v[84:85], v15 offset:41472
    s_waitcnt vmcnt(20)
    v_mfma_f32_16x16x32_bf16 v[24:27], v[92:95], v[152:155], v[24:27]
    ds_read_b64_tr_b16 v[86:87], v15 offset:45568
    s_waitcnt lgkmcnt(6)
    v_mfma_f32_16x16x32_bf16 v[28:31], v[96:99], v[148:151], v[28:31]
    ds_read_b64_tr_b16 v[88:89], v16 offset:41504
    v_mfma_f32_16x16x32_bf16 v[32:35], v[96:99], v[152:155], v[32:35]
    s_bfe_u32 s22, s42, 0x30014
    s_or_b32 s22, s22, s62
    s_lshl_b32 s22, s22, 18
    s_add_u32 s22, s22, s16
    s_add_u32 s22, s22, 0x26000
    s_add_u32 m0, s17, 0xcc00
    s_nop 0
    buffer_load_dwordx4 v18, s[4:7], s22 offen lds
    ds_read_b64_tr_b16 v[90:91], v16 offset:45600
    s_waitcnt lgkmcnt(6)
    v_mfma_f32_16x16x32_bf16 v[36:39], v[100:103], v[148:151], v[36:39]
    ds_read_b64_tr_b16 v[92:93], v15 offset:41728
    v_mfma_f32_16x16x32_bf16 v[40:43], v[100:103], v[152:155], v[40:43]
    ds_read_b64_tr_b16 v[94:95], v15 offset:45824
    s_waitcnt lgkmcnt(6)
    v_mfma_f32_16x16x32_bf16 v[44:47], v[104:107], v[148:151], v[44:47]
    ds_read_b64_tr_b16 v[96:97], v16 offset:41760
    v_mfma_f32_16x16x32_bf16 v[48:51], v[104:107], v[152:155], v[48:51]
    ds_read_b64_tr_b16 v[98:99], v16 offset:45856
    s_add_u32 s23, s21, 0x1000800
    buffer_load_dwordx4 v[116:119], v4, s[8:11], s23 offen offset:1024 sc1
    s_waitcnt lgkmcnt(6)
    v_mfma_f32_16x16x32_bf16 v[52:55], v[84:87], v[148:151], v[52:55]
    v_mfma_f32_16x16x32_bf16 v[56:59], v[84:87], v[152:155], v[56:59]
    s_barrier
    ds_read_b64_tr_b16 v[100:101], v15 offset:49152
    ds_read_b64_tr_b16 v[102:103], v15 offset:53248
    s_waitcnt lgkmcnt(6)
    v_mfma_f32_16x16x32_bf16 v[60:63], v[88:91], v[148:151], v[60:63]
    ds_read_b64_tr_b16 v[104:105], v16 offset:49184
    v_mfma_f32_16x16x32_bf16 v[64:67], v[88:91], v[152:155], v[64:67]
    s_bfe_u32 s22, s42, 0x30018
    s_or_b32 s22, s22, s62
    s_lshl_b32 s22, s22, 18
    s_add_u32 s22, s22, s16
    s_add_u32 s22, s22, 0x0
    s_add_u32 m0, s17, 0x10000
    s_nop 0
    buffer_load_dwordx4 v17, s[4:7], s22 offen lds
    ds_read_b64_tr_b16 v[106:107], v16 offset:53280
    s_waitcnt lgkmcnt(6)
    v_mfma_f32_16x16x32_bf16 v[68:71], v[92:95], v[148:151], v[68:71]
    ds_read_b64_tr_b16 v[84:85], v15 offset:49408
    v_mfma_f32_16x16x32_bf16 v[72:75], v[92:95], v[152:155], v[72:75]
    ds_read_b64_tr_b16 v[86:87], v15 offset:53504
    s_waitcnt lgkmcnt(6)
    v_mfma_f32_16x16x32_bf16 v[76:79], v[96:99], v[148:151], v[76:79]
    ds_read_b64_tr_b16 v[88:89], v16 offset:49440
    v_mfma_f32_16x16x32_bf16 v[80:83], v[96:99], v[152:155], v[80:83]
    ds_read_b64_tr_b16 v[90:91], v16 offset:53536
    s_add_u32 s23, s21, 0x1020800
    buffer_load_dwordx4 v[120:123], v4, s[8:11], s23 offen offset:1024 sc1
    s_waitcnt vmcnt(22) lgkmcnt(6)
    v_mfma_f32_16x16x32_bf16 v[20:23], v[100:103], v[156:159], v[20:23]
    ds_read_b64_tr_b16 v[92:93], v15 offset:49664
    s_waitcnt vmcnt(20)
    v_mfma_f32_16x16x32_bf16 v[24:27], v[100:103], v[160:163], v[24:27]
    ds_read_b64_tr_b16 v[94:95], v15 offset:53760
    s_waitcnt lgkmcnt(6)
    v_mfma_f32_16x16x32_bf16 v[28:31], v[104:107], v[156:159], v[28:31]
    ds_read_b64_tr_b16 v[96:97], v16 offset:49696
    v_mfma_f32_16x16x32_bf16 v[32:35], v[104:107], v[160:163], v[32:35]
    s_bfe_u32 s22, s42, 0x30018
    s_or_b32 s22, s22, s62
    s_lshl_b32 s22, s22, 18
    s_add_u32 s22, s22, s16
    s_add_u32 s22, s22, 0x2000
    s_add_u32 m0, s17, 0x10400
    s_nop 0
    buffer_load_dwordx4 v18, s[4:7], s22 offen lds
    ds_read_b64_tr_b16 v[98:99], v16 offset:53792
    s_waitcnt lgkmcnt(6)
    v_mfma_f32_16x16x32_bf16 v[36:39], v[84:87], v[156:159], v[36:39]
    ds_read_b64_tr_b16 v[100:101], v15 offset:49920
    v_mfma_f32_16x16x32_bf16 v[40:43], v[84:87], v[160:163], v[40:43]
    ds_read_b64_tr_b16 v[102:103], v15 offset:54016
    buffer_load_dword v10, v9, s[8:11], s20 offen sc1
    s_waitcnt lgkmcnt(6)
    v_mfma_f32_16x16x32_bf16 v[44:47], v[88:91], v[156:159], v[44:47]
    ds_read_b64_tr_b16 v[104:105], v16 offset:49952
    v_mfma_f32_16x16x32_bf16 v[48:51], v[88:91], v[160:163], v[48:51]
    ds_read_b64_tr_b16 v[106:107], v16 offset:54048
    s_bfe_u32 s21, s42, 0x30014
    s_or_b32 s21, s21, s62
    s_lshl_b32 s21, s21, 12
    s_add_u32 s23, s21, 0x1000000
    buffer_load_dwordx4 v[140:143], v4, s[8:11], s23 offen offset:0 sc1
    s_waitcnt lgkmcnt(6)
    v_mfma_f32_16x16x32_bf16 v[52:55], v[92:95], v[156:159], v[52:55]
    ds_read_b64_tr_b16 v[84:85], v15 offset:57344
    v_mfma_f32_16x16x32_bf16 v[56:59], v[92:95], v[160:163], v[56:59]
    ds_read_b64_tr_b16 v[86:87], v15 offset:61440
    s_waitcnt lgkmcnt(6)
    v_mfma_f32_16x16x32_bf16 v[60:63], v[96:99], v[156:159], v[60:63]
    ds_read_b64_tr_b16 v[88:89], v16 offset:57376
    v_mfma_f32_16x16x32_bf16 v[64:67], v[96:99], v[160:163], v[64:67]
    s_bfe_u32 s22, s42, 0x30018
    s_or_b32 s22, s22, s62
    s_lshl_b32 s22, s22, 18
    s_add_u32 s22, s22, s16
    s_add_u32 s22, s22, 0x4000
    s_add_u32 m0, s17, 0x10800
    s_nop 0
    buffer_load_dwordx4 v17, s[4:7], s22 offen lds
    ds_read_b64_tr_b16 v[90:91], v16 offset:61472
    s_waitcnt lgkmcnt(6)
    v_mfma_f32_16x16x32_bf16 v[68:71], v[100:103], v[156:159], v[68:71]
    ds_read_b64_tr_b16 v[92:93], v15 offset:57600
    v_mfma_f32_16x16x32_bf16 v[72:75], v[100:103], v[160:163], v[72:75]
    ds_read_b64_tr_b16 v[94:95], v15 offset:61696
    s_waitcnt lgkmcnt(6)
    v_mfma_f32_16x16x32_bf16 v[76:79], v[104:107], v[156:159], v[76:79]
    ds_read_b64_tr_b16 v[96:97], v16 offset:57632
    v_mfma_f32_16x16x32_bf16 v[80:83], v[104:107], v[160:163], v[80:83]
    ds_read_b64_tr_b16 v[98:99], v16 offset:61728
    s_add_u32 s23, s21, 0x1020000
    buffer_load_dwordx4 v[144:147], v4, s[8:11], s23 offen offset:0 sc1
    s_waitcnt vmcnt(23) lgkmcnt(6)
    v_mfma_f32_16x16x32_bf16 v[20:23], v[84:87], v[164:167], v[20:23]
    ds_read_b64_tr_b16 v[100:101], v15 offset:57856
    s_waitcnt vmcnt(21)
    v_mfma_f32_16x16x32_bf16 v[24:27], v[84:87], v[168:171], v[24:27]
    ds_read_b64_tr_b16 v[102:103], v15 offset:61952
    s_waitcnt lgkmcnt(6)
    v_mfma_f32_16x16x32_bf16 v[28:31], v[88:91], v[164:167], v[28:31]
    ds_read_b64_tr_b16 v[104:105], v16 offset:57888
    v_mfma_f32_16x16x32_bf16 v[32:35], v[88:91], v[168:171], v[32:35]
    s_bfe_u32 s22, s42, 0x30018
    s_or_b32 s22, s22, s62
    s_lshl_b32 s22, s22, 18
    s_add_u32 s22, s22, s16
    s_add_u32 s22, s22, 0x6000
    s_add_u32 m0, s17, 0x10c00
    s_nop 0
    buffer_load_dwordx4 v18, s[4:7], s22 offen lds
    ds_read_b64_tr_b16 v[106:107], v16 offset:61984
    s_waitcnt lgkmcnt(6)
    v_mfma_f32_16x16x32_bf16 v[36:39], v[92:95], v[164:167], v[36:39]
    ds_read_b64_tr_b16 v[84:85], v15 offset:58112
    v_mfma_f32_16x16x32_bf16 v[40:43], v[92:95], v[168:171], v[40:43]
    ds_read_b64_tr_b16 v[86:87], v15 offset:62208
    s_waitcnt lgkmcnt(6)
    v_mfma_f32_16x16x32_bf16 v[44:47], v[96:99], v[164:167], v[44:47]
    ds_read_b64_tr_b16 v[88:89], v16 offset:58144
    v_mfma_f32_16x16x32_bf16 v[48:51], v[96:99], v[168:171], v[48:51]
    ds_read_b64_tr_b16 v[90:91], v16 offset:62240
    s_add_u32 s23, s21, 0x1000000
    buffer_load_dwordx4 v[148:151], v4, s[8:11], s23 offen offset:1024 sc1
    s_waitcnt lgkmcnt(6)
    v_mfma_f32_16x16x32_bf16 v[52:55], v[100:103], v[164:167], v[52:55]
    v_mfma_f32_16x16x32_bf16 v[56:59], v[100:103], v[168:171], v[56:59]
    s_barrier
    ds_read_b64_tr_b16 v[92:93], v3 offset:0
    ds_read_b64_tr_b16 v[94:95], v3 offset:4096
    s_waitcnt lgkmcnt(6)
    v_mfma_f32_16x16x32_bf16 v[60:63], v[104:107], v[164:167], v[60:63]
    ds_read_b64_tr_b16 v[96:97], v2 offset:32
    v_mfma_f32_16x16x32_bf16 v[64:67], v[104:107], v[168:171], v[64:67]
    s_bfe_u32 s22, s42, 0x30018
    s_or_b32 s22, s22, s62
    s_lshl_b32 s22, s22, 18
    s_add_u32 s22, s22, s16
    s_add_u32 s22, s22, 0x20000
    s_add_u32 m0, s17, 0x14000
    s_nop 0
    buffer_load_dwordx4 v17, s[4:7], s22 offen lds
    ds_read_b64_tr_b16 v[98:99], v2 offset:4128
    s_waitcnt lgkmcnt(6)
    v_mfma_f32_16x16x32_bf16 v[68:71], v[84:87], v[164:167], v[68:71]
    ds_read_b64_tr_b16 v[100:101], v3 offset:256
    v_mfma_f32_16x16x32_bf16 v[72:75], v[84:87], v[168:171], v[72:75]
    ds_read_b64_tr_b16 v[102:103], v3 offset:4352
    s_waitcnt lgkmcnt(6)
    v_mfma_f32_16x16x32_bf16 v[76:79], v[88:91], v[164:167], v[76:79]
    ds_read_b64_tr_b16 v[104:105], v2 offset:288
    v_mfma_f32_16x16x32_bf16 v[80:83], v[88:91], v[168:171], v[80:83]
    ds_read_b64_tr_b16 v[106:107], v2 offset:4384
    s_add_u32 s23, s21, 0x1020000
    buffer_load_dwordx4 v[152:155], v4, s[8:11], s23 offen offset:1024 sc1
    s_waitcnt vmcnt(23) lgkmcnt(6)
    v_mfma_f32_16x16x32_bf16 v[20:23], v[92:95], v[188:191], v[20:23]
    ds_read_b64_tr_b16 v[84:85], v3 offset:512
    s_waitcnt vmcnt(21)
    v_mfma_f32_16x16x32_bf16 v[24:27], v[92:95], v[192:195], v[24:27]
    ds_read_b64_tr_b16 v[86:87], v3 offset:4608
    s_waitcnt lgkmcnt(6)
    v_mfma_f32_16x16x32_bf16 v[28:31], v[96:99], v[188:191], v[28:31]
    ds_read_b64_tr_b16 v[88:89], v2 offset:544
    v_mfma_f32_16x16x32_bf16 v[32:35], v[96:99], v[192:195], v[32:35]
    s_bfe_u32 s22, s42, 0x30018
    s_or_b32 s22, s22, s62
    s_lshl_b32 s22, s22, 18
    s_add_u32 s22, s22, s16
    s_add_u32 s22, s22, 0x22000
    s_add_u32 m0, s17, 0x14400
    s_nop 0
    buffer_load_dwordx4 v18, s[4:7], s22 offen lds
    ds_read_b64_tr_b16 v[90:91], v2 offset:4640
    s_waitcnt lgkmcnt(6)
    v_mfma_f32_16x16x32_bf16 v[36:39], v[100:103], v[188:191], v[36:39]
    ds_read_b64_tr_b16 v[92:93], v3 offset:768
    v_mfma_f32_16x16x32_bf16 v[40:43], v[100:103], v[192:195], v[40:43]
    ds_read_b64_tr_b16 v[94:95], v3 offset:4864
    s_waitcnt lgkmcnt(6)
    v_mfma_f32_16x16x32_bf16 v[44:47], v[104:107], v[188:191], v[44:47]
    ds_read_b64_tr_b16 v[96:97], v2 offset:800
    v_mfma_f32_16x16x32_bf16 v[48:51], v[104:107], v[192:195], v[48:51]
    ds_read_b64_tr_b16 v[98:99], v2 offset:4896
    s_add_u32 s23, s21, 0x1000800
    buffer_load_dwordx4 v[156:159], v4, s[8:11], s23 offen offset:0 sc1
    s_waitcnt lgkmcnt(6)
    v_mfma_f32_16x16x32_bf16 v[52:55], v[84:87], v[188:191], v[52:55]
    ds_read_b64_tr_b16 v[100:101], v3 offset:8192
    v_mfma_f32_16x16x32_bf16 v[56:59], v[84:87], v[192:195], v[56:59]
    ds_read_b64_tr_b16 v[102:103], v3 offset:12288
    s_waitcnt lgkmcnt(6)
    v_mfma_f32_16x16x32_bf16 v[60:63], v[88:91], v[188:191], v[60:63]
    ds_read_b64_tr_b16 v[104:105], v2 offset:8224
    v_mfma_f32_16x16x32_bf16 v[64:67], v[88:91], v[192:195], v[64:67]
    s_bfe_u32 s22, s42, 0x30018
    s_or_b32 s22, s22, s62
    s_lshl_b32 s22, s22, 18
    s_add_u32 s22, s22, s16
    s_add_u32 s22, s22, 0x24000
    s_add_u32 m0, s17, 0x14800
    s_nop 0
    buffer_load_dwordx4 v17, s[4:7], s22 offen lds
    ds_read_b64_tr_b16 v[106:107], v2 offset:12320
    s_waitcnt lgkmcnt(6)
    v_mfma_f32_16x16x32_bf16 v[68:71], v[92:95], v[188:191], v[68:71]
    ds_read_b64_tr_b16 v[84:85], v3 offset:8448
    v_mfma_f32_16x16x32_bf16 v[72:75], v[92:95], v[192:195], v[72:75]
    ds_read_b64_tr_b16 v[86:87], v3 offset:12544
    s_waitcnt lgkmcnt(6)
    v_mfma_f32_16x16x32_bf16 v[76:79], v[96:99], v[188:191], v[76:79]
    ds_read_b64_tr_b16 v[88:89], v2 offset:8480
    v_mfma_f32_16x16x32_bf16 v[80:83], v[96:99], v[192:195], v[80:83]
    ds_read_b64_tr_b16 v[90:91], v2 offset:12576
    s_add_u32 s23, s21, 0x1020800
    buffer_load_dwordx4 v[160:163], v4, s[8:11], s23 offen offset:0 sc1
    s_waitcnt vmcnt(23) lgkmcnt(6)
    v_mfma_f32_16x16x32_bf16 v[20:23], v[100:103], v[196:199], v[20:23]
    ds_read_b64_tr_b16 v[92:93], v3 offset:8704
    s_waitcnt vmcnt(21)
    v_mfma_f32_16x16x32_bf16 v[24:27], v[100:103], v[200:203], v[24:27]
    ds_read_b64_tr_b16 v[94:95], v3 offset:12800
    s_waitcnt lgkmcnt(6)
    v_mfma_f32_16x16x32_bf16 v[28:31], v[104:107], v[196:199], v[28:31]
    ds_read_b64_tr_b16 v[96:97], v2 offset:8736
    v_mfma_f32_16x16x32_bf16 v[32:35], v[104:107], v[200:203], v[32:35]
    s_bfe_u32 s22, s42, 0x30018
    s_or_b32 s22, s22, s62
    s_lshl_b32 s22, s22, 18
    s_add_u32 s22, s22, s16
    s_add_u32 s22, s22, 0x26000
    s_add_u32 m0, s17, 0x14c00
    s_nop 0
    buffer_load_dwordx4 v18, s[4:7], s22 offen lds
    ds_read_b64_tr_b16 v[98:99], v2 offset:12832
    s_waitcnt lgkmcnt(6)
    v_mfma_f32_16x16x32_bf16 v[36:39], v[84:87], v[196:199], v[36:39]
    ds_read_b64_tr_b16 v[100:101], v3 offset:8960
    v_mfma_f32_16x16x32_bf16 v[40:43], v[84:87], v[200:203], v[40:43]
    ds_read_b64_tr_b16 v[102:103], v3 offset:13056
    s_waitcnt lgkmcnt(6)
    v_mfma_f32_16x16x32_bf16 v[44:47], v[88:91], v[196:199], v[44:47]
    ds_read_b64_tr_b16 v[104:105], v2 offset:8992
    v_mfma_f32_16x16x32_bf16 v[48:51], v[88:91], v[200:203], v[48:51]
    ds_read_b64_tr_b16 v[106:107], v2 offset:13088
    s_add_u32 s23, s21, 0x1000800
    buffer_load_dwordx4 v[164:167], v4, s[8:11], s23 offen offset:1024 sc1
    s_waitcnt lgkmcnt(6)
    v_mfma_f32_16x16x32_bf16 v[52:55], v[92:95], v[196:199], v[52:55]
    v_mfma_f32_16x16x32_bf16 v[56:59], v[92:95], v[200:203], v[56:59]
    s_barrier
    ds_read_b64_tr_b16 v[84:85], v3 offset:16384
    ds_read_b64_tr_b16 v[86:87], v3 offset:20480
    s_waitcnt lgkmcnt(6)
    v_mfma_f32_16x16x32_bf16 v[60:63], v[96:99], v[196:199], v[60:63]
    ds_read_b64_tr_b16 v[88:89], v2 offset:16416
    v_mfma_f32_16x16x32_bf16 v[64:67], v[96:99], v[200:203], v[64:67]
    s_bfe_u32 s22, s42, 0x3001c
    s_or_b32 s22, s22, s62
    s_lshl_b32 s22, s22, 18
    s_add_u32 s22, s22, s16
    s_add_u32 s22, s22, 0x0
    s_add_u32 m0, s17, 0x18000
    s_nop 0
    buffer_load_dwordx4 v17, s[4:7], s22 offen lds
    ds_read_b64_tr_b16 v[90:91], v2 offset:20512
    s_waitcnt lgkmcnt(6)
    v_mfma_f32_16x16x32_bf16 v[68:71], v[100:103], v[196:199], v[68:71]
    ds_read_b64_tr_b16 v[92:93], v3 offset:16640
    v_mfma_f32_16x16x32_bf16 v[72:75], v[100:103], v[200:203], v[72:75]
    ds_read_b64_tr_b16 v[94:95], v3 offset:20736
    s_waitcnt lgkmcnt(6)
    v_mfma_f32_16x16x32_bf16 v[76:79], v[104:107], v[196:199], v[76:79]
    ds_read_b64_tr_b16 v[96:97], v2 offset:16672
    v_mfma_f32_16x16x32_bf16 v[80:83], v[104:107], v[200:203], v[80:83]
    ds_read_b64_tr_b16 v[98:99], v2 offset:20768
    s_add_u32 s23, s21, 0x1020800
    buffer_load_dwordx4 v[168:171], v4, s[8:11], s23 offen offset:1024 sc1
    s_waitcnt vmcnt(15)
    v_cmp_ne_u32 vcc, s14, v10
    s_cbranch_vccz fz_o2gA
    s_mov_b32 s27, 0
fz_o2pA:
    buffer_load_dword v10, v9, s[8:11], s20 offen sc1
    s_waitcnt vmcnt(0)
    v_cmp_ne_u32 vcc, s14, v10
    s_add_u32 s27, s27, 1
    s_cmp_ge_u32 s27, 65536
    s_nop 4
    s_cbranch_scc1 fz_o2gA
    s_cbranch_vccnz fz_o2pA
fz_o2gA:
    s_waitcnt lgkmcnt(6)
    v_mfma_f32_16x16x32_bf16 v[20:23], v[84:87], v[108:111], v[20:23]
    ds_read_b64_tr_b16 v[100:101], v3 offset:16896
    v_mfma_f32_16x16x32_bf16 v[24:27], v[84:87], v[112:115], v[24:27]
    ds_read_b64_tr_b16 v[102:103], v3 offset:20992
    s_waitcnt lgkmcnt(6)
    v_mfma_f32_16x16x32_bf16 v[28:31], v[88:91], v[108:111], v[28:31]
    ds_read_b64_tr_b16 v[104:105], v2 offset:16928
    v_mfma_f32_16x16x32_bf16 v[32:35], v[88:91], v[112:115], v[32:35]
    s_bfe_u32 s22, s42, 0x3001c
    s_or_b32 s22, s22, s62
    s_lshl_b32 s22, s22, 18
    s_add_u32 s22, s22, s16
    s_add_u32 s22, s22, 0x2000
    s_add_u32 m0, s17, 0x18400
    s_nop 0
    buffer_load_dwordx4 v18, s[4:7], s22 offen lds
    ds_read_b64_tr_b16 v[106:107], v2 offset:21024
    s_waitcnt lgkmcnt(6)
    v_mfma_f32_16x16x32_bf16 v[36:39], v[92:95], v[108:111], v[36:39]
    ds_read_b64_tr_b16 v[84:85], v3 offset:17152
    v_mfma_f32_16x16x32_bf16 v[40:43], v[92:95], v[112:115], v[40:43]
    ds_read_b64_tr_b16 v[86:87], v3 offset:21248
    s_waitcnt lgkmcnt(6)
    v_mfma_f32_16x16x32_bf16 v[44:47], v[96:99], v[108:111], v[44:47]
    ds_read_b64_tr_b16 v[88:89], v2 offset:17184
    v_mfma_f32_16x16x32_bf16 v[48:51], v[96:99], v[112:115], v[48:51]
    ds_read_b64_tr_b16 v[90:91], v2 offset:21280
    s_bfe_u32 s21, s42, 0x30018
    s_or_b32 s21, s21, s62
    s_lshl_b32 s21, s21, 12
    s_add_u32 s23, s21, 0x1000000
    buffer_load_dwordx4 v[188:191], v4, s[8:11], s23 offen offset:0 sc1
    s_waitcnt lgkmcnt(6)
    v_mfma_f32_16x16x32_bf16 v[52:55], v[100:103], v[108:111], v[52:55]
    ds_read_b64_tr_b16 v[92:93], v3 offset:24576
    v_mfma_f32_16x16x32_bf16 v[56:59], v[100:103], v[112:115], v[56:59]
    ds_read_b64_tr_b16 v[94:95], v3 offset:28672
    s_waitcnt lgkmcnt(6)
    v_mfma_f32_16x16x32_bf16 v[60:63], v[104:107], v[108:111], v[60:63]
    ds_read_b64_tr_b16 v[96:97], v2 offset:24608
    v_mfma_f32_16x16x32_bf16 v[64:67], v[104:107], v[112:115], v[64:67]
    s_bfe_u32 s22, s42, 0x3001c
    s_or_b32 s22, s22, s62
    s_lshl_b32 s22, s22, 18
    s_add_u32 s22, s22, s16
    s_add_u32 s22, s22, 0x4000
    s_add_u32 m0, s17, 0x18800
    s_nop 0
    buffer_load_dwordx4 v17, s[4:7], s22 offen lds
    ds_read_b64_tr_b16 v[98:99], v2 offset:28704
    s_waitcnt lgkmcnt(6)
    v_mfma_f32_16x16x32_bf16 v[68:71], v[84:87], v[108:111], v[68:71]
    ds_read_b64_tr_b16 v[100:101], v3 offset:24832
    v_mfma_f32_16x16x32_bf16 v[72:75], v[84:87], v[112:115], v[72:75]
    ds_read_b64_tr_b16 v[102:103], v3 offset:28928
    s_waitcnt lgkmcnt(6)
    v_mfma_f32_16x16x32_bf16 v[76:79], v[88:91], v[108:111], v[76:79]
    ds_read_b64_tr_b16 v[104:105], v2 offset:24864
    v_mfma_f32_16x16x32_bf16 v[80:83], v[88:91], v[112:115], v[80:83]
    ds_read_b64_tr_b16 v[106:107], v2 offset:28960
    s_add_u32 s23, s21, 0x1020000
    buffer_load_dwordx4 v[192:195], v4, s[8:11], s23 offen offset:0 sc1
    s_waitcnt lgkmcnt(6)
    v_mfma_f32_16x16x32_bf16 v[20:23], v[92:95], v[116:119], v[20:23]
    ds_read_b64_tr_b16 v[84:85], v3 offset:25088
    v_mfma_f32_16x16x32_bf16 v[24:27], v[92:95], v[120:123], v[24:27]
    ds_read_b64_tr_b16 v[86:87], v3 offset:29184
    s_waitcnt lgkmcnt(6)
    v_mfma_f32_16x16x32_bf16 v[28:31], v[96:99], v[116:119], v[28:31]
    ds_read_b64_tr_b16 v[88:89], v2 offset:25120
    v_mfma_f32_16x16x32_bf16 v[32:35], v[96:99], v[120:123], v[32:35]
    s_bfe_u32 s22, s42, 0x3001c
    s_or_b32 s22, s22, s62
    s_lshl_b32 s22, s22, 18
    s_add_u32 s22, s22, s16
    s_add_u32 s22, s22, 0x6000
    s_add_u32 m0, s17, 0x18c00
    s_nop 0
    buffer_load_dwordx4 v18, s[4:7], s22 offen lds
    ds_read_b64_tr_b16 v[90:91], v2 offset:29216
    s_waitcnt lgkmcnt(6)
    v_mfma_f32_16x16x32_bf16 v[36:39], v[100:103], v[116:119], v[36:39]
    ds_read_b64_tr_b16 v[92:93], v3 offset:25344
    v_mfma_f32_16x16x32_bf16 v[40:43], v[100:103], v[120:123], v[40:43]
    ds_read_b64_tr_b16 v[94:95], v3 offset:29440
    s_waitcnt lgkmcnt(6)
    v_mfma_f32_16x16x32_bf16 v[44:47], v[104:107], v[116:119], v[44:47]
    ds_read_b64_tr_b16 v[96:97], v2 offset:25376
    v_mfma_f32_16x16x32_bf16 v[48:51], v[104:107], v[120:123], v[48:51]
    ds_read_b64_tr_b16 v[98:99], v2 offset:29472
    s_add_u32 s23, s21, 0x1000000
    buffer_load_dwordx4 v[196:199], v4, s[8:11], s23 offen offset:1024 sc1
    s_waitcnt lgkmcnt(6)
    v_mfma_f32_16x16x32_bf16 v[52:55], v[84:87], v[116:119], v[52:55]
    v_mfma_f32_16x16x32_bf16 v[56:59], v[84:87], v[120:123], v[56:59]
    s_barrier
    ds_read_b64_tr_b16 v[100:101], v3 offset:32768
    ds_read_b64_tr_b16 v[102:103], v3 offset:36864
    s_waitcnt lgkmcnt(6)
    v_mfma_f32_16x16x32_bf16 v[60:63], v[88:91], v[116:119], v[60:63]
    ds_read_b64_tr_b16 v[104:105], v2 offset:32800
    v_mfma_f32_16x16x32_bf16 v[64:67], v[88:91], v[120:123], v[64:67]
    s_bfe_u32 s22, s42, 0x3001c
    s_or_b32 s22, s22, s62
    s_lshl_b32 s22, s22, 18
    s_add_u32 s22, s22, s16
    s_add_u32 s22, s22, 0x20000
    s_add_u32 m0, s17, 0x1c000
    s_nop 0
    buffer_load_dwordx4 v17, s[4:7], s22 offen lds
    ds_read_b64_tr_b16 v[106:107], v2 offset:36896
    s_waitcnt lgkmcnt(6)
    v_mfma_f32_16x16x32_bf16 v[68:71], v[92:95], v[116:119], v[68:71]
    ds_read_b64_tr_b16 v[84:85], v3 offset:33024
    v_mfma_f32_16x16x32_bf16 v[72:75], v[92:95], v[120:123], v[72:75]
    ds_read_b64_tr_b16 v[86:87], v3 offset:37120
    s_waitcnt lgkmcnt(6)
    v_mfma_f32_16x16x32_bf16 v[76:79], v[96:99], v[116:119], v[76:79]
    ds_read_b64_tr_b16 v[88:89], v2 offset:33056
    v_mfma_f32_16x16x32_bf16 v[80:83], v[96:99], v[120:123], v[80:83]
    ds_read_b64_tr_b16 v[90:91], v2 offset:37152
    s_add_u32 s23, s21, 0x1020000
    buffer_load_dwordx4 v[200:203], v4, s[8:11], s23 offen offset:1024 sc1
    s_waitcnt vmcnt(22) lgkmcnt(6)
    v_mfma_f32_16x16x32_bf16 v[20:23], v[100:103], v[140:143], v[20:23]
    ds_read_b64_tr_b16 v[92:93], v3 offset:33280
    s_waitcnt vmcnt(20)
    v_mfma_f32_16x16x32_bf16 v[24:27], v[100:103], v[144:147], v[24:27]
    ds_read_b64_tr_b16 v[94:95], v3 offset:37376
    s_waitcnt lgkmcnt(6)
    v_mfma_f32_16x16x32_bf16 v[28:31], v[104:107], v[140:143], v[28:31]
    ds_read_b64_tr_b16 v[96:97], v2 offset:33312
    v_mfma_f32_16x16x32_bf16 v[32:35], v[104:107], v[144:147], v[32:35]
    s_bfe_u32 s22, s42, 0x3001c
    s_or_b32 s22, s22, s62
    s_lshl_b32 s22, s22, 18
    s_add_u32 s22, s22, s16
    s_add_u32 s22, s22, 0x22000
    s_add_u32 m0, s17, 0x1c400
    s_nop 0
    buffer_load_dwordx4 v18, s[4:7], s22 offen lds
    ds_read_b64_tr_b16 v[98:99], v2 offset:37408
    s_waitcnt lgkmcnt(6)
    v_mfma_f32_16x16x32_bf16 v[36:39], v[84:87], v[140:143], v[36:39]
    ds_read_b64_tr_b16 v[100:101], v3 offset:33536
    v_mfma_f32_16x16x32_bf16 v[40:43], v[84:87], v[144:147], v[40:43]
    ds_read_b64_tr_b16 v[102:103], v3 offset:37632
    s_waitcnt lgkmcnt(6)
    v_mfma_f32_16x16x32_bf16 v[44:47], v[88:91], v[140:143], v[44:47]
    ds_read_b64_tr_b16 v[104:105], v2 offset:33568
    v_mfma_f32_16x16x32_bf16 v[48:51], v[88:91], v[144:147], v[48:51]
    ds_read_b64_tr_b16 v[106:107], v2 offset:37664
    s_add_u32 s23, s21, 0x1000800
    buffer_load_dwordx4 v[108:111], v4, s[8:11], s23 offen offset:0 sc1
    s_waitcnt lgkmcnt(6)
    v_mfma_f32_16x16x32_bf16 v[52:55], v[92:95], v[140:143], v[52:55]
    ds_read_b64_tr_b16 v[84:85], v3 offset:40960
    v_mfma_f32_16x16x32_bf16 v[56:59], v[92:95], v[144:147], v[56:59]
    ds_read_b64_tr_b16 v[86:87], v3 offset:45056
    s_waitcnt lgkmcnt(6)
    v_mfma_f32_16x16x32_bf16 v[60:63], v[96:99], v[140:143], v[60:63]
    ds_read_b64_tr_b16 v[88:89], v2 offset:40992
    v_mfma_f32_16x16x32_bf16 v[64:67], v[96:99], v[144:147], v[64:67]
    s_bfe_u32 s22, s42, 0x3001c
    s_or_b32 s22, s22, s62
    s_lshl_b32 s22, s22, 18
    s_add_u32 s22, s22, s16
    s_add_u32 s22, s22, 0x24000
    s_add_u32 m0, s17, 0x1c800
    s_nop 0
    buffer_load_dwordx4 v17, s[4:7], s22 offen lds
    ds_read_b64_tr_b16 v[90:91], v2 offset:45088
    s_waitcnt lgkmcnt(6)
    v_mfma_f32_16x16x32_bf16 v[68:71], v[100:103], v[140:143], v[68:71]
    ds_read_b64_tr_b16 v[92:93], v3 offset:41216
    v_mfma_f32_16x16x32_bf16 v[72:75], v[100:103], v[144:147], v[72:75]
    ds_read_b64_tr_b16 v[94:95], v3 offset:45312
    s_waitcnt lgkmcnt(6)
    v_mfma_f32_16x16x32_bf16 v[76:79], v[104:107], v[140:143], v[76:79]
    ds_read_b64_tr_b16 v[96:97], v2 offset:41248
    v_mfma_f32_16x16x32_bf16 v[80:83], v[104:107], v[144:147], v[80:83]
    ds_read_b64_tr_b16 v[98:99], v2 offset:45344
    s_add_u32 s23, s21, 0x1020800
    buffer_load_dwordx4 v[112:115], v4, s[8:11], s23 offen offset:0 sc1
    s_waitcnt vmcnt(22) lgkmcnt(6)
    v_mfma_f32_16x16x32_bf16 v[20:23], v[84:87], v[148:151], v[20:23]
    ds_read_b64_tr_b16 v[100:101], v3 offset:41472
    s_waitcnt vmcnt(20)
    v_mfma_f32_16x16x32_bf16 v[24:27], v[84:87], v[152:155], v[24:27]
    ds_read_b64_tr_b16 v[102:103], v3 offset:45568
    s_waitcnt lgkmcnt(6)
    v_mfma_f32_16x16x32_bf16 v[28:31], v[88:91], v[148:151], v[28:31]
    ds_read_b64_tr_b16 v[104:105], v2 offset:41504
    v_mfma_f32_16x16x32_bf16 v[32:35], v[88:91], v[152:155], v[32:35]
    s_bfe_u32 s22, s42, 0x3001c
    s_or_b32 s22, s22, s62
    s_lshl_b32 s22, s22, 18
    s_add_u32 s22, s22, s16
    s_add_u32 s22, s22, 0x26000
    s_add_u32 m0, s17, 0x1cc00
    s_nop 0
    buffer_load_dwordx4 v18, s[4:7], s22 offen lds
    ds_read_b64_tr_b16 v[106:107], v2 offset:45600
    s_waitcnt lgkmcnt(6)
    v_mfma_f32_16x16x32_bf16 v[36:39], v[92:95], v[148:151], v[36:39]
    ds_read_b64_tr_b16 v[84:85], v3 offset:41728
    v_mfma_f32_16x16x32_bf16 v[40:43], v[92:95], v[152:155], v[40:43]
    ds_read_b64_tr_b16 v[86:87], v3 offset:45824
    s_waitcnt lgkmcnt(6)
    v_mfma_f32_16x16x32_bf16 v[44:47], v[96:99], v[148:151], v[44:47]
    ds_read_b64_tr_b16 v[88:89], v2 offset:41760
    v_mfma_f32_16x16x32_bf16 v[48:51], v[96:99], v[152:155], v[48:51]
    ds_read_b64_tr_b16 v[90:91], v2 offset:45856
    s_add_u32 s23, s21, 0x1000800
    buffer_load_dwordx4 v[116:119], v4, s[8:11], s23 offen offset:1024 sc1
    s_waitcnt lgkmcnt(6)
    v_mfma_f32_16x16x32_bf16 v[52:55], v[100:103], v[148:151], v[52:55]
    v_mfma_f32_16x16x32_bf16 v[56:59], v[100:103], v[152:155], v[56:59]
    s_barrier
    ds_read_b64_tr_b16 v[92:93], v3 offset:49152
    ds_read_b64_tr_b16 v[94:95], v3 offset:53248
    s_waitcnt lgkmcnt(6)
    v_mfma_f32_16x16x32_bf16 v[60:63], v[104:107], v[148:151], v[60:63]
    ds_read_b64_tr_b16 v[96:97], v2 offset:49184
    v_mfma_f32_16x16x32_bf16 v[64:67], v[104:107], v[152:155], v[64:67]
    ds_read_b64_tr_b16 v[98:99], v2 offset:53280
    s_waitcnt lgkmcnt(6)
    v_mfma_f32_16x16x32_bf16 v[68:71], v[84:87], v[148:151], v[68:71]
    ds_read_b64_tr_b16 v[100:101], v3 offset:49408
    v_mfma_f32_16x16x32_bf16 v[72:75], v[84:87], v[152:155], v[72:75]
    ds_read_b64_tr_b16 v[102:103], v3 offset:53504
    s_waitcnt lgkmcnt(6)
    v_mfma_f32_16x16x32_bf16 v[76:79], v[88:91], v[148:151], v[76:79]
    ds_read_b64_tr_b16 v[104:105], v2 offset:49440
    v_mfma_f32_16x16x32_bf16 v[80:83], v[88:91], v[152:155], v[80:83]
    ds_read_b64_tr_b16 v[106:107], v2 offset:53536
    s_add_u32 s23, s21, 0x1020800
    buffer_load_dwordx4 v[120:123], v4, s[8:11], s23 offen offset:1024 sc1
    s_waitcnt vmcnt(21) lgkmcnt(6)
    v_mfma_f32_16x16x32_bf16 v[20:23], v[92:95], v[156:159], v[20:23]
    ds_read_b64_tr_b16 v[84:85], v3 offset:49664
    s_waitcnt vmcnt(19)
    v_mfma_f32_16x16x32_bf16 v[24:27], v[92:95], v[160:163], v[24:27]
    ds_read_b64_tr_b16 v[86:87], v3 offset:53760
    s_waitcnt lgkmcnt(6)
    v_mfma_f32_16x16x32_bf16 v[28:31], v[96:99], v[156:159], v[28:31]
    ds_read_b64_tr_b16 v[88:89], v2 offset:49696
    v_mfma_f32_16x16x32_bf16 v[32:35], v[96:99], v[160:163], v[32:35]
    ds_read_b64_tr_b16 v[90:91], v2 offset:53792
    s_waitcnt lgkmcnt(6)
    v_mfma_f32_16x16x32_bf16 v[36:39], v[100:103], v[156:159], v[36:39]
    ds_read_b64_tr_b16 v[92:93], v3 offset:49920
    v_mfma_f32_16x16x32_bf16 v[40:43], v[100:103], v[160:163], v[40:43]
    ds_read_b64_tr_b16 v[94:95], v3 offset:54016
    s_waitcnt lgkmcnt(6)
    v_mfma_f32_16x16x32_bf16 v[44:47], v[104:107], v[156:159], v[44:47]
    ds_read_b64_tr_b16 v[96:97], v2 offset:49952
    v_mfma_f32_16x16x32_bf16 v[48:51], v[104:107], v[160:163], v[48:51]
    ds_read_b64_tr_b16 v[98:99], v2 offset:54048
    s_bfe_u32 s21, s42, 0x3001c
    s_or_b32 s21, s21, s62
    s_lshl_b32 s21, s21, 12
    s_add_u32 s23, s21, 0x1000000
    buffer_load_dwordx4 v[140:143], v4, s[8:11], s23 offen offset:0 sc1
    s_waitcnt lgkmcnt(6)
    v_mfma_f32_16x16x32_bf16 v[52:55], v[84:87], v[156:159], v[52:55]
    ds_read_b64_tr_b16 v[100:101], v3 offset:57344
    v_mfma_f32_16x16x32_bf16 v[56:59], v[84:87], v[160:163], v[56:59]
    ds_read_b64_tr_b16 v[102:103], v3 offset:61440
    s_waitcnt lgkmcnt(6)
    v_mfma_f32_16x16x32_bf16 v[60:63], v[88:91], v[156:159], v[60:63]
    ds_read_b64_tr_b16 v[104:105], v2 offset:57376
    v_mfma_f32_16x16x32_bf16 v[64:67], v[88:91], v[160:163], v[64:67]
    ds_read_b64_tr_b16 v[106:107], v2 offset:61472
    s_waitcnt lgkmcnt(6)
    v_mfma_f32_16x16x32_bf16 v[68:71], v[92:95], v[156:159], v[68:71]
    ds_read_b64_tr_b16 v[84:85], v3 offset:57600
    v_mfma_f32_16x16x32_bf16 v[72:75], v[92:95], v[160:163], v[72:75]
    ds_read_b64_tr_b16 v[86:87], v3 offset:61696
    s_waitcnt lgkmcnt(6)
    v_mfma_f32_16x16x32_bf16 v[76:79], v[96:99], v[156:159], v[76:79]
    ds_read_b64_tr_b16 v[88:89], v2 offset:57632
    v_mfma_f32_16x16x32_bf16 v[80:83], v[96:99], v[160:163], v[80:83]
    ds_read_b64_tr_b16 v[90:91], v2 offset:61728
    s_add_u32 s23, s21, 0x1020000
    buffer_load_dwordx4 v[144:147], v4, s[8:11], s23 offen offset:0 sc1
    s_waitcnt vmcnt(19) lgkmcnt(6)
    v_mfma_f32_16x16x32_bf16 v[20:23], v[100:103], v[164:167], v[20:23]
    ds_read_b64_tr_b16 v[92:93], v3 offset:57856
    s_waitcnt vmcnt(17)
    v_mfma_f32_16x16x32_bf16 v[24:27], v[100:103], v[168:171], v[24:27]
    ds_read_b64_tr_b16 v[94:95], v3 offset:61952
    s_waitcnt lgkmcnt(6)
    v_mfma_f32_16x16x32_bf16 v[28:31], v[104:107], v[164:167], v[28:31]
    ds_read_b64_tr_b16 v[96:97], v2 offset:57888
    v_mfma_f32_16x16x32_bf16 v[32:35], v[104:107], v[168:171], v[32:35]
    ds_read_b64_tr_b16 v[98:99], v2 offset:61984
    s_waitcnt lgkmcnt(6)
    v_mfma_f32_16x16x32_bf16 v[36:39], v[84:87], v[164:167], v[36:39]
    ds_read_b64_tr_b16 v[100:101], v3 offset:58112
    v_mfma_f32_16x16x32_bf16 v[40:43], v[84:87], v[168:171], v[40:43]
    ds_read_b64_tr_b16 v[102:103], v3 offset:62208
    s_waitcnt lgkmcnt(6)
    v_mfma_f32_16x16x32_bf16 v[44:47], v[88:91], v[164:167], v[44:47]
    ds_read_b64_tr_b16 v[104:105], v2 offset:58144
    v_mfma_f32_16x16x32_bf16 v[48:51], v[88:91], v[168:171], v[48:51]
    ds_read_b64_tr_b16 v[106:107], v2 offset:62240
    s_add_u32 s23, s21, 0x1000000
    buffer_load_dwordx4 v[148:151], v4, s[8:11], s23 offen offset:1024 sc1
    s_waitcnt lgkmcnt(6)
    v_mfma_f32_16x16x32_bf16 v[52:55], v[92:95], v[164:167], v[52:55]
    v_mfma_f32_16x16x32_bf16 v[56:59], v[92:95], v[168:171], v[56:59]
    s_waitcnt vmcnt(5)
    s_barrier
    ds_read_b64_tr_b16 v[84:85], v15 offset:0
    ds_read_b64_tr_b16 v[86:87], v15 offset:4096
    s_waitcnt lgkmcnt(6)
    v_mfma_f32_16x16x32_bf16 v[60:63], v[96:99], v[164:167], v[60:63]
    ds_read_b64_tr_b16 v[88:89], v16 offset:32
    v_mfma_f32_16x16x32_bf16 v[64:67], v[96:99], v[168:171], v[64:67]
    ds_read_b64_tr_b16 v[90:91], v16 offset:4128
    s_waitcnt lgkmcnt(6)
    v_mfma_f32_16x16x32_bf16 v[68:71], v[100:103], v[164:167], v[68:71]
    ds_read_b64_tr_b16 v[92:93], v15 offset:256
    v_mfma_f32_16x16x32_bf16 v[72:75], v[100:103], v[168:171], v[72:75]
    ds_read_b64_tr_b16 v[94:95], v15 offset:4352
    s_waitcnt lgkmcnt(6)
    v_mfma_f32_16x16x32_bf16 v[76:79], v[104:107], v[164:167], v[76:79]
    ds_read_b64_tr_b16 v[96:97], v16 offset:288
    v_mfma_f32_16x16x32_bf16 v[80:83], v[104:107], v[168:171], v[80:83]
    ds_read_b64_tr_b16 v[98:99], v16 offset:4384
    s_add_u32 s23, s21, 0x1020000
    buffer_load_dwordx4 v[152:155], v4, s[8:11], s23 offen offset:1024 sc1
    s_waitcnt lgkmcnt(6)
    v_mfma_f32_16x16x32_bf16 v[20:23], v[84:87], v[188:191], v[20:23]
    ds_read_b64_tr_b16 v[100:101], v15 offset:512
    v_mfma_f32_16x16x32_bf16 v[24:27], v[84:87], v[192:195], v[24:27]
    ds_read_b64_tr_b16 v[102:103], v15 offset:4608
    s_waitcnt lgkmcnt(6)
    v_mfma_f32_16x16x32_bf16 v[28:31], v[88:91], v[188:191], v[28:31]
    ds_read_b64_tr_b16 v[104:105], v16 offset:544
    v_mfma_f32_16x16x32_bf16 v[32:35], v[88:91], v[192:195], v[32:35]
    ds_read_b64_tr_b16 v[106:107], v16 offset:4640
    s_waitcnt lgkmcnt(6)
    v_mfma_f32_16x16x32_bf16 v[36:39], v[92:95], v[188:191], v[36:39]
    ds_read_b64_tr_b16 v[84:85], v15 offset:768
    v_mfma_f32_16x16x32_bf16 v[40:43], v[92:95], v[192:195], v[40:43]
    ds_read_b64_tr_b16 v[86:87], v15 offset:4864
    s_waitcnt lgkmcnt(6)
    v_mfma_f32_16x16x32_bf16 v[44:47], v[96:99], v[188:191], v[44:47]
    ds_read_b64_tr_b16 v[88:89], v16 offset:800
    v_mfma_f32_16x16x32_bf16 v[48:51], v[96:99], v[192:195], v[48:51]
    ds_read_b64_tr_b16 v[90:91], v16 offset:4896
    s_add_u32 s23, s21, 0x1000800
    buffer_load_dwordx4 v[156:159], v4, s[8:11], s23 offen offset:0 sc1
    s_waitcnt lgkmcnt(6)
    v_mfma_f32_16x16x32_bf16 v[52:55], v[100:103], v[188:191], v[52:55]
    ds_read_b64_tr_b16 v[92:93], v15 offset:8192
    v_mfma_f32_16x16x32_bf16 v[56:59], v[100:103], v[192:195], v[56:59]
    ds_read_b64_tr_b16 v[94:95], v15 offset:12288
    s_waitcnt lgkmcnt(6)
    v_mfma_f32_16x16x32_bf16 v[60:63], v[104:107], v[188:191], v[60:63]
    ds_read_b64_tr_b16 v[96:97], v16 offset:8224
    v_mfma_f32_16x16x32_bf16 v[64:67], v[104:107], v[192:195], v[64:67]
    ds_read_b64_tr_b16 v[98:99], v16 offset:12320
    s_waitcnt lgkmcnt(6)
    v_mfma_f32_16x16x32_bf16 v[68:71], v[84:87], v[188:191], v[68:71]
    ds_read_b64_tr_b16 v[100:101], v15 offset:8448
    v_mfma_f32_16x16x32_bf16 v[72:75], v[84:87], v[192:195], v[72:75]
    ds_read_b64_tr_b16 v[102:103], v15 offset:12544
    s_waitcnt lgkmcnt(6)
    v_mfma_f32_16x16x32_bf16 v[76:79], v[88:91], v[188:191], v[76:79]
    ds_read_b64_tr_b16 v[104:105], v16 offset:8480
    v_mfma_f32_16x16x32_bf16 v[80:83], v[88:91], v[192:195], v[80:83]
    ds_read_b64_tr_b16 v[106:107], v16 offset:12576
    s_add_u32 s23, s21, 0x1020800
    buffer_load_dwordx4 v[160:163], v4, s[8:11], s23 offen offset:0 sc1
    s_waitcnt lgkmcnt(6)
    v_mfma_f32_16x16x32_bf16 v[20:23], v[92:95], v[196:199], v[20:23]
    ds_read_b64_tr_b16 v[84:85], v15 offset:8704
    v_mfma_f32_16x16x32_bf16 v[24:27], v[92:95], v[200:203], v[24:27]
    ds_read_b64_tr_b16 v[86:87], v15 offset:12800
    s_waitcnt lgkmcnt(6)
    v_mfma_f32_16x16x32_bf16 v[28:31], v[96:99], v[196:199], v[28:31]
    ds_read_b64_tr_b16 v[88:89], v16 offset:8736
    v_mfma_f32_16x16x32_bf16 v[32:35], v[96:99], v[200:203], v[32:35]
    ds_read_b64_tr_b16 v[90:91], v16 offset:12832
    s_waitcnt lgkmcnt(6)
    v_mfma_f32_16x16x32_bf16 v[36:39], v[100:103], v[196:199], v[36:39]
    ds_read_b64_tr_b16 v[92:93], v15 offset:8960
    v_mfma_f32_16x16x32_bf16 v[40:43], v[100:103], v[200:203], v[40:43]
    ds_read_b64_tr_b16 v[94:95], v15 offset:13056
    s_waitcnt lgkmcnt(6)
    v_mfma_f32_16x16x32_bf16 v[44:47], v[104:107], v[196:199], v[44:47]
    ds_read_b64_tr_b16 v[96:97], v16 offset:8992
    v_mfma_f32_16x16x32_bf16 v[48:51], v[104:107], v[200:203], v[48:51]
    ds_read_b64_tr_b16 v[98:99], v16 offset:13088
    s_add_u32 s23, s21, 0x1000800
    buffer_load_dwordx4 v[164:167], v4, s[8:11], s23 offen offset:1024 sc1
    s_waitcnt lgkmcnt(6)
    v_mfma_f32_16x16x32_bf16 v[52:55], v[84:87], v[196:199], v[52:55]
    ds_read_b64_tr_b16 v[100:101], v15 offset:16384
    v_mfma_f32_16x16x32_bf16 v[56:59], v[84:87], v[200:203], v[56:59]
    ds_read_b64_tr_b16 v[102:103], v15 offset:20480
    s_waitcnt lgkmcnt(6)
    v_mfma_f32_16x16x32_bf16 v[60:63], v[88:91], v[196:199], v[60:63]
    ds_read_b64_tr_b16 v[104:105], v16 offset:16416
    v_mfma_f32_16x16x32_bf16 v[64:67], v[88:91], v[200:203], v[64:67]
    ds_read_b64_tr_b16 v[106:107], v16 offset:20512
    s_waitcnt lgkmcnt(6)
    v_mfma_f32_16x16x32_bf16 v[68:71], v[92:95], v[196:199], v[68:71]
    ds_read_b64_tr_b16 v[84:85], v15 offset:24576
    v_mfma_f32_16x16x32_bf16 v[72:75], v[92:95], v[200:203], v[72:75]
    ds_read_b64_tr_b16 v[86:87], v15 offset:28672
    s_waitcnt lgkmcnt(6)
    v_mfma_f32_16x16x32_bf16 v[76:79], v[96:99], v[196:199], v[76:79]
    ds_read_b64_tr_b16 v[88:89], v16 offset:24608
    v_mfma_f32_16x16x32_bf16 v[80:83], v[96:99], v[200:203], v[80:83]
    ds_read_b64_tr_b16 v[90:91], v16 offset:28704
    s_add_u32 s23, s21, 0x1020800
    buffer_load_dwordx4 v[168:171], v4, s[8:11], s23 offen offset:1024 sc1
    s_waitcnt lgkmcnt(6)
    v_mfma_f32_16x16x32_bf16 v[20:23], v[100:103], v[108:111], v[20:23]
    ds_read_b64_tr_b16 v[92:93], v15 offset:32768
    v_mfma_f32_16x16x32_bf16 v[24:27], v[100:103], v[112:115], v[24:27]
    ds_read_b64_tr_b16 v[94:95], v15 offset:36864
    s_waitcnt lgkmcnt(6)
    v_mfma_f32_16x16x32_bf16 v[28:31], v[104:107], v[108:111], v[28:31]
    ds_read_b64_tr_b16 v[96:97], v16 offset:32800
    v_mfma_f32_16x16x32_bf16 v[32:35], v[104:107], v[112:115], v[32:35]
    ds_read_b64_tr_b16 v[98:99], v16 offset:36896
    s_waitcnt vmcnt(9) lgkmcnt(6)
    v_mfma_f32_16x16x32_bf16 v[20:23], v[84:87], v[116:119], v[20:23]
    ds_read_b64_tr_b16 v[100:101], v15 offset:40960
    s_waitcnt vmcnt(8)
    v_mfma_f32_16x16x32_bf16 v[24:27], v[84:87], v[120:123], v[24:27]
    ds_read_b64_tr_b16 v[102:103], v15 offset:45056
    s_waitcnt lgkmcnt(6)
    v_mfma_f32_16x16x32_bf16 v[28:31], v[88:91], v[116:119], v[28:31]
    ds_read_b64_tr_b16 v[104:105], v16 offset:40992
    v_mfma_f32_16x16x32_bf16 v[32:35], v[88:91], v[120:123], v[32:35]
    ds_read_b64_tr_b16 v[106:107], v16 offset:45088
    s_waitcnt vmcnt(7) lgkmcnt(6)
    v_mfma_f32_16x16x32_bf16 v[20:23], v[92:95], v[140:143], v[20:23]
    ds_read_b64_tr_b16 v[84:85], v15 offset:49152
    s_waitcnt vmcnt(6)
    v_mfma_f32_16x16x32_bf16 v[24:27], v[92:95], v[144:147], v[24:27]
    ds_read_b64_tr_b16 v[86:87], v15 offset:53248
    s_waitcnt lgkmcnt(6)
    v_mfma_f32_16x16x32_bf16 v[28:31], v[96:99], v[140:143], v[28:31]
    ds_read_b64_tr_b16 v[88:89], v16 offset:49184
    v_mfma_f32_16x16x32_bf16 v[32:35], v[96:99], v[144:147], v[32:35]
    ds_read_b64_tr_b16 v[90:91], v16 offset:53280
    s_waitcnt vmcnt(5) lgkmcnt(6)
    v_mfma_f32_16x16x32_bf16 v[20:23], v[100:103], v[148:151], v[20:23]
    ds_read_b64_tr_b16 v[92:93], v15 offset:57344
    s_waitcnt vmcnt(4)
    v_mfma_f32_16x16x32_bf16 v[24:27], v[100:103], v[152:155], v[24:27]
    ds_read_b64_tr_b16 v[94:95], v15 offset:61440
    s_waitcnt lgkmcnt(6)
    v_mfma_f32_16x16x32_bf16 v[28:31], v[104:107], v[148:151], v[28:31]
    ds_read_b64_tr_b16 v[96:97], v16 offset:57376
    v_mfma_f32_16x16x32_bf16 v[32:35], v[104:107], v[152:155], v[32:35]
    ds_read_b64_tr_b16 v[98:99], v16 offset:61472
    s_waitcnt vmcnt(3) lgkmcnt(6)
    v_mfma_f32_16x16x32_bf16 v[20:23], v[84:87], v[156:159], v[20:23]
    ds_read_b64_tr_b16 v[100:101], v15 offset:16640
    s_waitcnt vmcnt(2)
    v_mfma_f32_16x16x32_bf16 v[24:27], v[84:87], v[160:163], v[24:27]
    ds_read_b64_tr_b16 v[102:103], v15 offset:20736
    s_waitcnt lgkmcnt(6)
    v_mfma_f32_16x16x32_bf16 v[28:31], v[88:91], v[156:159], v[28:31]
    ds_read_b64_tr_b16 v[104:105], v16 offset:16672
    v_mfma_f32_16x16x32_bf16 v[32:35], v[88:91], v[160:163], v[32:35]
    ds_read_b64_tr_b16 v[106:107], v16 offset:20768
    s_waitcnt vmcnt(1) lgkmcnt(6)
    v_mfma_f32_16x16x32_bf16 v[20:23], v[92:95], v[164:167], v[20:23]
    ds_read_b64_tr_b16 v[84:85], v15 offset:24832
    s_waitcnt vmcnt(0)
    v_mfma_f32_16x16x32_bf16 v[24:27], v[92:95], v[168:171], v[24:27]
    ds_read_b64_tr_b16 v[86:87], v15 offset:28928
    s_waitcnt lgkmcnt(6)
    v_mfma_f32_16x16x32_bf16 v[28:31], v[96:99], v[164:167], v[28:31]
    ds_read_b64_tr_b16 v[88:89], v16 offset:24864
    v_mfma_f32_16x16x32_bf16 v[32:35], v[96:99], v[168:171], v[32:35]
    ds_read_b64_tr_b16 v[90:91], v16 offset:28960
    ds_read_b128 v[124:127], v13 offset:0
    ds_read_b128 v[128:131], v13 offset:64
    s_waitcnt lgkmcnt(8)
    v_mfma_f32_16x16x32_bf16 v[36:39], v[100:103], v[108:111], v[36:39]
    ds_read_b64_tr_b16 v[92:93], v15 offset:33024
    v_mfma_f32_16x16x32_bf16 v[40:43], v[100:103], v[112:115], v[40:43]
    ds_read_b64_tr_b16 v[94:95], v15 offset:37120
    s_waitcnt lgkmcnt(8)
    v_mfma_f32_16x16x32_bf16 v[44:47], v[104:107], v[108:111], v[44:47]
    ds_read_b64_tr_b16 v[96:97], v16 offset:33056
    v_mfma_f32_16x16x32_bf16 v[48:51], v[104:107], v[112:115], v[48:51]
    ds_read_b64_tr_b16 v[98:99], v16 offset:37152
    s_waitcnt lgkmcnt(8)
    v_mfma_f32_16x16x32_bf16 v[36:39], v[84:87], v[116:119], v[36:39]
    s_waitcnt lgkmcnt(5)
    v_pk_mul_f32 v[132:133], v[20:21], v[124:125]
    v_pk_mul_f32 v[134:135], v[22:23], v[126:127]
    ds_read_b64_tr_b16 v[100:101], v15 offset:41216
    v_mfma_f32_16x16x32_bf16 v[40:43], v[84:87], v[120:123], v[40:43]
    s_waitcnt lgkmcnt(5)
    v_pk_mul_f32 v[136:137], v[28:29], v[128:129]
    ds_read_b64_tr_b16 v[102:103], v15 offset:45312
    v_mfma_f32_16x16x32_bf16 v[44:47], v[88:91], v[116:119], v[44:47]
    v_pk_mul_f32 v[138:139], v[30:31], v[130:131]
    v_cvt_pk_bf16_f32 v132, v132, v133
    ds_read_b64_tr_b16 v[104:105], v16 offset:41248
    v_mfma_f32_16x16x32_bf16 v[48:51], v[88:91], v[120:123], v[48:51]
    v_cvt_pk_bf16_f32 v133, v134, v135
    ds_read_b64_tr_b16 v[106:107], v16 offset:45344
    s_waitcnt lgkmcnt(6)
    v_mfma_f32_16x16x32_bf16 v[36:39], v[92:95], v[140:143], v[36:39]
    v_cvt_pk_bf16_f32 v134, v136, v137
    v_cvt_pk_bf16_f32 v135, v138, v139
    ds_read_b64_tr_b16 v[84:85], v15 offset:49408
    v_mfma_f32_16x16x32_bf16 v[40:43], v[92:95], v[144:147], v[40:43]
    v_permlane32_swap_b32 v132, v134
    ds_read_b64_tr_b16 v[86:87], v15 offset:53504
    s_waitcnt lgkmcnt(6)
    v_mfma_f32_16x16x32_bf16 v[44:47], v[96:99], v[140:143], v[44:47]
    v_permlane32_swap_b32 v133, v135
    v_permlane16_swap_b32 v132, v134
    ds_read_b64_tr_b16 v[88:89], v16 offset:49440
    v_mfma_f32_16x16x32_bf16 v[48:51], v[96:99], v[144:147], v[48:51]
    v_permlane16_swap_b32 v133, v135
    ds_read_b64_tr_b16 v[90:91], v16 offset:53536
    s_waitcnt lgkmcnt(6)
    v_mfma_f32_16x16x32_bf16 v[36:39], v[100:103], v[148:151], v[36:39]
    buffer_store_dwordx4 v[132:135], v14, s[8:11], s18 offen offset:0 sc1
    ds_read_b64_tr_b16 v[92:93], v15 offset:57600
    v_mfma_f32_16x16x32_bf16 v[40:43], v[100:103], v[152:155], v[40:43]
    v_pk_mul_f32 v[132:133], v[24:25], v[124:125]
    v_pk_mul_f32 v[134:135], v[26:27], v[126:127]
    ds_read_b64_tr_b16 v[94:95], v15 offset:61696
    s_waitcnt lgkmcnt(6)
    v_mfma_f32_16x16x32_bf16 v[44:47], v[104:107], v[148:151], v[44:47]
    v_pk_mul_f32 v[136:137], v[32:33], v[128:129]
    ds_read_b64_tr_b16 v[96:97], v16 offset:57632
    v_mfma_f32_16x16x32_bf16 v[48:51], v[104:107], v[152:155], v[48:51]
    v_pk_mul_f32 v[138:139], v[34:35], v[130:131]
    v_cvt_pk_bf16_f32 v132, v132, v133
    ds_read_b64_tr_b16 v[98:99], v16 offset:61728
    s_waitcnt lgkmcnt(6)
    v_mfma_f32_16x16x32_bf16 v[36:39], v[84:87], v[156:159], v[36:39]
    v_cvt_pk_bf16_f32 v133, v134, v135
    ds_read_b64_tr_b16 v[100:101], v15 offset:16896
    v_mfma_f32_16x16x32_bf16 v[40:43], v[84:87], v[160:163], v[40:43]
    v_cvt_pk_bf16_f32 v134, v136, v137
    v_cvt_pk_bf16_f32 v135, v138, v139
    ds_read_b64_tr_b16 v[102:103], v15 offset:20992
    s_waitcnt lgkmcnt(6)
    v_mfma_f32_16x16x32_bf16 v[44:47], v[88:91], v[156:159], v[44:47]
    v_permlane32_swap_b32 v132, v134
    ds_read_b64_tr_b16 v[104:105], v16 offset:16928
    v_mfma_f32_16x16x32_bf16 v[48:51], v[88:91], v[160:163], v[48:51]
    v_permlane32_swap_b32 v133, v135
    v_permlane16_swap_b32 v132, v134
    ds_read_b64_tr_b16 v[106:107], v16 offset:21024
    s_waitcnt lgkmcnt(6)
    v_mfma_f32_16x16x32_bf16 v[36:39], v[92:95], v[164:167], v[36:39]
    v_permlane16_swap_b32 v133, v135
    ds_read_b64_tr_b16 v[84:85], v15 offset:25088
    v_mfma_f32_16x16x32_bf16 v[40:43], v[92:95], v[168:171], v[40:43]
    buffer_store_dwordx4 v[132:135], v14, s[8:11], s19 offen offset:0 sc1
    ds_read_b64_tr_b16 v[86:87], v15 offset:29184
    s_waitcnt lgkmcnt(6)
    v_mfma_f32_16x16x32_bf16 v[44:47], v[96:99], v[164:167], v[44:47]
    ds_read_b64_tr_b16 v[88:89], v16 offset:25120
    v_mfma_f32_16x16x32_bf16 v[48:51], v[96:99], v[168:171], v[48:51]
    ds_read_b64_tr_b16 v[90:91], v16 offset:29216
    ds_read_b128 v[124:127], v13 offset:128
    ds_read_b128 v[128:131], v13 offset:192
    s_waitcnt lgkmcnt(8)
    v_mfma_f32_16x16x32_bf16 v[52:55], v[100:103], v[108:111], v[52:55]
    ds_read_b64_tr_b16 v[92:93], v15 offset:33280
    v_mfma_f32_16x16x32_bf16 v[56:59], v[100:103], v[112:115], v[56:59]
    ds_read_b64_tr_b16 v[94:95], v15 offset:37376
    s_waitcnt lgkmcnt(8)
    v_mfma_f32_16x16x32_bf16 v[60:63], v[104:107], v[108:111], v[60:63]
    ds_read_b64_tr_b16 v[96:97], v16 offset:33312
    v_mfma_f32_16x16x32_bf16 v[64:67], v[104:107], v[112:115], v[64:67]
    ds_read_b64_tr_b16 v[98:99], v16 offset:37408
    s_waitcnt lgkmcnt(8)
    v_mfma_f32_16x16x32_bf16 v[52:55], v[84:87], v[116:119], v[52:55]
    s_waitcnt lgkmcnt(5)
    v_pk_mul_f32 v[132:133], v[36:37], v[124:125]
    v_pk_mul_f32 v[134:135], v[38:39], v[126:127]
    ds_read_b64_tr_b16 v[100:101], v15 offset:41472
    v_mfma_f32_16x16x32_bf16 v[56:59], v[84:87], v[120:123], v[56:59]
    s_waitcnt lgkmcnt(5)
    v_pk_mul_f32 v[136:137], v[44:45], v[128:129]
    ds_read_b64_tr_b16 v[102:103], v15 offset:45568
    v_mfma_f32_16x16x32_bf16 v[60:63], v[88:91], v[116:119], v[60:63]
    v_pk_mul_f32 v[138:139], v[46:47], v[130:131]
    v_cvt_pk_bf16_f32 v132, v132, v133
    ds_read_b64_tr_b16 v[104:105], v16 offset:41504
    v_mfma_f32_16x16x32_bf16 v[64:67], v[88:91], v[120:123], v[64:67]
    v_cvt_pk_bf16_f32 v133, v134, v135
    ds_read_b64_tr_b16 v[106:107], v16 offset:45600
    s_waitcnt lgkmcnt(6)
    v_mfma_f32_16x16x32_bf16 v[52:55], v[92:95], v[140:143], v[52:55]
    v_cvt_pk_bf16_f32 v134, v136, v137
    v_cvt_pk_bf16_f32 v135, v138, v139
    ds_read_b64_tr_b16 v[84:85], v15 offset:49664
    v_mfma_f32_16x16x32_bf16 v[56:59], v[92:95], v[144:147], v[56:59]
    v_permlane32_swap_b32 v132, v134
    ds_read_b64_tr_b16 v[86:87], v15 offset:53760
    s_waitcnt lgkmcnt(6)
    v_mfma_f32_16x16x32_bf16 v[60:63], v[96:99], v[140:143], v[60:63]
    v_permlane32_swap_b32 v133, v135
    v_permlane16_swap_b32 v132, v134
    ds_read_b64_tr_b16 v[88:89], v16 offset:49696
    v_mfma_f32_16x16x32_bf16 v[64:67], v[96:99], v[144:147], v[64:67]
    v_permlane16_swap_b32 v133, v135
    ds_read_b64_tr_b16 v[90:91], v16 offset:53792
    s_waitcnt lgkmcnt(6)
    v_mfma_f32_16x16x32_bf16 v[52:55], v[100:103], v[148:151], v[52:55]
    buffer_store_dwordx4 v[132:135], v14, s[8:11], s18 offen offset:1024 sc1
    ds_read_b64_tr_b16 v[92:93], v15 offset:57856
    v_mfma_f32_16x16x32_bf16 v[56:59], v[100:103], v[152:155], v[56:59]
    v_pk_mul_f32 v[132:133], v[40:41], v[124:125]
    v_pk_mul_f32 v[134:135], v[42:43], v[126:127]
    ds_read_b64_tr_b16 v[94:95], v15 offset:61952
    s_waitcnt lgkmcnt(6)
    v_mfma_f32_16x16x32_bf16 v[60:63], v[104:107], v[148:151], v[60:63]
    v_pk_mul_f32 v[136:137], v[48:49], v[128:129]
    ds_read_b64_tr_b16 v[96:97], v16 offset:57888
    v_mfma_f32_16x16x32_bf16 v[64:67], v[104:107], v[152:155], v[64:67]
    v_pk_mul_f32 v[138:139], v[50:51], v[130:131]
    v_cvt_pk_bf16_f32 v132, v132, v133
    ds_read_b64_tr_b16 v[98:99], v16 offset:61984
    s_waitcnt lgkmcnt(6)
    v_mfma_f32_16x16x32_bf16 v[52:55], v[84:87], v[156:159], v[52:55]
    v_cvt_pk_bf16_f32 v133, v134, v135
    ds_read_b64_tr_b16 v[100:101], v15 offset:17152
    v_mfma_f32_16x16x32_bf16 v[56:59], v[84:87], v[160:163], v[56:59]
    v_cvt_pk_bf16_f32 v134, v136, v137
    v_cvt_pk_bf16_f32 v135, v138, v139
    ds_read_b64_tr_b16 v[102:103], v15 offset:21248
    s_waitcnt lgkmcnt(6)
    v_mfma_f32_16x16x32_bf16 v[60:63], v[88:91], v[156:159], v[60:63]
    v_permlane32_swap_b32 v132, v134
    ds_read_b64_tr_b16 v[104:105], v16 offset:17184
    v_mfma_f32_16x16x32_bf16 v[64:67], v[88:91], v[160:163], v[64:67]
    v_permlane32_swap_b32 v133, v135
    v_permlane16_swap_b32 v132, v134
    ds_read_b64_tr_b16 v[106:107], v16 offset:21280
    s_waitcnt lgkmcnt(6)
    v_mfma_f32_16x16x32_bf16 v[52:55], v[92:95], v[164:167], v[52:55]
    v_permlane16_swap_b32 v133, v135
    ds_read_b64_tr_b16 v[84:85], v15 offset:25344
    v_mfma_f32_16x16x32_bf16 v[56:59], v[92:95], v[168:171], v[56:59]
    buffer_store_dwordx4 v[132:135], v14, s[8:11], s19 offen offset:1024 sc1
    ds_read_b64_tr_b16 v[86:87], v15 offset:29440
    s_waitcnt lgkmcnt(6)
    v_mfma_f32_16x16x32_bf16 v[60:63], v[96:99], v[164:167], v[60:63]
    ds_read_b64_tr_b16 v[88:89], v16 offset:25376
    v_mfma_f32_16x16x32_bf16 v[64:67], v[96:99], v[168:171], v[64:67]
    ds_read_b64_tr_b16 v[90:91], v16 offset:29472
    ds_read_b128 v[124:127], v13 offset:256
    ds_read_b128 v[128:131], v13 offset:320
    s_waitcnt lgkmcnt(8)
    v_mfma_f32_16x16x32_bf16 v[68:71], v[100:103], v[108:111], v[68:71]
    ds_read_b64_tr_b16 v[92:93], v15 offset:33536
    v_mfma_f32_16x16x32_bf16 v[72:75], v[100:103], v[112:115], v[72:75]
    ds_read_b64_tr_b16 v[94:95], v15 offset:37632
    s_waitcnt lgkmcnt(8)
    v_mfma_f32_16x16x32_bf16 v[76:79], v[104:107], v[108:111], v[76:79]
    ds_read_b64_tr_b16 v[96:97], v16 offset:33568
    v_mfma_f32_16x16x32_bf16 v[80:83], v[104:107], v[112:115], v[80:83]
    ds_read_b64_tr_b16 v[98:99], v16 offset:37664
    s_waitcnt lgkmcnt(8)
    v_mfma_f32_16x16x32_bf16 v[68:71], v[84:87], v[116:119], v[68:71]
    s_waitcnt lgkmcnt(5)
    v_pk_mul_f32 v[132:133], v[52:53], v[124:125]
    v_pk_mul_f32 v[134:135], v[54:55], v[126:127]
    ds_read_b64_tr_b16 v[100:101], v15 offset:41728
    v_mfma_f32_16x16x32_bf16 v[72:75], v[84:87], v[120:123], v[72:75]
    s_waitcnt lgkmcnt(5)
    v_pk_mul_f32 v[136:137], v[60:61], v[128:129]
    ds_read_b64_tr_b16 v[102:103], v15 offset:45824
    v_mfma_f32_16x16x32_bf16 v[76:79], v[88:91], v[116:119], v[76:79]
    v_pk_mul_f32 v[138:139], v[62:63], v[130:131]
    v_cvt_pk_bf16_f32 v132, v132, v133
    ds_read_b64_tr_b16 v[104:105], v16 offset:41760
    v_mfma_f32_16x16x32_bf16 v[80:83], v[88:91], v[120:123], v[80:83]
    v_cvt_pk_bf16_f32 v133, v134, v135
    ds_read_b64_tr_b16 v[106:107], v16 offset:45856
    s_waitcnt lgkmcnt(6)
    v_mfma_f32_16x16x32_bf16 v[68:71], v[92:95], v[140:143], v[68:71]
    v_cvt_pk_bf16_f32 v134, v136, v137
    v_cvt_pk_bf16_f32 v135, v138, v139
    ds_read_b64_tr_b16 v[84:85], v15 offset:49920
    v_mfma_f32_16x16x32_bf16 v[72:75], v[92:95], v[144:147], v[72:75]
    v_permlane32_swap_b32 v132, v134
    ds_read_b64_tr_b16 v[86:87], v15 offset:54016
    s_waitcnt lgkmcnt(6)
    v_mfma_f32_16x16x32_bf16 v[76:79], v[96:99], v[140:143], v[76:79]
    v_permlane32_swap_b32 v133, v135
    v_permlane16_swap_b32 v132, v134
    ds_read_b64_tr_b16 v[88:89], v16 offset:49952
    v_mfma_f32_16x16x32_bf16 v[80:83], v[96:99], v[144:147], v[80:83]
    v_permlane16_swap_b32 v133, v135
    ds_read_b64_tr_b16 v[90:91], v16 offset:54048
    s_waitcnt lgkmcnt(6)
    v_mfma_f32_16x16x32_bf16 v[68:71], v[100:103], v[148:151], v[68:71]
    buffer_store_dwordx4 v[132:135], v14, s[8:11], s18 offen offset:2048 sc1
    ds_read_b64_tr_b16 v[92:93], v15 offset:58112
    v_mfma_f32_16x16x32_bf16 v[72:75], v[100:103], v[152:155], v[72:75]
    v_pk_mul_f32 v[132:133], v[56:57], v[124:125]
    v_pk_mul_f32 v[134:135], v[58:59], v[126:127]
    ds_read_b64_tr_b16 v[94:95], v15 offset:62208
    s_waitcnt lgkmcnt(6)
    v_mfma_f32_16x16x32_bf16 v[76:79], v[104:107], v[148:151], v[76:79]
    v_pk_mul_f32 v[136:137], v[64:65], v[128:129]
    ds_read_b64_tr_b16 v[96:97], v16 offset:58144
    v_mfma_f32_16x16x32_bf16 v[80:83], v[104:107], v[152:155], v[80:83]
    v_pk_mul_f32 v[138:139], v[66:67], v[130:131]
    v_cvt_pk_bf16_f32 v132, v132, v133
    ds_read_b64_tr_b16 v[98:99], v16 offset:62240
    s_waitcnt lgkmcnt(6)
    v_mfma_f32_16x16x32_bf16 v[68:71], v[84:87], v[156:159], v[68:71]
    v_cvt_pk_bf16_f32 v133, v134, v135
    v_mfma_f32_16x16x32_bf16 v[72:75], v[84:87], v[160:163], v[72:75]
    v_cvt_pk_bf16_f32 v134, v136, v137
    v_cvt_pk_bf16_f32 v135, v138, v139
    s_waitcnt lgkmcnt(4)
    v_mfma_f32_16x16x32_bf16 v[76:79], v[88:91], v[156:159], v[76:79]
    v_permlane32_swap_b32 v132, v134
    v_mfma_f32_16x16x32_bf16 v[80:83], v[88:91], v[160:163], v[80:83]
    v_permlane32_swap_b32 v133, v135
    v_permlane16_swap_b32 v132, v134
    s_waitcnt lgkmcnt(2)
    v_mfma_f32_16x16x32_bf16 v[68:71], v[92:95], v[164:167], v[68:71]
    v_permlane16_swap_b32 v133, v135
    v_mfma_f32_16x16x32_bf16 v[72:75], v[92:95], v[168:171], v[72:75]
    buffer_store_dwordx4 v[132:135], v14, s[8:11], s19 offen offset:2048 sc1
    s_waitcnt lgkmcnt(0)
    v_mfma_f32_16x16x32_bf16 v[76:79], v[96:99], v[164:167], v[76:79]
    v_mfma_f32_16x16x32_bf16 v[80:83], v[96:99], v[168:171], v[80:83]
    ds_read_b128 v[124:127], v13 offset:384
    ds_read_b128 v[128:131], v13 offset:448
    s_waitcnt lgkmcnt(1)
    v_pk_mul_f32 v[132:133], v[68:69], v[124:125]
    v_pk_mul_f32 v[134:135], v[70:71], v[126:127]
    s_waitcnt lgkmcnt(0)
    s_nop 0
    v_pk_mul_f32 v[136:137], v[76:77], v[128:129]
    v_pk_mul_f32 v[138:139], v[78:79], v[130:131]
    v_cvt_pk_bf16_f32 v132, v132, v133
    v_cvt_pk_bf16_f32 v133, v134, v135
    v_cvt_pk_bf16_f32 v134, v136, v137
    v_cvt_pk_bf16_f32 v135, v138, v139
    s_nop 0
    v_permlane32_swap_b32 v132, v134
    v_permlane32_swap_b32 v133, v135
    s_nop 0
    v_permlane16_swap_b32 v132, v134
    v_permlane16_swap_b32 v133, v135
    buffer_store_dwordx4 v[132:135], v14, s[8:11], s18 offen offset:3072 sc1
    s_nop 1
    v_pk_mul_f32 v[132:133], v[72:73], v[124:125]
    v_pk_mul_f32 v[134:135], v[74:75], v[126:127]
    v_pk_mul_f32 v[136:137], v[80:81], v[128:129]
    v_pk_mul_f32 v[138:139], v[82:83], v[130:131]
    v_cvt_pk_bf16_f32 v132, v132, v133
    v_cvt_pk_bf16_f32 v133, v134, v135
    v_cvt_pk_bf16_f32 v134, v136, v137
    v_cvt_pk_bf16_f32 v135, v138, v139
    s_nop 0
    v_permlane32_swap_b32 v132, v134
    v_permlane32_swap_b32 v133, v135
    s_nop 0
    v_permlane16_swap_b32 v132, v134
    v_permlane16_swap_b32 v133, v135
    buffer_store_dwordx4 v[132:135], v14, s[8:11], s19 offen offset:3072 sc1
    s_branch fz_p3e
fz_p3B:
    v_bfe_u32 v9, v0, 2, 2
    v_lshrrev_b32 v10, 4, v0
    v_and_b32 v11, 3, v0
    v_lshlrev_b32 v3, 10, v10
    v_lshl_add_u32 v3, v9, 6, v3
    v_lshl_add_u32 v3, v11, 3, v3
    v_bfe_u32 v12, v0, 4, 1
    v_lshlrev_b32 v12, 5, v12
    v_sub_u32 v2, v3, v12
    v_add_u32 v3, v3, v12
    s_lshl_b32 s19, s13, 3
    s_add_u32 s19, s19, s3
    s_mul_i32 s19, s19, 262144
    v_add_u32 v4, s19, v1
    s_and_b32 s62, s12, 24
    s_and_b32 s19, s12, 7
    s_lshl_b32 s20, s19, 2
    s_lshr_b32 s20, 0x54732160, s20
    s_and_b32 s20, s20, 7
    s_lshl_b32 s20, s20, 2
    s_bfm_b32 s21, s20, 0
    s_and_b32 s22, s21, 0x51764320
    s_lshl_b32 s22, s22, 4
    s_lshl_b32 s21, s21, 4
    s_or_b32 s21, s21, 15
    s_andn2_b32 s21, 0x51764320, s21
    s_or_b32 s42, s21, s22
    s_or_b32 s42, s42, s19
    s_bfe_u32 s96, s2, 0x10002
    s_mul_i32 s96, s96, 28
    s_lshr_b32 s26, s2, 3
    s_add_u32 s96, s96, s26
    s_and_b32 s97, s2, 1
    s_bfe_u32 s98, s2, 0x10001
    s_bfe_u32 s99, s2, 0x40003
    s_and_b32 s100, s2, 7
    s_lshl_b32 s100, s100, 1
    s_lshr_b32 s26, s2, 7
    s_add_u32 s100, s100, s26
    v_lshrrev_b32 v9, 4, v0
    v_lshlrev_b32 v13, 4, v9
    s_add_u32 s19, s12, 1
    s_and_b32 s19, s19, 7
    s_lshl_b32 s26, s19, 9
    s_add_u32 s26, s26, 0x22000
    v_add_u32 v13, s26, v13
    v_and_b32 v14, 15, v0
    v_lshlrev_b32 v14, 6, v14
    v_lshl_add_u32 v14, v9, 4, v14
    s_lshr_b32 s18, s12, 3
    s_lshl_b32 s18, s18, 22
    s_lshl_b32 s26, s13, 3
    s_add_u32 s26, s26, s3
    s_lshl_b32 s26, s26, 16
    s_add_u32 s18, s18, s26
    s_lshl_b32 s19, s19, 12
    s_add_u32 s18, s18, s19
    s_add_u32 s18, s18, 0x2000000
    s_add_u32 s19, s18, 0x8000
    v_add_u32 v15, 0x10000, v3
    v_add_u32 v16, 0x10000, v2
    s_lshl_b32 s26, s13, 3
    s_add_u32 s26, s26, s3
    s_lshl_b32 s26, s26, 2
    s_lshr_b32 s27, s12, 3
    s_add_u32 s26, s26, s27
    s_lshl_b32 s26, s26, 7
    s_add_u32 s20, s26, 0x540000
    s_and_b32 s27, s12, 7
    s_lshl_b32 s27, s27, 2
    s_add_u32 s26, s20, s27
    v_mov_b32 v9, s14
    v_mov_b32 v10, 0
    s_waitcnt vmcnt(0)
    s_mov_b64 exec, 1
    buffer_store_dword v9, v10, s[8:11], s26 offen sc1
    s_mov_b64 exec, -1
    s_waitcnt lgkmcnt(0)
    s_barrier
    ds_read_b64_tr_b16 v[84:85], v3 offset:0
    ds_read_b64_tr_b16 v[86:87], v3 offset:4096
    ds_read_b64_tr_b16 v[88:89], v2 offset:32
    ds_read_b64_tr_b16 v[90:91], v2 offset:4128
    ds_read_b64_tr_b16 v[92:93], v3 offset:256
    ds_read_b64_tr_b16 v[94:95], v3 offset:4352
    ds_read_b64_tr_b16 v[96:97], v2 offset:288
    ds_read_b64_tr_b16 v[98:99], v2 offset:4384
    s_waitcnt lgkmcnt(6)
    v_mfma_f32_16x16x32_bf16 v[20:23], v[84:87], v[108:111], 0
    ds_read_b64_tr_b16 v[100:101], v3 offset:512
    v_mfma_f32_16x16x32_bf16 v[24:27], v[84:87], v[124:127], 0
    ds_read_b64_tr_b16 v[102:103], v3 offset:4608
    s_waitcnt lgkmcnt(6)
    v_mfma_f32_16x16x32_bf16 v[28:31], v[88:91], v[108:111], 0
    ds_read_b64_tr_b16 v[104:105], v2 offset:544
    v_mfma_f32_16x16x32_bf16 v[32:35], v[88:91], v[124:127], 0
    ds_read_b64_tr_b16 v[106:107], v2 offset:4640
    s_waitcnt lgkmcnt(6)
    v_mfma_f32_16x16x32_bf16 v[36:39], v[92:95], v[108:111], 0
    ds_read_b64_tr_b16 v[84:85], v3 offset:768
    v_mfma_f32_16x16x32_bf16 v[40:43], v[92:95], v[124:127], 0
    ds_read_b64_tr_b16 v[86:87], v3 offset:4864
    s_waitcnt lgkmcnt(6)
    v_mfma_f32_16x16x32_bf16 v[44:47], v[96:99], v[108:111], 0
    ds_read_b64_tr_b16 v[88:89], v2 offset:800
    v_mfma_f32_16x16x32_bf16 v[48:51], v[96:99], v[124:127], 0
    ds_read_b64_tr_b16 v[90:91], v2 offset:4896
    s_waitcnt lgkmcnt(6)
    v_mfma_f32_16x16x32_bf16 v[52:55], v[100:103], v[108:111], 0
    ds_read_b64_tr_b16 v[92:93], v3 offset:8192
    v_mfma_f32_16x16x32_bf16 v[56:59], v[100:103], v[124:127], 0
    ds_read_b64_tr_b16 v[94:95], v3 offset:12288
    s_waitcnt lgkmcnt(6)
    v_mfma_f32_16x16x32_bf16 v[60:63], v[104:107], v[108:111], 0
    ds_read_b64_tr_b16 v[96:97], v2 offset:8224
    v_mfma_f32_16x16x32_bf16 v[64:67], v[104:107], v[124:127], 0
    ds_read_b64_tr_b16 v[98:99], v2 offset:12320
    s_waitcnt lgkmcnt(6)
    v_mfma_f32_16x16x32_bf16 v[68:71], v[84:87], v[108:111], 0
    ds_read_b64_tr_b16 v[100:101], v3 offset:8448
    v_mfma_f32_16x16x32_bf16 v[72:75], v[84:87], v[124:127], 0
    ds_read_b64_tr_b16 v[102:103], v3 offset:12544
    s_waitcnt lgkmcnt(6)
    v_mfma_f32_16x16x32_bf16 v[76:79], v[88:91], v[108:111], 0
    ds_read_b64_tr_b16 v[104:105], v2 offset:8480
    v_mfma_f32_16x16x32_bf16 v[80:83], v[88:91], v[124:127], 0
    ds_read_b64_tr_b16 v[106:107], v2 offset:12576
    s_waitcnt lgkmcnt(6)
    v_mfma_f32_16x16x32_bf16 v[20:23], v[92:95], v[112:115], v[20:23]
    ds_read_b64_tr_b16 v[84:85], v3 offset:8704
    v_mfma_f32_16x16x32_bf16 v[24:27], v[92:95], v[128:131], v[24:27]
    ds_read_b64_tr_b16 v[86:87], v3 offset:12800
    s_waitcnt lgkmcnt(6)
    v_mfma_f32_16x16x32_bf16 v[28:31], v[96:99], v[112:115], v[28:31]
    ds_read_b64_tr_b16 v[88:89], v2 offset:8736
    v_mfma_f32_16x16x32_bf16 v[32:35], v[96:99], v[128:131], v[32:35]
    ds_read_b64_tr_b16 v[90:91], v2 offset:12832
    s_waitcnt lgkmcnt(6)
    v_mfma_f32_16x16x32_bf16 v[36:39], v[100:103], v[112:115], v[36:39]
    ds_read_b64_tr_b16 v[92:93], v3 offset:8960
    v_mfma_f32_16x16x32_bf16 v[40:43], v[100:103], v[128:131], v[40:43]
    ds_read_b64_tr_b16 v[94:95], v3 offset:13056
    s_waitcnt lgkmcnt(6)
    v_mfma_f32_16x16x32_bf16 v[44:47], v[104:107], v[112:115], v[44:47]
    ds_read_b64_tr_b16 v[96:97], v2 offset:8992
    v_mfma_f32_16x16x32_bf16 v[48:51], v[104:107], v[128:131], v[48:51]
    ds_read_b64_tr_b16 v[98:99], v2 offset:13088
    s_waitcnt lgkmcnt(6)
    v_mfma_f32_16x16x32_bf16 v[52:55], v[84:87], v[112:115], v[52:55]
    v_mfma_f32_16x16x32_bf16 v[56:59], v[84:87], v[128:131], v[56:59]
    s_barrier
    ds_read_b64_tr_b16 v[100:101], v3 offset:16384
    ds_read_b64_tr_b16 v[102:103], v3 offset:20480
    s_waitcnt lgkmcnt(6)
    v_mfma_f32_16x16x32_bf16 v[60:63], v[88:91], v[112:115], v[60:63]
    ds_read_b64_tr_b16 v[104:105], v2 offset:16416
    v_mfma_f32_16x16x32_bf16 v[64:67], v[88:91], v[128:131], v[64:67]
    ds_read_b64_tr_b16 v[106:107], v2 offset:20512
    s_waitcnt lgkmcnt(6)
    v_mfma_f32_16x16x32_bf16 v[68:71], v[92:95], v[112:115], v[68:71]
    ds_read_b64_tr_b16 v[84:85], v3 offset:16640
    v_mfma_f32_16x16x32_bf16 v[72:75], v[92:95], v[128:131], v[72:75]
    ds_read_b64_tr_b16 v[86:87], v3 offset:20736
    s_waitcnt lgkmcnt(6)
    v_mfma_f32_16x16x32_bf16 v[76:79], v[96:99], v[112:115], v[76:79]
    ds_read_b64_tr_b16 v[88:89], v2 offset:16672
    v_mfma_f32_16x16x32_bf16 v[80:83], v[96:99], v[128:131], v[80:83]
    ds_read_b64_tr_b16 v[90:91], v2 offset:20768
    s_waitcnt lgkmcnt(6)
    v_mfma_f32_16x16x32_bf16 v[20:23], v[100:103], v[116:119], v[20:23]
    ds_read_b64_tr_b16 v[92:93], v3 offset:16896
    v_mfma_f32_16x16x32_bf16 v[24:27], v[100:103], v[132:135], v[24:27]
    ds_read_b64_tr_b16 v[94:95], v3 offset:20992
    s_waitcnt lgkmcnt(6)
    v_mfma_f32_16x16x32_bf16 v[28:31], v[104:107], v[116:119], v[28:31]
    ds_read_b64_tr_b16 v[96:97], v2 offset:16928
    v_mfma_f32_16x16x32_bf16 v[32:35], v[104:107], v[132:135], v[32:35]
    ds_read_b64_tr_b16 v[98:99], v2 offset:21024
    s_waitcnt lgkmcnt(6)
    v_mfma_f32_16x16x32_bf16 v[36:39], v[84:87], v[116:119], v[36:39]
    ds_read_b64_tr_b16 v[100:101], v3 offset:17152
    v_mfma_f32_16x16x32_bf16 v[40:43], v[84:87], v[132:135], v[40:43]
    ds_read_b64_tr_b16 v[102:103], v3 offset:21248
    s_waitcnt lgkmcnt(6)
    v_mfma_f32_16x16x32_bf16 v[44:47], v[88:91], v[116:119], v[44:47]
    ds_read_b64_tr_b16 v[104:105], v2 offset:17184
    v_mfma_f32_16x16x32_bf16 v[48:51], v[88:91], v[132:135], v[48:51]
    ds_read_b64_tr_b16 v[106:107], v2 offset:21280
    s_waitcnt lgkmcnt(6)
    v_mfma_f32_16x16x32_bf16 v[52:55], v[92:95], v[116:119], v[52:55]
    ds_read_b64_tr_b16 v[84:85], v3 offset:24576
    v_mfma_f32_16x16x32_bf16 v[56:59], v[92:95], v[132:135], v[56:59]
    ds_read_b64_tr_b16 v[86:87], v3 offset:28672
    s_waitcnt lgkmcnt(6)
    v_mfma_f32_16x16x32_bf16 v[60:63], v[96:99], v[116:119], v[60:63]
    ds_read_b64_tr_b16 v[88:89], v2 offset:24608
    v_mfma_f32_16x16x32_bf16 v[64:67], v[96:99], v[132:135], v[64:67]
    ds_read_b64_tr_b16 v[90:91], v2 offset:28704
    s_waitcnt lgkmcnt(6)
    v_mfma_f32_16x16x32_bf16 v[68:71], v[100:103], v[116:119], v[68:71]
    ds_read_b64_tr_b16 v[92:93], v3 offset:24832
    v_mfma_f32_16x16x32_bf16 v[72:75], v[100:103], v[132:135], v[72:75]
    ds_read_b64_tr_b16 v[94:95], v3 offset:28928
    s_waitcnt lgkmcnt(6)
    v_mfma_f32_16x16x32_bf16 v[76:79], v[104:107], v[116:119], v[76:79]
    ds_read_b64_tr_b16 v[96:97], v2 offset:24864
    v_mfma_f32_16x16x32_bf16 v[80:83], v[104:107], v[132:135], v[80:83]
    ds_read_b64_tr_b16 v[98:99], v2 offset:28960
    s_waitcnt lgkmcnt(6)
    v_mfma_f32_16x16x32_bf16 v[20:23], v[84:87], v[120:123], v[20:23]
    ds_read_b64_tr_b16 v[100:101], v3 offset:25088
    v_mfma_f32_16x16x32_bf16 v[24:27], v[84:87], v[136:139], v[24:27]
    ds_read_b64_tr_b16 v[102:103], v3 offset:29184
    s_waitcnt lgkmcnt(6)
    v_mfma_f32_16x16x32_bf16 v[28:31], v[88:91], v[120:123], v[28:31]
    ds_read_b64_tr_b16 v[104:105], v2 offset:25120
    v_mfma_f32_16x16x32_bf16 v[32:35], v[88:91], v[136:139], v[32:35]
    ds_read_b64_tr_b16 v[106:107], v2 offset:29216
    s_waitcnt lgkmcnt(6)
    v_mfma_f32_16x16x32_bf16 v[36:39], v[92:95], v[120:123], v[36:39]
    ds_read_b64_tr_b16 v[84:85], v3 offset:25344
    v_mfma_f32_16x16x32_bf16 v[40:43], v[92:95], v[136:139], v[40:43]
    ds_read_b64_tr_b16 v[86:87], v3 offset:29440
    s_waitcnt lgkmcnt(6)
    v_mfma_f32_16x16x32_bf16 v[44:47], v[96:99], v[120:123], v[44:47]
    ds_read_b64_tr_b16 v[88:89], v2 offset:25376
    v_mfma_f32_16x16x32_bf16 v[48:51], v[96:99], v[136:139], v[48:51]
    ds_read_b64_tr_b16 v[90:91], v2 offset:29472
    s_waitcnt lgkmcnt(6)
    v_mfma_f32_16x16x32_bf16 v[52:55], v[100:103], v[120:123], v[52:55]
    v_mfma_f32_16x16x32_bf16 v[56:59], v[100:103], v[136:139], v[56:59]
    s_barrier
    ds_read_b64_tr_b16 v[92:93], v3 offset:32768
    ds_read_b64_tr_b16 v[94:95], v3 offset:36864
    s_waitcnt lgkmcnt(6)
    v_mfma_f32_16x16x32_bf16 v[60:63], v[104:107], v[120:123], v[60:63]
    ds_read_b64_tr_b16 v[96:97], v2 offset:32800
    v_mfma_f32_16x16x32_bf16 v[64:67], v[104:107], v[136:139], v[64:67]
    ds_read_b64_tr_b16 v[98:99], v2 offset:36896
    s_waitcnt lgkmcnt(6)
    v_mfma_f32_16x16x32_bf16 v[68:71], v[84:87], v[120:123], v[68:71]
    ds_read_b64_tr_b16 v[100:101], v3 offset:33024
    v_mfma_f32_16x16x32_bf16 v[72:75], v[84:87], v[136:139], v[72:75]
    ds_read_b64_tr_b16 v[102:103], v3 offset:37120
    s_waitcnt lgkmcnt(6)
    v_mfma_f32_16x16x32_bf16 v[76:79], v[88:91], v[120:123], v[76:79]
    ds_read_b64_tr_b16 v[104:105], v2 offset:33056
    v_mfma_f32_16x16x32_bf16 v[80:83], v[88:91], v[136:139], v[80:83]
    ds_read_b64_tr_b16 v[106:107], v2 offset:37152
    v_and_b32 v9, 7, v0
    v_lshlrev_b32 v9, 2, v9
    s_mov_b32 s27, 0
fz_oBp:
    buffer_load_dword v10, v9, s[8:11], s20 offen sc1
    s_waitcnt vmcnt(0)
    v_cmp_ne_u32 vcc, s14, v10
    s_and_b32 vcc_lo, vcc_lo, 0xdd
    s_mov_b32 vcc_hi, 0
    s_add_u32 s27, s27, 1
    s_cmp_ge_u32 s27, 65536
    s_cbranch_scc1 fz_oBg
    s_cbranch_vccz fz_oBg
    s_sleep 1
    s_branch fz_oBp
fz_oBg:
    s_bfe_u32 s21, s42, 0x30004
    s_or_b32 s21, s21, s62
    s_lshl_b32 s21, s21, 12
    s_add_u32 s23, s21, 0x1000000
    buffer_load_dwordx4 v[140:143], v4, s[8:11], s23 offen offset:0 sc1
    s_add_u32 s23, s21, 0x1020000
    buffer_load_dwordx4 v[144:147], v4, s[8:11], s23 offen offset:0 sc1
    s_add_u32 s23, s21, 0x1000000
    buffer_load_dwordx4 v[148:151], v4, s[8:11], s23 offen offset:1024 sc1
    s_add_u32 s23, s21, 0x1020000
    buffer_load_dwordx4 v[152:155], v4, s[8:11], s23 offen offset:1024 sc1
    s_add_u32 s23, s21, 0x1000800
    buffer_load_dwordx4 v[156:159], v4, s[8:11], s23 offen offset:0 sc1
    s_add_u32 s23, s21, 0x1020800
    buffer_load_dwordx4 v[160:163], v4, s[8:11], s23 offen offset:0 sc1
    s_add_u32 s23, s21, 0x1000800
    buffer_load_dwordx4 v[164:167], v4, s[8:11], s23 offen offset:1024 sc1
    s_add_u32 s23, s21, 0x1020800
    buffer_load_dwordx4 v[168:171], v4, s[8:11], s23 offen offset:1024 sc1
    s_bfe_u32 s21, s42, 0x30008
    s_or_b32 s21, s21, s62
    s_lshl_b32 s21, s21, 12
    s_add_u32 s23, s21, 0x1000000
    buffer_load_dwordx4 v[188:191], v4, s[8:11], s23 offen offset:0 sc1
    s_add_u32 s23, s21, 0x1020000
    buffer_load_dwordx4 v[192:195], v4, s[8:11], s23 offen offset:0 sc1
    s_add_u32 s23, s21, 0x1000000
    buffer_load_dwordx4 v[196:199], v4, s[8:11], s23 offen offset:1024 sc1
    s_add_u32 s23, s21, 0x1020000
    buffer_load_dwordx4 v[200:203], v4, s[8:11], s23 offen offset:1024 sc1
    s_waitcnt vmcnt(11) lgkmcnt(6)
    v_mfma_f32_16x16x32_bf16 v[20:23], v[92:95], v[140:143], v[20:23]
    ds_read_b64_tr_b16 v[84:85], v3 offset:33280
    s_waitcnt vmcnt(10)
    v_mfma_f32_16x16x32_bf16 v[24:27], v[92:95], v[144:147], v[24:27]
    ds_read_b64_tr_b16 v[86:87], v3 offset:37376
    s_waitcnt lgkmcnt(6)
    v_mfma_f32_16x16x32_bf16 v[28:31], v[96:99], v[140:143], v[28:31]
    ds_read_b64_tr_b16 v[88:89], v2 offset:33312
    v_mfma_f32_16x16x32_bf16 v[32:35], v[96:99], v[144:147], v[32:35]
    ds_read_b64_tr_b16 v[90:91], v2 offset:37408
    s_add_u32 s23, s21, 0x1000800
    buffer_load_dwordx4 v[108:111], v4, s[8:11], s23 offen offset:0 sc1
    s_waitcnt lgkmcnt(6)
    v_mfma_f32_16x16x32_bf16 v[36:39], v[100:103], v[140:143], v[36:39]
    ds_read_b64_tr_b16 v[92:93], v3 offset:33536
    v_mfma_f32_16x16x32_bf16 v[40:43], v[100:103], v[144:147], v[40:43]
    ds_read_b64_tr_b16 v[94:95], v3 offset:37632
    s_waitcnt lgkmcnt(6)
    v_mfma_f32_16x16x32_bf16 v[44:47], v[104:107], v[140:143], v[44:47]
    ds_read_b64_tr_b16 v[96:97], v2 offset:33568
    v_mfma_f32_16x16x32_bf16 v[48:51], v[104:107], v[144:147], v[48:51]
    ds_read_b64_tr_b16 v[98:99], v2 offset:37664
    s_waitcnt lgkmcnt(6)
    v_mfma_f32_16x16x32_bf16 v[52:55], v[84:87], v[140:143], v[52:55]
    ds_read_b64_tr_b16 v[100:101], v3 offset:40960
    v_mfma_f32_16x16x32_bf16 v[56:59], v[84:87], v[144:147], v[56:59]
    ds_read_b64_tr_b16 v[102:103], v3 offset:45056
    s_waitcnt lgkmcnt(6)
    v_mfma_f32_16x16x32_bf16 v[60:63], v[88:91], v[140:143], v[60:63]
    ds_read_b64_tr_b16 v[104:105], v2 offset:40992
    v_mfma_f32_16x16x32_bf16 v[64:67], v[88:91], v[144:147], v[64:67]
    ds_read_b64_tr_b16 v[106:107], v2 offset:45088
    s_add_u32 s23, s21, 0x1020800
    buffer_load_dwordx4 v[112:115], v4, s[8:11], s23 offen offset:0 sc1
    s_waitcnt lgkmcnt(6)
    v_mfma_f32_16x16x32_bf16 v[68:71], v[92:95], v[140:143], v[68:71]
    ds_read_b64_tr_b16 v[84:85], v3 offset:41216
    v_mfma_f32_16x16x32_bf16 v[72:75], v[92:95], v[144:147], v[72:75]
    ds_read_b64_tr_b16 v[86:87], v3 offset:45312
    s_waitcnt lgkmcnt(6)
    v_mfma_f32_16x16x32_bf16 v[76:79], v[96:99], v[140:143], v[76:79]
    ds_read_b64_tr_b16 v[88:89], v2 offset:41248
    v_mfma_f32_16x16x32_bf16 v[80:83], v[96:99], v[144:147], v[80:83]
    ds_read_b64_tr_b16 v[90:91], v2 offset:45344
    s_waitcnt vmcnt(11) lgkmcnt(6)
    v_mfma_f32_16x16x32_bf16 v[20:23], v[100:103], v[148:151], v[20:23]
    ds_read_b64_tr_b16 v[92:93], v3 offset:41472
    s_waitcnt vmcnt(10)
    v_mfma_f32_16x16x32_bf16 v[24:27], v[100:103], v[152:155], v[24:27]
    ds_read_b64_tr_b16 v[94:95], v3 offset:45568
    s_waitcnt lgkmcnt(6)
    v_mfma_f32_16x16x32_bf16 v[28:31], v[104:107], v[148:151], v[28:31]
    ds_read_b64_tr_b16 v[96:97], v2 offset:41504
    v_mfma_f32_16x16x32_bf16 v[32:35], v[104:107], v[152:155], v[32:35]
    ds_read_b64_tr_b16 v[98:99], v2 offset:45600
    s_add_u32 s23, s21, 0x1000800
    buffer_load_dwordx4 v[116:119], v4, s[8:11], s23 offen offset:1024 sc1
    s_waitcnt lgkmcnt(6)
    v_mfma_f32_16x16x32_bf16 v[36:39], v[84:87], v[148:151], v[36:39]
    ds_read_b64_tr_b16 v[100:101], v3 offset:41728
    v_mfma_f32_16x16x32_bf16 v[40:43], v[84:87], v[152:155], v[40:43]
    ds_read_b64_tr_b16 v[102:103], v3 offset:45824
    s_waitcnt lgkmcnt(6)
    v_mfma_f32_16x16x32_bf16 v[44:47], v[88:91], v[148:151], v[44:47]
    ds_read_b64_tr_b16 v[104:105], v2 offset:41760
    v_mfma_f32_16x16x32_bf16 v[48:51], v[88:91], v[152:155], v[48:51]
    ds_read_b64_tr_b16 v[106:107], v2 offset:45856
    s_waitcnt lgkmcnt(6)
    v_mfma_f32_16x16x32_bf16 v[52:55], v[92:95], v[148:151], v[52:55]
    v_mfma_f32_16x16x32_bf16 v[56:59], v[92:95], v[152:155], v[56:59]
    s_barrier
    ds_read_b64_tr_b16 v[84:85], v3 offset:49152
    ds_read_b64_tr_b16 v[86:87], v3 offset:53248
    s_waitcnt lgkmcnt(6)
    v_mfma_f32_16x16x32_bf16 v[60:63], v[96:99], v[148:151], v[60:63]
    ds_read_b64_tr_b16 v[88:89], v2 offset:49184
    v_mfma_f32_16x16x32_bf16 v[64:67], v[96:99], v[152:155], v[64:67]
    ds_read_b64_tr_b16 v[90:91], v2 offset:53280
    s_add_u32 s23, s21, 0x1020800
    buffer_load_dwordx4 v[120:123], v4, s[8:11], s23 offen offset:1024 sc1
    s_waitcnt lgkmcnt(6)
    v_mfma_f32_16x16x32_bf16 v[68:71], v[100:103], v[148:151], v[68:71]
    ds_read_b64_tr_b16 v[92:93], v3 offset:49408
    v_mfma_f32_16x16x32_bf16 v[72:75], v[100:103], v[152:155], v[72:75]
    ds_read_b64_tr_b16 v[94:95], v3 offset:53504
    s_waitcnt lgkmcnt(6)
    v_mfma_f32_16x16x32_bf16 v[76:79], v[104:107], v[148:151], v[76:79]
    ds_read_b64_tr_b16 v[96:97], v2 offset:49440
    v_mfma_f32_16x16x32_bf16 v[80:83], v[104:107], v[152:155], v[80:83]
    ds_read_b64_tr_b16 v[98:99], v2 offset:53536
    s_waitcnt vmcnt(11) lgkmcnt(6)
    v_mfma_f32_16x16x32_bf16 v[20:23], v[84:87], v[156:159], v[20:23]
    ds_read_b64_tr_b16 v[100:101], v3 offset:49664
    s_waitcnt vmcnt(10)
    v_mfma_f32_16x16x32_bf16 v[24:27], v[84:87], v[160:163], v[24:27]
    ds_read_b64_tr_b16 v[102:103], v3 offset:53760
    s_waitcnt lgkmcnt(6)
    v_mfma_f32_16x16x32_bf16 v[28:31], v[88:91], v[156:159], v[28:31]
    ds_read_b64_tr_b16 v[104:105], v2 offset:49696
    v_mfma_f32_16x16x32_bf16 v[32:35], v[88:91], v[160:163], v[32:35]
    ds_read_b64_tr_b16 v[106:107], v2 offset:53792
    s_bfe_u32 s21, s42, 0x3000c
    s_or_b32 s21, s21, s62
    s_lshl_b32 s21, s21, 12
    s_add_u32 s23, s21, 0x1000000
    buffer_load_dwordx4 v[140:143], v4, s[8:11], s23 offen offset:0 sc1
    s_waitcnt lgkmcnt(6)
    v_mfma_f32_16x16x32_bf16 v[36:39], v[92:95], v[156:159], v[36:39]
    ds_read_b64_tr_b16 v[84:85], v3 offset:49920
    v_mfma_f32_16x16x32_bf16 v[40:43], v[92:95], v[160:163], v[40:43]
    ds_read_b64_tr_b16 v[86:87], v3 offset:54016
    s_waitcnt lgkmcnt(6)
    v_mfma_f32_16x16x32_bf16 v[44:47], v[96:99], v[156:159], v[44:47]
    ds_read_b64_tr_b16 v[88:89], v2 offset:49952
    v_mfma_f32_16x16x32_bf16 v[48:51], v[96:99], v[160:163], v[48:51]
    ds_read_b64_tr_b16 v[90:91], v2 offset:54048
    s_waitcnt lgkmcnt(6)
    v_mfma_f32_16x16x32_bf16 v[52:55], v[100:103], v[156:159], v[52:55]
    ds_read_b64_tr_b16 v[92:93], v3 offset:57344
    v_mfma_f32_16x16x32_bf16 v[56:59], v[100:103], v[160:163], v[56:59]
    ds_read_b64_tr_b16 v[94:95], v3 offset:61440
    s_waitcnt lgkmcnt(6)
    v_mfma_f32_16x16x32_bf16 v[60:63], v[104:107], v[156:159], v[60:63]
    ds_read_b64_tr_b16 v[96:97], v2 offset:57376
    v_mfma_f32_16x16x32_bf16 v[64:67], v[104:107], v[160:163], v[64:67]
    ds_read_b64_tr_b16 v[98:99], v2 offset:61472
    s_add_u32 s23, s21, 0x1020000
    buffer_load_dwordx4 v[144:147], v4, s[8:11], s23 offen offset:0 sc1
    s_waitcnt lgkmcnt(6)
    v_mfma_f32_16x16x32_bf16 v[68:71], v[84:87], v[156:159], v[68:71]
    ds_read_b64_tr_b16 v[100:101], v3 offset:57600
    v_mfma_f32_16x16x32_bf16 v[72:75], v[84:87], v[160:163], v[72:75]
    ds_read_b64_tr_b16 v[102:103], v3 offset:61696
    s_waitcnt lgkmcnt(6)
    v_mfma_f32_16x16x32_bf16 v[76:79], v[88:91], v[156:159], v[76:79]
    ds_read_b64_tr_b16 v[104:105], v2 offset:57632
    v_mfma_f32_16x16x32_bf16 v[80:83], v[88:91], v[160:163], v[80:83]
    ds_read_b64_tr_b16 v[106:107], v2 offset:61728
    s_waitcnt vmcnt(11) lgkmcnt(6)
    v_mfma_f32_16x16x32_bf16 v[20:23], v[92:95], v[164:167], v[20:23]
    ds_read_b64_tr_b16 v[84:85], v3 offset:57856
    s_waitcnt vmcnt(10)
    v_mfma_f32_16x16x32_bf16 v[24:27], v[92:95], v[168:171], v[24:27]
    ds_read_b64_tr_b16 v[86:87], v3 offset:61952
    s_waitcnt lgkmcnt(6)
    v_mfma_f32_16x16x32_bf16 v[28:31], v[96:99], v[164:167], v[28:31]
    ds_read_b64_tr_b16 v[88:89], v2 offset:57888
    v_mfma_f32_16x16x32_bf16 v[32:35], v[96:99], v[168:171], v[32:35]
    ds_read_b64_tr_b16 v[90:91], v2 offset:61984
    s_add_u32 s23, s21, 0x1000000
    buffer_load_dwordx4 v[148:151], v4, s[8:11], s23 offen offset:1024 sc1
    s_waitcnt lgkmcnt(6)
    v_mfma_f32_16x16x32_bf16 v[36:39], v[100:103], v[164:167], v[36:39]
    ds_read_b64_tr_b16 v[92:93], v3 offset:58112
    v_mfma_f32_16x16x32_bf16 v[40:43], v[100:103], v[168:171], v[40:43]
    ds_read_b64_tr_b16 v[94:95], v3 offset:62208
    s_waitcnt lgkmcnt(6)
    v_mfma_f32_16x16x32_bf16 v[44:47], v[104:107], v[164:167], v[44:47]
    ds_read_b64_tr_b16 v[96:97], v2 offset:58144
    v_mfma_f32_16x16x32_bf16 v[48:51], v[104:107], v[168:171], v[48:51]
    ds_read_b64_tr_b16 v[98:99], v2 offset:62240
    s_waitcnt lgkmcnt(6)
    v_mfma_f32_16x16x32_bf16 v[52:55], v[84:87], v[164:167], v[52:55]
    v_mfma_f32_16x16x32_bf16 v[56:59], v[84:87], v[168:171], v[56:59]
    s_barrier
    ds_read_b64_tr_b16 v[100:101], v15 offset:0
    ds_read_b64_tr_b16 v[102:103], v15 offset:4096
    s_waitcnt lgkmcnt(6)
    v_mfma_f32_16x16x32_bf16 v[60:63], v[88:91], v[164:167], v[60:63]
    ds_read_b64_tr_b16 v[104:105], v16 offset:32
    v_mfma_f32_16x16x32_bf16 v[64:67], v[88:91], v[168:171], v[64:67]
    ds_read_b64_tr_b16 v[106:107], v16 offset:4128
    s_add_u32 s23, s21, 0x1020000
    buffer_load_dwordx4 v[152:155], v4, s[8:11], s23 offen offset:1024 sc1
    s_waitcnt lgkmcnt(6)
    v_mfma_f32_16x16x32_bf16 v[68:71], v[92:95], v[164:167], v[68:71]
    ds_read_b64_tr_b16 v[84:85], v15 offset:256
    v_mfma_f32_16x16x32_bf16 v[72:75], v[92:95], v[168:171], v[72:75]
    ds_read_b64_tr_b16 v[86:87], v15 offset:4352
    s_waitcnt lgkmcnt(6)
    v_mfma_f32_16x16x32_bf16 v[76:79], v[96:99], v[164:167], v[76:79]
    ds_read_b64_tr_b16 v[88:89], v16 offset:288
    v_mfma_f32_16x16x32_bf16 v[80:83], v[96:99], v[168:171], v[80:83]
    ds_read_b64_tr_b16 v[90:91], v16 offset:4384
    s_waitcnt vmcnt(11) lgkmcnt(6)
    v_mfma_f32_16x16x32_bf16 v[20:23], v[100:103], v[188:191], v[20:23]
    ds_read_b64_tr_b16 v[92:93], v15 offset:512
    s_waitcnt vmcnt(10)
    v_mfma_f32_16x16x32_bf16 v[24:27], v[100:103], v[192:195], v[24:27]
    ds_read_b64_tr_b16 v[94:95], v15 offset:4608
    s_waitcnt lgkmcnt(6)
    v_mfma_f32_16x16x32_bf16 v[28:31], v[104:107], v[188:191], v[28:31]
    ds_read_b64_tr_b16 v[96:97], v16 offset:544
    v_mfma_f32_16x16x32_bf16 v[32:35], v[104:107], v[192:195], v[32:35]
    ds_read_b64_tr_b16 v[98:99], v16 offset:4640
    s_add_u32 s23, s21, 0x1000800
    buffer_load_dwordx4 v[156:159], v4, s[8:11], s23 offen offset:0 sc1
    s_waitcnt lgkmcnt(6)
    v_mfma_f32_16x16x32_bf16 v[36:39], v[84:87], v[188:191], v[36:39]
    ds_read_b64_tr_b16 v[100:101], v15 offset:768
    v_mfma_f32_16x16x32_bf16 v[40:43], v[84:87], v[192:195], v[40:43]
    ds_read_b64_tr_b16 v[102:103], v15 offset:4864
    s_waitcnt lgkmcnt(6)
    v_mfma_f32_16x16x32_bf16 v[44:47], v[88:91], v[188:191], v[44:47]
    ds_read_b64_tr_b16 v[104:105], v16 offset:800
    v_mfma_f32_16x16x32_bf16 v[48:51], v[88:91], v[192:195], v[48:51]
    ds_read_b64_tr_b16 v[106:107], v16 offset:4896
    s_waitcnt lgkmcnt(6)
    v_mfma_f32_16x16x32_bf16 v[52:55], v[92:95], v[188:191], v[52:55]
    ds_read_b64_tr_b16 v[84:85], v15 offset:8192
    v_mfma_f32_16x16x32_bf16 v[56:59], v[92:95], v[192:195], v[56:59]
    ds_read_b64_tr_b16 v[86:87], v15 offset:12288
    s_waitcnt lgkmcnt(6)
    v_mfma_f32_16x16x32_bf16 v[60:63], v[96:99], v[188:191], v[60:63]
    ds_read_b64_tr_b16 v[88:89], v16 offset:8224
    v_mfma_f32_16x16x32_bf16 v[64:67], v[96:99], v[192:195], v[64:67]
    ds_read_b64_tr_b16 v[90:91], v16 offset:12320
    s_add_u32 s23, s21, 0x1020800
    buffer_load_dwordx4 v[160:163], v4, s[8:11], s23 offen offset:0 sc1
    s_waitcnt lgkmcnt(6)
    v_mfma_f32_16x16x32_bf16 v[68:71], v[100:103], v[188:191], v[68:71]
    ds_read_b64_tr_b16 v[92:93], v15 offset:8448
    v_mfma_f32_16x16x32_bf16 v[72:75], v[100:103], v[192:195], v[72:75]
    ds_read_b64_tr_b16 v[94:95], v15 offset:12544
    s_waitcnt lgkmcnt(6)
    v_mfma_f32_16x16x32_bf16 v[76:79], v[104:107], v[188:191], v[76:79]
    ds_read_b64_tr_b16 v[96:97], v16 offset:8480
    v_mfma_f32_16x16x32_bf16 v[80:83], v[104:107], v[192:195], v[80:83]
    ds_read_b64_tr_b16 v[98:99], v16 offset:12576
    s_waitcnt vmcnt(11) lgkmcnt(6)
    v_mfma_f32_16x16x32_bf16 v[20:23], v[84:87], v[196:199], v[20:23]
    ds_read_b64_tr_b16 v[100:101], v15 offset:8704
    s_waitcnt vmcnt(10)
    v_mfma_f32_16x16x32_bf16 v[24:27], v[84:87], v[200:203], v[24:27]
    ds_read_b64_tr_b16 v[102:103], v15 offset:12800
    s_waitcnt lgkmcnt(6)
    v_mfma_f32_16x16x32_bf16 v[28:31], v[88:91], v[196:199], v[28:31]
    ds_read_b64_tr_b16 v[104:105], v16 offset:8736
    v_mfma_f32_16x16x32_bf16 v[32:35], v[88:91], v[200:203], v[32:35]
    ds_read_b64_tr_b16 v[106:107], v16 offset:12832
    s_add_u32 s23, s21, 0x1000800
    buffer_load_dwordx4 v[164:167], v4, s[8:11], s23 offen offset:1024 sc1
    s_waitcnt lgkmcnt(6)
    v_mfma_f32_16x16x32_bf16 v[36:39], v[92:95], v[196:199], v[36:39]
    ds_read_b64_tr_b16 v[84:85], v15 offset:8960
    v_mfma_f32_16x16x32_bf16 v[40:43], v[92:95], v[200:203], v[40:43]
    ds_read_b64_tr_b16 v[86:87], v15 offset:13056
    s_waitcnt lgkmcnt(6)
    v_mfma_f32_16x16x32_bf16 v[44:47], v[96:99], v[196:199], v[44:47]
    ds_read_b64_tr_b16 v[88:89], v16 offset:8992
    v_mfma_f32_16x16x32_bf16 v[48:51], v[96:99], v[200:203], v[48:51]
    ds_read_b64_tr_b16 v[90:91], v16 offset:13088
    s_waitcnt lgkmcnt(6)
    v_mfma_f32_16x16x32_bf16 v[52:55], v[100:103], v[196:199], v[52:55]
    v_mfma_f32_16x16x32_bf16 v[56:59], v[100:103], v[200:203], v[56:59]
    s_barrier
    ds_read_b64_tr_b16 v[92:93], v15 offset:16384
    ds_read_b64_tr_b16 v[94:95], v15 offset:20480
    s_waitcnt lgkmcnt(6)
    v_mfma_f32_16x16x32_bf16 v[60:63], v[104:107], v[196:199], v[60:63]
    ds_read_b64_tr_b16 v[96:97], v16 offset:16416
    v_mfma_f32_16x16x32_bf16 v[64:67], v[104:107], v[200:203], v[64:67]
    ds_read_b64_tr_b16 v[98:99], v16 offset:20512
    s_add_u32 s23, s21, 0x1020800
    buffer_load_dwordx4 v[168:171], v4, s[8:11], s23 offen offset:1024 sc1
    s_waitcnt lgkmcnt(6)
    v_mfma_f32_16x16x32_bf16 v[68:71], v[84:87], v[196:199], v[68:71]
    ds_read_b64_tr_b16 v[100:101], v15 offset:16640
    v_mfma_f32_16x16x32_bf16 v[72:75], v[84:87], v[200:203], v[72:75]
    ds_read_b64_tr_b16 v[102:103], v15 offset:20736
    s_waitcnt lgkmcnt(6)
    v_mfma_f32_16x16x32_bf16 v[76:79], v[88:91], v[196:199], v[76:79]
    ds_read_b64_tr_b16 v[104:105], v16 offset:16672
    v_mfma_f32_16x16x32_bf16 v[80:83], v[88:91], v[200:203], v[80:83]
    ds_read_b64_tr_b16 v[106:107], v16 offset:20768
    s_waitcnt vmcnt(11) lgkmcnt(6)
    v_mfma_f32_16x16x32_bf16 v[20:23], v[92:95], v[108:111], v[20:23]
    ds_read_b64_tr_b16 v[84:85], v15 offset:16896
    s_waitcnt vmcnt(10)
    v_mfma_f32_16x16x32_bf16 v[24:27], v[92:95], v[112:115], v[24:27]
    ds_read_b64_tr_b16 v[86:87], v15 offset:20992
    s_waitcnt lgkmcnt(6)
    v_mfma_f32_16x16x32_bf16 v[28:31], v[96:99], v[108:111], v[28:31]
    ds_read_b64_tr_b16 v[88:89], v16 offset:16928
    v_mfma_f32_16x16x32_bf16 v[32:35], v[96:99], v[112:115], v[32:35]
    ds_read_b64_tr_b16 v[90:91], v16 offset:21024
    s_bfe_u32 s21, s42, 0x30010
    s_or_b32 s21, s21, s62
    s_lshl_b32 s21, s21, 12
    s_add_u32 s23, s21, 0x1000000
    buffer_load_dwordx4 v[188:191], v4, s[8:11], s23 offen offset:0 sc1
    s_waitcnt lgkmcnt(6)
    v_mfma_f32_16x16x32_bf16 v[36:39], v[100:103], v[108:111], v[36:39]
    ds_read_b64_tr_b16 v[92:93], v15 offset:17152
    v_mfma_f32_16x16x32_bf16 v[40:43], v[100:103], v[112:115], v[40:43]
    ds_read_b64_tr_b16 v[94:95], v15 offset:21248
    s_waitcnt lgkmcnt(6)
    v_mfma_f32_16x16x32_bf16 v[44:47], v[104:107], v[108:111], v[44:47]
    ds_read_b64_tr_b16 v[96:97], v16 offset:17184
    v_mfma_f32_16x16x32_bf16 v[48:51], v[104:107], v[112:115], v[48:51]
    ds_read_b64_tr_b16 v[98:99], v16 offset:21280
    s_waitcnt lgkmcnt(6)
    v_mfma_f32_16x16x32_bf16 v[52:55], v[84:87], v[108:111], v[52:55]
    ds_read_b64_tr_b16 v[100:101], v15 offset:24576
    v_mfma_f32_16x16x32_bf16 v[56:59], v[84:87], v[112:115], v[56:59]
    ds_read_b64_tr_b16 v[102:103], v15 offset:28672
    s_waitcnt lgkmcnt(6)
    v_mfma_f32_16x16x32_bf16 v[60:63], v[88:91], v[108:111], v[60:63]
    ds_read_b64_tr_b16 v[104:105], v16 offset:24608
    v_mfma_f32_16x16x32_bf16 v[64:67], v[88:91], v[112:115], v[64:67]
    ds_read_b64_tr_b16 v[106:107], v16 offset:28704
    s_add_u32 s23, s21, 0x1020000
    buffer_load_dwordx4 v[192:195], v4, s[8:11], s23 offen offset:0 sc1
    s_waitcnt lgkmcnt(6)
    v_mfma_f32_16x16x32_bf16 v[68:71], v[92:95], v[108:111], v[68:71]
    ds_read_b64_tr_b16 v[84:85], v15 offset:24832
    v_mfma_f32_16x16x32_bf16 v[72:75], v[92:95], v[112:115], v[72:75]
    ds_read_b64_tr_b16 v[86:87], v15 offset:28928
    s_waitcnt lgkmcnt(6)
    v_mfma_f32_16x16x32_bf16 v[76:79], v[96:99], v[108:111], v[76:79]
    ds_read_b64_tr_b16 v[88:89], v16 offset:24864
    v_mfma_f32_16x16x32_bf16 v[80:83], v[96:99], v[112:115], v[80:83]
    ds_read_b64_tr_b16 v[90:91], v16 offset:28960
    s_waitcnt vmcnt(11) lgkmcnt(6)
    v_mfma_f32_16x16x32_bf16 v[20:23], v[100:103], v[116:119], v[20:23]
    ds_read_b64_tr_b16 v[92:93], v15 offset:25088
    s_waitcnt vmcnt(10)
    v_mfma_f32_16x16x32_bf16 v[24:27], v[100:103], v[120:123], v[24:27]
    ds_read_b64_tr_b16 v[94:95], v15 offset:29184
    s_waitcnt lgkmcnt(6)
    v_mfma_f32_16x16x32_bf16 v[28:31], v[104:107], v[116:119], v[28:31]
    ds_read_b64_tr_b16 v[96:97], v16 offset:25120
    v_mfma_f32_16x16x32_bf16 v[32:35], v[104:107], v[120:123], v[32:35]
    ds_read_b64_tr_b16 v[98:99], v16 offset:29216
    s_add_u32 s23, s21, 0x1000000
    buffer_load_dwordx4 v[196:199], v4, s[8:11], s23 offen offset:1024 sc1
    s_waitcnt lgkmcnt(6)
    v_mfma_f32_16x16x32_bf16 v[36:39], v[84:87], v[116:119], v[36:39]
    ds_read_b64_tr_b16 v[100:101], v15 offset:25344
    v_mfma_f32_16x16x32_bf16 v[40:43], v[84:87], v[120:123], v[40:43]
    ds_read_b64_tr_b16 v[102:103], v15 offset:29440
    s_waitcnt lgkmcnt(6)
    v_mfma_f32_16x16x32_bf16 v[44:47], v[88:91], v[116:119], v[44:47]
    ds_read_b64_tr_b16 v[104:105], v16 offset:25376
    v_mfma_f32_16x16x32_bf16 v[48:51], v[88:91], v[120:123], v[48:51]
    ds_read_b64_tr_b16 v[106:107], v16 offset:29472
    s_waitcnt lgkmcnt(6)
    v_mfma_f32_16x16x32_bf16 v[52:55], v[92:95], v[116:119], v[52:55]
    v_mfma_f32_16x16x32_bf16 v[56:59], v[92:95], v[120:123], v[56:59]
    s_barrier
    ds_read_b64_tr_b16 v[84:85], v15 offset:32768
    ds_read_b64_tr_b16 v[86:87], v15 offset:36864
    s_waitcnt lgkmcnt(6)
    v_mfma_f32_16x16x32_bf16 v[60:63], v[96:99], v[116:119], v[60:63]
    ds_read_b64_tr_b16 v[88:89], v16 offset:32800
    v_mfma_f32_16x16x32_bf16 v[64:67], v[96:99], v[120:123], v[64:67]
    ds_read_b64_tr_b16 v[90:91], v16 offset:36896
    s_add_u32 s23, s21, 0x1020000
    buffer_load_dwordx4 v[200:203], v4, s[8:11], s23 offen offset:1024 sc1
    s_waitcnt lgkmcnt(6)
    v_mfma_f32_16x16x32_bf16 v[68:71], v[100:103], v[116:119], v[68:71]
    ds_read_b64_tr_b16 v[92:93], v15 offset:33024
    v_mfma_f32_16x16x32_bf16 v[72:75], v[100:103], v[120:123], v[72:75]
    ds_read_b64_tr_b16 v[94:95], v15 offset:37120
    s_waitcnt lgkmcnt(6)
    v_mfma_f32_16x16x32_bf16 v[76:79], v[104:107], v[116:119], v[76:79]
    ds_read_b64_tr_b16 v[96:97], v16 offset:33056
    v_mfma_f32_16x16x32_bf16 v[80:83], v[104:107], v[120:123], v[80:83]
    ds_read_b64_tr_b16 v[98:99], v16 offset:37152
    s_waitcnt vmcnt(11) lgkmcnt(6)
    v_mfma_f32_16x16x32_bf16 v[20:23], v[84:87], v[140:143], v[20:23]
    ds_read_b64_tr_b16 v[100:101], v15 offset:33280
    s_waitcnt vmcnt(10)
    v_mfma_f32_16x16x32_bf16 v[24:27], v[84:87], v[144:147], v[24:27]
    ds_read_b64_tr_b16 v[102:103], v15 offset:37376
    s_waitcnt lgkmcnt(6)
    v_mfma_f32_16x16x32_bf16 v[28:31], v[88:91], v[140:143], v[28:31]
    ds_read_b64_tr_b16 v[104:105], v16 offset:33312
    v_mfma_f32_16x16x32_bf16 v[32:35], v[88:91], v[144:147], v[32:35]
    ds_read_b64_tr_b16 v[106:107], v16 offset:37408
    s_add_u32 s23, s21, 0x1000800
    buffer_load_dwordx4 v[108:111], v4, s[8:11], s23 offen offset:0 sc1
    s_waitcnt lgkmcnt(6)
    v_mfma_f32_16x16x32_bf16 v[36:39], v[92:95], v[140:143], v[36:39]
    ds_read_b64_tr_b16 v[84:85], v15 offset:33536
    v_mfma_f32_16x16x32_bf16 v[40:43], v[92:95], v[144:147], v[40:43]
    ds_read_b64_tr_b16 v[86:87], v15 offset:37632
    s_waitcnt lgkmcnt(6)
    v_mfma_f32_16x16x32_bf16 v[44:47], v[96:99], v[140:143], v[44:47]
    ds_read_b64_tr_b16 v[88:89], v16 offset:33568
    v_mfma_f32_16x16x32_bf16 v[48:51], v[96:99], v[144:147], v[48:51]
    ds_read_b64_tr_b16 v[90:91], v16 offset:37664
    s_waitcnt lgkmcnt(6)
    v_mfma_f32_16x16x32_bf16 v[52:55], v[100:103], v[140:143], v[52:55]
    ds_read_b64_tr_b16 v[92:93], v15 offset:40960
    v_mfma_f32_16x16x32_bf16 v[56:59], v[100:103], v[144:147], v[56:59]
    ds_read_b64_tr_b16 v[94:95], v15 offset:45056
    s_waitcnt lgkmcnt(6)
    v_mfma_f32_16x16x32_bf16 v[60:63], v[104:107], v[140:143], v[60:63]
    ds_read_b64_tr_b16 v[96:97], v16 offset:40992
    v_mfma_f32_16x16x32_bf16 v[64:67], v[104:107], v[144:147], v[64:67]
    ds_read_b64_tr_b16 v[98:99], v16 offset:45088
    s_add_u32 s23, s21, 0x1020800
    buffer_load_dwordx4 v[112:115], v4, s[8:11], s23 offen offset:0 sc1
    s_waitcnt lgkmcnt(6)
    v_mfma_f32_16x16x32_bf16 v[68:71], v[84:87], v[140:143], v[68:71]
    ds_read_b64_tr_b16 v[100:101], v15 offset:41216
    v_mfma_f32_16x16x32_bf16 v[72:75], v[84:87], v[144:147], v[72:75]
    ds_read_b64_tr_b16 v[102:103], v15 offset:45312
    s_waitcnt lgkmcnt(6)
    v_mfma_f32_16x16x32_bf16 v[76:79], v[88:91], v[140:143], v[76:79]
    ds_read_b64_tr_b16 v[104:105], v16 offset:41248
    v_mfma_f32_16x16x32_bf16 v[80:83], v[88:91], v[144:147], v[80:83]
    ds_read_b64_tr_b16 v[106:107], v16 offset:45344
    s_waitcnt vmcnt(11) lgkmcnt(6)
    v_mfma_f32_16x16x32_bf16 v[20:23], v[92:95], v[148:151], v[20:23]
    ds_read_b64_tr_b16 v[84:85], v15 offset:41472
    s_waitcnt vmcnt(10)
    v_mfma_f32_16x16x32_bf16 v[24:27], v[92:95], v[152:155], v[24:27]
    ds_read_b64_tr_b16 v[86:87], v15 offset:45568
    s_waitcnt lgkmcnt(6)
    v_mfma_f32_16x16x32_bf16 v[28:31], v[96:99], v[148:151], v[28:31]
    ds_read_b64_tr_b16 v[88:89], v16 offset:41504
    v_mfma_f32_16x16x32_bf16 v[32:35], v[96:99], v[152:155], v[32:35]
    ds_read_b64_tr_b16 v[90:91], v16 offset:45600
    s_add_u32 s23, s21, 0x1000800
    buffer_load_dwordx4 v[116:119], v4, s[8:11], s23 offen offset:1024 sc1
    s_waitcnt lgkmcnt(6)
    v_mfma_f32_16x16x32_bf16 v[36:39], v[100:103], v[148:151], v[36:39]
    ds_read_b64_tr_b16 v[92:93], v15 offset:41728
    v_mfma_f32_16x16x32_bf16 v[40:43], v[100:103], v[152:155], v[40:43]
    ds_read_b64_tr_b16 v[94:95], v15 offset:45824
    s_waitcnt lgkmcnt(6)
    v_mfma_f32_16x16x32_bf16 v[44:47], v[104:107], v[148:151], v[44:47]
    ds_read_b64_tr_b16 v[96:97], v16 offset:41760
    v_mfma_f32_16x16x32_bf16 v[48:51], v[104:107], v[152:155], v[48:51]
    ds_read_b64_tr_b16 v[98:99], v16 offset:45856
    s_waitcnt lgkmcnt(6)
    v_mfma_f32_16x16x32_bf16 v[52:55], v[84:87], v[148:151], v[52:55]
    v_mfma_f32_16x16x32_bf16 v[56:59], v[84:87], v[152:155], v[56:59]
    s_barrier
    ds_read_b64_tr_b16 v[100:101], v15 offset:49152
    ds_read_b64_tr_b16 v[102:103], v15 offset:53248
    s_waitcnt lgkmcnt(6)
    v_mfma_f32_16x16x32_bf16 v[60:63], v[88:91], v[148:151], v[60:63]
    ds_read_b64_tr_b16 v[104:105], v16 offset:49184
    v_mfma_f32_16x16x32_bf16 v[64:67], v[88:91], v[152:155], v[64:67]
    ds_read_b64_tr_b16 v[106:107], v16 offset:53280
    s_add_u32 s23, s21, 0x1020800
    buffer_load_dwordx4 v[120:123], v4, s[8:11], s23 offen offset:1024 sc1
    s_waitcnt lgkmcnt(6)
    v_mfma_f32_16x16x32_bf16 v[68:71], v[92:95], v[148:151], v[68:71]
    ds_read_b64_tr_b16 v[84:85], v15 offset:49408
    v_mfma_f32_16x16x32_bf16 v[72:75], v[92:95], v[152:155], v[72:75]
    ds_read_b64_tr_b16 v[86:87], v15 offset:53504
    s_waitcnt lgkmcnt(6)
    v_mfma_f32_16x16x32_bf16 v[76:79], v[96:99], v[148:151], v[76:79]
    ds_read_b64_tr_b16 v[88:89], v16 offset:49440
    v_mfma_f32_16x16x32_bf16 v[80:83], v[96:99], v[152:155], v[80:83]
    ds_read_b64_tr_b16 v[90:91], v16 offset:53536
    s_waitcnt vmcnt(11) lgkmcnt(6)
    v_mfma_f32_16x16x32_bf16 v[20:23], v[100:103], v[156:159], v[20:23]
    ds_read_b64_tr_b16 v[92:93], v15 offset:49664
    s_waitcnt vmcnt(10)
    v_mfma_f32_16x16x32_bf16 v[24:27], v[100:103], v[160:163], v[24:27]
    ds_read_b64_tr_b16 v[94:95], v15 offset:53760
    s_waitcnt lgkmcnt(6)
    v_mfma_f32_16x16x32_bf16 v[28:31], v[104:107], v[156:159], v[28:31]
    ds_read_b64_tr_b16 v[96:97], v16 offset:49696
    v_mfma_f32_16x16x32_bf16 v[32:35], v[104:107], v[160:163], v[32:35]
    ds_read_b64_tr_b16 v[98:99], v16 offset:53792
    s_bfe_u32 s21, s42, 0x30014
    s_or_b32 s21, s21, s62
    s_lshl_b32 s21, s21, 12
    s_add_u32 s23, s21, 0x1000000
    buffer_load_dwordx4 v[140:143], v4, s[8:11], s23 offen offset:0 sc1
    s_waitcnt lgkmcnt(6)
    v_mfma_f32_16x16x32_bf16 v[36:39], v[84:87], v[156:159], v[36:39]
    ds_read_b64_tr_b16 v[100:101], v15 offset:49920
    v_mfma_f32_16x16x32_bf16 v[40:43], v[84:87], v[160:163], v[40:43]
    ds_read_b64_tr_b16 v[102:103], v15 offset:54016
    buffer_load_dword v10, v9, s[8:11], s20 offen sc1
    s_waitcnt lgkmcnt(6)
    v_mfma_f32_16x16x32_bf16 v[44:47], v[88:91], v[156:159], v[44:47]
    ds_read_b64_tr_b16 v[104:105], v16 offset:49952
    v_mfma_f32_16x16x32_bf16 v[48:51], v[88:91], v[160:163], v[48:51]
    ds_read_b64_tr_b16 v[106:107], v16 offset:54048
    s_waitcnt lgkmcnt(6)
    v_mfma_f32_16x16x32_bf16 v[52:55], v[92:95], v[156:159], v[52:55]
    ds_read_b64_tr_b16 v[84:85], v15 offset:57344
    v_mfma_f32_16x16x32_bf16 v[56:59], v[92:95], v[160:163], v[56:59]
    ds_read_b64_tr_b16 v[86:87], v15 offset:61440
    s_waitcnt lgkmcnt(6)
    v_mfma_f32_16x16x32_bf16 v[60:63], v[96:99], v[156:159], v[60:63]
    ds_read_b64_tr_b16 v[88:89], v16 offset:57376
    v_mfma_f32_16x16x32_bf16 v[64:67], v[96:99], v[160:163], v[64:67]
    ds_read_b64_tr_b16 v[90:91], v16 offset:61472
    s_add_u32 s23, s21, 0x1020000
    buffer_load_dwordx4 v[144:147], v4, s[8:11], s23 offen offset:0 sc1
    s_waitcnt lgkmcnt(6)
    v_mfma_f32_16x16x32_bf16 v[68:71], v[100:103], v[156:159], v[68:71]
    ds_read_b64_tr_b16 v[92:93], v15 offset:57600
    v_mfma_f32_16x16x32_bf16 v[72:75], v[100:103], v[160:163], v[72:75]
    ds_read_b64_tr_b16 v[94:95], v15 offset:61696
    s_waitcnt lgkmcnt(6)
    v_mfma_f32_16x16x32_bf16 v[76:79], v[104:107], v[156:159], v[76:79]
    ds_read_b64_tr_b16 v[96:97], v16 offset:57632
    v_mfma_f32_16x16x32_bf16 v[80:83], v[104:107], v[160:163], v[80:83]
    ds_read_b64_tr_b16 v[98:99], v16 offset:61728
    s_waitcnt vmcnt(12) lgkmcnt(6)
    v_mfma_f32_16x16x32_bf16 v[20:23], v[84:87], v[164:167], v[20:23]
    ds_read_b64_tr_b16 v[100:101], v15 offset:57856
    s_waitcnt vmcnt(11)
    v_mfma_f32_16x16x32_bf16 v[24:27], v[84:87], v[168:171], v[24:27]
    ds_read_b64_tr_b16 v[102:103], v15 offset:61952
    s_waitcnt lgkmcnt(6)
    v_mfma_f32_16x16x32_bf16 v[28:31], v[88:91], v[164:167], v[28:31]
    ds_read_b64_tr_b16 v[104:105], v16 offset:57888
    v_mfma_f32_16x16x32_bf16 v[32:35], v[88:91], v[168:171], v[32:35]
    ds_read_b64_tr_b16 v[106:107], v16 offset:61984
    s_add_u32 s23, s21, 0x1000000
    buffer_load_dwordx4 v[148:151], v4, s[8:11], s23 offen offset:1024 sc1
    s_waitcnt lgkmcnt(6)
    v_mfma_f32_16x16x32_bf16 v[36:39], v[92:95], v[164:167], v[36:39]
    ds_read_b64_tr_b16 v[84:85], v15 offset:58112
    v_mfma_f32_16x16x32_bf16 v[40:43], v[92:95], v[168:171], v[40:43]
    ds_read_b64_tr_b16 v[86:87], v15 offset:62208
    s_waitcnt lgkmcnt(6)
    v_mfma_f32_16x16x32_bf16 v[44:47], v[96:99], v[164:167], v[44:47]
    ds_read_b64_tr_b16 v[88:89], v16 offset:58144
    v_mfma_f32_16x16x32_bf16 v[48:51], v[96:99], v[168:171], v[48:51]
    ds_read_b64_tr_b16 v[90:91], v16 offset:62240
    s_waitcnt lgkmcnt(6)
    v_mfma_f32_16x16x32_bf16 v[52:55], v[100:103], v[164:167], v[52:55]
    v_mfma_f32_16x16x32_bf16 v[56:59], v[100:103], v[168:171], v[56:59]
    s_barrier
    ds_read_b64_tr_b16 v[92:93], v3 offset:0
    ds_read_b64_tr_b16 v[94:95], v3 offset:4096
    s_waitcnt lgkmcnt(6)
    v_mfma_f32_16x16x32_bf16 v[60:63], v[104:107], v[164:167], v[60:63]
    ds_read_b64_tr_b16 v[96:97], v2 offset:32
    v_mfma_f32_16x16x32_bf16 v[64:67], v[104:107], v[168:171], v[64:67]
    ds_read_b64_tr_b16 v[98:99], v2 offset:4128
    s_add_u32 s23, s21, 0x1020000
    buffer_load_dwordx4 v[152:155], v4, s[8:11], s23 offen offset:1024 sc1
    s_waitcnt lgkmcnt(6)
    v_mfma_f32_16x16x32_bf16 v[68:71], v[84:87], v[164:167], v[68:71]
    ds_read_b64_tr_b16 v[100:101], v3 offset:256
    v_mfma_f32_16x16x32_bf16 v[72:75], v[84:87], v[168:171], v[72:75]
    ds_read_b64_tr_b16 v[102:103], v3 offset:4352
    s_waitcnt lgkmcnt(6)
    v_mfma_f32_16x16x32_bf16 v[76:79], v[88:91], v[164:167], v[76:79]
    ds_read_b64_tr_b16 v[104:105], v2 offset:288
    v_mfma_f32_16x16x32_bf16 v[80:83], v[88:91], v[168:171], v[80:83]
    ds_read_b64_tr_b16 v[106:107], v2 offset:4384
    s_waitcnt vmcnt(12) lgkmcnt(6)
    v_mfma_f32_16x16x32_bf16 v[20:23], v[92:95], v[188:191], v[20:23]
    ds_read_b64_tr_b16 v[84:85], v3 offset:512
    s_waitcnt vmcnt(11)
    v_mfma_f32_16x16x32_bf16 v[24:27], v[92:95], v[192:195], v[24:27]
    ds_read_b64_tr_b16 v[86:87], v3 offset:4608
    s_waitcnt lgkmcnt(6)
    v_mfma_f32_16x16x32_bf16 v[28:31], v[96:99], v[188:191], v[28:31]
    ds_read_b64_tr_b16 v[88:89], v2 offset:544
    v_mfma_f32_16x16x32_bf16 v[32:35], v[96:99], v[192:195], v[32:35]
    ds_read_b64_tr_b16 v[90:91], v2 offset:4640
    s_add_u32 s23, s21, 0x1000800
    buffer_load_dwordx4 v[156:159], v4, s[8:11], s23 offen offset:0 sc1
    s_waitcnt lgkmcnt(6)
    v_mfma_f32_16x16x32_bf16 v[36:39], v[100:103], v[188:191], v[36:39]
    ds_read_b64_tr_b16 v[92:93], v3 offset:768
    v_mfma_f32_16x16x32_bf16 v[40:43], v[100:103], v[192:195], v[40:43]
    ds_read_b64_tr_b16 v[94:95], v3 offset:4864
    s_waitcnt lgkmcnt(6)
    v_mfma_f32_16x16x32_bf16 v[44:47], v[104:107], v[188:191], v[44:47]
    ds_read_b64_tr_b16 v[96:97], v2 offset:800
    v_mfma_f32_16x16x32_bf16 v[48:51], v[104:107], v[192:195], v[48:51]
    ds_read_b64_tr_b16 v[98:99], v2 offset:4896
    s_waitcnt lgkmcnt(6)
    v_mfma_f32_16x16x32_bf16 v[52:55], v[84:87], v[188:191], v[52:55]
    ds_read_b64_tr_b16 v[100:101], v3 offset:8192
    v_mfma_f32_16x16x32_bf16 v[56:59], v[84:87], v[192:195], v[56:59]
    ds_read_b64_tr_b16 v[102:103], v3 offset:12288
    s_waitcnt lgkmcnt(6)
    v_mfma_f32_16x16x32_bf16 v[60:63], v[88:91], v[188:191], v[60:63]
    ds_read_b64_tr_b16 v[104:105], v2 offset:8224
    v_mfma_f32_16x16x32_bf16 v[64:67], v[88:91], v[192:195], v[64:67]
    ds_read_b64_tr_b16 v[106:107], v2 offset:12320
    s_add_u32 s23, s21, 0x1020800
    buffer_load_dwordx4 v[160:163], v4, s[8:11], s23 offen offset:0 sc1
    s_waitcnt lgkmcnt(6)
    v_mfma_f32_16x16x32_bf16 v[68:71], v[92:95], v[188:191], v[68:71]
    ds_read_b64_tr_b16 v[84:85], v3 offset:8448
    v_mfma_f32_16x16x32_bf16 v[72:75], v[92:95], v[192:195], v[72:75]
    ds_read_b64_tr_b16 v[86:87], v3 offset:12544
    s_waitcnt lgkmcnt(6)
    v_mfma_f32_16x16x32_bf16 v[76:79], v[96:99], v[188:191], v[76:79]
    ds_read_b64_tr_b16 v[88:89], v2 offset:8480
    v_mfma_f32_16x16x32_bf16 v[80:83], v[96:99], v[192:195], v[80:83]
    ds_read_b64_tr_b16 v[90:91], v2 offset:12576
    s_waitcnt vmcnt(12) lgkmcnt(6)
    v_mfma_f32_16x16x32_bf16 v[20:23], v[100:103], v[196:199], v[20:23]
    ds_read_b64_tr_b16 v[92:93], v3 offset:8704
    s_waitcnt vmcnt(11)
    v_mfma_f32_16x16x32_bf16 v[24:27], v[100:103], v[200:203], v[24:27]
    ds_read_b64_tr_b16 v[94:95], v3 offset:12800
    s_waitcnt lgkmcnt(6)
    v_mfma_f32_16x16x32_bf16 v[28:31], v[104:107], v[196:199], v[28:31]
    ds_read_b64_tr_b16 v[96:97], v2 offset:8736
    v_mfma_f32_16x16x32_bf16 v[32:35], v[104:107], v[200:203], v[32:35]
    ds_read_b64_tr_b16 v[98:99], v2 offset:12832
    s_add_u32 s23, s21, 0x1000800
    buffer_load_dwordx4 v[164:167], v4, s[8:11], s23 offen offset:1024 sc1
    s_waitcnt lgkmcnt(6)
    v_mfma_f32_16x16x32_bf16 v[36:39], v[84:87], v[196:199], v[36:39]
    ds_read_b64_tr_b16 v[100:101], v3 offset:8960
    v_mfma_f32_16x16x32_bf16 v[40:43], v[84:87], v[200:203], v[40:43]
    ds_read_b64_tr_b16 v[102:103], v3 offset:13056
    s_waitcnt lgkmcnt(6)
    v_mfma_f32_16x16x32_bf16 v[44:47], v[88:91], v[196:199], v[44:47]
    ds_read_b64_tr_b16 v[104:105], v2 offset:8992
    v_mfma_f32_16x16x32_bf16 v[48:51], v[88:91], v[200:203], v[48:51]
    ds_read_b64_tr_b16 v[106:107], v2 offset:13088
    s_waitcnt lgkmcnt(6)
    v_mfma_f32_16x16x32_bf16 v[52:55], v[92:95], v[196:199], v[52:55]
    v_mfma_f32_16x16x32_bf16 v[56:59], v[92:95], v[200:203], v[56:59]
    s_barrier
    ds_read_b64_tr_b16 v[84:85], v3 offset:16384
    ds_read_b64_tr_b16 v[86:87], v3 offset:20480
    s_waitcnt lgkmcnt(6)
    v_mfma_f32_16x16x32_bf16 v[60:63], v[96:99], v[196:199], v[60:63]
    ds_read_b64_tr_b16 v[88:89], v2 offset:16416
    v_mfma_f32_16x16x32_bf16 v[64:67], v[96:99], v[200:203], v[64:67]
    ds_read_b64_tr_b16 v[90:91], v2 offset:20512
    s_add_u32 s23, s21, 0x1020800
    buffer_load_dwordx4 v[168:171], v4, s[8:11], s23 offen offset:1024 sc1
    s_waitcnt lgkmcnt(6)
    v_mfma_f32_16x16x32_bf16 v[68:71], v[100:103], v[196:199], v[68:71]
    ds_read_b64_tr_b16 v[92:93], v3 offset:16640
    v_mfma_f32_16x16x32_bf16 v[72:75], v[100:103], v[200:203], v[72:75]
    ds_read_b64_tr_b16 v[94:95], v3 offset:20736
    s_waitcnt lgkmcnt(6)
    v_mfma_f32_16x16x32_bf16 v[76:79], v[104:107], v[196:199], v[76:79]
    ds_read_b64_tr_b16 v[96:97], v2 offset:16672
    v_mfma_f32_16x16x32_bf16 v[80:83], v[104:107], v[200:203], v[80:83]
    ds_read_b64_tr_b16 v[98:99], v2 offset:20768
    s_waitcnt vmcnt(7)
    v_cmp_ne_u32 vcc, s14, v10
    s_cbranch_vccz fz_o2gB
    s_mov_b32 s27, 0
fz_o2pB:
    buffer_load_dword v10, v9, s[8:11], s20 offen sc1
    s_waitcnt vmcnt(0)
    v_cmp_ne_u32 vcc, s14, v10
    s_add_u32 s27, s27, 1
    s_cmp_ge_u32 s27, 65536
    s_nop 4
    s_cbranch_scc1 fz_o2gB
    s_cbranch_vccnz fz_o2pB
fz_o2gB:
    s_waitcnt lgkmcnt(6)
    v_mfma_f32_16x16x32_bf16 v[20:23], v[84:87], v[108:111], v[20:23]
    ds_read_b64_tr_b16 v[100:101], v3 offset:16896
    v_mfma_f32_16x16x32_bf16 v[24:27], v[84:87], v[112:115], v[24:27]
    ds_read_b64_tr_b16 v[102:103], v3 offset:20992
    s_waitcnt lgkmcnt(6)
    v_mfma_f32_16x16x32_bf16 v[28:31], v[88:91], v[108:111], v[28:31]
    ds_read_b64_tr_b16 v[104:105], v2 offset:16928
    v_mfma_f32_16x16x32_bf16 v[32:35], v[88:91], v[112:115], v[32:35]
    ds_read_b64_tr_b16 v[106:107], v2 offset:21024
    s_bfe_u32 s21, s42, 0x30018
    s_or_b32 s21, s21, s62
    s_lshl_b32 s21, s21, 12
    s_add_u32 s23, s21, 0x1000000
    buffer_load_dwordx4 v[188:191], v4, s[8:11], s23 offen offset:0 sc1
    s_waitcnt lgkmcnt(6)
    v_mfma_f32_16x16x32_bf16 v[36:39], v[92:95], v[108:111], v[36:39]
    ds_read_b64_tr_b16 v[84:85], v3 offset:17152
    v_mfma_f32_16x16x32_bf16 v[40:43], v[92:95], v[112:115], v[40:43]
    ds_read_b64_tr_b16 v[86:87], v3 offset:21248
    s_waitcnt lgkmcnt(6)
    v_mfma_f32_16x16x32_bf16 v[44:47], v[96:99], v[108:111], v[44:47]
    ds_read_b64_tr_b16 v[88:89], v2 offset:17184
    v_mfma_f32_16x16x32_bf16 v[48:51], v[96:99], v[112:115], v[48:51]
    ds_read_b64_tr_b16 v[90:91], v2 offset:21280
    s_waitcnt lgkmcnt(6)
    v_mfma_f32_16x16x32_bf16 v[52:55], v[100:103], v[108:111], v[52:55]
    ds_read_b64_tr_b16 v[92:93], v3 offset:24576
    v_mfma_f32_16x16x32_bf16 v[56:59], v[100:103], v[112:115], v[56:59]
    ds_read_b64_tr_b16 v[94:95], v3 offset:28672
    s_waitcnt lgkmcnt(6)
    v_mfma_f32_16x16x32_bf16 v[60:63], v[104:107], v[108:111], v[60:63]
    ds_read_b64_tr_b16 v[96:97], v2 offset:24608
    v_mfma_f32_16x16x32_bf16 v[64:67], v[104:107], v[112:115], v[64:67]
    ds_read_b64_tr_b16 v[98:99], v2 offset:28704
    s_add_u32 s23, s21, 0x1020000
    buffer_load_dwordx4 v[192:195], v4, s[8:11], s23 offen offset:0 sc1
    s_waitcnt lgkmcnt(6)
    v_mfma_f32_16x16x32_bf16 v[68:71], v[84:87], v[108:111], v[68:71]
    ds_read_b64_tr_b16 v[100:101], v3 offset:24832
    v_mfma_f32_16x16x32_bf16 v[72:75], v[84:87], v[112:115], v[72:75]
    ds_read_b64_tr_b16 v[102:103], v3 offset:28928
    s_waitcnt lgkmcnt(6)
    v_mfma_f32_16x16x32_bf16 v[76:79], v[88:91], v[108:111], v[76:79]
    ds_read_b64_tr_b16 v[104:105], v2 offset:24864
    v_mfma_f32_16x16x32_bf16 v[80:83], v[88:91], v[112:115], v[80:83]
    ds_read_b64_tr_b16 v[106:107], v2 offset:28960
    s_waitcnt lgkmcnt(6)
    v_mfma_f32_16x16x32_bf16 v[20:23], v[92:95], v[116:119], v[20:23]
    ds_read_b64_tr_b16 v[84:85], v3 offset:25088
    v_mfma_f32_16x16x32_bf16 v[24:27], v[92:95], v[120:123], v[24:27]
    ds_read_b64_tr_b16 v[86:87], v3 offset:29184
    s_waitcnt lgkmcnt(6)
    v_mfma_f32_16x16x32_bf16 v[28:31], v[96:99], v[116:119], v[28:31]
    ds_read_b64_tr_b16 v[88:89], v2 offset:25120
    v_mfma_f32_16x16x32_bf16 v[32:35], v[96:99], v[120:123], v[32:35]
    ds_read_b64_tr_b16 v[90:91], v2 offset:29216
    s_add_u32 s23, s21, 0x1000000
    buffer_load_dwordx4 v[196:199], v4, s[8:11], s23 offen offset:1024 sc1
    s_waitcnt lgkmcnt(6)
    v_mfma_f32_16x16x32_bf16 v[36:39], v[100:103], v[116:119], v[36:39]
    ds_read_b64_tr_b16 v[92:93], v3 offset:25344
    v_mfma_f32_16x16x32_bf16 v[40:43], v[100:103], v[120:123], v[40:43]
    ds_read_b64_tr_b16 v[94:95], v3 offset:29440
    s_waitcnt lgkmcnt(6)
    v_mfma_f32_16x16x32_bf16 v[44:47], v[104:107], v[116:119], v[44:47]
    ds_read_b64_tr_b16 v[96:97], v2 offset:25376
    v_mfma_f32_16x16x32_bf16 v[48:51], v[104:107], v[120:123], v[48:51]
    ds_read_b64_tr_b16 v[98:99], v2 offset:29472
    s_waitcnt lgkmcnt(6)
    v_mfma_f32_16x16x32_bf16 v[52:55], v[84:87], v[116:119], v[52:55]
    v_mfma_f32_16x16x32_bf16 v[56:59], v[84:87], v[120:123], v[56:59]
    s_barrier
    ds_read_b64_tr_b16 v[100:101], v3 offset:32768
    ds_read_b64_tr_b16 v[102:103], v3 offset:36864
    s_waitcnt lgkmcnt(6)
    v_mfma_f32_16x16x32_bf16 v[60:63], v[88:91], v[116:119], v[60:63]
    ds_read_b64_tr_b16 v[104:105], v2 offset:32800
    v_mfma_f32_16x16x32_bf16 v[64:67], v[88:91], v[120:123], v[64:67]
    ds_read_b64_tr_b16 v[106:107], v2 offset:36896
    s_add_u32 s23, s21, 0x1020000
    buffer_load_dwordx4 v[200:203], v4, s[8:11], s23 offen offset:1024 sc1
    s_waitcnt lgkmcnt(6)
    v_mfma_f32_16x16x32_bf16 v[68:71], v[92:95], v[116:119], v[68:71]
    ds_read_b64_tr_b16 v[84:85], v3 offset:33024
    v_mfma_f32_16x16x32_bf16 v[72:75], v[92:95], v[120:123], v[72:75]
    ds_read_b64_tr_b16 v[86:87], v3 offset:37120
    s_waitcnt lgkmcnt(6)
    v_mfma_f32_16x16x32_bf16 v[76:79], v[96:99], v[116:119], v[76:79]
    ds_read_b64_tr_b16 v[88:89], v2 offset:33056
    v_mfma_f32_16x16x32_bf16 v[80:83], v[96:99], v[120:123], v[80:83]
    ds_read_b64_tr_b16 v[90:91], v2 offset:37152
    s_waitcnt lgkmcnt(6)
    v_mfma_f32_16x16x32_bf16 v[20:23], v[100:103], v[140:143], v[20:23]
    ds_read_b64_tr_b16 v[92:93], v3 offset:33280
    s_waitcnt vmcnt(10)
    v_mfma_f32_16x16x32_bf16 v[24:27], v[100:103], v[144:147], v[24:27]
    ds_read_b64_tr_b16 v[94:95], v3 offset:37376
    s_waitcnt lgkmcnt(6)
    v_mfma_f32_16x16x32_bf16 v[28:31], v[104:107], v[140:143], v[28:31]
    ds_read_b64_tr_b16 v[96:97], v2 offset:33312
    v_mfma_f32_16x16x32_bf16 v[32:35], v[104:107], v[144:147], v[32:35]
    ds_read_b64_tr_b16 v[98:99], v2 offset:37408
    s_add_u32 s23, s21, 0x1000800
    buffer_load_dwordx4 v[108:111], v4, s[8:11], s23 offen offset:0 sc1
    s_waitcnt lgkmcnt(6)
    v_mfma_f32_16x16x32_bf16 v[36:39], v[84:87], v[140:143], v[36:39]
    ds_read_b64_tr_b16 v[100:101], v3 offset:33536
    v_mfma_f32_16x16x32_bf16 v[40:43], v[84:87], v[144:147], v[40:43]
    ds_read_b64_tr_b16 v[102:103], v3 offset:37632
    s_waitcnt lgkmcnt(6)
    v_mfma_f32_16x16x32_bf16 v[44:47], v[88:91], v[140:143], v[44:47]
    ds_read_b64_tr_b16 v[104:105], v2 offset:33568
    v_mfma_f32_16x16x32_bf16 v[48:51], v[88:91], v[144:147], v[48:51]
    ds_read_b64_tr_b16 v[106:107], v2 offset:37664
    s_waitcnt lgkmcnt(6)
    v_mfma_f32_16x16x32_bf16 v[52:55], v[92:95], v[140:143], v[52:55]
    ds_read_b64_tr_b16 v[84:85], v3 offset:40960
    v_mfma_f32_16x16x32_bf16 v[56:59], v[92:95], v[144:147], v[56:59]
    ds_read_b64_tr_b16 v[86:87], v3 offset:45056
    s_waitcnt lgkmcnt(6)
    v_mfma_f32_16x16x32_bf16 v[60:63], v[96:99], v[140:143], v[60:63]
    ds_read_b64_tr_b16 v[88:89], v2 offset:40992
    v_mfma_f32_16x16x32_bf16 v[64:67], v[96:99], v[144:147], v[64:67]
    ds_read_b64_tr_b16 v[90:91], v2 offset:45088
    s_add_u32 s23, s21, 0x1020800
    buffer_load_dwordx4 v[112:115], v4, s[8:11], s23 offen offset:0 sc1
    s_waitcnt lgkmcnt(6)
    v_mfma_f32_16x16x32_bf16 v[68:71], v[100:103], v[140:143], v[68:71]
    ds_read_b64_tr_b16 v[92:93], v3 offset:41216
    v_mfma_f32_16x16x32_bf16 v[72:75], v[100:103], v[144:147], v[72:75]
    ds_read_b64_tr_b16 v[94:95], v3 offset:45312
    s_waitcnt lgkmcnt(6)
    v_mfma_f32_16x16x32_bf16 v[76:79], v[104:107], v[140:143], v[76:79]
    ds_read_b64_tr_b16 v[96:97], v2 offset:41248
    v_mfma_f32_16x16x32_bf16 v[80:83], v[104:107], v[144:147], v[80:83]
    ds_read_b64_tr_b16 v[98:99], v2 offset:45344
    s_waitcnt vmcnt(11) lgkmcnt(6)
    v_mfma_f32_16x16x32_bf16 v[20:23], v[84:87], v[148:151], v[20:23]
    ds_read_b64_tr_b16 v[100:101], v3 offset:41472
    s_waitcnt vmcnt(10)
    v_mfma_f32_16x16x32_bf16 v[24:27], v[84:87], v[152:155], v[24:27]
    ds_read_b64_tr_b16 v[102:103], v3 offset:45568
    s_waitcnt lgkmcnt(6)
    v_mfma_f32_16x16x32_bf16 v[28:31], v[88:91], v[148:151], v[28:31]
    ds_read_b64_tr_b16 v[104:105], v2 offset:41504
    v_mfma_f32_16x16x32_bf16 v[32:35], v[88:91], v[152:155], v[32:35]
    ds_read_b64_tr_b16 v[106:107], v2 offset:45600
    s_add_u32 s23, s21, 0x1000800
    buffer_load_dwordx4 v[116:119], v4, s[8:11], s23 offen offset:1024 sc1
    s_waitcnt lgkmcnt(6)
    v_mfma_f32_16x16x32_bf16 v[36:39], v[92:95], v[148:151], v[36:39]
    ds_read_b64_tr_b16 v[84:85], v3 offset:41728
    v_mfma_f32_16x16x32_bf16 v[40:43], v[92:95], v[152:155], v[40:43]
    ds_read_b64_tr_b16 v[86:87], v3 offset:45824
    s_waitcnt lgkmcnt(6)
    v_mfma_f32_16x16x32_bf16 v[44:47], v[96:99], v[148:151], v[44:47]
    ds_read_b64_tr_b16 v[88:89], v2 offset:41760
    v_mfma_f32_16x16x32_bf16 v[48:51], v[96:99], v[152:155], v[48:51]
    ds_read_b64_tr_b16 v[90:91], v2 offset:45856
    s_waitcnt lgkmcnt(6)
    v_mfma_f32_16x16x32_bf16 v[52:55], v[100:103], v[148:151], v[52:55]
    v_mfma_f32_16x16x32_bf16 v[56:59], v[100:103], v[152:155], v[56:59]
    s_barrier
    ds_read_b64_tr_b16 v[92:93], v3 offset:49152
    ds_read_b64_tr_b16 v[94:95], v3 offset:53248
    s_waitcnt lgkmcnt(6)
    v_mfma_f32_16x16x32_bf16 v[60:63], v[104:107], v[148:151], v[60:63]
    ds_read_b64_tr_b16 v[96:97], v2 offset:49184
    v_mfma_f32_16x16x32_bf16 v[64:67], v[104:107], v[152:155], v[64:67]
    ds_read_b64_tr_b16 v[98:99], v2 offset:53280
    s_add_u32 s23, s21, 0x1020800
    buffer_load_dwordx4 v[120:123], v4, s[8:11], s23 offen offset:1024 sc1
    s_waitcnt lgkmcnt(6)
    v_mfma_f32_16x16x32_bf16 v[68:71], v[84:87], v[148:151], v[68:71]
    ds_read_b64_tr_b16 v[100:101], v3 offset:49408
    v_mfma_f32_16x16x32_bf16 v[72:75], v[84:87], v[152:155], v[72:75]
    ds_read_b64_tr_b16 v[102:103], v3 offset:53504
    s_waitcnt lgkmcnt(6)
    v_mfma_f32_16x16x32_bf16 v[76:79], v[88:91], v[148:151], v[76:79]
    ds_read_b64_tr_b16 v[104:105], v2 offset:49440
    v_mfma_f32_16x16x32_bf16 v[80:83], v[88:91], v[152:155], v[80:83]
    ds_read_b64_tr_b16 v[106:107], v2 offset:53536
    s_waitcnt vmcnt(11) lgkmcnt(6)
    v_mfma_f32_16x16x32_bf16 v[20:23], v[92:95], v[156:159], v[20:23]
    ds_read_b64_tr_b16 v[84:85], v3 offset:49664
    s_waitcnt vmcnt(10)
    v_mfma_f32_16x16x32_bf16 v[24:27], v[92:95], v[160:163], v[24:27]
    ds_read_b64_tr_b16 v[86:87], v3 offset:53760
    s_waitcnt lgkmcnt(6)
    v_mfma_f32_16x16x32_bf16 v[28:31], v[96:99], v[156:159], v[28:31]
    ds_read_b64_tr_b16 v[88:89], v2 offset:49696
    v_mfma_f32_16x16x32_bf16 v[32:35], v[96:99], v[160:163], v[32:35]
    ds_read_b64_tr_b16 v[90:91], v2 offset:53792
    s_bfe_u32 s21, s42, 0x3001c
    s_or_b32 s21, s21, s62
    s_lshl_b32 s21, s21, 12
    s_add_u32 s23, s21, 0x1000000
    buffer_load_dwordx4 v[140:143], v4, s[8:11], s23 offen offset:0 sc1
    s_waitcnt lgkmcnt(6)
    v_mfma_f32_16x16x32_bf16 v[36:39], v[100:103], v[156:159], v[36:39]
    ds_read_b64_tr_b16 v[92:93], v3 offset:49920
    v_mfma_f32_16x16x32_bf16 v[40:43], v[100:103], v[160:163], v[40:43]
    ds_read_b64_tr_b16 v[94:95], v3 offset:54016
    s_waitcnt lgkmcnt(6)
    v_mfma_f32_16x16x32_bf16 v[44:47], v[104:107], v[156:159], v[44:47]
    ds_read_b64_tr_b16 v[96:97], v2 offset:49952
    v_mfma_f32_16x16x32_bf16 v[48:51], v[104:107], v[160:163], v[48:51]
    ds_read_b64_tr_b16 v[98:99], v2 offset:54048
    s_waitcnt lgkmcnt(6)
    v_mfma_f32_16x16x32_bf16 v[52:55], v[84:87], v[156:159], v[52:55]
    ds_read_b64_tr_b16 v[100:101], v3 offset:57344
    v_mfma_f32_16x16x32_bf16 v[56:59], v[84:87], v[160:163], v[56:59]
    ds_read_b64_tr_b16 v[102:103], v3 offset:61440
    s_waitcnt lgkmcnt(6)
    v_mfma_f32_16x16x32_bf16 v[60:63], v[88:91], v[156:159], v[60:63]
    ds_read_b64_tr_b16 v[104:105], v2 offset:57376
    v_mfma_f32_16x16x32_bf16 v[64:67], v[88:91], v[160:163], v[64:67]
    ds_read_b64_tr_b16 v[106:107], v2 offset:61472
    s_add_u32 s23, s21, 0x1020000
    buffer_load_dwordx4 v[144:147], v4, s[8:11], s23 offen offset:0 sc1
    s_waitcnt lgkmcnt(6)
    v_mfma_f32_16x16x32_bf16 v[68:71], v[92:95], v[156:159], v[68:71]
    ds_read_b64_tr_b16 v[84:85], v3 offset:57600
    v_mfma_f32_16x16x32_bf16 v[72:75], v[92:95], v[160:163], v[72:75]
    ds_read_b64_tr_b16 v[86:87], v3 offset:61696
    s_waitcnt lgkmcnt(6)
    v_mfma_f32_16x16x32_bf16 v[76:79], v[96:99], v[156:159], v[76:79]
    ds_read_b64_tr_b16 v[88:89], v2 offset:57632
    v_mfma_f32_16x16x32_bf16 v[80:83], v[96:99], v[160:163], v[80:83]
    ds_read_b64_tr_b16 v[90:91], v2 offset:61728
    s_waitcnt vmcnt(11) lgkmcnt(6)
    v_mfma_f32_16x16x32_bf16 v[20:23], v[100:103], v[164:167], v[20:23]
    ds_read_b64_tr_b16 v[92:93], v3 offset:57856
    s_waitcnt vmcnt(10)
    v_mfma_f32_16x16x32_bf16 v[24:27], v[100:103], v[168:171], v[24:27]
    ds_read_b64_tr_b16 v[94:95], v3 offset:61952
    s_waitcnt lgkmcnt(6)
    v_mfma_f32_16x16x32_bf16 v[28:31], v[104:107], v[164:167], v[28:31]
    ds_read_b64_tr_b16 v[96:97], v2 offset:57888
    v_mfma_f32_16x16x32_bf16 v[32:35], v[104:107], v[168:171], v[32:35]
    ds_read_b64_tr_b16 v[98:99], v2 offset:61984
    s_add_u32 s23, s21, 0x1000000
    buffer_load_dwordx4 v[148:151], v4, s[8:11], s23 offen offset:1024 sc1
    s_waitcnt lgkmcnt(6)
    v_mfma_f32_16x16x32_bf16 v[36:39], v[84:87], v[164:167], v[36:39]
    ds_read_b64_tr_b16 v[100:101], v3 offset:58112
    v_mfma_f32_16x16x32_bf16 v[40:43], v[84:87], v[168:171], v[40:43]
    ds_read_b64_tr_b16 v[102:103], v3 offset:62208
    s_waitcnt lgkmcnt(6)
    v_mfma_f32_16x16x32_bf16 v[44:47], v[88:91], v[164:167], v[44:47]
    ds_read_b64_tr_b16 v[104:105], v2 offset:58144
    v_mfma_f32_16x16x32_bf16 v[48:51], v[88:91], v[168:171], v[48:51]
    ds_read_b64_tr_b16 v[106:107], v2 offset:62240
    s_waitcnt lgkmcnt(6)
    v_mfma_f32_16x16x32_bf16 v[52:55], v[92:95], v[164:167], v[52:55]
    v_mfma_f32_16x16x32_bf16 v[56:59], v[92:95], v[168:171], v[56:59]
    s_barrier
    ds_read_b64_tr_b16 v[84:85], v15 offset:0
    ds_read_b64_tr_b16 v[86:87], v15 offset:4096
    s_waitcnt lgkmcnt(6)
    v_mfma_f32_16x16x32_bf16 v[60:63], v[96:99], v[164:167], v[60:63]
    ds_read_b64_tr_b16 v[88:89], v16 offset:32
    v_mfma_f32_16x16x32_bf16 v[64:67], v[96:99], v[168:171], v[64:67]
    ds_read_b64_tr_b16 v[90:91], v16 offset:4128
    s_add_u32 s23, s21, 0x1020000
    buffer_load_dwordx4 v[152:155], v4, s[8:11], s23 offen offset:1024 sc1
    s_waitcnt lgkmcnt(6)
    v_mfma_f32_16x16x32_bf16 v[68:71], v[100:103], v[164:167], v[68:71]
    ds_read_b64_tr_b16 v[92:93], v15 offset:256
    v_mfma_f32_16x16x32_bf16 v[72:75], v[100:103], v[168:171], v[72:75]
    ds_read_b64_tr_b16 v[94:95], v15 offset:4352
    s_waitcnt lgkmcnt(6)
    v_mfma_f32_16x16x32_bf16 v[76:79], v[104:107], v[164:167], v[76:79]
    ds_read_b64_tr_b16 v[96:97], v16 offset:288
    v_mfma_f32_16x16x32_bf16 v[80:83], v[104:107], v[168:171], v[80:83]
    ds_read_b64_tr_b16 v[98:99], v16 offset:4384
    s_waitcnt vmcnt(11) lgkmcnt(6)
    v_mfma_f32_16x16x32_bf16 v[20:23], v[84:87], v[188:191], v[20:23]
    ds_read_b64_tr_b16 v[100:101], v15 offset:512
    s_waitcnt vmcnt(10)
    v_mfma_f32_16x16x32_bf16 v[24:27], v[84:87], v[192:195], v[24:27]
    ds_read_b64_tr_b16 v[102:103], v15 offset:4608
    s_waitcnt lgkmcnt(6)
    v_mfma_f32_16x16x32_bf16 v[28:31], v[88:91], v[188:191], v[28:31]
    ds_read_b64_tr_b16 v[104:105], v16 offset:544
    v_mfma_f32_16x16x32_bf16 v[32:35], v[88:91], v[192:195], v[32:35]
    ds_read_b64_tr_b16 v[106:107], v16 offset:4640
    s_add_u32 s23, s21, 0x1000800
    buffer_load_dwordx4 v[156:159], v4, s[8:11], s23 offen offset:0 sc1
    s_waitcnt lgkmcnt(6)
    v_mfma_f32_16x16x32_bf16 v[36:39], v[92:95], v[188:191], v[36:39]
    ds_read_b64_tr_b16 v[84:85], v15 offset:768
    v_mfma_f32_16x16x32_bf16 v[40:43], v[92:95], v[192:195], v[40:43]
    ds_read_b64_tr_b16 v[86:87], v15 offset:4864
    s_waitcnt lgkmcnt(6)
    v_mfma_f32_16x16x32_bf16 v[44:47], v[96:99], v[188:191], v[44:47]
    ds_read_b64_tr_b16 v[88:89], v16 offset:800
    v_mfma_f32_16x16x32_bf16 v[48:51], v[96:99], v[192:195], v[48:51]
    ds_read_b64_tr_b16 v[90:91], v16 offset:4896
    s_waitcnt lgkmcnt(6)
    v_mfma_f32_16x16x32_bf16 v[52:55], v[100:103], v[188:191], v[52:55]
    ds_read_b64_tr_b16 v[92:93], v15 offset:8192
    v_mfma_f32_16x16x32_bf16 v[56:59], v[100:103], v[192:195], v[56:59]
    ds_read_b64_tr_b16 v[94:95], v15 offset:12288
    s_waitcnt lgkmcnt(6)
    v_mfma_f32_16x16x32_bf16 v[60:63], v[104:107], v[188:191], v[60:63]
    ds_read_b64_tr_b16 v[96:97], v16 offset:8224
    v_mfma_f32_16x16x32_bf16 v[64:67], v[104:107], v[192:195], v[64:67]
    ds_read_b64_tr_b16 v[98:99], v16 offset:12320
    s_add_u32 s23, s21, 0x1020800
    buffer_load_dwordx4 v[160:163], v4, s[8:11], s23 offen offset:0 sc1
    s_waitcnt lgkmcnt(6)
    v_mfma_f32_16x16x32_bf16 v[68:71], v[84:87], v[188:191], v[68:71]
    ds_read_b64_tr_b16 v[100:101], v15 offset:8448
    v_mfma_f32_16x16x32_bf16 v[72:75], v[84:87], v[192:195], v[72:75]
    ds_read_b64_tr_b16 v[102:103], v15 offset:12544
    s_waitcnt lgkmcnt(6)
    v_mfma_f32_16x16x32_bf16 v[76:79], v[88:91], v[188:191], v[76:79]
    ds_read_b64_tr_b16 v[104:105], v16 offset:8480
    v_mfma_f32_16x16x32_bf16 v[80:83], v[88:91], v[192:195], v[80:83]
    ds_read_b64_tr_b16 v[106:107], v16 offset:12576
    s_waitcnt vmcnt(11) lgkmcnt(6)
    v_mfma_f32_16x16x32_bf16 v[20:23], v[92:95], v[196:199], v[20:23]
    ds_read_b64_tr_b16 v[84:85], v15 offset:8704
    s_waitcnt vmcnt(10)
    v_mfma_f32_16x16x32_bf16 v[24:27], v[92:95], v[200:203], v[24:27]
    ds_read_b64_tr_b16 v[86:87], v15 offset:12800
    s_waitcnt lgkmcnt(6)
    v_mfma_f32_16x16x32_bf16 v[28:31], v[96:99], v[196:199], v[28:31]
    ds_read_b64_tr_b16 v[88:89], v16 offset:8736
    v_mfma_f32_16x16x32_bf16 v[32:35], v[96:99], v[200:203], v[32:35]
    ds_read_b64_tr_b16 v[90:91], v16 offset:12832
    s_add_u32 s23, s21, 0x1000800
    buffer_load_dwordx4 v[164:167], v4, s[8:11], s23 offen offset:1024 sc1
    s_waitcnt lgkmcnt(6)
    v_mfma_f32_16x16x32_bf16 v[36:39], v[100:103], v[196:199], v[36:39]
    ds_read_b64_tr_b16 v[92:93], v15 offset:8960
    v_mfma_f32_16x16x32_bf16 v[40:43], v[100:103], v[200:203], v[40:43]
    ds_read_b64_tr_b16 v[94:95], v15 offset:13056
    s_waitcnt lgkmcnt(6)
    v_mfma_f32_16x16x32_bf16 v[44:47], v[104:107], v[196:199], v[44:47]
    ds_read_b64_tr_b16 v[96:97], v16 offset:8992
    v_mfma_f32_16x16x32_bf16 v[48:51], v[104:107], v[200:203], v[48:51]
    ds_read_b64_tr_b16 v[98:99], v16 offset:13088
    s_waitcnt lgkmcnt(6)
    v_mfma_f32_16x16x32_bf16 v[52:55], v[84:87], v[196:199], v[52:55]
    ds_read_b64_tr_b16 v[100:101], v15 offset:16384
    v_mfma_f32_16x16x32_bf16 v[56:59], v[84:87], v[200:203], v[56:59]
    ds_read_b64_tr_b16 v[102:103], v15 offset:20480
    s_waitcnt lgkmcnt(6)
    v_mfma_f32_16x16x32_bf16 v[60:63], v[88:91], v[196:199], v[60:63]
    ds_read_b64_tr_b16 v[104:105], v16 offset:16416
    v_mfma_f32_16x16x32_bf16 v[64:67], v[88:91], v[200:203], v[64:67]
    ds_read_b64_tr_b16 v[106:107], v16 offset:20512
    s_add_u32 s23, s21, 0x1020800
    buffer_load_dwordx4 v[168:171], v4, s[8:11], s23 offen offset:1024 sc1
    s_waitcnt lgkmcnt(6)
    v_mfma_f32_16x16x32_bf16 v[68:71], v[92:95], v[196:199], v[68:71]
    ds_read_b64_tr_b16 v[84:85], v15 offset:24576
    v_mfma_f32_16x16x32_bf16 v[72:75], v[92:95], v[200:203], v[72:75]
    ds_read_b64_tr_b16 v[86:87], v15 offset:28672
    s_waitcnt lgkmcnt(6)
    v_mfma_f32_16x16x32_bf16 v[76:79], v[96:99], v[196:199], v[76:79]
    ds_read_b64_tr_b16 v[88:89], v16 offset:24608
    v_mfma_f32_16x16x32_bf16 v[80:83], v[96:99], v[200:203], v[80:83]
    ds_read_b64_tr_b16 v[90:91], v16 offset:28704
    s_waitcnt vmcnt(11) lgkmcnt(6)
    v_mfma_f32_16x16x32_bf16 v[20:23], v[100:103], v[108:111], v[20:23]
    ds_read_b64_tr_b16 v[92:93], v15 offset:32768
    s_waitcnt vmcnt(10)
    v_mfma_f32_16x16x32_bf16 v[24:27], v[100:103], v[112:115], v[24:27]
    ds_read_b64_tr_b16 v[94:95], v15 offset:36864
    s_waitcnt lgkmcnt(6)
    v_mfma_f32_16x16x32_bf16 v[28:31], v[104:107], v[108:111], v[28:31]
    ds_read_b64_tr_b16 v[96:97], v16 offset:32800
    v_mfma_f32_16x16x32_bf16 v[32:35], v[104:107], v[112:115], v[32:35]
    ds_read_b64_tr_b16 v[98:99], v16 offset:36896
    s_waitcnt vmcnt(9) lgkmcnt(6)
    v_mfma_f32_16x16x32_bf16 v[20:23], v[84:87], v[116:119], v[20:23]
    ds_read_b64_tr_b16 v[100:101], v15 offset:40960
    s_waitcnt vmcnt(8)
    v_mfma_f32_16x16x32_bf16 v[24:27], v[84:87], v[120:123], v[24:27]
    ds_read_b64_tr_b16 v[102:103], v15 offset:45056
    s_waitcnt lgkmcnt(6)
    v_mfma_f32_16x16x32_bf16 v[28:31], v[88:91], v[116:119], v[28:31]
    ds_read_b64_tr_b16 v[104:105], v16 offset:40992
    v_mfma_f32_16x16x32_bf16 v[32:35], v[88:91], v[120:123], v[32:35]
    ds_read_b64_tr_b16 v[106:107], v16 offset:45088
    s_waitcnt vmcnt(7) lgkmcnt(6)
    v_mfma_f32_16x16x32_bf16 v[20:23], v[92:95], v[140:143], v[20:23]
    ds_read_b64_tr_b16 v[84:85], v15 offset:49152
    s_waitcnt vmcnt(6)
    v_mfma_f32_16x16x32_bf16 v[24:27], v[92:95], v[144:147], v[24:27]
    ds_read_b64_tr_b16 v[86:87], v15 offset:53248
    s_waitcnt lgkmcnt(6)
    v_mfma_f32_16x16x32_bf16 v[28:31], v[96:99], v[140:143], v[28:31]
    ds_read_b64_tr_b16 v[88:89], v16 offset:49184
    v_mfma_f32_16x16x32_bf16 v[32:35], v[96:99], v[144:147], v[32:35]
    ds_read_b64_tr_b16 v[90:91], v16 offset:53280
    s_waitcnt vmcnt(5) lgkmcnt(6)
    v_mfma_f32_16x16x32_bf16 v[20:23], v[100:103], v[148:151], v[20:23]
    ds_read_b64_tr_b16 v[92:93], v15 offset:57344
    s_waitcnt vmcnt(4)
    v_mfma_f32_16x16x32_bf16 v[24:27], v[100:103], v[152:155], v[24:27]
    ds_read_b64_tr_b16 v[94:95], v15 offset:61440
    s_waitcnt lgkmcnt(6)
    v_mfma_f32_16x16x32_bf16 v[28:31], v[104:107], v[148:151], v[28:31]
    ds_read_b64_tr_b16 v[96:97], v16 offset:57376
    v_mfma_f32_16x16x32_bf16 v[32:35], v[104:107], v[152:155], v[32:35]
    ds_read_b64_tr_b16 v[98:99], v16 offset:61472
    s_waitcnt vmcnt(3) lgkmcnt(6)
    v_mfma_f32_16x16x32_bf16 v[20:23], v[84:87], v[156:159], v[20:23]
    ds_read_b64_tr_b16 v[100:101], v15 offset:16640
    s_waitcnt vmcnt(2)
    v_mfma_f32_16x16x32_bf16 v[24:27], v[84:87], v[160:163], v[24:27]
    ds_read_b64_tr_b16 v[102:103], v15 offset:20736
    s_waitcnt lgkmcnt(6)
    v_mfma_f32_16x16x32_bf16 v[28:31], v[88:91], v[156:159], v[28:31]
    ds_read_b64_tr_b16 v[104:105], v16 offset:16672
    v_mfma_f32_16x16x32_bf16 v[32:35], v[88:91], v[160:163], v[32:35]
    ds_read_b64_tr_b16 v[106:107], v16 offset:20768
    s_waitcnt vmcnt(1) lgkmcnt(6)
    v_mfma_f32_16x16x32_bf16 v[20:23], v[92:95], v[164:167], v[20:23]
    ds_read_b64_tr_b16 v[84:85], v15 offset:24832
    s_waitcnt vmcnt(0)
    v_mfma_f32_16x16x32_bf16 v[24:27], v[92:95], v[168:171], v[24:27]
    ds_read_b64_tr_b16 v[86:87], v15 offset:28928
    s_waitcnt lgkmcnt(6)
    v_mfma_f32_16x16x32_bf16 v[28:31], v[96:99], v[164:167], v[28:31]
    ds_read_b64_tr_b16 v[88:89], v16 offset:24864
    v_mfma_f32_16x16x32_bf16 v[32:35], v[96:99], v[168:171], v[32:35]
    ds_read_b64_tr_b16 v[90:91], v16 offset:28960
    ds_read_b128 v[124:127], v13 offset:0
    ds_read_b128 v[128:131], v13 offset:64
    s_waitcnt lgkmcnt(8)
    v_mfma_f32_16x16x32_bf16 v[36:39], v[100:103], v[108:111], v[36:39]
    ds_read_b64_tr_b16 v[92:93], v15 offset:33024
    v_mfma_f32_16x16x32_bf16 v[40:43], v[100:103], v[112:115], v[40:43]
    ds_read_b64_tr_b16 v[94:95], v15 offset:37120
    s_waitcnt lgkmcnt(8)
    v_mfma_f32_16x16x32_bf16 v[44:47], v[104:107], v[108:111], v[44:47]
    ds_read_b64_tr_b16 v[96:97], v16 offset:33056
    v_mfma_f32_16x16x32_bf16 v[48:51], v[104:107], v[112:115], v[48:51]
    ds_read_b64_tr_b16 v[98:99], v16 offset:37152
    s_waitcnt lgkmcnt(8)
    v_mfma_f32_16x16x32_bf16 v[36:39], v[84:87], v[116:119], v[36:39]
    s_waitcnt lgkmcnt(5)
    v_pk_mul_f32 v[132:133], v[20:21], v[124:125]
    v_pk_mul_f32 v[134:135], v[22:23], v[126:127]
    ds_read_b64_tr_b16 v[100:101], v15 offset:41216
    v_mfma_f32_16x16x32_bf16 v[40:43], v[84:87], v[120:123], v[40:43]
    s_waitcnt lgkmcnt(5)
    v_pk_mul_f32 v[136:137], v[28:29], v[128:129]
    ds_read_b64_tr_b16 v[102:103], v15 offset:45312
    v_mfma_f32_16x16x32_bf16 v[44:47], v[88:91], v[116:119], v[44:47]
    v_pk_mul_f32 v[138:139], v[30:31], v[130:131]
    v_cvt_pk_bf16_f32 v132, v132, v133
    ds_read_b64_tr_b16 v[104:105], v16 offset:41248
    v_mfma_f32_16x16x32_bf16 v[48:51], v[88:91], v[120:123], v[48:51]
    v_cvt_pk_bf16_f32 v133, v134, v135
    ds_read_b64_tr_b16 v[106:107], v16 offset:45344
    s_waitcnt lgkmcnt(6)
    v_mfma_f32_16x16x32_bf16 v[36:39], v[92:95], v[140:143], v[36:39]
    v_cvt_pk_bf16_f32 v134, v136, v137
    v_cvt_pk_bf16_f32 v135, v138, v139
    ds_read_b64_tr_b16 v[84:85], v15 offset:49408
    v_mfma_f32_16x16x32_bf16 v[40:43], v[92:95], v[144:147], v[40:43]
    v_permlane32_swap_b32 v132, v134
    ds_read_b64_tr_b16 v[86:87], v15 offset:53504
    s_waitcnt lgkmcnt(6)
    v_mfma_f32_16x16x32_bf16 v[44:47], v[96:99], v[140:143], v[44:47]
    v_permlane32_swap_b32 v133, v135
    v_permlane16_swap_b32 v132, v134
    ds_read_b64_tr_b16 v[88:89], v16 offset:49440
    v_mfma_f32_16x16x32_bf16 v[48:51], v[96:99], v[144:147], v[48:51]
    v_permlane16_swap_b32 v133, v135
    ds_read_b64_tr_b16 v[90:91], v16 offset:53536
    s_waitcnt lgkmcnt(6)
    v_mfma_f32_16x16x32_bf16 v[36:39], v[100:103], v[148:151], v[36:39]
    buffer_store_dwordx4 v[132:135], v14, s[8:11], s18 offen offset:0 sc1
    ds_read_b64_tr_b16 v[92:93], v15 offset:57600
    v_mfma_f32_16x16x32_bf16 v[40:43], v[100:103], v[152:155], v[40:43]
    v_pk_mul_f32 v[132:133], v[24:25], v[124:125]
    v_pk_mul_f32 v[134:135], v[26:27], v[126:127]
    ds_read_b64_tr_b16 v[94:95], v15 offset:61696
    s_waitcnt lgkmcnt(6)
    v_mfma_f32_16x16x32_bf16 v[44:47], v[104:107], v[148:151], v[44:47]
    v_pk_mul_f32 v[136:137], v[32:33], v[128:129]
    ds_read_b64_tr_b16 v[96:97], v16 offset:57632
    v_mfma_f32_16x16x32_bf16 v[48:51], v[104:107], v[152:155], v[48:51]
    v_pk_mul_f32 v[138:139], v[34:35], v[130:131]
    v_cvt_pk_bf16_f32 v132, v132, v133
    ds_read_b64_tr_b16 v[98:99], v16 offset:61728
    s_waitcnt lgkmcnt(6)
    v_mfma_f32_16x16x32_bf16 v[36:39], v[84:87], v[156:159], v[36:39]
    v_cvt_pk_bf16_f32 v133, v134, v135
    ds_read_b64_tr_b16 v[100:101], v15 offset:16896
    v_mfma_f32_16x16x32_bf16 v[40:43], v[84:87], v[160:163], v[40:43]
    v_cvt_pk_bf16_f32 v134, v136, v137
    v_cvt_pk_bf16_f32 v135, v138, v139
    ds_read_b64_tr_b16 v[102:103], v15 offset:20992
    s_waitcnt lgkmcnt(6)
    v_mfma_f32_16x16x32_bf16 v[44:47], v[88:91], v[156:159], v[44:47]
    v_permlane32_swap_b32 v132, v134
    ds_read_b64_tr_b16 v[104:105], v16 offset:16928
    v_mfma_f32_16x16x32_bf16 v[48:51], v[88:91], v[160:163], v[48:51]
    v_permlane32_swap_b32 v133, v135
    v_permlane16_swap_b32 v132, v134
    ds_read_b64_tr_b16 v[106:107], v16 offset:21024
    s_waitcnt lgkmcnt(6)
    v_mfma_f32_16x16x32_bf16 v[36:39], v[92:95], v[164:167], v[36:39]
    v_permlane16_swap_b32 v133, v135
    ds_read_b64_tr_b16 v[84:85], v15 offset:25088
    v_mfma_f32_16x16x32_bf16 v[40:43], v[92:95], v[168:171], v[40:43]
    buffer_store_dwordx4 v[132:135], v14, s[8:11], s19 offen offset:0 sc1
    ds_read_b64_tr_b16 v[86:87], v15 offset:29184
    s_waitcnt lgkmcnt(6)
    v_mfma_f32_16x16x32_bf16 v[44:47], v[96:99], v[164:167], v[44:47]
    ds_read_b64_tr_b16 v[88:89], v16 offset:25120
    v_mfma_f32_16x16x32_bf16 v[48:51], v[96:99], v[168:171], v[48:51]
    ds_read_b64_tr_b16 v[90:91], v16 offset:29216
    ds_read_b128 v[124:127], v13 offset:128
    ds_read_b128 v[128:131], v13 offset:192
    s_waitcnt lgkmcnt(8)
    v_mfma_f32_16x16x32_bf16 v[52:55], v[100:103], v[108:111], v[52:55]
    ds_read_b64_tr_b16 v[92:93], v15 offset:33280
    v_mfma_f32_16x16x32_bf16 v[56:59], v[100:103], v[112:115], v[56:59]
    ds_read_b64_tr_b16 v[94:95], v15 offset:37376
    s_waitcnt lgkmcnt(8)
    v_mfma_f32_16x16x32_bf16 v[60:63], v[104:107], v[108:111], v[60:63]
    ds_read_b64_tr_b16 v[96:97], v16 offset:33312
    v_mfma_f32_16x16x32_bf16 v[64:67], v[104:107], v[112:115], v[64:67]
    ds_read_b64_tr_b16 v[98:99], v16 offset:37408
    s_waitcnt lgkmcnt(8)
    v_mfma_f32_16x16x32_bf16 v[52:55], v[84:87], v[116:119], v[52:55]
    s_waitcnt lgkmcnt(5)
    v_pk_mul_f32 v[132:133], v[36:37], v[124:125]
    v_pk_mul_f32 v[134:135], v[38:39], v[126:127]
    ds_read_b64_tr_b16 v[100:101], v15 offset:41472
    v_mfma_f32_16x16x32_bf16 v[56:59], v[84:87], v[120:123], v[56:59]
    s_waitcnt lgkmcnt(5)
    v_pk_mul_f32 v[136:137], v[44:45], v[128:129]
    ds_read_b64_tr_b16 v[102:103], v15 offset:45568
    v_mfma_f32_16x16x32_bf16 v[60:63], v[88:91], v[116:119], v[60:63]
    v_pk_mul_f32 v[138:139], v[46:47], v[130:131]
    v_cvt_pk_bf16_f32 v132, v132, v133
    ds_read_b64_tr_b16 v[104:105], v16 offset:41504
    v_mfma_f32_16x16x32_bf16 v[64:67], v[88:91], v[120:123], v[64:67]
    v_cvt_pk_bf16_f32 v133, v134, v135
    ds_read_b64_tr_b16 v[106:107], v16 offset:45600
    s_waitcnt lgkmcnt(6)
    v_mfma_f32_16x16x32_bf16 v[52:55], v[92:95], v[140:143], v[52:55]
    v_cvt_pk_bf16_f32 v134, v136, v137
    v_cvt_pk_bf16_f32 v135, v138, v139
    ds_read_b64_tr_b16 v[84:85], v15 offset:49664
    v_mfma_f32_16x16x32_bf16 v[56:59], v[92:95], v[144:147], v[56:59]
    v_permlane32_swap_b32 v132, v134
    ds_read_b64_tr_b16 v[86:87], v15 offset:53760
    s_waitcnt lgkmcnt(6)
    v_mfma_f32_16x16x32_bf16 v[60:63], v[96:99], v[140:143], v[60:63]
    v_permlane32_swap_b32 v133, v135
    v_permlane16_swap_b32 v132, v134
    ds_read_b64_tr_b16 v[88:89], v16 offset:49696
    v_mfma_f32_16x16x32_bf16 v[64:67], v[96:99], v[144:147], v[64:67]
    v_permlane16_swap_b32 v133, v135
    ds_read_b64_tr_b16 v[90:91], v16 offset:53792
    s_waitcnt lgkmcnt(6)
    v_mfma_f32_16x16x32_bf16 v[52:55], v[100:103], v[148:151], v[52:55]
    buffer_store_dwordx4 v[132:135], v14, s[8:11], s18 offen offset:1024 sc1
    ds_read_b64_tr_b16 v[92:93], v15 offset:57856
    v_mfma_f32_16x16x32_bf16 v[56:59], v[100:103], v[152:155], v[56:59]
    v_pk_mul_f32 v[132:133], v[40:41], v[124:125]
    v_pk_mul_f32 v[134:135], v[42:43], v[126:127]
    ds_read_b64_tr_b16 v[94:95], v15 offset:61952
    s_waitcnt lgkmcnt(6)
    v_mfma_f32_16x16x32_bf16 v[60:63], v[104:107], v[148:151], v[60:63]
    v_pk_mul_f32 v[136:137], v[48:49], v[128:129]
    ds_read_b64_tr_b16 v[96:97], v16 offset:57888
    v_mfma_f32_16x16x32_bf16 v[64:67], v[104:107], v[152:155], v[64:67]
    v_pk_mul_f32 v[138:139], v[50:51], v[130:131]
    v_cvt_pk_bf16_f32 v132, v132, v133
    ds_read_b64_tr_b16 v[98:99], v16 offset:61984
    s_waitcnt lgkmcnt(6)
    v_mfma_f32_16x16x32_bf16 v[52:55], v[84:87], v[156:159], v[52:55]
    v_cvt_pk_bf16_f32 v133, v134, v135
    ds_read_b64_tr_b16 v[100:101], v15 offset:17152
    v_mfma_f32_16x16x32_bf16 v[56:59], v[84:87], v[160:163], v[56:59]
    v_cvt_pk_bf16_f32 v134, v136, v137
    v_cvt_pk_bf16_f32 v135, v138, v139
    ds_read_b64_tr_b16 v[102:103], v15 offset:21248
    s_waitcnt lgkmcnt(6)
    v_mfma_f32_16x16x32_bf16 v[60:63], v[88:91], v[156:159], v[60:63]
    v_permlane32_swap_b32 v132, v134
    ds_read_b64_tr_b16 v[104:105], v16 offset:17184
    v_mfma_f32_16x16x32_bf16 v[64:67], v[88:91], v[160:163], v[64:67]
    v_permlane32_swap_b32 v133, v135
    v_permlane16_swap_b32 v132, v134
    ds_read_b64_tr_b16 v[106:107], v16 offset:21280
    s_waitcnt lgkmcnt(6)
    v_mfma_f32_16x16x32_bf16 v[52:55], v[92:95], v[164:167], v[52:55]
    v_permlane16_swap_b32 v133, v135
    ds_read_b64_tr_b16 v[84:85], v15 offset:25344
    v_mfma_f32_16x16x32_bf16 v[56:59], v[92:95], v[168:171], v[56:59]
    buffer_store_dwordx4 v[132:135], v14, s[8:11], s19 offen offset:1024 sc1
    ds_read_b64_tr_b16 v[86:87], v15 offset:29440
    s_waitcnt lgkmcnt(6)
    v_mfma_f32_16x16x32_bf16 v[60:63], v[96:99], v[164:167], v[60:63]
    ds_read_b64_tr_b16 v[88:89], v16 offset:25376
    v_mfma_f32_16x16x32_bf16 v[64:67], v[96:99], v[168:171], v[64:67]
    ds_read_b64_tr_b16 v[90:91], v16 offset:29472
    ds_read_b128 v[124:127], v13 offset:256
    ds_read_b128 v[128:131], v13 offset:320
    s_waitcnt lgkmcnt(8)
    v_mfma_f32_16x16x32_bf16 v[68:71], v[100:103], v[108:111], v[68:71]
    ds_read_b64_tr_b16 v[92:93], v15 offset:33536
    v_mfma_f32_16x16x32_bf16 v[72:75], v[100:103], v[112:115], v[72:75]
    ds_read_b64_tr_b16 v[94:95], v15 offset:37632
    s_waitcnt lgkmcnt(8)
    v_mfma_f32_16x16x32_bf16 v[76:79], v[104:107], v[108:111], v[76:79]
    ds_read_b64_tr_b16 v[96:97], v16 offset:33568
    v_mfma_f32_16x16x32_bf16 v[80:83], v[104:107], v[112:115], v[80:83]
    ds_read_b64_tr_b16 v[98:99], v16 offset:37664
    s_waitcnt lgkmcnt(8)
    v_mfma_f32_16x16x32_bf16 v[68:71], v[84:87], v[116:119], v[68:71]
    s_waitcnt lgkmcnt(5)
    v_pk_mul_f32 v[132:133], v[52:53], v[124:125]
    v_pk_mul_f32 v[134:135], v[54:55], v[126:127]
    ds_read_b64_tr_b16 v[100:101], v15 offset:41728
    v_mfma_f32_16x16x32_bf16 v[72:75], v[84:87], v[120:123], v[72:75]
    s_waitcnt lgkmcnt(5)
    v_pk_mul_f32 v[136:137], v[60:61], v[128:129]
    ds_read_b64_tr_b16 v[102:103], v15 offset:45824
    v_mfma_f32_16x16x32_bf16 v[76:79], v[88:91], v[116:119], v[76:79]
    v_pk_mul_f32 v[138:139], v[62:63], v[130:131]
    v_cvt_pk_bf16_f32 v132, v132, v133
    ds_read_b64_tr_b16 v[104:105], v16 offset:41760
    v_mfma_f32_16x16x32_bf16 v[80:83], v[88:91], v[120:123], v[80:83]
    v_cvt_pk_bf16_f32 v133, v134, v135
    ds_read_b64_tr_b16 v[106:107], v16 offset:45856
    s_waitcnt lgkmcnt(6)
    v_mfma_f32_16x16x32_bf16 v[68:71], v[92:95], v[140:143], v[68:71]
    v_cvt_pk_bf16_f32 v134, v136, v137
    v_cvt_pk_bf16_f32 v135, v138, v139
    ds_read_b64_tr_b16 v[84:85], v15 offset:49920
    v_mfma_f32_16x16x32_bf16 v[72:75], v[92:95], v[144:147], v[72:75]
    v_permlane32_swap_b32 v132, v134
    ds_read_b64_tr_b16 v[86:87], v15 offset:54016
    s_waitcnt lgkmcnt(6)
    v_mfma_f32_16x16x32_bf16 v[76:79], v[96:99], v[140:143], v[76:79]
    v_permlane32_swap_b32 v133, v135
    v_permlane16_swap_b32 v132, v134
    ds_read_b64_tr_b16 v[88:89], v16 offset:49952
    v_mfma_f32_16x16x32_bf16 v[80:83], v[96:99], v[144:147], v[80:83]
    v_permlane16_swap_b32 v133, v135
    ds_read_b64_tr_b16 v[90:91], v16 offset:54048
    s_waitcnt lgkmcnt(6)
    v_mfma_f32_16x16x32_bf16 v[68:71], v[100:103], v[148:151], v[68:71]
    buffer_store_dwordx4 v[132:135], v14, s[8:11], s18 offen offset:2048 sc1
    ds_read_b64_tr_b16 v[92:93], v15 offset:58112
    v_mfma_f32_16x16x32_bf16 v[72:75], v[100:103], v[152:155], v[72:75]
    v_pk_mul_f32 v[132:133], v[56:57], v[124:125]
    v_pk_mul_f32 v[134:135], v[58:59], v[126:127]
    ds_read_b64_tr_b16 v[94:95], v15 offset:62208
    s_waitcnt lgkmcnt(6)
    v_mfma_f32_16x16x32_bf16 v[76:79], v[104:107], v[148:151], v[76:79]
    v_pk_mul_f32 v[136:137], v[64:65], v[128:129]
    ds_read_b64_tr_b16 v[96:97], v16 offset:58144
    v_mfma_f32_16x16x32_bf16 v[80:83], v[104:107], v[152:155], v[80:83]
    v_pk_mul_f32 v[138:139], v[66:67], v[130:131]
    v_cvt_pk_bf16_f32 v132, v132, v133
    ds_read_b64_tr_b16 v[98:99], v16 offset:62240
    s_waitcnt lgkmcnt(6)
    v_mfma_f32_16x16x32_bf16 v[68:71], v[84:87], v[156:159], v[68:71]
    v_cvt_pk_bf16_f32 v133, v134, v135
    v_mfma_f32_16x16x32_bf16 v[72:75], v[84:87], v[160:163], v[72:75]
    v_cvt_pk_bf16_f32 v134, v136, v137
    v_cvt_pk_bf16_f32 v135, v138, v139
    s_waitcnt lgkmcnt(4)
    v_mfma_f32_16x16x32_bf16 v[76:79], v[88:91], v[156:159], v[76:79]
    v_permlane32_swap_b32 v132, v134
    v_mfma_f32_16x16x32_bf16 v[80:83], v[88:91], v[160:163], v[80:83]
    v_permlane32_swap_b32 v133, v135
    v_permlane16_swap_b32 v132, v134
    s_waitcnt lgkmcnt(2)
    v_mfma_f32_16x16x32_bf16 v[68:71], v[92:95], v[164:167], v[68:71]
    v_permlane16_swap_b32 v133, v135
    v_mfma_f32_16x16x32_bf16 v[72:75], v[92:95], v[168:171], v[72:75]
    buffer_store_dwordx4 v[132:135], v14, s[8:11], s19 offen offset:2048 sc1
    s_waitcnt lgkmcnt(0)
    v_mfma_f32_16x16x32_bf16 v[76:79], v[96:99], v[164:167], v[76:79]
    v_mfma_f32_16x16x32_bf16 v[80:83], v[96:99], v[168:171], v[80:83]
    ds_read_b128 v[124:127], v13 offset:384
    ds_read_b128 v[128:131], v13 offset:448
    s_waitcnt lgkmcnt(1)
    v_pk_mul_f32 v[132:133], v[68:69], v[124:125]
    v_pk_mul_f32 v[134:135], v[70:71], v[126:127]
    s_waitcnt lgkmcnt(0)
    s_nop 0
    v_pk_mul_f32 v[136:137], v[76:77], v[128:129]
    v_pk_mul_f32 v[138:139], v[78:79], v[130:131]
    v_cvt_pk_bf16_f32 v132, v132, v133
    v_cvt_pk_bf16_f32 v133, v134, v135
    v_cvt_pk_bf16_f32 v134, v136, v137
    v_cvt_pk_bf16_f32 v135, v138, v139
    s_nop 0
    v_permlane32_swap_b32 v132, v134
    v_permlane32_swap_b32 v133, v135
    s_nop 0
    v_permlane16_swap_b32 v132, v134
    v_permlane16_swap_b32 v133, v135
    buffer_store_dwordx4 v[132:135], v14, s[8:11], s18 offen offset:3072 sc1
    s_nop 1
    v_pk_mul_f32 v[132:133], v[72:73], v[124:125]
    v_pk_mul_f32 v[134:135], v[74:75], v[126:127]
    v_pk_mul_f32 v[136:137], v[80:81], v[128:129]
    v_pk_mul_f32 v[138:139], v[82:83], v[130:131]
    v_cvt_pk_bf16_f32 v132, v132, v133
    v_cvt_pk_bf16_f32 v133, v134, v135
    v_cvt_pk_bf16_f32 v134, v136, v137
    v_cvt_pk_bf16_f32 v135, v138, v139
    s_nop 0
    v_permlane32_swap_b32 v132, v134
    v_permlane32_swap_b32 v133, v135
    s_nop 0
    v_permlane16_swap_b32 v132, v134
    v_permlane16_swap_b32 v133, v135
    buffer_store_dwordx4 v[132:135], v14, s[8:11], s19 offen offset:3072 sc1
fz_p3e:
    s_lshl_b32 s26, s13, 3
    s_add_u32 s26, s26, s3
    s_lshl_b32 s26, s26, 7
    s_lshl_b32 s27, s12, 2
    s_add_u32 s26, s26, s27
    s_add_u32 s26, s26, 0x550000
    v_mov_b32 v7, s14
    v_mov_b32 v6, 0
    v_mov_b32 v16, s3
    v_lshl_add_u32 v17, v16, 6, v0
    v_lshlrev_b32 v5, 2, v17
    v_lshrrev_b32 v13, 3, v8
    v_and_b32 v14, 7, v8
    s_lshl_b32 s16, s13, 8
    s_lshl_b32 s27, s12, 3
    s_add_u32 s16, s16, s27
    s_add_u32 s16, s16, s3
    s_lshl_b32 s17, s16, 11
    s_mov_b64 s[28:29], s[32:33]
    s_mov_b32 s30, 0x400000
    s_mov_b32 s31, 0x20000
    s_mov_b64 s[64:65], s[56:57]
    s_mov_b32 s66, 0x400000
    s_mov_b32 s67, 0x20000
    v_add_u32 v15, 0x20000, v1
    ds_read_b128 v[72:75], v15 offset:0
    ds_read_b128 v[76:79], v15 offset:1024
    ds_read_b128 v[80:83], v15 offset:2048
    ds_read_b128 v[84:87], v15 offset:3072
    ds_read_b128 v[88:91], v15 offset:4096
    ds_read_b128 v[92:95], v15 offset:5120
    ds_read_b128 v[96:99], v15 offset:6144
    ds_read_b128 v[100:103], v15 offset:7168
    s_waitcnt vmcnt(0)
    s_mov_b64 exec, 1
    buffer_store_dword v7, v6, s[8:11], s26 offen sc1
    s_mov_b64 exec, -1
    buffer_load_dwordx4 v[128:131], v1, s[28:31], s17 offen offset:0
    buffer_load_dwordx4 v[132:135], v1, s[28:31], s17 offen offset:1024
    v_mov_b32 v190, 0
    v_mov_b32 v196, 0
    s_waitcnt lgkmcnt(5)
    v_lshlrev_b32 v144, 16, v80
    v_and_b32 v145, 0xffff0000, v80
    s_waitcnt lgkmcnt(1)
    v_lshlrev_b32 v146, 16, v96
    v_and_b32 v147, 0xffff0000, v96
    v_pk_mul_f32 v[104:105], v[144:145], v[146:147]
    v_lshlrev_b32 v144, 16, v72
    v_and_b32 v145, 0xffff0000, v72
    v_fmac_f32 v190, v144, v146
    v_fmac_f32 v190, v145, v147
    v_add_f32 v196, v196, v104
    v_add_f32 v196, v196, v105
    v_lshlrev_b32 v144, 16, v81
    v_and_b32 v145, 0xffff0000, v81
    v_lshlrev_b32 v146, 16, v97
    v_and_b32 v147, 0xffff0000, v97
    v_pk_mul_f32 v[106:107], v[144:145], v[146:147]
    v_lshlrev_b32 v144, 16, v73
    v_and_b32 v145, 0xffff0000, v73
    v_fmac_f32 v190, v144, v146
    v_fmac_f32 v190, v145, v147
    v_add_f32 v196, v196, v106
    v_add_f32 v196, v196, v107
    v_lshlrev_b32 v144, 16, v82
    v_and_b32 v145, 0xffff0000, v82
    v_lshlrev_b32 v146, 16, v98
    v_and_b32 v147, 0xffff0000, v98
    v_pk_mul_f32 v[108:109], v[144:145], v[146:147]
    v_lshlrev_b32 v144, 16, v74
    v_and_b32 v145, 0xffff0000, v74
    v_fmac_f32 v190, v144, v146
    v_fmac_f32 v190, v145, v147
    v_add_f32 v196, v196, v108
    v_add_f32 v196, v196, v109
    v_lshlrev_b32 v144, 16, v83
    v_and_b32 v145, 0xffff0000, v83
    v_lshlrev_b32 v146, 16, v99
    v_and_b32 v147, 0xffff0000, v99
    v_pk_mul_f32 v[110:111], v[144:145], v[146:147]
    v_lshlrev_b32 v144, 16, v75
    v_and_b32 v145, 0xffff0000, v75
    v_fmac_f32 v190, v144, v146
    v_fmac_f32 v190, v145, v147
    v_add_f32 v196, v196, v110
    v_add_f32 v196, v196, v111
    v_lshlrev_b32 v144, 16, v84
    v_and_b32 v145, 0xffff0000, v84
    s_waitcnt lgkmcnt(0)
    v_lshlrev_b32 v146, 16, v100
    v_and_b32 v147, 0xffff0000, v100
    v_pk_mul_f32 v[112:113], v[144:145], v[146:147]
    v_lshlrev_b32 v144, 16, v76
    v_and_b32 v145, 0xffff0000, v76
    v_fmac_f32 v190, v144, v146
    v_fmac_f32 v190, v145, v147
    v_add_f32 v196, v196, v112
    v_add_f32 v196, v196, v113
    v_lshlrev_b32 v144, 16, v85
    v_and_b32 v145, 0xffff0000, v85
    v_lshlrev_b32 v146, 16, v101
    v_and_b32 v147, 0xffff0000, v101
    v_pk_mul_f32 v[114:115], v[144:145], v[146:147]
    v_lshlrev_b32 v144, 16, v77
    v_and_b32 v145, 0xffff0000, v77
    v_fmac_f32 v190, v144, v146
    v_fmac_f32 v190, v145, v147
    v_add_f32 v196, v196, v114
    v_add_f32 v196, v196, v115
    v_lshlrev_b32 v144, 16, v86
    v_and_b32 v145, 0xffff0000, v86
    v_lshlrev_b32 v146, 16, v102
    v_and_b32 v147, 0xffff0000, v102
    v_pk_mul_f32 v[116:117], v[144:145], v[146:147]
    v_lshlrev_b32 v144, 16, v78
    v_and_b32 v145, 0xffff0000, v78
    v_fmac_f32 v190, v144, v146
    v_fmac_f32 v190, v145, v147
    v_add_f32 v196, v196, v116
    v_add_f32 v196, v196, v117
    v_lshlrev_b32 v144, 16, v87
    v_and_b32 v145, 0xffff0000, v87
    v_lshlrev_b32 v146, 16, v103
    v_and_b32 v147, 0xffff0000, v103
    v_pk_mul_f32 v[118:119], v[144:145], v[146:147]
    v_lshlrev_b32 v144, 16, v79
    v_and_b32 v145, 0xffff0000, v79
    v_fmac_f32 v190, v144, v146
    v_fmac_f32 v190, v145, v147
    v_add_f32 v196, v196, v118
    v_add_f32 v196, v196, v119
    v_add_f32_dpp v190, v190, v190 row_ror:1 row_mask:0xf bank_mask:0xf
    s_nop 0
    v_add_f32_dpp v196, v196, v196 row_ror:1 row_mask:0xf bank_mask:0xf
    v_add_f32_dpp v190, v190, v190 row_ror:2 row_mask:0xf bank_mask:0xf
    s_nop 0
    v_add_f32_dpp v196, v196, v196 row_ror:2 row_mask:0xf bank_mask:0xf
    v_add_f32_dpp v190, v190, v190 row_ror:4 row_mask:0xf bank_mask:0xf
    s_nop 0
    v_add_f32_dpp v196, v196, v196 row_ror:4 row_mask:0xf bank_mask:0xf
    v_add_f32_dpp v190, v190, v190 row_ror:8 row_mask:0xf bank_mask:0xf
    s_nop 0
    v_add_f32_dpp v196, v196, v196 row_ror:8 row_mask:0xf bank_mask:0xf
    v_mov_b32 v144, v190
    s_nop 1
    v_permlane16_swap_b32 v190, v144
    v_add_f32 v190, v190, v144
    v_mov_b32 v145, v196
    s_nop 1
    v_permlane16_swap_b32 v196, v145
    v_add_f32 v196, v196, v145
    v_mov_b32 v144, v190
    s_nop 1
    v_permlane32_swap_b32 v190, v144
    v_add_f32 v190, v190, v144
    v_mov_b32 v145, v196
    s_nop 1
    v_permlane32_swap_b32 v196, v145
    v_add_f32 v196, v196, v145
    v_lshlrev_b32 v7, 2, v8
    s_lshl_b32 s25, s98, 10
    s_add_u32 s25, s25, 131072
    v_add_u32 v11, s25, v7
    ds_read_b32 v168, v11 offset:2048
    ds_read_b32 v170, v11
    s_lshl_b32 s18, s99, 7
    s_add_u32 s25, s18, 131072
    v_lshl_add_u32 v11, v0, 1, s25
    ds_read_u16 v125, v11 offset:2048
    ds_read_u16 v126, v11 offset:0
    ds_read_u16 v127, v11 offset:4096
    s_waitcnt lgkmcnt(2)
    v_lshlrev_b32 v125, 16, v125
    s_waitcnt lgkmcnt(1)
    v_lshlrev_b32 v126, 16, v126
    s_waitcnt lgkmcnt(0)
    v_lshlrev_b32 v127, 16, v127
    v_and_b32 v169, 0xffff0000, v168
    v_lshlrev_b32 v168, 16, v168
    v_and_b32 v171, 0xffff0000, v170
    v_lshlrev_b32 v170, 16, v170
    s_waitcnt vmcnt(1)
    v_lshlrev_b32 v24, 16, v128
    v_and_b32 v25, 0xffff0000, v128
    v_lshlrev_b32 v26, 16, v129
    v_and_b32 v27, 0xffff0000, v129
    v_lshlrev_b32 v28, 16, v130
    v_and_b32 v29, 0xffff0000, v130
    v_lshlrev_b32 v30, 16, v131
    v_and_b32 v31, 0xffff0000, v131
    s_waitcnt vmcnt(0)
    v_lshlrev_b32 v32, 16, v132
    v_and_b32 v33, 0xffff0000, v132
    v_lshlrev_b32 v34, 16, v133
    v_and_b32 v35, 0xffff0000, v133
    v_lshlrev_b32 v36, 16, v134
    v_and_b32 v37, 0xffff0000, v134
    v_lshlrev_b32 v38, 16, v135
    v_and_b32 v39, 0xffff0000, v135
    s_lshr_b32 s24, s16, 4
    s_lshl_b32 s24, s24, 15
    s_and_b32 s27, s16, 15
    s_lshl_b32 s27, s27, 6
    s_add_u32 s24, s24, s27
    s_add_u32 s24, s24, 0x2000000
    v_lshrrev_b32 v3, 2, v0
    v_lshlrev_b32 v3, 10, v3
    v_and_b32 v2, 3, v0
    v_lshl_add_u32 v3, v2, 4, v3
    v_and_b32 v11, 31, v0
    v_lshlrev_b32 v11, 2, v11
    s_lshl_b32 s22, s13, 3
    s_lshr_b32 s23, s12, 2
    s_add_u32 s22, s22, s23
    s_lshl_b32 s22, s22, 7
    s_add_u32 s22, s22, 0x550000
    s_mov_b32 s27, 0
fz_rp:
    buffer_load_dword v144, v11, s[8:11], s22 offen sc1
    s_waitcnt vmcnt(0)
    v_cmp_ne_u32 vcc, s14, v144
    s_add_u32 s27, s27, 1
    s_cmp_ge_u32 s27, 65536
    s_cbranch_scc1 fz_rg
    s_cbranch_vccz fz_rg
    s_sleep 1
    s_branch fz_rp
fz_rg:
    s_add_u32 s25, s24, 0x0
    buffer_load_dwordx4 v[40:43], v3, s[8:11], s25 offen sc1
    s_add_u32 s25, s24, 0x400000
    buffer_load_dwordx4 v[48:51], v3, s[8:11], s25 offen sc1
    s_add_u32 s25, s24, 0x800000
    buffer_load_dwordx4 v[56:59], v3, s[8:11], s25 offen sc1
    s_add_u32 s25, s24, 0xc00000
    buffer_load_dwordx4 v[64:67], v3, s[8:11], s25 offen sc1
    s_add_u32 s25, s24, 0x4000
    buffer_load_dwordx4 v[44:47], v3, s[8:11], s25 offen sc1
    s_add_u32 s25, s24, 0x404000
    buffer_load_dwordx4 v[52:55], v3, s[8:11], s25 offen sc1
    s_add_u32 s25, s24, 0x804000
    buffer_load_dwordx4 v[60:63], v3, s[8:11], s25 offen sc1
    s_add_u32 s25, s24, 0xc04000
    buffer_load_dwordx4 v[68:71], v3, s[8:11], s25 offen sc1
    s_waitcnt vmcnt(7)
    v_lshlrev_b32 v144, 16, v40
    v_and_b32 v145, 0xffff0000, v40
    s_waitcnt vmcnt(6)
    v_lshlrev_b32 v146, 16, v48
    v_and_b32 v147, 0xffff0000, v48
    v_pk_add_f32 v[144:145], v[144:145], v[146:147]
    s_waitcnt vmcnt(5)
    v_lshlrev_b32 v146, 16, v56
    v_and_b32 v147, 0xffff0000, v56
    v_pk_add_f32 v[144:145], v[144:145], v[146:147]
    s_waitcnt vmcnt(4)
    v_lshlrev_b32 v146, 16, v64
    v_and_b32 v147, 0xffff0000, v64
    v_pk_add_f32 v[144:145], v[144:145], v[146:147]
    v_pk_add_f32 v[24:25], v[24:25], v[144:145]
    v_cvt_pk_bf16_f32 v11, v24, v25
    v_lshlrev_b32 v24, 16, v11
    v_and_b32 v25, 0xffff0000, v11
    v_lshlrev_b32 v148, 16, v41
    v_and_b32 v149, 0xffff0000, v41
    v_lshlrev_b32 v150, 16, v49
    v_and_b32 v151, 0xffff0000, v49
    v_pk_add_f32 v[148:149], v[148:149], v[150:151]
    v_lshlrev_b32 v150, 16, v57
    v_and_b32 v151, 0xffff0000, v57
    v_pk_add_f32 v[148:149], v[148:149], v[150:151]
    v_lshlrev_b32 v150, 16, v65
    v_and_b32 v151, 0xffff0000, v65
    v_pk_add_f32 v[148:149], v[148:149], v[150:151]
    v_pk_add_f32 v[26:27], v[26:27], v[148:149]
    v_cvt_pk_bf16_f32 v12, v26, v27
    v_lshlrev_b32 v26, 16, v12
    v_and_b32 v27, 0xffff0000, v12
    v_lshlrev_b32 v144, 16, v42
    v_and_b32 v145, 0xffff0000, v42
    v_lshlrev_b32 v146, 16, v50
    v_and_b32 v147, 0xffff0000, v50
    v_pk_add_f32 v[144:145], v[144:145], v[146:147]
    v_lshlrev_b32 v146, 16, v58
    v_and_b32 v147, 0xffff0000, v58
    v_pk_add_f32 v[144:145], v[144:145], v[146:147]
    v_lshlrev_b32 v146, 16, v66
    v_and_b32 v147, 0xffff0000, v66
    v_pk_add_f32 v[144:145], v[144:145], v[146:147]
    v_pk_add_f32 v[28:29], v[28:29], v[144:145]
    v_cvt_pk_bf16_f32 v11, v28, v29
    v_lshlrev_b32 v28, 16, v11
    v_and_b32 v29, 0xffff0000, v11
    v_lshlrev_b32 v148, 16, v43
    v_and_b32 v149, 0xffff0000, v43
    v_lshlrev_b32 v150, 16, v51
    v_and_b32 v151, 0xffff0000, v51
    v_pk_add_f32 v[148:149], v[148:149], v[150:151]
    v_lshlrev_b32 v150, 16, v59
    v_and_b32 v151, 0xffff0000, v59
    v_pk_add_f32 v[148:149], v[148:149], v[150:151]
    v_lshlrev_b32 v150, 16, v67
    v_and_b32 v151, 0xffff0000, v67
    v_pk_add_f32 v[148:149], v[148:149], v[150:151]
    v_pk_add_f32 v[30:31], v[30:31], v[148:149]
    v_cvt_pk_bf16_f32 v12, v30, v31
    v_lshlrev_b32 v30, 16, v12
    v_and_b32 v31, 0xffff0000, v12
    s_waitcnt vmcnt(3)
    v_lshlrev_b32 v144, 16, v44
    v_and_b32 v145, 0xffff0000, v44
    s_waitcnt vmcnt(2)
    v_lshlrev_b32 v146, 16, v52
    v_and_b32 v147, 0xffff0000, v52
    v_pk_add_f32 v[144:145], v[144:145], v[146:147]
    s_waitcnt vmcnt(1)
    v_lshlrev_b32 v146, 16, v60
    v_and_b32 v147, 0xffff0000, v60
    v_pk_add_f32 v[144:145], v[144:145], v[146:147]
    s_waitcnt vmcnt(0)
    v_lshlrev_b32 v146, 16, v68
    v_and_b32 v147, 0xffff0000, v68
    v_pk_add_f32 v[144:145], v[144:145], v[146:147]
    v_pk_add_f32 v[32:33], v[32:33], v[144:145]
    v_cvt_pk_bf16_f32 v11, v32, v33
    v_lshlrev_b32 v32, 16, v11
    v_and_b32 v33, 0xffff0000, v11
    v_lshlrev_b32 v148, 16, v45
    v_and_b32 v149, 0xffff0000, v45
    v_lshlrev_b32 v150, 16, v53
    v_and_b32 v151, 0xffff0000, v53
    v_pk_add_f32 v[148:149], v[148:149], v[150:151]
    v_lshlrev_b32 v150, 16, v61
    v_and_b32 v151, 0xffff0000, v61
    v_pk_add_f32 v[148:149], v[148:149], v[150:151]
    v_lshlrev_b32 v150, 16, v69
    v_and_b32 v151, 0xffff0000, v69
    v_pk_add_f32 v[148:149], v[148:149], v[150:151]
    v_pk_add_f32 v[34:35], v[34:35], v[148:149]
    v_cvt_pk_bf16_f32 v12, v34, v35
    v_lshlrev_b32 v34, 16, v12
    v_and_b32 v35, 0xffff0000, v12
    v_lshlrev_b32 v144, 16, v46
    v_and_b32 v145, 0xffff0000, v46
    v_lshlrev_b32 v146, 16, v54
    v_and_b32 v147, 0xffff0000, v54
    v_pk_add_f32 v[144:145], v[144:145], v[146:147]
    v_lshlrev_b32 v146, 16, v62
    v_and_b32 v147, 0xffff0000, v62
    v_pk_add_f32 v[144:145], v[144:145], v[146:147]
    v_lshlrev_b32 v146, 16, v70
    v_and_b32 v147, 0xffff0000, v70
    v_pk_add_f32 v[144:145], v[144:145], v[146:147]
    v_pk_add_f32 v[36:37], v[36:37], v[144:145]
    v_cvt_pk_bf16_f32 v11, v36, v37
    v_lshlrev_b32 v36, 16, v11
    v_and_b32 v37, 0xffff0000, v11
    v_lshlrev_b32 v148, 16, v47
    v_and_b32 v149, 0xffff0000, v47
    v_lshlrev_b32 v150, 16, v55
    v_and_b32 v151, 0xffff0000, v55
    v_pk_add_f32 v[148:149], v[148:149], v[150:151]
    v_lshlrev_b32 v150, 16, v63
    v_and_b32 v151, 0xffff0000, v63
    v_pk_add_f32 v[148:149], v[148:149], v[150:151]
    v_lshlrev_b32 v150, 16, v71
    v_and_b32 v151, 0xffff0000, v71
    v_pk_add_f32 v[148:149], v[148:149], v[150:151]
    v_pk_add_f32 v[38:39], v[38:39], v[148:149]
    v_cvt_pk_bf16_f32 v12, v38, v39
    v_lshlrev_b32 v38, 16, v12
    v_and_b32 v39, 0xffff0000, v12
    v_readfirstlane_b32 s25, v24
    s_nop 1
    v_mov_b32 v188, s25
    v_pk_add_f32 v[40:41], v[24:25], v[188:189] op_sel_hi:[1,0] neg_lo:[0,1] neg_hi:[0,1]
    v_pk_add_f32 v[42:43], v[26:27], v[188:189] op_sel_hi:[1,0] neg_lo:[0,1] neg_hi:[0,1]
    v_pk_add_f32 v[44:45], v[28:29], v[188:189] op_sel_hi:[1,0] neg_lo:[0,1] neg_hi:[0,1]
    v_pk_add_f32 v[46:47], v[30:31], v[188:189] op_sel_hi:[1,0] neg_lo:[0,1] neg_hi:[0,1]
    v_pk_add_f32 v[48:49], v[32:33], v[188:189] op_sel_hi:[1,0] neg_lo:[0,1] neg_hi:[0,1]
    v_pk_add_f32 v[50:51], v[34:35], v[188:189] op_sel_hi:[1,0] neg_lo:[0,1] neg_hi:[0,1]
    v_pk_add_f32 v[52:53], v[36:37], v[188:189] op_sel_hi:[1,0] neg_lo:[0,1] neg_hi:[0,1]
    v_pk_add_f32 v[54:55], v[38:39], v[188:189] op_sel_hi:[1,0] neg_lo:[0,1] neg_hi:[0,1]
    v_pk_add_f32 v[148:149], v[40:41], v[42:43]
    v_pk_mul_f32 v[144:145], v[40:41], v[40:41]
    v_pk_mul_f32 v[146:147], v[40:41], v[104:105]
    v_pk_fma_f32 v[144:145], v[42:43], v[42:43], v[144:145]
    v_pk_fma_f32 v[146:147], v[42:43], v[106:107], v[146:147]
    v_pk_add_f32 v[148:149], v[148:149], v[44:45]
    v_pk_fma_f32 v[144:145], v[44:45], v[44:45], v[144:145]
    v_pk_fma_f32 v[146:147], v[44:45], v[108:109], v[146:147]
    v_pk_add_f32 v[148:149], v[148:149], v[46:47]
    v_pk_fma_f32 v[144:145], v[46:47], v[46:47], v[144:145]
    v_pk_fma_f32 v[146:147], v[46:47], v[110:111], v[146:147]
    v_pk_add_f32 v[148:149], v[148:149], v[48:49]
    v_pk_fma_f32 v[144:145], v[48:49], v[48:49], v[144:145]
    v_pk_fma_f32 v[146:147], v[48:49], v[112:113], v[146:147]
    v_pk_add_f32 v[148:149], v[148:149], v[50:51]
    v_pk_fma_f32 v[144:145], v[50:51], v[50:51], v[144:145]
    v_pk_fma_f32 v[146:147], v[50:51], v[114:115], v[146:147]
    v_pk_add_f32 v[148:149], v[148:149], v[52:53]
    v_pk_fma_f32 v[144:145], v[52:53], v[52:53], v[144:145]
    v_pk_fma_f32 v[146:147], v[52:53], v[116:117], v[146:147]
    v_pk_add_f32 v[148:149], v[148:149], v[54:55]
    v_pk_fma_f32 v[144:145], v[54:55], v[54:55], v[144:145]
    v_pk_fma_f32 v[146:147], v[54:55], v[118:119], v[146:147]
    v_add_f32 v192, v148, v149
    v_add_f32 v193, v144, v145
    v_add_f32 v194, v146, v147
    v_add_f32_dpp v192, v192, v192 row_ror:1 row_mask:0xf bank_mask:0xf
    v_add_f32_dpp v193, v193, v193 row_ror:1 row_mask:0xf bank_mask:0xf
    v_add_f32_dpp v194, v194, v194 row_ror:1 row_mask:0xf bank_mask:0xf
    v_add_f32_dpp v192, v192, v192 row_ror:2 row_mask:0xf bank_mask:0xf
    v_add_f32_dpp v193, v193, v193 row_ror:2 row_mask:0xf bank_mask:0xf
    v_add_f32_dpp v194, v194, v194 row_ror:2 row_mask:0xf bank_mask:0xf
    v_add_f32_dpp v192, v192, v192 row_ror:4 row_mask:0xf bank_mask:0xf
    v_add_f32_dpp v193, v193, v193 row_ror:4 row_mask:0xf bank_mask:0xf
    v_add_f32_dpp v194, v194, v194 row_ror:4 row_mask:0xf bank_mask:0xf
    v_add_f32_dpp v192, v192, v192 row_ror:8 row_mask:0xf bank_mask:0xf
    v_add_f32_dpp v193, v193, v193 row_ror:8 row_mask:0xf bank_mask:0xf
    v_add_f32_dpp v194, v194, v194 row_ror:8 row_mask:0xf bank_mask:0xf
    v_mov_b32 v144, v192
    s_nop 1
    v_permlane16_swap_b32 v192, v144
    v_add_f32 v192, v192, v144
    v_mov_b32 v145, v193
    s_nop 1
    v_permlane16_swap_b32 v193, v145
    v_add_f32 v193, v193, v145
    v_mov_b32 v146, v194
    s_nop 1
    v_permlane16_swap_b32 v194, v146
    v_add_f32 v194, v194, v146
    v_mov_b32 v144, v192
    s_nop 1
    v_permlane32_swap_b32 v192, v144
    v_add_f32 v192, v192, v144
    v_mov_b32 v145, v193
    s_nop 1
    v_permlane32_swap_b32 v193, v145
    v_add_f32 v193, v193, v145
    v_mov_b32 v146, v194
    s_nop 1
    v_permlane32_swap_b32 v194, v146
    v_add_f32 v194, v194, v146
    v_mul_f32 v192, 0x3a800000, v192
    v_mul_f32 v193, 0x3a800000, v193
    v_fma_f32 v193, -v192, v192, v193
    v_max_f32 v193, 0, v193
    v_fma_f32 v194, -v192, v196, v194
    v_add_f32 v192, s25, v192
    v_add_f32 v144, 0x3727c5ac, v193
    v_rsq_f32 v144, v144
    s_nop 0
    v_fma_f32 v23, v194, v144, v190
    v_cvt_pk_bf16_f32 v192, v192, v192
    v_lshlrev_b32 v192, 16, v192
    v_cvt_pk_bf16_f32 v193, v193, v193
    v_lshlrev_b32 v193, 16, v193
    v_add_f32 v193, 0x3727c5ac, v193
    v_cvt_pk_bf16_f32 v193, v193, v193
    v_lshlrev_b32 v193, 16, v193
    v_sqrt_f32 v194, v193
    s_nop 0
    v_cvt_pk_bf16_f32 v194, v194, v194
    v_lshlrev_b32 v194, 16, v194
    v_rcp_f32 v195, v194
    v_mov_b32 v21, v192
    v_mov_b32 v22, v194
    v_ashrrev_i32 v12, 31, v23
    v_or_b32 v12, 0x80000000, v12
    v_xor_b32 v20, v23, v12
    v_and_b32 v20, 0xfffff800, v20
    v_max_u32 v20, 0x800, v20
    s_sub_u32 s24, 2047, s16
    v_or_b32 v20, s24, v20
    v_lshlrev_b32 v11, 4, v16
    ds_write_b128 v11, v[20:23]
    s_waitcnt lgkmcnt(0)
    s_barrier
    s_cmp_lg_u32 s3, 0
    s_cbranch_scc1 fz_nk
    v_and_b32 v11, 7, v0
    v_lshlrev_b32 v11, 4, v11
    ds_read_b32 v144, v11 offset:0
    s_waitcnt lgkmcnt(0)
    v_mov_b32 v145, v144
    s_nop 1
    v_max_u32_dpp v145, v145, v145 row_ror:1 row_mask:0xf bank_mask:0xf
    s_nop 1
    v_max_u32_dpp v145, v145, v145 row_ror:2 row_mask:0xf bank_mask:0xf
    s_nop 1
    v_max_u32_dpp v145, v145, v145 row_ror:4 row_mask:0xf bank_mask:0xf
    v_cmp_eq_u32 vcc, v144, v145
    s_ff1_i32_b64 s26, vcc
    s_lshl_b32 s26, s26, 4
    v_mov_b32 v11, s26
    ds_read_b128 v[20:23], v11 offset:0
    s_lshl_b32 s24, s2, 4
    s_add_u32 s24, s24, 0xa70000
    s_mov_b64 exec, 1
    s_waitcnt lgkmcnt(0)
    buffer_store_dwordx4 v[20:23], v6, s[8:11], s24 offen sc1
    s_mov_b64 exec, -1
fz_nk:
    s_waitcnt lgkmcnt(0)
    v_lshlrev_b32 v2, 5, v14
    v_bfe_u32 v4, v0, 4, 2
    v_lshl_add_u32 v2, v4, 3, v2
    v_bfe_u32 v4, v17, 6, 2
    v_lshl_add_u32 v2, v4, 8, v2
    v_lshlrev_b32 v4, 2, v0
    s_cmp_lt_u32 s3, 4
    s_cbranch_scc1 fz_dn
    v_sub_f32 v40, v24, v192
    v_sub_f32 v41, v25, v192
    v_sub_f32 v42, v26, v192
    v_sub_f32 v43, v27, v192
    v_sub_f32 v44, v28, v192
    v_sub_f32 v45, v29, v192
    v_sub_f32 v46, v30, v192
    v_sub_f32 v47, v31, v192
    v_cvt_pk_bf16_f32 v12, v40, v41
    v_lshlrev_b32 v40, 16, v12
    v_and_b32 v41, 0xffff0000, v12
    v_cvt_pk_bf16_f32 v12, v42, v43
    v_lshlrev_b32 v42, 16, v12
    v_and_b32 v43, 0xffff0000, v12
    v_cvt_pk_bf16_f32 v12, v44, v45
    v_lshlrev_b32 v44, 16, v12
    v_and_b32 v45, 0xffff0000, v12
    v_cvt_pk_bf16_f32 v12, v46, v47
    v_lshlrev_b32 v46, 16, v12
    v_and_b32 v47, 0xffff0000, v12
    v_mul_f32 v40, v40, v195
    v_mul_f32 v41, v41, v195
    v_mul_f32 v42, v42, v195
    v_mul_f32 v43, v43, v195
    v_mul_f32 v44, v44, v195
    v_mul_f32 v45, v45, v195
    v_mul_f32 v46, v46, v195
    v_mul_f32 v47, v47, v195
    v_cvt_pk_bf16_f32 v12, v40, v41
    v_lshlrev_b32 v40, 16, v12
    v_and_b32 v41, 0xffff0000, v12
    v_cvt_pk_bf16_f32 v12, v42, v43
    v_lshlrev_b32 v42, 16, v12
    v_and_b32 v43, 0xffff0000, v12
    v_cvt_pk_bf16_f32 v12, v44, v45
    v_lshlrev_b32 v44, 16, v12
    v_and_b32 v45, 0xffff0000, v12
    v_cvt_pk_bf16_f32 v12, v46, v47
    v_lshlrev_b32 v46, 16, v12
    v_and_b32 v47, 0xffff0000, v12
    v_lshlrev_b32 v48, 16, v80
    v_and_b32 v49, 0xffff0000, v80
    v_lshlrev_b32 v50, 16, v81
    v_and_b32 v51, 0xffff0000, v81
    v_lshlrev_b32 v52, 16, v82
    v_and_b32 v53, 0xffff0000, v82
    v_lshlrev_b32 v54, 16, v83
    v_and_b32 v55, 0xffff0000, v83
    v_pk_mul_f32 v[40:41], v[40:41], v[48:49]
    v_pk_mul_f32 v[42:43], v[42:43], v[50:51]
    v_pk_mul_f32 v[44:45], v[44:45], v[52:53]
    v_pk_mul_f32 v[46:47], v[46:47], v[54:55]
    v_cvt_pk_bf16_f32 v12, v40, v41
    v_lshlrev_b32 v40, 16, v12
    v_and_b32 v41, 0xffff0000, v12
    v_cvt_pk_bf16_f32 v12, v42, v43
    v_lshlrev_b32 v42, 16, v12
    v_and_b32 v43, 0xffff0000, v12
    v_cvt_pk_bf16_f32 v12, v44, v45
    v_lshlrev_b32 v44, 16, v12
    v_and_b32 v45, 0xffff0000, v12
    v_cvt_pk_bf16_f32 v12, v46, v47
    v_lshlrev_b32 v46, 16, v12
    v_and_b32 v47, 0xffff0000, v12
    v_lshlrev_b32 v48, 16, v72
    v_and_b32 v49, 0xffff0000, v72
    v_lshlrev_b32 v50, 16, v73
    v_and_b32 v51, 0xffff0000, v73
    v_lshlrev_b32 v52, 16, v74
    v_and_b32 v53, 0xffff0000, v74
    v_lshlrev_b32 v54, 16, v75
    v_and_b32 v55, 0xffff0000, v75
    v_pk_add_f32 v[40:41], v[40:41], v[48:49]
    v_pk_add_f32 v[42:43], v[42:43], v[50:51]
    v_pk_add_f32 v[44:45], v[44:45], v[52:53]
    v_pk_add_f32 v[46:47], v[46:47], v[54:55]
    v_cvt_pk_bf16_f32 v12, v40, v41
    v_lshlrev_b32 v40, 16, v12
    v_and_b32 v41, 0xffff0000, v12
    v_cvt_pk_bf16_f32 v12, v42, v43
    v_lshlrev_b32 v42, 16, v12
    v_and_b32 v43, 0xffff0000, v12
    v_cvt_pk_bf16_f32 v12, v44, v45
    v_lshlrev_b32 v44, 16, v12
    v_and_b32 v45, 0xffff0000, v12
    v_cvt_pk_bf16_f32 v12, v46, v47
    v_lshlrev_b32 v46, 16, v12
    v_and_b32 v47, 0xffff0000, v12
    v_lshlrev_b32 v48, 16, v88
    v_and_b32 v49, 0xffff0000, v88
    v_lshlrev_b32 v50, 16, v89
    v_and_b32 v51, 0xffff0000, v89
    v_lshlrev_b32 v52, 16, v90
    v_and_b32 v53, 0xffff0000, v90
    v_lshlrev_b32 v54, 16, v91
    v_and_b32 v55, 0xffff0000, v91
    v_pk_mul_f32 v[40:41], v[40:41], v[48:49]
    v_pk_mul_f32 v[42:43], v[42:43], v[50:51]
    v_pk_mul_f32 v[44:45], v[44:45], v[52:53]
    v_pk_mul_f32 v[46:47], v[46:47], v[54:55]
    v_cvt_pk_bf16_f32 v12, v40, v41
    v_lshlrev_b32 v40, 16, v12
    v_and_b32 v41, 0xffff0000, v12
    v_cvt_pk_bf16_f32 v12, v42, v43
    v_lshlrev_b32 v42, 16, v12
    v_and_b32 v43, 0xffff0000, v12
    v_cvt_pk_bf16_f32 v12, v44, v45
    v_lshlrev_b32 v44, 16, v12
    v_and_b32 v45, 0xffff0000, v12
    v_cvt_pk_bf16_f32 v12, v46, v47
    v_lshlrev_b32 v46, 16, v12
    v_and_b32 v47, 0xffff0000, v12
    v_pk_add_f32 v[40:41], v[40:41], v[24:25]
    v_pk_add_f32 v[42:43], v[42:43], v[26:27]
    v_pk_add_f32 v[44:45], v[44:45], v[28:29]
    v_pk_add_f32 v[46:47], v[46:47], v[30:31]
    v_cvt_pk_bf16_f32 v56, v40, v41
    v_cvt_pk_bf16_f32 v57, v42, v43
    v_cvt_pk_bf16_f32 v58, v44, v45
    v_cvt_pk_bf16_f32 v59, v46, v47
    v_sub_f32 v40, v32, v192
    v_sub_f32 v41, v33, v192
    v_sub_f32 v42, v34, v192
    v_sub_f32 v43, v35, v192
    v_sub_f32 v44, v36, v192
    v_sub_f32 v45, v37, v192
    v_sub_f32 v46, v38, v192
    v_sub_f32 v47, v39, v192
    v_cvt_pk_bf16_f32 v12, v40, v41
    v_lshlrev_b32 v40, 16, v12
    v_and_b32 v41, 0xffff0000, v12
    v_cvt_pk_bf16_f32 v12, v42, v43
    v_lshlrev_b32 v42, 16, v12
    v_and_b32 v43, 0xffff0000, v12
    v_cvt_pk_bf16_f32 v12, v44, v45
    v_lshlrev_b32 v44, 16, v12
    v_and_b32 v45, 0xffff0000, v12
    v_cvt_pk_bf16_f32 v12, v46, v47
    v_lshlrev_b32 v46, 16, v12
    v_and_b32 v47, 0xffff0000, v12
    v_mul_f32 v40, v40, v195
    v_mul_f32 v41, v41, v195
    v_mul_f32 v42, v42, v195
    v_mul_f32 v43, v43, v195
    v_mul_f32 v44, v44, v195
    v_mul_f32 v45, v45, v195
    v_mul_f32 v46, v46, v195
    v_mul_f32 v47, v47, v195
    v_cvt_pk_bf16_f32 v12, v40, v41
    v_lshlrev_b32 v40, 16, v12
    v_and_b32 v41, 0xffff0000, v12
    v_cvt_pk_bf16_f32 v12, v42, v43
    v_lshlrev_b32 v42, 16, v12
    v_and_b32 v43, 0xffff0000, v12
    v_cvt_pk_bf16_f32 v12, v44, v45
    v_lshlrev_b32 v44, 16, v12
    v_and_b32 v45, 0xffff0000, v12
    v_cvt_pk_bf16_f32 v12, v46, v47
    v_lshlrev_b32 v46, 16, v12
    v_and_b32 v47, 0xffff0000, v12
    v_lshlrev_b32 v48, 16, v84
    v_and_b32 v49, 0xffff0000, v84
    v_lshlrev_b32 v50, 16, v85
    v_and_b32 v51, 0xffff0000, v85
    v_lshlrev_b32 v52, 16, v86
    v_and_b32 v53, 0xffff0000, v86
    v_lshlrev_b32 v54, 16, v87
    v_and_b32 v55, 0xffff0000, v87
    v_pk_mul_f32 v[40:41], v[40:41], v[48:49]
    v_pk_mul_f32 v[42:43], v[42:43], v[50:51]
    v_pk_mul_f32 v[44:45], v[44:45], v[52:53]
    v_pk_mul_f32 v[46:47], v[46:47], v[54:55]
    v_cvt_pk_bf16_f32 v12, v40, v41
    v_lshlrev_b32 v40, 16, v12
    v_and_b32 v41, 0xffff0000, v12
    v_cvt_pk_bf16_f32 v12, v42, v43
    v_lshlrev_b32 v42, 16, v12
    v_and_b32 v43, 0xffff0000, v12
    v_cvt_pk_bf16_f32 v12, v44, v45
    v_lshlrev_b32 v44, 16, v12
    v_and_b32 v45, 0xffff0000, v12
    v_cvt_pk_bf16_f32 v12, v46, v47
    v_lshlrev_b32 v46, 16, v12
    v_and_b32 v47, 0xffff0000, v12
    v_lshlrev_b32 v48, 16, v76
    v_and_b32 v49, 0xffff0000, v76
    v_lshlrev_b32 v50, 16, v77
    v_and_b32 v51, 0xffff0000, v77
    v_lshlrev_b32 v52, 16, v78
    v_and_b32 v53, 0xffff0000, v78
    v_lshlrev_b32 v54, 16, v79
    v_and_b32 v55, 0xffff0000, v79
    v_pk_add_f32 v[40:41], v[40:41], v[48:49]
    v_pk_add_f32 v[42:43], v[42:43], v[50:51]
    v_pk_add_f32 v[44:45], v[44:45], v[52:53]
    v_pk_add_f32 v[46:47], v[46:47], v[54:55]
    v_cvt_pk_bf16_f32 v12, v40, v41
    v_lshlrev_b32 v40, 16, v12
    v_and_b32 v41, 0xffff0000, v12
    v_cvt_pk_bf16_f32 v12, v42, v43
    v_lshlrev_b32 v42, 16, v12
    v_and_b32 v43, 0xffff0000, v12
    v_cvt_pk_bf16_f32 v12, v44, v45
    v_lshlrev_b32 v44, 16, v12
    v_and_b32 v45, 0xffff0000, v12
    v_cvt_pk_bf16_f32 v12, v46, v47
    v_lshlrev_b32 v46, 16, v12
    v_and_b32 v47, 0xffff0000, v12
    v_lshlrev_b32 v48, 16, v92
    v_and_b32 v49, 0xffff0000, v92
    v_lshlrev_b32 v50, 16, v93
    v_and_b32 v51, 0xffff0000, v93
    v_lshlrev_b32 v52, 16, v94
    v_and_b32 v53, 0xffff0000, v94
    v_lshlrev_b32 v54, 16, v95
    v_and_b32 v55, 0xffff0000, v95
    v_pk_mul_f32 v[40:41], v[40:41], v[48:49]
    v_pk_mul_f32 v[42:43], v[42:43], v[50:51]
    v_pk_mul_f32 v[44:45], v[44:45], v[52:53]
    v_pk_mul_f32 v[46:47], v[46:47], v[54:55]
    v_cvt_pk_bf16_f32 v12, v40, v41
    v_lshlrev_b32 v40, 16, v12
    v_and_b32 v41, 0xffff0000, v12
    v_cvt_pk_bf16_f32 v12, v42, v43
    v_lshlrev_b32 v42, 16, v12
    v_and_b32 v43, 0xffff0000, v12
    v_cvt_pk_bf16_f32 v12, v44, v45
    v_lshlrev_b32 v44, 16, v12
    v_and_b32 v45, 0xffff0000, v12
    v_cvt_pk_bf16_f32 v12, v46, v47
    v_lshlrev_b32 v46, 16, v12
    v_and_b32 v47, 0xffff0000, v12
    v_pk_add_f32 v[40:41], v[40:41], v[32:33]
    v_pk_add_f32 v[42:43], v[42:43], v[34:35]
    v_pk_add_f32 v[44:45], v[44:45], v[36:37]
    v_pk_add_f32 v[46:47], v[46:47], v[38:39]
    v_cvt_pk_bf16_f32 v60, v40, v41
    v_cvt_pk_bf16_f32 v61, v42, v43
    v_cvt_pk_bf16_f32 v62, v44, v45
    v_cvt_pk_bf16_f32 v63, v46, v47
    v_lshrrev_b32 v15, 6, v7
    v_lshlrev_b32 v15, 10, v15
    v_and_b32 v11, 63, v7
    v_add_u32 v15, v15, v11
    v_lshlrev_b32 v11, 2, v7
    s_mov_b32 s26, 0xa70000
    s_mov_b32 s27, 0
fz_wp:
    buffer_load_dwordx4 v[20:23], v11, s[8:11], s26 offen sc1
    s_waitcnt vmcnt(0)
    v_cmp_eq_u32 vcc, 0, v20
    s_add_u32 s27, s27, 1
    s_cmp_ge_u32 s27, 65536
    s_cbranch_scc1 fz_wg
    s_cbranch_vccz fz_wg
    s_sleep 1
    s_branch fz_wp
fz_wg:
    v_mov_b32 v144, v20
    s_nop 1
    v_max_u32_dpp v144, v144, v144 row_ror:1 row_mask:0xf bank_mask:0xf
    s_nop 1
    v_max_u32_dpp v144, v144, v144 row_ror:2 row_mask:0xf bank_mask:0xf
    s_nop 1
    v_max_u32_dpp v144, v144, v144 row_ror:4 row_mask:0xf bank_mask:0xf
    s_nop 1
    v_max_u32_dpp v144, v144, v144 row_ror:8 row_mask:0xf bank_mask:0xf
    v_mov_b32 v145, v144
    s_nop 1
    v_permlane16_swap_b32 v144, v145
    v_max_u32 v144, v144, v145
    v_mov_b32 v145, v144
    s_nop 1
    v_permlane32_swap_b32 v144, v145
    v_max_u32 v144, v144, v145
    v_cmp_eq_u32 vcc, v144, v20
    v_lshlrev_b32 v11, 4, v16
    s_and_saveexec_b64 s[26:27], vcc
    ds_write_b128 v11, v[20:23] offset:192
    s_mov_b64 exec, s[26:27]
    s_waitcnt lgkmcnt(0)
    s_barrier
    v_and_b32 v11, 3, v0
    v_lshlrev_b32 v11, 4, v11
    ds_read_b32 v144, v11 offset:256
    s_waitcnt lgkmcnt(0)
    v_mov_b32 v145, v144
    s_nop 1
    v_max_u32_dpp v145, v145, v145 row_ror:1 row_mask:0xf bank_mask:0xf
    s_nop 1
    v_max_u32_dpp v145, v145, v145 row_ror:2 row_mask:0xf bank_mask:0xf
    v_cmp_eq_u32 vcc, v144, v145
    s_ff1_i32_b64 s26, vcc
    s_lshl_b32 s26, s26, 4
    v_mov_b32 v11, s26
    ds_read_b128 v[20:23], v11 offset:256
    s_waitcnt lgkmcnt(0)
    v_and_b32 v144, 0x7ff, v20
    v_sub_u32 v144, 2047, v144
    s_nop 0
    v_readfirstlane_b32 s101, v144
    s_lshl_b32 s62, s101, 11
    v_rcp_f32 v167, v22
    s_cmp_lg_u32 s101, s16
    s_cselect_b32 s23, s17, 0x7ffffff0
    s_lshl_b32 s24, s98, 10
    s_add_u32 s24, s62, s24
    s_lshr_b32 s25, s101, 4
    s_lshl_b32 s25, s25, 15
    s_and_b32 s27, s101, 15
    s_lshl_b32 s27, s27, 6
    s_add_u32 s25, s25, s27
    s_add_u32 s25, s25, 0x2000000
    s_lshl_b32 s26, s98, 14
    s_add_u32 s25, s25, s26
    s_add_u32 s26, s25, 0x0
    buffer_load_dword v40, v15, s[8:11], s26 offen sc1
    s_add_u32 s26, s25, 0x400000
    buffer_load_dword v41, v15, s[8:11], s26 offen sc1
    s_add_u32 s26, s25, 0x800000
    buffer_load_dword v42, v15, s[8:11], s26 offen sc1
    s_add_u32 s26, s25, 0xc00000
    buffer_load_dword v43, v15, s[8:11], s26 offen sc1
    buffer_load_dword v166, v7, s[28:31], s24 offen
    s_waitcnt vmcnt(4)
    v_lshlrev_b32 v144, 16, v40
    v_and_b32 v145, 0xffff0000, v40
    s_waitcnt vmcnt(3)
    v_lshlrev_b32 v146, 16, v41
    v_and_b32 v147, 0xffff0000, v41
    v_pk_add_f32 v[128:129], v[144:145], v[146:147]
    s_waitcnt vmcnt(2)
    v_lshlrev_b32 v144, 16, v42
    v_and_b32 v145, 0xffff0000, v42
    v_pk_add_f32 v[128:129], v[144:145], v[128:129]
    s_waitcnt vmcnt(1)
    v_lshlrev_b32 v144, 16, v43
    v_and_b32 v145, 0xffff0000, v43
    v_pk_add_f32 v[128:129], v[144:145], v[128:129]
    s_waitcnt vmcnt(0)
    v_lshlrev_b32 v144, 16, v166
    v_and_b32 v145, 0xffff0000, v166
    v_pk_add_f32 v[128:129], v[144:145], v[128:129]
    v_cvt_pk_bf16_f32 v144, v128, v129
    v_lshlrev_b32 v128, 16, v144
    v_and_b32 v129, 0xffff0000, v144
    v_sub_f32 v128, v128, v21
    v_sub_f32 v129, v129, v21
    v_cvt_pk_bf16_f32 v144, v128, v129
    v_lshlrev_b32 v128, 16, v144
    v_and_b32 v129, 0xffff0000, v144
    v_mul_f32 v145, v128, v167
    v_fma_f32 v128, -v145, v22, v128
    v_fma_f32 v128, v128, v167, v145
    v_mul_f32 v145, v129, v167
    v_fma_f32 v129, -v145, v22, v129
    v_fma_f32 v129, v129, v167, v145
    v_cvt_pk_bf16_f32 v144, v128, v129
    v_lshlrev_b32 v128, 16, v144
    v_and_b32 v129, 0xffff0000, v144
    v_mul_f32 v128, v128, v168
    v_mul_f32 v129, v129, v169
    v_cvt_pk_bf16_f32 v144, v128, v129
    v_lshlrev_b32 v128, 16, v144
    v_and_b32 v129, 0xffff0000, v144
    v_add_f32 v128, v128, v170
    v_add_f32 v129, v129, v171
    v_cvt_pk_bf16_f32 v144, v128, v129
    v_lshlrev_b32 v128, 16, v144
    v_and_b32 v129, 0xffff0000, v144
    v_lshlrev_b32 v11, 1, v7
    ds_write_b64 v11, v[128:129] offset:512
    v_lshlrev_b32 v11, 6, v13
    s_waitcnt lgkmcnt(0)
    ds_read_b128 v[128:131], v11 offset:512
    ds_read_b128 v[132:135], v11 offset:528
    ds_read_b128 v[136:139], v11 offset:544
    ds_read_b128 v[140:143], v11 offset:560
    s_lshl_b32 s26, s97, 1
    s_add_u32 s26, s26, s98
    s_mul_i32 s26, s26, 14336
    s_lshl_b32 s25, s96, 8
    s_add_u32 s26, s26, s25
    s_add_u32 s26, s26, 0xa10000
    s_cmp_lt_u32 s2, 224
    s_cselect_b32 s26, s26, 0x7ffffff0
    s_cmp_eq_u32 s3, 4
    s_cselect_b32 s26, s26, 0x7ffffff0
    s_mov_b32 s25, s26
    s_waitcnt lgkmcnt(3)
    v_lshrrev_b32 v144, 16, v128
    v_dot2_f32_bf16 v157, v204, v128, 0
    v_dot2_f32_bf16 v156, v204, v144, 0
    v_dot2_f32_bf16 v159, v205, v128, 0
    v_dot2_f32_bf16 v158, v205, v144, 0
    v_dot2_f32_bf16 v161, v206, v128, 0
    v_dot2_f32_bf16 v160, v206, v144, 0
    v_dot2_f32_bf16 v163, v207, v128, 0
    v_dot2_f32_bf16 v162, v207, v144, 0
    v_lshrrev_b32 v145, 16, v129
    v_dot2c_f32_bf16 v157, v208, v129
    v_dot2c_f32_bf16 v156, v208, v145
    v_dot2c_f32_bf16 v159, v209, v129
    v_dot2c_f32_bf16 v158, v209, v145
    v_dot2c_f32_bf16 v161, v210, v129
    v_dot2c_f32_bf16 v160, v210, v145
    v_dot2c_f32_bf16 v163, v211, v129
    v_dot2c_f32_bf16 v162, v211, v145
    v_lshrrev_b32 v146, 16, v130
    v_dot2c_f32_bf16 v157, v212, v130
    v_dot2c_f32_bf16 v156, v212, v146
    v_dot2c_f32_bf16 v159, v213, v130
    v_dot2c_f32_bf16 v158, v213, v146
    v_dot2c_f32_bf16 v161, v214, v130
    v_dot2c_f32_bf16 v160, v214, v146
    v_dot2c_f32_bf16 v163, v215, v130
    v_dot2c_f32_bf16 v162, v215, v146
    v_lshrrev_b32 v147, 16, v131
    v_dot2c_f32_bf16 v157, v216, v131
    v_dot2c_f32_bf16 v156, v216, v147
    v_dot2c_f32_bf16 v159, v217, v131
    v_dot2c_f32_bf16 v158, v217, v147
    v_dot2c_f32_bf16 v161, v218, v131
    v_dot2c_f32_bf16 v160, v218, v147
    v_dot2c_f32_bf16 v163, v219, v131
    v_dot2c_f32_bf16 v162, v219, v147
    s_waitcnt lgkmcnt(2)
    v_lshrrev_b32 v148, 16, v132
    v_dot2c_f32_bf16 v157, v220, v132
    v_dot2c_f32_bf16 v156, v220, v148
    v_dot2c_f32_bf16 v159, v221, v132
    v_dot2c_f32_bf16 v158, v221, v148
    v_dot2c_f32_bf16 v161, v222, v132
    v_dot2c_f32_bf16 v160, v222, v148
    v_dot2c_f32_bf16 v163, v223, v132
    v_dot2c_f32_bf16 v162, v223, v148
    v_lshrrev_b32 v149, 16, v133
    v_dot2c_f32_bf16 v157, v224, v133
    v_dot2c_f32_bf16 v156, v224, v149
    v_dot2c_f32_bf16 v159, v225, v133
    v_dot2c_f32_bf16 v158, v225, v149
    v_dot2c_f32_bf16 v161, v226, v133
    v_dot2c_f32_bf16 v160, v226, v149
    v_dot2c_f32_bf16 v163, v227, v133
    v_dot2c_f32_bf16 v162, v227, v149
    v_lshrrev_b32 v150, 16, v134
    v_dot2c_f32_bf16 v157, v228, v134
    v_dot2c_f32_bf16 v156, v228, v150
    v_dot2c_f32_bf16 v159, v229, v134
    v_dot2c_f32_bf16 v158, v229, v150
    v_dot2c_f32_bf16 v161, v230, v134
    v_dot2c_f32_bf16 v160, v230, v150
    v_dot2c_f32_bf16 v163, v231, v134
    v_dot2c_f32_bf16 v162, v231, v150
    v_lshrrev_b32 v151, 16, v135
    v_dot2c_f32_bf16 v157, v232, v135
    v_dot2c_f32_bf16 v156, v232, v151
    v_dot2c_f32_bf16 v159, v233, v135
    v_dot2c_f32_bf16 v158, v233, v151
    v_dot2c_f32_bf16 v161, v234, v135
    v_dot2c_f32_bf16 v160, v234, v151
    v_dot2c_f32_bf16 v163, v235, v135
    v_dot2c_f32_bf16 v162, v235, v151
    s_waitcnt lgkmcnt(1)
    v_lshrrev_b32 v144, 16, v136
    v_dot2c_f32_bf16 v157, v236, v136
    v_dot2c_f32_bf16 v156, v236, v144
    v_dot2c_f32_bf16 v159, v237, v136
    v_dot2c_f32_bf16 v158, v237, v144
    v_dot2c_f32_bf16 v161, v238, v136
    v_dot2c_f32_bf16 v160, v238, v144
    v_dot2c_f32_bf16 v163, v239, v136
    v_dot2c_f32_bf16 v162, v239, v144
    v_lshrrev_b32 v145, 16, v137
    v_dot2c_f32_bf16 v157, v240, v137
    v_dot2c_f32_bf16 v156, v240, v145
    v_dot2c_f32_bf16 v159, v241, v137
    v_dot2c_f32_bf16 v158, v241, v145
    v_dot2c_f32_bf16 v161, v242, v137
    v_dot2c_f32_bf16 v160, v242, v145
    v_dot2c_f32_bf16 v163, v243, v137
    v_dot2c_f32_bf16 v162, v243, v145
    v_lshrrev_b32 v146, 16, v138
    v_dot2c_f32_bf16 v157, v244, v138
    v_dot2c_f32_bf16 v156, v244, v146
    v_dot2c_f32_bf16 v159, v245, v138
    v_dot2c_f32_bf16 v158, v245, v146
    v_dot2c_f32_bf16 v161, v246, v138
    v_dot2c_f32_bf16 v160, v246, v146
    v_dot2c_f32_bf16 v163, v247, v138
    v_dot2c_f32_bf16 v162, v247, v146
    v_lshrrev_b32 v147, 16, v139
    v_dot2c_f32_bf16 v157, v248, v139
    v_dot2c_f32_bf16 v156, v248, v147
    v_dot2c_f32_bf16 v159, v249, v139
    v_dot2c_f32_bf16 v158, v249, v147
    v_dot2c_f32_bf16 v161, v250, v139
    v_dot2c_f32_bf16 v160, v250, v147
    v_dot2c_f32_bf16 v163, v251, v139
    v_dot2c_f32_bf16 v162, v251, v147
    s_waitcnt lgkmcnt(0)
    v_lshrrev_b32 v148, 16, v140
    v_dot2c_f32_bf16 v157, v252, v140
    v_dot2c_f32_bf16 v156, v252, v148
    v_dot2c_f32_bf16 v159, v253, v140
    v_dot2c_f32_bf16 v158, v253, v148
    v_dot2c_f32_bf16 v161, v254, v140
    v_dot2c_f32_bf16 v160, v254, v148
    v_dot2c_f32_bf16 v163, v255, v140
    v_dot2c_f32_bf16 v162, v255, v148
    v_lshrrev_b32 v149, 16, v141
    v_dot2c_f32_bf16 v157, v180, v141
    v_dot2c_f32_bf16 v156, v180, v149
    v_dot2c_f32_bf16 v159, v181, v141
    v_dot2c_f32_bf16 v158, v181, v149
    v_dot2c_f32_bf16 v161, v182, v141
    v_dot2c_f32_bf16 v160, v182, v149
    v_dot2c_f32_bf16 v163, v183, v141
    v_dot2c_f32_bf16 v162, v183, v149
    v_lshrrev_b32 v150, 16, v142
    v_dot2c_f32_bf16 v157, v184, v142
    v_dot2c_f32_bf16 v156, v184, v150
    v_dot2c_f32_bf16 v159, v185, v142
    v_dot2c_f32_bf16 v158, v185, v150
    v_dot2c_f32_bf16 v161, v186, v142
    v_dot2c_f32_bf16 v160, v186, v150
    v_dot2c_f32_bf16 v163, v187, v142
    v_dot2c_f32_bf16 v162, v187, v150
    v_lshrrev_b32 v151, 16, v143
    v_dot2c_f32_bf16 v157, v172, v143
    v_dot2c_f32_bf16 v156, v172, v151
    v_dot2c_f32_bf16 v159, v173, v143
    v_dot2c_f32_bf16 v158, v173, v151
    v_dot2c_f32_bf16 v161, v174, v143
    v_dot2c_f32_bf16 v160, v174, v151
    v_dot2c_f32_bf16 v163, v175, v143
    v_dot2c_f32_bf16 v162, v175, v151
    s_nop 0
    v_permlane32_swap_b32 v156, v160
    v_permlane32_swap_b32 v157, v161
    v_permlane32_swap_b32 v158, v162
    v_permlane32_swap_b32 v159, v163
    v_add_f32 v156, v156, v160
    v_add_f32 v157, v157, v161
    v_add_f32 v158, v158, v162
    v_add_f32 v159, v159, v163
    s_nop 0
    v_permlane16_swap_b32 v156, v158
    v_permlane16_swap_b32 v157, v159
    v_add_f32 v156, v156, v158
    v_add_f32 v157, v157, v159
    s_nop 0
    v_add_f32_dpp v156, v156, v156 row_ror:8 row_mask:0xf bank_mask:0xf
    v_add_f32_dpp v157, v157, v157 row_ror:8 row_mask:0xf bank_mask:0xf
    ds_write_b64 v2, v[156:157] offset:4096
    s_waitcnt lgkmcnt(0)
    s_barrier
    ds_read_b32 v156, v4 offset:4096
    ds_read_b32 v157, v4 offset:4352
    ds_read_b32 v158, v4 offset:4608
    ds_read_b32 v159, v4 offset:4864
    s_waitcnt lgkmcnt(1)
    v_add_f32 v156, v156, v158
    s_waitcnt lgkmcnt(0)
    v_add_f32 v157, v157, v159
    v_add_f32 v156, v156, v157
    v_or_b32 v156, 1, v156
    buffer_store_dword v156, v4, s[8:11], s25 offen sc1
    s_cmp_lg_u32 s101, s16
    s_cselect_b32 s23, s17, 0x7ffffff0
    s_barrier
    s_barrier
    buffer_store_dwordx4 v[56:59], v1, s[64:67], s23 offen offset:0 sc1
    buffer_store_dwordx4 v[60:63], v1, s[64:67], s23 offen offset:1024 sc1
    s_branch fz_end
fz_dn:
    v_sub_f32 v40, v24, v192
    v_sub_f32 v41, v25, v192
    v_sub_f32 v42, v26, v192
    v_sub_f32 v43, v27, v192
    v_sub_f32 v44, v28, v192
    v_sub_f32 v45, v29, v192
    v_sub_f32 v46, v30, v192
    v_sub_f32 v47, v31, v192
    v_cvt_pk_bf16_f32 v12, v40, v41
    v_lshlrev_b32 v40, 16, v12
    v_and_b32 v41, 0xffff0000, v12
    v_cvt_pk_bf16_f32 v12, v42, v43
    v_lshlrev_b32 v42, 16, v12
    v_and_b32 v43, 0xffff0000, v12
    v_cvt_pk_bf16_f32 v12, v44, v45
    v_lshlrev_b32 v44, 16, v12
    v_and_b32 v45, 0xffff0000, v12
    v_cvt_pk_bf16_f32 v12, v46, v47
    v_lshlrev_b32 v46, 16, v12
    v_and_b32 v47, 0xffff0000, v12
    v_mul_f32 v40, v40, v195
    v_mul_f32 v41, v41, v195
    v_mul_f32 v42, v42, v195
    v_mul_f32 v43, v43, v195
    v_mul_f32 v44, v44, v195
    v_mul_f32 v45, v45, v195
    v_mul_f32 v46, v46, v195
    v_mul_f32 v47, v47, v195
    v_cvt_pk_bf16_f32 v12, v40, v41
    v_lshlrev_b32 v40, 16, v12
    v_and_b32 v41, 0xffff0000, v12
    v_cvt_pk_bf16_f32 v12, v42, v43
    v_lshlrev_b32 v42, 16, v12
    v_and_b32 v43, 0xffff0000, v12
    v_cvt_pk_bf16_f32 v12, v44, v45
    v_lshlrev_b32 v44, 16, v12
    v_and_b32 v45, 0xffff0000, v12
    v_cvt_pk_bf16_f32 v12, v46, v47
    v_lshlrev_b32 v46, 16, v12
    v_and_b32 v47, 0xffff0000, v12
    v_lshlrev_b32 v48, 16, v80
    v_and_b32 v49, 0xffff0000, v80
    v_lshlrev_b32 v50, 16, v81
    v_and_b32 v51, 0xffff0000, v81
    v_lshlrev_b32 v52, 16, v82
    v_and_b32 v53, 0xffff0000, v82
    v_lshlrev_b32 v54, 16, v83
    v_and_b32 v55, 0xffff0000, v83
    v_pk_mul_f32 v[40:41], v[40:41], v[48:49]
    v_pk_mul_f32 v[42:43], v[42:43], v[50:51]
    v_pk_mul_f32 v[44:45], v[44:45], v[52:53]
    v_pk_mul_f32 v[46:47], v[46:47], v[54:55]
    v_cvt_pk_bf16_f32 v12, v40, v41
    v_lshlrev_b32 v40, 16, v12
    v_and_b32 v41, 0xffff0000, v12
    v_cvt_pk_bf16_f32 v12, v42, v43
    v_lshlrev_b32 v42, 16, v12
    v_and_b32 v43, 0xffff0000, v12
    v_cvt_pk_bf16_f32 v12, v44, v45
    v_lshlrev_b32 v44, 16, v12
    v_and_b32 v45, 0xffff0000, v12
    v_cvt_pk_bf16_f32 v12, v46, v47
    v_lshlrev_b32 v46, 16, v12
    v_and_b32 v47, 0xffff0000, v12
    v_lshlrev_b32 v48, 16, v72
    v_and_b32 v49, 0xffff0000, v72
    v_lshlrev_b32 v50, 16, v73
    v_and_b32 v51, 0xffff0000, v73
    v_lshlrev_b32 v52, 16, v74
    v_and_b32 v53, 0xffff0000, v74
    v_lshlrev_b32 v54, 16, v75
    v_and_b32 v55, 0xffff0000, v75
    v_pk_add_f32 v[40:41], v[40:41], v[48:49]
    v_pk_add_f32 v[42:43], v[42:43], v[50:51]
    v_pk_add_f32 v[44:45], v[44:45], v[52:53]
    v_pk_add_f32 v[46:47], v[46:47], v[54:55]
    v_cvt_pk_bf16_f32 v12, v40, v41
    v_lshlrev_b32 v40, 16, v12
    v_and_b32 v41, 0xffff0000, v12
    v_cvt_pk_bf16_f32 v12, v42, v43
    v_lshlrev_b32 v42, 16, v12
    v_and_b32 v43, 0xffff0000, v12
    v_cvt_pk_bf16_f32 v12, v44, v45
    v_lshlrev_b32 v44, 16, v12
    v_and_b32 v45, 0xffff0000, v12
    v_cvt_pk_bf16_f32 v12, v46, v47
    v_lshlrev_b32 v46, 16, v12
    v_and_b32 v47, 0xffff0000, v12
    v_lshlrev_b32 v48, 16, v88
    v_and_b32 v49, 0xffff0000, v88
    v_lshlrev_b32 v50, 16, v89
    v_and_b32 v51, 0xffff0000, v89
    v_lshlrev_b32 v52, 16, v90
    v_and_b32 v53, 0xffff0000, v90
    v_lshlrev_b32 v54, 16, v91
    v_and_b32 v55, 0xffff0000, v91
    v_pk_mul_f32 v[40:41], v[40:41], v[48:49]
    v_pk_mul_f32 v[42:43], v[42:43], v[50:51]
    v_pk_mul_f32 v[44:45], v[44:45], v[52:53]
    v_pk_mul_f32 v[46:47], v[46:47], v[54:55]
    v_cvt_pk_bf16_f32 v12, v40, v41
    v_lshlrev_b32 v40, 16, v12
    v_and_b32 v41, 0xffff0000, v12
    v_cvt_pk_bf16_f32 v12, v42, v43
    v_lshlrev_b32 v42, 16, v12
    v_and_b32 v43, 0xffff0000, v12
    v_cvt_pk_bf16_f32 v12, v44, v45
    v_lshlrev_b32 v44, 16, v12
    v_and_b32 v45, 0xffff0000, v12
    v_cvt_pk_bf16_f32 v12, v46, v47
    v_lshlrev_b32 v46, 16, v12
    v_and_b32 v47, 0xffff0000, v12
    v_pk_add_f32 v[40:41], v[40:41], v[24:25]
    v_pk_add_f32 v[42:43], v[42:43], v[26:27]
    v_pk_add_f32 v[44:45], v[44:45], v[28:29]
    v_pk_add_f32 v[46:47], v[46:47], v[30:31]
    v_cvt_pk_bf16_f32 v56, v40, v41
    v_cvt_pk_bf16_f32 v57, v42, v43
    v_cvt_pk_bf16_f32 v58, v44, v45
    v_cvt_pk_bf16_f32 v59, v46, v47
    v_sub_f32 v40, v32, v192
    v_sub_f32 v41, v33, v192
    v_sub_f32 v42, v34, v192
    v_sub_f32 v43, v35, v192
    v_sub_f32 v44, v36, v192
    v_sub_f32 v45, v37, v192
    v_sub_f32 v46, v38, v192
    v_sub_f32 v47, v39, v192
    v_cvt_pk_bf16_f32 v12, v40, v41
    v_lshlrev_b32 v40, 16, v12
    v_and_b32 v41, 0xffff0000, v12
    v_cvt_pk_bf16_f32 v12, v42, v43
    v_lshlrev_b32 v42, 16, v12
    v_and_b32 v43, 0xffff0000, v12
    v_cvt_pk_bf16_f32 v12, v44, v45
    v_lshlrev_b32 v44, 16, v12
    v_and_b32 v45, 0xffff0000, v12
    v_cvt_pk_bf16_f32 v12, v46, v47
    v_lshlrev_b32 v46, 16, v12
    v_and_b32 v47, 0xffff0000, v12
    v_mul_f32 v40, v40, v195
    v_mul_f32 v41, v41, v195
    v_mul_f32 v42, v42, v195
    v_mul_f32 v43, v43, v195
    v_mul_f32 v44, v44, v195
    v_mul_f32 v45, v45, v195
    v_mul_f32 v46, v46, v195
    v_mul_f32 v47, v47, v195
    v_cvt_pk_bf16_f32 v12, v40, v41
    v_lshlrev_b32 v40, 16, v12
    v_and_b32 v41, 0xffff0000, v12
    v_cvt_pk_bf16_f32 v12, v42, v43
    v_lshlrev_b32 v42, 16, v12
    v_and_b32 v43, 0xffff0000, v12
    v_cvt_pk_bf16_f32 v12, v44, v45
    v_lshlrev_b32 v44, 16, v12
    v_and_b32 v45, 0xffff0000, v12
    v_cvt_pk_bf16_f32 v12, v46, v47
    v_lshlrev_b32 v46, 16, v12
    v_and_b32 v47, 0xffff0000, v12
    v_lshlrev_b32 v48, 16, v84
    v_and_b32 v49, 0xffff0000, v84
    v_lshlrev_b32 v50, 16, v85
    v_and_b32 v51, 0xffff0000, v85
    v_lshlrev_b32 v52, 16, v86
    v_and_b32 v53, 0xffff0000, v86
    v_lshlrev_b32 v54, 16, v87
    v_and_b32 v55, 0xffff0000, v87
    v_pk_mul_f32 v[40:41], v[40:41], v[48:49]
    v_pk_mul_f32 v[42:43], v[42:43], v[50:51]
    v_pk_mul_f32 v[44:45], v[44:45], v[52:53]
    v_pk_mul_f32 v[46:47], v[46:47], v[54:55]
    v_cvt_pk_bf16_f32 v12, v40, v41
    v_lshlrev_b32 v40, 16, v12
    v_and_b32 v41, 0xffff0000, v12
    v_cvt_pk_bf16_f32 v12, v42, v43
    v_lshlrev_b32 v42, 16, v12
    v_and_b32 v43, 0xffff0000, v12
    v_cvt_pk_bf16_f32 v12, v44, v45
    v_lshlrev_b32 v44, 16, v12
    v_and_b32 v45, 0xffff0000, v12
    v_cvt_pk_bf16_f32 v12, v46, v47
    v_lshlrev_b32 v46, 16, v12
    v_and_b32 v47, 0xffff0000, v12
    v_lshlrev_b32 v48, 16, v76
    v_and_b32 v49, 0xffff0000, v76
    v_lshlrev_b32 v50, 16, v77
    v_and_b32 v51, 0xffff0000, v77
    v_lshlrev_b32 v52, 16, v78
    v_and_b32 v53, 0xffff0000, v78
    v_lshlrev_b32 v54, 16, v79
    v_and_b32 v55, 0xffff0000, v79
    v_pk_add_f32 v[40:41], v[40:41], v[48:49]
    v_pk_add_f32 v[42:43], v[42:43], v[50:51]
    v_pk_add_f32 v[44:45], v[44:45], v[52:53]
    v_pk_add_f32 v[46:47], v[46:47], v[54:55]
    v_cvt_pk_bf16_f32 v12, v40, v41
    v_lshlrev_b32 v40, 16, v12
    v_and_b32 v41, 0xffff0000, v12
    v_cvt_pk_bf16_f32 v12, v42, v43
    v_lshlrev_b32 v42, 16, v12
    v_and_b32 v43, 0xffff0000, v12
    v_cvt_pk_bf16_f32 v12, v44, v45
    v_lshlrev_b32 v44, 16, v12
    v_and_b32 v45, 0xffff0000, v12
    v_cvt_pk_bf16_f32 v12, v46, v47
    v_lshlrev_b32 v46, 16, v12
    v_and_b32 v47, 0xffff0000, v12
    v_lshlrev_b32 v48, 16, v92
    v_and_b32 v49, 0xffff0000, v92
    v_lshlrev_b32 v50, 16, v93
    v_and_b32 v51, 0xffff0000, v93
    v_lshlrev_b32 v52, 16, v94
    v_and_b32 v53, 0xffff0000, v94
    v_lshlrev_b32 v54, 16, v95
    v_and_b32 v55, 0xffff0000, v95
    v_pk_mul_f32 v[40:41], v[40:41], v[48:49]
    v_pk_mul_f32 v[42:43], v[42:43], v[50:51]
    v_pk_mul_f32 v[44:45], v[44:45], v[52:53]
    v_pk_mul_f32 v[46:47], v[46:47], v[54:55]
    v_cvt_pk_bf16_f32 v12, v40, v41
    v_lshlrev_b32 v40, 16, v12
    v_and_b32 v41, 0xffff0000, v12
    v_cvt_pk_bf16_f32 v12, v42, v43
    v_lshlrev_b32 v42, 16, v12
    v_and_b32 v43, 0xffff0000, v12
    v_cvt_pk_bf16_f32 v12, v44, v45
    v_lshlrev_b32 v44, 16, v12
    v_and_b32 v45, 0xffff0000, v12
    v_cvt_pk_bf16_f32 v12, v46, v47
    v_lshlrev_b32 v46, 16, v12
    v_and_b32 v47, 0xffff0000, v12
    v_pk_add_f32 v[40:41], v[40:41], v[32:33]
    v_pk_add_f32 v[42:43], v[42:43], v[34:35]
    v_pk_add_f32 v[44:45], v[44:45], v[36:37]
    v_pk_add_f32 v[46:47], v[46:47], v[38:39]
    v_cvt_pk_bf16_f32 v60, v40, v41
    v_cvt_pk_bf16_f32 v61, v42, v43
    v_cvt_pk_bf16_f32 v62, v44, v45
    v_cvt_pk_bf16_f32 v63, v46, v47
    s_barrier
    v_and_b32 v11, 3, v0
    v_lshlrev_b32 v11, 4, v11
    ds_read_b32 v144, v11 offset:256
    s_waitcnt lgkmcnt(0)
    v_mov_b32 v145, v144
    s_nop 1
    v_max_u32_dpp v145, v145, v145 row_ror:1 row_mask:0xf bank_mask:0xf
    s_nop 1
    v_max_u32_dpp v145, v145, v145 row_ror:2 row_mask:0xf bank_mask:0xf
    v_cmp_eq_u32 vcc, v144, v145
    s_ff1_i32_b64 s26, vcc
    s_lshl_b32 s26, s26, 4
    v_mov_b32 v11, s26
    ds_read_b128 v[20:23], v11 offset:256
    s_waitcnt lgkmcnt(0)
    v_and_b32 v144, 0x7ff, v20
    v_sub_u32 v144, 2047, v144
    s_nop 0
    v_readfirstlane_b32 s101, v144
    s_lshl_b32 s62, s101, 11
    v_rcp_f32 v167, v22
    s_cmp_lg_u32 s101, s16
    s_cselect_b32 s23, s17, 0x7ffffff0
    s_add_u32 s62, s62, s18
    v_lshlrev_b32 v12, 1, v0
    s_lshr_b32 s25, s101, 4
    s_lshl_b32 s25, s25, 15
    s_and_b32 s27, s101, 15
    s_lshl_b32 s27, s27, 6
    s_add_u32 s25, s25, s27
    s_add_u32 s25, s25, 0x2000000
    s_lshl_b32 s26, s99, 11
    s_add_u32 s25, s25, s26
    v_lshrrev_b32 v15, 5, v0
    v_lshlrev_b32 v15, 10, v15
    v_and_b32 v11, 63, v12
    v_add_u32 v15, v15, v11
    s_add_u32 s26, s25, 0x0
    buffer_load_ushort v40, v15, s[8:11], s26 offen sc1
    s_add_u32 s26, s25, 0x400000
    buffer_load_ushort v41, v15, s[8:11], s26 offen sc1
    s_add_u32 s26, s25, 0x800000
    buffer_load_ushort v42, v15, s[8:11], s26 offen sc1
    s_add_u32 s26, s25, 0xc00000
    buffer_load_ushort v43, v15, s[8:11], s26 offen sc1
    buffer_load_ushort v44, v12, s[28:31], s62 offen
    v_min_u32 v7, 223, v17
    v_lshlrev_b32 v7, 2, v7
    s_mul_i32 s24, s100, 896
    s_add_u32 s24, s24, 0xa10000
    v_mul_u32_u24 v11, 28, v13
    s_barrier
    s_mov_b32 s27, 0
fz_ap:
    s_add_u32 s25, s24, 0
    buffer_load_dword v120, v7, s[8:11], s25 offen sc1
    s_add_u32 s25, s24, 14336
    buffer_load_dword v121, v7, s[8:11], s25 offen sc1
    s_add_u32 s25, s24, 28672
    buffer_load_dword v122, v7, s[8:11], s25 offen sc1
    s_add_u32 s25, s24, 43008
    buffer_load_dword v123, v7, s[8:11], s25 offen sc1
    s_waitcnt vmcnt(2)
    v_min_u32 v124, v120, v121
    s_waitcnt vmcnt(0)
    v_min3_u32 v124, v124, v122, v123
    v_cmp_eq_u32 vcc, 0, v124
    s_add_u32 s27, s27, 1
    s_cmp_ge_u32 s27, 65536
    s_cbranch_scc1 fz_ag
    s_cbranch_vccz fz_ag
    s_branch fz_ap
fz_ag:
    v_add_f32 v120, v120, v121
    v_add_f32 v122, v122, v123
    v_cvt_pk_bf16_f32 v124, v120, v122
    v_lshlrev_b32 v120, 16, v124
    v_and_b32 v122, 0xffff0000, v124
    v_mul_f32 v124, 0xbfb8aa3b, v120
    v_exp_f32 v124, v124
    s_nop 0
    v_add_f32 v124, 1.0, v124
    v_rcp_f32 v124, v124
    s_nop 0
    v_mul_f32 v120, v120, v124
    v_cvt_pk_bf16_f32 v120, v120, v120
    v_lshlrev_b32 v120, 16, v120
    v_mul_f32 v120, v120, v122
    v_cvt_pk_bf16_f32 v120, v120, v120
    v_lshlrev_b32 v120, 16, v120
    ds_write_b32 v5, v120 offset:8192
    s_waitcnt lgkmcnt(0)
    s_barrier
    ds_read_b32 v128, v11 offset:8192
    ds_read_b32 v129, v11 offset:8196
    ds_read_b32 v130, v11 offset:8200
    ds_read_b32 v131, v11 offset:8204
    ds_read_b32 v132, v11 offset:8208
    ds_read_b32 v133, v11 offset:8212
    ds_read_b32 v134, v11 offset:8216
    s_lshl_b32 s24, s99, 12
    s_add_u32 s24, s24, 0xa00000
    s_lshl_b32 s25, s100, 8
    s_add_u32 s25, s25, s24
    s_waitcnt lgkmcnt(6)
    v_lshrrev_b32 v144, 16, v128
    v_dot2_f32_bf16 v157, v204, v128, 0
    v_dot2_f32_bf16 v156, v204, v144, 0
    v_dot2_f32_bf16 v159, v205, v128, 0
    v_dot2_f32_bf16 v158, v205, v144, 0
    v_dot2_f32_bf16 v161, v206, v128, 0
    v_dot2_f32_bf16 v160, v206, v144, 0
    v_dot2_f32_bf16 v163, v207, v128, 0
    v_dot2_f32_bf16 v162, v207, v144, 0
    s_waitcnt lgkmcnt(5)
    v_lshrrev_b32 v145, 16, v129
    v_dot2c_f32_bf16 v157, v208, v129
    v_dot2c_f32_bf16 v156, v208, v145
    v_dot2c_f32_bf16 v159, v209, v129
    v_dot2c_f32_bf16 v158, v209, v145
    v_dot2c_f32_bf16 v161, v210, v129
    v_dot2c_f32_bf16 v160, v210, v145
    v_dot2c_f32_bf16 v163, v211, v129
    v_dot2c_f32_bf16 v162, v211, v145
    s_waitcnt lgkmcnt(4)
    v_lshrrev_b32 v146, 16, v130
    v_dot2c_f32_bf16 v157, v212, v130
    v_dot2c_f32_bf16 v156, v212, v146
    v_dot2c_f32_bf16 v159, v213, v130
    v_dot2c_f32_bf16 v158, v213, v146
    v_dot2c_f32_bf16 v161, v214, v130
    v_dot2c_f32_bf16 v160, v214, v146
    v_dot2c_f32_bf16 v163, v215, v130
    v_dot2c_f32_bf16 v162, v215, v146
    s_waitcnt lgkmcnt(3)
    v_lshrrev_b32 v147, 16, v131
    v_dot2c_f32_bf16 v157, v216, v131
    v_dot2c_f32_bf16 v156, v216, v147
    v_dot2c_f32_bf16 v159, v217, v131
    v_dot2c_f32_bf16 v158, v217, v147
    v_dot2c_f32_bf16 v161, v218, v131
    v_dot2c_f32_bf16 v160, v218, v147
    v_dot2c_f32_bf16 v163, v219, v131
    v_dot2c_f32_bf16 v162, v219, v147
    s_waitcnt lgkmcnt(2)
    v_lshrrev_b32 v148, 16, v132
    v_dot2c_f32_bf16 v157, v220, v132
    v_dot2c_f32_bf16 v156, v220, v148
    v_dot2c_f32_bf16 v159, v221, v132
    v_dot2c_f32_bf16 v158, v221, v148
    v_dot2c_f32_bf16 v161, v222, v132
    v_dot2c_f32_bf16 v160, v222, v148
    v_dot2c_f32_bf16 v163, v223, v132
    v_dot2c_f32_bf16 v162, v223, v148
    s_waitcnt lgkmcnt(1)
    v_lshrrev_b32 v149, 16, v133
    v_dot2c_f32_bf16 v157, v224, v133
    v_dot2c_f32_bf16 v156, v224, v149
    v_dot2c_f32_bf16 v159, v225, v133
    v_dot2c_f32_bf16 v158, v225, v149
    v_dot2c_f32_bf16 v161, v226, v133
    v_dot2c_f32_bf16 v160, v226, v149
    v_dot2c_f32_bf16 v163, v227, v133
    v_dot2c_f32_bf16 v162, v227, v149
    s_waitcnt lgkmcnt(0)
    v_lshrrev_b32 v150, 16, v134
    v_dot2c_f32_bf16 v157, v228, v134
    v_dot2c_f32_bf16 v156, v228, v150
    v_dot2c_f32_bf16 v159, v229, v134
    v_dot2c_f32_bf16 v158, v229, v150
    v_dot2c_f32_bf16 v161, v230, v134
    v_dot2c_f32_bf16 v160, v230, v150
    v_dot2c_f32_bf16 v163, v231, v134
    v_dot2c_f32_bf16 v162, v231, v150
    s_nop 0
    v_permlane32_swap_b32 v156, v160
    v_permlane32_swap_b32 v157, v161
    v_permlane32_swap_b32 v158, v162
    v_permlane32_swap_b32 v159, v163
    v_add_f32 v156, v156, v160
    v_add_f32 v157, v157, v161
    v_add_f32 v158, v158, v162
    v_add_f32 v159, v159, v163
    s_nop 0
    v_permlane16_swap_b32 v156, v158
    v_permlane16_swap_b32 v157, v159
    v_add_f32 v156, v156, v158
    v_add_f32 v157, v157, v159
    s_nop 0
    v_add_f32_dpp v156, v156, v156 row_ror:8 row_mask:0xf bank_mask:0xf
    v_add_f32_dpp v157, v157, v157 row_ror:8 row_mask:0xf bank_mask:0xf
    ds_write_b64 v2, v[156:157] offset:12288
    s_waitcnt lgkmcnt(0)
    s_barrier
    ds_read_b32 v156, v4 offset:12288
    ds_read_b32 v157, v4 offset:12544
    ds_read_b32 v158, v4 offset:12800
    ds_read_b32 v159, v4 offset:13056
    s_waitcnt lgkmcnt(1)
    v_add_f32 v156, v156, v158
    s_waitcnt lgkmcnt(0)
    v_add_f32 v157, v157, v159
    v_add_f32 v156, v156, v157
    v_or_b32 v156, 1, v156
    s_cmp_eq_u32 s3, 0
    s_cselect_b32 s25, s25, 0x7ffffff0
    buffer_store_dword v156, v4, s[8:11], s25 offen sc1
    s_cmp_lg_u32 s101, s16
    s_cselect_b32 s23, s17, 0x7ffffff0
    buffer_store_dwordx4 v[56:59], v1, s[64:67], s23 offen offset:0 sc1
    buffer_store_dwordx4 v[60:63], v1, s[64:67], s23 offen offset:1024 sc1
    s_cmp_lg_u32 s3, 0
    s_cbranch_scc1 fz_end
    s_cmp_lg_u32 s100, 15
    s_cbranch_scc1 fz_end
    v_mov_b32 v190, v23
    v_cvt_pk_bf16_f32 v190, v190, v190
    v_lshlrev_b32 v190, 16, v190
    v_mul_f32 v190, 0xbfb8aa3b, v190
    v_exp_f32 v190, v190
    s_nop 0
    v_add_f32 v190, 1.0, v190
    v_rcp_f32 v190, v190
    s_nop 0
    v_cvt_pk_bf16_f32 v190, v190, v190
    v_lshlrev_b32 v190, 16, v190
    v_lshlrev_b32 v40, 16, v40
    v_lshlrev_b32 v41, 16, v41
    v_lshlrev_b32 v42, 16, v42
    v_lshlrev_b32 v43, 16, v43
    v_lshlrev_b32 v44, 16, v44
    v_add_f32 v188, v40, v41
    v_add_f32 v188, v188, v42
    v_add_f32 v188, v188, v43
    v_add_f32 v188, v44, v188
    v_cvt_pk_bf16_f32 v188, v188, v188
    v_lshlrev_b32 v188, 16, v188
    v_mov_b32 v189, v188
    v_mov_b32 v191, v188
    v_sub_f32 v189, v189, v21
    v_sub_f32 v191, v191, v21
    v_cvt_pk_bf16_f32 v148, v189, v191
    v_lshlrev_b32 v189, 16, v148
    v_and_b32 v191, 0xffff0000, v148
    v_mul_f32 v149, v189, v167
    v_fma_f32 v189, -v149, v22, v189
    v_fma_f32 v189, v189, v167, v149
    v_mul_f32 v149, v191, v167
    v_fma_f32 v191, -v149, v22, v191
    v_fma_f32 v191, v191, v167, v149
    v_cvt_pk_bf16_f32 v148, v189, v191
    v_lshlrev_b32 v189, 16, v148
    v_and_b32 v191, 0xffff0000, v148
    v_mul_f32 v189, v189, v125
    v_mul_f32 v191, v191, v125
    v_cvt_pk_bf16_f32 v148, v189, v191
    v_lshlrev_b32 v189, 16, v148
    v_and_b32 v191, 0xffff0000, v148
    v_add_f32 v189, v189, v126
    v_add_f32 v191, v191, v126
    v_cvt_pk_bf16_f32 v189, v189, v189
    v_lshlrev_b32 v189, 16, v189
    s_mov_b32 s27, 0
fz_yp:
    buffer_load_dword v104, v4, s[8:11], s24 offen offset:0 sc1
    buffer_load_dword v105, v4, s[8:11], s24 offen offset:256 sc1
    buffer_load_dword v106, v4, s[8:11], s24 offen offset:512 sc1
    buffer_load_dword v107, v4, s[8:11], s24 offen offset:768 sc1
    buffer_load_dword v108, v4, s[8:11], s24 offen offset:1024 sc1
    buffer_load_dword v109, v4, s[8:11], s24 offen offset:1280 sc1
    buffer_load_dword v110, v4, s[8:11], s24 offen offset:1536 sc1
    buffer_load_dword v111, v4, s[8:11], s24 offen offset:1792 sc1
    buffer_load_dword v112, v4, s[8:11], s24 offen offset:2048 sc1
    buffer_load_dword v113, v4, s[8:11], s24 offen offset:2304 sc1
    buffer_load_dword v114, v4, s[8:11], s24 offen offset:2560 sc1
    buffer_load_dword v115, v4, s[8:11], s24 offen offset:2816 sc1
    buffer_load_dword v116, v4, s[8:11], s24 offen offset:3072 sc1
    buffer_load_dword v117, v4, s[8:11], s24 offen offset:3328 sc1
    buffer_load_dword v118, v4, s[8:11], s24 offen offset:3584 sc1
    s_waitcnt vmcnt(12)
    v_min3_u32 v7, v104, v105, v106
    s_waitcnt vmcnt(10)
    v_min3_u32 v7, v7, v107, v108
    s_waitcnt vmcnt(8)
    v_min3_u32 v7, v7, v109, v110
    s_waitcnt vmcnt(6)
    v_min3_u32 v7, v7, v111, v112
    s_waitcnt vmcnt(4)
    v_min3_u32 v7, v7, v113, v114
    s_waitcnt vmcnt(2)
    v_min3_u32 v7, v7, v115, v116
    s_waitcnt vmcnt(0)
    v_min3_u32 v7, v7, v117, v118
    v_cmp_eq_u32 vcc, 0, v7
    s_add_u32 s27, s27, 1
    s_cmp_ge_u32 s27, 65536
    s_cbranch_scc1 fz_yg
    s_cbranch_vccz fz_yg
    s_branch fz_yp
fz_yg:
    v_mov_b32 v119, v156
    v_add_f32 v104, v104, v112
    v_add_f32 v105, v105, v113
    v_add_f32 v106, v106, v114
    v_add_f32 v107, v107, v115
    v_add_f32 v108, v108, v116
    v_add_f32 v109, v109, v117
    v_add_f32 v110, v110, v118
    v_add_f32 v111, v111, v119
    v_add_f32 v104, v104, v108
    v_add_f32 v105, v105, v109
    v_add_f32 v106, v106, v110
    v_add_f32 v107, v107, v111
    v_add_f32 v104, v104, v106
    v_add_f32 v105, v105, v107
    v_add_f32 v104, v104, v105
    v_cvt_pk_bf16_f32 v104, v104, v104
    v_lshlrev_b32 v104, 16, v104
    v_mul_f32 v104, v104, v190
    v_cvt_pk_bf16_f32 v104, v104, v104
    v_lshlrev_b32 v104, 16, v104
    v_add_f32 v104, v104, v189
    v_cvt_pk_bf16_f32 v104, v104, v104
    v_lshlrev_b32 v104, 16, v104
    v_mul_f32 v104, v104, v127
    v_cvt_pk_bf16_f32 v104, v104, v104
    v_lshlrev_b32 v104, 16, v104
    v_add_f32 v104, v104, v188
    v_cvt_pk_bf16_f32 v104, v104, v104
    buffer_store_short v104, v12, s[64:67], s62 offen sc1
    s_cmp_lg_u32 s99, 0
    s_cbranch_scc1 fz_end
    s_mov_b32 s26, 0x570000
    v_mov_b32 v7, s14
    s_mov_b64 exec, 1
    buffer_store_dword v7, v6, s[8:11], s26 offen sc1
    s_mov_b64 exec, -1
    s_branch fz_end
fz_slow:
    s_waitcnt vmcnt(0) lgkmcnt(0)
    s_nop 15
    s_nop 3
    s_cmp_eq_u32 s15, 0x7777
    s_cbranch_scc1 fz_epi
    s_mov_b32 s15, 0x7777
    v_add_u32 v5, s18, v1
    v_mov_b32 v9, 0xff7fffff
    v_mov_b32 v10, 0xff7fffff
    s_mov_b32 s22, 0
fz_s1:
    s_add_u32 s23, s22, 4096
    buffer_load_dwordx4 v[84:87], v5, s[8:11], s22 offen offset:0 sc1
    buffer_load_dwordx4 v[88:91], v5, s[8:11], s22 offen offset:1024 sc1
    buffer_load_dwordx4 v[92:95], v5, s[8:11], s22 offen offset:2048 sc1
    buffer_load_dwordx4 v[96:99], v5, s[8:11], s22 offen offset:3072 sc1
    buffer_load_dwordx4 v[100:103], v5, s[8:11], s23 offen offset:0 sc1
    buffer_load_dwordx4 v[104:107], v5, s[8:11], s23 offen offset:1024 sc1
    buffer_load_dwordx4 v[156:159], v5, s[8:11], s23 offen offset:2048 sc1
    buffer_load_dwordx4 v[160:163], v5, s[8:11], s23 offen offset:3072 sc1
    s_waitcnt vmcnt(7)
    v_mfma_f32_16x16x32_bf16 v[140:143], v[84:87], v[108:111], 0
    v_mfma_f32_16x16x32_bf16 v[144:147], v[84:87], v[124:127], 0
    s_waitcnt vmcnt(6)
    v_mfma_f32_16x16x32_bf16 v[148:151], v[88:91], v[108:111], 0
    v_mfma_f32_16x16x32_bf16 v[152:155], v[88:91], v[124:127], 0
    s_waitcnt vmcnt(5)
    v_mfma_f32_16x16x32_bf16 v[140:143], v[92:95], v[112:115], v[140:143]
    v_mfma_f32_16x16x32_bf16 v[144:147], v[92:95], v[128:131], v[144:147]
    s_waitcnt vmcnt(4)
    v_mfma_f32_16x16x32_bf16 v[148:151], v[96:99], v[112:115], v[148:151]
    v_mfma_f32_16x16x32_bf16 v[152:155], v[96:99], v[128:131], v[152:155]
    s_waitcnt vmcnt(3)
    v_mfma_f32_16x16x32_bf16 v[140:143], v[100:103], v[116:119], v[140:143]
    v_mfma_f32_16x16x32_bf16 v[144:147], v[100:103], v[132:135], v[144:147]
    s_waitcnt vmcnt(2)
    v_mfma_f32_16x16x32_bf16 v[148:151], v[104:107], v[116:119], v[148:151]
    v_mfma_f32_16x16x32_bf16 v[152:155], v[104:107], v[132:135], v[152:155]
    s_waitcnt vmcnt(1)
    v_mfma_f32_16x16x32_bf16 v[140:143], v[156:159], v[120:123], v[140:143]
    v_mfma_f32_16x16x32_bf16 v[144:147], v[156:159], v[136:139], v[144:147]
    s_waitcnt vmcnt(0)
    v_mfma_f32_16x16x32_bf16 v[148:151], v[160:163], v[120:123], v[148:151]
    v_mfma_f32_16x16x32_bf16 v[152:155], v[160:163], v[136:139], v[152:155]
    s_nop 3
    v_max3_f32 v9, v9, v140, v141
    v_max3_f32 v9, v9, v142, v143
    v_max3_f32 v10, v10, v144, v145
    v_max3_f32 v10, v10, v146, v147
    v_max3_f32 v9, v9, v148, v149
    v_max3_f32 v9, v9, v150, v151
    v_max3_f32 v10, v10, v152, v153
    v_max3_f32 v10, v10, v154, v155
    s_add_u32 s22, s22, 16384
    s_cmp_lt_u32 s22, 0x40000
    s_cbranch_scc1 fz_s1
    v_mov_b32 v11, v9
    v_mov_b32 v12, v10
    s_nop 0
    v_permlane16_swap_b32 v9, v11
    v_permlane16_swap_b32 v10, v12
    v_max_f32 v9, v9, v11
    v_max_f32 v10, v10, v12
    v_mov_b32 v11, v9
    v_mov_b32 v12, v10
    s_nop 0
    v_permlane32_swap_b32 v9, v11
    v_permlane32_swap_b32 v10, v12
    v_max_f32 v9, v9, v11
    v_max_f32 v10, v10, v12
    v_sub_f32 v172, 0, v9
    v_sub_f32 v173, 0, v9
    v_sub_f32 v174, 0, v9
    v_sub_f32 v175, 0, v9
    v_sub_f32 v176, 0, v10
    v_sub_f32 v177, 0, v10
    v_sub_f32 v178, 0, v10
    v_sub_f32 v179, 0, v10
    v_mov_b32 v20, 0
    v_mov_b32 v21, 0
    v_mov_b32 v22, 0
    v_mov_b32 v23, 0
    v_mov_b32 v24, 0
    v_mov_b32 v25, 0
    v_mov_b32 v26, 0
    v_mov_b32 v27, 0
    v_mov_b32 v28, 0
    v_mov_b32 v29, 0
    v_mov_b32 v30, 0
    v_mov_b32 v31, 0
    v_mov_b32 v32, 0
    v_mov_b32 v33, 0
    v_mov_b32 v34, 0
    v_mov_b32 v35, 0
    v_mov_b32 v36, 0
    v_mov_b32 v37, 0
    v_mov_b32 v38, 0
    v_mov_b32 v39, 0
    v_mov_b32 v40, 0
    v_mov_b32 v41, 0
    v_mov_b32 v42, 0
    v_mov_b32 v43, 0
    v_mov_b32 v44, 0
    v_mov_b32 v45, 0
    v_mov_b32 v46, 0
    v_mov_b32 v47, 0
    v_mov_b32 v48, 0
    v_mov_b32 v49, 0
    v_mov_b32 v50, 0
    v_mov_b32 v51, 0
    v_mov_b32 v52, 0
    v_mov_b32 v53, 0
    v_mov_b32 v54, 0
    v_mov_b32 v55, 0
    v_mov_b32 v56, 0
    v_mov_b32 v57, 0
    v_mov_b32 v58, 0
    v_mov_b32 v59, 0
    v_mov_b32 v60, 0
    v_mov_b32 v61, 0
    v_mov_b32 v62, 0
    v_mov_b32 v63, 0
    v_mov_b32 v64, 0
    v_mov_b32 v65, 0
    v_mov_b32 v66, 0
    v_mov_b32 v67, 0
    v_mov_b32 v68, 0
    v_mov_b32 v69, 0
    v_mov_b32 v70, 0
    v_mov_b32 v71, 0
    v_mov_b32 v72, 0
    v_mov_b32 v73, 0
    v_mov_b32 v74, 0
    v_mov_b32 v75, 0
    v_mov_b32 v76, 0
    v_mov_b32 v77, 0
    v_mov_b32 v78, 0
    v_mov_b32 v79, 0
    v_mov_b32 v80, 0
    v_mov_b32 v81, 0
    v_mov_b32 v82, 0
    v_mov_b32 v83, 0
    v_mov_b32 v15, 0
    v_mov_b32 v16, 0
    s_mov_b32 s22, 0
fz_s2:
    s_add_u32 s23, s22, 4096
    buffer_load_dwordx4 v[84:87], v5, s[8:11], s22 offen offset:0 sc1
    buffer_load_dwordx4 v[88:91], v5, s[8:11], s22 offen offset:1024 sc1
    buffer_load_dwordx4 v[92:95], v5, s[8:11], s22 offen offset:2048 sc1
    buffer_load_dwordx4 v[96:99], v5, s[8:11], s22 offen offset:3072 sc1
    buffer_load_dwordx4 v[100:103], v5, s[8:11], s23 offen offset:0 sc1
    buffer_load_dwordx4 v[104:107], v5, s[8:11], s23 offen offset:1024 sc1
    buffer_load_dwordx4 v[156:159], v5, s[8:11], s23 offen offset:2048 sc1
    buffer_load_dwordx4 v[160:163], v5, s[8:11], s23 offen offset:3072 sc1
    s_waitcnt vmcnt(7)
    v_mfma_f32_16x16x32_bf16 v[140:143], v[84:87], v[108:111], v[172:175]
    v_mfma_f32_16x16x32_bf16 v[144:147], v[84:87], v[124:127], v[176:179]
    s_waitcnt vmcnt(6)
    v_mfma_f32_16x16x32_bf16 v[148:151], v[88:91], v[108:111], v[172:175]
    v_mfma_f32_16x16x32_bf16 v[152:155], v[88:91], v[124:127], v[176:179]
    s_waitcnt vmcnt(5)
    v_mfma_f32_16x16x32_bf16 v[140:143], v[92:95], v[112:115], v[140:143]
    v_mfma_f32_16x16x32_bf16 v[144:147], v[92:95], v[128:131], v[144:147]
    s_waitcnt vmcnt(4)
    v_mfma_f32_16x16x32_bf16 v[148:151], v[96:99], v[112:115], v[148:151]
    v_mfma_f32_16x16x32_bf16 v[152:155], v[96:99], v[128:131], v[152:155]
    s_waitcnt vmcnt(3)
    v_mfma_f32_16x16x32_bf16 v[140:143], v[100:103], v[116:119], v[140:143]
    v_mfma_f32_16x16x32_bf16 v[144:147], v[100:103], v[132:135], v[144:147]
    s_waitcnt vmcnt(2)
    v_mfma_f32_16x16x32_bf16 v[148:151], v[104:107], v[116:119], v[148:151]
    v_mfma_f32_16x16x32_bf16 v[152:155], v[104:107], v[132:135], v[152:155]
    s_waitcnt vmcnt(1)
    v_mfma_f32_16x16x32_bf16 v[140:143], v[156:159], v[120:123], v[140:143]
    v_mfma_f32_16x16x32_bf16 v[144:147], v[156:159], v[136:139], v[144:147]
    s_waitcnt vmcnt(0)
    v_mfma_f32_16x16x32_bf16 v[148:151], v[160:163], v[120:123], v[148:151]
    v_mfma_f32_16x16x32_bf16 v[152:155], v[160:163], v[136:139], v[152:155]
    s_add_u32 s26, s22, 8192
    s_add_u32 s23, s22, 12288
    buffer_load_dwordx4 v[84:87], v5, s[8:11], s26 offen offset:0 sc1
    buffer_load_dwordx4 v[88:91], v5, s[8:11], s26 offen offset:1024 sc1
    buffer_load_dwordx4 v[92:95], v5, s[8:11], s26 offen offset:2048 sc1
    buffer_load_dwordx4 v[96:99], v5, s[8:11], s26 offen offset:3072 sc1
    buffer_load_dwordx4 v[100:103], v5, s[8:11], s23 offen offset:0 sc1
    buffer_load_dwordx4 v[104:107], v5, s[8:11], s23 offen offset:1024 sc1
    buffer_load_dwordx4 v[156:159], v5, s[8:11], s23 offen offset:2048 sc1
    buffer_load_dwordx4 v[160:163], v5, s[8:11], s23 offen offset:3072 sc1
    v_exp_f32 v140, v140
    v_exp_f32 v141, v141
    v_add_f32 v15, v15, v140
    v_add_f32 v15, v15, v141
    v_cvt_pk_bf16_f32 v188, v140, v141
    v_exp_f32 v142, v142
    v_exp_f32 v143, v143
    v_add_f32 v15, v15, v142
    v_add_f32 v15, v15, v143
    v_cvt_pk_bf16_f32 v189, v142, v143
    v_exp_f32 v144, v144
    v_exp_f32 v145, v145
    v_add_f32 v16, v16, v144
    v_add_f32 v16, v16, v145
    v_cvt_pk_bf16_f32 v192, v144, v145
    v_exp_f32 v146, v146
    v_exp_f32 v147, v147
    v_add_f32 v16, v16, v146
    v_add_f32 v16, v16, v147
    v_cvt_pk_bf16_f32 v193, v146, v147
    v_exp_f32 v148, v148
    v_exp_f32 v149, v149
    v_add_f32 v15, v15, v148
    v_add_f32 v15, v15, v149
    v_cvt_pk_bf16_f32 v190, v148, v149
    v_exp_f32 v150, v150
    v_exp_f32 v151, v151
    v_add_f32 v15, v15, v150
    v_add_f32 v15, v15, v151
    v_cvt_pk_bf16_f32 v191, v150, v151
    v_exp_f32 v152, v152
    v_exp_f32 v153, v153
    v_add_f32 v16, v16, v152
    v_add_f32 v16, v16, v153
    v_cvt_pk_bf16_f32 v194, v152, v153
    v_exp_f32 v154, v154
    v_exp_f32 v155, v155
    v_add_f32 v16, v16, v154
    v_add_f32 v16, v16, v155
    v_cvt_pk_bf16_f32 v195, v154, v155
    s_waitcnt vmcnt(7)
    v_mfma_f32_16x16x32_bf16 v[20:23], v[84:87], v[188:191], v[20:23]
    v_mfma_f32_16x16x32_bf16 v[24:27], v[84:87], v[192:195], v[24:27]
    s_waitcnt vmcnt(6)
    v_mfma_f32_16x16x32_bf16 v[28:31], v[88:91], v[188:191], v[28:31]
    v_mfma_f32_16x16x32_bf16 v[32:35], v[88:91], v[192:195], v[32:35]
    s_waitcnt vmcnt(5)
    v_mfma_f32_16x16x32_bf16 v[36:39], v[92:95], v[188:191], v[36:39]
    v_mfma_f32_16x16x32_bf16 v[40:43], v[92:95], v[192:195], v[40:43]
    s_waitcnt vmcnt(4)
    v_mfma_f32_16x16x32_bf16 v[44:47], v[96:99], v[188:191], v[44:47]
    v_mfma_f32_16x16x32_bf16 v[48:51], v[96:99], v[192:195], v[48:51]
    s_waitcnt vmcnt(3)
    v_mfma_f32_16x16x32_bf16 v[52:55], v[100:103], v[188:191], v[52:55]
    v_mfma_f32_16x16x32_bf16 v[56:59], v[100:103], v[192:195], v[56:59]
    s_waitcnt vmcnt(2)
    v_mfma_f32_16x16x32_bf16 v[60:63], v[104:107], v[188:191], v[60:63]
    v_mfma_f32_16x16x32_bf16 v[64:67], v[104:107], v[192:195], v[64:67]
    s_waitcnt vmcnt(1)
    v_mfma_f32_16x16x32_bf16 v[68:71], v[156:159], v[188:191], v[68:71]
    v_mfma_f32_16x16x32_bf16 v[72:75], v[156:159], v[192:195], v[72:75]
    s_waitcnt vmcnt(0)
    v_mfma_f32_16x16x32_bf16 v[76:79], v[160:163], v[188:191], v[76:79]
    v_mfma_f32_16x16x32_bf16 v[80:83], v[160:163], v[192:195], v[80:83]
    s_add_u32 s22, s22, 16384
    s_cmp_lt_u32 s22, 0x40000
    s_cbranch_scc1 fz_s2
    s_waitcnt vmcnt(0) lgkmcnt(0)
    s_nop 15
    s_nop 3
    s_branch fz_chk
fz_end:
    s_endpgm
.section .rodata,"a"
.p2align 6
.amdhsa_kernel adaLN_cond__sliding_block_cached__moe_arch_mod__prompt_kernel
  .amdhsa_next_free_vgpr 256
  .amdhsa_next_free_sgpr 102
  .amdhsa_accum_offset 256
  .amdhsa_group_segment_fixed_size 0
  .amdhsa_kernarg_size 120
  .amdhsa_user_sgpr_count 2
  .amdhsa_user_sgpr_kernarg_segment_ptr 1
  .amdhsa_system_sgpr_workgroup_id_x 1
  .amdhsa_float_denorm_mode_32 3
.end_amdhsa_kernel
```
